```python
import torch

def _softmax(x, axis=-1):
    return torch.softmax(x, dim=axis)

def _gelu(x):
    return torch.nn.functional.gelu(x, approximate='tanh')

def _silu(x):
    return torch.nn.functional.silu(x)

def _sigmoid(x):
    return torch.sigmoid(x)

def _layernorm(x, axis=-1, eps=1e-05):
    m = x.mean(dim=axis, keepdim=True)
    v = x.var(dim=axis, keepdim=True, unbiased=False)
    return (x - m) / torch.sqrt(v + eps)

def _scatter_add(tgt, idx, src, axis=0):
    return tgt.clone().index_add_(axis, idx, src)

def _segment_sum(src, seg, n):
    out = torch.zeros((n,) + src.shape[1:], dtype=src.dtype)
    return out.index_add_(0, seg, src)

def _pad(x, pw):
    flat = tuple((v for pair in reversed(pw) for v in pair))
    return torch.nn.functional.pad(x, flat)
kernel_name = 'adaLN_cond__memory_aug_recurrent_mem_tr__glu_gated_swiglu__prompt'

def setup_inputs():

    _w = lambda a: (lambda t: t.to(torch.bfloat16) if t.is_floating_point() else t)(torch.as_tensor(a))

    def _A_setup():
        B, S, Dm = (1, 2048, 1024)
        H, Dh = (32, 128)
        M, seg = (8, 32)
        seg = min(seg, S)
        S = S // seg * seg
        return {'x': _w((lambda *s: torch.randn(*s, dtype=torch.bfloat16) * 0.05)(B, S, Dm)), 'mem0': _w((lambda *s: torch.randn(*s, dtype=torch.bfloat16) * 0.8)(B, M, Dm)), 'Wq': _w((lambda *s: torch.randn(*s, dtype=torch.bfloat16) * 0.8)(Dm, H, Dh) * Dm ** (-0.5)), 'Wk': _w((lambda *s: torch.randn(*s, dtype=torch.bfloat16) * 0.8)(Dm, H, Dh) * Dm ** (-0.5)), 'Wv': _w((lambda *s: torch.randn(*s, dtype=torch.bfloat16) * 0.8)(Dm, H, Dh) * Dm ** (-0.5)), 'Wo': _w((lambda *s: torch.randn(*s, dtype=torch.bfloat16) * 0.8)(H, Dh, Dm) * (H * Dh) ** (-0.5)), 'seg_len': seg}
    _A_in = _A_setup()

    def _B_setup():
        B, S, D, F = (1, 2048, 1024, 3584)
        return {'x': _w((lambda *s: torch.randn(*s, dtype=torch.bfloat16) * 0.05)(B, S, D)), 'w1': _w((lambda *s: torch.randn(*s, dtype=torch.bfloat16) * 0.4)(D, F) * (2.0 / D) ** 0.5), 'w3': _w((lambda *s: torch.randn(*s, dtype=torch.bfloat16) * 0.4)(D, F) * (2.0 / D) ** 0.5), 'w2': _w((lambda *s: torch.randn(*s, dtype=torch.bfloat16) * 0.4)(F, D) * (2.0 / F) ** 0.5)}
    _B_in = _B_setup()
    return {'A_x': _A_in['x'], 'A_mem0': _A_in['mem0'], 'A_Wq': _A_in['Wq'], 'A_Wk': _A_in['Wk'], 'A_Wv': _A_in['Wv'], 'A_Wo': _A_in['Wo'], 'A_seg_len': _A_in['seg_len'], 'B_x': _B_in['x'], 'B_w1': _B_in['w1'], 'B_w3': _B_in['w3'], 'B_w2': _B_in['w2'], 'c': _w((lambda *s: torch.randn(*s, dtype=torch.bfloat16) * 0.1)(1, 1024) * 8.0), 'w_mod': _w((lambda *s: torch.randn(*s, dtype=torch.bfloat16) * 0.1)(1024, 6 * 1024) * 1024 ** (-0.5) * 8.0)}

def reference(A_x, A_mem0, A_Wq, A_Wk, A_Wv, A_Wo, A_seg_len, B_x, B_w1, B_w3, B_w2, c, w_mod):

    def _A_ref(x, mem0, Wq, Wk, Wv, Wo, seg_len):
        B, S, Dm = x.shape
        H, Dh = (Wq.shape[1], Wq.shape[2])
        M = mem0.shape[1]
        scale = Dh ** (-0.5)
        n_seg = S // seg_len
        L = M + seg_len
        idx = torch.arange(L)
        mask = (idx[:, None] < M) | (idx[:, None] >= idx[None, :])
        mem = mem0
        outs = []
        for s in range(n_seg):
            xs = x[:, s * seg_len:(s + 1) * seg_len, :].clone()
            h = torch.concatenate([mem, xs], axis=1)
            q = torch.einsum('btd,dhe->bhte', h, Wq)
            k = torch.einsum('btd,dhe->bhte', h, Wk)
            v = torch.einsum('btd,dhe->bhte', h, Wv)
            scores = torch.einsum('bhqe,bhke->bhqk', q, k) * scale
            scores = torch.where(mask[None, None], scores, -1000000000.0)
            p = _softmax(scores, axis=-1)
            o = torch.einsum('bhqk,bhke->bhqe', p, v)
            o = torch.einsum('bhte,hed->btd', o, Wo)
            mem = o[:, :M, :].clone()
            outs.append(o[:, M:, :])
        return torch.concatenate(outs, axis=1)

    def _B_ref(x, w1, w3, w2):
        gate = torch.einsum('bsd,df->bsf', x, w1)
        up = torch.einsum('bsd,df->bsf', x, w3)
        h = _silu(gate) * up
        out = torch.einsum('bsf,fd->bsd', h, w2)
        return out
    x = A_x
    mod = (_silu(c) @ w_mod).reshape(c.shape[0], 6, 1, -1)
    sa, ca, ga, sb, cb, gb = (mod[:, 0].clone(), mod[:, 1].clone(), mod[:, 2].clone(), mod[:, 3].clone(), mod[:, 4].clone(), mod[:, 5].clone())
    h = _layernorm(x, axis=-1) * (1 + ca) + sa
    x = x + ga * _A_ref(h, A_mem0, A_Wq, A_Wk, A_Wv, A_Wo, A_seg_len)
    h = _layernorm(x, axis=-1) * (1 + cb) + sb
    x = x + gb * _B_ref(h, B_w1, B_w3, B_w2)
    return x
```

```asm
; @launch grid=(256,1,1) block=(256,1,1) lds=163840
.amdgcn_target "amdgcn-amd-amdhsa--gfx950"
.text
.globl adaLN_cond__memory_aug_recurrent_mem_tr__glu_gated_swiglu__prompt_kernel
.p2align 8
.type adaLN_cond__memory_aug_recurrent_mem_tr__glu_gated_swiglu__prompt_kernel,@function
adaLN_cond__memory_aug_recurrent_mem_tr__glu_gated_swiglu__prompt_kernel:
  s_cmp_ge_u32 s2, 256
  s_cbranch_scc1 L_END
  s_load_dwordx2 s[4:5], s[0:1], 120
  s_load_dwordx2 s[12:13], s[0:1], 112
  v_lshrrev_b32 v1, 6, v0
  v_and_b32 v0, 63, v0
  v_readfirstlane_b32 s20, v1
  s_mov_b32 s6, 171966464
  s_mov_b32 s7, 0x20000
  s_mov_b32 s14, 256
  s_mov_b32 s15, 0x20000
  s_mov_b32 s24, 300000
  s_and_b32 s22, s2, 7
  s_lshr_b32 s23, s2, 3
  s_waitcnt lgkmcnt(0)
  s_add_u32 s4, s4, 0x1fffff
  s_addc_u32 s5, s5, 0
  s_and_b32 s4, s4, 0xffe00000
  s_cmp_ge_u32 s22, 4
  s_cbranch_scc1 L_TRAIL
  s_lshr_b32 s40, s22, 1
  s_bitcmp1_b32 s22, 0
  s_cbranch_scc0 L_REC
  s_lshl_b32 s40, s40, 5
  s_add_u32 s21, s40, s23
  s_branch L_QKV
L_REC:
  s_lshl_b32 s40, s40, 4
  s_lshr_b32 s41, s23, 1
  s_add_u32 s21, s40, s41
  s_bitcmp1_b32 s23, 0
  s_cbranch_scc1 L_VO
  s_branch L_QK
L_TRAIL:
  s_sub_u32 s40, s22, 4
  s_lshl_b32 s40, s40, 5
  s_add_u32 s21, s40, s23
  s_cmp_lg_u32 s22, 7
  s_cbranch_scc1 L_MOD
L_INIT:
  s_lshl_b32 s40, s23, 2
  s_add_u32 s40, s40, s20
  s_lshl_b32 s40, s40, 12
  s_add_u32 s41, s40, 1048576
  v_lshlrev_b32 v1, 4, v0
  v_mov_b32 v4, -1
  v_mov_b32 v5, -1
  v_mov_b32 v6, -1
  v_mov_b32 v7, -1
  buffer_store_dwordx4 v[4:7], v1, s[4:7], s40 offen offset:0 sc1
  buffer_store_dwordx4 v[4:7], v1, s[4:7], s40 offen offset:1024 sc1
  buffer_store_dwordx4 v[4:7], v1, s[4:7], s40 offen offset:2048 sc1
  buffer_store_dwordx4 v[4:7], v1, s[4:7], s40 offen offset:3072 sc1
  buffer_store_dwordx4 v[4:7], v1, s[4:7], s41 offen offset:0 sc1
  buffer_store_dwordx4 v[4:7], v1, s[4:7], s41 offen offset:1024 sc1
  buffer_store_dwordx4 v[4:7], v1, s[4:7], s41 offen offset:2048 sc1
  buffer_store_dwordx4 v[4:7], v1, s[4:7], s41 offen offset:3072 sc1
  s_lshl_b32 s40, s23, 2
  s_add_u32 s40, s40, 128
  v_mov_b32 v2, 2147483392
  s_mov_b64 exec, 1
  v_mov_b32 v2, s40
  s_mov_b64 exec, -1
  v_mov_b32 v3, 1
  s_waitcnt vmcnt(0)
  s_barrier
  s_cmp_lg_u32 s20, 0
  s_cbranch_scc1 L_LN1
  buffer_store_dword v3, v2, s[12:15], 0 offen sc1
  s_branch L_LN1
L_MOD:
  s_load_dwordx2 s[16:17], s[0:1], 88
  s_mov_b32 s18, 2048
  s_mov_b32 s19, 0x20000
  s_waitcnt lgkmcnt(0)
  s_load_dwordx2 s[8:9], s[0:1], 96
  s_mov_b32 s10, 12582912
  s_mov_b32 s11, 0x20000
  s_waitcnt lgkmcnt(0)
  s_lshl_b32 s40, s20, 9
  v_lshl_add_u32 v1, v0, 3, s40
  buffer_load_dwordx2 v[8:9], v1, s[16:19], 0 offen
  v_bfe_u32 v2, v0, 5, 1
  v_mul_u32_u24 v2, 98304, v2
  v_bfe_u32 v3, v0, 4, 1
  v_mul_u32_u24 v3, 24576, v3
  v_add_u32 v2, v2, v3
  v_bfe_u32 v3, v0, 3, 1
  v_mul_u32_u24 v3, 12288, v3
  v_add_u32 v2, v2, v3
  v_lshrrev_b32 v3, 3, v0
  v_and_b32 v3, 6, v3
  v_xor_b32 v3, v3, v0
  v_and_b32 v3, 7, v3
  v_lshl_add_u32 v2, v3, 4, v2
  s_lshr_b32 s40, s20, 1
  s_mul_i32 s40, s40, 49152
  s_and_b32 s41, s20, 1
  s_mul_i32 s41, s41, 196608
  s_add_u32 s40, s40, s41
  s_lshl_b32 s41, s21, 7
  s_add_u32 s40, s40, s41
  v_add_u32 v2, s40, v2
  s_lshl_b32 s41, s20, 10
  s_add_u32 m0, s41, 0
  s_mov_b32 s42, 0
  buffer_load_dwordx4 v2, s[8:11], s42 offen lds
  s_add_u32 m0, s41, 4096
  s_mov_b32 s42, 393216
  buffer_load_dwordx4 v2, s[8:11], s42 offen lds
  s_add_u32 m0, s41, 8192
  s_mov_b32 s42, 786432
  buffer_load_dwordx4 v2, s[8:11], s42 offen lds
  s_add_u32 m0, s41, 12288
  s_mov_b32 s42, 1179648
  buffer_load_dwordx4 v2, s[8:11], s42 offen lds
  s_add_u32 m0, s41, 16384
  s_mov_b32 s42, 1572864
  buffer_load_dwordx4 v2, s[8:11], s42 offen lds
  s_add_u32 m0, s41, 20480
  s_mov_b32 s42, 1966080
  buffer_load_dwordx4 v2, s[8:11], s42 offen lds
  s_add_u32 m0, s41, 24576
  s_mov_b32 s42, 2359296
  buffer_load_dwordx4 v2, s[8:11], s42 offen lds
  s_add_u32 m0, s41, 28672
  s_mov_b32 s42, 2752512
  buffer_load_dwordx4 v2, s[8:11], s42 offen lds
  s_add_u32 m0, s41, 32768
  s_mov_b32 s42, 3145728
  buffer_load_dwordx4 v2, s[8:11], s42 offen lds
  s_add_u32 m0, s41, 36864
  s_mov_b32 s42, 3538944
  buffer_load_dwordx4 v2, s[8:11], s42 offen lds
  s_add_u32 m0, s41, 40960
  s_mov_b32 s42, 3932160
  buffer_load_dwordx4 v2, s[8:11], s42 offen lds
  s_add_u32 m0, s41, 45056
  s_mov_b32 s42, 4325376
  buffer_load_dwordx4 v2, s[8:11], s42 offen lds
  s_add_u32 m0, s41, 49152
  s_mov_b32 s42, 4718592
  buffer_load_dwordx4 v2, s[8:11], s42 offen lds
  s_add_u32 m0, s41, 53248
  s_mov_b32 s42, 5111808
  buffer_load_dwordx4 v2, s[8:11], s42 offen lds
  s_add_u32 m0, s41, 57344
  s_mov_b32 s42, 5505024
  buffer_load_dwordx4 v2, s[8:11], s42 offen lds
  s_add_u32 m0, s41, 61440
  s_mov_b32 s42, 5898240
  buffer_load_dwordx4 v2, s[8:11], s42 offen lds
  s_add_u32 m0, s41, 65536
  s_mov_b32 s42, 6291456
  buffer_load_dwordx4 v2, s[8:11], s42 offen lds
  s_add_u32 m0, s41, 69632
  s_mov_b32 s42, 6684672
  buffer_load_dwordx4 v2, s[8:11], s42 offen lds
  s_add_u32 m0, s41, 73728
  s_mov_b32 s42, 7077888
  buffer_load_dwordx4 v2, s[8:11], s42 offen lds
  s_add_u32 m0, s41, 77824
  s_mov_b32 s42, 7471104
  buffer_load_dwordx4 v2, s[8:11], s42 offen lds
  s_add_u32 m0, s41, 81920
  s_mov_b32 s42, 7864320
  buffer_load_dwordx4 v2, s[8:11], s42 offen lds
  s_add_u32 m0, s41, 86016
  s_mov_b32 s42, 8257536
  buffer_load_dwordx4 v2, s[8:11], s42 offen lds
  s_add_u32 m0, s41, 90112
  s_mov_b32 s42, 8650752
  buffer_load_dwordx4 v2, s[8:11], s42 offen lds
  s_add_u32 m0, s41, 94208
  s_mov_b32 s42, 9043968
  buffer_load_dwordx4 v2, s[8:11], s42 offen lds
  s_add_u32 m0, s41, 98304
  s_mov_b32 s42, 9437184
  buffer_load_dwordx4 v2, s[8:11], s42 offen lds
  s_add_u32 m0, s41, 102400
  s_mov_b32 s42, 9830400
  buffer_load_dwordx4 v2, s[8:11], s42 offen lds
  s_add_u32 m0, s41, 106496
  s_mov_b32 s42, 10223616
  buffer_load_dwordx4 v2, s[8:11], s42 offen lds
  s_add_u32 m0, s41, 110592
  s_mov_b32 s42, 10616832
  buffer_load_dwordx4 v2, s[8:11], s42 offen lds
  s_add_u32 m0, s41, 114688
  s_mov_b32 s42, 11010048
  buffer_load_dwordx4 v2, s[8:11], s42 offen lds
  s_add_u32 m0, s41, 118784
  s_mov_b32 s42, 11403264
  buffer_load_dwordx4 v2, s[8:11], s42 offen lds
  s_add_u32 m0, s41, 122880
  s_mov_b32 s42, 11796480
  buffer_load_dwordx4 v2, s[8:11], s42 offen lds
  s_add_u32 m0, s41, 126976
  s_mov_b32 s42, 12189696
  buffer_load_dwordx4 v2, s[8:11], s42 offen lds
  v_bfe_u32 v3, v0, 3, 2
  v_xor_b32 v3, s20, v3
  v_lshlrev_b32 v3, 5, v3
  v_lshrrev_b32 v4, 2, v0
  v_lshl_add_u32 v4, v4, 7, v3
  v_and_b32 v3, 3, v0
  v_lshl_add_u32 v4, v3, 3, v4
  v_add_u32 v5, 0x10000, v4
  v_lshrrev_b32 v6, 4, v0
  v_lshlrev_b32 v6, 4, v6
  v_add_u32 v6, 0x20000, v6
  v_add_u32 v1, 0x20000, v1
  s_mov_b32 s37, 0xbfb8aa3b
  s_waitcnt vmcnt(32)
  v_lshlrev_b32 v10, 16, v8
  v_and_b32 v11, 0xffff0000, v8
  v_lshlrev_b32 v12, 16, v9
  v_and_b32 v13, 0xffff0000, v9
  v_mul_f32 v14, s37, v10
  v_mul_f32 v15, s37, v11
  v_mul_f32 v16, s37, v12
  v_mul_f32 v17, s37, v13
  v_exp_f32 v14, v14
  v_exp_f32 v15, v15
  v_exp_f32 v16, v16
  v_exp_f32 v17, v17
  v_add_f32 v14, 1.0, v14
  v_add_f32 v15, 1.0, v15
  v_add_f32 v16, 1.0, v16
  v_add_f32 v17, 1.0, v17
  v_rcp_f32 v14, v14
  v_rcp_f32 v15, v15
  v_rcp_f32 v16, v16
  v_rcp_f32 v17, v17
  v_mul_f32 v10, v10, v14
  v_mul_f32 v11, v11, v15
  v_mul_f32 v12, v12, v16
  v_mul_f32 v13, v13, v17
  v_cvt_pk_bf16_f32 v8, v10, v11
  v_cvt_pk_bf16_f32 v9, v12, v13
  ds_write_b64 v1, v[8:9]
  s_waitcnt vmcnt(28) lgkmcnt(0)
  s_barrier
  ds_read_b64_tr_b16 v[24:25], v4 offset:0
  ds_read_b64_tr_b16 v[26:27], v4 offset:2048
  ds_read_b128 v[28:31], v6 offset:0
  ds_read_b64_tr_b16 v[32:33], v4 offset:4096
  ds_read_b64_tr_b16 v[34:35], v4 offset:6144
  ds_read_b128 v[36:39], v6 offset:64
  ds_read_b64_tr_b16 v[40:41], v4 offset:8192
  ds_read_b64_tr_b16 v[42:43], v4 offset:10240
  ds_read_b128 v[44:47], v6 offset:128
  ds_read_b64_tr_b16 v[48:49], v4 offset:12288
  ds_read_b64_tr_b16 v[50:51], v4 offset:14336
  ds_read_b128 v[52:55], v6 offset:192
  s_waitcnt lgkmcnt(9)
  v_mfma_f32_16x16x32_bf16 v[20:23], v[24:27], v[28:31], 0
  s_waitcnt lgkmcnt(6)
  v_mfma_f32_16x16x32_bf16 v[20:23], v[32:35], v[36:39], v[20:23]
  s_waitcnt lgkmcnt(3)
  v_mfma_f32_16x16x32_bf16 v[20:23], v[40:43], v[44:47], v[20:23]
  s_waitcnt lgkmcnt(0)
  v_mfma_f32_16x16x32_bf16 v[20:23], v[48:51], v[52:55], v[20:23]
  s_waitcnt vmcnt(24) lgkmcnt(0)
  s_barrier
  ds_read_b64_tr_b16 v[24:25], v4 offset:16384
  ds_read_b64_tr_b16 v[26:27], v4 offset:18432
  ds_read_b128 v[28:31], v6 offset:256
  ds_read_b64_tr_b16 v[32:33], v4 offset:20480
  ds_read_b64_tr_b16 v[34:35], v4 offset:22528
  ds_read_b128 v[36:39], v6 offset:320
  ds_read_b64_tr_b16 v[40:41], v4 offset:24576
  ds_read_b64_tr_b16 v[42:43], v4 offset:26624
  ds_read_b128 v[44:47], v6 offset:384
  ds_read_b64_tr_b16 v[48:49], v4 offset:28672
  ds_read_b64_tr_b16 v[50:51], v4 offset:30720
  ds_read_b128 v[52:55], v6 offset:448
  s_waitcnt lgkmcnt(9)
  v_mfma_f32_16x16x32_bf16 v[20:23], v[24:27], v[28:31], v[20:23]
  s_waitcnt lgkmcnt(6)
  v_mfma_f32_16x16x32_bf16 v[20:23], v[32:35], v[36:39], v[20:23]
  s_waitcnt lgkmcnt(3)
  v_mfma_f32_16x16x32_bf16 v[20:23], v[40:43], v[44:47], v[20:23]
  s_waitcnt lgkmcnt(0)
  v_mfma_f32_16x16x32_bf16 v[20:23], v[48:51], v[52:55], v[20:23]
  s_waitcnt vmcnt(20) lgkmcnt(0)
  s_barrier
  ds_read_b64_tr_b16 v[24:25], v4 offset:32768
  ds_read_b64_tr_b16 v[26:27], v4 offset:34816
  ds_read_b128 v[28:31], v6 offset:512
  ds_read_b64_tr_b16 v[32:33], v4 offset:36864
  ds_read_b64_tr_b16 v[34:35], v4 offset:38912
  ds_read_b128 v[36:39], v6 offset:576
  ds_read_b64_tr_b16 v[40:41], v4 offset:40960
  ds_read_b64_tr_b16 v[42:43], v4 offset:43008
  ds_read_b128 v[44:47], v6 offset:640
  ds_read_b64_tr_b16 v[48:49], v4 offset:45056
  ds_read_b64_tr_b16 v[50:51], v4 offset:47104
  ds_read_b128 v[52:55], v6 offset:704
  s_waitcnt lgkmcnt(9)
  v_mfma_f32_16x16x32_bf16 v[20:23], v[24:27], v[28:31], v[20:23]
  s_waitcnt lgkmcnt(6)
  v_mfma_f32_16x16x32_bf16 v[20:23], v[32:35], v[36:39], v[20:23]
  s_waitcnt lgkmcnt(3)
  v_mfma_f32_16x16x32_bf16 v[20:23], v[40:43], v[44:47], v[20:23]
  s_waitcnt lgkmcnt(0)
  v_mfma_f32_16x16x32_bf16 v[20:23], v[48:51], v[52:55], v[20:23]
  s_waitcnt vmcnt(16) lgkmcnt(0)
  s_barrier
  ds_read_b64_tr_b16 v[24:25], v4 offset:49152
  ds_read_b64_tr_b16 v[26:27], v4 offset:51200
  ds_read_b128 v[28:31], v6 offset:768
  ds_read_b64_tr_b16 v[32:33], v4 offset:53248
  ds_read_b64_tr_b16 v[34:35], v4 offset:55296
  ds_read_b128 v[36:39], v6 offset:832
  ds_read_b64_tr_b16 v[40:41], v4 offset:57344
  ds_read_b64_tr_b16 v[42:43], v4 offset:59392
  ds_read_b128 v[44:47], v6 offset:896
  ds_read_b64_tr_b16 v[48:49], v4 offset:61440
  ds_read_b64_tr_b16 v[50:51], v4 offset:63488
  ds_read_b128 v[52:55], v6 offset:960
  s_waitcnt lgkmcnt(9)
  v_mfma_f32_16x16x32_bf16 v[20:23], v[24:27], v[28:31], v[20:23]
  s_waitcnt lgkmcnt(6)
  v_mfma_f32_16x16x32_bf16 v[20:23], v[32:35], v[36:39], v[20:23]
  s_waitcnt lgkmcnt(3)
  v_mfma_f32_16x16x32_bf16 v[20:23], v[40:43], v[44:47], v[20:23]
  s_waitcnt lgkmcnt(0)
  v_mfma_f32_16x16x32_bf16 v[20:23], v[48:51], v[52:55], v[20:23]
  s_waitcnt vmcnt(12) lgkmcnt(0)
  s_barrier
  ds_read_b64_tr_b16 v[24:25], v5 offset:0
  ds_read_b64_tr_b16 v[26:27], v5 offset:2048
  ds_read_b128 v[28:31], v6 offset:1024
  ds_read_b64_tr_b16 v[32:33], v5 offset:4096
  ds_read_b64_tr_b16 v[34:35], v5 offset:6144
  ds_read_b128 v[36:39], v6 offset:1088
  ds_read_b64_tr_b16 v[40:41], v5 offset:8192
  ds_read_b64_tr_b16 v[42:43], v5 offset:10240
  ds_read_b128 v[44:47], v6 offset:1152
  ds_read_b64_tr_b16 v[48:49], v5 offset:12288
  ds_read_b64_tr_b16 v[50:51], v5 offset:14336
  ds_read_b128 v[52:55], v6 offset:1216
  s_waitcnt lgkmcnt(9)
  v_mfma_f32_16x16x32_bf16 v[20:23], v[24:27], v[28:31], v[20:23]
  s_waitcnt lgkmcnt(6)
  v_mfma_f32_16x16x32_bf16 v[20:23], v[32:35], v[36:39], v[20:23]
  s_waitcnt lgkmcnt(3)
  v_mfma_f32_16x16x32_bf16 v[20:23], v[40:43], v[44:47], v[20:23]
  s_waitcnt lgkmcnt(0)
  v_mfma_f32_16x16x32_bf16 v[20:23], v[48:51], v[52:55], v[20:23]
  s_waitcnt vmcnt(8) lgkmcnt(0)
  s_barrier
  ds_read_b64_tr_b16 v[24:25], v5 offset:16384
  ds_read_b64_tr_b16 v[26:27], v5 offset:18432
  ds_read_b128 v[28:31], v6 offset:1280
  ds_read_b64_tr_b16 v[32:33], v5 offset:20480
  ds_read_b64_tr_b16 v[34:35], v5 offset:22528
  ds_read_b128 v[36:39], v6 offset:1344
  ds_read_b64_tr_b16 v[40:41], v5 offset:24576
  ds_read_b64_tr_b16 v[42:43], v5 offset:26624
  ds_read_b128 v[44:47], v6 offset:1408
  ds_read_b64_tr_b16 v[48:49], v5 offset:28672
  ds_read_b64_tr_b16 v[50:51], v5 offset:30720
  ds_read_b128 v[52:55], v6 offset:1472
  s_waitcnt lgkmcnt(9)
  v_mfma_f32_16x16x32_bf16 v[20:23], v[24:27], v[28:31], v[20:23]
  s_waitcnt lgkmcnt(6)
  v_mfma_f32_16x16x32_bf16 v[20:23], v[32:35], v[36:39], v[20:23]
  s_waitcnt lgkmcnt(3)
  v_mfma_f32_16x16x32_bf16 v[20:23], v[40:43], v[44:47], v[20:23]
  s_waitcnt lgkmcnt(0)
  v_mfma_f32_16x16x32_bf16 v[20:23], v[48:51], v[52:55], v[20:23]
  s_waitcnt vmcnt(4) lgkmcnt(0)
  s_barrier
  ds_read_b64_tr_b16 v[24:25], v5 offset:32768
  ds_read_b64_tr_b16 v[26:27], v5 offset:34816
  ds_read_b128 v[28:31], v6 offset:1536
  ds_read_b64_tr_b16 v[32:33], v5 offset:36864
  ds_read_b64_tr_b16 v[34:35], v5 offset:38912
  ds_read_b128 v[36:39], v6 offset:1600
  ds_read_b64_tr_b16 v[40:41], v5 offset:40960
  ds_read_b64_tr_b16 v[42:43], v5 offset:43008
  ds_read_b128 v[44:47], v6 offset:1664
  ds_read_b64_tr_b16 v[48:49], v5 offset:45056
  ds_read_b64_tr_b16 v[50:51], v5 offset:47104
  ds_read_b128 v[52:55], v6 offset:1728
  s_waitcnt lgkmcnt(9)
  v_mfma_f32_16x16x32_bf16 v[20:23], v[24:27], v[28:31], v[20:23]
  s_waitcnt lgkmcnt(6)
  v_mfma_f32_16x16x32_bf16 v[20:23], v[32:35], v[36:39], v[20:23]
  s_waitcnt lgkmcnt(3)
  v_mfma_f32_16x16x32_bf16 v[20:23], v[40:43], v[44:47], v[20:23]
  s_waitcnt lgkmcnt(0)
  v_mfma_f32_16x16x32_bf16 v[20:23], v[48:51], v[52:55], v[20:23]
  s_waitcnt vmcnt(0) lgkmcnt(0)
  s_barrier
  ds_read_b64_tr_b16 v[24:25], v5 offset:49152
  ds_read_b64_tr_b16 v[26:27], v5 offset:51200
  ds_read_b128 v[28:31], v6 offset:1792
  ds_read_b64_tr_b16 v[32:33], v5 offset:53248
  ds_read_b64_tr_b16 v[34:35], v5 offset:55296
  ds_read_b128 v[36:39], v6 offset:1856
  ds_read_b64_tr_b16 v[40:41], v5 offset:57344
  ds_read_b64_tr_b16 v[42:43], v5 offset:59392
  ds_read_b128 v[44:47], v6 offset:1920
  ds_read_b64_tr_b16 v[48:49], v5 offset:61440
  ds_read_b64_tr_b16 v[50:51], v5 offset:63488
  ds_read_b128 v[52:55], v6 offset:1984
  s_waitcnt lgkmcnt(9)
  v_mfma_f32_16x16x32_bf16 v[20:23], v[24:27], v[28:31], v[20:23]
  s_waitcnt lgkmcnt(6)
  v_mfma_f32_16x16x32_bf16 v[20:23], v[32:35], v[36:39], v[20:23]
  s_waitcnt lgkmcnt(3)
  v_mfma_f32_16x16x32_bf16 v[20:23], v[40:43], v[44:47], v[20:23]
  s_waitcnt lgkmcnt(0)
  v_mfma_f32_16x16x32_bf16 v[20:23], v[48:51], v[52:55], v[20:23]
  s_lshl_b32 s40, s21, 8
  s_lshl_b32 s41, s20, 6
  s_add_u32 s40, s40, s41
  s_add_u32 s40, s40, 1572864
  v_and_b32 v2, 15, v0
  v_cmp_eq_u32 vcc, 0, v2
  v_mov_b32 v3, 2147483392
  s_nop 0
  v_cndmask_b32 v1, v3, v0, vcc
  v_cvt_pk_bf16_f32 v8, v20, v21
  v_cvt_pk_bf16_f32 v9, v22, v23
  v_lshlrev_b32 v20, 16, v8
  v_and_b32 v21, 0xffff0000, v8
  v_lshlrev_b32 v22, 16, v9
  v_and_b32 v23, 0xffff0000, v9
  buffer_store_dwordx4 v[20:23], v1, s[4:7], s40 offen sc1
  v_min_u32 v2, 31, v0
  v_lshlrev_b32 v2, 2, v2
  v_add_u32 v2, 128, v2
  s_nop 1
Lpoll_1:
  buffer_load_dword v3, v2, s[12:15], 0 offen sc1
  s_sub_u32 s24, s24, 1
  s_cbranch_scc1 L_FAIL
  s_waitcnt vmcnt(0)
  v_cmp_gt_i32 vcc, 1, v3
  s_cbranch_vccz Lpolld_2
  s_sleep 2
  s_branch Lpoll_1
Lpolld_2:
  s_lshl_b32 s40, s21, 7
  s_add_u32 s40, s40, 1376256
  v_mov_b32 v2, 2147483392
  s_mov_b64 exec, 1
  v_mov_b32 v2, s40
  s_mov_b64 exec, -1
  v_mov_b32 v3, 1
  s_barrier
  s_cmp_lg_u32 s20, 0
  s_cbranch_scc1 L_LN1
  buffer_store_dword v3, v2, s[4:7], 0 offen sc1
L_LN1:
  s_load_dwordx2 s[16:17], s[0:1], 0
  s_mov_b32 s18, 4194304
  s_mov_b32 s19, 0x20000
  s_waitcnt lgkmcnt(0)
  s_sub_u32 s43, s22, 4
  s_lshl_b32 s43, s43, 5
  s_add_u32 s43, s43, s23
  s_lshl_b32 s43, s43, 2
  s_add_u32 s43, s43, s20
  s_lshl_b32 s44, s43, 13
  s_add_u32 s45, s44, 4096
  v_lshlrev_b32 v1, 3, v0
  v_lshlrev_b32 v2, 4, v0
  buffer_load_dwordx2 v[8:9], v1, s[16:19], s44 offen offset:0
  buffer_load_dwordx2 v[10:11], v1, s[16:19], s44 offen offset:512
  buffer_load_dwordx2 v[12:13], v1, s[16:19], s44 offen offset:1024
  buffer_load_dwordx2 v[14:15], v1, s[16:19], s44 offen offset:1536
  buffer_load_dwordx2 v[16:17], v1, s[16:19], s44 offen offset:2048
  buffer_load_dwordx2 v[18:19], v1, s[16:19], s44 offen offset:2560
  buffer_load_dwordx2 v[20:21], v1, s[16:19], s44 offen offset:3072
  buffer_load_dwordx2 v[22:23], v1, s[16:19], s44 offen offset:3584
  buffer_load_dwordx2 v[24:25], v1, s[16:19], s45 offen offset:0
  buffer_load_dwordx2 v[26:27], v1, s[16:19], s45 offen offset:512
  buffer_load_dwordx2 v[28:29], v1, s[16:19], s45 offen offset:1024
  buffer_load_dwordx2 v[30:31], v1, s[16:19], s45 offen offset:1536
  buffer_load_dwordx2 v[32:33], v1, s[16:19], s45 offen offset:2048
  buffer_load_dwordx2 v[34:35], v1, s[16:19], s45 offen offset:2560
  buffer_load_dwordx2 v[36:37], v1, s[16:19], s45 offen offset:3072
  buffer_load_dwordx2 v[38:39], v1, s[16:19], s45 offen offset:3584
  s_waitcnt vmcnt(0)
  v_lshlrev_b32 v40, 16, v8
  v_and_b32 v41, 0xffff0000, v8
  v_lshlrev_b32 v42, 16, v9
  v_and_b32 v43, 0xffff0000, v9
  v_lshlrev_b32 v44, 16, v10
  v_and_b32 v45, 0xffff0000, v10
  v_lshlrev_b32 v46, 16, v11
  v_and_b32 v47, 0xffff0000, v11
  v_lshlrev_b32 v48, 16, v12
  v_and_b32 v49, 0xffff0000, v12
  v_lshlrev_b32 v50, 16, v13
  v_and_b32 v51, 0xffff0000, v13
  v_lshlrev_b32 v52, 16, v14
  v_and_b32 v53, 0xffff0000, v14
  v_lshlrev_b32 v54, 16, v15
  v_and_b32 v55, 0xffff0000, v15
  v_lshlrev_b32 v56, 16, v16
  v_and_b32 v57, 0xffff0000, v16
  v_lshlrev_b32 v58, 16, v17
  v_and_b32 v59, 0xffff0000, v17
  v_lshlrev_b32 v60, 16, v18
  v_and_b32 v61, 0xffff0000, v18
  v_lshlrev_b32 v62, 16, v19
  v_and_b32 v63, 0xffff0000, v19
  v_lshlrev_b32 v64, 16, v20
  v_and_b32 v65, 0xffff0000, v20
  v_lshlrev_b32 v66, 16, v21
  v_and_b32 v67, 0xffff0000, v21
  v_lshlrev_b32 v68, 16, v22
  v_and_b32 v69, 0xffff0000, v22
  v_lshlrev_b32 v70, 16, v23
  v_and_b32 v71, 0xffff0000, v23
  v_lshlrev_b32 v72, 16, v24
  v_and_b32 v73, 0xffff0000, v24
  v_lshlrev_b32 v74, 16, v25
  v_and_b32 v75, 0xffff0000, v25
  v_lshlrev_b32 v76, 16, v26
  v_and_b32 v77, 0xffff0000, v26
  v_lshlrev_b32 v78, 16, v27
  v_and_b32 v79, 0xffff0000, v27
  v_lshlrev_b32 v80, 16, v28
  v_and_b32 v81, 0xffff0000, v28
  v_lshlrev_b32 v82, 16, v29
  v_and_b32 v83, 0xffff0000, v29
  v_lshlrev_b32 v84, 16, v30
  v_and_b32 v85, 0xffff0000, v30
  v_lshlrev_b32 v86, 16, v31
  v_and_b32 v87, 0xffff0000, v31
  v_lshlrev_b32 v88, 16, v32
  v_and_b32 v89, 0xffff0000, v32
  v_lshlrev_b32 v90, 16, v33
  v_and_b32 v91, 0xffff0000, v33
  v_lshlrev_b32 v92, 16, v34
  v_and_b32 v93, 0xffff0000, v34
  v_lshlrev_b32 v94, 16, v35
  v_and_b32 v95, 0xffff0000, v35
  v_lshlrev_b32 v96, 16, v36
  v_and_b32 v97, 0xffff0000, v36
  v_lshlrev_b32 v98, 16, v37
  v_and_b32 v99, 0xffff0000, v37
  v_lshlrev_b32 v100, 16, v38
  v_and_b32 v101, 0xffff0000, v38
  v_lshlrev_b32 v102, 16, v39
  v_and_b32 v103, 0xffff0000, v39
  v_pk_add_f32 v[104:105], v[40:41], v[42:43]
  v_pk_add_f32 v[108:109], v[56:57], v[58:59]
  v_pk_add_f32 v[112:113], v[72:73], v[74:75]
  v_pk_add_f32 v[116:117], v[88:89], v[90:91]
  v_pk_add_f32 v[104:105], v[104:105], v[44:45]
  v_pk_add_f32 v[108:109], v[108:109], v[60:61]
  v_pk_add_f32 v[112:113], v[112:113], v[76:77]
  v_pk_add_f32 v[116:117], v[116:117], v[92:93]
  v_pk_add_f32 v[104:105], v[104:105], v[46:47]
  v_pk_add_f32 v[108:109], v[108:109], v[62:63]
  v_pk_add_f32 v[112:113], v[112:113], v[78:79]
  v_pk_add_f32 v[116:117], v[116:117], v[94:95]
  v_pk_add_f32 v[104:105], v[104:105], v[48:49]
  v_pk_add_f32 v[108:109], v[108:109], v[64:65]
  v_pk_add_f32 v[112:113], v[112:113], v[80:81]
  v_pk_add_f32 v[116:117], v[116:117], v[96:97]
  v_pk_add_f32 v[104:105], v[104:105], v[50:51]
  v_pk_add_f32 v[108:109], v[108:109], v[66:67]
  v_pk_add_f32 v[112:113], v[112:113], v[82:83]
  v_pk_add_f32 v[116:117], v[116:117], v[98:99]
  v_pk_add_f32 v[104:105], v[104:105], v[52:53]
  v_pk_add_f32 v[108:109], v[108:109], v[68:69]
  v_pk_add_f32 v[112:113], v[112:113], v[84:85]
  v_pk_add_f32 v[116:117], v[116:117], v[100:101]
  v_pk_add_f32 v[104:105], v[104:105], v[54:55]
  v_pk_add_f32 v[108:109], v[108:109], v[70:71]
  v_pk_add_f32 v[112:113], v[112:113], v[86:87]
  v_pk_add_f32 v[116:117], v[116:117], v[102:103]
  v_add_f32 v104, v104, v105
  v_add_f32 v108, v108, v109
  v_add_f32 v112, v112, v113
  v_add_f32 v116, v116, v117
  v_add_f32_dpp v104, v104, v104 row_ror:8 row_mask:0xf bank_mask:0xf
  v_add_f32_dpp v108, v108, v108 row_ror:8 row_mask:0xf bank_mask:0xf
  v_add_f32_dpp v112, v112, v112 row_ror:8 row_mask:0xf bank_mask:0xf
  v_add_f32_dpp v116, v116, v116 row_ror:8 row_mask:0xf bank_mask:0xf
  v_add_f32_dpp v104, v104, v104 row_ror:4 row_mask:0xf bank_mask:0xf
  v_add_f32_dpp v108, v108, v108 row_ror:4 row_mask:0xf bank_mask:0xf
  v_add_f32_dpp v112, v112, v112 row_ror:4 row_mask:0xf bank_mask:0xf
  v_add_f32_dpp v116, v116, v116 row_ror:4 row_mask:0xf bank_mask:0xf
  v_add_f32_dpp v104, v104, v104 row_ror:2 row_mask:0xf bank_mask:0xf
  v_add_f32_dpp v108, v108, v108 row_ror:2 row_mask:0xf bank_mask:0xf
  v_add_f32_dpp v112, v112, v112 row_ror:2 row_mask:0xf bank_mask:0xf
  v_add_f32_dpp v116, v116, v116 row_ror:2 row_mask:0xf bank_mask:0xf
  v_add_f32_dpp v104, v104, v104 row_ror:1 row_mask:0xf bank_mask:0xf
  v_add_f32_dpp v108, v108, v108 row_ror:1 row_mask:0xf bank_mask:0xf
  v_add_f32_dpp v112, v112, v112 row_ror:1 row_mask:0xf bank_mask:0xf
  v_add_f32_dpp v116, v116, v116 row_ror:1 row_mask:0xf bank_mask:0xf
  v_mov_b32 v105, v104
  v_mov_b32 v109, v108
  v_mov_b32 v113, v112
  v_mov_b32 v117, v116
  v_permlane16_swap_b32 v105, v104
  v_permlane16_swap_b32 v109, v108
  v_permlane16_swap_b32 v113, v112
  v_permlane16_swap_b32 v117, v116
  v_add_f32 v104, v104, v105
  v_add_f32 v108, v108, v109
  v_add_f32 v112, v112, v113
  v_add_f32 v116, v116, v117
  v_mov_b32 v105, v104
  v_mov_b32 v109, v108
  v_mov_b32 v113, v112
  v_mov_b32 v117, v116
  v_permlane32_swap_b32 v105, v104
  v_permlane32_swap_b32 v109, v108
  v_permlane32_swap_b32 v113, v112
  v_permlane32_swap_b32 v117, v116
  v_add_f32 v104, v104, v105
  v_add_f32 v108, v108, v109
  v_add_f32 v112, v112, v113
  v_add_f32 v116, v116, v117
  v_mul_f32 v104, 0xba800000, v104
  v_mul_f32 v108, 0xba800000, v108
  v_mul_f32 v112, 0xba800000, v112
  v_mul_f32 v116, 0xba800000, v116
  v_pk_add_f32 v[40:41], v[40:41], v[104:105] op_sel_hi:[1,0]
  v_pk_add_f32 v[56:57], v[56:57], v[108:109] op_sel_hi:[1,0]
  v_pk_add_f32 v[72:73], v[72:73], v[112:113] op_sel_hi:[1,0]
  v_pk_add_f32 v[88:89], v[88:89], v[116:117] op_sel_hi:[1,0]
  v_pk_add_f32 v[42:43], v[42:43], v[104:105] op_sel_hi:[1,0]
  v_pk_add_f32 v[58:59], v[58:59], v[108:109] op_sel_hi:[1,0]
  v_pk_add_f32 v[74:75], v[74:75], v[112:113] op_sel_hi:[1,0]
  v_pk_add_f32 v[90:91], v[90:91], v[116:117] op_sel_hi:[1,0]
  v_pk_add_f32 v[44:45], v[44:45], v[104:105] op_sel_hi:[1,0]
  v_pk_add_f32 v[60:61], v[60:61], v[108:109] op_sel_hi:[1,0]
  v_pk_add_f32 v[76:77], v[76:77], v[112:113] op_sel_hi:[1,0]
  v_pk_add_f32 v[92:93], v[92:93], v[116:117] op_sel_hi:[1,0]
  v_pk_add_f32 v[46:47], v[46:47], v[104:105] op_sel_hi:[1,0]
  v_pk_add_f32 v[62:63], v[62:63], v[108:109] op_sel_hi:[1,0]
  v_pk_add_f32 v[78:79], v[78:79], v[112:113] op_sel_hi:[1,0]
  v_pk_add_f32 v[94:95], v[94:95], v[116:117] op_sel_hi:[1,0]
  v_pk_add_f32 v[48:49], v[48:49], v[104:105] op_sel_hi:[1,0]
  v_pk_add_f32 v[64:65], v[64:65], v[108:109] op_sel_hi:[1,0]
  v_pk_add_f32 v[80:81], v[80:81], v[112:113] op_sel_hi:[1,0]
  v_pk_add_f32 v[96:97], v[96:97], v[116:117] op_sel_hi:[1,0]
  v_pk_add_f32 v[50:51], v[50:51], v[104:105] op_sel_hi:[1,0]
  v_pk_add_f32 v[66:67], v[66:67], v[108:109] op_sel_hi:[1,0]
  v_pk_add_f32 v[82:83], v[82:83], v[112:113] op_sel_hi:[1,0]
  v_pk_add_f32 v[98:99], v[98:99], v[116:117] op_sel_hi:[1,0]
  v_pk_add_f32 v[52:53], v[52:53], v[104:105] op_sel_hi:[1,0]
  v_pk_add_f32 v[68:69], v[68:69], v[108:109] op_sel_hi:[1,0]
  v_pk_add_f32 v[84:85], v[84:85], v[112:113] op_sel_hi:[1,0]
  v_pk_add_f32 v[100:101], v[100:101], v[116:117] op_sel_hi:[1,0]
  v_pk_add_f32 v[54:55], v[54:55], v[104:105] op_sel_hi:[1,0]
  v_pk_add_f32 v[70:71], v[70:71], v[108:109] op_sel_hi:[1,0]
  v_pk_add_f32 v[86:87], v[86:87], v[112:113] op_sel_hi:[1,0]
  v_pk_add_f32 v[102:103], v[102:103], v[116:117] op_sel_hi:[1,0]
  v_pk_mul_f32 v[104:105], v[40:41], v[40:41]
  v_pk_mul_f32 v[108:109], v[56:57], v[56:57]
  v_pk_mul_f32 v[112:113], v[72:73], v[72:73]
  v_pk_mul_f32 v[116:117], v[88:89], v[88:89]
  v_pk_fma_f32 v[104:105], v[42:43], v[42:43], v[104:105]
  v_pk_fma_f32 v[108:109], v[58:59], v[58:59], v[108:109]
  v_pk_fma_f32 v[112:113], v[74:75], v[74:75], v[112:113]
  v_pk_fma_f32 v[116:117], v[90:91], v[90:91], v[116:117]
  v_pk_fma_f32 v[104:105], v[44:45], v[44:45], v[104:105]
  v_pk_fma_f32 v[108:109], v[60:61], v[60:61], v[108:109]
  v_pk_fma_f32 v[112:113], v[76:77], v[76:77], v[112:113]
  v_pk_fma_f32 v[116:117], v[92:93], v[92:93], v[116:117]
  v_pk_fma_f32 v[104:105], v[46:47], v[46:47], v[104:105]
  v_pk_fma_f32 v[108:109], v[62:63], v[62:63], v[108:109]
  v_pk_fma_f32 v[112:113], v[78:79], v[78:79], v[112:113]
  v_pk_fma_f32 v[116:117], v[94:95], v[94:95], v[116:117]
  v_pk_fma_f32 v[104:105], v[48:49], v[48:49], v[104:105]
  v_pk_fma_f32 v[108:109], v[64:65], v[64:65], v[108:109]
  v_pk_fma_f32 v[112:113], v[80:81], v[80:81], v[112:113]
  v_pk_fma_f32 v[116:117], v[96:97], v[96:97], v[116:117]
  v_pk_fma_f32 v[104:105], v[50:51], v[50:51], v[104:105]
  v_pk_fma_f32 v[108:109], v[66:67], v[66:67], v[108:109]
  v_pk_fma_f32 v[112:113], v[82:83], v[82:83], v[112:113]
  v_pk_fma_f32 v[116:117], v[98:99], v[98:99], v[116:117]
  v_pk_fma_f32 v[104:105], v[52:53], v[52:53], v[104:105]
  v_pk_fma_f32 v[108:109], v[68:69], v[68:69], v[108:109]
  v_pk_fma_f32 v[112:113], v[84:85], v[84:85], v[112:113]
  v_pk_fma_f32 v[116:117], v[100:101], v[100:101], v[116:117]
  v_pk_fma_f32 v[104:105], v[54:55], v[54:55], v[104:105]
  v_pk_fma_f32 v[108:109], v[70:71], v[70:71], v[108:109]
  v_pk_fma_f32 v[112:113], v[86:87], v[86:87], v[112:113]
  v_pk_fma_f32 v[116:117], v[102:103], v[102:103], v[116:117]
  v_add_f32 v104, v104, v105
  v_add_f32 v108, v108, v109
  v_add_f32 v112, v112, v113
  v_add_f32 v116, v116, v117
  v_add_f32_dpp v104, v104, v104 row_ror:8 row_mask:0xf bank_mask:0xf
  v_add_f32_dpp v108, v108, v108 row_ror:8 row_mask:0xf bank_mask:0xf
  v_add_f32_dpp v112, v112, v112 row_ror:8 row_mask:0xf bank_mask:0xf
  v_add_f32_dpp v116, v116, v116 row_ror:8 row_mask:0xf bank_mask:0xf
  v_add_f32_dpp v104, v104, v104 row_ror:4 row_mask:0xf bank_mask:0xf
  v_add_f32_dpp v108, v108, v108 row_ror:4 row_mask:0xf bank_mask:0xf
  v_add_f32_dpp v112, v112, v112 row_ror:4 row_mask:0xf bank_mask:0xf
  v_add_f32_dpp v116, v116, v116 row_ror:4 row_mask:0xf bank_mask:0xf
  v_add_f32_dpp v104, v104, v104 row_ror:2 row_mask:0xf bank_mask:0xf
  v_add_f32_dpp v108, v108, v108 row_ror:2 row_mask:0xf bank_mask:0xf
  v_add_f32_dpp v112, v112, v112 row_ror:2 row_mask:0xf bank_mask:0xf
  v_add_f32_dpp v116, v116, v116 row_ror:2 row_mask:0xf bank_mask:0xf
  v_add_f32_dpp v104, v104, v104 row_ror:1 row_mask:0xf bank_mask:0xf
  v_add_f32_dpp v108, v108, v108 row_ror:1 row_mask:0xf bank_mask:0xf
  v_add_f32_dpp v112, v112, v112 row_ror:1 row_mask:0xf bank_mask:0xf
  v_add_f32_dpp v116, v116, v116 row_ror:1 row_mask:0xf bank_mask:0xf
  v_mov_b32 v105, v104
  v_mov_b32 v109, v108
  v_mov_b32 v113, v112
  v_mov_b32 v117, v116
  v_permlane16_swap_b32 v105, v104
  v_permlane16_swap_b32 v109, v108
  v_permlane16_swap_b32 v113, v112
  v_permlane16_swap_b32 v117, v116
  v_add_f32 v104, v104, v105
  v_add_f32 v108, v108, v109
  v_add_f32 v112, v112, v113
  v_add_f32 v116, v116, v117
  v_mov_b32 v105, v104
  v_mov_b32 v109, v108
  v_mov_b32 v113, v112
  v_mov_b32 v117, v116
  v_permlane32_swap_b32 v105, v104
  v_permlane32_swap_b32 v109, v108
  v_permlane32_swap_b32 v113, v112
  v_permlane32_swap_b32 v117, v116
  v_add_f32 v104, v104, v105
  v_add_f32 v108, v108, v109
  v_add_f32 v112, v112, v113
  v_add_f32 v116, v116, v117
  v_mul_f32 v104, 0x3a800000, v104
  v_mul_f32 v108, 0x3a800000, v108
  v_mul_f32 v112, 0x3a800000, v112
  v_mul_f32 v116, 0x3a800000, v116
  v_add_f32 v104, 0x3727c5ac, v104
  v_add_f32 v108, 0x3727c5ac, v108
  v_add_f32 v112, 0x3727c5ac, v112
  v_add_f32 v116, 0x3727c5ac, v116
  v_rsq_f32 v104, v104
  v_rsq_f32 v108, v108
  v_rsq_f32 v112, v112
  v_rsq_f32 v116, v116
  v_pk_mul_f32 v[40:41], v[40:41], v[104:105] op_sel_hi:[1,0]
  v_pk_mul_f32 v[56:57], v[56:57], v[108:109] op_sel_hi:[1,0]
  v_pk_mul_f32 v[72:73], v[72:73], v[112:113] op_sel_hi:[1,0]
  v_pk_mul_f32 v[88:89], v[88:89], v[116:117] op_sel_hi:[1,0]
  v_pk_mul_f32 v[42:43], v[42:43], v[104:105] op_sel_hi:[1,0]
  v_pk_mul_f32 v[58:59], v[58:59], v[108:109] op_sel_hi:[1,0]
  v_pk_mul_f32 v[74:75], v[74:75], v[112:113] op_sel_hi:[1,0]
  v_pk_mul_f32 v[90:91], v[90:91], v[116:117] op_sel_hi:[1,0]
  v_pk_mul_f32 v[44:45], v[44:45], v[104:105] op_sel_hi:[1,0]
  v_pk_mul_f32 v[60:61], v[60:61], v[108:109] op_sel_hi:[1,0]
  v_pk_mul_f32 v[76:77], v[76:77], v[112:113] op_sel_hi:[1,0]
  v_pk_mul_f32 v[92:93], v[92:93], v[116:117] op_sel_hi:[1,0]
  v_pk_mul_f32 v[46:47], v[46:47], v[104:105] op_sel_hi:[1,0]
  v_pk_mul_f32 v[62:63], v[62:63], v[108:109] op_sel_hi:[1,0]
  v_pk_mul_f32 v[78:79], v[78:79], v[112:113] op_sel_hi:[1,0]
  v_pk_mul_f32 v[94:95], v[94:95], v[116:117] op_sel_hi:[1,0]
  v_pk_mul_f32 v[48:49], v[48:49], v[104:105] op_sel_hi:[1,0]
  v_pk_mul_f32 v[64:65], v[64:65], v[108:109] op_sel_hi:[1,0]
  v_pk_mul_f32 v[80:81], v[80:81], v[112:113] op_sel_hi:[1,0]
  v_pk_mul_f32 v[96:97], v[96:97], v[116:117] op_sel_hi:[1,0]
  v_pk_mul_f32 v[50:51], v[50:51], v[104:105] op_sel_hi:[1,0]
  v_pk_mul_f32 v[66:67], v[66:67], v[108:109] op_sel_hi:[1,0]
  v_pk_mul_f32 v[82:83], v[82:83], v[112:113] op_sel_hi:[1,0]
  v_pk_mul_f32 v[98:99], v[98:99], v[116:117] op_sel_hi:[1,0]
  v_pk_mul_f32 v[52:53], v[52:53], v[104:105] op_sel_hi:[1,0]
  v_pk_mul_f32 v[68:69], v[68:69], v[108:109] op_sel_hi:[1,0]
  v_pk_mul_f32 v[84:85], v[84:85], v[112:113] op_sel_hi:[1,0]
  v_pk_mul_f32 v[100:101], v[100:101], v[116:117] op_sel_hi:[1,0]
  v_pk_mul_f32 v[54:55], v[54:55], v[104:105] op_sel_hi:[1,0]
  v_pk_mul_f32 v[70:71], v[70:71], v[108:109] op_sel_hi:[1,0]
  v_pk_mul_f32 v[86:87], v[86:87], v[112:113] op_sel_hi:[1,0]
  v_pk_mul_f32 v[102:103], v[102:103], v[116:117] op_sel_hi:[1,0]
  v_min_u32 v3, 31, v0
  v_lshlrev_b32 v3, 2, v3
  v_add_u32 v3, 128, v3
  s_nop 1
Lpoll_3:
  buffer_load_dword v4, v3, s[12:15], 0 offen sc1
  s_sub_u32 s24, s24, 1
  s_cbranch_scc1 L_FAIL
  s_waitcnt vmcnt(0)
  v_cmp_gt_i32 vcc, 1, v4
  s_cbranch_vccz Lpolld_4
  s_sleep 2
  s_branch Lpoll_3
Lpolld_4:
  v_min_u32 v3, 31, v0
  v_lshlrev_b32 v3, 7, v3
  v_add_u32 v3, 1376256, v3
  s_nop 1
Lpoll_5:
  buffer_load_dword v4, v3, s[4:7], 0 offen sc1
  s_sub_u32 s24, s24, 1
  s_cbranch_scc1 L_FAIL
  s_waitcnt vmcnt(0)
  v_cmp_gt_i32 vcc, 1, v4
  s_cbranch_vccz Lpolld_6
  s_sleep 2
  s_branch Lpoll_5
Lpolld_6:
  s_mov_b32 s40, 1572864
  buffer_load_dwordx4 v[136:139], v2, s[4:7], s40 offen offset:0 sc1
  buffer_load_dwordx4 v[140:143], v2, s[4:7], s40 offen offset:1024 sc1
  buffer_load_dwordx4 v[144:147], v2, s[4:7], s40 offen offset:2048 sc1
  buffer_load_dwordx4 v[148:151], v2, s[4:7], s40 offen offset:3072 sc1
  s_mov_b32 s40, 1576960
  buffer_load_dwordx4 v[120:123], v2, s[4:7], s40 offen offset:0 sc1
  buffer_load_dwordx4 v[124:127], v2, s[4:7], s40 offen offset:1024 sc1
  buffer_load_dwordx4 v[128:131], v2, s[4:7], s40 offen offset:2048 sc1
  buffer_load_dwordx4 v[132:135], v2, s[4:7], s40 offen offset:3072 sc1
  s_waitcnt vmcnt(0)
  v_add_f32 v120, 1.0, v120
  v_add_f32 v121, 1.0, v121
  v_add_f32 v122, 1.0, v122
  v_add_f32 v123, 1.0, v123
  v_add_f32 v124, 1.0, v124
  v_add_f32 v125, 1.0, v125
  v_add_f32 v126, 1.0, v126
  v_add_f32 v127, 1.0, v127
  v_add_f32 v128, 1.0, v128
  v_add_f32 v129, 1.0, v129
  v_add_f32 v130, 1.0, v130
  v_add_f32 v131, 1.0, v131
  v_add_f32 v132, 1.0, v132
  v_add_f32 v133, 1.0, v133
  v_add_f32 v134, 1.0, v134
  v_add_f32 v135, 1.0, v135
  s_add_u32 s44, s44, 2097152
  s_add_u32 s45, s45, 2097152
  v_pk_fma_f32 v[40:41], v[40:41], v[120:121], v[136:137]
  v_pk_fma_f32 v[42:43], v[42:43], v[122:123], v[138:139]
  v_pk_fma_f32 v[44:45], v[44:45], v[124:125], v[140:141]
  v_pk_fma_f32 v[46:47], v[46:47], v[126:127], v[142:143]
  v_pk_fma_f32 v[48:49], v[48:49], v[128:129], v[144:145]
  v_pk_fma_f32 v[50:51], v[50:51], v[130:131], v[146:147]
  v_pk_fma_f32 v[52:53], v[52:53], v[132:133], v[148:149]
  v_pk_fma_f32 v[54:55], v[54:55], v[134:135], v[150:151]
  v_cvt_pk_bf16_f32 v8, v40, v41
  v_cvt_pk_bf16_f32 v9, v42, v43
  v_cvt_pk_bf16_f32 v10, v44, v45
  v_cvt_pk_bf16_f32 v11, v46, v47
  v_cvt_pk_bf16_f32 v12, v48, v49
  v_cvt_pk_bf16_f32 v13, v50, v51
  v_cvt_pk_bf16_f32 v14, v52, v53
  v_cvt_pk_bf16_f32 v15, v54, v55
  buffer_store_dwordx4 v[8:11], v2, s[4:7], s44 offen offset:0 sc1
  buffer_store_dwordx4 v[12:15], v2, s[4:7], s44 offen offset:1024 sc1
  v_pk_fma_f32 v[56:57], v[56:57], v[120:121], v[136:137]
  v_pk_fma_f32 v[58:59], v[58:59], v[122:123], v[138:139]
  v_pk_fma_f32 v[60:61], v[60:61], v[124:125], v[140:141]
  v_pk_fma_f32 v[62:63], v[62:63], v[126:127], v[142:143]
  v_pk_fma_f32 v[64:65], v[64:65], v[128:129], v[144:145]
  v_pk_fma_f32 v[66:67], v[66:67], v[130:131], v[146:147]
  v_pk_fma_f32 v[68:69], v[68:69], v[132:133], v[148:149]
  v_pk_fma_f32 v[70:71], v[70:71], v[134:135], v[150:151]
  v_cvt_pk_bf16_f32 v16, v56, v57
  v_cvt_pk_bf16_f32 v17, v58, v59
  v_cvt_pk_bf16_f32 v18, v60, v61
  v_cvt_pk_bf16_f32 v19, v62, v63
  v_cvt_pk_bf16_f32 v20, v64, v65
  v_cvt_pk_bf16_f32 v21, v66, v67
  v_cvt_pk_bf16_f32 v22, v68, v69
  v_cvt_pk_bf16_f32 v23, v70, v71
  buffer_store_dwordx4 v[16:19], v2, s[4:7], s44 offen offset:2048 sc1
  buffer_store_dwordx4 v[20:23], v2, s[4:7], s44 offen offset:3072 sc1
  v_pk_fma_f32 v[72:73], v[72:73], v[120:121], v[136:137]
  v_pk_fma_f32 v[74:75], v[74:75], v[122:123], v[138:139]
  v_pk_fma_f32 v[76:77], v[76:77], v[124:125], v[140:141]
  v_pk_fma_f32 v[78:79], v[78:79], v[126:127], v[142:143]
  v_pk_fma_f32 v[80:81], v[80:81], v[128:129], v[144:145]
  v_pk_fma_f32 v[82:83], v[82:83], v[130:131], v[146:147]
  v_pk_fma_f32 v[84:85], v[84:85], v[132:133], v[148:149]
  v_pk_fma_f32 v[86:87], v[86:87], v[134:135], v[150:151]
  v_cvt_pk_bf16_f32 v24, v72, v73
  v_cvt_pk_bf16_f32 v25, v74, v75
  v_cvt_pk_bf16_f32 v26, v76, v77
  v_cvt_pk_bf16_f32 v27, v78, v79
  v_cvt_pk_bf16_f32 v28, v80, v81
  v_cvt_pk_bf16_f32 v29, v82, v83
  v_cvt_pk_bf16_f32 v30, v84, v85
  v_cvt_pk_bf16_f32 v31, v86, v87
  buffer_store_dwordx4 v[24:27], v2, s[4:7], s45 offen offset:0 sc1
  buffer_store_dwordx4 v[28:31], v2, s[4:7], s45 offen offset:1024 sc1
  v_pk_fma_f32 v[88:89], v[88:89], v[120:121], v[136:137]
  v_pk_fma_f32 v[90:91], v[90:91], v[122:123], v[138:139]
  v_pk_fma_f32 v[92:93], v[92:93], v[124:125], v[140:141]
  v_pk_fma_f32 v[94:95], v[94:95], v[126:127], v[142:143]
  v_pk_fma_f32 v[96:97], v[96:97], v[128:129], v[144:145]
  v_pk_fma_f32 v[98:99], v[98:99], v[130:131], v[146:147]
  v_pk_fma_f32 v[100:101], v[100:101], v[132:133], v[148:149]
  v_pk_fma_f32 v[102:103], v[102:103], v[134:135], v[150:151]
  v_cvt_pk_bf16_f32 v32, v88, v89
  v_cvt_pk_bf16_f32 v33, v90, v91
  v_cvt_pk_bf16_f32 v34, v92, v93
  v_cvt_pk_bf16_f32 v35, v94, v95
  v_cvt_pk_bf16_f32 v36, v96, v97
  v_cvt_pk_bf16_f32 v37, v98, v99
  v_cvt_pk_bf16_f32 v38, v100, v101
  v_cvt_pk_bf16_f32 v39, v102, v103
  buffer_store_dwordx4 v[32:35], v2, s[4:7], s45 offen offset:2048 sc1
  buffer_store_dwordx4 v[36:39], v2, s[4:7], s45 offen offset:3072 sc1
  s_lshr_b32 s40, s43, 3
  s_lshl_b32 s40, s40, 7
  s_and_b32 s41, s43, 7
  s_lshl_b32 s41, s41, 2
  s_add_u32 s40, s40, s41
  s_add_u32 s40, s40, 1388544
  v_mov_b32 v3, 2147483392
  s_mov_b64 exec, 1
  v_mov_b32 v3, s40
  s_mov_b64 exec, -1
  v_mov_b32 v4, 1
  s_waitcnt vmcnt(0)
  buffer_store_dword v4, v3, s[4:7], 0 offen sc1
  s_mov_b32 s43, 32
  s_cmp_eq_u32 s22, 7
  s_cselect_b32 s43, 24, s43
  s_sub_u32 s40, s22, 5
  s_cmp_lt_u32 s40, 2
  s_cselect_b32 s43, 28, s43
  s_cmp_lt_u32 s23, s43
  s_cbranch_scc1 L_HEAVY
  s_sub_u32 s21, s23, s43
  s_cmp_eq_u32 s22, 7
  s_cbranch_scc1 L_AT
  s_lshl_b32 s40, s40, 2
  s_add_u32 s21, s21, s40
  s_branch L_LNF
L_HEAVY:
  v_mov_b32 v1, 1396736
  s_nop 1
Lpoll_7:
  buffer_load_dword v2, v1, s[4:7], 0 offen sc1
  s_sub_u32 s24, s24, 1
  s_cbranch_scc1 L_FAIL
  s_waitcnt vmcnt(0)
  v_cmp_gt_i32 vcc, 0, v2
  s_cbranch_vccz Lpolld_8
  s_sleep 8
  s_branch Lpoll_7
Lpolld_8:
  s_mov_b32 s21, s23
  s_cmp_eq_u32 s22, 4
  s_cbranch_scc1 L_WO
  s_cmp_eq_u32 s22, 7
  s_cbranch_scc1 L_F2
  s_sub_u32 s40, s22, 5
  s_mul_i32 s40, s40, 28
  s_add_u32 s21, s21, s40
  s_branch L_F1
L_FAIL:
  s_mov_b64 exec, -1
  s_lshl_b32 s40, s2, 8
  s_add_u32 s40, s40, s25
  s_add_u32 s40, s40, 0x70000000
  v_mov_b32 v1, 60
  v_mov_b32 v2, s40
  buffer_store_dword v2, v1, s[12:15], 0 offen
L_END:
  s_endpgm
L_AT:
  s_lshl_b32 s43, s21, 2
  s_add_u32 s43, s43, s20
  v_lshlrev_b32 v1, 4, v0
  v_lshlrev_b32 v2, 3, v0
  s_mul_i32 s26, s43, 24576
  s_add_u32 s26, s26, 58720256
  s_lshl_b32 s27, s43, 12
  s_add_u32 s27, s27, 14680064
  s_lshl_b32 s28, s43, 11
  s_add_u32 s28, s28, 23068672
  s_lshl_b32 s30, s43, 13
  s_add_u32 s30, s30, 27262976
  s_mov_b32 s25, 0
  s_mov_b32 s29, 1
  s_mov_b32 s38, 0x3e0293ee
  s_mov_b32 s39, s38
  s_lshl_b32 s44, s43, 1
  s_lshl_b32 s45, s43, 2
  v_mov_b32 v220, 0xd028965f
  v_min_u32 v3, 1, v0
  v_add_u32 v3, s44, v3
  v_lshlrev_b32 v3, 7, v3
  v_add_u32 v3, 1396736, v3
  v_min_u32 v4, 3, v0
  v_add_u32 v4, s45, v4
  v_lshlrev_b32 v4, 7, v4
  v_add_u32 v4, 1404928, v4
  s_lshl_b32 s40, s43, 7
  s_add_u32 s40, s40, 1421312
  v_mov_b32 v6, 2147483392
  s_mov_b64 exec, 1
  v_mov_b32 v6, s40
  s_mov_b64 exec, -1
  v_mov_b32 v120, 0
  v_mov_b32 v121, 0
  v_mov_b32 v122, 0
  v_mov_b32 v123, 0
  v_mov_b32 v124, 0
  v_mov_b32 v125, 0
  v_mov_b32 v126, 0
  v_mov_b32 v127, 0
  v_mov_b32 v128, 0
  v_mov_b32 v129, 0
  v_mov_b32 v130, 0
  v_mov_b32 v131, 0
  v_mov_b32 v132, 0
  v_mov_b32 v133, 0
  v_mov_b32 v134, 0
  v_mov_b32 v135, 0
  v_mov_b32 v158, 0
  v_mov_b32 v159, 0
  v_mov_b32 v164, 0
  v_mov_b32 v165, 0
  v_mov_b32 v166, 0
  v_mov_b32 v167, 0
  v_mov_b32 v168, 0
  v_mov_b32 v169, 0
  v_mov_b32 v170, 0
  v_mov_b32 v171, 0
  v_mov_b32 v172, 0
  v_mov_b32 v173, 0
  v_mov_b32 v174, 0
  v_mov_b32 v175, 0
  v_mov_b32 v176, 0
  v_mov_b32 v177, 0
  v_mov_b32 v178, 0
  v_mov_b32 v179, 0
  v_mov_b32 v180, 0x3f803f80
  v_mov_b32 v181, 0x3f803f80
  v_mov_b32 v182, 0x3f803f80
  v_mov_b32 v183, 0x3f803f80
  v_lshrrev_b32 v192, 4, v0
  v_lshlrev_b32 v192, 2, v192
  v_and_b32 v193, 15, v0
  v_sub_u32 v192, v193, v192
  v_cmp_le_i32 s[48:49], 0, v192
  v_cmp_le_i32 s[50:51], 1, v192
  v_cmp_le_i32 s[52:53], 2, v192
  v_cmp_le_i32 s[54:55], 3, v192
  s_nop 4
Lpoll_9:
  buffer_load_dword v5, v3, s[4:7], 0 offen sc1
  s_sub_u32 s24, s24, 1
  s_cbranch_scc1 L_FAIL
  s_waitcnt vmcnt(0)
  v_cmp_gt_i32 vcc, s29, v5
  s_cbranch_vccz Lpolld_10
  s_sleep 2
  s_branch Lpoll_9
Lpolld_10:
  s_add_u32 s40, s26, 8192
  buffer_load_dwordx4 v[40:43], v1, s[4:7], s40 offen offset:0 sc1
  buffer_load_dwordx4 v[44:47], v1, s[4:7], s40 offen offset:1024 sc1
  buffer_load_dwordx4 v[48:51], v1, s[4:7], s40 offen offset:2048 sc1
  buffer_load_dwordx4 v[52:55], v1, s[4:7], s40 offen offset:3072 sc1
  s_add_u32 s40, s26, 12288
  buffer_load_dwordx4 v[56:59], v1, s[4:7], s40 offen offset:0 sc1
  buffer_load_dwordx4 v[60:63], v1, s[4:7], s40 offen offset:1024 sc1
  buffer_load_dwordx4 v[64:67], v1, s[4:7], s40 offen offset:2048 sc1
  buffer_load_dwordx4 v[68:71], v1, s[4:7], s40 offen offset:3072 sc1
  s_add_u32 s40, s26, 0
  buffer_load_dwordx4 v[8:11], v1, s[4:7], s40 offen offset:0 sc1
  buffer_load_dwordx4 v[12:15], v1, s[4:7], s40 offen offset:1024 sc1
  buffer_load_dwordx4 v[16:19], v1, s[4:7], s40 offen offset:2048 sc1
  buffer_load_dwordx4 v[20:23], v1, s[4:7], s40 offen offset:3072 sc1
  s_add_u32 s40, s26, 4096
  buffer_load_dwordx4 v[24:27], v1, s[4:7], s40 offen offset:0 sc1
  buffer_load_dwordx4 v[28:31], v1, s[4:7], s40 offen offset:1024 sc1
  buffer_load_dwordx4 v[32:35], v1, s[4:7], s40 offen offset:2048 sc1
  buffer_load_dwordx4 v[36:39], v1, s[4:7], s40 offen offset:3072 sc1
  s_add_u32 s40, s26, 16384
  buffer_load_dwordx4 v[72:75], v1, s[4:7], s40 offen offset:0 sc1
  buffer_load_dwordx4 v[76:79], v1, s[4:7], s40 offen offset:1024 sc1
  buffer_load_dwordx4 v[80:83], v1, s[4:7], s40 offen offset:2048 sc1
  buffer_load_dwordx4 v[84:87], v1, s[4:7], s40 offen offset:3072 sc1
  s_add_u32 s40, s26, 20480
  buffer_load_dwordx4 v[88:91], v1, s[4:7], s40 offen offset:0 sc1
  buffer_load_dwordx4 v[92:95], v1, s[4:7], s40 offen offset:1024 sc1
  buffer_load_dwordx4 v[96:99], v1, s[4:7], s40 offen offset:2048 sc1
  buffer_load_dwordx4 v[100:103], v1, s[4:7], s40 offen offset:3072 sc1
  s_waitcnt vmcnt(8)
L_AT_top:
  s_add_u32 s26, s26, 786432
  s_add_u32 s31, s29, 1
  s_min_u32 s31, s31, 64
  v_mfma_f32_16x16x32_bf16 v[136:139], v[40:43], v[8:11], 0
  v_mfma_f32_16x16x32_bf16 v[140:143], v[40:43], v[12:15], 0
  v_mfma_f32_16x16x32_bf16 v[144:147], v[44:47], v[12:15], 0
  v_mfma_f32_16x16x32_bf16 v[136:139], v[48:51], v[16:19], v[136:139]
  v_mfma_f32_16x16x32_bf16 v[140:143], v[48:51], v[20:23], v[140:143]
  v_mfma_f32_16x16x32_bf16 v[144:147], v[52:55], v[20:23], v[144:147]
  v_mfma_f32_16x16x32_bf16 v[136:139], v[56:59], v[24:27], v[136:139]
  v_mfma_f32_16x16x32_bf16 v[140:143], v[56:59], v[28:31], v[140:143]
  v_mfma_f32_16x16x32_bf16 v[144:147], v[60:63], v[28:31], v[144:147]
  v_mfma_f32_16x16x32_bf16 v[136:139], v[64:67], v[32:35], v[136:139]
  v_mfma_f32_16x16x32_bf16 v[140:143], v[64:67], v[36:39], v[140:143]
  v_mfma_f32_16x16x32_bf16 v[144:147], v[68:71], v[36:39], v[144:147]
  s_nop 5
  v_cndmask_b32 v136, v220, v136, s[48:49]
  v_cndmask_b32 v137, v220, v137, s[50:51]
  v_cndmask_b32 v138, v220, v138, s[52:53]
  v_cndmask_b32 v139, v220, v139, s[54:55]
  v_cndmask_b32 v144, v220, v144, s[48:49]
  v_cndmask_b32 v145, v220, v145, s[50:51]
  v_cndmask_b32 v146, v220, v146, s[52:53]
  v_cndmask_b32 v147, v220, v147, s[54:55]
  v_max3_f32 v216, v136, v137, v138
  v_max3_f32 v218, v140, v141, v142
  v_max_f32 v216, v216, v139
  v_max3_f32 v218, v218, v143, v144
  v_max3_f32 v218, v218, v145, v146
  v_max_f32 v218, v218, v147
  s_nop 1
Lpoll_11:
  buffer_load_dword v5, v3, s[4:7], 0 offen sc1
  s_sub_u32 s24, s24, 1
  s_cbranch_scc1 L_FAIL
  s_waitcnt vmcnt(0)
  v_cmp_gt_i32 vcc, s31, v5
  s_cbranch_vccz Lpolld_12
  s_sleep 2
  s_branch Lpoll_11
Lpolld_12:
  s_add_u32 s40, s26, 8192
  buffer_load_dwordx4 v[40:43], v1, s[4:7], s40 offen offset:0 sc1
  buffer_load_dwordx4 v[44:47], v1, s[4:7], s40 offen offset:1024 sc1
  buffer_load_dwordx4 v[48:51], v1, s[4:7], s40 offen offset:2048 sc1
  buffer_load_dwordx4 v[52:55], v1, s[4:7], s40 offen offset:3072 sc1
  s_add_u32 s40, s26, 12288
  buffer_load_dwordx4 v[56:59], v1, s[4:7], s40 offen offset:0 sc1
  buffer_load_dwordx4 v[60:63], v1, s[4:7], s40 offen offset:1024 sc1
  buffer_load_dwordx4 v[64:67], v1, s[4:7], s40 offen offset:2048 sc1
  buffer_load_dwordx4 v[68:71], v1, s[4:7], s40 offen offset:3072 sc1
Lpoll_13:
  buffer_load_dword v5, v4, s[4:7], 0 offen sc1
  s_sub_u32 s24, s24, 1
  s_cbranch_scc1 L_FAIL
  s_waitcnt vmcnt(0)
  v_cmp_gt_i32 vcc, s29, v5
  s_cbranch_vccz Lpolld_14
  s_sleep 1
  s_branch Lpoll_13
Lpolld_14:
  buffer_load_dwordx4 v[104:107], v1, s[4:7], s27 offen offset:0 sc1
  buffer_load_dwordx4 v[108:111], v1, s[4:7], s27 offen offset:1024 sc1
  buffer_load_dwordx4 v[112:115], v1, s[4:7], s27 offen offset:2048 sc1
  buffer_load_dwordx4 v[116:119], v1, s[4:7], s27 offen offset:3072 sc1
  buffer_load_dwordx2 v[120:121], v2, s[4:7], s28 offen offset:0 sc1
  buffer_load_dwordx2 v[124:125], v2, s[4:7], s28 offen offset:512 sc1
  buffer_load_dwordx2 v[128:129], v2, s[4:7], s28 offen offset:1024 sc1
  buffer_load_dwordx2 v[132:133], v2, s[4:7], s28 offen offset:1536 sc1
  s_waitcnt vmcnt(7)
  v_mfma_f32_16x16x32_bf16 v[148:151], v[104:107], v[8:11], 0
  v_mfma_f32_16x16x32_bf16 v[152:155], v[104:107], v[12:15], 0
  s_waitcnt vmcnt(6)
  v_mfma_f32_16x16x32_bf16 v[148:151], v[108:111], v[16:19], v[148:151]
  v_mfma_f32_16x16x32_bf16 v[152:155], v[108:111], v[20:23], v[152:155]
  s_waitcnt vmcnt(5)
  v_mfma_f32_16x16x32_bf16 v[148:151], v[112:115], v[24:27], v[148:151]
  v_mfma_f32_16x16x32_bf16 v[152:155], v[112:115], v[28:31], v[152:155]
  s_waitcnt vmcnt(4)
  v_mfma_f32_16x16x32_bf16 v[148:151], v[116:119], v[32:35], v[148:151]
  v_mfma_f32_16x16x32_bf16 v[152:155], v[116:119], v[36:39], v[152:155]
  s_add_u32 s40, s26, 0
  buffer_load_dwordx4 v[8:11], v1, s[4:7], s40 offen offset:0 sc1
  buffer_load_dwordx4 v[12:15], v1, s[4:7], s40 offen offset:1024 sc1
  buffer_load_dwordx4 v[16:19], v1, s[4:7], s40 offen offset:2048 sc1
  buffer_load_dwordx4 v[20:23], v1, s[4:7], s40 offen offset:3072 sc1
  s_add_u32 s40, s26, 4096
  buffer_load_dwordx4 v[24:27], v1, s[4:7], s40 offen offset:0 sc1
  buffer_load_dwordx4 v[28:31], v1, s[4:7], s40 offen offset:1024 sc1
  buffer_load_dwordx4 v[32:35], v1, s[4:7], s40 offen offset:2048 sc1
  buffer_load_dwordx4 v[36:39], v1, s[4:7], s40 offen offset:3072 sc1
  v_max3_f32 v216, v216, v148, v149
  v_max3_f32 v218, v218, v152, v153
  v_mov_b32 v217, v216
  v_mov_b32 v219, v218
  s_nop 0
  v_permlane16_swap_b32 v217, v216
  v_permlane16_swap_b32 v219, v218
  v_max_f32 v216, v216, v217
  v_max_f32 v218, v218, v219
  v_mov_b32 v217, v216
  v_mov_b32 v219, v218
  s_nop 0
  v_permlane32_swap_b32 v217, v216
  v_permlane32_swap_b32 v219, v218
  v_max_f32 v216, v216, v217
  v_max_f32 v218, v218, v219
  v_mul_f32 v216, s38, v216
  v_mul_f32 v218, s38, v218
  v_pk_fma_f32 v[136:137], v[136:137], s[38:39], v[216:217] op_sel_hi:[1,1,0] neg_lo:[0,0,1] neg_hi:[0,0,1]
  v_pk_fma_f32 v[138:139], v[138:139], s[38:39], v[216:217] op_sel_hi:[1,1,0] neg_lo:[0,0,1] neg_hi:[0,0,1]
  v_pk_fma_f32 v[148:149], v[148:149], s[38:39], v[216:217] op_sel_hi:[1,1,0] neg_lo:[0,0,1] neg_hi:[0,0,1]
  v_pk_fma_f32 v[140:141], v[140:141], s[38:39], v[218:219] op_sel_hi:[1,1,0] neg_lo:[0,0,1] neg_hi:[0,0,1]
  v_pk_fma_f32 v[142:143], v[142:143], s[38:39], v[218:219] op_sel_hi:[1,1,0] neg_lo:[0,0,1] neg_hi:[0,0,1]
  v_pk_fma_f32 v[144:145], v[144:145], s[38:39], v[218:219] op_sel_hi:[1,1,0] neg_lo:[0,0,1] neg_hi:[0,0,1]
  v_pk_fma_f32 v[146:147], v[146:147], s[38:39], v[218:219] op_sel_hi:[1,1,0] neg_lo:[0,0,1] neg_hi:[0,0,1]
  v_pk_fma_f32 v[152:153], v[152:153], s[38:39], v[218:219] op_sel_hi:[1,1,0] neg_lo:[0,0,1] neg_hi:[0,0,1]
  v_exp_f32 v136, v136
  v_exp_f32 v137, v137
  v_exp_f32 v138, v138
  v_exp_f32 v139, v139
  v_exp_f32 v148, v148
  v_exp_f32 v149, v149
  v_exp_f32 v140, v140
  v_exp_f32 v141, v141
  v_exp_f32 v142, v142
  v_exp_f32 v143, v143
  v_exp_f32 v144, v144
  v_exp_f32 v145, v145
  v_exp_f32 v146, v146
  v_exp_f32 v147, v147
  v_exp_f32 v152, v152
  v_exp_f32 v153, v153
  v_cvt_pk_bf16_f32 v156, v136, v137
  v_cvt_pk_bf16_f32 v157, v138, v139
  v_cvt_pk_bf16_f32 v164, v148, v149
  v_cvt_pk_bf16_f32 v173, v148, v149
  v_cvt_pk_bf16_f32 v160, v140, v141
  v_cvt_pk_bf16_f32 v161, v142, v143
  v_cvt_pk_bf16_f32 v162, v144, v145
  v_cvt_pk_bf16_f32 v163, v146, v147
  v_cvt_pk_bf16_f32 v168, v152, v153
  v_cvt_pk_bf16_f32 v177, v152, v153
  v_mfma_f32_16x16x32_bf16 v[184:187], v[180:183], v[156:159], 0
  v_mfma_f32_16x16x32_bf16 v[188:191], v[180:183], v[160:163], 0
  v_mfma_f32_16x16x32_bf16 v[184:187], v[180:183], v[164:167], v[184:187]
  v_mfma_f32_16x16x32_bf16 v[188:191], v[180:183], v[168:171], v[188:191]
  s_waitcnt vmcnt(8)
  s_add_u32 s41, s30, 4096
  v_mfma_f32_16x16x32_bf16 v[192:195], v[72:75], v[156:159], 0
  v_mfma_f32_16x16x32_bf16 v[196:199], v[76:79], v[156:159], 0
  v_mfma_f32_16x16x32_bf16 v[192:195], v[120:123], v[164:167], v[192:195]
  v_mfma_f32_16x16x32_bf16 v[196:199], v[120:123], v[172:175], v[196:199]
  s_nop 0
  v_rcp_f32 v184, v184
  v_rcp_f32 v188, v188
  v_mfma_f32_16x16x32_bf16 v[200:203], v[72:75], v[160:163], 0
  v_mfma_f32_16x16x32_bf16 v[204:207], v[76:79], v[160:163], 0
  v_mfma_f32_16x16x32_bf16 v[200:203], v[120:123], v[168:171], v[200:203]
  v_mfma_f32_16x16x32_bf16 v[204:207], v[120:123], v[176:179], v[204:207]
  v_pk_mul_f32 v[192:193], v[192:193], v[184:185] op_sel_hi:[1,0]
  v_pk_mul_f32 v[194:195], v[194:195], v[184:185] op_sel_hi:[1,0]
  v_pk_mul_f32 v[196:197], v[196:197], v[184:185] op_sel_hi:[1,0]
  v_pk_mul_f32 v[198:199], v[198:199], v[184:185] op_sel_hi:[1,0]
  v_cvt_pk_bf16_f32 v208, v192, v193
  v_cvt_pk_bf16_f32 v209, v194, v195
  v_cvt_pk_bf16_f32 v210, v196, v197
  v_cvt_pk_bf16_f32 v211, v198, v199
  buffer_store_dwordx4 v[208:211], v1, s[4:7], s30 offen offset:0 sc1
  v_mfma_f32_16x16x32_bf16 v[192:195], v[80:83], v[156:159], 0
  v_mfma_f32_16x16x32_bf16 v[196:199], v[84:87], v[156:159], 0
  v_mfma_f32_16x16x32_bf16 v[192:195], v[124:127], v[164:167], v[192:195]
  v_mfma_f32_16x16x32_bf16 v[196:199], v[124:127], v[172:175], v[196:199]
  v_pk_mul_f32 v[200:201], v[200:201], v[188:189] op_sel_hi:[1,0]
  v_pk_mul_f32 v[202:203], v[202:203], v[188:189] op_sel_hi:[1,0]
  v_pk_mul_f32 v[204:205], v[204:205], v[188:189] op_sel_hi:[1,0]
  v_pk_mul_f32 v[206:207], v[206:207], v[188:189] op_sel_hi:[1,0]
  v_cvt_pk_bf16_f32 v212, v200, v201
  v_cvt_pk_bf16_f32 v213, v202, v203
  v_cvt_pk_bf16_f32 v214, v204, v205
  v_cvt_pk_bf16_f32 v215, v206, v207
  buffer_store_dwordx4 v[212:215], v1, s[4:7], s30 offen offset:1024 sc1
  v_mfma_f32_16x16x32_bf16 v[200:203], v[80:83], v[160:163], 0
  v_mfma_f32_16x16x32_bf16 v[204:207], v[84:87], v[160:163], 0
  v_mfma_f32_16x16x32_bf16 v[200:203], v[124:127], v[168:171], v[200:203]
  v_mfma_f32_16x16x32_bf16 v[204:207], v[124:127], v[176:179], v[204:207]
  v_pk_mul_f32 v[192:193], v[192:193], v[184:185] op_sel_hi:[1,0]
  v_pk_mul_f32 v[194:195], v[194:195], v[184:185] op_sel_hi:[1,0]
  v_pk_mul_f32 v[196:197], v[196:197], v[184:185] op_sel_hi:[1,0]
  v_pk_mul_f32 v[198:199], v[198:199], v[184:185] op_sel_hi:[1,0]
  v_cvt_pk_bf16_f32 v208, v192, v193
  v_cvt_pk_bf16_f32 v209, v194, v195
  v_cvt_pk_bf16_f32 v210, v196, v197
  v_cvt_pk_bf16_f32 v211, v198, v199
  buffer_store_dwordx4 v[208:211], v1, s[4:7], s30 offen offset:2048 sc1
  v_mfma_f32_16x16x32_bf16 v[192:195], v[88:91], v[156:159], 0
  v_mfma_f32_16x16x32_bf16 v[196:199], v[92:95], v[156:159], 0
  v_mfma_f32_16x16x32_bf16 v[192:195], v[128:131], v[164:167], v[192:195]
  v_mfma_f32_16x16x32_bf16 v[196:199], v[128:131], v[172:175], v[196:199]
  v_pk_mul_f32 v[200:201], v[200:201], v[188:189] op_sel_hi:[1,0]
  v_pk_mul_f32 v[202:203], v[202:203], v[188:189] op_sel_hi:[1,0]
  v_pk_mul_f32 v[204:205], v[204:205], v[188:189] op_sel_hi:[1,0]
  v_pk_mul_f32 v[206:207], v[206:207], v[188:189] op_sel_hi:[1,0]
  v_cvt_pk_bf16_f32 v212, v200, v201
  v_cvt_pk_bf16_f32 v213, v202, v203
  v_cvt_pk_bf16_f32 v214, v204, v205
  v_cvt_pk_bf16_f32 v215, v206, v207
  buffer_store_dwordx4 v[212:215], v1, s[4:7], s30 offen offset:3072 sc1
  v_mfma_f32_16x16x32_bf16 v[200:203], v[88:91], v[160:163], 0
  v_mfma_f32_16x16x32_bf16 v[204:207], v[92:95], v[160:163], 0
  v_mfma_f32_16x16x32_bf16 v[200:203], v[128:131], v[168:171], v[200:203]
  v_mfma_f32_16x16x32_bf16 v[204:207], v[128:131], v[176:179], v[204:207]
  v_pk_mul_f32 v[192:193], v[192:193], v[184:185] op_sel_hi:[1,0]
  v_pk_mul_f32 v[194:195], v[194:195], v[184:185] op_sel_hi:[1,0]
  v_pk_mul_f32 v[196:197], v[196:197], v[184:185] op_sel_hi:[1,0]
  v_pk_mul_f32 v[198:199], v[198:199], v[184:185] op_sel_hi:[1,0]
  v_cvt_pk_bf16_f32 v208, v192, v193
  v_cvt_pk_bf16_f32 v209, v194, v195
  v_cvt_pk_bf16_f32 v210, v196, v197
  v_cvt_pk_bf16_f32 v211, v198, v199
  buffer_store_dwordx4 v[208:211], v1, s[4:7], s41 offen offset:0 sc1
  v_mfma_f32_16x16x32_bf16 v[192:195], v[96:99], v[156:159], 0
  v_mfma_f32_16x16x32_bf16 v[196:199], v[100:103], v[156:159], 0
  v_mfma_f32_16x16x32_bf16 v[192:195], v[132:135], v[164:167], v[192:195]
  v_mfma_f32_16x16x32_bf16 v[196:199], v[132:135], v[172:175], v[196:199]
  v_pk_mul_f32 v[200:201], v[200:201], v[188:189] op_sel_hi:[1,0]
  v_pk_mul_f32 v[202:203], v[202:203], v[188:189] op_sel_hi:[1,0]
  v_pk_mul_f32 v[204:205], v[204:205], v[188:189] op_sel_hi:[1,0]
  v_pk_mul_f32 v[206:207], v[206:207], v[188:189] op_sel_hi:[1,0]
  v_cvt_pk_bf16_f32 v212, v200, v201
  v_cvt_pk_bf16_f32 v213, v202, v203
  v_cvt_pk_bf16_f32 v214, v204, v205
  v_cvt_pk_bf16_f32 v215, v206, v207
  buffer_store_dwordx4 v[212:215], v1, s[4:7], s41 offen offset:1024 sc1
  v_mfma_f32_16x16x32_bf16 v[200:203], v[96:99], v[160:163], 0
  v_mfma_f32_16x16x32_bf16 v[204:207], v[100:103], v[160:163], 0
  v_mfma_f32_16x16x32_bf16 v[200:203], v[132:135], v[168:171], v[200:203]
  v_mfma_f32_16x16x32_bf16 v[204:207], v[132:135], v[176:179], v[204:207]
  v_pk_mul_f32 v[192:193], v[192:193], v[184:185] op_sel_hi:[1,0]
  v_pk_mul_f32 v[194:195], v[194:195], v[184:185] op_sel_hi:[1,0]
  v_pk_mul_f32 v[196:197], v[196:197], v[184:185] op_sel_hi:[1,0]
  v_pk_mul_f32 v[198:199], v[198:199], v[184:185] op_sel_hi:[1,0]
  v_cvt_pk_bf16_f32 v208, v192, v193
  v_cvt_pk_bf16_f32 v209, v194, v195
  v_cvt_pk_bf16_f32 v210, v196, v197
  v_cvt_pk_bf16_f32 v211, v198, v199
  buffer_store_dwordx4 v[208:211], v1, s[4:7], s41 offen offset:2048 sc1
  v_pk_mul_f32 v[200:201], v[200:201], v[188:189] op_sel_hi:[1,0]
  v_pk_mul_f32 v[202:203], v[202:203], v[188:189] op_sel_hi:[1,0]
  v_pk_mul_f32 v[204:205], v[204:205], v[188:189] op_sel_hi:[1,0]
  v_pk_mul_f32 v[206:207], v[206:207], v[188:189] op_sel_hi:[1,0]
  v_cvt_pk_bf16_f32 v212, v200, v201
  v_cvt_pk_bf16_f32 v213, v202, v203
  v_cvt_pk_bf16_f32 v214, v204, v205
  v_cvt_pk_bf16_f32 v215, v206, v207
  buffer_store_dwordx4 v[212:215], v1, s[4:7], s41 offen offset:3072 sc1
  s_add_u32 s40, s26, 16384
  buffer_load_dwordx4 v[72:75], v1, s[4:7], s40 offen offset:0 sc1
  buffer_load_dwordx4 v[76:79], v1, s[4:7], s40 offen offset:1024 sc1
  buffer_load_dwordx4 v[80:83], v1, s[4:7], s40 offen offset:2048 sc1
  buffer_load_dwordx4 v[84:87], v1, s[4:7], s40 offen offset:3072 sc1
  s_add_u32 s40, s26, 20480
  buffer_load_dwordx4 v[88:91], v1, s[4:7], s40 offen offset:0 sc1
  buffer_load_dwordx4 v[92:95], v1, s[4:7], s40 offen offset:1024 sc1
  buffer_load_dwordx4 v[96:99], v1, s[4:7], s40 offen offset:2048 sc1
  buffer_load_dwordx4 v[100:103], v1, s[4:7], s40 offen offset:3072 sc1
  v_mov_b32 v5, s29
  s_waitcnt vmcnt(8)
  buffer_store_dword v5, v6, s[4:7], 0 offen sc1
  s_add_u32 s25, s25, 1
  s_add_u32 s29, s29, 1
  s_add_u32 s27, s27, 131072
  s_add_u32 s28, s28, 65536
  s_add_u32 s30, s30, 262144
  s_cmp_lt_u32 s25, 64
  s_cbranch_scc1 L_AT_top
  s_branch L_END
L_LNF:
  v_lshlrev_b32 v1, 3, v0
  v_lshlrev_b32 v2, 4, v0
  s_lshl_b32 s43, s21, 1
  s_and_b32 s40, s20, 1
  s_add_u32 s43, s43, s40
  s_lshl_b32 s26, s43, 12
  s_lshl_b32 s27, s43, 13
  s_mov_b32 s25, 0
  s_mov_b32 s29, 1
  v_min_u32 v3, 63, v0
  v_lshlrev_b32 v3, 7, v3
  v_add_u32 v3, 1380352, v3
  s_nop 1
Lpoll_15:
  buffer_load_dword v4, v3, s[4:7], 0 offen sc1
  s_sub_u32 s24, s24, 1
  s_cbranch_scc1 L_FAIL
  s_waitcnt vmcnt(0)
  v_cmp_gt_i32 vcc, 1, v4
  s_cbranch_vccz Lpolld_16
  s_sleep 2
  s_branch Lpoll_15
Lpolld_16:
  s_cmp_ge_u32 s20, 2
  s_cbranch_scc1 L_FIN
  s_mov_b32 s40, 1581056
  buffer_load_dwordx4 v[32:35], v2, s[4:7], s40 offen offset:0 sc1
  buffer_load_dwordx4 v[36:39], v2, s[4:7], s40 offen offset:1024 sc1
  buffer_load_dwordx4 v[40:43], v2, s[4:7], s40 offen offset:2048 sc1
  buffer_load_dwordx4 v[44:47], v2, s[4:7], s40 offen offset:3072 sc1
  s_mov_b32 s40, 1585152
  buffer_load_dwordx4 v[48:51], v2, s[4:7], s40 offen offset:0 sc1
  buffer_load_dwordx4 v[52:55], v2, s[4:7], s40 offen offset:1024 sc1
  buffer_load_dwordx4 v[56:59], v2, s[4:7], s40 offen offset:2048 sc1
  buffer_load_dwordx4 v[60:63], v2, s[4:7], s40 offen offset:3072 sc1
  s_mov_b32 s40, 1589248
  buffer_load_dwordx4 v[64:67], v2, s[4:7], s40 offen offset:0 sc1
  buffer_load_dwordx4 v[68:71], v2, s[4:7], s40 offen offset:1024 sc1
  buffer_load_dwordx4 v[72:75], v2, s[4:7], s40 offen offset:2048 sc1
  buffer_load_dwordx4 v[76:79], v2, s[4:7], s40 offen offset:3072 sc1
  s_waitcnt vmcnt(0)
  v_add_f32 v64, 1.0, v64
  v_add_f32 v65, 1.0, v65
  v_add_f32 v66, 1.0, v66
  v_add_f32 v67, 1.0, v67
  v_add_f32 v68, 1.0, v68
  v_add_f32 v69, 1.0, v69
  v_add_f32 v70, 1.0, v70
  v_add_f32 v71, 1.0, v71
  v_add_f32 v72, 1.0, v72
  v_add_f32 v73, 1.0, v73
  v_add_f32 v74, 1.0, v74
  v_add_f32 v75, 1.0, v75
  v_add_f32 v76, 1.0, v76
  v_add_f32 v77, 1.0, v77
  v_add_f32 v78, 1.0, v78
  v_add_f32 v79, 1.0, v79
  v_min_u32 v3, 31, v0
  v_lshlrev_b32 v3, 7, v3
  v_add_u32 v3, 1425408, v3
  s_lshl_b32 s40, s43, 7
  s_add_u32 s40, s40, 1429504
  s_add_u32 s27, s27, 109051904
  v_mov_b32 v5, 2147483392
  s_mov_b64 exec, 1
  v_mov_b32 v5, s40
  s_mov_b64 exec, -1
  s_nop 0
L_LN2_top:
  buffer_load_dwordx2 v[8:9], v1, s[16:19], s26 offen offset:0
  buffer_load_dwordx2 v[10:11], v1, s[16:19], s26 offen offset:512
  buffer_load_dwordx2 v[12:13], v1, s[16:19], s26 offen offset:1024
  buffer_load_dwordx2 v[14:15], v1, s[16:19], s26 offen offset:1536
  buffer_load_dwordx2 v[16:17], v1, s[16:19], s26 offen offset:2048
  buffer_load_dwordx2 v[18:19], v1, s[16:19], s26 offen offset:2560
  buffer_load_dwordx2 v[20:21], v1, s[16:19], s26 offen offset:3072
  buffer_load_dwordx2 v[22:23], v1, s[16:19], s26 offen offset:3584
Lpoll_17:
  buffer_load_dword v4, v3, s[4:7], 0 offen sc1
  s_sub_u32 s24, s24, 1
  s_cbranch_scc1 L_FAIL
  s_waitcnt vmcnt(0)
  v_cmp_gt_i32 vcc, s29, v4
  s_cbranch_vccz Lpolld_18
  s_sleep 2
  s_branch Lpoll_17
Lpolld_18:
  s_add_u32 s40, s27, 0
  buffer_load_dwordx4 v[80:83], v2, s[4:7], s40 offen offset:0 sc1
  buffer_load_dwordx4 v[84:87], v2, s[4:7], s40 offen offset:1024 sc1
  buffer_load_dwordx4 v[88:91], v2, s[4:7], s40 offen offset:2048 sc1
  buffer_load_dwordx4 v[92:95], v2, s[4:7], s40 offen offset:3072 sc1
  s_add_u32 s40, s27, 4096
  buffer_load_dwordx4 v[144:147], v2, s[4:7], s40 offen offset:0 sc1
  buffer_load_dwordx4 v[148:151], v2, s[4:7], s40 offen offset:1024 sc1
  buffer_load_dwordx4 v[152:155], v2, s[4:7], s40 offen offset:2048 sc1
  buffer_load_dwordx4 v[156:159], v2, s[4:7], s40 offen offset:3072 sc1
  s_add_u32 s40, s27, 131072
  buffer_load_dwordx4 v[96:99], v2, s[4:7], s40 offen offset:0 sc1
  buffer_load_dwordx4 v[100:103], v2, s[4:7], s40 offen offset:1024 sc1
  buffer_load_dwordx4 v[104:107], v2, s[4:7], s40 offen offset:2048 sc1
  buffer_load_dwordx4 v[108:111], v2, s[4:7], s40 offen offset:3072 sc1
  s_add_u32 s40, s27, 135168
  buffer_load_dwordx4 v[160:163], v2, s[4:7], s40 offen offset:0 sc1
  buffer_load_dwordx4 v[164:167], v2, s[4:7], s40 offen offset:1024 sc1
  buffer_load_dwordx4 v[168:171], v2, s[4:7], s40 offen offset:2048 sc1
  buffer_load_dwordx4 v[172:175], v2, s[4:7], s40 offen offset:3072 sc1
  s_add_u32 s40, s27, 262144
  buffer_load_dwordx4 v[112:115], v2, s[4:7], s40 offen offset:0 sc1
  buffer_load_dwordx4 v[116:119], v2, s[4:7], s40 offen offset:1024 sc1
  buffer_load_dwordx4 v[120:123], v2, s[4:7], s40 offen offset:2048 sc1
  buffer_load_dwordx4 v[124:127], v2, s[4:7], s40 offen offset:3072 sc1
  s_add_u32 s40, s27, 266240
  buffer_load_dwordx4 v[176:179], v2, s[4:7], s40 offen offset:0 sc1
  buffer_load_dwordx4 v[180:183], v2, s[4:7], s40 offen offset:1024 sc1
  buffer_load_dwordx4 v[184:187], v2, s[4:7], s40 offen offset:2048 sc1
  buffer_load_dwordx4 v[188:191], v2, s[4:7], s40 offen offset:3072 sc1
  s_add_u32 s40, s27, 393216
  buffer_load_dwordx4 v[128:131], v2, s[4:7], s40 offen offset:0 sc1
  buffer_load_dwordx4 v[132:135], v2, s[4:7], s40 offen offset:1024 sc1
  buffer_load_dwordx4 v[136:139], v2, s[4:7], s40 offen offset:2048 sc1
  buffer_load_dwordx4 v[140:143], v2, s[4:7], s40 offen offset:3072 sc1
  s_add_u32 s40, s27, 397312
  buffer_load_dwordx4 v[192:195], v2, s[4:7], s40 offen offset:0 sc1
  buffer_load_dwordx4 v[196:199], v2, s[4:7], s40 offen offset:1024 sc1
  buffer_load_dwordx4 v[200:203], v2, s[4:7], s40 offen offset:2048 sc1
  buffer_load_dwordx4 v[204:207], v2, s[4:7], s40 offen offset:3072 sc1
  v_lshlrev_b32 v208, 16, v8
  v_and_b32 v209, 0xffff0000, v8
  v_lshlrev_b32 v210, 16, v9
  v_and_b32 v211, 0xffff0000, v9
  v_lshlrev_b32 v212, 16, v10
  v_and_b32 v213, 0xffff0000, v10
  v_lshlrev_b32 v214, 16, v11
  v_and_b32 v215, 0xffff0000, v11
  v_lshlrev_b32 v216, 16, v12
  v_and_b32 v217, 0xffff0000, v12
  v_lshlrev_b32 v218, 16, v13
  v_and_b32 v219, 0xffff0000, v13
  v_lshlrev_b32 v220, 16, v14
  v_and_b32 v221, 0xffff0000, v14
  v_lshlrev_b32 v222, 16, v15
  v_and_b32 v223, 0xffff0000, v15
  v_lshlrev_b32 v224, 16, v16
  v_and_b32 v225, 0xffff0000, v16
  v_lshlrev_b32 v226, 16, v17
  v_and_b32 v227, 0xffff0000, v17
  v_lshlrev_b32 v228, 16, v18
  v_and_b32 v229, 0xffff0000, v18
  v_lshlrev_b32 v230, 16, v19
  v_and_b32 v231, 0xffff0000, v19
  v_lshlrev_b32 v232, 16, v20
  v_and_b32 v233, 0xffff0000, v20
  v_lshlrev_b32 v234, 16, v21
  v_and_b32 v235, 0xffff0000, v21
  v_lshlrev_b32 v236, 16, v22
  v_and_b32 v237, 0xffff0000, v22
  v_lshlrev_b32 v238, 16, v23
  v_and_b32 v239, 0xffff0000, v23
  s_waitcnt vmcnt(16)
  v_pk_add_f32 v[80:81], v[80:81], v[96:97]
  v_pk_add_f32 v[82:83], v[82:83], v[98:99]
  v_pk_add_f32 v[84:85], v[84:85], v[100:101]
  v_pk_add_f32 v[86:87], v[86:87], v[102:103]
  v_pk_add_f32 v[88:89], v[88:89], v[104:105]
  v_pk_add_f32 v[90:91], v[90:91], v[106:107]
  v_pk_add_f32 v[92:93], v[92:93], v[108:109]
  v_pk_add_f32 v[94:95], v[94:95], v[110:111]
  v_pk_add_f32 v[144:145], v[144:145], v[160:161]
  v_pk_add_f32 v[146:147], v[146:147], v[162:163]
  v_pk_add_f32 v[148:149], v[148:149], v[164:165]
  v_pk_add_f32 v[150:151], v[150:151], v[166:167]
  v_pk_add_f32 v[152:153], v[152:153], v[168:169]
  v_pk_add_f32 v[154:155], v[154:155], v[170:171]
  v_pk_add_f32 v[156:157], v[156:157], v[172:173]
  v_pk_add_f32 v[158:159], v[158:159], v[174:175]
  s_waitcnt vmcnt(8)
  v_pk_add_f32 v[80:81], v[80:81], v[112:113]
  v_pk_add_f32 v[82:83], v[82:83], v[114:115]
  v_pk_add_f32 v[84:85], v[84:85], v[116:117]
  v_pk_add_f32 v[86:87], v[86:87], v[118:119]
  v_pk_add_f32 v[88:89], v[88:89], v[120:121]
  v_pk_add_f32 v[90:91], v[90:91], v[122:123]
  v_pk_add_f32 v[92:93], v[92:93], v[124:125]
  v_pk_add_f32 v[94:95], v[94:95], v[126:127]
  v_pk_add_f32 v[144:145], v[144:145], v[176:177]
  v_pk_add_f32 v[146:147], v[146:147], v[178:179]
  v_pk_add_f32 v[148:149], v[148:149], v[180:181]
  v_pk_add_f32 v[150:151], v[150:151], v[182:183]
  v_pk_add_f32 v[152:153], v[152:153], v[184:185]
  v_pk_add_f32 v[154:155], v[154:155], v[186:187]
  v_pk_add_f32 v[156:157], v[156:157], v[188:189]
  v_pk_add_f32 v[158:159], v[158:159], v[190:191]
  s_waitcnt vmcnt(0)
  v_pk_add_f32 v[80:81], v[80:81], v[128:129]
  v_pk_add_f32 v[82:83], v[82:83], v[130:131]
  v_pk_add_f32 v[84:85], v[84:85], v[132:133]
  v_pk_add_f32 v[86:87], v[86:87], v[134:135]
  v_pk_add_f32 v[88:89], v[88:89], v[136:137]
  v_pk_add_f32 v[90:91], v[90:91], v[138:139]
  v_pk_add_f32 v[92:93], v[92:93], v[140:141]
  v_pk_add_f32 v[94:95], v[94:95], v[142:143]
  v_pk_add_f32 v[144:145], v[144:145], v[192:193]
  v_pk_add_f32 v[146:147], v[146:147], v[194:195]
  v_pk_add_f32 v[148:149], v[148:149], v[196:197]
  v_pk_add_f32 v[150:151], v[150:151], v[198:199]
  v_pk_add_f32 v[152:153], v[152:153], v[200:201]
  v_pk_add_f32 v[154:155], v[154:155], v[202:203]
  v_pk_add_f32 v[156:157], v[156:157], v[204:205]
  v_pk_add_f32 v[158:159], v[158:159], v[206:207]
  v_pk_fma_f32 v[208:209], v[80:81], v[32:33], v[208:209]
  v_pk_fma_f32 v[210:211], v[82:83], v[34:35], v[210:211]
  v_pk_fma_f32 v[212:213], v[84:85], v[36:37], v[212:213]
  v_pk_fma_f32 v[214:215], v[86:87], v[38:39], v[214:215]
  v_pk_fma_f32 v[216:217], v[88:89], v[40:41], v[216:217]
  v_pk_fma_f32 v[218:219], v[90:91], v[42:43], v[218:219]
  v_pk_fma_f32 v[220:221], v[92:93], v[44:45], v[220:221]
  v_pk_fma_f32 v[222:223], v[94:95], v[46:47], v[222:223]
  v_pk_fma_f32 v[224:225], v[144:145], v[32:33], v[224:225]
  v_pk_fma_f32 v[226:227], v[146:147], v[34:35], v[226:227]
  v_pk_fma_f32 v[228:229], v[148:149], v[36:37], v[228:229]
  v_pk_fma_f32 v[230:231], v[150:151], v[38:39], v[230:231]
  v_pk_fma_f32 v[232:233], v[152:153], v[40:41], v[232:233]
  v_pk_fma_f32 v[234:235], v[154:155], v[42:43], v[234:235]
  v_pk_fma_f32 v[236:237], v[156:157], v[44:45], v[236:237]
  v_pk_fma_f32 v[238:239], v[158:159], v[46:47], v[238:239]
  s_add_u32 s41, s26, 10485760
  s_add_u32 s42, s26, 6291456
  v_cvt_pk_bf16_f32 v8, v208, v209
  v_cvt_pk_bf16_f32 v9, v210, v211
  v_cvt_pk_bf16_f32 v10, v212, v213
  v_cvt_pk_bf16_f32 v11, v214, v215
  v_cvt_pk_bf16_f32 v12, v216, v217
  v_cvt_pk_bf16_f32 v13, v218, v219
  v_cvt_pk_bf16_f32 v14, v220, v221
  v_cvt_pk_bf16_f32 v15, v222, v223
  buffer_store_dwordx4 v[8:11], v2, s[4:7], s41 offen offset:0 sc1
  buffer_store_dwordx4 v[12:15], v2, s[4:7], s41 offen offset:1024 sc1
  v_lshlrev_b32 v208, 16, v8
  v_and_b32 v209, 0xffff0000, v8
  v_lshlrev_b32 v210, 16, v9
  v_and_b32 v211, 0xffff0000, v9
  v_lshlrev_b32 v212, 16, v10
  v_and_b32 v213, 0xffff0000, v10
  v_lshlrev_b32 v214, 16, v11
  v_and_b32 v215, 0xffff0000, v11
  v_lshlrev_b32 v216, 16, v12
  v_and_b32 v217, 0xffff0000, v12
  v_lshlrev_b32 v218, 16, v13
  v_and_b32 v219, 0xffff0000, v13
  v_lshlrev_b32 v220, 16, v14
  v_and_b32 v221, 0xffff0000, v14
  v_lshlrev_b32 v222, 16, v15
  v_and_b32 v223, 0xffff0000, v15
  v_cvt_pk_bf16_f32 v16, v224, v225
  v_cvt_pk_bf16_f32 v17, v226, v227
  v_cvt_pk_bf16_f32 v18, v228, v229
  v_cvt_pk_bf16_f32 v19, v230, v231
  v_cvt_pk_bf16_f32 v20, v232, v233
  v_cvt_pk_bf16_f32 v21, v234, v235
  v_cvt_pk_bf16_f32 v22, v236, v237
  v_cvt_pk_bf16_f32 v23, v238, v239
  buffer_store_dwordx4 v[16:19], v2, s[4:7], s41 offen offset:2048 sc1
  buffer_store_dwordx4 v[20:23], v2, s[4:7], s41 offen offset:3072 sc1
  v_lshlrev_b32 v224, 16, v16
  v_and_b32 v225, 0xffff0000, v16
  v_lshlrev_b32 v226, 16, v17
  v_and_b32 v227, 0xffff0000, v17
  v_lshlrev_b32 v228, 16, v18
  v_and_b32 v229, 0xffff0000, v18
  v_lshlrev_b32 v230, 16, v19
  v_and_b32 v231, 0xffff0000, v19
  v_lshlrev_b32 v232, 16, v20
  v_and_b32 v233, 0xffff0000, v20
  v_lshlrev_b32 v234, 16, v21
  v_and_b32 v235, 0xffff0000, v21
  v_lshlrev_b32 v236, 16, v22
  v_and_b32 v237, 0xffff0000, v22
  v_lshlrev_b32 v238, 16, v23
  v_and_b32 v239, 0xffff0000, v23
  v_pk_add_f32 v[24:25], v[208:209], v[210:211]
  v_pk_add_f32 v[28:29], v[224:225], v[226:227]
  v_pk_add_f32 v[24:25], v[24:25], v[212:213]
  v_pk_add_f32 v[28:29], v[28:29], v[228:229]
  v_pk_add_f32 v[24:25], v[24:25], v[214:215]
  v_pk_add_f32 v[28:29], v[28:29], v[230:231]
  v_pk_add_f32 v[24:25], v[24:25], v[216:217]
  v_pk_add_f32 v[28:29], v[28:29], v[232:233]
  v_pk_add_f32 v[24:25], v[24:25], v[218:219]
  v_pk_add_f32 v[28:29], v[28:29], v[234:235]
  v_pk_add_f32 v[24:25], v[24:25], v[220:221]
  v_pk_add_f32 v[28:29], v[28:29], v[236:237]
  v_pk_add_f32 v[24:25], v[24:25], v[222:223]
  v_pk_add_f32 v[28:29], v[28:29], v[238:239]
  v_add_f32 v24, v24, v25
  v_add_f32 v28, v28, v29
  s_nop 0
  v_add_f32_dpp v24, v24, v24 row_ror:8 row_mask:0xf bank_mask:0xf
  v_add_f32_dpp v28, v28, v28 row_ror:8 row_mask:0xf bank_mask:0xf
  s_nop 0
  v_add_f32_dpp v24, v24, v24 row_ror:4 row_mask:0xf bank_mask:0xf
  v_add_f32_dpp v28, v28, v28 row_ror:4 row_mask:0xf bank_mask:0xf
  s_nop 0
  v_add_f32_dpp v24, v24, v24 row_ror:2 row_mask:0xf bank_mask:0xf
  v_add_f32_dpp v28, v28, v28 row_ror:2 row_mask:0xf bank_mask:0xf
  s_nop 0
  v_add_f32_dpp v24, v24, v24 row_ror:1 row_mask:0xf bank_mask:0xf
  v_add_f32_dpp v28, v28, v28 row_ror:1 row_mask:0xf bank_mask:0xf
  v_mov_b32 v25, v24
  v_mov_b32 v29, v28
  s_nop 0
  v_permlane16_swap_b32 v25, v24
  v_permlane16_swap_b32 v29, v28
  v_add_f32 v24, v24, v25
  v_add_f32 v28, v28, v29
  v_mov_b32 v25, v24
  v_mov_b32 v29, v28
  s_nop 0
  v_permlane32_swap_b32 v25, v24
  v_permlane32_swap_b32 v29, v28
  v_add_f32 v24, v24, v25
  v_add_f32 v28, v28, v29
  v_mul_f32 v24, 0xba800000, v24
  v_mul_f32 v28, 0xba800000, v28
  v_pk_add_f32 v[208:209], v[208:209], v[24:25] op_sel_hi:[1,0]
  v_pk_add_f32 v[224:225], v[224:225], v[28:29] op_sel_hi:[1,0]
  v_pk_add_f32 v[210:211], v[210:211], v[24:25] op_sel_hi:[1,0]
  v_pk_add_f32 v[226:227], v[226:227], v[28:29] op_sel_hi:[1,0]
  v_pk_add_f32 v[212:213], v[212:213], v[24:25] op_sel_hi:[1,0]
  v_pk_add_f32 v[228:229], v[228:229], v[28:29] op_sel_hi:[1,0]
  v_pk_add_f32 v[214:215], v[214:215], v[24:25] op_sel_hi:[1,0]
  v_pk_add_f32 v[230:231], v[230:231], v[28:29] op_sel_hi:[1,0]
  v_pk_add_f32 v[216:217], v[216:217], v[24:25] op_sel_hi:[1,0]
  v_pk_add_f32 v[232:233], v[232:233], v[28:29] op_sel_hi:[1,0]
  v_pk_add_f32 v[218:219], v[218:219], v[24:25] op_sel_hi:[1,0]
  v_pk_add_f32 v[234:235], v[234:235], v[28:29] op_sel_hi:[1,0]
  v_pk_add_f32 v[220:221], v[220:221], v[24:25] op_sel_hi:[1,0]
  v_pk_add_f32 v[236:237], v[236:237], v[28:29] op_sel_hi:[1,0]
  v_pk_add_f32 v[222:223], v[222:223], v[24:25] op_sel_hi:[1,0]
  v_pk_add_f32 v[238:239], v[238:239], v[28:29] op_sel_hi:[1,0]
  v_pk_mul_f32 v[24:25], v[208:209], v[208:209]
  v_pk_mul_f32 v[28:29], v[224:225], v[224:225]
  v_pk_fma_f32 v[24:25], v[210:211], v[210:211], v[24:25]
  v_pk_fma_f32 v[28:29], v[226:227], v[226:227], v[28:29]
  v_pk_fma_f32 v[24:25], v[212:213], v[212:213], v[24:25]
  v_pk_fma_f32 v[28:29], v[228:229], v[228:229], v[28:29]
  v_pk_fma_f32 v[24:25], v[214:215], v[214:215], v[24:25]
  v_pk_fma_f32 v[28:29], v[230:231], v[230:231], v[28:29]
  v_pk_fma_f32 v[24:25], v[216:217], v[216:217], v[24:25]
  v_pk_fma_f32 v[28:29], v[232:233], v[232:233], v[28:29]
  v_pk_fma_f32 v[24:25], v[218:219], v[218:219], v[24:25]
  v_pk_fma_f32 v[28:29], v[234:235], v[234:235], v[28:29]
  v_pk_fma_f32 v[24:25], v[220:221], v[220:221], v[24:25]
  v_pk_fma_f32 v[28:29], v[236:237], v[236:237], v[28:29]
  v_pk_fma_f32 v[24:25], v[222:223], v[222:223], v[24:25]
  v_pk_fma_f32 v[28:29], v[238:239], v[238:239], v[28:29]
  v_add_f32 v24, v24, v25
  v_add_f32 v28, v28, v29
  s_nop 0
  v_add_f32_dpp v24, v24, v24 row_ror:8 row_mask:0xf bank_mask:0xf
  v_add_f32_dpp v28, v28, v28 row_ror:8 row_mask:0xf bank_mask:0xf
  s_nop 0
  v_add_f32_dpp v24, v24, v24 row_ror:4 row_mask:0xf bank_mask:0xf
  v_add_f32_dpp v28, v28, v28 row_ror:4 row_mask:0xf bank_mask:0xf
  s_nop 0
  v_add_f32_dpp v24, v24, v24 row_ror:2 row_mask:0xf bank_mask:0xf
  v_add_f32_dpp v28, v28, v28 row_ror:2 row_mask:0xf bank_mask:0xf
  s_nop 0
  v_add_f32_dpp v24, v24, v24 row_ror:1 row_mask:0xf bank_mask:0xf
  v_add_f32_dpp v28, v28, v28 row_ror:1 row_mask:0xf bank_mask:0xf
  v_mov_b32 v25, v24
  v_mov_b32 v29, v28
  s_nop 0
  v_permlane16_swap_b32 v25, v24
  v_permlane16_swap_b32 v29, v28
  v_add_f32 v24, v24, v25
  v_add_f32 v28, v28, v29
  v_mov_b32 v25, v24
  v_mov_b32 v29, v28
  s_nop 0
  v_permlane32_swap_b32 v25, v24
  v_permlane32_swap_b32 v29, v28
  v_add_f32 v24, v24, v25
  v_add_f32 v28, v28, v29
  v_mul_f32 v24, 0x3a800000, v24
  v_mul_f32 v28, 0x3a800000, v28
  v_add_f32 v24, 0x3727c5ac, v24
  v_add_f32 v28, 0x3727c5ac, v28
  v_rsq_f32 v24, v24
  v_rsq_f32 v28, v28
  v_pk_mul_f32 v[208:209], v[208:209], v[24:25] op_sel_hi:[1,0]
  v_pk_mul_f32 v[224:225], v[224:225], v[28:29] op_sel_hi:[1,0]
  v_pk_mul_f32 v[210:211], v[210:211], v[24:25] op_sel_hi:[1,0]
  v_pk_mul_f32 v[226:227], v[226:227], v[28:29] op_sel_hi:[1,0]
  v_pk_mul_f32 v[212:213], v[212:213], v[24:25] op_sel_hi:[1,0]
  v_pk_mul_f32 v[228:229], v[228:229], v[28:29] op_sel_hi:[1,0]
  v_pk_mul_f32 v[214:215], v[214:215], v[24:25] op_sel_hi:[1,0]
  v_pk_mul_f32 v[230:231], v[230:231], v[28:29] op_sel_hi:[1,0]
  v_pk_mul_f32 v[216:217], v[216:217], v[24:25] op_sel_hi:[1,0]
  v_pk_mul_f32 v[232:233], v[232:233], v[28:29] op_sel_hi:[1,0]
  v_pk_mul_f32 v[218:219], v[218:219], v[24:25] op_sel_hi:[1,0]
  v_pk_mul_f32 v[234:235], v[234:235], v[28:29] op_sel_hi:[1,0]
  v_pk_mul_f32 v[220:221], v[220:221], v[24:25] op_sel_hi:[1,0]
  v_pk_mul_f32 v[236:237], v[236:237], v[28:29] op_sel_hi:[1,0]
  v_pk_mul_f32 v[222:223], v[222:223], v[24:25] op_sel_hi:[1,0]
  v_pk_mul_f32 v[238:239], v[238:239], v[28:29] op_sel_hi:[1,0]
  v_pk_fma_f32 v[208:209], v[208:209], v[64:65], v[48:49]
  v_pk_fma_f32 v[210:211], v[210:211], v[66:67], v[50:51]
  v_pk_fma_f32 v[212:213], v[212:213], v[68:69], v[52:53]
  v_pk_fma_f32 v[214:215], v[214:215], v[70:71], v[54:55]
  v_pk_fma_f32 v[216:217], v[216:217], v[72:73], v[56:57]
  v_pk_fma_f32 v[218:219], v[218:219], v[74:75], v[58:59]
  v_pk_fma_f32 v[220:221], v[220:221], v[76:77], v[60:61]
  v_pk_fma_f32 v[222:223], v[222:223], v[78:79], v[62:63]
  v_cvt_pk_bf16_f32 v80, v208, v209
  v_cvt_pk_bf16_f32 v81, v210, v211
  v_cvt_pk_bf16_f32 v82, v212, v213
  v_cvt_pk_bf16_f32 v83, v214, v215
  v_cvt_pk_bf16_f32 v84, v216, v217
  v_cvt_pk_bf16_f32 v85, v218, v219
  v_cvt_pk_bf16_f32 v86, v220, v221
  v_cvt_pk_bf16_f32 v87, v222, v223
  buffer_store_dwordx4 v[80:83], v2, s[4:7], s42 offen offset:0 sc1
  buffer_store_dwordx4 v[84:87], v2, s[4:7], s42 offen offset:1024 sc1
  v_pk_fma_f32 v[224:225], v[224:225], v[64:65], v[48:49]
  v_pk_fma_f32 v[226:227], v[226:227], v[66:67], v[50:51]
  v_pk_fma_f32 v[228:229], v[228:229], v[68:69], v[52:53]
  v_pk_fma_f32 v[230:231], v[230:231], v[70:71], v[54:55]
  v_pk_fma_f32 v[232:233], v[232:233], v[72:73], v[56:57]
  v_pk_fma_f32 v[234:235], v[234:235], v[74:75], v[58:59]
  v_pk_fma_f32 v[236:237], v[236:237], v[76:77], v[60:61]
  v_pk_fma_f32 v[238:239], v[238:239], v[78:79], v[62:63]
  v_cvt_pk_bf16_f32 v88, v224, v225
  v_cvt_pk_bf16_f32 v89, v226, v227
  v_cvt_pk_bf16_f32 v90, v228, v229
  v_cvt_pk_bf16_f32 v91, v230, v231
  v_cvt_pk_bf16_f32 v92, v232, v233
  v_cvt_pk_bf16_f32 v93, v234, v235
  v_cvt_pk_bf16_f32 v94, v236, v237
  v_cvt_pk_bf16_f32 v95, v238, v239
  buffer_store_dwordx4 v[88:91], v2, s[4:7], s42 offen offset:2048 sc1
  buffer_store_dwordx4 v[92:95], v2, s[4:7], s42 offen offset:3072 sc1
  v_mov_b32 v4, s29
  s_waitcnt vmcnt(0)
  buffer_store_dword v4, v5, s[4:7], 0 offen sc1
  s_add_u32 s25, s25, 1
  s_add_u32 s29, s29, 1
  s_add_u32 s26, s26, 65536
  s_add_u32 s27, s27, 524288
  s_cmp_lt_u32 s25, 64
  s_cbranch_scc1 L_LN2_top
  s_branch L_END
L_FIN:
  s_load_dwordx2 s[16:17], s[0:1], 104
  s_mov_b32 s18, 4194304
  s_mov_b32 s19, 0x20000
  s_waitcnt lgkmcnt(0)
  s_mov_b32 s40, 1593344
  buffer_load_dwordx4 v[32:35], v2, s[4:7], s40 offen offset:0 sc1
  buffer_load_dwordx4 v[36:39], v2, s[4:7], s40 offen offset:1024 sc1
  buffer_load_dwordx4 v[40:43], v2, s[4:7], s40 offen offset:2048 sc1
  buffer_load_dwordx4 v[44:47], v2, s[4:7], s40 offen offset:3072 sc1
  v_min_u32 v3, 23, v0
  v_lshlrev_b32 v3, 7, v3
  v_add_u32 v3, 1438720, v3
  s_add_u32 s27, s27, 142606336
  s_nop 0
L_FIN_top:
Lpoll_19:
  buffer_load_dword v4, v3, s[4:7], 0 offen sc1
  s_sub_u32 s24, s24, 1
  s_cbranch_scc1 L_FAIL
  s_waitcnt vmcnt(0)
  v_cmp_gt_i32 vcc, s29, v4
  s_cbranch_vccz Lpolld_20
  s_sleep 2
  s_branch Lpoll_19
Lpolld_20:
  s_add_u32 s41, s26, 10485760
  buffer_load_dwordx4 v[8:11], v2, s[4:7], s41 offen offset:0 sc1
  buffer_load_dwordx4 v[12:15], v2, s[4:7], s41 offen offset:1024 sc1
  buffer_load_dwordx4 v[16:19], v2, s[4:7], s41 offen offset:2048 sc1
  buffer_load_dwordx4 v[20:23], v2, s[4:7], s41 offen offset:3072 sc1
  s_add_u32 s40, s27, 0
  buffer_load_dwordx4 v[80:83], v2, s[4:7], s40 offen offset:0 sc1
  buffer_load_dwordx4 v[84:87], v2, s[4:7], s40 offen offset:1024 sc1
  buffer_load_dwordx4 v[88:91], v2, s[4:7], s40 offen offset:2048 sc1
  buffer_load_dwordx4 v[92:95], v2, s[4:7], s40 offen offset:3072 sc1
  s_add_u32 s40, s27, 4096
  buffer_load_dwordx4 v[128:131], v2, s[4:7], s40 offen offset:0 sc1
  buffer_load_dwordx4 v[132:135], v2, s[4:7], s40 offen offset:1024 sc1
  buffer_load_dwordx4 v[136:139], v2, s[4:7], s40 offen offset:2048 sc1
  buffer_load_dwordx4 v[140:143], v2, s[4:7], s40 offen offset:3072 sc1
  s_add_u32 s40, s27, 131072
  buffer_load_dwordx4 v[96:99], v2, s[4:7], s40 offen offset:0 sc1
  buffer_load_dwordx4 v[100:103], v2, s[4:7], s40 offen offset:1024 sc1
  buffer_load_dwordx4 v[104:107], v2, s[4:7], s40 offen offset:2048 sc1
  buffer_load_dwordx4 v[108:111], v2, s[4:7], s40 offen offset:3072 sc1
  s_add_u32 s40, s27, 135168
  buffer_load_dwordx4 v[144:147], v2, s[4:7], s40 offen offset:0 sc1
  buffer_load_dwordx4 v[148:151], v2, s[4:7], s40 offen offset:1024 sc1
  buffer_load_dwordx4 v[152:155], v2, s[4:7], s40 offen offset:2048 sc1
  buffer_load_dwordx4 v[156:159], v2, s[4:7], s40 offen offset:3072 sc1
  s_add_u32 s40, s27, 262144
  buffer_load_dwordx4 v[112:115], v2, s[4:7], s40 offen offset:0 sc1
  buffer_load_dwordx4 v[116:119], v2, s[4:7], s40 offen offset:1024 sc1
  buffer_load_dwordx4 v[120:123], v2, s[4:7], s40 offen offset:2048 sc1
  buffer_load_dwordx4 v[124:127], v2, s[4:7], s40 offen offset:3072 sc1
  s_add_u32 s40, s27, 266240
  buffer_load_dwordx4 v[160:163], v2, s[4:7], s40 offen offset:0 sc1
  buffer_load_dwordx4 v[164:167], v2, s[4:7], s40 offen offset:1024 sc1
  buffer_load_dwordx4 v[168:171], v2, s[4:7], s40 offen offset:2048 sc1
  buffer_load_dwordx4 v[172:175], v2, s[4:7], s40 offen offset:3072 sc1
  s_waitcnt vmcnt(24)
  v_lshlrev_b32 v208, 16, v8
  v_and_b32 v209, 0xffff0000, v8
  v_lshlrev_b32 v210, 16, v9
  v_and_b32 v211, 0xffff0000, v9
  v_lshlrev_b32 v212, 16, v10
  v_and_b32 v213, 0xffff0000, v10
  v_lshlrev_b32 v214, 16, v11
  v_and_b32 v215, 0xffff0000, v11
  v_lshlrev_b32 v216, 16, v12
  v_and_b32 v217, 0xffff0000, v12
  v_lshlrev_b32 v218, 16, v13
  v_and_b32 v219, 0xffff0000, v13
  v_lshlrev_b32 v220, 16, v14
  v_and_b32 v221, 0xffff0000, v14
  v_lshlrev_b32 v222, 16, v15
  v_and_b32 v223, 0xffff0000, v15
  v_lshlrev_b32 v224, 16, v16
  v_and_b32 v225, 0xffff0000, v16
  v_lshlrev_b32 v226, 16, v17
  v_and_b32 v227, 0xffff0000, v17
  v_lshlrev_b32 v228, 16, v18
  v_and_b32 v229, 0xffff0000, v18
  v_lshlrev_b32 v230, 16, v19
  v_and_b32 v231, 0xffff0000, v19
  v_lshlrev_b32 v232, 16, v20
  v_and_b32 v233, 0xffff0000, v20
  v_lshlrev_b32 v234, 16, v21
  v_and_b32 v235, 0xffff0000, v21
  v_lshlrev_b32 v236, 16, v22
  v_and_b32 v237, 0xffff0000, v22
  v_lshlrev_b32 v238, 16, v23
  v_and_b32 v239, 0xffff0000, v23
  s_waitcnt vmcnt(8)
  v_pk_add_f32 v[80:81], v[80:81], v[96:97]
  v_pk_add_f32 v[82:83], v[82:83], v[98:99]
  v_pk_add_f32 v[84:85], v[84:85], v[100:101]
  v_pk_add_f32 v[86:87], v[86:87], v[102:103]
  v_pk_add_f32 v[88:89], v[88:89], v[104:105]
  v_pk_add_f32 v[90:91], v[90:91], v[106:107]
  v_pk_add_f32 v[92:93], v[92:93], v[108:109]
  v_pk_add_f32 v[94:95], v[94:95], v[110:111]
  v_pk_add_f32 v[128:129], v[128:129], v[144:145]
  v_pk_add_f32 v[130:131], v[130:131], v[146:147]
  v_pk_add_f32 v[132:133], v[132:133], v[148:149]
  v_pk_add_f32 v[134:135], v[134:135], v[150:151]
  v_pk_add_f32 v[136:137], v[136:137], v[152:153]
  v_pk_add_f32 v[138:139], v[138:139], v[154:155]
  v_pk_add_f32 v[140:141], v[140:141], v[156:157]
  v_pk_add_f32 v[142:143], v[142:143], v[158:159]
  s_waitcnt vmcnt(0)
  v_pk_add_f32 v[80:81], v[80:81], v[112:113]
  v_pk_add_f32 v[82:83], v[82:83], v[114:115]
  v_pk_add_f32 v[84:85], v[84:85], v[116:117]
  v_pk_add_f32 v[86:87], v[86:87], v[118:119]
  v_pk_add_f32 v[88:89], v[88:89], v[120:121]
  v_pk_add_f32 v[90:91], v[90:91], v[122:123]
  v_pk_add_f32 v[92:93], v[92:93], v[124:125]
  v_pk_add_f32 v[94:95], v[94:95], v[126:127]
  v_pk_add_f32 v[128:129], v[128:129], v[160:161]
  v_pk_add_f32 v[130:131], v[130:131], v[162:163]
  v_pk_add_f32 v[132:133], v[132:133], v[164:165]
  v_pk_add_f32 v[134:135], v[134:135], v[166:167]
  v_pk_add_f32 v[136:137], v[136:137], v[168:169]
  v_pk_add_f32 v[138:139], v[138:139], v[170:171]
  v_pk_add_f32 v[140:141], v[140:141], v[172:173]
  v_pk_add_f32 v[142:143], v[142:143], v[174:175]
  v_pk_fma_f32 v[208:209], v[80:81], v[32:33], v[208:209]
  v_pk_fma_f32 v[210:211], v[82:83], v[34:35], v[210:211]
  v_pk_fma_f32 v[212:213], v[84:85], v[36:37], v[212:213]
  v_pk_fma_f32 v[214:215], v[86:87], v[38:39], v[214:215]
  v_pk_fma_f32 v[216:217], v[88:89], v[40:41], v[216:217]
  v_pk_fma_f32 v[218:219], v[90:91], v[42:43], v[218:219]
  v_pk_fma_f32 v[220:221], v[92:93], v[44:45], v[220:221]
  v_pk_fma_f32 v[222:223], v[94:95], v[46:47], v[222:223]
  v_pk_fma_f32 v[224:225], v[128:129], v[32:33], v[224:225]
  v_pk_fma_f32 v[226:227], v[130:131], v[34:35], v[226:227]
  v_pk_fma_f32 v[228:229], v[132:133], v[36:37], v[228:229]
  v_pk_fma_f32 v[230:231], v[134:135], v[38:39], v[230:231]
  v_pk_fma_f32 v[232:233], v[136:137], v[40:41], v[232:233]
  v_pk_fma_f32 v[234:235], v[138:139], v[42:43], v[234:235]
  v_pk_fma_f32 v[236:237], v[140:141], v[44:45], v[236:237]
  v_pk_fma_f32 v[238:239], v[142:143], v[46:47], v[238:239]
  v_cvt_pk_bf16_f32 v8, v208, v209
  v_cvt_pk_bf16_f32 v9, v210, v211
  v_cvt_pk_bf16_f32 v10, v212, v213
  v_cvt_pk_bf16_f32 v11, v214, v215
  v_cvt_pk_bf16_f32 v12, v216, v217
  v_cvt_pk_bf16_f32 v13, v218, v219
  v_cvt_pk_bf16_f32 v14, v220, v221
  v_cvt_pk_bf16_f32 v15, v222, v223
  buffer_store_dwordx2 v[8:9], v1, s[16:19], s26 offen offset:0
  buffer_store_dwordx2 v[10:11], v1, s[16:19], s26 offen offset:512
  buffer_store_dwordx2 v[12:13], v1, s[16:19], s26 offen offset:1024
  buffer_store_dwordx2 v[14:15], v1, s[16:19], s26 offen offset:1536
  v_cvt_pk_bf16_f32 v16, v224, v225
  v_cvt_pk_bf16_f32 v17, v226, v227
  v_cvt_pk_bf16_f32 v18, v228, v229
  v_cvt_pk_bf16_f32 v19, v230, v231
  v_cvt_pk_bf16_f32 v20, v232, v233
  v_cvt_pk_bf16_f32 v21, v234, v235
  v_cvt_pk_bf16_f32 v22, v236, v237
  v_cvt_pk_bf16_f32 v23, v238, v239
  buffer_store_dwordx2 v[16:17], v1, s[16:19], s26 offen offset:2048
  buffer_store_dwordx2 v[18:19], v1, s[16:19], s26 offen offset:2560
  buffer_store_dwordx2 v[20:21], v1, s[16:19], s26 offen offset:3072
  buffer_store_dwordx2 v[22:23], v1, s[16:19], s26 offen offset:3584
  s_add_u32 s25, s25, 1
  s_add_u32 s29, s29, 1
  s_add_u32 s26, s26, 65536
  s_add_u32 s27, s27, 393216
  s_cmp_lt_u32 s25, 64
  s_cbranch_scc1 L_FIN_top
  s_branch L_END
L_QKV:
  s_and_b32 s43, s21, 1
  s_lshr_b32 s44, s21, 1
  s_lshl_b32 s44, s44, 8
  s_add_u32 s45, s44, 128
  s_lshl_b32 s46, s43, 7
  s_add_u32 s46, s46, s44
  s_load_dwordx4 s[48:51], s[0:1], 16
  s_waitcnt lgkmcnt(0)
  s_cmp_eq_u32 s43, 0
  s_cselect_b32 s8, s48, s50
  s_cselect_b32 s9, s49, s51
  s_mov_b32 s10, 8388608
  s_mov_b32 s11, 0x20000
  v_bfe_u32 v40, v0, 5, 1
  v_mul_u32_u24 v40, 32768, v40
  v_bfe_u32 v41, v0, 4, 1
  v_mul_u32_u24 v41, 16384, v41
  v_add_u32 v40, v40, v41
  v_bfe_u32 v41, v0, 3, 1
  v_mul_u32_u24 v41, 8192, v41
  v_add_u32 v40, v40, v41
  v_lshrrev_b32 v41, 3, v0
  v_and_b32 v41, 6, v41
  v_xor_b32 v41, v41, v0
  v_and_b32 v41, 7, v41
  v_lshl_add_u32 v40, v41, 4, v40
  s_lshr_b32 s40, s20, 1
  s_mul_i32 s40, s40, 2097152
  s_and_b32 s41, s20, 1
  s_mul_i32 s41, s41, 65536
  s_add_u32 s40, s40, s41
  v_add_u32 v40, s40, v40
  v_bfe_u32 v41, v0, 3, 2
  v_xor_b32 v41, s20, v41
  v_lshlrev_b32 v41, 5, v41
  v_lshrrev_b32 v42, 2, v0
  v_lshl_add_u32 v42, v42, 7, v41
  v_and_b32 v41, 3, v0
  v_lshl_add_u32 v42, v41, 3, v42
  v_add_u32 v43, 0x10000, v42
  v_add_u32 v44, s44, v40
  v_add_u32 v45, s45, v40
  v_add_u32 v46, s46, v40
  s_lshl_b32 s41, s20, 10
  s_add_u32 m0, s41, 0
  s_mov_b32 s42, 0
  buffer_load_dwordx4 v44, s[8:11], s42 offen lds
  s_add_u32 m0, s41, 4096
  s_mov_b32 s42, 131072
  buffer_load_dwordx4 v44, s[8:11], s42 offen lds
  s_add_u32 m0, s41, 8192
  s_mov_b32 s42, 262144
  buffer_load_dwordx4 v44, s[8:11], s42 offen lds
  s_add_u32 m0, s41, 12288
  s_mov_b32 s42, 393216
  buffer_load_dwordx4 v44, s[8:11], s42 offen lds
  s_add_u32 m0, s41, 16384
  s_mov_b32 s42, 524288
  buffer_load_dwordx4 v44, s[8:11], s42 offen lds
  s_add_u32 m0, s41, 20480
  s_mov_b32 s42, 655360
  buffer_load_dwordx4 v44, s[8:11], s42 offen lds
  s_add_u32 m0, s41, 24576
  s_mov_b32 s42, 786432
  buffer_load_dwordx4 v44, s[8:11], s42 offen lds
  s_add_u32 m0, s41, 28672
  s_mov_b32 s42, 917504
  buffer_load_dwordx4 v44, s[8:11], s42 offen lds
  s_add_u32 m0, s41, 32768
  s_mov_b32 s42, 1048576
  buffer_load_dwordx4 v44, s[8:11], s42 offen lds
  s_add_u32 m0, s41, 36864
  s_mov_b32 s42, 1179648
  buffer_load_dwordx4 v44, s[8:11], s42 offen lds
  s_add_u32 m0, s41, 40960
  s_mov_b32 s42, 1310720
  buffer_load_dwordx4 v44, s[8:11], s42 offen lds
  s_add_u32 m0, s41, 45056
  s_mov_b32 s42, 1441792
  buffer_load_dwordx4 v44, s[8:11], s42 offen lds
  s_add_u32 m0, s41, 49152
  s_mov_b32 s42, 1572864
  buffer_load_dwordx4 v44, s[8:11], s42 offen lds
  s_add_u32 m0, s41, 53248
  s_mov_b32 s42, 1703936
  buffer_load_dwordx4 v44, s[8:11], s42 offen lds
  s_add_u32 m0, s41, 57344
  s_mov_b32 s42, 1835008
  buffer_load_dwordx4 v44, s[8:11], s42 offen lds
  s_add_u32 m0, s41, 61440
  s_mov_b32 s42, 1966080
  buffer_load_dwordx4 v44, s[8:11], s42 offen lds
  s_add_u32 m0, s41, 65536
  s_mov_b32 s42, 4194304
  buffer_load_dwordx4 v44, s[8:11], s42 offen lds
  s_add_u32 m0, s41, 69632
  s_mov_b32 s42, 4325376
  buffer_load_dwordx4 v44, s[8:11], s42 offen lds
  s_add_u32 m0, s41, 73728
  s_mov_b32 s42, 4456448
  buffer_load_dwordx4 v44, s[8:11], s42 offen lds
  s_add_u32 m0, s41, 77824
  s_mov_b32 s42, 4587520
  buffer_load_dwordx4 v44, s[8:11], s42 offen lds
  s_add_u32 m0, s41, 81920
  s_mov_b32 s42, 4718592
  buffer_load_dwordx4 v44, s[8:11], s42 offen lds
  s_add_u32 m0, s41, 86016
  s_mov_b32 s42, 4849664
  buffer_load_dwordx4 v44, s[8:11], s42 offen lds
  s_add_u32 m0, s41, 90112
  s_mov_b32 s42, 4980736
  buffer_load_dwordx4 v44, s[8:11], s42 offen lds
  s_add_u32 m0, s41, 94208
  s_mov_b32 s42, 5111808
  buffer_load_dwordx4 v44, s[8:11], s42 offen lds
  s_add_u32 m0, s41, 98304
  s_mov_b32 s42, 5242880
  buffer_load_dwordx4 v44, s[8:11], s42 offen lds
  s_add_u32 m0, s41, 102400
  s_mov_b32 s42, 5373952
  buffer_load_dwordx4 v44, s[8:11], s42 offen lds
  s_add_u32 m0, s41, 106496
  s_mov_b32 s42, 5505024
  buffer_load_dwordx4 v44, s[8:11], s42 offen lds
  s_add_u32 m0, s41, 110592
  s_mov_b32 s42, 5636096
  buffer_load_dwordx4 v44, s[8:11], s42 offen lds
  s_waitcnt vmcnt(24) lgkmcnt(0)
  s_barrier
  s_add_u32 m0, s41, 114688
  s_mov_b32 s42, 5767168
  buffer_load_dwordx4 v44, s[8:11], s42 offen lds
  s_add_u32 m0, s41, 118784
  s_mov_b32 s42, 5898240
  buffer_load_dwordx4 v44, s[8:11], s42 offen lds
  s_add_u32 m0, s41, 122880
  s_mov_b32 s42, 6029312
  buffer_load_dwordx4 v44, s[8:11], s42 offen lds
  s_add_u32 m0, s41, 126976
  s_mov_b32 s42, 6160384
  buffer_load_dwordx4 v44, s[8:11], s42 offen lds
  ds_read_b64_tr_b16 a[0:1], v42 offset:0
  ds_read_b64_tr_b16 a[2:3], v42 offset:2048
  ds_read_b64_tr_b16 a[4:5], v42 offset:4096
  ds_read_b64_tr_b16 a[6:7], v42 offset:6144
  ds_read_b64_tr_b16 a[8:9], v42 offset:8192
  ds_read_b64_tr_b16 a[10:11], v42 offset:10240
  ds_read_b64_tr_b16 a[12:13], v42 offset:12288
  ds_read_b64_tr_b16 a[14:15], v42 offset:14336
  s_waitcnt vmcnt(24) lgkmcnt(0)
  s_barrier
  s_add_u32 m0, s41, 0
  s_mov_b32 s42, 0
  buffer_load_dwordx4 v45, s[8:11], s42 offen lds
  s_add_u32 m0, s41, 4096
  s_mov_b32 s42, 131072
  buffer_load_dwordx4 v45, s[8:11], s42 offen lds
  s_add_u32 m0, s41, 8192
  s_mov_b32 s42, 262144
  buffer_load_dwordx4 v45, s[8:11], s42 offen lds
  s_add_u32 m0, s41, 12288
  s_mov_b32 s42, 393216
  buffer_load_dwordx4 v45, s[8:11], s42 offen lds
  ds_read_b64_tr_b16 a[16:17], v42 offset:16384
  ds_read_b64_tr_b16 a[18:19], v42 offset:18432
  ds_read_b64_tr_b16 a[20:21], v42 offset:20480
  ds_read_b64_tr_b16 a[22:23], v42 offset:22528
  ds_read_b64_tr_b16 a[24:25], v42 offset:24576
  ds_read_b64_tr_b16 a[26:27], v42 offset:26624
  ds_read_b64_tr_b16 a[28:29], v42 offset:28672
  ds_read_b64_tr_b16 a[30:31], v42 offset:30720
  s_waitcnt vmcnt(24) lgkmcnt(0)
  s_barrier
  s_add_u32 m0, s41, 16384
  s_mov_b32 s42, 524288
  buffer_load_dwordx4 v45, s[8:11], s42 offen lds
  s_add_u32 m0, s41, 20480
  s_mov_b32 s42, 655360
  buffer_load_dwordx4 v45, s[8:11], s42 offen lds
  s_add_u32 m0, s41, 24576
  s_mov_b32 s42, 786432
  buffer_load_dwordx4 v45, s[8:11], s42 offen lds
  s_add_u32 m0, s41, 28672
  s_mov_b32 s42, 917504
  buffer_load_dwordx4 v45, s[8:11], s42 offen lds
  ds_read_b64_tr_b16 a[32:33], v42 offset:32768
  ds_read_b64_tr_b16 a[34:35], v42 offset:34816
  ds_read_b64_tr_b16 a[36:37], v42 offset:36864
  ds_read_b64_tr_b16 a[38:39], v42 offset:38912
  ds_read_b64_tr_b16 a[40:41], v42 offset:40960
  ds_read_b64_tr_b16 a[42:43], v42 offset:43008
  ds_read_b64_tr_b16 a[44:45], v42 offset:45056
  ds_read_b64_tr_b16 a[46:47], v42 offset:47104
  s_waitcnt vmcnt(24) lgkmcnt(0)
  s_barrier
  s_add_u32 m0, s41, 32768
  s_mov_b32 s42, 1048576
  buffer_load_dwordx4 v45, s[8:11], s42 offen lds
  s_add_u32 m0, s41, 36864
  s_mov_b32 s42, 1179648
  buffer_load_dwordx4 v45, s[8:11], s42 offen lds
  s_add_u32 m0, s41, 40960
  s_mov_b32 s42, 1310720
  buffer_load_dwordx4 v45, s[8:11], s42 offen lds
  s_add_u32 m0, s41, 45056
  s_mov_b32 s42, 1441792
  buffer_load_dwordx4 v45, s[8:11], s42 offen lds
  ds_read_b64_tr_b16 a[48:49], v42 offset:49152
  ds_read_b64_tr_b16 a[50:51], v42 offset:51200
  ds_read_b64_tr_b16 a[52:53], v42 offset:53248
  ds_read_b64_tr_b16 a[54:55], v42 offset:55296
  ds_read_b64_tr_b16 a[56:57], v42 offset:57344
  ds_read_b64_tr_b16 a[58:59], v42 offset:59392
  ds_read_b64_tr_b16 a[60:61], v42 offset:61440
  ds_read_b64_tr_b16 a[62:63], v42 offset:63488
  s_waitcnt vmcnt(24) lgkmcnt(0)
  s_barrier
  s_add_u32 m0, s41, 49152
  s_mov_b32 s42, 1572864
  buffer_load_dwordx4 v45, s[8:11], s42 offen lds
  s_add_u32 m0, s41, 53248
  s_mov_b32 s42, 1703936
  buffer_load_dwordx4 v45, s[8:11], s42 offen lds
  s_add_u32 m0, s41, 57344
  s_mov_b32 s42, 1835008
  buffer_load_dwordx4 v45, s[8:11], s42 offen lds
  s_add_u32 m0, s41, 61440
  s_mov_b32 s42, 1966080
  buffer_load_dwordx4 v45, s[8:11], s42 offen lds
  ds_read_b64_tr_b16 a[64:65], v43 offset:0
  ds_read_b64_tr_b16 a[66:67], v43 offset:2048
  ds_read_b64_tr_b16 a[68:69], v43 offset:4096
  ds_read_b64_tr_b16 a[70:71], v43 offset:6144
  ds_read_b64_tr_b16 a[72:73], v43 offset:8192
  ds_read_b64_tr_b16 a[74:75], v43 offset:10240
  ds_read_b64_tr_b16 a[76:77], v43 offset:12288
  ds_read_b64_tr_b16 a[78:79], v43 offset:14336
  s_waitcnt vmcnt(24) lgkmcnt(0)
  s_barrier
  s_add_u32 m0, s41, 65536
  s_mov_b32 s42, 4194304
  buffer_load_dwordx4 v45, s[8:11], s42 offen lds
  s_add_u32 m0, s41, 69632
  s_mov_b32 s42, 4325376
  buffer_load_dwordx4 v45, s[8:11], s42 offen lds
  s_add_u32 m0, s41, 73728
  s_mov_b32 s42, 4456448
  buffer_load_dwordx4 v45, s[8:11], s42 offen lds
  s_add_u32 m0, s41, 77824
  s_mov_b32 s42, 4587520
  buffer_load_dwordx4 v45, s[8:11], s42 offen lds
  ds_read_b64_tr_b16 a[80:81], v43 offset:16384
  ds_read_b64_tr_b16 a[82:83], v43 offset:18432
  ds_read_b64_tr_b16 a[84:85], v43 offset:20480
  ds_read_b64_tr_b16 a[86:87], v43 offset:22528
  ds_read_b64_tr_b16 a[88:89], v43 offset:24576
  ds_read_b64_tr_b16 a[90:91], v43 offset:26624
  ds_read_b64_tr_b16 a[92:93], v43 offset:28672
  ds_read_b64_tr_b16 a[94:95], v43 offset:30720
  s_waitcnt vmcnt(24) lgkmcnt(0)
  s_barrier
  s_add_u32 m0, s41, 81920
  s_mov_b32 s42, 4718592
  buffer_load_dwordx4 v45, s[8:11], s42 offen lds
  s_add_u32 m0, s41, 86016
  s_mov_b32 s42, 4849664
  buffer_load_dwordx4 v45, s[8:11], s42 offen lds
  s_add_u32 m0, s41, 90112
  s_mov_b32 s42, 4980736
  buffer_load_dwordx4 v45, s[8:11], s42 offen lds
  s_add_u32 m0, s41, 94208
  s_mov_b32 s42, 5111808
  buffer_load_dwordx4 v45, s[8:11], s42 offen lds
  ds_read_b64_tr_b16 a[96:97], v43 offset:32768
  ds_read_b64_tr_b16 a[98:99], v43 offset:34816
  ds_read_b64_tr_b16 a[100:101], v43 offset:36864
  ds_read_b64_tr_b16 a[102:103], v43 offset:38912
  ds_read_b64_tr_b16 a[104:105], v43 offset:40960
  ds_read_b64_tr_b16 a[106:107], v43 offset:43008
  ds_read_b64_tr_b16 a[108:109], v43 offset:45056
  ds_read_b64_tr_b16 a[110:111], v43 offset:47104
  s_waitcnt vmcnt(24) lgkmcnt(0)
  s_barrier
  s_add_u32 m0, s41, 98304
  s_mov_b32 s42, 5242880
  buffer_load_dwordx4 v45, s[8:11], s42 offen lds
  s_add_u32 m0, s41, 102400
  s_mov_b32 s42, 5373952
  buffer_load_dwordx4 v45, s[8:11], s42 offen lds
  s_add_u32 m0, s41, 106496
  s_mov_b32 s42, 5505024
  buffer_load_dwordx4 v45, s[8:11], s42 offen lds
  s_add_u32 m0, s41, 110592
  s_mov_b32 s42, 5636096
  buffer_load_dwordx4 v45, s[8:11], s42 offen lds
  ds_read_b64_tr_b16 a[112:113], v43 offset:49152
  ds_read_b64_tr_b16 a[114:115], v43 offset:51200
  ds_read_b64_tr_b16 a[116:117], v43 offset:53248
  ds_read_b64_tr_b16 a[118:119], v43 offset:55296
  ds_read_b64_tr_b16 a[120:121], v43 offset:57344
  ds_read_b64_tr_b16 a[122:123], v43 offset:59392
  ds_read_b64_tr_b16 a[124:125], v43 offset:61440
  ds_read_b64_tr_b16 a[126:127], v43 offset:63488
  s_waitcnt vmcnt(24) lgkmcnt(0)
  s_barrier
  s_add_u32 m0, s41, 114688
  s_mov_b32 s42, 5767168
  buffer_load_dwordx4 v45, s[8:11], s42 offen lds
  s_add_u32 m0, s41, 118784
  s_mov_b32 s42, 5898240
  buffer_load_dwordx4 v45, s[8:11], s42 offen lds
  s_add_u32 m0, s41, 122880
  s_mov_b32 s42, 6029312
  buffer_load_dwordx4 v45, s[8:11], s42 offen lds
  s_add_u32 m0, s41, 126976
  s_mov_b32 s42, 6160384
  buffer_load_dwordx4 v45, s[8:11], s42 offen lds
  ds_read_b64_tr_b16 a[128:129], v42 offset:0
  ds_read_b64_tr_b16 a[130:131], v42 offset:2048
  ds_read_b64_tr_b16 a[132:133], v42 offset:4096
  ds_read_b64_tr_b16 a[134:135], v42 offset:6144
  ds_read_b64_tr_b16 a[136:137], v42 offset:8192
  ds_read_b64_tr_b16 a[138:139], v42 offset:10240
  ds_read_b64_tr_b16 a[140:141], v42 offset:12288
  ds_read_b64_tr_b16 a[142:143], v42 offset:14336
  s_waitcnt vmcnt(24) lgkmcnt(0)
  s_barrier
  s_load_dwordx2 s[8:9], s[0:1], 32
  s_mov_b32 s10, 8388608
  s_mov_b32 s11, 0x20000
  s_waitcnt lgkmcnt(0)
  s_add_u32 m0, s41, 0
  s_mov_b32 s42, 0
  buffer_load_dwordx4 v46, s[8:11], s42 offen lds
  s_add_u32 m0, s41, 4096
  s_mov_b32 s42, 131072
  buffer_load_dwordx4 v46, s[8:11], s42 offen lds
  s_add_u32 m0, s41, 8192
  s_mov_b32 s42, 262144
  buffer_load_dwordx4 v46, s[8:11], s42 offen lds
  s_add_u32 m0, s41, 12288
  s_mov_b32 s42, 393216
  buffer_load_dwordx4 v46, s[8:11], s42 offen lds
  ds_read_b64_tr_b16 a[144:145], v42 offset:16384
  ds_read_b64_tr_b16 a[146:147], v42 offset:18432
  ds_read_b64_tr_b16 a[148:149], v42 offset:20480
  ds_read_b64_tr_b16 a[150:151], v42 offset:22528
  ds_read_b64_tr_b16 a[152:153], v42 offset:24576
  ds_read_b64_tr_b16 a[154:155], v42 offset:26624
  ds_read_b64_tr_b16 a[156:157], v42 offset:28672
  ds_read_b64_tr_b16 a[158:159], v42 offset:30720
  s_waitcnt vmcnt(24) lgkmcnt(0)
  s_barrier
  s_add_u32 m0, s41, 16384
  s_mov_b32 s42, 524288
  buffer_load_dwordx4 v46, s[8:11], s42 offen lds
  s_add_u32 m0, s41, 20480
  s_mov_b32 s42, 655360
  buffer_load_dwordx4 v46, s[8:11], s42 offen lds
  s_add_u32 m0, s41, 24576
  s_mov_b32 s42, 786432
  buffer_load_dwordx4 v46, s[8:11], s42 offen lds
  s_add_u32 m0, s41, 28672
  s_mov_b32 s42, 917504
  buffer_load_dwordx4 v46, s[8:11], s42 offen lds
  ds_read_b64_tr_b16 a[160:161], v42 offset:32768
  ds_read_b64_tr_b16 a[162:163], v42 offset:34816
  ds_read_b64_tr_b16 a[164:165], v42 offset:36864
  ds_read_b64_tr_b16 a[166:167], v42 offset:38912
  ds_read_b64_tr_b16 a[168:169], v42 offset:40960
  ds_read_b64_tr_b16 a[170:171], v42 offset:43008
  ds_read_b64_tr_b16 a[172:173], v42 offset:45056
  ds_read_b64_tr_b16 a[174:175], v42 offset:47104
  s_waitcnt vmcnt(24) lgkmcnt(0)
  s_barrier
  s_add_u32 m0, s41, 32768
  s_mov_b32 s42, 1048576
  buffer_load_dwordx4 v46, s[8:11], s42 offen lds
  s_add_u32 m0, s41, 36864
  s_mov_b32 s42, 1179648
  buffer_load_dwordx4 v46, s[8:11], s42 offen lds
  s_add_u32 m0, s41, 40960
  s_mov_b32 s42, 1310720
  buffer_load_dwordx4 v46, s[8:11], s42 offen lds
  s_add_u32 m0, s41, 45056
  s_mov_b32 s42, 1441792
  buffer_load_dwordx4 v46, s[8:11], s42 offen lds
  ds_read_b64_tr_b16 a[176:177], v42 offset:49152
  ds_read_b64_tr_b16 a[178:179], v42 offset:51200
  ds_read_b64_tr_b16 a[180:181], v42 offset:53248
  ds_read_b64_tr_b16 a[182:183], v42 offset:55296
  ds_read_b64_tr_b16 a[184:185], v42 offset:57344
  ds_read_b64_tr_b16 a[186:187], v42 offset:59392
  ds_read_b64_tr_b16 a[188:189], v42 offset:61440
  ds_read_b64_tr_b16 a[190:191], v42 offset:63488
  s_waitcnt vmcnt(24) lgkmcnt(0)
  s_barrier
  s_add_u32 m0, s41, 49152
  s_mov_b32 s42, 1572864
  buffer_load_dwordx4 v46, s[8:11], s42 offen lds
  s_add_u32 m0, s41, 53248
  s_mov_b32 s42, 1703936
  buffer_load_dwordx4 v46, s[8:11], s42 offen lds
  s_add_u32 m0, s41, 57344
  s_mov_b32 s42, 1835008
  buffer_load_dwordx4 v46, s[8:11], s42 offen lds
  s_add_u32 m0, s41, 61440
  s_mov_b32 s42, 1966080
  buffer_load_dwordx4 v46, s[8:11], s42 offen lds
  ds_read_b64_tr_b16 a[192:193], v43 offset:0
  ds_read_b64_tr_b16 a[194:195], v43 offset:2048
  ds_read_b64_tr_b16 a[196:197], v43 offset:4096
  ds_read_b64_tr_b16 a[198:199], v43 offset:6144
  ds_read_b64_tr_b16 a[200:201], v43 offset:8192
  ds_read_b64_tr_b16 a[202:203], v43 offset:10240
  ds_read_b64_tr_b16 a[204:205], v43 offset:12288
  ds_read_b64_tr_b16 a[206:207], v43 offset:14336
  s_waitcnt vmcnt(24) lgkmcnt(0)
  s_barrier
  s_add_u32 m0, s41, 65536
  s_mov_b32 s42, 4194304
  buffer_load_dwordx4 v46, s[8:11], s42 offen lds
  s_add_u32 m0, s41, 69632
  s_mov_b32 s42, 4325376
  buffer_load_dwordx4 v46, s[8:11], s42 offen lds
  s_add_u32 m0, s41, 73728
  s_mov_b32 s42, 4456448
  buffer_load_dwordx4 v46, s[8:11], s42 offen lds
  s_add_u32 m0, s41, 77824
  s_mov_b32 s42, 4587520
  buffer_load_dwordx4 v46, s[8:11], s42 offen lds
  ds_read_b64_tr_b16 a[208:209], v43 offset:16384
  ds_read_b64_tr_b16 a[210:211], v43 offset:18432
  ds_read_b64_tr_b16 a[212:213], v43 offset:20480
  ds_read_b64_tr_b16 a[214:215], v43 offset:22528
  ds_read_b64_tr_b16 a[216:217], v43 offset:24576
  ds_read_b64_tr_b16 a[218:219], v43 offset:26624
  ds_read_b64_tr_b16 a[220:221], v43 offset:28672
  ds_read_b64_tr_b16 a[222:223], v43 offset:30720
  s_waitcnt vmcnt(24) lgkmcnt(0)
  s_barrier
  s_add_u32 m0, s41, 81920
  s_mov_b32 s42, 4718592
  buffer_load_dwordx4 v46, s[8:11], s42 offen lds
  s_add_u32 m0, s41, 86016
  s_mov_b32 s42, 4849664
  buffer_load_dwordx4 v46, s[8:11], s42 offen lds
  s_add_u32 m0, s41, 90112
  s_mov_b32 s42, 4980736
  buffer_load_dwordx4 v46, s[8:11], s42 offen lds
  s_add_u32 m0, s41, 94208
  s_mov_b32 s42, 5111808
  buffer_load_dwordx4 v46, s[8:11], s42 offen lds
  ds_read_b64_tr_b16 a[224:225], v43 offset:32768
  ds_read_b64_tr_b16 a[226:227], v43 offset:34816
  ds_read_b64_tr_b16 a[228:229], v43 offset:36864
  ds_read_b64_tr_b16 a[230:231], v43 offset:38912
  ds_read_b64_tr_b16 a[232:233], v43 offset:40960
  ds_read_b64_tr_b16 a[234:235], v43 offset:43008
  ds_read_b64_tr_b16 a[236:237], v43 offset:45056
  ds_read_b64_tr_b16 a[238:239], v43 offset:47104
  s_waitcnt vmcnt(24) lgkmcnt(0)
  s_barrier
  s_add_u32 m0, s41, 98304
  s_mov_b32 s42, 5242880
  buffer_load_dwordx4 v46, s[8:11], s42 offen lds
  s_add_u32 m0, s41, 102400
  s_mov_b32 s42, 5373952
  buffer_load_dwordx4 v46, s[8:11], s42 offen lds
  s_add_u32 m0, s41, 106496
  s_mov_b32 s42, 5505024
  buffer_load_dwordx4 v46, s[8:11], s42 offen lds
  s_add_u32 m0, s41, 110592
  s_mov_b32 s42, 5636096
  buffer_load_dwordx4 v46, s[8:11], s42 offen lds
  ds_read_b64_tr_b16 a[240:241], v43 offset:49152
  ds_read_b64_tr_b16 a[242:243], v43 offset:51200
  ds_read_b64_tr_b16 a[244:245], v43 offset:53248
  ds_read_b64_tr_b16 a[246:247], v43 offset:55296
  ds_read_b64_tr_b16 a[248:249], v43 offset:57344
  ds_read_b64_tr_b16 a[250:251], v43 offset:59392
  ds_read_b64_tr_b16 a[252:253], v43 offset:61440
  ds_read_b64_tr_b16 a[254:255], v43 offset:63488
  s_waitcnt vmcnt(24) lgkmcnt(0)
  s_barrier
  s_add_u32 m0, s41, 114688
  s_mov_b32 s42, 5767168
  buffer_load_dwordx4 v46, s[8:11], s42 offen lds
  s_add_u32 m0, s41, 118784
  s_mov_b32 s42, 5898240
  buffer_load_dwordx4 v46, s[8:11], s42 offen lds
  s_add_u32 m0, s41, 122880
  s_mov_b32 s42, 6029312
  buffer_load_dwordx4 v46, s[8:11], s42 offen lds
  s_add_u32 m0, s41, 126976
  s_mov_b32 s42, 6160384
  buffer_load_dwordx4 v46, s[8:11], s42 offen lds
  ds_read_b64_tr_b16 v[128:129], v42 offset:0
  ds_read_b64_tr_b16 v[130:131], v42 offset:2048
  ds_read_b64_tr_b16 v[132:133], v42 offset:4096
  ds_read_b64_tr_b16 v[134:135], v42 offset:6144
  ds_read_b64_tr_b16 v[136:137], v42 offset:8192
  ds_read_b64_tr_b16 v[138:139], v42 offset:10240
  ds_read_b64_tr_b16 v[140:141], v42 offset:12288
  ds_read_b64_tr_b16 v[142:143], v42 offset:14336
  s_waitcnt vmcnt(24) lgkmcnt(0)
  s_barrier
  ds_read_b64_tr_b16 v[144:145], v42 offset:16384
  ds_read_b64_tr_b16 v[146:147], v42 offset:18432
  ds_read_b64_tr_b16 v[148:149], v42 offset:20480
  ds_read_b64_tr_b16 v[150:151], v42 offset:22528
  ds_read_b64_tr_b16 v[152:153], v42 offset:24576
  ds_read_b64_tr_b16 v[154:155], v42 offset:26624
  ds_read_b64_tr_b16 v[156:157], v42 offset:28672
  ds_read_b64_tr_b16 v[158:159], v42 offset:30720
  s_waitcnt vmcnt(20) lgkmcnt(0)
  s_barrier
  ds_read_b64_tr_b16 v[160:161], v42 offset:32768
  ds_read_b64_tr_b16 v[162:163], v42 offset:34816
  ds_read_b64_tr_b16 v[164:165], v42 offset:36864
  ds_read_b64_tr_b16 v[166:167], v42 offset:38912
  ds_read_b64_tr_b16 v[168:169], v42 offset:40960
  ds_read_b64_tr_b16 v[170:171], v42 offset:43008
  ds_read_b64_tr_b16 v[172:173], v42 offset:45056
  ds_read_b64_tr_b16 v[174:175], v42 offset:47104
  s_waitcnt vmcnt(16) lgkmcnt(0)
  s_barrier
  ds_read_b64_tr_b16 v[176:177], v42 offset:49152
  ds_read_b64_tr_b16 v[178:179], v42 offset:51200
  ds_read_b64_tr_b16 v[180:181], v42 offset:53248
  ds_read_b64_tr_b16 v[182:183], v42 offset:55296
  ds_read_b64_tr_b16 v[184:185], v42 offset:57344
  ds_read_b64_tr_b16 v[186:187], v42 offset:59392
  ds_read_b64_tr_b16 v[188:189], v42 offset:61440
  ds_read_b64_tr_b16 v[190:191], v42 offset:63488
  s_waitcnt vmcnt(12) lgkmcnt(0)
  s_barrier
  ds_read_b64_tr_b16 v[192:193], v43 offset:0
  ds_read_b64_tr_b16 v[194:195], v43 offset:2048
  ds_read_b64_tr_b16 v[196:197], v43 offset:4096
  ds_read_b64_tr_b16 v[198:199], v43 offset:6144
  ds_read_b64_tr_b16 v[200:201], v43 offset:8192
  ds_read_b64_tr_b16 v[202:203], v43 offset:10240
  ds_read_b64_tr_b16 v[204:205], v43 offset:12288
  ds_read_b64_tr_b16 v[206:207], v43 offset:14336
  s_waitcnt vmcnt(8) lgkmcnt(0)
  s_barrier
  ds_read_b64_tr_b16 v[208:209], v43 offset:16384
  ds_read_b64_tr_b16 v[210:211], v43 offset:18432
  ds_read_b64_tr_b16 v[212:213], v43 offset:20480
  ds_read_b64_tr_b16 v[214:215], v43 offset:22528
  ds_read_b64_tr_b16 v[216:217], v43 offset:24576
  ds_read_b64_tr_b16 v[218:219], v43 offset:26624
  ds_read_b64_tr_b16 v[220:221], v43 offset:28672
  ds_read_b64_tr_b16 v[222:223], v43 offset:30720
  s_waitcnt vmcnt(4) lgkmcnt(0)
  s_barrier
  ds_read_b64_tr_b16 v[224:225], v43 offset:32768
  ds_read_b64_tr_b16 v[226:227], v43 offset:34816
  ds_read_b64_tr_b16 v[228:229], v43 offset:36864
  ds_read_b64_tr_b16 v[230:231], v43 offset:38912
  ds_read_b64_tr_b16 v[232:233], v43 offset:40960
  ds_read_b64_tr_b16 v[234:235], v43 offset:43008
  ds_read_b64_tr_b16 v[236:237], v43 offset:45056
  ds_read_b64_tr_b16 v[238:239], v43 offset:47104
  s_waitcnt vmcnt(0) lgkmcnt(0)
  s_barrier
  ds_read_b64_tr_b16 v[240:241], v43 offset:49152
  ds_read_b64_tr_b16 v[242:243], v43 offset:51200
  ds_read_b64_tr_b16 v[244:245], v43 offset:53248
  ds_read_b64_tr_b16 v[246:247], v43 offset:55296
  ds_read_b64_tr_b16 v[248:249], v43 offset:57344
  ds_read_b64_tr_b16 v[250:251], v43 offset:59392
  ds_read_b64_tr_b16 v[252:253], v43 offset:61440
  ds_read_b64_tr_b16 v[254:255], v43 offset:63488
  s_waitcnt lgkmcnt(0)
  s_barrier
  v_min_u32 v2, 31, v0
  v_lshlrev_b32 v2, 2, v2
  v_add_u32 v2, 128, v2
  s_nop 1
Lpoll_21:
  buffer_load_dword v3, v2, s[12:15], 0 offen sc1
  s_sub_u32 s24, s24, 1
  s_cbranch_scc1 L_FAIL
  s_waitcnt vmcnt(0)
  v_cmp_gt_i32 vcc, 1, v3
  s_cbranch_vccz Lpolld_22
  s_sleep 2
  s_branch Lpoll_21
Lpolld_22:
  v_min_u32 v2, 7, v0
  v_lshlrev_b32 v2, 2, v2
  v_add_u32 v2, 1388544, v2
  s_lshl_b32 s40, s21, 7
  s_add_u32 s40, s40, 1396736
  v_mov_b32 v77, 2147483392
  s_mov_b64 exec, 1
  v_mov_b32 v77, s40
  s_mov_b64 exec, -1
  s_mov_b32 s27, 2097152
  s_lshr_b32 s40, s21, 1
  s_mul_i32 s40, s40, 24576
  s_add_u32 s31, s40, 58720256
  s_and_b32 s41, s21, 1
  s_lshl_b32 s42, s20, 11
  s_lshl_b32 s40, s41, 13
  s_add_u32 s40, s40, s42
  v_lshl_add_u32 v76, v0, 4, s40
  s_lshl_b32 s40, s41, 10
  s_add_u32 s40, s40, s42
  s_add_u32 s40, s40, 16384
  v_lshl_add_u32 v84, v0, 4, s40
  v_lshrrev_b32 v60, 3, v0
  v_and_b32 v61, 6, v60
  v_xor_b32 v61, v61, v0
  v_and_b32 v61, 7, v61
  v_lshlrev_b32 v61, 4, v61
  v_lshl_add_u32 v1, v60, 11, v61
  s_lshl_b32 s40, s20, 14
  v_add_u32 v1, s40, v1
  s_lshl_b32 s32, s20, 10
  v_and_b32 v60, 6, v0
  v_lshrrev_b32 v61, 4, v0
  v_xor_b32 v60, v60, v61
  v_lshlrev_b32 v60, 4, v60
  v_and_b32 v61, 15, v0
  v_lshl_add_u32 v78, v61, 7, v60
  v_xor_b32 v79, 64, v78
  s_lshl_b32 s40, s20, 2
  s_add_u32 s40, s40, 131072
  v_mov_b32 v80, s40
  v_mov_b32 v60, 0
  ds_write_b32 v80, v60
  s_mov_b32 s25, 0
  s_mov_b32 s26, 0
  s_mov_b32 s29, 1
  s_mov_b32 s30, 0
  s_waitcnt lgkmcnt(0)
  s_barrier
  s_branch L_QKV_poll
L_QKV_top:
  s_cmp_lg_u32 s28, 0
  s_cbranch_scc1 L_QKV_go
  v_mov_b32 v60, s25
  v_and_b32 v61, 3, v0
  v_lshlrev_b32 v61, 2, v61
  v_add_u32 v61, 131072, v61
  s_waitcnt vmcnt(0)
  ds_write_b32 v80, v60
  ds_read_b32 v61, v61
  s_waitcnt lgkmcnt(0)
  v_cmp_gt_i32 vcc, s25, v61
  s_cbranch_vccnz L_QKV_nosig
  buffer_store_dword v60, v77, s[4:7], 0 offen sc1
L_QKV_nosig:
  s_cmp_ge_u32 s25, 64
  s_cbranch_scc1 L_END
L_QKV_poll:
  s_nop 0
Lpoll_23:
  buffer_load_dword v3, v2, s[4:7], s30 offen sc1
  s_sub_u32 s24, s24, 1
  s_cbranch_scc1 L_FAIL
  s_waitcnt vmcnt(0)
  v_cmp_gt_i32 vcc, s29, v3
  s_cbranch_vccz Lpolld_24
  s_sleep 2
  s_branch Lpoll_23
Lpolld_24:
  s_add_u32 s34, s26, s32
  s_mov_b32 s35, s27
  s_add_u32 m0, s34, 0
  s_nop 0
  buffer_load_dwordx4 v1, s[4:7], s35 offen offset:0 sc1 lds
  s_add_u32 m0, s34, 3968
  s_nop 0
  buffer_load_dwordx4 v1, s[4:7], s35 offen offset:128 sc1 lds
  s_add_u32 m0, s34, 7936
  s_nop 0
  buffer_load_dwordx4 v1, s[4:7], s35 offen offset:256 sc1 lds
  s_add_u32 m0, s34, 11904
  s_nop 0
  buffer_load_dwordx4 v1, s[4:7], s35 offen offset:384 sc1 lds
  s_add_u32 m0, s34, 15872
  s_nop 0
  buffer_load_dwordx4 v1, s[4:7], s35 offen offset:512 sc1 lds
  s_add_u32 m0, s34, 19840
  s_nop 0
  buffer_load_dwordx4 v1, s[4:7], s35 offen offset:640 sc1 lds
  s_add_u32 m0, s34, 23808
  s_nop 0
  buffer_load_dwordx4 v1, s[4:7], s35 offen offset:768 sc1 lds
  s_add_u32 m0, s34, 27776
  s_nop 0
  buffer_load_dwordx4 v1, s[4:7], s35 offen offset:896 sc1 lds
  s_add_u32 m0, s34, 31744
  s_nop 0
  buffer_load_dwordx4 v1, s[4:7], s35 offen offset:1024 sc1 lds
  s_add_u32 m0, s34, 35712
  s_nop 0
  buffer_load_dwordx4 v1, s[4:7], s35 offen offset:1152 sc1 lds
  s_add_u32 m0, s34, 39680
  s_nop 0
  buffer_load_dwordx4 v1, s[4:7], s35 offen offset:1280 sc1 lds
  s_add_u32 m0, s34, 43648
  s_nop 0
  buffer_load_dwordx4 v1, s[4:7], s35 offen offset:1408 sc1 lds
  s_add_u32 m0, s34, 47616
  s_nop 0
  buffer_load_dwordx4 v1, s[4:7], s35 offen offset:1536 sc1 lds
  s_add_u32 m0, s34, 51584
  s_nop 0
  buffer_load_dwordx4 v1, s[4:7], s35 offen offset:1664 sc1 lds
  s_add_u32 m0, s34, 55552
  s_nop 0
  buffer_load_dwordx4 v1, s[4:7], s35 offen offset:1792 sc1 lds
  s_add_u32 m0, s34, 59520
  s_nop 0
  buffer_load_dwordx4 v1, s[4:7], s35 offen offset:1920 sc1 lds
L_QKV_go:
  v_add_u32 v82, s26, v78
  v_add_u32 v83, s26, v79
  s_sub_u32 s26, 65536, s26
  s_add_u32 s27, s27, 65536
  s_add_u32 s34, s26, s32
  s_mov_b32 s35, s27
  s_add_u32 s30, s30, 128
  s_waitcnt vmcnt(12) lgkmcnt(0)
  s_barrier
  ds_read_b128 v[4:7], v82 offset:0
  ds_read_b128 v[8:11], v82 offset:2048
  ds_read_b128 v[12:15], v83 offset:0
  ds_read_b128 v[16:19], v83 offset:2048
  ds_read_b128 v[20:23], v82 offset:4096
  ds_read_b128 v[24:27], v82 offset:6144
  buffer_load_dword v3, v2, s[4:7], s30 offen sc1
  s_waitcnt lgkmcnt(4)
  v_mfma_f32_16x16x32_bf16 v[36:39], a[0:3], v[4:7], 0
  ds_read_b128 v[28:31], v83 offset:4096
  v_mfma_f32_16x16x32_bf16 v[40:43], a[0:3], v[8:11], 0
  ds_read_b128 v[32:35], v83 offset:6144
  v_mfma_f32_16x16x32_bf16 v[44:47], a[128:131], v[4:7], 0
  v_mfma_f32_16x16x32_bf16 v[48:51], a[128:131], v[8:11], 0
  v_mfma_f32_16x16x32_bf16 v[52:55], v[4:7], v[128:131], 0
  v_mfma_f32_16x16x32_bf16 v[56:59], v[8:11], v[128:131], 0
  s_waitcnt lgkmcnt(4)
  v_mfma_f32_16x16x32_bf16 v[36:39], a[4:7], v[12:15], v[36:39]
  ds_read_b128 v[4:7], v82 offset:8192
  v_mfma_f32_16x16x32_bf16 v[40:43], a[4:7], v[16:19], v[40:43]
  ds_read_b128 v[8:11], v82 offset:10240
  v_mfma_f32_16x16x32_bf16 v[44:47], a[132:135], v[12:15], v[44:47]
  v_mfma_f32_16x16x32_bf16 v[48:51], a[132:135], v[16:19], v[48:51]
  v_mfma_f32_16x16x32_bf16 v[52:55], v[12:15], v[132:135], v[52:55]
  v_mfma_f32_16x16x32_bf16 v[56:59], v[16:19], v[132:135], v[56:59]
  s_waitcnt lgkmcnt(4)
  v_mfma_f32_16x16x32_bf16 v[36:39], a[8:11], v[20:23], v[36:39]
  ds_read_b128 v[12:15], v83 offset:8192
  v_mfma_f32_16x16x32_bf16 v[40:43], a[8:11], v[24:27], v[40:43]
  ds_read_b128 v[16:19], v83 offset:10240
  v_mfma_f32_16x16x32_bf16 v[44:47], a[136:139], v[20:23], v[44:47]
  v_mfma_f32_16x16x32_bf16 v[48:51], a[136:139], v[24:27], v[48:51]
  v_mfma_f32_16x16x32_bf16 v[52:55], v[20:23], v[136:139], v[52:55]
  v_mfma_f32_16x16x32_bf16 v[56:59], v[24:27], v[136:139], v[56:59]
  s_waitcnt lgkmcnt(4)
  v_mfma_f32_16x16x32_bf16 v[36:39], a[12:15], v[28:31], v[36:39]
  ds_read_b128 v[20:23], v82 offset:12288
  v_mfma_f32_16x16x32_bf16 v[40:43], a[12:15], v[32:35], v[40:43]
  ds_read_b128 v[24:27], v82 offset:14336
  v_mfma_f32_16x16x32_bf16 v[44:47], a[140:143], v[28:31], v[44:47]
  v_mfma_f32_16x16x32_bf16 v[48:51], a[140:143], v[32:35], v[48:51]
  v_mfma_f32_16x16x32_bf16 v[52:55], v[28:31], v[140:143], v[52:55]
  v_mfma_f32_16x16x32_bf16 v[56:59], v[32:35], v[140:143], v[56:59]
  s_waitcnt lgkmcnt(4)
  v_mfma_f32_16x16x32_bf16 v[36:39], a[16:19], v[4:7], v[36:39]
  ds_read_b128 v[28:31], v83 offset:12288
  v_mfma_f32_16x16x32_bf16 v[40:43], a[16:19], v[8:11], v[40:43]
  ds_read_b128 v[32:35], v83 offset:14336
  v_mfma_f32_16x16x32_bf16 v[44:47], a[144:147], v[4:7], v[44:47]
  v_mfma_f32_16x16x32_bf16 v[48:51], a[144:147], v[8:11], v[48:51]
  v_mfma_f32_16x16x32_bf16 v[52:55], v[4:7], v[144:147], v[52:55]
  v_mfma_f32_16x16x32_bf16 v[56:59], v[8:11], v[144:147], v[56:59]
  s_waitcnt vmcnt(9)
  s_barrier
  s_waitcnt lgkmcnt(4)
  v_mfma_f32_16x16x32_bf16 v[36:39], a[20:23], v[12:15], v[36:39]
  ds_read_b128 v[4:7], v82 offset:16384
  v_mfma_f32_16x16x32_bf16 v[40:43], a[20:23], v[16:19], v[40:43]
  ds_read_b128 v[8:11], v82 offset:18432
  v_mfma_f32_16x16x32_bf16 v[44:47], a[148:151], v[12:15], v[44:47]
  v_mfma_f32_16x16x32_bf16 v[48:51], a[148:151], v[16:19], v[48:51]
  v_mfma_f32_16x16x32_bf16 v[52:55], v[12:15], v[148:151], v[52:55]
  v_mfma_f32_16x16x32_bf16 v[56:59], v[16:19], v[148:151], v[56:59]
  s_waitcnt lgkmcnt(4)
  v_mfma_f32_16x16x32_bf16 v[36:39], a[24:27], v[20:23], v[36:39]
  ds_read_b128 v[12:15], v83 offset:16384
  v_mfma_f32_16x16x32_bf16 v[40:43], a[24:27], v[24:27], v[40:43]
  ds_read_b128 v[16:19], v83 offset:18432
  v_mfma_f32_16x16x32_bf16 v[44:47], a[152:155], v[20:23], v[44:47]
  v_mfma_f32_16x16x32_bf16 v[48:51], a[152:155], v[24:27], v[48:51]
  v_mfma_f32_16x16x32_bf16 v[52:55], v[20:23], v[152:155], v[52:55]
  v_mfma_f32_16x16x32_bf16 v[56:59], v[24:27], v[152:155], v[56:59]
  s_waitcnt lgkmcnt(4)
  v_mfma_f32_16x16x32_bf16 v[36:39], a[28:31], v[28:31], v[36:39]
  ds_read_b128 v[20:23], v82 offset:20480
  v_mfma_f32_16x16x32_bf16 v[40:43], a[28:31], v[32:35], v[40:43]
  ds_read_b128 v[24:27], v82 offset:22528
  v_mfma_f32_16x16x32_bf16 v[44:47], a[156:159], v[28:31], v[44:47]
  v_mfma_f32_16x16x32_bf16 v[48:51], a[156:159], v[32:35], v[48:51]
  v_mfma_f32_16x16x32_bf16 v[52:55], v[28:31], v[156:159], v[52:55]
  v_mfma_f32_16x16x32_bf16 v[56:59], v[32:35], v[156:159], v[56:59]
  s_waitcnt lgkmcnt(4)
  v_mfma_f32_16x16x32_bf16 v[36:39], a[32:35], v[4:7], v[36:39]
  ds_read_b128 v[28:31], v83 offset:20480
  v_mfma_f32_16x16x32_bf16 v[40:43], a[32:35], v[8:11], v[40:43]
  ds_read_b128 v[32:35], v83 offset:22528
  v_mfma_f32_16x16x32_bf16 v[44:47], a[160:163], v[4:7], v[44:47]
  v_mfma_f32_16x16x32_bf16 v[48:51], a[160:163], v[8:11], v[48:51]
  v_mfma_f32_16x16x32_bf16 v[52:55], v[4:7], v[160:163], v[52:55]
  v_mfma_f32_16x16x32_bf16 v[56:59], v[8:11], v[160:163], v[56:59]
  s_waitcnt lgkmcnt(4)
  v_mfma_f32_16x16x32_bf16 v[36:39], a[36:39], v[12:15], v[36:39]
  ds_read_b128 v[4:7], v82 offset:24576
  v_mfma_f32_16x16x32_bf16 v[40:43], a[36:39], v[16:19], v[40:43]
  ds_read_b128 v[8:11], v82 offset:26624
  v_mfma_f32_16x16x32_bf16 v[44:47], a[164:167], v[12:15], v[44:47]
  v_mfma_f32_16x16x32_bf16 v[48:51], a[164:167], v[16:19], v[48:51]
  v_mfma_f32_16x16x32_bf16 v[52:55], v[12:15], v[164:167], v[52:55]
  v_mfma_f32_16x16x32_bf16 v[56:59], v[16:19], v[164:167], v[56:59]
  s_waitcnt lgkmcnt(4)
  v_mfma_f32_16x16x32_bf16 v[36:39], a[40:43], v[20:23], v[36:39]
  ds_read_b128 v[12:15], v83 offset:24576
  v_mfma_f32_16x16x32_bf16 v[40:43], a[40:43], v[24:27], v[40:43]
  ds_read_b128 v[16:19], v83 offset:26624
  v_mfma_f32_16x16x32_bf16 v[44:47], a[168:171], v[20:23], v[44:47]
  v_mfma_f32_16x16x32_bf16 v[48:51], a[168:171], v[24:27], v[48:51]
  v_mfma_f32_16x16x32_bf16 v[52:55], v[20:23], v[168:171], v[52:55]
  v_mfma_f32_16x16x32_bf16 v[56:59], v[24:27], v[168:171], v[56:59]
  s_waitcnt lgkmcnt(4)
  v_mfma_f32_16x16x32_bf16 v[36:39], a[44:47], v[28:31], v[36:39]
  ds_read_b128 v[20:23], v82 offset:28672
  v_mfma_f32_16x16x32_bf16 v[40:43], a[44:47], v[32:35], v[40:43]
  ds_read_b128 v[24:27], v82 offset:30720
  v_mfma_f32_16x16x32_bf16 v[44:47], a[172:175], v[28:31], v[44:47]
  v_mfma_f32_16x16x32_bf16 v[48:51], a[172:175], v[32:35], v[48:51]
  v_mfma_f32_16x16x32_bf16 v[52:55], v[28:31], v[172:175], v[52:55]
  v_mfma_f32_16x16x32_bf16 v[56:59], v[32:35], v[172:175], v[56:59]
  s_waitcnt lgkmcnt(4)
  v_mfma_f32_16x16x32_bf16 v[36:39], a[48:51], v[4:7], v[36:39]
  ds_read_b128 v[28:31], v83 offset:28672
  v_mfma_f32_16x16x32_bf16 v[40:43], a[48:51], v[8:11], v[40:43]
  ds_read_b128 v[32:35], v83 offset:30720
  v_mfma_f32_16x16x32_bf16 v[44:47], a[176:179], v[4:7], v[44:47]
  v_mfma_f32_16x16x32_bf16 v[48:51], a[176:179], v[8:11], v[48:51]
  v_mfma_f32_16x16x32_bf16 v[52:55], v[4:7], v[176:179], v[52:55]
  v_mfma_f32_16x16x32_bf16 v[56:59], v[8:11], v[176:179], v[56:59]
  s_waitcnt vmcnt(0)
  s_barrier
  v_mov_b32 v60, s25
  v_cmp_gt_i32 vcc, s29, v3
  s_cmp_lg_u32 s20, 0
  s_cbranch_scc1 L_QKV_s2
  buffer_store_dword v60, v77, s[4:7], 0 offen sc1
L_QKV_s2:
  s_mov_b32 s28, 0
  s_cbranch_vccnz L_QKV_nopf
  s_cmp_ge_u32 s25, 63
  s_cbranch_scc1 L_QKV_nopf
  s_mov_b32 s28, 1
  s_waitcnt lgkmcnt(4)
  v_mfma_f32_16x16x32_bf16 v[36:39], a[52:55], v[12:15], v[36:39]
  ds_read_b128 v[4:7], v82 offset:32768
  v_mfma_f32_16x16x32_bf16 v[40:43], a[52:55], v[16:19], v[40:43]
  ds_read_b128 v[8:11], v82 offset:34816
  v_mfma_f32_16x16x32_bf16 v[44:47], a[180:183], v[12:15], v[44:47]
  s_add_u32 m0, s34, 0
  s_nop 0
  buffer_load_dwordx4 v1, s[4:7], s35 offen offset:0 sc1 lds
  v_mfma_f32_16x16x32_bf16 v[48:51], a[180:183], v[16:19], v[48:51]
  v_mfma_f32_16x16x32_bf16 v[52:55], v[12:15], v[180:183], v[52:55]
  v_mfma_f32_16x16x32_bf16 v[56:59], v[16:19], v[180:183], v[56:59]
  s_waitcnt lgkmcnt(4)
  v_mfma_f32_16x16x32_bf16 v[36:39], a[56:59], v[20:23], v[36:39]
  ds_read_b128 v[12:15], v83 offset:32768
  v_mfma_f32_16x16x32_bf16 v[40:43], a[56:59], v[24:27], v[40:43]
  ds_read_b128 v[16:19], v83 offset:34816
  v_mfma_f32_16x16x32_bf16 v[44:47], a[184:187], v[20:23], v[44:47]
  s_add_u32 m0, s34, 3968
  s_nop 0
  buffer_load_dwordx4 v1, s[4:7], s35 offen offset:128 sc1 lds
  v_mfma_f32_16x16x32_bf16 v[48:51], a[184:187], v[24:27], v[48:51]
  v_mfma_f32_16x16x32_bf16 v[52:55], v[20:23], v[184:187], v[52:55]
  v_mfma_f32_16x16x32_bf16 v[56:59], v[24:27], v[184:187], v[56:59]
  s_waitcnt lgkmcnt(4)
  v_mfma_f32_16x16x32_bf16 v[36:39], a[60:63], v[28:31], v[36:39]
  ds_read_b128 v[20:23], v82 offset:36864
  v_mfma_f32_16x16x32_bf16 v[40:43], a[60:63], v[32:35], v[40:43]
  ds_read_b128 v[24:27], v82 offset:38912
  v_mfma_f32_16x16x32_bf16 v[44:47], a[188:191], v[28:31], v[44:47]
  s_add_u32 m0, s34, 7936
  s_nop 0
  buffer_load_dwordx4 v1, s[4:7], s35 offen offset:256 sc1 lds
  v_mfma_f32_16x16x32_bf16 v[48:51], a[188:191], v[32:35], v[48:51]
  v_mfma_f32_16x16x32_bf16 v[52:55], v[28:31], v[188:191], v[52:55]
  v_mfma_f32_16x16x32_bf16 v[56:59], v[32:35], v[188:191], v[56:59]
  s_waitcnt lgkmcnt(4)
  v_mfma_f32_16x16x32_bf16 v[36:39], a[64:67], v[4:7], v[36:39]
  ds_read_b128 v[28:31], v83 offset:36864
  v_mfma_f32_16x16x32_bf16 v[40:43], a[64:67], v[8:11], v[40:43]
  ds_read_b128 v[32:35], v83 offset:38912
  v_mfma_f32_16x16x32_bf16 v[44:47], a[192:195], v[4:7], v[44:47]
  s_add_u32 m0, s34, 11904
  s_nop 0
  buffer_load_dwordx4 v1, s[4:7], s35 offen offset:384 sc1 lds
  v_mfma_f32_16x16x32_bf16 v[48:51], a[192:195], v[8:11], v[48:51]
  v_mfma_f32_16x16x32_bf16 v[52:55], v[4:7], v[192:195], v[52:55]
  v_mfma_f32_16x16x32_bf16 v[56:59], v[8:11], v[192:195], v[56:59]
  s_waitcnt lgkmcnt(4)
  v_mfma_f32_16x16x32_bf16 v[36:39], a[68:71], v[12:15], v[36:39]
  ds_read_b128 v[4:7], v82 offset:40960
  v_mfma_f32_16x16x32_bf16 v[40:43], a[68:71], v[16:19], v[40:43]
  ds_read_b128 v[8:11], v82 offset:43008
  v_mfma_f32_16x16x32_bf16 v[44:47], a[196:199], v[12:15], v[44:47]
  s_add_u32 m0, s34, 15872
  s_nop 0
  buffer_load_dwordx4 v1, s[4:7], s35 offen offset:512 sc1 lds
  v_mfma_f32_16x16x32_bf16 v[48:51], a[196:199], v[16:19], v[48:51]
  v_mfma_f32_16x16x32_bf16 v[52:55], v[12:15], v[196:199], v[52:55]
  v_mfma_f32_16x16x32_bf16 v[56:59], v[16:19], v[196:199], v[56:59]
  s_waitcnt lgkmcnt(4)
  v_mfma_f32_16x16x32_bf16 v[36:39], a[72:75], v[20:23], v[36:39]
  ds_read_b128 v[12:15], v83 offset:40960
  v_mfma_f32_16x16x32_bf16 v[40:43], a[72:75], v[24:27], v[40:43]
  ds_read_b128 v[16:19], v83 offset:43008
  v_mfma_f32_16x16x32_bf16 v[44:47], a[200:203], v[20:23], v[44:47]
  s_add_u32 m0, s34, 19840
  s_nop 0
  buffer_load_dwordx4 v1, s[4:7], s35 offen offset:640 sc1 lds
  v_mfma_f32_16x16x32_bf16 v[48:51], a[200:203], v[24:27], v[48:51]
  v_mfma_f32_16x16x32_bf16 v[52:55], v[20:23], v[200:203], v[52:55]
  v_mfma_f32_16x16x32_bf16 v[56:59], v[24:27], v[200:203], v[56:59]
  s_waitcnt lgkmcnt(4)
  v_mfma_f32_16x16x32_bf16 v[36:39], a[76:79], v[28:31], v[36:39]
  ds_read_b128 v[20:23], v82 offset:45056
  v_mfma_f32_16x16x32_bf16 v[40:43], a[76:79], v[32:35], v[40:43]
  ds_read_b128 v[24:27], v82 offset:47104
  v_mfma_f32_16x16x32_bf16 v[44:47], a[204:207], v[28:31], v[44:47]
  s_add_u32 m0, s34, 23808
  s_nop 0
  buffer_load_dwordx4 v1, s[4:7], s35 offen offset:768 sc1 lds
  v_mfma_f32_16x16x32_bf16 v[48:51], a[204:207], v[32:35], v[48:51]
  v_mfma_f32_16x16x32_bf16 v[52:55], v[28:31], v[204:207], v[52:55]
  v_mfma_f32_16x16x32_bf16 v[56:59], v[32:35], v[204:207], v[56:59]
  s_waitcnt lgkmcnt(4)
  v_mfma_f32_16x16x32_bf16 v[36:39], a[80:83], v[4:7], v[36:39]
  ds_read_b128 v[28:31], v83 offset:45056
  v_mfma_f32_16x16x32_bf16 v[40:43], a[80:83], v[8:11], v[40:43]
  ds_read_b128 v[32:35], v83 offset:47104
  v_mfma_f32_16x16x32_bf16 v[44:47], a[208:211], v[4:7], v[44:47]
  s_add_u32 m0, s34, 27776
  s_nop 0
  buffer_load_dwordx4 v1, s[4:7], s35 offen offset:896 sc1 lds
  v_mfma_f32_16x16x32_bf16 v[48:51], a[208:211], v[8:11], v[48:51]
  v_mfma_f32_16x16x32_bf16 v[52:55], v[4:7], v[208:211], v[52:55]
  v_mfma_f32_16x16x32_bf16 v[56:59], v[8:11], v[208:211], v[56:59]
  s_waitcnt lgkmcnt(4)
  v_mfma_f32_16x16x32_bf16 v[36:39], a[84:87], v[12:15], v[36:39]
  ds_read_b128 v[4:7], v82 offset:49152
  v_mfma_f32_16x16x32_bf16 v[40:43], a[84:87], v[16:19], v[40:43]
  ds_read_b128 v[8:11], v82 offset:51200
  v_mfma_f32_16x16x32_bf16 v[44:47], a[212:215], v[12:15], v[44:47]
  s_add_u32 m0, s34, 31744
  s_nop 0
  buffer_load_dwordx4 v1, s[4:7], s35 offen offset:1024 sc1 lds
  v_mfma_f32_16x16x32_bf16 v[48:51], a[212:215], v[16:19], v[48:51]
  v_mfma_f32_16x16x32_bf16 v[52:55], v[12:15], v[212:215], v[52:55]
  v_mfma_f32_16x16x32_bf16 v[56:59], v[16:19], v[212:215], v[56:59]
  s_waitcnt lgkmcnt(4)
  v_mfma_f32_16x16x32_bf16 v[36:39], a[88:91], v[20:23], v[36:39]
  ds_read_b128 v[12:15], v83 offset:49152
  v_mfma_f32_16x16x32_bf16 v[40:43], a[88:91], v[24:27], v[40:43]
  ds_read_b128 v[16:19], v83 offset:51200
  v_mfma_f32_16x16x32_bf16 v[44:47], a[216:219], v[20:23], v[44:47]
  s_add_u32 m0, s34, 35712
  s_nop 0
  buffer_load_dwordx4 v1, s[4:7], s35 offen offset:1152 sc1 lds
  v_mfma_f32_16x16x32_bf16 v[48:51], a[216:219], v[24:27], v[48:51]
  v_mfma_f32_16x16x32_bf16 v[52:55], v[20:23], v[216:219], v[52:55]
  v_mfma_f32_16x16x32_bf16 v[56:59], v[24:27], v[216:219], v[56:59]
  s_waitcnt lgkmcnt(4)
  v_mfma_f32_16x16x32_bf16 v[36:39], a[92:95], v[28:31], v[36:39]
  ds_read_b128 v[20:23], v82 offset:53248
  v_mfma_f32_16x16x32_bf16 v[40:43], a[92:95], v[32:35], v[40:43]
  ds_read_b128 v[24:27], v82 offset:55296
  v_mfma_f32_16x16x32_bf16 v[44:47], a[220:223], v[28:31], v[44:47]
  s_add_u32 m0, s34, 39680
  s_nop 0
  buffer_load_dwordx4 v1, s[4:7], s35 offen offset:1280 sc1 lds
  v_mfma_f32_16x16x32_bf16 v[48:51], a[220:223], v[32:35], v[48:51]
  v_mfma_f32_16x16x32_bf16 v[52:55], v[28:31], v[220:223], v[52:55]
  v_mfma_f32_16x16x32_bf16 v[56:59], v[32:35], v[220:223], v[56:59]
  s_waitcnt lgkmcnt(4)
  v_mfma_f32_16x16x32_bf16 v[36:39], a[96:99], v[4:7], v[36:39]
  ds_read_b128 v[28:31], v83 offset:53248
  v_mfma_f32_16x16x32_bf16 v[40:43], a[96:99], v[8:11], v[40:43]
  ds_read_b128 v[32:35], v83 offset:55296
  v_mfma_f32_16x16x32_bf16 v[44:47], a[224:227], v[4:7], v[44:47]
  s_add_u32 m0, s34, 43648
  s_nop 0
  buffer_load_dwordx4 v1, s[4:7], s35 offen offset:1408 sc1 lds
  v_mfma_f32_16x16x32_bf16 v[48:51], a[224:227], v[8:11], v[48:51]
  v_mfma_f32_16x16x32_bf16 v[52:55], v[4:7], v[224:227], v[52:55]
  v_mfma_f32_16x16x32_bf16 v[56:59], v[8:11], v[224:227], v[56:59]
  s_waitcnt lgkmcnt(4)
  v_mfma_f32_16x16x32_bf16 v[36:39], a[100:103], v[12:15], v[36:39]
  ds_read_b128 v[4:7], v82 offset:57344
  v_mfma_f32_16x16x32_bf16 v[40:43], a[100:103], v[16:19], v[40:43]
  ds_read_b128 v[8:11], v82 offset:59392
  v_mfma_f32_16x16x32_bf16 v[44:47], a[228:231], v[12:15], v[44:47]
  s_add_u32 m0, s34, 47616
  s_nop 0
  buffer_load_dwordx4 v1, s[4:7], s35 offen offset:1536 sc1 lds
  v_mfma_f32_16x16x32_bf16 v[48:51], a[228:231], v[16:19], v[48:51]
  v_mfma_f32_16x16x32_bf16 v[52:55], v[12:15], v[228:231], v[52:55]
  v_mfma_f32_16x16x32_bf16 v[56:59], v[16:19], v[228:231], v[56:59]
  s_waitcnt lgkmcnt(4)
  v_mfma_f32_16x16x32_bf16 v[36:39], a[104:107], v[20:23], v[36:39]
  ds_read_b128 v[12:15], v83 offset:57344
  v_mfma_f32_16x16x32_bf16 v[40:43], a[104:107], v[24:27], v[40:43]
  ds_read_b128 v[16:19], v83 offset:59392
  v_mfma_f32_16x16x32_bf16 v[44:47], a[232:235], v[20:23], v[44:47]
  s_add_u32 m0, s34, 51584
  s_nop 0
  buffer_load_dwordx4 v1, s[4:7], s35 offen offset:1664 sc1 lds
  v_mfma_f32_16x16x32_bf16 v[48:51], a[232:235], v[24:27], v[48:51]
  v_mfma_f32_16x16x32_bf16 v[52:55], v[20:23], v[232:235], v[52:55]
  v_mfma_f32_16x16x32_bf16 v[56:59], v[24:27], v[232:235], v[56:59]
  s_waitcnt lgkmcnt(4)
  v_mfma_f32_16x16x32_bf16 v[36:39], a[108:111], v[28:31], v[36:39]
  ds_read_b128 v[20:23], v82 offset:61440
  v_mfma_f32_16x16x32_bf16 v[40:43], a[108:111], v[32:35], v[40:43]
  ds_read_b128 v[24:27], v82 offset:63488
  v_mfma_f32_16x16x32_bf16 v[44:47], a[236:239], v[28:31], v[44:47]
  s_add_u32 m0, s34, 55552
  s_nop 0
  buffer_load_dwordx4 v1, s[4:7], s35 offen offset:1792 sc1 lds
  v_mfma_f32_16x16x32_bf16 v[48:51], a[236:239], v[32:35], v[48:51]
  v_mfma_f32_16x16x32_bf16 v[52:55], v[28:31], v[236:239], v[52:55]
  v_mfma_f32_16x16x32_bf16 v[56:59], v[32:35], v[236:239], v[56:59]
  s_waitcnt lgkmcnt(4)
  v_mfma_f32_16x16x32_bf16 v[36:39], a[112:115], v[4:7], v[36:39]
  ds_read_b128 v[28:31], v83 offset:61440
  v_mfma_f32_16x16x32_bf16 v[40:43], a[112:115], v[8:11], v[40:43]
  ds_read_b128 v[32:35], v83 offset:63488
  v_mfma_f32_16x16x32_bf16 v[44:47], a[240:243], v[4:7], v[44:47]
  s_add_u32 m0, s34, 59520
  s_nop 0
  buffer_load_dwordx4 v1, s[4:7], s35 offen offset:1920 sc1 lds
  v_mfma_f32_16x16x32_bf16 v[48:51], a[240:243], v[8:11], v[48:51]
  v_mfma_f32_16x16x32_bf16 v[52:55], v[4:7], v[240:243], v[52:55]
  v_mfma_f32_16x16x32_bf16 v[56:59], v[8:11], v[240:243], v[56:59]
  s_waitcnt lgkmcnt(4)
  v_mfma_f32_16x16x32_bf16 v[36:39], a[116:119], v[12:15], v[36:39]
  v_mfma_f32_16x16x32_bf16 v[40:43], a[116:119], v[16:19], v[40:43]
  v_mfma_f32_16x16x32_bf16 v[44:47], a[244:247], v[12:15], v[44:47]
  v_mfma_f32_16x16x32_bf16 v[48:51], a[244:247], v[16:19], v[48:51]
  v_mfma_f32_16x16x32_bf16 v[52:55], v[12:15], v[244:247], v[52:55]
  v_mfma_f32_16x16x32_bf16 v[56:59], v[16:19], v[244:247], v[56:59]
  s_waitcnt lgkmcnt(2)
  v_mfma_f32_16x16x32_bf16 v[36:39], a[120:123], v[20:23], v[36:39]
  v_mfma_f32_16x16x32_bf16 v[40:43], a[120:123], v[24:27], v[40:43]
  v_mfma_f32_16x16x32_bf16 v[44:47], a[248:251], v[20:23], v[44:47]
  v_mfma_f32_16x16x32_bf16 v[48:51], a[248:251], v[24:27], v[48:51]
  v_mfma_f32_16x16x32_bf16 v[52:55], v[20:23], v[248:251], v[52:55]
  v_mfma_f32_16x16x32_bf16 v[56:59], v[24:27], v[248:251], v[56:59]
  s_waitcnt lgkmcnt(0)
  v_mfma_f32_16x16x32_bf16 v[36:39], a[124:127], v[28:31], v[36:39]
  v_mfma_f32_16x16x32_bf16 v[40:43], a[124:127], v[32:35], v[40:43]
  v_mfma_f32_16x16x32_bf16 v[44:47], a[252:255], v[28:31], v[44:47]
  v_mfma_f32_16x16x32_bf16 v[48:51], a[252:255], v[32:35], v[48:51]
  v_mfma_f32_16x16x32_bf16 v[52:55], v[28:31], v[252:255], v[52:55]
  v_mfma_f32_16x16x32_bf16 v[56:59], v[32:35], v[252:255], v[56:59]
  s_nop 7
  s_branch L_QKV_epi
L_QKV_nopf:
  s_waitcnt lgkmcnt(4)
  v_mfma_f32_16x16x32_bf16 v[36:39], a[52:55], v[12:15], v[36:39]
  ds_read_b128 v[4:7], v82 offset:32768
  v_mfma_f32_16x16x32_bf16 v[40:43], a[52:55], v[16:19], v[40:43]
  ds_read_b128 v[8:11], v82 offset:34816
  v_mfma_f32_16x16x32_bf16 v[44:47], a[180:183], v[12:15], v[44:47]
  v_mfma_f32_16x16x32_bf16 v[48:51], a[180:183], v[16:19], v[48:51]
  v_mfma_f32_16x16x32_bf16 v[52:55], v[12:15], v[180:183], v[52:55]
  v_mfma_f32_16x16x32_bf16 v[56:59], v[16:19], v[180:183], v[56:59]
  s_waitcnt lgkmcnt(4)
  v_mfma_f32_16x16x32_bf16 v[36:39], a[56:59], v[20:23], v[36:39]
  ds_read_b128 v[12:15], v83 offset:32768
  v_mfma_f32_16x16x32_bf16 v[40:43], a[56:59], v[24:27], v[40:43]
  ds_read_b128 v[16:19], v83 offset:34816
  v_mfma_f32_16x16x32_bf16 v[44:47], a[184:187], v[20:23], v[44:47]
  v_mfma_f32_16x16x32_bf16 v[48:51], a[184:187], v[24:27], v[48:51]
  v_mfma_f32_16x16x32_bf16 v[52:55], v[20:23], v[184:187], v[52:55]
  v_mfma_f32_16x16x32_bf16 v[56:59], v[24:27], v[184:187], v[56:59]
  s_waitcnt lgkmcnt(4)
  v_mfma_f32_16x16x32_bf16 v[36:39], a[60:63], v[28:31], v[36:39]
  ds_read_b128 v[20:23], v82 offset:36864
  v_mfma_f32_16x16x32_bf16 v[40:43], a[60:63], v[32:35], v[40:43]
  ds_read_b128 v[24:27], v82 offset:38912
  v_mfma_f32_16x16x32_bf16 v[44:47], a[188:191], v[28:31], v[44:47]
  v_mfma_f32_16x16x32_bf16 v[48:51], a[188:191], v[32:35], v[48:51]
  v_mfma_f32_16x16x32_bf16 v[52:55], v[28:31], v[188:191], v[52:55]
  v_mfma_f32_16x16x32_bf16 v[56:59], v[32:35], v[188:191], v[56:59]
  s_waitcnt lgkmcnt(4)
  v_mfma_f32_16x16x32_bf16 v[36:39], a[64:67], v[4:7], v[36:39]
  ds_read_b128 v[28:31], v83 offset:36864
  v_mfma_f32_16x16x32_bf16 v[40:43], a[64:67], v[8:11], v[40:43]
  ds_read_b128 v[32:35], v83 offset:38912
  v_mfma_f32_16x16x32_bf16 v[44:47], a[192:195], v[4:7], v[44:47]
  v_mfma_f32_16x16x32_bf16 v[48:51], a[192:195], v[8:11], v[48:51]
  v_mfma_f32_16x16x32_bf16 v[52:55], v[4:7], v[192:195], v[52:55]
  v_mfma_f32_16x16x32_bf16 v[56:59], v[8:11], v[192:195], v[56:59]
  s_waitcnt lgkmcnt(4)
  v_mfma_f32_16x16x32_bf16 v[36:39], a[68:71], v[12:15], v[36:39]
  ds_read_b128 v[4:7], v82 offset:40960
  v_mfma_f32_16x16x32_bf16 v[40:43], a[68:71], v[16:19], v[40:43]
  ds_read_b128 v[8:11], v82 offset:43008
  v_mfma_f32_16x16x32_bf16 v[44:47], a[196:199], v[12:15], v[44:47]
  v_mfma_f32_16x16x32_bf16 v[48:51], a[196:199], v[16:19], v[48:51]
  v_mfma_f32_16x16x32_bf16 v[52:55], v[12:15], v[196:199], v[52:55]
  v_mfma_f32_16x16x32_bf16 v[56:59], v[16:19], v[196:199], v[56:59]
  s_waitcnt lgkmcnt(4)
  v_mfma_f32_16x16x32_bf16 v[36:39], a[72:75], v[20:23], v[36:39]
  ds_read_b128 v[12:15], v83 offset:40960
  v_mfma_f32_16x16x32_bf16 v[40:43], a[72:75], v[24:27], v[40:43]
  ds_read_b128 v[16:19], v83 offset:43008
  v_mfma_f32_16x16x32_bf16 v[44:47], a[200:203], v[20:23], v[44:47]
  v_mfma_f32_16x16x32_bf16 v[48:51], a[200:203], v[24:27], v[48:51]
  v_mfma_f32_16x16x32_bf16 v[52:55], v[20:23], v[200:203], v[52:55]
  v_mfma_f32_16x16x32_bf16 v[56:59], v[24:27], v[200:203], v[56:59]
  s_waitcnt lgkmcnt(4)
  v_mfma_f32_16x16x32_bf16 v[36:39], a[76:79], v[28:31], v[36:39]
  ds_read_b128 v[20:23], v82 offset:45056
  v_mfma_f32_16x16x32_bf16 v[40:43], a[76:79], v[32:35], v[40:43]
  ds_read_b128 v[24:27], v82 offset:47104
  v_mfma_f32_16x16x32_bf16 v[44:47], a[204:207], v[28:31], v[44:47]
  v_mfma_f32_16x16x32_bf16 v[48:51], a[204:207], v[32:35], v[48:51]
  v_mfma_f32_16x16x32_bf16 v[52:55], v[28:31], v[204:207], v[52:55]
  v_mfma_f32_16x16x32_bf16 v[56:59], v[32:35], v[204:207], v[56:59]
  s_waitcnt lgkmcnt(4)
  v_mfma_f32_16x16x32_bf16 v[36:39], a[80:83], v[4:7], v[36:39]
  ds_read_b128 v[28:31], v83 offset:45056
  v_mfma_f32_16x16x32_bf16 v[40:43], a[80:83], v[8:11], v[40:43]
  ds_read_b128 v[32:35], v83 offset:47104
  v_mfma_f32_16x16x32_bf16 v[44:47], a[208:211], v[4:7], v[44:47]
  v_mfma_f32_16x16x32_bf16 v[48:51], a[208:211], v[8:11], v[48:51]
  v_mfma_f32_16x16x32_bf16 v[52:55], v[4:7], v[208:211], v[52:55]
  v_mfma_f32_16x16x32_bf16 v[56:59], v[8:11], v[208:211], v[56:59]
  s_waitcnt lgkmcnt(4)
  v_mfma_f32_16x16x32_bf16 v[36:39], a[84:87], v[12:15], v[36:39]
  ds_read_b128 v[4:7], v82 offset:49152
  v_mfma_f32_16x16x32_bf16 v[40:43], a[84:87], v[16:19], v[40:43]
  ds_read_b128 v[8:11], v82 offset:51200
  v_mfma_f32_16x16x32_bf16 v[44:47], a[212:215], v[12:15], v[44:47]
  v_mfma_f32_16x16x32_bf16 v[48:51], a[212:215], v[16:19], v[48:51]
  v_mfma_f32_16x16x32_bf16 v[52:55], v[12:15], v[212:215], v[52:55]
  v_mfma_f32_16x16x32_bf16 v[56:59], v[16:19], v[212:215], v[56:59]
  s_waitcnt lgkmcnt(4)
  v_mfma_f32_16x16x32_bf16 v[36:39], a[88:91], v[20:23], v[36:39]
  ds_read_b128 v[12:15], v83 offset:49152
  v_mfma_f32_16x16x32_bf16 v[40:43], a[88:91], v[24:27], v[40:43]
  ds_read_b128 v[16:19], v83 offset:51200
  v_mfma_f32_16x16x32_bf16 v[44:47], a[216:219], v[20:23], v[44:47]
  v_mfma_f32_16x16x32_bf16 v[48:51], a[216:219], v[24:27], v[48:51]
  v_mfma_f32_16x16x32_bf16 v[52:55], v[20:23], v[216:219], v[52:55]
  v_mfma_f32_16x16x32_bf16 v[56:59], v[24:27], v[216:219], v[56:59]
  s_waitcnt lgkmcnt(4)
  v_mfma_f32_16x16x32_bf16 v[36:39], a[92:95], v[28:31], v[36:39]
  ds_read_b128 v[20:23], v82 offset:53248
  v_mfma_f32_16x16x32_bf16 v[40:43], a[92:95], v[32:35], v[40:43]
  ds_read_b128 v[24:27], v82 offset:55296
  v_mfma_f32_16x16x32_bf16 v[44:47], a[220:223], v[28:31], v[44:47]
  v_mfma_f32_16x16x32_bf16 v[48:51], a[220:223], v[32:35], v[48:51]
  v_mfma_f32_16x16x32_bf16 v[52:55], v[28:31], v[220:223], v[52:55]
  v_mfma_f32_16x16x32_bf16 v[56:59], v[32:35], v[220:223], v[56:59]
  s_waitcnt lgkmcnt(4)
  v_mfma_f32_16x16x32_bf16 v[36:39], a[96:99], v[4:7], v[36:39]
  ds_read_b128 v[28:31], v83 offset:53248
  v_mfma_f32_16x16x32_bf16 v[40:43], a[96:99], v[8:11], v[40:43]
  ds_read_b128 v[32:35], v83 offset:55296
  v_mfma_f32_16x16x32_bf16 v[44:47], a[224:227], v[4:7], v[44:47]
  v_mfma_f32_16x16x32_bf16 v[48:51], a[224:227], v[8:11], v[48:51]
  v_mfma_f32_16x16x32_bf16 v[52:55], v[4:7], v[224:227], v[52:55]
  v_mfma_f32_16x16x32_bf16 v[56:59], v[8:11], v[224:227], v[56:59]
  s_waitcnt lgkmcnt(4)
  v_mfma_f32_16x16x32_bf16 v[36:39], a[100:103], v[12:15], v[36:39]
  ds_read_b128 v[4:7], v82 offset:57344
  v_mfma_f32_16x16x32_bf16 v[40:43], a[100:103], v[16:19], v[40:43]
  ds_read_b128 v[8:11], v82 offset:59392
  v_mfma_f32_16x16x32_bf16 v[44:47], a[228:231], v[12:15], v[44:47]
  v_mfma_f32_16x16x32_bf16 v[48:51], a[228:231], v[16:19], v[48:51]
  v_mfma_f32_16x16x32_bf16 v[52:55], v[12:15], v[228:231], v[52:55]
  v_mfma_f32_16x16x32_bf16 v[56:59], v[16:19], v[228:231], v[56:59]
  s_waitcnt lgkmcnt(4)
  v_mfma_f32_16x16x32_bf16 v[36:39], a[104:107], v[20:23], v[36:39]
  ds_read_b128 v[12:15], v83 offset:57344
  v_mfma_f32_16x16x32_bf16 v[40:43], a[104:107], v[24:27], v[40:43]
  ds_read_b128 v[16:19], v83 offset:59392
  v_mfma_f32_16x16x32_bf16 v[44:47], a[232:235], v[20:23], v[44:47]
  v_mfma_f32_16x16x32_bf16 v[48:51], a[232:235], v[24:27], v[48:51]
  v_mfma_f32_16x16x32_bf16 v[52:55], v[20:23], v[232:235], v[52:55]
  v_mfma_f32_16x16x32_bf16 v[56:59], v[24:27], v[232:235], v[56:59]
  s_waitcnt lgkmcnt(4)
  v_mfma_f32_16x16x32_bf16 v[36:39], a[108:111], v[28:31], v[36:39]
  ds_read_b128 v[20:23], v82 offset:61440
  v_mfma_f32_16x16x32_bf16 v[40:43], a[108:111], v[32:35], v[40:43]
  ds_read_b128 v[24:27], v82 offset:63488
  v_mfma_f32_16x16x32_bf16 v[44:47], a[236:239], v[28:31], v[44:47]
  v_mfma_f32_16x16x32_bf16 v[48:51], a[236:239], v[32:35], v[48:51]
  v_mfma_f32_16x16x32_bf16 v[52:55], v[28:31], v[236:239], v[52:55]
  v_mfma_f32_16x16x32_bf16 v[56:59], v[32:35], v[236:239], v[56:59]
  s_waitcnt lgkmcnt(4)
  v_mfma_f32_16x16x32_bf16 v[36:39], a[112:115], v[4:7], v[36:39]
  ds_read_b128 v[28:31], v83 offset:61440
  v_mfma_f32_16x16x32_bf16 v[40:43], a[112:115], v[8:11], v[40:43]
  ds_read_b128 v[32:35], v83 offset:63488
  v_mfma_f32_16x16x32_bf16 v[44:47], a[240:243], v[4:7], v[44:47]
  v_mfma_f32_16x16x32_bf16 v[48:51], a[240:243], v[8:11], v[48:51]
  v_mfma_f32_16x16x32_bf16 v[52:55], v[4:7], v[240:243], v[52:55]
  v_mfma_f32_16x16x32_bf16 v[56:59], v[8:11], v[240:243], v[56:59]
  s_waitcnt lgkmcnt(4)
  v_mfma_f32_16x16x32_bf16 v[36:39], a[116:119], v[12:15], v[36:39]
  v_mfma_f32_16x16x32_bf16 v[40:43], a[116:119], v[16:19], v[40:43]
  v_mfma_f32_16x16x32_bf16 v[44:47], a[244:247], v[12:15], v[44:47]
  v_mfma_f32_16x16x32_bf16 v[48:51], a[244:247], v[16:19], v[48:51]
  v_mfma_f32_16x16x32_bf16 v[52:55], v[12:15], v[244:247], v[52:55]
  v_mfma_f32_16x16x32_bf16 v[56:59], v[16:19], v[244:247], v[56:59]
  s_waitcnt lgkmcnt(2)
  v_mfma_f32_16x16x32_bf16 v[36:39], a[120:123], v[20:23], v[36:39]
  v_mfma_f32_16x16x32_bf16 v[40:43], a[120:123], v[24:27], v[40:43]
  v_mfma_f32_16x16x32_bf16 v[44:47], a[248:251], v[20:23], v[44:47]
  v_mfma_f32_16x16x32_bf16 v[48:51], a[248:251], v[24:27], v[48:51]
  v_mfma_f32_16x16x32_bf16 v[52:55], v[20:23], v[248:251], v[52:55]
  v_mfma_f32_16x16x32_bf16 v[56:59], v[24:27], v[248:251], v[56:59]
  s_waitcnt lgkmcnt(0)
  v_mfma_f32_16x16x32_bf16 v[36:39], a[124:127], v[28:31], v[36:39]
  v_mfma_f32_16x16x32_bf16 v[40:43], a[124:127], v[32:35], v[40:43]
  v_mfma_f32_16x16x32_bf16 v[44:47], a[252:255], v[28:31], v[44:47]
  v_mfma_f32_16x16x32_bf16 v[48:51], a[252:255], v[32:35], v[48:51]
  v_mfma_f32_16x16x32_bf16 v[52:55], v[28:31], v[252:255], v[52:55]
  v_mfma_f32_16x16x32_bf16 v[56:59], v[32:35], v[252:255], v[56:59]
L_QKV_epi:
  s_nop 2
  v_cvt_pk_bf16_f32 v60, v36, v37
  v_cvt_pk_bf16_f32 v61, v38, v39
  v_cvt_pk_bf16_f32 v62, v44, v45
  v_cvt_pk_bf16_f32 v63, v46, v47
  buffer_store_dwordx4 v[60:63], v76, s[4:7], s31 offen offset:0 sc1
  v_cvt_pk_bf16_f32 v64, v40, v41
  v_cvt_pk_bf16_f32 v65, v42, v43
  v_cvt_pk_bf16_f32 v66, v48, v49
  v_cvt_pk_bf16_f32 v67, v50, v51
  buffer_store_dwordx4 v[64:67], v76, s[4:7], s31 offen offset:1024 sc1
  v_cvt_pk_bf16_f32 v68, v52, v53
  v_cvt_pk_bf16_f32 v69, v54, v55
  v_cvt_pk_bf16_f32 v70, v56, v57
  v_cvt_pk_bf16_f32 v71, v58, v59
  buffer_store_dwordx4 v[68:71], v84, s[4:7], s31 offen sc1
  s_add_u32 s25, s25, 1
  s_add_u32 s31, s31, 786432
  s_branch L_QKV_top
L_WO:
  s_load_dwordx2 s[8:9], s[0:1], 40
  s_mov_b32 s10, 8388608
  s_mov_b32 s11, 0x20000
  s_waitcnt lgkmcnt(0)
  s_lshr_b32 s44, s21, 3
  s_mul_i32 s44, s44, 2097152
  s_and_b32 s45, s21, 7
  s_lshl_b32 s45, s45, 8
  s_add_u32 s44, s44, s45
  s_add_u32 s45, s44, 128
  v_bfe_u32 v40, v0, 5, 1
  v_mul_u32_u24 v40, 8192, v40
  v_bfe_u32 v41, v0, 4, 1
  v_mul_u32_u24 v41, 4096, v41
  v_add_u32 v40, v40, v41
  v_bfe_u32 v41, v0, 3, 1
  v_mul_u32_u24 v41, 2048, v41
  v_add_u32 v40, v40, v41
  v_lshrrev_b32 v41, 3, v0
  v_and_b32 v41, 6, v41
  v_xor_b32 v41, v41, v0
  v_and_b32 v41, 7, v41
  v_lshl_add_u32 v40, v41, 4, v40
  s_lshr_b32 s40, s20, 1
  s_mul_i32 s40, s40, 131072
  s_and_b32 s41, s20, 1
  s_mul_i32 s41, s41, 16384
  s_add_u32 s40, s40, s41
  v_add_u32 v40, s40, v40
  v_bfe_u32 v41, v0, 3, 2
  v_xor_b32 v41, s20, v41
  v_lshlrev_b32 v41, 5, v41
  v_lshrrev_b32 v42, 2, v0
  v_lshl_add_u32 v42, v42, 7, v41
  v_and_b32 v41, 3, v0
  v_lshl_add_u32 v42, v41, 3, v42
  v_add_u32 v43, 0x10000, v42
  v_add_u32 v44, s44, v40
  v_add_u32 v45, s45, v40
  s_lshl_b32 s41, s20, 10
  s_add_u32 m0, s41, 0
  s_mov_b32 s42, 0
  buffer_load_dwordx4 v44, s[8:11], s42 offen lds
  s_add_u32 m0, s41, 4096
  s_mov_b32 s42, 32768
  buffer_load_dwordx4 v44, s[8:11], s42 offen lds
  s_add_u32 m0, s41, 8192
  s_mov_b32 s42, 65536
  buffer_load_dwordx4 v44, s[8:11], s42 offen lds
  s_add_u32 m0, s41, 12288
  s_mov_b32 s42, 98304
  buffer_load_dwordx4 v44, s[8:11], s42 offen lds
  s_add_u32 m0, s41, 16384
  s_mov_b32 s42, 262144
  buffer_load_dwordx4 v44, s[8:11], s42 offen lds
  s_add_u32 m0, s41, 20480
  s_mov_b32 s42, 294912
  buffer_load_dwordx4 v44, s[8:11], s42 offen lds
  s_add_u32 m0, s41, 24576
  s_mov_b32 s42, 327680
  buffer_load_dwordx4 v44, s[8:11], s42 offen lds
  s_add_u32 m0, s41, 28672
  s_mov_b32 s42, 360448
  buffer_load_dwordx4 v44, s[8:11], s42 offen lds
  s_add_u32 m0, s41, 32768
  s_mov_b32 s42, 524288
  buffer_load_dwordx4 v44, s[8:11], s42 offen lds
  s_add_u32 m0, s41, 36864
  s_mov_b32 s42, 557056
  buffer_load_dwordx4 v44, s[8:11], s42 offen lds
  s_add_u32 m0, s41, 40960
  s_mov_b32 s42, 589824
  buffer_load_dwordx4 v44, s[8:11], s42 offen lds
  s_add_u32 m0, s41, 45056
  s_mov_b32 s42, 622592
  buffer_load_dwordx4 v44, s[8:11], s42 offen lds
  s_add_u32 m0, s41, 49152
  s_mov_b32 s42, 786432
  buffer_load_dwordx4 v44, s[8:11], s42 offen lds
  s_add_u32 m0, s41, 53248
  s_mov_b32 s42, 819200
  buffer_load_dwordx4 v44, s[8:11], s42 offen lds
  s_add_u32 m0, s41, 57344
  s_mov_b32 s42, 851968
  buffer_load_dwordx4 v44, s[8:11], s42 offen lds
  s_add_u32 m0, s41, 61440
  s_mov_b32 s42, 884736
  buffer_load_dwordx4 v44, s[8:11], s42 offen lds
  s_add_u32 m0, s41, 65536
  s_mov_b32 s42, 1048576
  buffer_load_dwordx4 v44, s[8:11], s42 offen lds
  s_add_u32 m0, s41, 69632
  s_mov_b32 s42, 1081344
  buffer_load_dwordx4 v44, s[8:11], s42 offen lds
  s_add_u32 m0, s41, 73728
  s_mov_b32 s42, 1114112
  buffer_load_dwordx4 v44, s[8:11], s42 offen lds
  s_add_u32 m0, s41, 77824
  s_mov_b32 s42, 1146880
  buffer_load_dwordx4 v44, s[8:11], s42 offen lds
  s_add_u32 m0, s41, 81920
  s_mov_b32 s42, 1310720
  buffer_load_dwordx4 v44, s[8:11], s42 offen lds
  s_add_u32 m0, s41, 86016
  s_mov_b32 s42, 1343488
  buffer_load_dwordx4 v44, s[8:11], s42 offen lds
  s_add_u32 m0, s41, 90112
  s_mov_b32 s42, 1376256
  buffer_load_dwordx4 v44, s[8:11], s42 offen lds
  s_add_u32 m0, s41, 94208
  s_mov_b32 s42, 1409024
  buffer_load_dwordx4 v44, s[8:11], s42 offen lds
  s_add_u32 m0, s41, 98304
  s_mov_b32 s42, 1572864
  buffer_load_dwordx4 v44, s[8:11], s42 offen lds
  s_add_u32 m0, s41, 102400
  s_mov_b32 s42, 1605632
  buffer_load_dwordx4 v44, s[8:11], s42 offen lds
  s_add_u32 m0, s41, 106496
  s_mov_b32 s42, 1638400
  buffer_load_dwordx4 v44, s[8:11], s42 offen lds
  s_add_u32 m0, s41, 110592
  s_mov_b32 s42, 1671168
  buffer_load_dwordx4 v44, s[8:11], s42 offen lds
  s_waitcnt vmcnt(24) lgkmcnt(0)
  s_barrier
  s_add_u32 m0, s41, 114688
  s_mov_b32 s42, 1835008
  buffer_load_dwordx4 v44, s[8:11], s42 offen lds
  s_add_u32 m0, s41, 118784
  s_mov_b32 s42, 1867776
  buffer_load_dwordx4 v44, s[8:11], s42 offen lds
  s_add_u32 m0, s41, 122880
  s_mov_b32 s42, 1900544
  buffer_load_dwordx4 v44, s[8:11], s42 offen lds
  s_add_u32 m0, s41, 126976
  s_mov_b32 s42, 1933312
  buffer_load_dwordx4 v44, s[8:11], s42 offen lds
  ds_read_b64_tr_b16 a[0:1], v42 offset:0
  ds_read_b64_tr_b16 a[2:3], v42 offset:2048
  ds_read_b64_tr_b16 a[4:5], v42 offset:4096
  ds_read_b64_tr_b16 a[6:7], v42 offset:6144
  ds_read_b64_tr_b16 a[8:9], v42 offset:8192
  ds_read_b64_tr_b16 a[10:11], v42 offset:10240
  ds_read_b64_tr_b16 a[12:13], v42 offset:12288
  ds_read_b64_tr_b16 a[14:15], v42 offset:14336
  s_waitcnt vmcnt(24) lgkmcnt(0)
  s_barrier
  s_add_u32 m0, s41, 0
  s_mov_b32 s42, 0
  buffer_load_dwordx4 v45, s[8:11], s42 offen lds
  s_add_u32 m0, s41, 4096
  s_mov_b32 s42, 32768
  buffer_load_dwordx4 v45, s[8:11], s42 offen lds
  s_add_u32 m0, s41, 8192
  s_mov_b32 s42, 65536
  buffer_load_dwordx4 v45, s[8:11], s42 offen lds
  s_add_u32 m0, s41, 12288
  s_mov_b32 s42, 98304
  buffer_load_dwordx4 v45, s[8:11], s42 offen lds
  ds_read_b64_tr_b16 a[16:17], v42 offset:16384
  ds_read_b64_tr_b16 a[18:19], v42 offset:18432
  ds_read_b64_tr_b16 a[20:21], v42 offset:20480
  ds_read_b64_tr_b16 a[22:23], v42 offset:22528
  ds_read_b64_tr_b16 a[24:25], v42 offset:24576
  ds_read_b64_tr_b16 a[26:27], v42 offset:26624
  ds_read_b64_tr_b16 a[28:29], v42 offset:28672
  ds_read_b64_tr_b16 a[30:31], v42 offset:30720
  s_waitcnt vmcnt(24) lgkmcnt(0)
  s_barrier
  s_add_u32 m0, s41, 16384
  s_mov_b32 s42, 262144
  buffer_load_dwordx4 v45, s[8:11], s42 offen lds
  s_add_u32 m0, s41, 20480
  s_mov_b32 s42, 294912
  buffer_load_dwordx4 v45, s[8:11], s42 offen lds
  s_add_u32 m0, s41, 24576
  s_mov_b32 s42, 327680
  buffer_load_dwordx4 v45, s[8:11], s42 offen lds
  s_add_u32 m0, s41, 28672
  s_mov_b32 s42, 360448
  buffer_load_dwordx4 v45, s[8:11], s42 offen lds
  ds_read_b64_tr_b16 a[32:33], v42 offset:32768
  ds_read_b64_tr_b16 a[34:35], v42 offset:34816
  ds_read_b64_tr_b16 a[36:37], v42 offset:36864
  ds_read_b64_tr_b16 a[38:39], v42 offset:38912
  ds_read_b64_tr_b16 a[40:41], v42 offset:40960
  ds_read_b64_tr_b16 a[42:43], v42 offset:43008
  ds_read_b64_tr_b16 a[44:45], v42 offset:45056
  ds_read_b64_tr_b16 a[46:47], v42 offset:47104
  s_waitcnt vmcnt(24) lgkmcnt(0)
  s_barrier
  s_add_u32 m0, s41, 32768
  s_mov_b32 s42, 524288
  buffer_load_dwordx4 v45, s[8:11], s42 offen lds
  s_add_u32 m0, s41, 36864
  s_mov_b32 s42, 557056
  buffer_load_dwordx4 v45, s[8:11], s42 offen lds
  s_add_u32 m0, s41, 40960
  s_mov_b32 s42, 589824
  buffer_load_dwordx4 v45, s[8:11], s42 offen lds
  s_add_u32 m0, s41, 45056
  s_mov_b32 s42, 622592
  buffer_load_dwordx4 v45, s[8:11], s42 offen lds
  ds_read_b64_tr_b16 a[48:49], v42 offset:49152
  ds_read_b64_tr_b16 a[50:51], v42 offset:51200
  ds_read_b64_tr_b16 a[52:53], v42 offset:53248
  ds_read_b64_tr_b16 a[54:55], v42 offset:55296
  ds_read_b64_tr_b16 a[56:57], v42 offset:57344
  ds_read_b64_tr_b16 a[58:59], v42 offset:59392
  ds_read_b64_tr_b16 a[60:61], v42 offset:61440
  ds_read_b64_tr_b16 a[62:63], v42 offset:63488
  s_waitcnt vmcnt(24) lgkmcnt(0)
  s_barrier
  s_add_u32 m0, s41, 49152
  s_mov_b32 s42, 786432
  buffer_load_dwordx4 v45, s[8:11], s42 offen lds
  s_add_u32 m0, s41, 53248
  s_mov_b32 s42, 819200
  buffer_load_dwordx4 v45, s[8:11], s42 offen lds
  s_add_u32 m0, s41, 57344
  s_mov_b32 s42, 851968
  buffer_load_dwordx4 v45, s[8:11], s42 offen lds
  s_add_u32 m0, s41, 61440
  s_mov_b32 s42, 884736
  buffer_load_dwordx4 v45, s[8:11], s42 offen lds
  ds_read_b64_tr_b16 a[64:65], v43 offset:0
  ds_read_b64_tr_b16 a[66:67], v43 offset:2048
  ds_read_b64_tr_b16 a[68:69], v43 offset:4096
  ds_read_b64_tr_b16 a[70:71], v43 offset:6144
  ds_read_b64_tr_b16 a[72:73], v43 offset:8192
  ds_read_b64_tr_b16 a[74:75], v43 offset:10240
  ds_read_b64_tr_b16 a[76:77], v43 offset:12288
  ds_read_b64_tr_b16 a[78:79], v43 offset:14336
  s_waitcnt vmcnt(24) lgkmcnt(0)
  s_barrier
  s_add_u32 m0, s41, 65536
  s_mov_b32 s42, 1048576
  buffer_load_dwordx4 v45, s[8:11], s42 offen lds
  s_add_u32 m0, s41, 69632
  s_mov_b32 s42, 1081344
  buffer_load_dwordx4 v45, s[8:11], s42 offen lds
  s_add_u32 m0, s41, 73728
  s_mov_b32 s42, 1114112
  buffer_load_dwordx4 v45, s[8:11], s42 offen lds
  s_add_u32 m0, s41, 77824
  s_mov_b32 s42, 1146880
  buffer_load_dwordx4 v45, s[8:11], s42 offen lds
  ds_read_b64_tr_b16 a[80:81], v43 offset:16384
  ds_read_b64_tr_b16 a[82:83], v43 offset:18432
  ds_read_b64_tr_b16 a[84:85], v43 offset:20480
  ds_read_b64_tr_b16 a[86:87], v43 offset:22528
  ds_read_b64_tr_b16 a[88:89], v43 offset:24576
  ds_read_b64_tr_b16 a[90:91], v43 offset:26624
  ds_read_b64_tr_b16 a[92:93], v43 offset:28672
  ds_read_b64_tr_b16 a[94:95], v43 offset:30720
  s_waitcnt vmcnt(24) lgkmcnt(0)
  s_barrier
  s_add_u32 m0, s41, 81920
  s_mov_b32 s42, 1310720
  buffer_load_dwordx4 v45, s[8:11], s42 offen lds
  s_add_u32 m0, s41, 86016
  s_mov_b32 s42, 1343488
  buffer_load_dwordx4 v45, s[8:11], s42 offen lds
  s_add_u32 m0, s41, 90112
  s_mov_b32 s42, 1376256
  buffer_load_dwordx4 v45, s[8:11], s42 offen lds
  s_add_u32 m0, s41, 94208
  s_mov_b32 s42, 1409024
  buffer_load_dwordx4 v45, s[8:11], s42 offen lds
  ds_read_b64_tr_b16 a[96:97], v43 offset:32768
  ds_read_b64_tr_b16 a[98:99], v43 offset:34816
  ds_read_b64_tr_b16 a[100:101], v43 offset:36864
  ds_read_b64_tr_b16 a[102:103], v43 offset:38912
  ds_read_b64_tr_b16 a[104:105], v43 offset:40960
  ds_read_b64_tr_b16 a[106:107], v43 offset:43008
  ds_read_b64_tr_b16 a[108:109], v43 offset:45056
  ds_read_b64_tr_b16 a[110:111], v43 offset:47104
  s_waitcnt vmcnt(24) lgkmcnt(0)
  s_barrier
  s_add_u32 m0, s41, 98304
  s_mov_b32 s42, 1572864
  buffer_load_dwordx4 v45, s[8:11], s42 offen lds
  s_add_u32 m0, s41, 102400
  s_mov_b32 s42, 1605632
  buffer_load_dwordx4 v45, s[8:11], s42 offen lds
  s_add_u32 m0, s41, 106496
  s_mov_b32 s42, 1638400
  buffer_load_dwordx4 v45, s[8:11], s42 offen lds
  s_add_u32 m0, s41, 110592
  s_mov_b32 s42, 1671168
  buffer_load_dwordx4 v45, s[8:11], s42 offen lds
  ds_read_b64_tr_b16 a[112:113], v43 offset:49152
  ds_read_b64_tr_b16 a[114:115], v43 offset:51200
  ds_read_b64_tr_b16 a[116:117], v43 offset:53248
  ds_read_b64_tr_b16 a[118:119], v43 offset:55296
  ds_read_b64_tr_b16 a[120:121], v43 offset:57344
  ds_read_b64_tr_b16 a[122:123], v43 offset:59392
  ds_read_b64_tr_b16 a[124:125], v43 offset:61440
  ds_read_b64_tr_b16 a[126:127], v43 offset:63488
  s_waitcnt vmcnt(24) lgkmcnt(0)
  s_barrier
  s_add_u32 m0, s41, 114688
  s_mov_b32 s42, 1835008
  buffer_load_dwordx4 v45, s[8:11], s42 offen lds
  s_add_u32 m0, s41, 118784
  s_mov_b32 s42, 1867776
  buffer_load_dwordx4 v45, s[8:11], s42 offen lds
  s_add_u32 m0, s41, 122880
  s_mov_b32 s42, 1900544
  buffer_load_dwordx4 v45, s[8:11], s42 offen lds
  s_add_u32 m0, s41, 126976
  s_mov_b32 s42, 1933312
  buffer_load_dwordx4 v45, s[8:11], s42 offen lds
  ds_read_b64_tr_b16 a[128:129], v42 offset:0
  ds_read_b64_tr_b16 a[130:131], v42 offset:2048
  ds_read_b64_tr_b16 a[132:133], v42 offset:4096
  ds_read_b64_tr_b16 a[134:135], v42 offset:6144
  ds_read_b64_tr_b16 a[136:137], v42 offset:8192
  ds_read_b64_tr_b16 a[138:139], v42 offset:10240
  ds_read_b64_tr_b16 a[140:141], v42 offset:12288
  ds_read_b64_tr_b16 a[142:143], v42 offset:14336
  s_waitcnt vmcnt(24) lgkmcnt(0)
  s_barrier
  ds_read_b64_tr_b16 a[144:145], v42 offset:16384
  ds_read_b64_tr_b16 a[146:147], v42 offset:18432
  ds_read_b64_tr_b16 a[148:149], v42 offset:20480
  ds_read_b64_tr_b16 a[150:151], v42 offset:22528
  ds_read_b64_tr_b16 a[152:153], v42 offset:24576
  ds_read_b64_tr_b16 a[154:155], v42 offset:26624
  ds_read_b64_tr_b16 a[156:157], v42 offset:28672
  ds_read_b64_tr_b16 a[158:159], v42 offset:30720
  s_waitcnt vmcnt(20) lgkmcnt(0)
  s_barrier
  ds_read_b64_tr_b16 a[160:161], v42 offset:32768
  ds_read_b64_tr_b16 a[162:163], v42 offset:34816
  ds_read_b64_tr_b16 a[164:165], v42 offset:36864
  ds_read_b64_tr_b16 a[166:167], v42 offset:38912
  ds_read_b64_tr_b16 a[168:169], v42 offset:40960
  ds_read_b64_tr_b16 a[170:171], v42 offset:43008
  ds_read_b64_tr_b16 a[172:173], v42 offset:45056
  ds_read_b64_tr_b16 a[174:175], v42 offset:47104
  s_waitcnt vmcnt(16) lgkmcnt(0)
  s_barrier
  ds_read_b64_tr_b16 a[176:177], v42 offset:49152
  ds_read_b64_tr_b16 a[178:179], v42 offset:51200
  ds_read_b64_tr_b16 a[180:181], v42 offset:53248
  ds_read_b64_tr_b16 a[182:183], v42 offset:55296
  ds_read_b64_tr_b16 a[184:185], v42 offset:57344
  ds_read_b64_tr_b16 a[186:187], v42 offset:59392
  ds_read_b64_tr_b16 a[188:189], v42 offset:61440
  ds_read_b64_tr_b16 a[190:191], v42 offset:63488
  s_waitcnt vmcnt(12) lgkmcnt(0)
  s_barrier
  ds_read_b64_tr_b16 a[192:193], v43 offset:0
  ds_read_b64_tr_b16 a[194:195], v43 offset:2048
  ds_read_b64_tr_b16 a[196:197], v43 offset:4096
  ds_read_b64_tr_b16 a[198:199], v43 offset:6144
  ds_read_b64_tr_b16 a[200:201], v43 offset:8192
  ds_read_b64_tr_b16 a[202:203], v43 offset:10240
  ds_read_b64_tr_b16 a[204:205], v43 offset:12288
  ds_read_b64_tr_b16 a[206:207], v43 offset:14336
  s_waitcnt vmcnt(8) lgkmcnt(0)
  s_barrier
  ds_read_b64_tr_b16 a[208:209], v43 offset:16384
  ds_read_b64_tr_b16 a[210:211], v43 offset:18432
  ds_read_b64_tr_b16 a[212:213], v43 offset:20480
  ds_read_b64_tr_b16 a[214:215], v43 offset:22528
  ds_read_b64_tr_b16 a[216:217], v43 offset:24576
  ds_read_b64_tr_b16 a[218:219], v43 offset:26624
  ds_read_b64_tr_b16 a[220:221], v43 offset:28672
  ds_read_b64_tr_b16 a[222:223], v43 offset:30720
  s_waitcnt vmcnt(4) lgkmcnt(0)
  s_barrier
  ds_read_b64_tr_b16 a[224:225], v43 offset:32768
  ds_read_b64_tr_b16 a[226:227], v43 offset:34816
  ds_read_b64_tr_b16 a[228:229], v43 offset:36864
  ds_read_b64_tr_b16 a[230:231], v43 offset:38912
  ds_read_b64_tr_b16 a[232:233], v43 offset:40960
  ds_read_b64_tr_b16 a[234:235], v43 offset:43008
  ds_read_b64_tr_b16 a[236:237], v43 offset:45056
  ds_read_b64_tr_b16 a[238:239], v43 offset:47104
  s_waitcnt vmcnt(0) lgkmcnt(0)
  s_barrier
  ds_read_b64_tr_b16 a[240:241], v43 offset:49152
  ds_read_b64_tr_b16 a[242:243], v43 offset:51200
  ds_read_b64_tr_b16 a[244:245], v43 offset:53248
  ds_read_b64_tr_b16 a[246:247], v43 offset:55296
  ds_read_b64_tr_b16 a[248:249], v43 offset:57344
  ds_read_b64_tr_b16 a[250:251], v43 offset:59392
  ds_read_b64_tr_b16 a[252:253], v43 offset:61440
  ds_read_b64_tr_b16 a[254:255], v43 offset:63488
  s_waitcnt lgkmcnt(0)
  s_barrier
  s_and_b32 s43, s21, 24
  v_min_u32 v2, 7, v0
  v_add_u32 v2, s43, v2
  v_lshlrev_b32 v2, 7, v2
  v_add_u32 v2, 1421312, v2
  s_lshl_b32 s40, s21, 7
  s_add_u32 s40, s40, 1425408
  v_mov_b32 v69, 2147483392
  s_mov_b64 exec, 1
  v_mov_b32 v69, s40
  s_mov_b64 exec, -1
  s_lshl_b32 s40, s43, 13
  s_add_u32 s27, s40, 27262976
  s_lshr_b32 s40, s21, 3
  s_lshl_b32 s40, s40, 17
  s_add_u32 s31, s40, 109051904
  s_and_b32 s40, s21, 7
  s_lshl_b32 s40, s40, 9
  s_lshl_b32 s41, s20, 6
  s_add_u32 s40, s40, s41
  v_and_b32 v52, 15, v0
  v_lshl_add_u32 v68, v52, 12, s40
  v_lshrrev_b32 v52, 4, v0
  v_lshl_add_u32 v68, v52, 4, v68
  v_add_u32 v76, 0x10000, v68
  v_lshlrev_b32 v1, 4, v0
  s_lshl_b32 s32, s20, 12
  s_mul_i32 s33, s20, 3072
  v_mov_b32 v70, v1
  v_add_u32 v71, 0x10000, v70
  s_lshl_b32 s40, s20, 2
  s_add_u32 s40, s40, 131072
  v_mov_b32 v72, s40
  v_mov_b32 v52, 0
  ds_write_b32 v72, v52
  s_mov_b32 s25, 0
  s_mov_b32 s26, 0
  s_mov_b32 s29, 1
  s_mov_b32 s30, 0
  s_waitcnt lgkmcnt(0)
  s_barrier
  s_branch L_WO_poll
L_WO_top:
  s_cmp_lg_u32 s28, 0
  s_cbranch_scc1 L_WO_go
  v_mov_b32 v52, s25
  v_and_b32 v53, 3, v0
  v_lshlrev_b32 v53, 2, v53
  v_add_u32 v53, 131072, v53
  s_waitcnt vmcnt(0)
  ds_write_b32 v72, v52
  ds_read_b32 v53, v53
  s_waitcnt lgkmcnt(0)
  v_cmp_gt_i32 vcc, s25, v53
  s_cbranch_vccnz L_WO_nosig
  buffer_store_dword v52, v69, s[4:7], 0 offen sc1
L_WO_nosig:
  s_cmp_ge_u32 s25, 64
  s_cbranch_scc1 L_END
L_WO_poll:
  s_nop 0
Lpoll_25:
  buffer_load_dword v3, v2, s[4:7], s30 offen sc1
  s_sub_u32 s24, s24, 1
  s_cbranch_scc1 L_FAIL
  s_waitcnt vmcnt(0)
  v_cmp_gt_i32 vcc, s29, v3
  s_cbranch_vccz Lpolld_26
  s_sleep 2
  s_branch Lpoll_25
Lpolld_26:
  s_mov_b32 s34, s26
  s_mov_b32 s35, s27
  s_add_u32 s36, s32, 0
  s_add_u32 m0, s34, s36
  s_add_u32 s36, s35, s36
  buffer_load_dwordx4 v1, s[4:7], s36 offen offset:0 sc1 lds
  buffer_load_dwordx4 v1, s[4:7], s36 offen offset:1024 sc1 lds
  buffer_load_dwordx4 v1, s[4:7], s36 offen offset:2048 sc1 lds
  buffer_load_dwordx4 v1, s[4:7], s36 offen offset:3072 sc1 lds
  s_add_u32 s36, s32, 16384
  s_add_u32 m0, s34, s36
  s_add_u32 s36, s35, s36
  buffer_load_dwordx4 v1, s[4:7], s36 offen offset:0 sc1 lds
  buffer_load_dwordx4 v1, s[4:7], s36 offen offset:1024 sc1 lds
  buffer_load_dwordx4 v1, s[4:7], s36 offen offset:2048 sc1 lds
  buffer_load_dwordx4 v1, s[4:7], s36 offen offset:3072 sc1 lds
  s_add_u32 s36, s32, 32768
  s_add_u32 m0, s34, s36
  s_add_u32 s36, s35, s36
  buffer_load_dwordx4 v1, s[4:7], s36 offen offset:0 sc1 lds
  buffer_load_dwordx4 v1, s[4:7], s36 offen offset:1024 sc1 lds
  buffer_load_dwordx4 v1, s[4:7], s36 offen offset:2048 sc1 lds
  buffer_load_dwordx4 v1, s[4:7], s36 offen offset:3072 sc1 lds
  s_add_u32 s36, s32, 49152
  s_add_u32 m0, s34, s36
  s_add_u32 s36, s35, s36
  buffer_load_dwordx4 v1, s[4:7], s36 offen offset:0 sc1 lds
  buffer_load_dwordx4 v1, s[4:7], s36 offen offset:1024 sc1 lds
  buffer_load_dwordx4 v1, s[4:7], s36 offen offset:2048 sc1 lds
  buffer_load_dwordx4 v1, s[4:7], s36 offen offset:3072 sc1 lds
L_WO_go:
  v_add_u32 v74, s26, v70
  v_add_u32 v75, s26, v71
  s_sub_u32 s26, 65536, s26
  s_add_u32 s27, s27, 262144
  s_mov_b32 s34, s26
  s_mov_b32 s35, s27
  s_add_u32 s29, s29, 1
  s_waitcnt vmcnt(12) lgkmcnt(0)
  s_barrier
  ds_read_b128 v[4:7], v74 offset:0
  ds_read_b128 v[8:11], v74 offset:1024
  ds_read_b128 v[12:15], v74 offset:2048
  ds_read_b128 v[16:19], v74 offset:3072
  ds_read_b128 v[20:23], v74 offset:4096
  ds_read_b128 v[24:27], v74 offset:5120
  buffer_load_dword v3, v2, s[4:7], s30 offen sc1
  s_waitcnt lgkmcnt(4)
  v_mfma_f32_16x16x32_bf16 v[36:39], a[0:3], v[4:7], 0
  ds_read_b128 v[28:31], v74 offset:6144
  v_mfma_f32_16x16x32_bf16 v[40:43], a[0:3], v[8:11], 0
  ds_read_b128 v[32:35], v74 offset:7168
  v_mfma_f32_16x16x32_bf16 v[44:47], a[128:131], v[4:7], 0
  v_mfma_f32_16x16x32_bf16 v[48:51], a[128:131], v[8:11], 0
  s_waitcnt lgkmcnt(4)
  v_mfma_f32_16x16x32_bf16 v[36:39], a[4:7], v[12:15], v[36:39]
  ds_read_b128 v[4:7], v74 offset:8192
  v_mfma_f32_16x16x32_bf16 v[40:43], a[4:7], v[16:19], v[40:43]
  ds_read_b128 v[8:11], v74 offset:9216
  v_mfma_f32_16x16x32_bf16 v[44:47], a[132:135], v[12:15], v[44:47]
  v_mfma_f32_16x16x32_bf16 v[48:51], a[132:135], v[16:19], v[48:51]
  s_waitcnt lgkmcnt(4)
  v_mfma_f32_16x16x32_bf16 v[36:39], a[8:11], v[20:23], v[36:39]
  ds_read_b128 v[12:15], v74 offset:10240
  v_mfma_f32_16x16x32_bf16 v[40:43], a[8:11], v[24:27], v[40:43]
  ds_read_b128 v[16:19], v74 offset:11264
  v_mfma_f32_16x16x32_bf16 v[44:47], a[136:139], v[20:23], v[44:47]
  v_mfma_f32_16x16x32_bf16 v[48:51], a[136:139], v[24:27], v[48:51]
  s_waitcnt lgkmcnt(4)
  v_mfma_f32_16x16x32_bf16 v[36:39], a[12:15], v[28:31], v[36:39]
  ds_read_b128 v[20:23], v74 offset:12288
  v_mfma_f32_16x16x32_bf16 v[40:43], a[12:15], v[32:35], v[40:43]
  ds_read_b128 v[24:27], v74 offset:13312
  v_mfma_f32_16x16x32_bf16 v[44:47], a[140:143], v[28:31], v[44:47]
  v_mfma_f32_16x16x32_bf16 v[48:51], a[140:143], v[32:35], v[48:51]
  s_waitcnt lgkmcnt(4)
  v_mfma_f32_16x16x32_bf16 v[36:39], a[16:19], v[4:7], v[36:39]
  ds_read_b128 v[28:31], v74 offset:14336
  v_mfma_f32_16x16x32_bf16 v[40:43], a[16:19], v[8:11], v[40:43]
  ds_read_b128 v[32:35], v74 offset:15360
  v_mfma_f32_16x16x32_bf16 v[44:47], a[144:147], v[4:7], v[44:47]
  v_mfma_f32_16x16x32_bf16 v[48:51], a[144:147], v[8:11], v[48:51]
  s_waitcnt vmcnt(9)
  s_barrier
  s_waitcnt lgkmcnt(4)
  v_mfma_f32_16x16x32_bf16 v[36:39], a[20:23], v[12:15], v[36:39]
  ds_read_b128 v[4:7], v74 offset:16384
  v_mfma_f32_16x16x32_bf16 v[40:43], a[20:23], v[16:19], v[40:43]
  ds_read_b128 v[8:11], v74 offset:17408
  v_mfma_f32_16x16x32_bf16 v[44:47], a[148:151], v[12:15], v[44:47]
  v_mfma_f32_16x16x32_bf16 v[48:51], a[148:151], v[16:19], v[48:51]
  s_waitcnt lgkmcnt(4)
  v_mfma_f32_16x16x32_bf16 v[36:39], a[24:27], v[20:23], v[36:39]
  ds_read_b128 v[12:15], v74 offset:18432
  v_mfma_f32_16x16x32_bf16 v[40:43], a[24:27], v[24:27], v[40:43]
  ds_read_b128 v[16:19], v74 offset:19456
  v_mfma_f32_16x16x32_bf16 v[44:47], a[152:155], v[20:23], v[44:47]
  v_mfma_f32_16x16x32_bf16 v[48:51], a[152:155], v[24:27], v[48:51]
  s_waitcnt lgkmcnt(4)
  v_mfma_f32_16x16x32_bf16 v[36:39], a[28:31], v[28:31], v[36:39]
  ds_read_b128 v[20:23], v74 offset:20480
  v_mfma_f32_16x16x32_bf16 v[40:43], a[28:31], v[32:35], v[40:43]
  ds_read_b128 v[24:27], v74 offset:21504
  v_mfma_f32_16x16x32_bf16 v[44:47], a[156:159], v[28:31], v[44:47]
  v_mfma_f32_16x16x32_bf16 v[48:51], a[156:159], v[32:35], v[48:51]
  s_waitcnt lgkmcnt(4)
  v_mfma_f32_16x16x32_bf16 v[36:39], a[32:35], v[4:7], v[36:39]
  ds_read_b128 v[28:31], v74 offset:22528
  v_mfma_f32_16x16x32_bf16 v[40:43], a[32:35], v[8:11], v[40:43]
  ds_read_b128 v[32:35], v74 offset:23552
  v_mfma_f32_16x16x32_bf16 v[44:47], a[160:163], v[4:7], v[44:47]
  v_mfma_f32_16x16x32_bf16 v[48:51], a[160:163], v[8:11], v[48:51]
  s_waitcnt lgkmcnt(4)
  v_mfma_f32_16x16x32_bf16 v[36:39], a[36:39], v[12:15], v[36:39]
  ds_read_b128 v[4:7], v74 offset:24576
  v_mfma_f32_16x16x32_bf16 v[40:43], a[36:39], v[16:19], v[40:43]
  ds_read_b128 v[8:11], v74 offset:25600
  v_mfma_f32_16x16x32_bf16 v[44:47], a[164:167], v[12:15], v[44:47]
  v_mfma_f32_16x16x32_bf16 v[48:51], a[164:167], v[16:19], v[48:51]
  s_waitcnt lgkmcnt(4)
  v_mfma_f32_16x16x32_bf16 v[36:39], a[40:43], v[20:23], v[36:39]
  ds_read_b128 v[12:15], v74 offset:26624
  v_mfma_f32_16x16x32_bf16 v[40:43], a[40:43], v[24:27], v[40:43]
  ds_read_b128 v[16:19], v74 offset:27648
  v_mfma_f32_16x16x32_bf16 v[44:47], a[168:171], v[20:23], v[44:47]
  v_mfma_f32_16x16x32_bf16 v[48:51], a[168:171], v[24:27], v[48:51]
  s_waitcnt lgkmcnt(4)
  v_mfma_f32_16x16x32_bf16 v[36:39], a[44:47], v[28:31], v[36:39]
  ds_read_b128 v[20:23], v74 offset:28672
  v_mfma_f32_16x16x32_bf16 v[40:43], a[44:47], v[32:35], v[40:43]
  ds_read_b128 v[24:27], v74 offset:29696
  v_mfma_f32_16x16x32_bf16 v[44:47], a[172:175], v[28:31], v[44:47]
  v_mfma_f32_16x16x32_bf16 v[48:51], a[172:175], v[32:35], v[48:51]
  s_waitcnt lgkmcnt(4)
  v_mfma_f32_16x16x32_bf16 v[36:39], a[48:51], v[4:7], v[36:39]
  ds_read_b128 v[28:31], v74 offset:30720
  v_mfma_f32_16x16x32_bf16 v[40:43], a[48:51], v[8:11], v[40:43]
  ds_read_b128 v[32:35], v74 offset:31744
  v_mfma_f32_16x16x32_bf16 v[44:47], a[176:179], v[4:7], v[44:47]
  v_mfma_f32_16x16x32_bf16 v[48:51], a[176:179], v[8:11], v[48:51]
  s_waitcnt vmcnt(0)
  s_barrier
  v_mov_b32 v52, s25
  v_cmp_gt_i32 vcc, s29, v3
  s_cmp_lg_u32 s20, 0
  s_cbranch_scc1 L_WO_s2
  buffer_store_dword v52, v69, s[4:7], 0 offen sc1
L_WO_s2:
  s_mov_b32 s28, 0
  s_cbranch_vccnz L_WO_nopf
  s_cmp_ge_u32 s25, 63
  s_cbranch_scc1 L_WO_nopf
  s_mov_b32 s28, 1
  s_waitcnt lgkmcnt(4)
  v_mfma_f32_16x16x32_bf16 v[36:39], a[52:55], v[12:15], v[36:39]
  ds_read_b128 v[4:7], v74 offset:32768
  v_mfma_f32_16x16x32_bf16 v[40:43], a[52:55], v[16:19], v[40:43]
  ds_read_b128 v[8:11], v74 offset:33792
  v_mfma_f32_16x16x32_bf16 v[44:47], a[180:183], v[12:15], v[44:47]
  s_add_u32 s36, s32, 0
  s_add_u32 m0, s34, s36
  s_add_u32 s36, s35, s36
  buffer_load_dwordx4 v1, s[4:7], s36 offen offset:0 sc1 lds
  v_mfma_f32_16x16x32_bf16 v[48:51], a[180:183], v[16:19], v[48:51]
  s_waitcnt lgkmcnt(4)
  v_mfma_f32_16x16x32_bf16 v[36:39], a[56:59], v[20:23], v[36:39]
  ds_read_b128 v[12:15], v74 offset:34816
  v_mfma_f32_16x16x32_bf16 v[40:43], a[56:59], v[24:27], v[40:43]
  ds_read_b128 v[16:19], v74 offset:35840
  v_mfma_f32_16x16x32_bf16 v[44:47], a[184:187], v[20:23], v[44:47]
  buffer_load_dwordx4 v1, s[4:7], s36 offen offset:1024 sc1 lds
  v_mfma_f32_16x16x32_bf16 v[48:51], a[184:187], v[24:27], v[48:51]
  s_waitcnt lgkmcnt(4)
  v_mfma_f32_16x16x32_bf16 v[36:39], a[60:63], v[28:31], v[36:39]
  ds_read_b128 v[20:23], v74 offset:36864
  v_mfma_f32_16x16x32_bf16 v[40:43], a[60:63], v[32:35], v[40:43]
  ds_read_b128 v[24:27], v74 offset:37888
  v_mfma_f32_16x16x32_bf16 v[44:47], a[188:191], v[28:31], v[44:47]
  buffer_load_dwordx4 v1, s[4:7], s36 offen offset:2048 sc1 lds
  v_mfma_f32_16x16x32_bf16 v[48:51], a[188:191], v[32:35], v[48:51]
  s_waitcnt lgkmcnt(4)
  v_mfma_f32_16x16x32_bf16 v[36:39], a[64:67], v[4:7], v[36:39]
  ds_read_b128 v[28:31], v74 offset:38912
  v_mfma_f32_16x16x32_bf16 v[40:43], a[64:67], v[8:11], v[40:43]
  ds_read_b128 v[32:35], v74 offset:39936
  v_mfma_f32_16x16x32_bf16 v[44:47], a[192:195], v[4:7], v[44:47]
  buffer_load_dwordx4 v1, s[4:7], s36 offen offset:3072 sc1 lds
  v_mfma_f32_16x16x32_bf16 v[48:51], a[192:195], v[8:11], v[48:51]
  s_waitcnt lgkmcnt(4)
  v_mfma_f32_16x16x32_bf16 v[36:39], a[68:71], v[12:15], v[36:39]
  ds_read_b128 v[4:7], v74 offset:40960
  v_mfma_f32_16x16x32_bf16 v[40:43], a[68:71], v[16:19], v[40:43]
  ds_read_b128 v[8:11], v74 offset:41984
  v_mfma_f32_16x16x32_bf16 v[44:47], a[196:199], v[12:15], v[44:47]
  s_add_u32 s36, s32, 16384
  s_add_u32 m0, s34, s36
  s_add_u32 s36, s35, s36
  buffer_load_dwordx4 v1, s[4:7], s36 offen offset:0 sc1 lds
  v_mfma_f32_16x16x32_bf16 v[48:51], a[196:199], v[16:19], v[48:51]
  s_waitcnt lgkmcnt(4)
  v_mfma_f32_16x16x32_bf16 v[36:39], a[72:75], v[20:23], v[36:39]
  ds_read_b128 v[12:15], v74 offset:43008
  v_mfma_f32_16x16x32_bf16 v[40:43], a[72:75], v[24:27], v[40:43]
  ds_read_b128 v[16:19], v74 offset:44032
  v_mfma_f32_16x16x32_bf16 v[44:47], a[200:203], v[20:23], v[44:47]
  buffer_load_dwordx4 v1, s[4:7], s36 offen offset:1024 sc1 lds
  v_mfma_f32_16x16x32_bf16 v[48:51], a[200:203], v[24:27], v[48:51]
  s_waitcnt lgkmcnt(4)
  v_mfma_f32_16x16x32_bf16 v[36:39], a[76:79], v[28:31], v[36:39]
  ds_read_b128 v[20:23], v74 offset:45056
  v_mfma_f32_16x16x32_bf16 v[40:43], a[76:79], v[32:35], v[40:43]
  ds_read_b128 v[24:27], v74 offset:46080
  v_mfma_f32_16x16x32_bf16 v[44:47], a[204:207], v[28:31], v[44:47]
  buffer_load_dwordx4 v1, s[4:7], s36 offen offset:2048 sc1 lds
  v_mfma_f32_16x16x32_bf16 v[48:51], a[204:207], v[32:35], v[48:51]
  s_waitcnt lgkmcnt(4)
  v_mfma_f32_16x16x32_bf16 v[36:39], a[80:83], v[4:7], v[36:39]
  ds_read_b128 v[28:31], v74 offset:47104
  v_mfma_f32_16x16x32_bf16 v[40:43], a[80:83], v[8:11], v[40:43]
  ds_read_b128 v[32:35], v74 offset:48128
  v_mfma_f32_16x16x32_bf16 v[44:47], a[208:211], v[4:7], v[44:47]
  buffer_load_dwordx4 v1, s[4:7], s36 offen offset:3072 sc1 lds
  v_mfma_f32_16x16x32_bf16 v[48:51], a[208:211], v[8:11], v[48:51]
  s_waitcnt lgkmcnt(4)
  v_mfma_f32_16x16x32_bf16 v[36:39], a[84:87], v[12:15], v[36:39]
  ds_read_b128 v[4:7], v74 offset:49152
  v_mfma_f32_16x16x32_bf16 v[40:43], a[84:87], v[16:19], v[40:43]
  ds_read_b128 v[8:11], v74 offset:50176
  v_mfma_f32_16x16x32_bf16 v[44:47], a[212:215], v[12:15], v[44:47]
  s_add_u32 s36, s32, 32768
  s_add_u32 m0, s34, s36
  s_add_u32 s36, s35, s36
  buffer_load_dwordx4 v1, s[4:7], s36 offen offset:0 sc1 lds
  v_mfma_f32_16x16x32_bf16 v[48:51], a[212:215], v[16:19], v[48:51]
  s_waitcnt lgkmcnt(4)
  v_mfma_f32_16x16x32_bf16 v[36:39], a[88:91], v[20:23], v[36:39]
  ds_read_b128 v[12:15], v74 offset:51200
  v_mfma_f32_16x16x32_bf16 v[40:43], a[88:91], v[24:27], v[40:43]
  ds_read_b128 v[16:19], v74 offset:52224
  v_mfma_f32_16x16x32_bf16 v[44:47], a[216:219], v[20:23], v[44:47]
  buffer_load_dwordx4 v1, s[4:7], s36 offen offset:1024 sc1 lds
  v_mfma_f32_16x16x32_bf16 v[48:51], a[216:219], v[24:27], v[48:51]
  s_waitcnt lgkmcnt(4)
  v_mfma_f32_16x16x32_bf16 v[36:39], a[92:95], v[28:31], v[36:39]
  ds_read_b128 v[20:23], v74 offset:53248
  v_mfma_f32_16x16x32_bf16 v[40:43], a[92:95], v[32:35], v[40:43]
  ds_read_b128 v[24:27], v74 offset:54272
  v_mfma_f32_16x16x32_bf16 v[44:47], a[220:223], v[28:31], v[44:47]
  buffer_load_dwordx4 v1, s[4:7], s36 offen offset:2048 sc1 lds
  v_mfma_f32_16x16x32_bf16 v[48:51], a[220:223], v[32:35], v[48:51]
  s_waitcnt lgkmcnt(4)
  v_mfma_f32_16x16x32_bf16 v[36:39], a[96:99], v[4:7], v[36:39]
  ds_read_b128 v[28:31], v74 offset:55296
  v_mfma_f32_16x16x32_bf16 v[40:43], a[96:99], v[8:11], v[40:43]
  ds_read_b128 v[32:35], v74 offset:56320
  v_mfma_f32_16x16x32_bf16 v[44:47], a[224:227], v[4:7], v[44:47]
  buffer_load_dwordx4 v1, s[4:7], s36 offen offset:3072 sc1 lds
  v_mfma_f32_16x16x32_bf16 v[48:51], a[224:227], v[8:11], v[48:51]
  s_waitcnt lgkmcnt(4)
  v_mfma_f32_16x16x32_bf16 v[36:39], a[100:103], v[12:15], v[36:39]
  ds_read_b128 v[4:7], v74 offset:57344
  v_mfma_f32_16x16x32_bf16 v[40:43], a[100:103], v[16:19], v[40:43]
  ds_read_b128 v[8:11], v74 offset:58368
  v_mfma_f32_16x16x32_bf16 v[44:47], a[228:231], v[12:15], v[44:47]
  s_add_u32 s36, s32, 49152
  s_add_u32 m0, s34, s36
  s_add_u32 s36, s35, s36
  buffer_load_dwordx4 v1, s[4:7], s36 offen offset:0 sc1 lds
  v_mfma_f32_16x16x32_bf16 v[48:51], a[228:231], v[16:19], v[48:51]
  s_waitcnt lgkmcnt(4)
  v_mfma_f32_16x16x32_bf16 v[36:39], a[104:107], v[20:23], v[36:39]
  ds_read_b128 v[12:15], v74 offset:59392
  v_mfma_f32_16x16x32_bf16 v[40:43], a[104:107], v[24:27], v[40:43]
  ds_read_b128 v[16:19], v74 offset:60416
  v_mfma_f32_16x16x32_bf16 v[44:47], a[232:235], v[20:23], v[44:47]
  buffer_load_dwordx4 v1, s[4:7], s36 offen offset:1024 sc1 lds
  v_mfma_f32_16x16x32_bf16 v[48:51], a[232:235], v[24:27], v[48:51]
  s_waitcnt lgkmcnt(4)
  v_mfma_f32_16x16x32_bf16 v[36:39], a[108:111], v[28:31], v[36:39]
  ds_read_b128 v[20:23], v74 offset:61440
  v_mfma_f32_16x16x32_bf16 v[40:43], a[108:111], v[32:35], v[40:43]
  ds_read_b128 v[24:27], v74 offset:62464
  v_mfma_f32_16x16x32_bf16 v[44:47], a[236:239], v[28:31], v[44:47]
  buffer_load_dwordx4 v1, s[4:7], s36 offen offset:2048 sc1 lds
  v_mfma_f32_16x16x32_bf16 v[48:51], a[236:239], v[32:35], v[48:51]
  s_waitcnt lgkmcnt(4)
  v_mfma_f32_16x16x32_bf16 v[36:39], a[112:115], v[4:7], v[36:39]
  ds_read_b128 v[28:31], v74 offset:63488
  v_mfma_f32_16x16x32_bf16 v[40:43], a[112:115], v[8:11], v[40:43]
  ds_read_b128 v[32:35], v74 offset:64512
  v_mfma_f32_16x16x32_bf16 v[44:47], a[240:243], v[4:7], v[44:47]
  buffer_load_dwordx4 v1, s[4:7], s36 offen offset:3072 sc1 lds
  v_mfma_f32_16x16x32_bf16 v[48:51], a[240:243], v[8:11], v[48:51]
  s_waitcnt lgkmcnt(4)
  v_mfma_f32_16x16x32_bf16 v[36:39], a[116:119], v[12:15], v[36:39]
  v_mfma_f32_16x16x32_bf16 v[40:43], a[116:119], v[16:19], v[40:43]
  v_mfma_f32_16x16x32_bf16 v[44:47], a[244:247], v[12:15], v[44:47]
  v_mfma_f32_16x16x32_bf16 v[48:51], a[244:247], v[16:19], v[48:51]
  s_waitcnt lgkmcnt(2)
  v_mfma_f32_16x16x32_bf16 v[36:39], a[120:123], v[20:23], v[36:39]
  v_mfma_f32_16x16x32_bf16 v[40:43], a[120:123], v[24:27], v[40:43]
  v_mfma_f32_16x16x32_bf16 v[44:47], a[248:251], v[20:23], v[44:47]
  v_mfma_f32_16x16x32_bf16 v[48:51], a[248:251], v[24:27], v[48:51]
  s_waitcnt lgkmcnt(0)
  v_mfma_f32_16x16x32_bf16 v[36:39], a[124:127], v[28:31], v[36:39]
  v_mfma_f32_16x16x32_bf16 v[40:43], a[124:127], v[32:35], v[40:43]
  v_mfma_f32_16x16x32_bf16 v[44:47], a[252:255], v[28:31], v[44:47]
  v_mfma_f32_16x16x32_bf16 v[48:51], a[252:255], v[32:35], v[48:51]
  s_nop 7
  s_branch L_WO_epi
L_WO_nopf:
  s_waitcnt lgkmcnt(4)
  v_mfma_f32_16x16x32_bf16 v[36:39], a[52:55], v[12:15], v[36:39]
  ds_read_b128 v[4:7], v74 offset:32768
  v_mfma_f32_16x16x32_bf16 v[40:43], a[52:55], v[16:19], v[40:43]
  ds_read_b128 v[8:11], v74 offset:33792
  v_mfma_f32_16x16x32_bf16 v[44:47], a[180:183], v[12:15], v[44:47]
  v_mfma_f32_16x16x32_bf16 v[48:51], a[180:183], v[16:19], v[48:51]
  s_waitcnt lgkmcnt(4)
  v_mfma_f32_16x16x32_bf16 v[36:39], a[56:59], v[20:23], v[36:39]
  ds_read_b128 v[12:15], v74 offset:34816
  v_mfma_f32_16x16x32_bf16 v[40:43], a[56:59], v[24:27], v[40:43]
  ds_read_b128 v[16:19], v74 offset:35840
  v_mfma_f32_16x16x32_bf16 v[44:47], a[184:187], v[20:23], v[44:47]
  v_mfma_f32_16x16x32_bf16 v[48:51], a[184:187], v[24:27], v[48:51]
  s_waitcnt lgkmcnt(4)
  v_mfma_f32_16x16x32_bf16 v[36:39], a[60:63], v[28:31], v[36:39]
  ds_read_b128 v[20:23], v74 offset:36864
  v_mfma_f32_16x16x32_bf16 v[40:43], a[60:63], v[32:35], v[40:43]
  ds_read_b128 v[24:27], v74 offset:37888
  v_mfma_f32_16x16x32_bf16 v[44:47], a[188:191], v[28:31], v[44:47]
  v_mfma_f32_16x16x32_bf16 v[48:51], a[188:191], v[32:35], v[48:51]
  s_waitcnt lgkmcnt(4)
  v_mfma_f32_16x16x32_bf16 v[36:39], a[64:67], v[4:7], v[36:39]
  ds_read_b128 v[28:31], v74 offset:38912
  v_mfma_f32_16x16x32_bf16 v[40:43], a[64:67], v[8:11], v[40:43]
  ds_read_b128 v[32:35], v74 offset:39936
  v_mfma_f32_16x16x32_bf16 v[44:47], a[192:195], v[4:7], v[44:47]
  v_mfma_f32_16x16x32_bf16 v[48:51], a[192:195], v[8:11], v[48:51]
  s_waitcnt lgkmcnt(4)
  v_mfma_f32_16x16x32_bf16 v[36:39], a[68:71], v[12:15], v[36:39]
  ds_read_b128 v[4:7], v74 offset:40960
  v_mfma_f32_16x16x32_bf16 v[40:43], a[68:71], v[16:19], v[40:43]
  ds_read_b128 v[8:11], v74 offset:41984
  v_mfma_f32_16x16x32_bf16 v[44:47], a[196:199], v[12:15], v[44:47]
  v_mfma_f32_16x16x32_bf16 v[48:51], a[196:199], v[16:19], v[48:51]
  s_waitcnt lgkmcnt(4)
  v_mfma_f32_16x16x32_bf16 v[36:39], a[72:75], v[20:23], v[36:39]
  ds_read_b128 v[12:15], v74 offset:43008
  v_mfma_f32_16x16x32_bf16 v[40:43], a[72:75], v[24:27], v[40:43]
  ds_read_b128 v[16:19], v74 offset:44032
  v_mfma_f32_16x16x32_bf16 v[44:47], a[200:203], v[20:23], v[44:47]
  v_mfma_f32_16x16x32_bf16 v[48:51], a[200:203], v[24:27], v[48:51]
  s_waitcnt lgkmcnt(4)
  v_mfma_f32_16x16x32_bf16 v[36:39], a[76:79], v[28:31], v[36:39]
  ds_read_b128 v[20:23], v74 offset:45056
  v_mfma_f32_16x16x32_bf16 v[40:43], a[76:79], v[32:35], v[40:43]
  ds_read_b128 v[24:27], v74 offset:46080
  v_mfma_f32_16x16x32_bf16 v[44:47], a[204:207], v[28:31], v[44:47]
  v_mfma_f32_16x16x32_bf16 v[48:51], a[204:207], v[32:35], v[48:51]
  s_waitcnt lgkmcnt(4)
  v_mfma_f32_16x16x32_bf16 v[36:39], a[80:83], v[4:7], v[36:39]
  ds_read_b128 v[28:31], v74 offset:47104
  v_mfma_f32_16x16x32_bf16 v[40:43], a[80:83], v[8:11], v[40:43]
  ds_read_b128 v[32:35], v74 offset:48128
  v_mfma_f32_16x16x32_bf16 v[44:47], a[208:211], v[4:7], v[44:47]
  v_mfma_f32_16x16x32_bf16 v[48:51], a[208:211], v[8:11], v[48:51]
  s_waitcnt lgkmcnt(4)
  v_mfma_f32_16x16x32_bf16 v[36:39], a[84:87], v[12:15], v[36:39]
  ds_read_b128 v[4:7], v74 offset:49152
  v_mfma_f32_16x16x32_bf16 v[40:43], a[84:87], v[16:19], v[40:43]
  ds_read_b128 v[8:11], v74 offset:50176
  v_mfma_f32_16x16x32_bf16 v[44:47], a[212:215], v[12:15], v[44:47]
  v_mfma_f32_16x16x32_bf16 v[48:51], a[212:215], v[16:19], v[48:51]
  s_waitcnt lgkmcnt(4)
  v_mfma_f32_16x16x32_bf16 v[36:39], a[88:91], v[20:23], v[36:39]
  ds_read_b128 v[12:15], v74 offset:51200
  v_mfma_f32_16x16x32_bf16 v[40:43], a[88:91], v[24:27], v[40:43]
  ds_read_b128 v[16:19], v74 offset:52224
  v_mfma_f32_16x16x32_bf16 v[44:47], a[216:219], v[20:23], v[44:47]
  v_mfma_f32_16x16x32_bf16 v[48:51], a[216:219], v[24:27], v[48:51]
  s_waitcnt lgkmcnt(4)
  v_mfma_f32_16x16x32_bf16 v[36:39], a[92:95], v[28:31], v[36:39]
  ds_read_b128 v[20:23], v74 offset:53248
  v_mfma_f32_16x16x32_bf16 v[40:43], a[92:95], v[32:35], v[40:43]
  ds_read_b128 v[24:27], v74 offset:54272
  v_mfma_f32_16x16x32_bf16 v[44:47], a[220:223], v[28:31], v[44:47]
  v_mfma_f32_16x16x32_bf16 v[48:51], a[220:223], v[32:35], v[48:51]
  s_waitcnt lgkmcnt(4)
  v_mfma_f32_16x16x32_bf16 v[36:39], a[96:99], v[4:7], v[36:39]
  ds_read_b128 v[28:31], v74 offset:55296
  v_mfma_f32_16x16x32_bf16 v[40:43], a[96:99], v[8:11], v[40:43]
  ds_read_b128 v[32:35], v74 offset:56320
  v_mfma_f32_16x16x32_bf16 v[44:47], a[224:227], v[4:7], v[44:47]
  v_mfma_f32_16x16x32_bf16 v[48:51], a[224:227], v[8:11], v[48:51]
  s_waitcnt lgkmcnt(4)
  v_mfma_f32_16x16x32_bf16 v[36:39], a[100:103], v[12:15], v[36:39]
  ds_read_b128 v[4:7], v74 offset:57344
  v_mfma_f32_16x16x32_bf16 v[40:43], a[100:103], v[16:19], v[40:43]
  ds_read_b128 v[8:11], v74 offset:58368
  v_mfma_f32_16x16x32_bf16 v[44:47], a[228:231], v[12:15], v[44:47]
  v_mfma_f32_16x16x32_bf16 v[48:51], a[228:231], v[16:19], v[48:51]
  s_waitcnt lgkmcnt(4)
  v_mfma_f32_16x16x32_bf16 v[36:39], a[104:107], v[20:23], v[36:39]
  ds_read_b128 v[12:15], v74 offset:59392
  v_mfma_f32_16x16x32_bf16 v[40:43], a[104:107], v[24:27], v[40:43]
  ds_read_b128 v[16:19], v74 offset:60416
  v_mfma_f32_16x16x32_bf16 v[44:47], a[232:235], v[20:23], v[44:47]
  v_mfma_f32_16x16x32_bf16 v[48:51], a[232:235], v[24:27], v[48:51]
  s_waitcnt lgkmcnt(4)
  v_mfma_f32_16x16x32_bf16 v[36:39], a[108:111], v[28:31], v[36:39]
  ds_read_b128 v[20:23], v74 offset:61440
  v_mfma_f32_16x16x32_bf16 v[40:43], a[108:111], v[32:35], v[40:43]
  ds_read_b128 v[24:27], v74 offset:62464
  v_mfma_f32_16x16x32_bf16 v[44:47], a[236:239], v[28:31], v[44:47]
  v_mfma_f32_16x16x32_bf16 v[48:51], a[236:239], v[32:35], v[48:51]
  s_waitcnt lgkmcnt(4)
  v_mfma_f32_16x16x32_bf16 v[36:39], a[112:115], v[4:7], v[36:39]
  ds_read_b128 v[28:31], v74 offset:63488
  v_mfma_f32_16x16x32_bf16 v[40:43], a[112:115], v[8:11], v[40:43]
  ds_read_b128 v[32:35], v74 offset:64512
  v_mfma_f32_16x16x32_bf16 v[44:47], a[240:243], v[4:7], v[44:47]
  v_mfma_f32_16x16x32_bf16 v[48:51], a[240:243], v[8:11], v[48:51]
  s_waitcnt lgkmcnt(4)
  v_mfma_f32_16x16x32_bf16 v[36:39], a[116:119], v[12:15], v[36:39]
  v_mfma_f32_16x16x32_bf16 v[40:43], a[116:119], v[16:19], v[40:43]
  v_mfma_f32_16x16x32_bf16 v[44:47], a[244:247], v[12:15], v[44:47]
  v_mfma_f32_16x16x32_bf16 v[48:51], a[244:247], v[16:19], v[48:51]
  s_waitcnt lgkmcnt(2)
  v_mfma_f32_16x16x32_bf16 v[36:39], a[120:123], v[20:23], v[36:39]
  v_mfma_f32_16x16x32_bf16 v[40:43], a[120:123], v[24:27], v[40:43]
  v_mfma_f32_16x16x32_bf16 v[44:47], a[248:251], v[20:23], v[44:47]
  v_mfma_f32_16x16x32_bf16 v[48:51], a[248:251], v[24:27], v[48:51]
  s_waitcnt lgkmcnt(0)
  v_mfma_f32_16x16x32_bf16 v[36:39], a[124:127], v[28:31], v[36:39]
  v_mfma_f32_16x16x32_bf16 v[40:43], a[124:127], v[32:35], v[40:43]
  v_mfma_f32_16x16x32_bf16 v[44:47], a[252:255], v[28:31], v[44:47]
  v_mfma_f32_16x16x32_bf16 v[48:51], a[252:255], v[32:35], v[48:51]
L_WO_epi:
  s_nop 4
  buffer_store_dwordx4 v[36:39], v68, s[4:7], s31 offen offset:0 sc1
  buffer_store_dwordx4 v[40:43], v76, s[4:7], s31 offen offset:0 sc1
  buffer_store_dwordx4 v[44:47], v68, s[4:7], s31 offen offset:256 sc1
  buffer_store_dwordx4 v[48:51], v76, s[4:7], s31 offen offset:256 sc1
  s_add_u32 s25, s25, 1
  s_add_u32 s31, s31, 524288
  s_branch L_WO_top
L_F1:
  s_load_dwordx2 s[8:9], s[0:1], 64
  s_mov_b32 s10, 7340032
  s_mov_b32 s11, 0x20000
  s_waitcnt lgkmcnt(0)
  s_lshl_b32 s44, s21, 7
  v_bfe_u32 v40, v0, 5, 1
  v_mul_u32_u24 v40, 28672, v40
  v_bfe_u32 v41, v0, 4, 1
  v_mul_u32_u24 v41, 14336, v41
  v_add_u32 v40, v40, v41
  v_bfe_u32 v41, v0, 3, 1
  v_mul_u32_u24 v41, 7168, v41
  v_add_u32 v40, v40, v41
  v_lshrrev_b32 v41, 3, v0
  v_and_b32 v41, 6, v41
  v_xor_b32 v41, v41, v0
  v_and_b32 v41, 7, v41
  v_lshl_add_u32 v40, v41, 4, v40
  s_lshr_b32 s40, s20, 1
  s_mul_i32 s40, s40, 1835008
  s_and_b32 s41, s20, 1
  s_mul_i32 s41, s41, 57344
  s_add_u32 s40, s40, s41
  v_add_u32 v40, s40, v40
  v_bfe_u32 v41, v0, 3, 2
  v_xor_b32 v41, s20, v41
  v_lshlrev_b32 v41, 5, v41
  v_lshrrev_b32 v42, 2, v0
  v_lshl_add_u32 v42, v42, 7, v41
  v_and_b32 v41, 3, v0
  v_lshl_add_u32 v42, v41, 3, v42
  v_add_u32 v43, 0x10000, v42
  v_add_u32 v44, s44, v40
  v_add_u32 v45, s44, v40
  s_lshl_b32 s41, s20, 10
  s_add_u32 m0, s41, 0
  s_mov_b32 s42, 0
  buffer_load_dwordx4 v44, s[8:11], s42 offen lds
  s_add_u32 m0, s41, 4096
  s_mov_b32 s42, 114688
  buffer_load_dwordx4 v44, s[8:11], s42 offen lds
  s_add_u32 m0, s41, 8192
  s_mov_b32 s42, 229376
  buffer_load_dwordx4 v44, s[8:11], s42 offen lds
  s_add_u32 m0, s41, 12288
  s_mov_b32 s42, 344064
  buffer_load_dwordx4 v44, s[8:11], s42 offen lds
  s_add_u32 m0, s41, 16384
  s_mov_b32 s42, 458752
  buffer_load_dwordx4 v44, s[8:11], s42 offen lds
  s_add_u32 m0, s41, 20480
  s_mov_b32 s42, 573440
  buffer_load_dwordx4 v44, s[8:11], s42 offen lds
  s_add_u32 m0, s41, 24576
  s_mov_b32 s42, 688128
  buffer_load_dwordx4 v44, s[8:11], s42 offen lds
  s_add_u32 m0, s41, 28672
  s_mov_b32 s42, 802816
  buffer_load_dwordx4 v44, s[8:11], s42 offen lds
  s_add_u32 m0, s41, 32768
  s_mov_b32 s42, 917504
  buffer_load_dwordx4 v44, s[8:11], s42 offen lds
  s_add_u32 m0, s41, 36864
  s_mov_b32 s42, 1032192
  buffer_load_dwordx4 v44, s[8:11], s42 offen lds
  s_add_u32 m0, s41, 40960
  s_mov_b32 s42, 1146880
  buffer_load_dwordx4 v44, s[8:11], s42 offen lds
  s_add_u32 m0, s41, 45056
  s_mov_b32 s42, 1261568
  buffer_load_dwordx4 v44, s[8:11], s42 offen lds
  s_add_u32 m0, s41, 49152
  s_mov_b32 s42, 1376256
  buffer_load_dwordx4 v44, s[8:11], s42 offen lds
  s_add_u32 m0, s41, 53248
  s_mov_b32 s42, 1490944
  buffer_load_dwordx4 v44, s[8:11], s42 offen lds
  s_add_u32 m0, s41, 57344
  s_mov_b32 s42, 1605632
  buffer_load_dwordx4 v44, s[8:11], s42 offen lds
  s_add_u32 m0, s41, 61440
  s_mov_b32 s42, 1720320
  buffer_load_dwordx4 v44, s[8:11], s42 offen lds
  s_add_u32 m0, s41, 65536
  s_mov_b32 s42, 3670016
  buffer_load_dwordx4 v44, s[8:11], s42 offen lds
  s_add_u32 m0, s41, 69632
  s_mov_b32 s42, 3784704
  buffer_load_dwordx4 v44, s[8:11], s42 offen lds
  s_add_u32 m0, s41, 73728
  s_mov_b32 s42, 3899392
  buffer_load_dwordx4 v44, s[8:11], s42 offen lds
  s_add_u32 m0, s41, 77824
  s_mov_b32 s42, 4014080
  buffer_load_dwordx4 v44, s[8:11], s42 offen lds
  s_add_u32 m0, s41, 81920
  s_mov_b32 s42, 4128768
  buffer_load_dwordx4 v44, s[8:11], s42 offen lds
  s_add_u32 m0, s41, 86016
  s_mov_b32 s42, 4243456
  buffer_load_dwordx4 v44, s[8:11], s42 offen lds
  s_add_u32 m0, s41, 90112
  s_mov_b32 s42, 4358144
  buffer_load_dwordx4 v44, s[8:11], s42 offen lds
  s_add_u32 m0, s41, 94208
  s_mov_b32 s42, 4472832
  buffer_load_dwordx4 v44, s[8:11], s42 offen lds
  s_add_u32 m0, s41, 98304
  s_mov_b32 s42, 4587520
  buffer_load_dwordx4 v44, s[8:11], s42 offen lds
  s_add_u32 m0, s41, 102400
  s_mov_b32 s42, 4702208
  buffer_load_dwordx4 v44, s[8:11], s42 offen lds
  s_add_u32 m0, s41, 106496
  s_mov_b32 s42, 4816896
  buffer_load_dwordx4 v44, s[8:11], s42 offen lds
  s_add_u32 m0, s41, 110592
  s_mov_b32 s42, 4931584
  buffer_load_dwordx4 v44, s[8:11], s42 offen lds
  s_waitcnt vmcnt(24) lgkmcnt(0)
  s_barrier
  s_add_u32 m0, s41, 114688
  s_mov_b32 s42, 5046272
  buffer_load_dwordx4 v44, s[8:11], s42 offen lds
  s_add_u32 m0, s41, 118784
  s_mov_b32 s42, 5160960
  buffer_load_dwordx4 v44, s[8:11], s42 offen lds
  s_add_u32 m0, s41, 122880
  s_mov_b32 s42, 5275648
  buffer_load_dwordx4 v44, s[8:11], s42 offen lds
  s_add_u32 m0, s41, 126976
  s_mov_b32 s42, 5390336
  buffer_load_dwordx4 v44, s[8:11], s42 offen lds
  ds_read_b64_tr_b16 a[0:1], v42 offset:0
  ds_read_b64_tr_b16 a[2:3], v42 offset:2048
  ds_read_b64_tr_b16 a[4:5], v42 offset:4096
  ds_read_b64_tr_b16 a[6:7], v42 offset:6144
  ds_read_b64_tr_b16 a[8:9], v42 offset:8192
  ds_read_b64_tr_b16 a[10:11], v42 offset:10240
  ds_read_b64_tr_b16 a[12:13], v42 offset:12288
  ds_read_b64_tr_b16 a[14:15], v42 offset:14336
  s_waitcnt vmcnt(24) lgkmcnt(0)
  s_barrier
  s_load_dwordx2 s[8:9], s[0:1], 72
  s_mov_b32 s10, 7340032
  s_mov_b32 s11, 0x20000
  s_waitcnt lgkmcnt(0)
  s_add_u32 m0, s41, 0
  s_mov_b32 s42, 0
  buffer_load_dwordx4 v45, s[8:11], s42 offen lds
  s_add_u32 m0, s41, 4096
  s_mov_b32 s42, 114688
  buffer_load_dwordx4 v45, s[8:11], s42 offen lds
  s_add_u32 m0, s41, 8192
  s_mov_b32 s42, 229376
  buffer_load_dwordx4 v45, s[8:11], s42 offen lds
  s_add_u32 m0, s41, 12288
  s_mov_b32 s42, 344064
  buffer_load_dwordx4 v45, s[8:11], s42 offen lds
  ds_read_b64_tr_b16 a[16:17], v42 offset:16384
  ds_read_b64_tr_b16 a[18:19], v42 offset:18432
  ds_read_b64_tr_b16 a[20:21], v42 offset:20480
  ds_read_b64_tr_b16 a[22:23], v42 offset:22528
  ds_read_b64_tr_b16 a[24:25], v42 offset:24576
  ds_read_b64_tr_b16 a[26:27], v42 offset:26624
  ds_read_b64_tr_b16 a[28:29], v42 offset:28672
  ds_read_b64_tr_b16 a[30:31], v42 offset:30720
  s_waitcnt vmcnt(24) lgkmcnt(0)
  s_barrier
  s_add_u32 m0, s41, 16384
  s_mov_b32 s42, 458752
  buffer_load_dwordx4 v45, s[8:11], s42 offen lds
  s_add_u32 m0, s41, 20480
  s_mov_b32 s42, 573440
  buffer_load_dwordx4 v45, s[8:11], s42 offen lds
  s_add_u32 m0, s41, 24576
  s_mov_b32 s42, 688128
  buffer_load_dwordx4 v45, s[8:11], s42 offen lds
  s_add_u32 m0, s41, 28672
  s_mov_b32 s42, 802816
  buffer_load_dwordx4 v45, s[8:11], s42 offen lds
  ds_read_b64_tr_b16 a[32:33], v42 offset:32768
  ds_read_b64_tr_b16 a[34:35], v42 offset:34816
  ds_read_b64_tr_b16 a[36:37], v42 offset:36864
  ds_read_b64_tr_b16 a[38:39], v42 offset:38912
  ds_read_b64_tr_b16 a[40:41], v42 offset:40960
  ds_read_b64_tr_b16 a[42:43], v42 offset:43008
  ds_read_b64_tr_b16 a[44:45], v42 offset:45056
  ds_read_b64_tr_b16 a[46:47], v42 offset:47104
  s_waitcnt vmcnt(24) lgkmcnt(0)
  s_barrier
  s_add_u32 m0, s41, 32768
  s_mov_b32 s42, 917504
  buffer_load_dwordx4 v45, s[8:11], s42 offen lds
  s_add_u32 m0, s41, 36864
  s_mov_b32 s42, 1032192
  buffer_load_dwordx4 v45, s[8:11], s42 offen lds
  s_add_u32 m0, s41, 40960
  s_mov_b32 s42, 1146880
  buffer_load_dwordx4 v45, s[8:11], s42 offen lds
  s_add_u32 m0, s41, 45056
  s_mov_b32 s42, 1261568
  buffer_load_dwordx4 v45, s[8:11], s42 offen lds
  ds_read_b64_tr_b16 a[48:49], v42 offset:49152
  ds_read_b64_tr_b16 a[50:51], v42 offset:51200
  ds_read_b64_tr_b16 a[52:53], v42 offset:53248
  ds_read_b64_tr_b16 a[54:55], v42 offset:55296
  ds_read_b64_tr_b16 a[56:57], v42 offset:57344
  ds_read_b64_tr_b16 a[58:59], v42 offset:59392
  ds_read_b64_tr_b16 a[60:61], v42 offset:61440
  ds_read_b64_tr_b16 a[62:63], v42 offset:63488
  s_waitcnt vmcnt(24) lgkmcnt(0)
  s_barrier
  s_add_u32 m0, s41, 49152
  s_mov_b32 s42, 1376256
  buffer_load_dwordx4 v45, s[8:11], s42 offen lds
  s_add_u32 m0, s41, 53248
  s_mov_b32 s42, 1490944
  buffer_load_dwordx4 v45, s[8:11], s42 offen lds
  s_add_u32 m0, s41, 57344
  s_mov_b32 s42, 1605632
  buffer_load_dwordx4 v45, s[8:11], s42 offen lds
  s_add_u32 m0, s41, 61440
  s_mov_b32 s42, 1720320
  buffer_load_dwordx4 v45, s[8:11], s42 offen lds
  ds_read_b64_tr_b16 a[64:65], v43 offset:0
  ds_read_b64_tr_b16 a[66:67], v43 offset:2048
  ds_read_b64_tr_b16 a[68:69], v43 offset:4096
  ds_read_b64_tr_b16 a[70:71], v43 offset:6144
  ds_read_b64_tr_b16 a[72:73], v43 offset:8192
  ds_read_b64_tr_b16 a[74:75], v43 offset:10240
  ds_read_b64_tr_b16 a[76:77], v43 offset:12288
  ds_read_b64_tr_b16 a[78:79], v43 offset:14336
  s_waitcnt vmcnt(24) lgkmcnt(0)
  s_barrier
  s_add_u32 m0, s41, 65536
  s_mov_b32 s42, 3670016
  buffer_load_dwordx4 v45, s[8:11], s42 offen lds
  s_add_u32 m0, s41, 69632
  s_mov_b32 s42, 3784704
  buffer_load_dwordx4 v45, s[8:11], s42 offen lds
  s_add_u32 m0, s41, 73728
  s_mov_b32 s42, 3899392
  buffer_load_dwordx4 v45, s[8:11], s42 offen lds
  s_add_u32 m0, s41, 77824
  s_mov_b32 s42, 4014080
  buffer_load_dwordx4 v45, s[8:11], s42 offen lds
  ds_read_b64_tr_b16 a[80:81], v43 offset:16384
  ds_read_b64_tr_b16 a[82:83], v43 offset:18432
  ds_read_b64_tr_b16 a[84:85], v43 offset:20480
  ds_read_b64_tr_b16 a[86:87], v43 offset:22528
  ds_read_b64_tr_b16 a[88:89], v43 offset:24576
  ds_read_b64_tr_b16 a[90:91], v43 offset:26624
  ds_read_b64_tr_b16 a[92:93], v43 offset:28672
  ds_read_b64_tr_b16 a[94:95], v43 offset:30720
  s_waitcnt vmcnt(24) lgkmcnt(0)
  s_barrier
  s_add_u32 m0, s41, 81920
  s_mov_b32 s42, 4128768
  buffer_load_dwordx4 v45, s[8:11], s42 offen lds
  s_add_u32 m0, s41, 86016
  s_mov_b32 s42, 4243456
  buffer_load_dwordx4 v45, s[8:11], s42 offen lds
  s_add_u32 m0, s41, 90112
  s_mov_b32 s42, 4358144
  buffer_load_dwordx4 v45, s[8:11], s42 offen lds
  s_add_u32 m0, s41, 94208
  s_mov_b32 s42, 4472832
  buffer_load_dwordx4 v45, s[8:11], s42 offen lds
  ds_read_b64_tr_b16 a[96:97], v43 offset:32768
  ds_read_b64_tr_b16 a[98:99], v43 offset:34816
  ds_read_b64_tr_b16 a[100:101], v43 offset:36864
  ds_read_b64_tr_b16 a[102:103], v43 offset:38912
  ds_read_b64_tr_b16 a[104:105], v43 offset:40960
  ds_read_b64_tr_b16 a[106:107], v43 offset:43008
  ds_read_b64_tr_b16 a[108:109], v43 offset:45056
  ds_read_b64_tr_b16 a[110:111], v43 offset:47104
  s_waitcnt vmcnt(24) lgkmcnt(0)
  s_barrier
  s_add_u32 m0, s41, 98304
  s_mov_b32 s42, 4587520
  buffer_load_dwordx4 v45, s[8:11], s42 offen lds
  s_add_u32 m0, s41, 102400
  s_mov_b32 s42, 4702208
  buffer_load_dwordx4 v45, s[8:11], s42 offen lds
  s_add_u32 m0, s41, 106496
  s_mov_b32 s42, 4816896
  buffer_load_dwordx4 v45, s[8:11], s42 offen lds
  s_add_u32 m0, s41, 110592
  s_mov_b32 s42, 4931584
  buffer_load_dwordx4 v45, s[8:11], s42 offen lds
  ds_read_b64_tr_b16 a[112:113], v43 offset:49152
  ds_read_b64_tr_b16 a[114:115], v43 offset:51200
  ds_read_b64_tr_b16 a[116:117], v43 offset:53248
  ds_read_b64_tr_b16 a[118:119], v43 offset:55296
  ds_read_b64_tr_b16 a[120:121], v43 offset:57344
  ds_read_b64_tr_b16 a[122:123], v43 offset:59392
  ds_read_b64_tr_b16 a[124:125], v43 offset:61440
  ds_read_b64_tr_b16 a[126:127], v43 offset:63488
  s_waitcnt vmcnt(24) lgkmcnt(0)
  s_barrier
  s_add_u32 m0, s41, 114688
  s_mov_b32 s42, 5046272
  buffer_load_dwordx4 v45, s[8:11], s42 offen lds
  s_add_u32 m0, s41, 118784
  s_mov_b32 s42, 5160960
  buffer_load_dwordx4 v45, s[8:11], s42 offen lds
  s_add_u32 m0, s41, 122880
  s_mov_b32 s42, 5275648
  buffer_load_dwordx4 v45, s[8:11], s42 offen lds
  s_add_u32 m0, s41, 126976
  s_mov_b32 s42, 5390336
  buffer_load_dwordx4 v45, s[8:11], s42 offen lds
  ds_read_b64_tr_b16 a[128:129], v42 offset:0
  ds_read_b64_tr_b16 a[130:131], v42 offset:2048
  ds_read_b64_tr_b16 a[132:133], v42 offset:4096
  ds_read_b64_tr_b16 a[134:135], v42 offset:6144
  ds_read_b64_tr_b16 a[136:137], v42 offset:8192
  ds_read_b64_tr_b16 a[138:139], v42 offset:10240
  ds_read_b64_tr_b16 a[140:141], v42 offset:12288
  ds_read_b64_tr_b16 a[142:143], v42 offset:14336
  s_waitcnt vmcnt(24) lgkmcnt(0)
  s_barrier
  ds_read_b64_tr_b16 a[144:145], v42 offset:16384
  ds_read_b64_tr_b16 a[146:147], v42 offset:18432
  ds_read_b64_tr_b16 a[148:149], v42 offset:20480
  ds_read_b64_tr_b16 a[150:151], v42 offset:22528
  ds_read_b64_tr_b16 a[152:153], v42 offset:24576
  ds_read_b64_tr_b16 a[154:155], v42 offset:26624
  ds_read_b64_tr_b16 a[156:157], v42 offset:28672
  ds_read_b64_tr_b16 a[158:159], v42 offset:30720
  s_waitcnt vmcnt(20) lgkmcnt(0)
  s_barrier
  ds_read_b64_tr_b16 a[160:161], v42 offset:32768
  ds_read_b64_tr_b16 a[162:163], v42 offset:34816
  ds_read_b64_tr_b16 a[164:165], v42 offset:36864
  ds_read_b64_tr_b16 a[166:167], v42 offset:38912
  ds_read_b64_tr_b16 a[168:169], v42 offset:40960
  ds_read_b64_tr_b16 a[170:171], v42 offset:43008
  ds_read_b64_tr_b16 a[172:173], v42 offset:45056
  ds_read_b64_tr_b16 a[174:175], v42 offset:47104
  s_waitcnt vmcnt(16) lgkmcnt(0)
  s_barrier
  ds_read_b64_tr_b16 a[176:177], v42 offset:49152
  ds_read_b64_tr_b16 a[178:179], v42 offset:51200
  ds_read_b64_tr_b16 a[180:181], v42 offset:53248
  ds_read_b64_tr_b16 a[182:183], v42 offset:55296
  ds_read_b64_tr_b16 a[184:185], v42 offset:57344
  ds_read_b64_tr_b16 a[186:187], v42 offset:59392
  ds_read_b64_tr_b16 a[188:189], v42 offset:61440
  ds_read_b64_tr_b16 a[190:191], v42 offset:63488
  s_waitcnt vmcnt(12) lgkmcnt(0)
  s_barrier
  ds_read_b64_tr_b16 a[192:193], v43 offset:0
  ds_read_b64_tr_b16 a[194:195], v43 offset:2048
  ds_read_b64_tr_b16 a[196:197], v43 offset:4096
  ds_read_b64_tr_b16 a[198:199], v43 offset:6144
  ds_read_b64_tr_b16 a[200:201], v43 offset:8192
  ds_read_b64_tr_b16 a[202:203], v43 offset:10240
  ds_read_b64_tr_b16 a[204:205], v43 offset:12288
  ds_read_b64_tr_b16 a[206:207], v43 offset:14336
  s_waitcnt vmcnt(8) lgkmcnt(0)
  s_barrier
  ds_read_b64_tr_b16 a[208:209], v43 offset:16384
  ds_read_b64_tr_b16 a[210:211], v43 offset:18432
  ds_read_b64_tr_b16 a[212:213], v43 offset:20480
  ds_read_b64_tr_b16 a[214:215], v43 offset:22528
  ds_read_b64_tr_b16 a[216:217], v43 offset:24576
  ds_read_b64_tr_b16 a[218:219], v43 offset:26624
  ds_read_b64_tr_b16 a[220:221], v43 offset:28672
  ds_read_b64_tr_b16 a[222:223], v43 offset:30720
  s_waitcnt vmcnt(4) lgkmcnt(0)
  s_barrier
  ds_read_b64_tr_b16 a[224:225], v43 offset:32768
  ds_read_b64_tr_b16 a[226:227], v43 offset:34816
  ds_read_b64_tr_b16 a[228:229], v43 offset:36864
  ds_read_b64_tr_b16 a[230:231], v43 offset:38912
  ds_read_b64_tr_b16 a[232:233], v43 offset:40960
  ds_read_b64_tr_b16 a[234:235], v43 offset:43008
  ds_read_b64_tr_b16 a[236:237], v43 offset:45056
  ds_read_b64_tr_b16 a[238:239], v43 offset:47104
  s_waitcnt vmcnt(0) lgkmcnt(0)
  s_barrier
  ds_read_b64_tr_b16 a[240:241], v43 offset:49152
  ds_read_b64_tr_b16 a[242:243], v43 offset:51200
  ds_read_b64_tr_b16 a[244:245], v43 offset:53248
  ds_read_b64_tr_b16 a[246:247], v43 offset:55296
  ds_read_b64_tr_b16 a[248:249], v43 offset:57344
  ds_read_b64_tr_b16 a[250:251], v43 offset:59392
  ds_read_b64_tr_b16 a[252:253], v43 offset:61440
  ds_read_b64_tr_b16 a[254:255], v43 offset:63488
  s_waitcnt lgkmcnt(0)
  s_barrier
  v_min_u32 v2, 15, v0
  v_lshlrev_b32 v2, 7, v2
  v_add_u32 v2, 1429504, v2
  s_lshl_b32 s40, s21, 7
  s_add_u32 s40, s40, 1431552
  v_mov_b32 v69, 2147483392
  s_mov_b64 exec, 1
  v_mov_b32 v69, s40
  s_mov_b64 exec, -1
  s_mov_b32 s27, 6291456
  s_lshl_b32 s40, s21, 12
  s_add_u32 s31, s40, 44040192
  s_lshr_b32 s40, s20, 1
  s_lshl_b32 s40, s40, 11
  s_and_b32 s41, s20, 1
  s_lshl_b32 s41, s41, 9
  s_add_u32 s40, s40, s41
  v_and_b32 v52, 31, v0
  v_lshl_add_u32 v68, v52, 4, s40
  v_lshrrev_b32 v52, 5, v0
  v_lshl_add_u32 v68, v52, 10, v68
  s_mov_b32 s37, 0xbfb8aa3b
  v_lshrrev_b32 v52, 3, v0
  v_and_b32 v53, 6, v52
  v_xor_b32 v53, v53, v0
  v_and_b32 v53, 7, v53
  v_lshlrev_b32 v53, 4, v53
  v_lshl_add_u32 v1, v52, 11, v53
  s_lshl_b32 s40, s20, 14
  v_add_u32 v1, s40, v1
  s_lshl_b32 s32, s20, 10
  v_and_b32 v52, 6, v0
  v_lshrrev_b32 v53, 4, v0
  v_xor_b32 v52, v52, v53
  v_lshlrev_b32 v52, 4, v52
  v_and_b32 v53, 15, v0
  v_lshl_add_u32 v70, v53, 7, v52
  v_xor_b32 v71, 64, v70
  s_lshl_b32 s40, s20, 2
  s_add_u32 s40, s40, 131072
  v_mov_b32 v72, s40
  v_mov_b32 v52, 0
  ds_write_b32 v72, v52
  s_mov_b32 s25, 0
  s_mov_b32 s26, 0
  s_mov_b32 s29, 1
  s_mov_b32 s30, 0
  s_waitcnt lgkmcnt(0)
  s_barrier
  s_branch L_F1_poll
L_F1_top:
  s_cmp_lg_u32 s28, 0
  s_cbranch_scc1 L_F1_go
  v_mov_b32 v52, s25
  v_and_b32 v53, 3, v0
  v_lshlrev_b32 v53, 2, v53
  v_add_u32 v53, 131072, v53
  s_waitcnt vmcnt(0)
  ds_write_b32 v72, v52
  ds_read_b32 v53, v53
  s_waitcnt lgkmcnt(0)
  v_cmp_gt_i32 vcc, s25, v53
  s_cbranch_vccnz L_F1_nosig
  buffer_store_dword v52, v69, s[4:7], 0 offen sc1
L_F1_nosig:
  s_cmp_ge_u32 s25, 64
  s_cbranch_scc1 L_END
L_F1_poll:
  s_nop 0
Lpoll_27:
  buffer_load_dword v3, v2, s[4:7], s30 offen sc1
  s_sub_u32 s24, s24, 1
  s_cbranch_scc1 L_FAIL
  s_waitcnt vmcnt(0)
  v_cmp_gt_i32 vcc, s29, v3
  s_cbranch_vccz Lpolld_28
  s_sleep 2
  s_branch Lpoll_27
Lpolld_28:
  s_add_u32 s34, s26, s32
  s_mov_b32 s35, s27
  s_add_u32 m0, s34, 0
  s_nop 0
  buffer_load_dwordx4 v1, s[4:7], s35 offen offset:0 sc1 lds
  s_add_u32 m0, s34, 3968
  s_nop 0
  buffer_load_dwordx4 v1, s[4:7], s35 offen offset:128 sc1 lds
  s_add_u32 m0, s34, 7936
  s_nop 0
  buffer_load_dwordx4 v1, s[4:7], s35 offen offset:256 sc1 lds
  s_add_u32 m0, s34, 11904
  s_nop 0
  buffer_load_dwordx4 v1, s[4:7], s35 offen offset:384 sc1 lds
  s_add_u32 m0, s34, 15872
  s_nop 0
  buffer_load_dwordx4 v1, s[4:7], s35 offen offset:512 sc1 lds
  s_add_u32 m0, s34, 19840
  s_nop 0
  buffer_load_dwordx4 v1, s[4:7], s35 offen offset:640 sc1 lds
  s_add_u32 m0, s34, 23808
  s_nop 0
  buffer_load_dwordx4 v1, s[4:7], s35 offen offset:768 sc1 lds
  s_add_u32 m0, s34, 27776
  s_nop 0
  buffer_load_dwordx4 v1, s[4:7], s35 offen offset:896 sc1 lds
  s_add_u32 m0, s34, 31744
  s_nop 0
  buffer_load_dwordx4 v1, s[4:7], s35 offen offset:1024 sc1 lds
  s_add_u32 m0, s34, 35712
  s_nop 0
  buffer_load_dwordx4 v1, s[4:7], s35 offen offset:1152 sc1 lds
  s_add_u32 m0, s34, 39680
  s_nop 0
  buffer_load_dwordx4 v1, s[4:7], s35 offen offset:1280 sc1 lds
  s_add_u32 m0, s34, 43648
  s_nop 0
  buffer_load_dwordx4 v1, s[4:7], s35 offen offset:1408 sc1 lds
  s_add_u32 m0, s34, 47616
  s_nop 0
  buffer_load_dwordx4 v1, s[4:7], s35 offen offset:1536 sc1 lds
  s_add_u32 m0, s34, 51584
  s_nop 0
  buffer_load_dwordx4 v1, s[4:7], s35 offen offset:1664 sc1 lds
  s_add_u32 m0, s34, 55552
  s_nop 0
  buffer_load_dwordx4 v1, s[4:7], s35 offen offset:1792 sc1 lds
  s_add_u32 m0, s34, 59520
  s_nop 0
  buffer_load_dwordx4 v1, s[4:7], s35 offen offset:1920 sc1 lds
L_F1_go:
  v_add_u32 v74, s26, v70
  v_add_u32 v75, s26, v71
  s_sub_u32 s26, 65536, s26
  s_add_u32 s27, s27, 65536
  s_add_u32 s34, s26, s32
  s_mov_b32 s35, s27
  s_add_u32 s29, s29, 1
  s_waitcnt vmcnt(12) lgkmcnt(0)
  s_barrier
  ds_read_b128 v[4:7], v74 offset:0
  ds_read_b128 v[8:11], v74 offset:2048
  ds_read_b128 v[12:15], v75 offset:0
  ds_read_b128 v[16:19], v75 offset:2048
  ds_read_b128 v[20:23], v74 offset:4096
  ds_read_b128 v[24:27], v74 offset:6144
  buffer_load_dword v3, v2, s[4:7], s30 offen sc1
  s_waitcnt lgkmcnt(4)
  v_mfma_f32_16x16x32_bf16 v[36:39], a[0:3], v[4:7], 0
  ds_read_b128 v[28:31], v75 offset:4096
  v_mfma_f32_16x16x32_bf16 v[40:43], a[0:3], v[8:11], 0
  ds_read_b128 v[32:35], v75 offset:6144
  v_mfma_f32_16x16x32_bf16 v[44:47], a[128:131], v[4:7], 0
  v_mfma_f32_16x16x32_bf16 v[48:51], a[128:131], v[8:11], 0
  s_waitcnt lgkmcnt(4)
  v_mfma_f32_16x16x32_bf16 v[36:39], a[4:7], v[12:15], v[36:39]
  ds_read_b128 v[4:7], v74 offset:8192
  v_mfma_f32_16x16x32_bf16 v[40:43], a[4:7], v[16:19], v[40:43]
  ds_read_b128 v[8:11], v74 offset:10240
  v_mfma_f32_16x16x32_bf16 v[44:47], a[132:135], v[12:15], v[44:47]
  v_mfma_f32_16x16x32_bf16 v[48:51], a[132:135], v[16:19], v[48:51]
  s_waitcnt lgkmcnt(4)
  v_mfma_f32_16x16x32_bf16 v[36:39], a[8:11], v[20:23], v[36:39]
  ds_read_b128 v[12:15], v75 offset:8192
  v_mfma_f32_16x16x32_bf16 v[40:43], a[8:11], v[24:27], v[40:43]
  ds_read_b128 v[16:19], v75 offset:10240
  v_mfma_f32_16x16x32_bf16 v[44:47], a[136:139], v[20:23], v[44:47]
  v_mfma_f32_16x16x32_bf16 v[48:51], a[136:139], v[24:27], v[48:51]
  s_waitcnt lgkmcnt(4)
  v_mfma_f32_16x16x32_bf16 v[36:39], a[12:15], v[28:31], v[36:39]
  ds_read_b128 v[20:23], v74 offset:12288
  v_mfma_f32_16x16x32_bf16 v[40:43], a[12:15], v[32:35], v[40:43]
  ds_read_b128 v[24:27], v74 offset:14336
  v_mfma_f32_16x16x32_bf16 v[44:47], a[140:143], v[28:31], v[44:47]
  v_mfma_f32_16x16x32_bf16 v[48:51], a[140:143], v[32:35], v[48:51]
  s_waitcnt lgkmcnt(4)
  v_mfma_f32_16x16x32_bf16 v[36:39], a[16:19], v[4:7], v[36:39]
  ds_read_b128 v[28:31], v75 offset:12288
  v_mfma_f32_16x16x32_bf16 v[40:43], a[16:19], v[8:11], v[40:43]
  ds_read_b128 v[32:35], v75 offset:14336
  v_mfma_f32_16x16x32_bf16 v[44:47], a[144:147], v[4:7], v[44:47]
  v_mfma_f32_16x16x32_bf16 v[48:51], a[144:147], v[8:11], v[48:51]
  s_waitcnt vmcnt(9)
  s_barrier
  s_waitcnt lgkmcnt(4)
  v_mfma_f32_16x16x32_bf16 v[36:39], a[20:23], v[12:15], v[36:39]
  ds_read_b128 v[4:7], v74 offset:16384
  v_mfma_f32_16x16x32_bf16 v[40:43], a[20:23], v[16:19], v[40:43]
  ds_read_b128 v[8:11], v74 offset:18432
  v_mfma_f32_16x16x32_bf16 v[44:47], a[148:151], v[12:15], v[44:47]
  v_mfma_f32_16x16x32_bf16 v[48:51], a[148:151], v[16:19], v[48:51]
  s_waitcnt lgkmcnt(4)
  v_mfma_f32_16x16x32_bf16 v[36:39], a[24:27], v[20:23], v[36:39]
  ds_read_b128 v[12:15], v75 offset:16384
  v_mfma_f32_16x16x32_bf16 v[40:43], a[24:27], v[24:27], v[40:43]
  ds_read_b128 v[16:19], v75 offset:18432
  v_mfma_f32_16x16x32_bf16 v[44:47], a[152:155], v[20:23], v[44:47]
  v_mfma_f32_16x16x32_bf16 v[48:51], a[152:155], v[24:27], v[48:51]
  s_waitcnt lgkmcnt(4)
  v_mfma_f32_16x16x32_bf16 v[36:39], a[28:31], v[28:31], v[36:39]
  ds_read_b128 v[20:23], v74 offset:20480
  v_mfma_f32_16x16x32_bf16 v[40:43], a[28:31], v[32:35], v[40:43]
  ds_read_b128 v[24:27], v74 offset:22528
  v_mfma_f32_16x16x32_bf16 v[44:47], a[156:159], v[28:31], v[44:47]
  v_mfma_f32_16x16x32_bf16 v[48:51], a[156:159], v[32:35], v[48:51]
  s_waitcnt lgkmcnt(4)
  v_mfma_f32_16x16x32_bf16 v[36:39], a[32:35], v[4:7], v[36:39]
  ds_read_b128 v[28:31], v75 offset:20480
  v_mfma_f32_16x16x32_bf16 v[40:43], a[32:35], v[8:11], v[40:43]
  ds_read_b128 v[32:35], v75 offset:22528
  v_mfma_f32_16x16x32_bf16 v[44:47], a[160:163], v[4:7], v[44:47]
  v_mfma_f32_16x16x32_bf16 v[48:51], a[160:163], v[8:11], v[48:51]
  s_waitcnt lgkmcnt(4)
  v_mfma_f32_16x16x32_bf16 v[36:39], a[36:39], v[12:15], v[36:39]
  ds_read_b128 v[4:7], v74 offset:24576
  v_mfma_f32_16x16x32_bf16 v[40:43], a[36:39], v[16:19], v[40:43]
  ds_read_b128 v[8:11], v74 offset:26624
  v_mfma_f32_16x16x32_bf16 v[44:47], a[164:167], v[12:15], v[44:47]
  v_mfma_f32_16x16x32_bf16 v[48:51], a[164:167], v[16:19], v[48:51]
  s_waitcnt lgkmcnt(4)
  v_mfma_f32_16x16x32_bf16 v[36:39], a[40:43], v[20:23], v[36:39]
  ds_read_b128 v[12:15], v75 offset:24576
  v_mfma_f32_16x16x32_bf16 v[40:43], a[40:43], v[24:27], v[40:43]
  ds_read_b128 v[16:19], v75 offset:26624
  v_mfma_f32_16x16x32_bf16 v[44:47], a[168:171], v[20:23], v[44:47]
  v_mfma_f32_16x16x32_bf16 v[48:51], a[168:171], v[24:27], v[48:51]
  s_waitcnt lgkmcnt(4)
  v_mfma_f32_16x16x32_bf16 v[36:39], a[44:47], v[28:31], v[36:39]
  ds_read_b128 v[20:23], v74 offset:28672
  v_mfma_f32_16x16x32_bf16 v[40:43], a[44:47], v[32:35], v[40:43]
  ds_read_b128 v[24:27], v74 offset:30720
  v_mfma_f32_16x16x32_bf16 v[44:47], a[172:175], v[28:31], v[44:47]
  v_mfma_f32_16x16x32_bf16 v[48:51], a[172:175], v[32:35], v[48:51]
  s_waitcnt lgkmcnt(4)
  v_mfma_f32_16x16x32_bf16 v[36:39], a[48:51], v[4:7], v[36:39]
  ds_read_b128 v[28:31], v75 offset:28672
  v_mfma_f32_16x16x32_bf16 v[40:43], a[48:51], v[8:11], v[40:43]
  ds_read_b128 v[32:35], v75 offset:30720
  v_mfma_f32_16x16x32_bf16 v[44:47], a[176:179], v[4:7], v[44:47]
  v_mfma_f32_16x16x32_bf16 v[48:51], a[176:179], v[8:11], v[48:51]
  s_waitcnt vmcnt(0)
  s_barrier
  v_mov_b32 v52, s25
  v_cmp_gt_i32 vcc, s29, v3
  s_cmp_lg_u32 s20, 0
  s_cbranch_scc1 L_F1_s2
  buffer_store_dword v52, v69, s[4:7], 0 offen sc1
L_F1_s2:
  s_mov_b32 s28, 0
  s_cbranch_vccnz L_F1_nopf
  s_cmp_ge_u32 s25, 63
  s_cbranch_scc1 L_F1_nopf
  s_mov_b32 s28, 1
  s_waitcnt lgkmcnt(4)
  v_mfma_f32_16x16x32_bf16 v[36:39], a[52:55], v[12:15], v[36:39]
  ds_read_b128 v[4:7], v74 offset:32768
  v_mfma_f32_16x16x32_bf16 v[40:43], a[52:55], v[16:19], v[40:43]
  ds_read_b128 v[8:11], v74 offset:34816
  v_mfma_f32_16x16x32_bf16 v[44:47], a[180:183], v[12:15], v[44:47]
  s_add_u32 m0, s34, 0
  s_nop 0
  buffer_load_dwordx4 v1, s[4:7], s35 offen offset:0 sc1 lds
  v_mfma_f32_16x16x32_bf16 v[48:51], a[180:183], v[16:19], v[48:51]
  s_waitcnt lgkmcnt(4)
  v_mfma_f32_16x16x32_bf16 v[36:39], a[56:59], v[20:23], v[36:39]
  ds_read_b128 v[12:15], v75 offset:32768
  v_mfma_f32_16x16x32_bf16 v[40:43], a[56:59], v[24:27], v[40:43]
  ds_read_b128 v[16:19], v75 offset:34816
  v_mfma_f32_16x16x32_bf16 v[44:47], a[184:187], v[20:23], v[44:47]
  s_add_u32 m0, s34, 3968
  s_nop 0
  buffer_load_dwordx4 v1, s[4:7], s35 offen offset:128 sc1 lds
  v_mfma_f32_16x16x32_bf16 v[48:51], a[184:187], v[24:27], v[48:51]
  s_waitcnt lgkmcnt(4)
  v_mfma_f32_16x16x32_bf16 v[36:39], a[60:63], v[28:31], v[36:39]
  ds_read_b128 v[20:23], v74 offset:36864
  v_mfma_f32_16x16x32_bf16 v[40:43], a[60:63], v[32:35], v[40:43]
  ds_read_b128 v[24:27], v74 offset:38912
  v_mfma_f32_16x16x32_bf16 v[44:47], a[188:191], v[28:31], v[44:47]
  s_add_u32 m0, s34, 7936
  s_nop 0
  buffer_load_dwordx4 v1, s[4:7], s35 offen offset:256 sc1 lds
  v_mfma_f32_16x16x32_bf16 v[48:51], a[188:191], v[32:35], v[48:51]
  s_waitcnt lgkmcnt(4)
  v_mfma_f32_16x16x32_bf16 v[36:39], a[64:67], v[4:7], v[36:39]
  ds_read_b128 v[28:31], v75 offset:36864
  v_mfma_f32_16x16x32_bf16 v[40:43], a[64:67], v[8:11], v[40:43]
  ds_read_b128 v[32:35], v75 offset:38912
  v_mfma_f32_16x16x32_bf16 v[44:47], a[192:195], v[4:7], v[44:47]
  s_add_u32 m0, s34, 11904
  s_nop 0
  buffer_load_dwordx4 v1, s[4:7], s35 offen offset:384 sc1 lds
  v_mfma_f32_16x16x32_bf16 v[48:51], a[192:195], v[8:11], v[48:51]
  s_waitcnt lgkmcnt(4)
  v_mfma_f32_16x16x32_bf16 v[36:39], a[68:71], v[12:15], v[36:39]
  ds_read_b128 v[4:7], v74 offset:40960
  v_mfma_f32_16x16x32_bf16 v[40:43], a[68:71], v[16:19], v[40:43]
  ds_read_b128 v[8:11], v74 offset:43008
  v_mfma_f32_16x16x32_bf16 v[44:47], a[196:199], v[12:15], v[44:47]
  s_add_u32 m0, s34, 15872
  s_nop 0
  buffer_load_dwordx4 v1, s[4:7], s35 offen offset:512 sc1 lds
  v_mfma_f32_16x16x32_bf16 v[48:51], a[196:199], v[16:19], v[48:51]
  s_waitcnt lgkmcnt(4)
  v_mfma_f32_16x16x32_bf16 v[36:39], a[72:75], v[20:23], v[36:39]
  ds_read_b128 v[12:15], v75 offset:40960
  v_mfma_f32_16x16x32_bf16 v[40:43], a[72:75], v[24:27], v[40:43]
  ds_read_b128 v[16:19], v75 offset:43008
  v_mfma_f32_16x16x32_bf16 v[44:47], a[200:203], v[20:23], v[44:47]
  s_add_u32 m0, s34, 19840
  s_nop 0
  buffer_load_dwordx4 v1, s[4:7], s35 offen offset:640 sc1 lds
  v_mfma_f32_16x16x32_bf16 v[48:51], a[200:203], v[24:27], v[48:51]
  s_waitcnt lgkmcnt(4)
  v_mfma_f32_16x16x32_bf16 v[36:39], a[76:79], v[28:31], v[36:39]
  ds_read_b128 v[20:23], v74 offset:45056
  v_mfma_f32_16x16x32_bf16 v[40:43], a[76:79], v[32:35], v[40:43]
  ds_read_b128 v[24:27], v74 offset:47104
  v_mfma_f32_16x16x32_bf16 v[44:47], a[204:207], v[28:31], v[44:47]
  s_add_u32 m0, s34, 23808
  s_nop 0
  buffer_load_dwordx4 v1, s[4:7], s35 offen offset:768 sc1 lds
  v_mfma_f32_16x16x32_bf16 v[48:51], a[204:207], v[32:35], v[48:51]
  s_waitcnt lgkmcnt(4)
  v_mfma_f32_16x16x32_bf16 v[36:39], a[80:83], v[4:7], v[36:39]
  ds_read_b128 v[28:31], v75 offset:45056
  v_mfma_f32_16x16x32_bf16 v[40:43], a[80:83], v[8:11], v[40:43]
  ds_read_b128 v[32:35], v75 offset:47104
  v_mfma_f32_16x16x32_bf16 v[44:47], a[208:211], v[4:7], v[44:47]
  s_add_u32 m0, s34, 27776
  s_nop 0
  buffer_load_dwordx4 v1, s[4:7], s35 offen offset:896 sc1 lds
  v_mfma_f32_16x16x32_bf16 v[48:51], a[208:211], v[8:11], v[48:51]
  s_waitcnt lgkmcnt(4)
  v_mfma_f32_16x16x32_bf16 v[36:39], a[84:87], v[12:15], v[36:39]
  ds_read_b128 v[4:7], v74 offset:49152
  v_mfma_f32_16x16x32_bf16 v[40:43], a[84:87], v[16:19], v[40:43]
  ds_read_b128 v[8:11], v74 offset:51200
  v_mfma_f32_16x16x32_bf16 v[44:47], a[212:215], v[12:15], v[44:47]
  s_add_u32 m0, s34, 31744
  s_nop 0
  buffer_load_dwordx4 v1, s[4:7], s35 offen offset:1024 sc1 lds
  v_mfma_f32_16x16x32_bf16 v[48:51], a[212:215], v[16:19], v[48:51]
  s_waitcnt lgkmcnt(4)
  v_mfma_f32_16x16x32_bf16 v[36:39], a[88:91], v[20:23], v[36:39]
  ds_read_b128 v[12:15], v75 offset:49152
  v_mfma_f32_16x16x32_bf16 v[40:43], a[88:91], v[24:27], v[40:43]
  ds_read_b128 v[16:19], v75 offset:51200
  v_mfma_f32_16x16x32_bf16 v[44:47], a[216:219], v[20:23], v[44:47]
  s_add_u32 m0, s34, 35712
  s_nop 0
  buffer_load_dwordx4 v1, s[4:7], s35 offen offset:1152 sc1 lds
  v_mfma_f32_16x16x32_bf16 v[48:51], a[216:219], v[24:27], v[48:51]
  s_waitcnt lgkmcnt(4)
  v_mfma_f32_16x16x32_bf16 v[36:39], a[92:95], v[28:31], v[36:39]
  ds_read_b128 v[20:23], v74 offset:53248
  v_mfma_f32_16x16x32_bf16 v[40:43], a[92:95], v[32:35], v[40:43]
  ds_read_b128 v[24:27], v74 offset:55296
  v_mfma_f32_16x16x32_bf16 v[44:47], a[220:223], v[28:31], v[44:47]
  s_add_u32 m0, s34, 39680
  s_nop 0
  buffer_load_dwordx4 v1, s[4:7], s35 offen offset:1280 sc1 lds
  v_mfma_f32_16x16x32_bf16 v[48:51], a[220:223], v[32:35], v[48:51]
  s_waitcnt lgkmcnt(4)
  v_mfma_f32_16x16x32_bf16 v[36:39], a[96:99], v[4:7], v[36:39]
  ds_read_b128 v[28:31], v75 offset:53248
  v_mfma_f32_16x16x32_bf16 v[40:43], a[96:99], v[8:11], v[40:43]
  ds_read_b128 v[32:35], v75 offset:55296
  v_mfma_f32_16x16x32_bf16 v[44:47], a[224:227], v[4:7], v[44:47]
  s_add_u32 m0, s34, 43648
  s_nop 0
  buffer_load_dwordx4 v1, s[4:7], s35 offen offset:1408 sc1 lds
  v_mfma_f32_16x16x32_bf16 v[48:51], a[224:227], v[8:11], v[48:51]
  s_waitcnt lgkmcnt(4)
  v_mfma_f32_16x16x32_bf16 v[36:39], a[100:103], v[12:15], v[36:39]
  ds_read_b128 v[4:7], v74 offset:57344
  v_mfma_f32_16x16x32_bf16 v[40:43], a[100:103], v[16:19], v[40:43]
  ds_read_b128 v[8:11], v74 offset:59392
  v_mfma_f32_16x16x32_bf16 v[44:47], a[228:231], v[12:15], v[44:47]
  s_add_u32 m0, s34, 47616
  s_nop 0
  buffer_load_dwordx4 v1, s[4:7], s35 offen offset:1536 sc1 lds
  v_mfma_f32_16x16x32_bf16 v[48:51], a[228:231], v[16:19], v[48:51]
  s_waitcnt lgkmcnt(4)
  v_mfma_f32_16x16x32_bf16 v[36:39], a[104:107], v[20:23], v[36:39]
  ds_read_b128 v[12:15], v75 offset:57344
  v_mfma_f32_16x16x32_bf16 v[40:43], a[104:107], v[24:27], v[40:43]
  ds_read_b128 v[16:19], v75 offset:59392
  v_mfma_f32_16x16x32_bf16 v[44:47], a[232:235], v[20:23], v[44:47]
  s_add_u32 m0, s34, 51584
  s_nop 0
  buffer_load_dwordx4 v1, s[4:7], s35 offen offset:1664 sc1 lds
  v_mfma_f32_16x16x32_bf16 v[48:51], a[232:235], v[24:27], v[48:51]
  s_waitcnt lgkmcnt(4)
  v_mfma_f32_16x16x32_bf16 v[36:39], a[108:111], v[28:31], v[36:39]
  ds_read_b128 v[20:23], v74 offset:61440
  v_mfma_f32_16x16x32_bf16 v[40:43], a[108:111], v[32:35], v[40:43]
  ds_read_b128 v[24:27], v74 offset:63488
  v_mfma_f32_16x16x32_bf16 v[44:47], a[236:239], v[28:31], v[44:47]
  s_add_u32 m0, s34, 55552
  s_nop 0
  buffer_load_dwordx4 v1, s[4:7], s35 offen offset:1792 sc1 lds
  v_mfma_f32_16x16x32_bf16 v[48:51], a[236:239], v[32:35], v[48:51]
  s_waitcnt lgkmcnt(4)
  v_mfma_f32_16x16x32_bf16 v[36:39], a[112:115], v[4:7], v[36:39]
  ds_read_b128 v[28:31], v75 offset:61440
  v_mfma_f32_16x16x32_bf16 v[40:43], a[112:115], v[8:11], v[40:43]
  ds_read_b128 v[32:35], v75 offset:63488
  v_mfma_f32_16x16x32_bf16 v[44:47], a[240:243], v[4:7], v[44:47]
  s_add_u32 m0, s34, 59520
  s_nop 0
  buffer_load_dwordx4 v1, s[4:7], s35 offen offset:1920 sc1 lds
  v_mfma_f32_16x16x32_bf16 v[48:51], a[240:243], v[8:11], v[48:51]
  s_waitcnt lgkmcnt(4)
  v_mfma_f32_16x16x32_bf16 v[36:39], a[116:119], v[12:15], v[36:39]
  v_mfma_f32_16x16x32_bf16 v[40:43], a[116:119], v[16:19], v[40:43]
  v_mfma_f32_16x16x32_bf16 v[44:47], a[244:247], v[12:15], v[44:47]
  v_mfma_f32_16x16x32_bf16 v[48:51], a[244:247], v[16:19], v[48:51]
  s_waitcnt lgkmcnt(2)
  v_mfma_f32_16x16x32_bf16 v[36:39], a[120:123], v[20:23], v[36:39]
  v_mfma_f32_16x16x32_bf16 v[40:43], a[120:123], v[24:27], v[40:43]
  v_mfma_f32_16x16x32_bf16 v[44:47], a[248:251], v[20:23], v[44:47]
  v_mfma_f32_16x16x32_bf16 v[48:51], a[248:251], v[24:27], v[48:51]
  s_waitcnt lgkmcnt(0)
  v_mfma_f32_16x16x32_bf16 v[36:39], a[124:127], v[28:31], v[36:39]
  v_mfma_f32_16x16x32_bf16 v[40:43], a[124:127], v[32:35], v[40:43]
  v_mfma_f32_16x16x32_bf16 v[44:47], a[252:255], v[28:31], v[44:47]
  v_mfma_f32_16x16x32_bf16 v[48:51], a[252:255], v[32:35], v[48:51]
  s_nop 7
  s_branch L_F1_epi
L_F1_nopf:
  s_waitcnt lgkmcnt(4)
  v_mfma_f32_16x16x32_bf16 v[36:39], a[52:55], v[12:15], v[36:39]
  ds_read_b128 v[4:7], v74 offset:32768
  v_mfma_f32_16x16x32_bf16 v[40:43], a[52:55], v[16:19], v[40:43]
  ds_read_b128 v[8:11], v74 offset:34816
  v_mfma_f32_16x16x32_bf16 v[44:47], a[180:183], v[12:15], v[44:47]
  v_mfma_f32_16x16x32_bf16 v[48:51], a[180:183], v[16:19], v[48:51]
  s_waitcnt lgkmcnt(4)
  v_mfma_f32_16x16x32_bf16 v[36:39], a[56:59], v[20:23], v[36:39]
  ds_read_b128 v[12:15], v75 offset:32768
  v_mfma_f32_16x16x32_bf16 v[40:43], a[56:59], v[24:27], v[40:43]
  ds_read_b128 v[16:19], v75 offset:34816
  v_mfma_f32_16x16x32_bf16 v[44:47], a[184:187], v[20:23], v[44:47]
  v_mfma_f32_16x16x32_bf16 v[48:51], a[184:187], v[24:27], v[48:51]
  s_waitcnt lgkmcnt(4)
  v_mfma_f32_16x16x32_bf16 v[36:39], a[60:63], v[28:31], v[36:39]
  ds_read_b128 v[20:23], v74 offset:36864
  v_mfma_f32_16x16x32_bf16 v[40:43], a[60:63], v[32:35], v[40:43]
  ds_read_b128 v[24:27], v74 offset:38912
  v_mfma_f32_16x16x32_bf16 v[44:47], a[188:191], v[28:31], v[44:47]
  v_mfma_f32_16x16x32_bf16 v[48:51], a[188:191], v[32:35], v[48:51]
  s_waitcnt lgkmcnt(4)
  v_mfma_f32_16x16x32_bf16 v[36:39], a[64:67], v[4:7], v[36:39]
  ds_read_b128 v[28:31], v75 offset:36864
  v_mfma_f32_16x16x32_bf16 v[40:43], a[64:67], v[8:11], v[40:43]
  ds_read_b128 v[32:35], v75 offset:38912
  v_mfma_f32_16x16x32_bf16 v[44:47], a[192:195], v[4:7], v[44:47]
  v_mfma_f32_16x16x32_bf16 v[48:51], a[192:195], v[8:11], v[48:51]
  s_waitcnt lgkmcnt(4)
  v_mfma_f32_16x16x32_bf16 v[36:39], a[68:71], v[12:15], v[36:39]
  ds_read_b128 v[4:7], v74 offset:40960
  v_mfma_f32_16x16x32_bf16 v[40:43], a[68:71], v[16:19], v[40:43]
  ds_read_b128 v[8:11], v74 offset:43008
  v_mfma_f32_16x16x32_bf16 v[44:47], a[196:199], v[12:15], v[44:47]
  v_mfma_f32_16x16x32_bf16 v[48:51], a[196:199], v[16:19], v[48:51]
  s_waitcnt lgkmcnt(4)
  v_mfma_f32_16x16x32_bf16 v[36:39], a[72:75], v[20:23], v[36:39]
  ds_read_b128 v[12:15], v75 offset:40960
  v_mfma_f32_16x16x32_bf16 v[40:43], a[72:75], v[24:27], v[40:43]
  ds_read_b128 v[16:19], v75 offset:43008
  v_mfma_f32_16x16x32_bf16 v[44:47], a[200:203], v[20:23], v[44:47]
  v_mfma_f32_16x16x32_bf16 v[48:51], a[200:203], v[24:27], v[48:51]
  s_waitcnt lgkmcnt(4)
  v_mfma_f32_16x16x32_bf16 v[36:39], a[76:79], v[28:31], v[36:39]
  ds_read_b128 v[20:23], v74 offset:45056
  v_mfma_f32_16x16x32_bf16 v[40:43], a[76:79], v[32:35], v[40:43]
  ds_read_b128 v[24:27], v74 offset:47104
  v_mfma_f32_16x16x32_bf16 v[44:47], a[204:207], v[28:31], v[44:47]
  v_mfma_f32_16x16x32_bf16 v[48:51], a[204:207], v[32:35], v[48:51]
  s_waitcnt lgkmcnt(4)
  v_mfma_f32_16x16x32_bf16 v[36:39], a[80:83], v[4:7], v[36:39]
  ds_read_b128 v[28:31], v75 offset:45056
  v_mfma_f32_16x16x32_bf16 v[40:43], a[80:83], v[8:11], v[40:43]
  ds_read_b128 v[32:35], v75 offset:47104
  v_mfma_f32_16x16x32_bf16 v[44:47], a[208:211], v[4:7], v[44:47]
  v_mfma_f32_16x16x32_bf16 v[48:51], a[208:211], v[8:11], v[48:51]
  s_waitcnt lgkmcnt(4)
  v_mfma_f32_16x16x32_bf16 v[36:39], a[84:87], v[12:15], v[36:39]
  ds_read_b128 v[4:7], v74 offset:49152
  v_mfma_f32_16x16x32_bf16 v[40:43], a[84:87], v[16:19], v[40:43]
  ds_read_b128 v[8:11], v74 offset:51200
  v_mfma_f32_16x16x32_bf16 v[44:47], a[212:215], v[12:15], v[44:47]
  v_mfma_f32_16x16x32_bf16 v[48:51], a[212:215], v[16:19], v[48:51]
  s_waitcnt lgkmcnt(4)
  v_mfma_f32_16x16x32_bf16 v[36:39], a[88:91], v[20:23], v[36:39]
  ds_read_b128 v[12:15], v75 offset:49152
  v_mfma_f32_16x16x32_bf16 v[40:43], a[88:91], v[24:27], v[40:43]
  ds_read_b128 v[16:19], v75 offset:51200
  v_mfma_f32_16x16x32_bf16 v[44:47], a[216:219], v[20:23], v[44:47]
  v_mfma_f32_16x16x32_bf16 v[48:51], a[216:219], v[24:27], v[48:51]
  s_waitcnt lgkmcnt(4)
  v_mfma_f32_16x16x32_bf16 v[36:39], a[92:95], v[28:31], v[36:39]
  ds_read_b128 v[20:23], v74 offset:53248
  v_mfma_f32_16x16x32_bf16 v[40:43], a[92:95], v[32:35], v[40:43]
  ds_read_b128 v[24:27], v74 offset:55296
  v_mfma_f32_16x16x32_bf16 v[44:47], a[220:223], v[28:31], v[44:47]
  v_mfma_f32_16x16x32_bf16 v[48:51], a[220:223], v[32:35], v[48:51]
  s_waitcnt lgkmcnt(4)
  v_mfma_f32_16x16x32_bf16 v[36:39], a[96:99], v[4:7], v[36:39]
  ds_read_b128 v[28:31], v75 offset:53248
  v_mfma_f32_16x16x32_bf16 v[40:43], a[96:99], v[8:11], v[40:43]
  ds_read_b128 v[32:35], v75 offset:55296
  v_mfma_f32_16x16x32_bf16 v[44:47], a[224:227], v[4:7], v[44:47]
  v_mfma_f32_16x16x32_bf16 v[48:51], a[224:227], v[8:11], v[48:51]
  s_waitcnt lgkmcnt(4)
  v_mfma_f32_16x16x32_bf16 v[36:39], a[100:103], v[12:15], v[36:39]
  ds_read_b128 v[4:7], v74 offset:57344
  v_mfma_f32_16x16x32_bf16 v[40:43], a[100:103], v[16:19], v[40:43]
  ds_read_b128 v[8:11], v74 offset:59392
  v_mfma_f32_16x16x32_bf16 v[44:47], a[228:231], v[12:15], v[44:47]
  v_mfma_f32_16x16x32_bf16 v[48:51], a[228:231], v[16:19], v[48:51]
  s_waitcnt lgkmcnt(4)
  v_mfma_f32_16x16x32_bf16 v[36:39], a[104:107], v[20:23], v[36:39]
  ds_read_b128 v[12:15], v75 offset:57344
  v_mfma_f32_16x16x32_bf16 v[40:43], a[104:107], v[24:27], v[40:43]
  ds_read_b128 v[16:19], v75 offset:59392
  v_mfma_f32_16x16x32_bf16 v[44:47], a[232:235], v[20:23], v[44:47]
  v_mfma_f32_16x16x32_bf16 v[48:51], a[232:235], v[24:27], v[48:51]
  s_waitcnt lgkmcnt(4)
  v_mfma_f32_16x16x32_bf16 v[36:39], a[108:111], v[28:31], v[36:39]
  ds_read_b128 v[20:23], v74 offset:61440
  v_mfma_f32_16x16x32_bf16 v[40:43], a[108:111], v[32:35], v[40:43]
  ds_read_b128 v[24:27], v74 offset:63488
  v_mfma_f32_16x16x32_bf16 v[44:47], a[236:239], v[28:31], v[44:47]
  v_mfma_f32_16x16x32_bf16 v[48:51], a[236:239], v[32:35], v[48:51]
  s_waitcnt lgkmcnt(4)
  v_mfma_f32_16x16x32_bf16 v[36:39], a[112:115], v[4:7], v[36:39]
  ds_read_b128 v[28:31], v75 offset:61440
  v_mfma_f32_16x16x32_bf16 v[40:43], a[112:115], v[8:11], v[40:43]
  ds_read_b128 v[32:35], v75 offset:63488
  v_mfma_f32_16x16x32_bf16 v[44:47], a[240:243], v[4:7], v[44:47]
  v_mfma_f32_16x16x32_bf16 v[48:51], a[240:243], v[8:11], v[48:51]
  s_waitcnt lgkmcnt(4)
  v_mfma_f32_16x16x32_bf16 v[36:39], a[116:119], v[12:15], v[36:39]
  v_mfma_f32_16x16x32_bf16 v[40:43], a[116:119], v[16:19], v[40:43]
  v_mfma_f32_16x16x32_bf16 v[44:47], a[244:247], v[12:15], v[44:47]
  v_mfma_f32_16x16x32_bf16 v[48:51], a[244:247], v[16:19], v[48:51]
  s_waitcnt lgkmcnt(2)
  v_mfma_f32_16x16x32_bf16 v[36:39], a[120:123], v[20:23], v[36:39]
  v_mfma_f32_16x16x32_bf16 v[40:43], a[120:123], v[24:27], v[40:43]
  v_mfma_f32_16x16x32_bf16 v[44:47], a[248:251], v[20:23], v[44:47]
  v_mfma_f32_16x16x32_bf16 v[48:51], a[248:251], v[24:27], v[48:51]
  s_waitcnt lgkmcnt(0)
  v_mfma_f32_16x16x32_bf16 v[36:39], a[124:127], v[28:31], v[36:39]
  v_mfma_f32_16x16x32_bf16 v[40:43], a[124:127], v[32:35], v[40:43]
  v_mfma_f32_16x16x32_bf16 v[44:47], a[252:255], v[28:31], v[44:47]
  v_mfma_f32_16x16x32_bf16 v[48:51], a[252:255], v[32:35], v[48:51]
L_F1_epi:
  s_nop 4
  v_mul_f32 v52, s37, v36
  v_mul_f32 v53, s37, v37
  v_mul_f32 v54, s37, v38
  v_mul_f32 v55, s37, v39
  v_mul_f32 v56, s37, v40
  v_mul_f32 v57, s37, v41
  v_mul_f32 v58, s37, v42
  v_mul_f32 v59, s37, v43
  v_exp_f32 v52, v52
  v_exp_f32 v53, v53
  v_exp_f32 v54, v54
  v_exp_f32 v55, v55
  v_exp_f32 v56, v56
  v_exp_f32 v57, v57
  v_exp_f32 v58, v58
  v_exp_f32 v59, v59
  v_pk_mul_f32 v[36:37], v[36:37], v[44:45]
  v_pk_mul_f32 v[38:39], v[38:39], v[46:47]
  v_pk_mul_f32 v[40:41], v[40:41], v[48:49]
  v_pk_mul_f32 v[42:43], v[42:43], v[50:51]
  v_add_f32 v52, 1.0, v52
  v_add_f32 v53, 1.0, v53
  v_add_f32 v54, 1.0, v54
  v_add_f32 v55, 1.0, v55
  v_add_f32 v56, 1.0, v56
  v_add_f32 v57, 1.0, v57
  v_add_f32 v58, 1.0, v58
  v_add_f32 v59, 1.0, v59
  v_rcp_f32 v52, v52
  v_rcp_f32 v53, v53
  v_rcp_f32 v54, v54
  v_rcp_f32 v55, v55
  v_rcp_f32 v56, v56
  v_rcp_f32 v57, v57
  v_rcp_f32 v58, v58
  v_rcp_f32 v59, v59
  v_pk_mul_f32 v[36:37], v[36:37], v[52:53]
  v_pk_mul_f32 v[38:39], v[38:39], v[54:55]
  v_pk_mul_f32 v[40:41], v[40:41], v[56:57]
  v_pk_mul_f32 v[42:43], v[42:43], v[58:59]
  v_cvt_pk_bf16_f32 v60, v36, v37
  v_cvt_pk_bf16_f32 v61, v38, v39
  v_cvt_pk_bf16_f32 v62, v40, v41
  v_cvt_pk_bf16_f32 v63, v42, v43
  s_nop 0
  v_permlane32_swap_b32 v60, v62
  v_permlane32_swap_b32 v61, v63
  buffer_store_dwordx4 v[60:63], v68, s[4:7], s31 offen sc1
  s_add_u32 s25, s25, 1
  s_add_u32 s31, s31, 229376
  s_branch L_F1_top
L_F2:
  s_load_dwordx2 s[8:9], s[0:1], 80
  s_mov_b32 s10, 7340032
  s_mov_b32 s11, 0x20000
  s_waitcnt lgkmcnt(0)
  s_lshr_b32 s44, s21, 3
  s_mul_i32 s44, s44, 2424832
  s_and_b32 s45, s21, 7
  s_lshl_b32 s45, s45, 8
  s_add_u32 s44, s44, s45
  s_add_u32 s45, s44, 128
  v_bfe_u32 v40, v0, 5, 1
  v_mul_u32_u24 v40, 8192, v40
  v_bfe_u32 v41, v0, 4, 1
  v_mul_u32_u24 v41, 4096, v41
  v_add_u32 v40, v40, v41
  v_bfe_u32 v41, v0, 3, 1
  v_mul_u32_u24 v41, 2048, v41
  v_add_u32 v40, v40, v41
  v_lshrrev_b32 v41, 3, v0
  v_and_b32 v41, 6, v41
  v_xor_b32 v41, v41, v0
  v_and_b32 v41, 7, v41
  v_lshl_add_u32 v40, v41, 4, v40
  s_lshr_b32 s40, s20, 1
  s_mul_i32 s40, s40, 16384
  s_and_b32 s41, s20, 1
  s_mul_i32 s41, s41, 32768
  s_add_u32 s40, s40, s41
  v_add_u32 v40, s40, v40
  v_bfe_u32 v41, v0, 3, 2
  v_xor_b32 v41, s20, v41
  v_lshlrev_b32 v41, 5, v41
  v_lshrrev_b32 v42, 2, v0
  v_lshl_add_u32 v42, v42, 7, v41
  v_and_b32 v41, 3, v0
  v_lshl_add_u32 v42, v41, 3, v42
  v_add_u32 v43, 0x10000, v42
  v_add_u32 v44, s44, v40
  v_add_u32 v45, s45, v40
  s_lshl_b32 s41, s20, 10
  s_add_u32 m0, s41, 0
  s_mov_b32 s42, 0
  buffer_load_dwordx4 v44, s[8:11], s42 offen lds
  s_add_u32 m0, s41, 4096
  s_mov_b32 s42, 65536
  buffer_load_dwordx4 v44, s[8:11], s42 offen lds
  s_add_u32 m0, s41, 8192
  s_mov_b32 s42, 131072
  buffer_load_dwordx4 v44, s[8:11], s42 offen lds
  s_add_u32 m0, s41, 12288
  s_mov_b32 s42, 196608
  buffer_load_dwordx4 v44, s[8:11], s42 offen lds
  s_add_u32 m0, s41, 16384
  s_mov_b32 s42, 262144
  buffer_load_dwordx4 v44, s[8:11], s42 offen lds
  s_add_u32 m0, s41, 20480
  s_mov_b32 s42, 327680
  buffer_load_dwordx4 v44, s[8:11], s42 offen lds
  s_add_u32 m0, s41, 24576
  s_mov_b32 s42, 393216
  buffer_load_dwordx4 v44, s[8:11], s42 offen lds
  s_add_u32 m0, s41, 28672
  s_mov_b32 s42, 458752
  buffer_load_dwordx4 v44, s[8:11], s42 offen lds
  s_add_u32 m0, s41, 32768
  s_mov_b32 s42, 524288
  buffer_load_dwordx4 v44, s[8:11], s42 offen lds
  s_add_u32 m0, s41, 36864
  s_mov_b32 s42, 589824
  buffer_load_dwordx4 v44, s[8:11], s42 offen lds
  s_add_u32 m0, s41, 40960
  s_mov_b32 s42, 655360
  buffer_load_dwordx4 v44, s[8:11], s42 offen lds
  s_add_u32 m0, s41, 45056
  s_mov_b32 s42, 720896
  buffer_load_dwordx4 v44, s[8:11], s42 offen lds
  s_add_u32 m0, s41, 49152
  s_mov_b32 s42, 786432
  buffer_load_dwordx4 v44, s[8:11], s42 offen lds
  s_add_u32 m0, s41, 53248
  s_mov_b32 s42, 851968
  buffer_load_dwordx4 v44, s[8:11], s42 offen lds
  s_add_u32 m0, s41, 57344
  s_mov_b32 s42, 917504
  buffer_load_dwordx4 v44, s[8:11], s42 offen lds
  s_add_u32 m0, s41, 61440
  s_mov_b32 s42, 983040
  buffer_load_dwordx4 v44, s[8:11], s42 offen lds
  s_add_u32 m0, s41, 65536
  s_mov_b32 s42, 1048576
  buffer_load_dwordx4 v44, s[8:11], s42 offen lds
  s_add_u32 m0, s41, 69632
  s_mov_b32 s42, 1114112
  buffer_load_dwordx4 v44, s[8:11], s42 offen lds
  s_add_u32 m0, s41, 73728
  s_mov_b32 s42, 1179648
  buffer_load_dwordx4 v44, s[8:11], s42 offen lds
  s_add_u32 m0, s41, 77824
  s_mov_b32 s42, 1245184
  buffer_load_dwordx4 v44, s[8:11], s42 offen lds
  s_add_u32 m0, s41, 81920
  s_mov_b32 s42, 1310720
  buffer_load_dwordx4 v44, s[8:11], s42 offen lds
  s_add_u32 m0, s41, 86016
  s_mov_b32 s42, 1376256
  buffer_load_dwordx4 v44, s[8:11], s42 offen lds
  s_add_u32 m0, s41, 90112
  s_mov_b32 s42, 1441792
  buffer_load_dwordx4 v44, s[8:11], s42 offen lds
  s_add_u32 m0, s41, 94208
  s_mov_b32 s42, 1507328
  buffer_load_dwordx4 v44, s[8:11], s42 offen lds
  s_add_u32 m0, s41, 98304
  s_mov_b32 s42, 1572864
  buffer_load_dwordx4 v44, s[8:11], s42 offen lds
  s_add_u32 m0, s41, 102400
  s_mov_b32 s42, 1638400
  buffer_load_dwordx4 v44, s[8:11], s42 offen lds
  s_add_u32 m0, s41, 106496
  s_mov_b32 s42, 1703936
  buffer_load_dwordx4 v44, s[8:11], s42 offen lds
  s_add_u32 m0, s41, 110592
  s_mov_b32 s42, 1769472
  buffer_load_dwordx4 v44, s[8:11], s42 offen lds
  s_waitcnt vmcnt(24) lgkmcnt(0)
  s_barrier
  s_add_u32 m0, s41, 114688
  s_mov_b32 s42, 1835008
  buffer_load_dwordx4 v44, s[8:11], s42 offen lds
  s_add_u32 m0, s41, 118784
  s_mov_b32 s42, 1900544
  buffer_load_dwordx4 v44, s[8:11], s42 offen lds
  s_add_u32 m0, s41, 122880
  s_mov_b32 s42, 1966080
  buffer_load_dwordx4 v44, s[8:11], s42 offen lds
  s_add_u32 m0, s41, 126976
  s_mov_b32 s42, 2031616
  buffer_load_dwordx4 v44, s[8:11], s42 offen lds
  ds_read_b64_tr_b16 a[0:1], v42 offset:0
  ds_read_b64_tr_b16 a[2:3], v42 offset:2048
  ds_read_b64_tr_b16 a[4:5], v42 offset:4096
  ds_read_b64_tr_b16 a[6:7], v42 offset:6144
  ds_read_b64_tr_b16 a[8:9], v42 offset:8192
  ds_read_b64_tr_b16 a[10:11], v42 offset:10240
  ds_read_b64_tr_b16 a[12:13], v42 offset:12288
  ds_read_b64_tr_b16 a[14:15], v42 offset:14336
  s_waitcnt vmcnt(24) lgkmcnt(0)
  s_barrier
  s_add_u32 m0, s41, 0
  s_mov_b32 s42, 2097152
  buffer_load_dwordx4 v44, s[8:11], s42 offen lds
  s_add_u32 m0, s41, 4096
  s_mov_b32 s42, 2162688
  buffer_load_dwordx4 v44, s[8:11], s42 offen lds
  s_add_u32 m0, s41, 8192
  s_mov_b32 s42, 2228224
  buffer_load_dwordx4 v44, s[8:11], s42 offen lds
  s_add_u32 m0, s41, 12288
  s_mov_b32 s42, 2293760
  buffer_load_dwordx4 v44, s[8:11], s42 offen lds
  ds_read_b64_tr_b16 a[16:17], v42 offset:16384
  ds_read_b64_tr_b16 a[18:19], v42 offset:18432
  ds_read_b64_tr_b16 a[20:21], v42 offset:20480
  ds_read_b64_tr_b16 a[22:23], v42 offset:22528
  ds_read_b64_tr_b16 a[24:25], v42 offset:24576
  ds_read_b64_tr_b16 a[26:27], v42 offset:26624
  ds_read_b64_tr_b16 a[28:29], v42 offset:28672
  ds_read_b64_tr_b16 a[30:31], v42 offset:30720
  s_waitcnt vmcnt(24) lgkmcnt(0)
  s_barrier
  s_add_u32 m0, s41, 16384
  s_mov_b32 s42, 2359296
  buffer_load_dwordx4 v44, s[8:11], s42 offen lds
  s_add_u32 m0, s41, 20480
  s_mov_b32 s42, 2424832
  buffer_load_dwordx4 v44, s[8:11], s42 offen lds
  s_add_u32 m0, s41, 24576
  s_mov_b32 s42, 0
  buffer_load_dwordx4 v45, s[8:11], s42 offen lds
  s_add_u32 m0, s41, 28672
  s_mov_b32 s42, 65536
  buffer_load_dwordx4 v45, s[8:11], s42 offen lds
  ds_read_b64_tr_b16 a[32:33], v42 offset:32768
  ds_read_b64_tr_b16 a[34:35], v42 offset:34816
  ds_read_b64_tr_b16 a[36:37], v42 offset:36864
  ds_read_b64_tr_b16 a[38:39], v42 offset:38912
  ds_read_b64_tr_b16 a[40:41], v42 offset:40960
  ds_read_b64_tr_b16 a[42:43], v42 offset:43008
  ds_read_b64_tr_b16 a[44:45], v42 offset:45056
  ds_read_b64_tr_b16 a[46:47], v42 offset:47104
  s_waitcnt vmcnt(24) lgkmcnt(0)
  s_barrier
  s_add_u32 m0, s41, 32768
  s_mov_b32 s42, 131072
  buffer_load_dwordx4 v45, s[8:11], s42 offen lds
  s_add_u32 m0, s41, 36864
  s_mov_b32 s42, 196608
  buffer_load_dwordx4 v45, s[8:11], s42 offen lds
  s_add_u32 m0, s41, 40960
  s_mov_b32 s42, 262144
  buffer_load_dwordx4 v45, s[8:11], s42 offen lds
  s_add_u32 m0, s41, 45056
  s_mov_b32 s42, 327680
  buffer_load_dwordx4 v45, s[8:11], s42 offen lds
  ds_read_b64_tr_b16 a[48:49], v42 offset:49152
  ds_read_b64_tr_b16 a[50:51], v42 offset:51200
  ds_read_b64_tr_b16 a[52:53], v42 offset:53248
  ds_read_b64_tr_b16 a[54:55], v42 offset:55296
  ds_read_b64_tr_b16 a[56:57], v42 offset:57344
  ds_read_b64_tr_b16 a[58:59], v42 offset:59392
  ds_read_b64_tr_b16 a[60:61], v42 offset:61440
  ds_read_b64_tr_b16 a[62:63], v42 offset:63488
  s_waitcnt vmcnt(24) lgkmcnt(0)
  s_barrier
  s_add_u32 m0, s41, 49152
  s_mov_b32 s42, 393216
  buffer_load_dwordx4 v45, s[8:11], s42 offen lds
  s_add_u32 m0, s41, 53248
  s_mov_b32 s42, 458752
  buffer_load_dwordx4 v45, s[8:11], s42 offen lds
  s_add_u32 m0, s41, 57344
  s_mov_b32 s42, 524288
  buffer_load_dwordx4 v45, s[8:11], s42 offen lds
  s_add_u32 m0, s41, 61440
  s_mov_b32 s42, 589824
  buffer_load_dwordx4 v45, s[8:11], s42 offen lds
  ds_read_b64_tr_b16 a[64:65], v43 offset:0
  ds_read_b64_tr_b16 a[66:67], v43 offset:2048
  ds_read_b64_tr_b16 a[68:69], v43 offset:4096
  ds_read_b64_tr_b16 a[70:71], v43 offset:6144
  ds_read_b64_tr_b16 a[72:73], v43 offset:8192
  ds_read_b64_tr_b16 a[74:75], v43 offset:10240
  ds_read_b64_tr_b16 a[76:77], v43 offset:12288
  ds_read_b64_tr_b16 a[78:79], v43 offset:14336
  s_waitcnt vmcnt(24) lgkmcnt(0)
  s_barrier
  s_add_u32 m0, s41, 65536
  s_mov_b32 s42, 655360
  buffer_load_dwordx4 v45, s[8:11], s42 offen lds
  s_add_u32 m0, s41, 69632
  s_mov_b32 s42, 720896
  buffer_load_dwordx4 v45, s[8:11], s42 offen lds
  s_add_u32 m0, s41, 73728
  s_mov_b32 s42, 786432
  buffer_load_dwordx4 v45, s[8:11], s42 offen lds
  s_add_u32 m0, s41, 77824
  s_mov_b32 s42, 851968
  buffer_load_dwordx4 v45, s[8:11], s42 offen lds
  ds_read_b64_tr_b16 a[80:81], v43 offset:16384
  ds_read_b64_tr_b16 a[82:83], v43 offset:18432
  ds_read_b64_tr_b16 a[84:85], v43 offset:20480
  ds_read_b64_tr_b16 a[86:87], v43 offset:22528
  ds_read_b64_tr_b16 a[88:89], v43 offset:24576
  ds_read_b64_tr_b16 a[90:91], v43 offset:26624
  ds_read_b64_tr_b16 a[92:93], v43 offset:28672
  ds_read_b64_tr_b16 a[94:95], v43 offset:30720
  s_waitcnt vmcnt(24) lgkmcnt(0)
  s_barrier
  s_add_u32 m0, s41, 81920
  s_mov_b32 s42, 917504
  buffer_load_dwordx4 v45, s[8:11], s42 offen lds
  s_add_u32 m0, s41, 86016
  s_mov_b32 s42, 983040
  buffer_load_dwordx4 v45, s[8:11], s42 offen lds
  s_add_u32 m0, s41, 90112
  s_mov_b32 s42, 1048576
  buffer_load_dwordx4 v45, s[8:11], s42 offen lds
  s_add_u32 m0, s41, 94208
  s_mov_b32 s42, 1114112
  buffer_load_dwordx4 v45, s[8:11], s42 offen lds
  ds_read_b64_tr_b16 a[96:97], v43 offset:32768
  ds_read_b64_tr_b16 a[98:99], v43 offset:34816
  ds_read_b64_tr_b16 a[100:101], v43 offset:36864
  ds_read_b64_tr_b16 a[102:103], v43 offset:38912
  ds_read_b64_tr_b16 a[104:105], v43 offset:40960
  ds_read_b64_tr_b16 a[106:107], v43 offset:43008
  ds_read_b64_tr_b16 a[108:109], v43 offset:45056
  ds_read_b64_tr_b16 a[110:111], v43 offset:47104
  s_waitcnt vmcnt(24) lgkmcnt(0)
  s_barrier
  s_add_u32 m0, s41, 98304
  s_mov_b32 s42, 1179648
  buffer_load_dwordx4 v45, s[8:11], s42 offen lds
  s_add_u32 m0, s41, 102400
  s_mov_b32 s42, 1245184
  buffer_load_dwordx4 v45, s[8:11], s42 offen lds
  s_add_u32 m0, s41, 106496
  s_mov_b32 s42, 1310720
  buffer_load_dwordx4 v45, s[8:11], s42 offen lds
  s_add_u32 m0, s41, 110592
  s_mov_b32 s42, 1376256
  buffer_load_dwordx4 v45, s[8:11], s42 offen lds
  ds_read_b64_tr_b16 a[112:113], v43 offset:49152
  ds_read_b64_tr_b16 a[114:115], v43 offset:51200
  ds_read_b64_tr_b16 a[116:117], v43 offset:53248
  ds_read_b64_tr_b16 a[118:119], v43 offset:55296
  ds_read_b64_tr_b16 a[120:121], v43 offset:57344
  ds_read_b64_tr_b16 a[122:123], v43 offset:59392
  ds_read_b64_tr_b16 a[124:125], v43 offset:61440
  ds_read_b64_tr_b16 a[126:127], v43 offset:63488
  s_waitcnt vmcnt(24) lgkmcnt(0)
  s_barrier
  s_add_u32 m0, s41, 114688
  s_mov_b32 s42, 1441792
  buffer_load_dwordx4 v45, s[8:11], s42 offen lds
  s_add_u32 m0, s41, 118784
  s_mov_b32 s42, 1507328
  buffer_load_dwordx4 v45, s[8:11], s42 offen lds
  s_add_u32 m0, s41, 122880
  s_mov_b32 s42, 1572864
  buffer_load_dwordx4 v45, s[8:11], s42 offen lds
  s_add_u32 m0, s41, 126976
  s_mov_b32 s42, 1638400
  buffer_load_dwordx4 v45, s[8:11], s42 offen lds
  ds_read_b64_tr_b16 a[128:129], v42 offset:0
  ds_read_b64_tr_b16 a[130:131], v42 offset:2048
  ds_read_b64_tr_b16 a[132:133], v42 offset:4096
  ds_read_b64_tr_b16 a[134:135], v42 offset:6144
  ds_read_b64_tr_b16 a[136:137], v42 offset:8192
  ds_read_b64_tr_b16 a[138:139], v42 offset:10240
  ds_read_b64_tr_b16 a[140:141], v42 offset:12288
  ds_read_b64_tr_b16 a[142:143], v42 offset:14336
  s_waitcnt vmcnt(24) lgkmcnt(0)
  s_barrier
  s_add_u32 m0, s41, 0
  s_mov_b32 s42, 1703936
  buffer_load_dwordx4 v45, s[8:11], s42 offen lds
  s_add_u32 m0, s41, 4096
  s_mov_b32 s42, 1769472
  buffer_load_dwordx4 v45, s[8:11], s42 offen lds
  s_add_u32 m0, s41, 8192
  s_mov_b32 s42, 1835008
  buffer_load_dwordx4 v45, s[8:11], s42 offen lds
  s_add_u32 m0, s41, 12288
  s_mov_b32 s42, 1900544
  buffer_load_dwordx4 v45, s[8:11], s42 offen lds
  ds_read_b64_tr_b16 a[144:145], v42 offset:16384
  ds_read_b64_tr_b16 a[146:147], v42 offset:18432
  ds_read_b64_tr_b16 a[148:149], v42 offset:20480
  ds_read_b64_tr_b16 a[150:151], v42 offset:22528
  ds_read_b64_tr_b16 a[152:153], v42 offset:24576
  ds_read_b64_tr_b16 a[154:155], v42 offset:26624
  ds_read_b64_tr_b16 a[156:157], v42 offset:28672
  ds_read_b64_tr_b16 a[158:159], v42 offset:30720
  s_waitcnt vmcnt(24) lgkmcnt(0)
  s_barrier
  s_add_u32 m0, s41, 16384
  s_mov_b32 s42, 1966080
  buffer_load_dwordx4 v45, s[8:11], s42 offen lds
  s_add_u32 m0, s41, 20480
  s_mov_b32 s42, 2031616
  buffer_load_dwordx4 v45, s[8:11], s42 offen lds
  s_add_u32 m0, s41, 24576
  s_mov_b32 s42, 2097152
  buffer_load_dwordx4 v45, s[8:11], s42 offen lds
  s_add_u32 m0, s41, 28672
  s_mov_b32 s42, 2162688
  buffer_load_dwordx4 v45, s[8:11], s42 offen lds
  ds_read_b64_tr_b16 a[160:161], v42 offset:32768
  ds_read_b64_tr_b16 a[162:163], v42 offset:34816
  ds_read_b64_tr_b16 a[164:165], v42 offset:36864
  ds_read_b64_tr_b16 a[166:167], v42 offset:38912
  ds_read_b64_tr_b16 a[168:169], v42 offset:40960
  ds_read_b64_tr_b16 a[170:171], v42 offset:43008
  ds_read_b64_tr_b16 a[172:173], v42 offset:45056
  ds_read_b64_tr_b16 a[174:175], v42 offset:47104
  s_waitcnt vmcnt(24) lgkmcnt(0)
  s_barrier
  s_add_u32 m0, s41, 32768
  s_mov_b32 s42, 2228224
  buffer_load_dwordx4 v45, s[8:11], s42 offen lds
  s_add_u32 m0, s41, 36864
  s_mov_b32 s42, 2293760
  buffer_load_dwordx4 v45, s[8:11], s42 offen lds
  s_add_u32 m0, s41, 40960
  s_mov_b32 s42, 2359296
  buffer_load_dwordx4 v45, s[8:11], s42 offen lds
  s_add_u32 m0, s41, 45056
  s_mov_b32 s42, 2424832
  buffer_load_dwordx4 v45, s[8:11], s42 offen lds
  ds_read_b64_tr_b16 a[176:177], v42 offset:49152
  ds_read_b64_tr_b16 a[178:179], v42 offset:51200
  ds_read_b64_tr_b16 a[180:181], v42 offset:53248
  ds_read_b64_tr_b16 a[182:183], v42 offset:55296
  ds_read_b64_tr_b16 a[184:185], v42 offset:57344
  ds_read_b64_tr_b16 a[186:187], v42 offset:59392
  ds_read_b64_tr_b16 a[188:189], v42 offset:61440
  ds_read_b64_tr_b16 a[190:191], v42 offset:63488
  s_waitcnt vmcnt(24) lgkmcnt(0)
  s_barrier
  ds_read_b64_tr_b16 a[192:193], v43 offset:0
  ds_read_b64_tr_b16 a[194:195], v43 offset:2048
  ds_read_b64_tr_b16 a[196:197], v43 offset:4096
  ds_read_b64_tr_b16 a[198:199], v43 offset:6144
  ds_read_b64_tr_b16 a[200:201], v43 offset:8192
  ds_read_b64_tr_b16 a[202:203], v43 offset:10240
  ds_read_b64_tr_b16 a[204:205], v43 offset:12288
  ds_read_b64_tr_b16 a[206:207], v43 offset:14336
  s_waitcnt vmcnt(20) lgkmcnt(0)
  s_barrier
  ds_read_b64_tr_b16 a[208:209], v43 offset:16384
  ds_read_b64_tr_b16 a[210:211], v43 offset:18432
  ds_read_b64_tr_b16 a[212:213], v43 offset:20480
  ds_read_b64_tr_b16 a[214:215], v43 offset:22528
  ds_read_b64_tr_b16 a[216:217], v43 offset:24576
  ds_read_b64_tr_b16 a[218:219], v43 offset:26624
  ds_read_b64_tr_b16 a[220:221], v43 offset:28672
  ds_read_b64_tr_b16 a[222:223], v43 offset:30720
  s_waitcnt vmcnt(16) lgkmcnt(0)
  s_barrier
  ds_read_b64_tr_b16 a[224:225], v43 offset:32768
  ds_read_b64_tr_b16 a[226:227], v43 offset:34816
  ds_read_b64_tr_b16 a[228:229], v43 offset:36864
  ds_read_b64_tr_b16 a[230:231], v43 offset:38912
  ds_read_b64_tr_b16 a[232:233], v43 offset:40960
  ds_read_b64_tr_b16 a[234:235], v43 offset:43008
  ds_read_b64_tr_b16 a[236:237], v43 offset:45056
  ds_read_b64_tr_b16 a[238:239], v43 offset:47104
  s_waitcnt vmcnt(12) lgkmcnt(0)
  s_barrier
  ds_read_b64_tr_b16 a[240:241], v43 offset:49152
  ds_read_b64_tr_b16 a[242:243], v43 offset:51200
  ds_read_b64_tr_b16 a[244:245], v43 offset:53248
  ds_read_b64_tr_b16 a[246:247], v43 offset:55296
  ds_read_b64_tr_b16 a[248:249], v43 offset:57344
  ds_read_b64_tr_b16 a[250:251], v43 offset:59392
  ds_read_b64_tr_b16 a[252:253], v43 offset:61440
  ds_read_b64_tr_b16 a[254:255], v43 offset:63488
  s_waitcnt vmcnt(8) lgkmcnt(0)
  s_barrier
  ds_read_b64_tr_b16 v[128:129], v42 offset:0
  ds_read_b64_tr_b16 v[130:131], v42 offset:2048
  ds_read_b64_tr_b16 v[132:133], v42 offset:4096
  ds_read_b64_tr_b16 v[134:135], v42 offset:6144
  ds_read_b64_tr_b16 v[136:137], v42 offset:8192
  ds_read_b64_tr_b16 v[138:139], v42 offset:10240
  ds_read_b64_tr_b16 v[140:141], v42 offset:12288
  ds_read_b64_tr_b16 v[142:143], v42 offset:14336
  s_waitcnt vmcnt(4) lgkmcnt(0)
  s_barrier
  ds_read_b64_tr_b16 v[144:145], v42 offset:16384
  ds_read_b64_tr_b16 v[146:147], v42 offset:18432
  ds_read_b64_tr_b16 v[148:149], v42 offset:20480
  ds_read_b64_tr_b16 v[150:151], v42 offset:22528
  ds_read_b64_tr_b16 v[152:153], v42 offset:24576
  ds_read_b64_tr_b16 v[154:155], v42 offset:26624
  ds_read_b64_tr_b16 v[156:157], v42 offset:28672
  ds_read_b64_tr_b16 v[158:159], v42 offset:30720
  s_waitcnt vmcnt(0) lgkmcnt(0)
  s_barrier
  ds_read_b64_tr_b16 v[160:161], v42 offset:32768
  ds_read_b64_tr_b16 v[162:163], v42 offset:34816
  ds_read_b64_tr_b16 v[164:165], v42 offset:36864
  ds_read_b64_tr_b16 v[166:167], v42 offset:38912
  ds_read_b64_tr_b16 v[168:169], v42 offset:40960
  ds_read_b64_tr_b16 v[170:171], v42 offset:43008
  ds_read_b64_tr_b16 v[172:173], v42 offset:45056
  ds_read_b64_tr_b16 v[174:175], v42 offset:47104
  s_waitcnt lgkmcnt(0)
  s_barrier
  s_cmp_lt_u32 s21, 8
  s_cbranch_scc1 L_F2_keep
  v_accvgpr_write_b32 a0, 0
  v_accvgpr_write_b32 a1, 0
  v_accvgpr_write_b32 a2, 0
  v_accvgpr_write_b32 a3, 0
  v_accvgpr_write_b32 a152, 0
  v_accvgpr_write_b32 a153, 0
  v_accvgpr_write_b32 a154, 0
  v_accvgpr_write_b32 a155, 0
  s_nop 1
L_F2_keep:
  s_lshr_b32 s43, s21, 3
  s_mul_i32 s43, s43, 37
  s_lshr_b32 s44, s43, 1
  v_min_u32 v52, 19, v0
  v_add_u32 v52, s44, v52
  v_min_u32 v52, 55, v52
  v_lshlrev_b32 v52, 7, v52
  v_add_u32 v2, 1431552, v52
  s_lshl_b32 s40, s43, 11
  s_add_u32 s27, s40, 44040192
  s_lshl_b32 s40, s21, 7
  s_add_u32 s40, s40, 1438720
  v_mov_b32 v69, 2147483392
  s_mov_b64 exec, 1
  v_mov_b32 v69, s40
  s_mov_b64 exec, -1
  s_lshr_b32 s40, s21, 3
  s_lshl_b32 s40, s40, 17
  s_add_u32 s31, s40, 142606336
  s_and_b32 s40, s21, 7
  s_lshl_b32 s40, s40, 9
  s_lshl_b32 s41, s20, 6
  s_add_u32 s40, s40, s41
  v_and_b32 v52, 15, v0
  v_lshl_add_u32 v68, v52, 12, s40
  v_lshrrev_b32 v52, 4, v0
  v_lshl_add_u32 v68, v52, 4, v68
  v_add_u32 v76, 0x10000, v68
  v_lshlrev_b32 v1, 4, v0
  s_lshl_b32 s32, s20, 12
  s_mul_i32 s33, s20, 3072
  v_mov_b32 v70, v1
  v_add_u32 v71, 0x10000, v70
  s_lshl_b32 s40, s20, 2
  s_add_u32 s40, s40, 155648
  v_mov_b32 v72, s40
  v_mov_b32 v52, 0
  ds_write_b32 v72, v52
  s_mov_b32 s25, 0
  s_mov_b32 s26, 0
  s_mov_b32 s29, 1
  s_mov_b32 s30, 0
  s_waitcnt lgkmcnt(0)
  s_barrier
  s_branch L_F2_poll
L_F2_top:
  s_cmp_lg_u32 s28, 0
  s_cbranch_scc1 L_F2_go
  v_mov_b32 v52, s25
  v_and_b32 v53, 3, v0
  v_lshlrev_b32 v53, 2, v53
  v_add_u32 v53, 155648, v53
  s_waitcnt vmcnt(0)
  ds_write_b32 v72, v52
  ds_read_b32 v53, v53
  s_waitcnt lgkmcnt(0)
  v_cmp_gt_i32 vcc, s25, v53
  s_cbranch_vccnz L_F2_nosig
  buffer_store_dword v52, v69, s[4:7], 0 offen sc1
L_F2_nosig:
  s_cmp_ge_u32 s25, 64
  s_cbranch_scc1 L_END
L_F2_poll:
  s_nop 0
Lpoll_29:
  buffer_load_dword v3, v2, s[4:7], s30 offen sc1
  s_sub_u32 s24, s24, 1
  s_cbranch_scc1 L_FAIL
  s_waitcnt vmcnt(0)
  v_cmp_gt_i32 vcc, s29, v3
  s_cbranch_vccz Lpolld_30
  s_sleep 2
  s_branch Lpoll_29
Lpolld_30:
  s_mov_b32 s34, s26
  s_mov_b32 s35, s27
  s_add_u32 s36, s32, 0
  s_add_u32 m0, s34, s36
  s_add_u32 s36, s35, s36
  buffer_load_dwordx4 v1, s[4:7], s36 offen offset:0 sc1 lds
  buffer_load_dwordx4 v1, s[4:7], s36 offen offset:1024 sc1 lds
  buffer_load_dwordx4 v1, s[4:7], s36 offen offset:2048 sc1 lds
  buffer_load_dwordx4 v1, s[4:7], s36 offen offset:3072 sc1 lds
  s_add_u32 s36, s32, 16384
  s_add_u32 m0, s34, s36
  s_add_u32 s36, s35, s36
  buffer_load_dwordx4 v1, s[4:7], s36 offen offset:0 sc1 lds
  buffer_load_dwordx4 v1, s[4:7], s36 offen offset:1024 sc1 lds
  buffer_load_dwordx4 v1, s[4:7], s36 offen offset:2048 sc1 lds
  buffer_load_dwordx4 v1, s[4:7], s36 offen offset:3072 sc1 lds
  s_add_u32 s36, s32, 32768
  s_add_u32 m0, s34, s36
  s_add_u32 s36, s35, s36
  buffer_load_dwordx4 v1, s[4:7], s36 offen offset:0 sc1 lds
  buffer_load_dwordx4 v1, s[4:7], s36 offen offset:1024 sc1 lds
  buffer_load_dwordx4 v1, s[4:7], s36 offen offset:2048 sc1 lds
  buffer_load_dwordx4 v1, s[4:7], s36 offen offset:3072 sc1 lds
  s_add_u32 s36, s32, 49152
  s_add_u32 m0, s34, s36
  s_add_u32 s36, s35, s36
  buffer_load_dwordx4 v1, s[4:7], s36 offen offset:0 sc1 lds
  buffer_load_dwordx4 v1, s[4:7], s36 offen offset:1024 sc1 lds
  buffer_load_dwordx4 v1, s[4:7], s36 offen offset:2048 sc1 lds
  buffer_load_dwordx4 v1, s[4:7], s36 offen offset:3072 sc1 lds
  s_add_u32 s36, s33, 65536
  s_add_u32 m0, s34, s36
  s_add_u32 s36, s35, s36
  buffer_load_dwordx4 v1, s[4:7], s36 offen offset:0 sc1 lds
  buffer_load_dwordx4 v1, s[4:7], s36 offen offset:1024 sc1 lds
  buffer_load_dwordx4 v1, s[4:7], s36 offen offset:2048 sc1 lds
L_F2_go:
  v_add_u32 v74, s26, v70
  v_add_u32 v75, s26, v71
  s_sub_u32 s26, 77824, s26
  s_add_u32 s27, s27, 229376
  s_mov_b32 s34, s26
  s_mov_b32 s35, s27
  s_add_u32 s29, s29, 1
  s_waitcnt vmcnt(15) lgkmcnt(0)
  s_barrier
  ds_read_b128 v[4:7], v74 offset:0
  ds_read_b128 v[8:11], v74 offset:1024
  ds_read_b128 v[12:15], v74 offset:2048
  ds_read_b128 v[16:19], v74 offset:3072
  ds_read_b128 v[20:23], v74 offset:4096
  ds_read_b128 v[24:27], v74 offset:5120
  buffer_load_dword v3, v2, s[4:7], s30 offen sc1
  s_waitcnt lgkmcnt(4)
  v_mfma_f32_16x16x32_bf16 v[36:39], a[0:3], v[4:7], 0
  ds_read_b128 v[28:31], v74 offset:6144
  v_mfma_f32_16x16x32_bf16 v[40:43], a[0:3], v[8:11], 0
  ds_read_b128 v[32:35], v74 offset:7168
  v_mfma_f32_16x16x32_bf16 v[44:47], a[152:155], v[4:7], 0
  v_mfma_f32_16x16x32_bf16 v[48:51], a[152:155], v[8:11], 0
  s_waitcnt lgkmcnt(4)
  v_mfma_f32_16x16x32_bf16 v[36:39], a[4:7], v[12:15], v[36:39]
  ds_read_b128 v[4:7], v74 offset:8192
  v_mfma_f32_16x16x32_bf16 v[40:43], a[4:7], v[16:19], v[40:43]
  ds_read_b128 v[8:11], v74 offset:9216
  v_mfma_f32_16x16x32_bf16 v[44:47], a[156:159], v[12:15], v[44:47]
  v_mfma_f32_16x16x32_bf16 v[48:51], a[156:159], v[16:19], v[48:51]
  s_waitcnt lgkmcnt(4)
  v_mfma_f32_16x16x32_bf16 v[36:39], a[8:11], v[20:23], v[36:39]
  ds_read_b128 v[12:15], v74 offset:10240
  v_mfma_f32_16x16x32_bf16 v[40:43], a[8:11], v[24:27], v[40:43]
  ds_read_b128 v[16:19], v74 offset:11264
  v_mfma_f32_16x16x32_bf16 v[44:47], a[160:163], v[20:23], v[44:47]
  v_mfma_f32_16x16x32_bf16 v[48:51], a[160:163], v[24:27], v[48:51]
  s_waitcnt lgkmcnt(4)
  v_mfma_f32_16x16x32_bf16 v[36:39], a[12:15], v[28:31], v[36:39]
  ds_read_b128 v[20:23], v74 offset:12288
  v_mfma_f32_16x16x32_bf16 v[40:43], a[12:15], v[32:35], v[40:43]
  ds_read_b128 v[24:27], v74 offset:13312
  v_mfma_f32_16x16x32_bf16 v[44:47], a[164:167], v[28:31], v[44:47]
  v_mfma_f32_16x16x32_bf16 v[48:51], a[164:167], v[32:35], v[48:51]
  s_waitcnt lgkmcnt(4)
  v_mfma_f32_16x16x32_bf16 v[36:39], a[16:19], v[4:7], v[36:39]
  ds_read_b128 v[28:31], v74 offset:14336
  v_mfma_f32_16x16x32_bf16 v[40:43], a[16:19], v[8:11], v[40:43]
  ds_read_b128 v[32:35], v74 offset:15360
  v_mfma_f32_16x16x32_bf16 v[44:47], a[168:171], v[4:7], v[44:47]
  v_mfma_f32_16x16x32_bf16 v[48:51], a[168:171], v[8:11], v[48:51]
  s_waitcnt vmcnt(12)
  s_barrier
  s_waitcnt lgkmcnt(4)
  v_mfma_f32_16x16x32_bf16 v[36:39], a[20:23], v[12:15], v[36:39]
  ds_read_b128 v[4:7], v74 offset:16384
  v_mfma_f32_16x16x32_bf16 v[40:43], a[20:23], v[16:19], v[40:43]
  ds_read_b128 v[8:11], v74 offset:17408
  v_mfma_f32_16x16x32_bf16 v[44:47], a[172:175], v[12:15], v[44:47]
  v_mfma_f32_16x16x32_bf16 v[48:51], a[172:175], v[16:19], v[48:51]
  s_waitcnt lgkmcnt(4)
  v_mfma_f32_16x16x32_bf16 v[36:39], a[24:27], v[20:23], v[36:39]
  ds_read_b128 v[12:15], v74 offset:18432
  v_mfma_f32_16x16x32_bf16 v[40:43], a[24:27], v[24:27], v[40:43]
  ds_read_b128 v[16:19], v74 offset:19456
  v_mfma_f32_16x16x32_bf16 v[44:47], a[176:179], v[20:23], v[44:47]
  v_mfma_f32_16x16x32_bf16 v[48:51], a[176:179], v[24:27], v[48:51]
  s_waitcnt lgkmcnt(4)
  v_mfma_f32_16x16x32_bf16 v[36:39], a[28:31], v[28:31], v[36:39]
  ds_read_b128 v[20:23], v74 offset:20480
  v_mfma_f32_16x16x32_bf16 v[40:43], a[28:31], v[32:35], v[40:43]
  ds_read_b128 v[24:27], v74 offset:21504
  v_mfma_f32_16x16x32_bf16 v[44:47], a[180:183], v[28:31], v[44:47]
  v_mfma_f32_16x16x32_bf16 v[48:51], a[180:183], v[32:35], v[48:51]
  s_waitcnt lgkmcnt(4)
  v_mfma_f32_16x16x32_bf16 v[36:39], a[32:35], v[4:7], v[36:39]
  ds_read_b128 v[28:31], v74 offset:22528
  v_mfma_f32_16x16x32_bf16 v[40:43], a[32:35], v[8:11], v[40:43]
  ds_read_b128 v[32:35], v74 offset:23552
  v_mfma_f32_16x16x32_bf16 v[44:47], a[184:187], v[4:7], v[44:47]
  v_mfma_f32_16x16x32_bf16 v[48:51], a[184:187], v[8:11], v[48:51]
  s_waitcnt lgkmcnt(4)
  v_mfma_f32_16x16x32_bf16 v[36:39], a[36:39], v[12:15], v[36:39]
  ds_read_b128 v[4:7], v74 offset:24576
  v_mfma_f32_16x16x32_bf16 v[40:43], a[36:39], v[16:19], v[40:43]
  ds_read_b128 v[8:11], v74 offset:25600
  v_mfma_f32_16x16x32_bf16 v[44:47], a[188:191], v[12:15], v[44:47]
  v_mfma_f32_16x16x32_bf16 v[48:51], a[188:191], v[16:19], v[48:51]
  s_waitcnt lgkmcnt(4)
  v_mfma_f32_16x16x32_bf16 v[36:39], a[40:43], v[20:23], v[36:39]
  ds_read_b128 v[12:15], v74 offset:26624
  v_mfma_f32_16x16x32_bf16 v[40:43], a[40:43], v[24:27], v[40:43]
  ds_read_b128 v[16:19], v74 offset:27648
  v_mfma_f32_16x16x32_bf16 v[44:47], a[192:195], v[20:23], v[44:47]
  v_mfma_f32_16x16x32_bf16 v[48:51], a[192:195], v[24:27], v[48:51]
  s_waitcnt lgkmcnt(4)
  v_mfma_f32_16x16x32_bf16 v[36:39], a[44:47], v[28:31], v[36:39]
  ds_read_b128 v[20:23], v74 offset:28672
  v_mfma_f32_16x16x32_bf16 v[40:43], a[44:47], v[32:35], v[40:43]
  ds_read_b128 v[24:27], v74 offset:29696
  v_mfma_f32_16x16x32_bf16 v[44:47], a[196:199], v[28:31], v[44:47]
  v_mfma_f32_16x16x32_bf16 v[48:51], a[196:199], v[32:35], v[48:51]
  s_waitcnt lgkmcnt(4)
  v_mfma_f32_16x16x32_bf16 v[36:39], a[48:51], v[4:7], v[36:39]
  ds_read_b128 v[28:31], v74 offset:30720
  v_mfma_f32_16x16x32_bf16 v[40:43], a[48:51], v[8:11], v[40:43]
  ds_read_b128 v[32:35], v74 offset:31744
  v_mfma_f32_16x16x32_bf16 v[44:47], a[200:203], v[4:7], v[44:47]
  v_mfma_f32_16x16x32_bf16 v[48:51], a[200:203], v[8:11], v[48:51]
  s_waitcnt vmcnt(0)
  s_barrier
  v_mov_b32 v52, s25
  v_cmp_gt_i32 vcc, s29, v3
  s_cmp_lg_u32 s20, 0
  s_cbranch_scc1 L_F2_s2
  buffer_store_dword v52, v69, s[4:7], 0 offen sc1
L_F2_s2:
  s_mov_b32 s28, 0
  s_cbranch_vccnz L_F2_nopf
  s_cmp_ge_u32 s25, 63
  s_cbranch_scc1 L_F2_nopf
  s_mov_b32 s28, 1
  s_waitcnt lgkmcnt(4)
  v_mfma_f32_16x16x32_bf16 v[36:39], a[52:55], v[12:15], v[36:39]
  ds_read_b128 v[4:7], v74 offset:32768
  v_mfma_f32_16x16x32_bf16 v[40:43], a[52:55], v[16:19], v[40:43]
  ds_read_b128 v[8:11], v74 offset:33792
  v_mfma_f32_16x16x32_bf16 v[44:47], a[204:207], v[12:15], v[44:47]
  s_add_u32 s36, s32, 0
  s_add_u32 m0, s34, s36
  s_add_u32 s36, s35, s36
  buffer_load_dwordx4 v1, s[4:7], s36 offen offset:0 sc1 lds
  v_mfma_f32_16x16x32_bf16 v[48:51], a[204:207], v[16:19], v[48:51]
  s_waitcnt lgkmcnt(4)
  v_mfma_f32_16x16x32_bf16 v[36:39], a[56:59], v[20:23], v[36:39]
  ds_read_b128 v[12:15], v74 offset:34816
  v_mfma_f32_16x16x32_bf16 v[40:43], a[56:59], v[24:27], v[40:43]
  ds_read_b128 v[16:19], v74 offset:35840
  v_mfma_f32_16x16x32_bf16 v[44:47], a[208:211], v[20:23], v[44:47]
  buffer_load_dwordx4 v1, s[4:7], s36 offen offset:1024 sc1 lds
  v_mfma_f32_16x16x32_bf16 v[48:51], a[208:211], v[24:27], v[48:51]
  s_waitcnt lgkmcnt(4)
  v_mfma_f32_16x16x32_bf16 v[36:39], a[60:63], v[28:31], v[36:39]
  ds_read_b128 v[20:23], v74 offset:36864
  v_mfma_f32_16x16x32_bf16 v[40:43], a[60:63], v[32:35], v[40:43]
  ds_read_b128 v[24:27], v74 offset:37888
  v_mfma_f32_16x16x32_bf16 v[44:47], a[212:215], v[28:31], v[44:47]
  buffer_load_dwordx4 v1, s[4:7], s36 offen offset:2048 sc1 lds
  v_mfma_f32_16x16x32_bf16 v[48:51], a[212:215], v[32:35], v[48:51]
  s_waitcnt lgkmcnt(4)
  v_mfma_f32_16x16x32_bf16 v[36:39], a[64:67], v[4:7], v[36:39]
  ds_read_b128 v[28:31], v74 offset:38912
  v_mfma_f32_16x16x32_bf16 v[40:43], a[64:67], v[8:11], v[40:43]
  ds_read_b128 v[32:35], v74 offset:39936
  v_mfma_f32_16x16x32_bf16 v[44:47], a[216:219], v[4:7], v[44:47]
  buffer_load_dwordx4 v1, s[4:7], s36 offen offset:3072 sc1 lds
  v_mfma_f32_16x16x32_bf16 v[48:51], a[216:219], v[8:11], v[48:51]
  s_waitcnt lgkmcnt(4)
  v_mfma_f32_16x16x32_bf16 v[36:39], a[68:71], v[12:15], v[36:39]
  ds_read_b128 v[4:7], v74 offset:40960
  v_mfma_f32_16x16x32_bf16 v[40:43], a[68:71], v[16:19], v[40:43]
  ds_read_b128 v[8:11], v74 offset:41984
  v_mfma_f32_16x16x32_bf16 v[44:47], a[220:223], v[12:15], v[44:47]
  s_add_u32 s36, s32, 16384
  s_add_u32 m0, s34, s36
  s_add_u32 s36, s35, s36
  buffer_load_dwordx4 v1, s[4:7], s36 offen offset:0 sc1 lds
  v_mfma_f32_16x16x32_bf16 v[48:51], a[220:223], v[16:19], v[48:51]
  s_waitcnt lgkmcnt(4)
  v_mfma_f32_16x16x32_bf16 v[36:39], a[72:75], v[20:23], v[36:39]
  ds_read_b128 v[12:15], v74 offset:43008
  v_mfma_f32_16x16x32_bf16 v[40:43], a[72:75], v[24:27], v[40:43]
  ds_read_b128 v[16:19], v74 offset:44032
  v_mfma_f32_16x16x32_bf16 v[44:47], a[224:227], v[20:23], v[44:47]
  buffer_load_dwordx4 v1, s[4:7], s36 offen offset:1024 sc1 lds
  v_mfma_f32_16x16x32_bf16 v[48:51], a[224:227], v[24:27], v[48:51]
  s_waitcnt lgkmcnt(4)
  v_mfma_f32_16x16x32_bf16 v[36:39], a[76:79], v[28:31], v[36:39]
  ds_read_b128 v[20:23], v74 offset:45056
  v_mfma_f32_16x16x32_bf16 v[40:43], a[76:79], v[32:35], v[40:43]
  ds_read_b128 v[24:27], v74 offset:46080
  v_mfma_f32_16x16x32_bf16 v[44:47], a[228:231], v[28:31], v[44:47]
  buffer_load_dwordx4 v1, s[4:7], s36 offen offset:2048 sc1 lds
  v_mfma_f32_16x16x32_bf16 v[48:51], a[228:231], v[32:35], v[48:51]
  s_waitcnt lgkmcnt(4)
  v_mfma_f32_16x16x32_bf16 v[36:39], a[80:83], v[4:7], v[36:39]
  ds_read_b128 v[28:31], v74 offset:47104
  v_mfma_f32_16x16x32_bf16 v[40:43], a[80:83], v[8:11], v[40:43]
  ds_read_b128 v[32:35], v74 offset:48128
  v_mfma_f32_16x16x32_bf16 v[44:47], a[232:235], v[4:7], v[44:47]
  buffer_load_dwordx4 v1, s[4:7], s36 offen offset:3072 sc1 lds
  v_mfma_f32_16x16x32_bf16 v[48:51], a[232:235], v[8:11], v[48:51]
  s_waitcnt lgkmcnt(4)
  v_mfma_f32_16x16x32_bf16 v[36:39], a[84:87], v[12:15], v[36:39]
  ds_read_b128 v[4:7], v74 offset:49152
  v_mfma_f32_16x16x32_bf16 v[40:43], a[84:87], v[16:19], v[40:43]
  ds_read_b128 v[8:11], v74 offset:50176
  v_mfma_f32_16x16x32_bf16 v[44:47], a[236:239], v[12:15], v[44:47]
  s_add_u32 s36, s32, 32768
  s_add_u32 m0, s34, s36
  s_add_u32 s36, s35, s36
  buffer_load_dwordx4 v1, s[4:7], s36 offen offset:0 sc1 lds
  v_mfma_f32_16x16x32_bf16 v[48:51], a[236:239], v[16:19], v[48:51]
  s_waitcnt lgkmcnt(4)
  v_mfma_f32_16x16x32_bf16 v[36:39], a[88:91], v[20:23], v[36:39]
  ds_read_b128 v[12:15], v74 offset:51200
  v_mfma_f32_16x16x32_bf16 v[40:43], a[88:91], v[24:27], v[40:43]
  ds_read_b128 v[16:19], v74 offset:52224
  v_mfma_f32_16x16x32_bf16 v[44:47], a[240:243], v[20:23], v[44:47]
  buffer_load_dwordx4 v1, s[4:7], s36 offen offset:1024 sc1 lds
  v_mfma_f32_16x16x32_bf16 v[48:51], a[240:243], v[24:27], v[48:51]
  s_waitcnt lgkmcnt(4)
  v_mfma_f32_16x16x32_bf16 v[36:39], a[92:95], v[28:31], v[36:39]
  ds_read_b128 v[20:23], v74 offset:53248
  v_mfma_f32_16x16x32_bf16 v[40:43], a[92:95], v[32:35], v[40:43]
  ds_read_b128 v[24:27], v74 offset:54272
  v_mfma_f32_16x16x32_bf16 v[44:47], a[244:247], v[28:31], v[44:47]
  buffer_load_dwordx4 v1, s[4:7], s36 offen offset:2048 sc1 lds
  v_mfma_f32_16x16x32_bf16 v[48:51], a[244:247], v[32:35], v[48:51]
  s_waitcnt lgkmcnt(4)
  v_mfma_f32_16x16x32_bf16 v[36:39], a[96:99], v[4:7], v[36:39]
  ds_read_b128 v[28:31], v74 offset:55296
  v_mfma_f32_16x16x32_bf16 v[40:43], a[96:99], v[8:11], v[40:43]
  ds_read_b128 v[32:35], v74 offset:56320
  v_mfma_f32_16x16x32_bf16 v[44:47], a[248:251], v[4:7], v[44:47]
  buffer_load_dwordx4 v1, s[4:7], s36 offen offset:3072 sc1 lds
  v_mfma_f32_16x16x32_bf16 v[48:51], a[248:251], v[8:11], v[48:51]
  s_waitcnt lgkmcnt(4)
  v_mfma_f32_16x16x32_bf16 v[36:39], a[100:103], v[12:15], v[36:39]
  ds_read_b128 v[4:7], v74 offset:57344
  v_mfma_f32_16x16x32_bf16 v[40:43], a[100:103], v[16:19], v[40:43]
  ds_read_b128 v[8:11], v74 offset:58368
  v_mfma_f32_16x16x32_bf16 v[44:47], a[252:255], v[12:15], v[44:47]
  s_add_u32 s36, s32, 49152
  s_add_u32 m0, s34, s36
  s_add_u32 s36, s35, s36
  buffer_load_dwordx4 v1, s[4:7], s36 offen offset:0 sc1 lds
  v_mfma_f32_16x16x32_bf16 v[48:51], a[252:255], v[16:19], v[48:51]
  s_waitcnt lgkmcnt(4)
  v_mfma_f32_16x16x32_bf16 v[36:39], a[104:107], v[20:23], v[36:39]
  ds_read_b128 v[12:15], v74 offset:59392
  v_mfma_f32_16x16x32_bf16 v[40:43], a[104:107], v[24:27], v[40:43]
  ds_read_b128 v[16:19], v74 offset:60416
  v_mfma_f32_16x16x32_bf16 v[44:47], v[128:131], v[20:23], v[44:47]
  buffer_load_dwordx4 v1, s[4:7], s36 offen offset:1024 sc1 lds
  v_mfma_f32_16x16x32_bf16 v[48:51], v[128:131], v[24:27], v[48:51]
  s_waitcnt lgkmcnt(4)
  v_mfma_f32_16x16x32_bf16 v[36:39], a[108:111], v[28:31], v[36:39]
  ds_read_b128 v[20:23], v74 offset:61440
  v_mfma_f32_16x16x32_bf16 v[40:43], a[108:111], v[32:35], v[40:43]
  ds_read_b128 v[24:27], v74 offset:62464
  v_mfma_f32_16x16x32_bf16 v[44:47], v[132:135], v[28:31], v[44:47]
  buffer_load_dwordx4 v1, s[4:7], s36 offen offset:2048 sc1 lds
  v_mfma_f32_16x16x32_bf16 v[48:51], v[132:135], v[32:35], v[48:51]
  s_waitcnt lgkmcnt(4)
  v_mfma_f32_16x16x32_bf16 v[36:39], a[112:115], v[4:7], v[36:39]
  ds_read_b128 v[28:31], v74 offset:63488
  v_mfma_f32_16x16x32_bf16 v[40:43], a[112:115], v[8:11], v[40:43]
  ds_read_b128 v[32:35], v74 offset:64512
  v_mfma_f32_16x16x32_bf16 v[44:47], v[136:139], v[4:7], v[44:47]
  buffer_load_dwordx4 v1, s[4:7], s36 offen offset:3072 sc1 lds
  v_mfma_f32_16x16x32_bf16 v[48:51], v[136:139], v[8:11], v[48:51]
  s_waitcnt lgkmcnt(4)
  v_mfma_f32_16x16x32_bf16 v[36:39], a[116:119], v[12:15], v[36:39]
  ds_read_b128 v[4:7], v75 offset:0
  v_mfma_f32_16x16x32_bf16 v[40:43], a[116:119], v[16:19], v[40:43]
  ds_read_b128 v[8:11], v75 offset:1024
  v_mfma_f32_16x16x32_bf16 v[44:47], v[140:143], v[12:15], v[44:47]
  s_add_u32 s36, s33, 65536
  s_add_u32 m0, s34, s36
  s_add_u32 s36, s35, s36
  buffer_load_dwordx4 v1, s[4:7], s36 offen offset:0 sc1 lds
  v_mfma_f32_16x16x32_bf16 v[48:51], v[140:143], v[16:19], v[48:51]
  s_waitcnt lgkmcnt(4)
  v_mfma_f32_16x16x32_bf16 v[36:39], a[120:123], v[20:23], v[36:39]
  ds_read_b128 v[12:15], v75 offset:2048
  v_mfma_f32_16x16x32_bf16 v[40:43], a[120:123], v[24:27], v[40:43]
  ds_read_b128 v[16:19], v75 offset:3072
  v_mfma_f32_16x16x32_bf16 v[44:47], v[144:147], v[20:23], v[44:47]
  buffer_load_dwordx4 v1, s[4:7], s36 offen offset:1024 sc1 lds
  v_mfma_f32_16x16x32_bf16 v[48:51], v[144:147], v[24:27], v[48:51]
  s_waitcnt lgkmcnt(4)
  v_mfma_f32_16x16x32_bf16 v[36:39], a[124:127], v[28:31], v[36:39]
  ds_read_b128 v[20:23], v75 offset:4096
  v_mfma_f32_16x16x32_bf16 v[40:43], a[124:127], v[32:35], v[40:43]
  ds_read_b128 v[24:27], v75 offset:5120
  v_mfma_f32_16x16x32_bf16 v[44:47], v[148:151], v[28:31], v[44:47]
  buffer_load_dwordx4 v1, s[4:7], s36 offen offset:2048 sc1 lds
  v_mfma_f32_16x16x32_bf16 v[48:51], v[148:151], v[32:35], v[48:51]
  s_waitcnt lgkmcnt(4)
  v_mfma_f32_16x16x32_bf16 v[36:39], a[128:131], v[4:7], v[36:39]
  ds_read_b128 v[28:31], v75 offset:6144
  v_mfma_f32_16x16x32_bf16 v[40:43], a[128:131], v[8:11], v[40:43]
  ds_read_b128 v[32:35], v75 offset:7168
  v_mfma_f32_16x16x32_bf16 v[44:47], v[152:155], v[4:7], v[44:47]
  v_mfma_f32_16x16x32_bf16 v[48:51], v[152:155], v[8:11], v[48:51]
  s_waitcnt lgkmcnt(4)
  v_mfma_f32_16x16x32_bf16 v[36:39], a[132:135], v[12:15], v[36:39]
  ds_read_b128 v[4:7], v75 offset:8192
  v_mfma_f32_16x16x32_bf16 v[40:43], a[132:135], v[16:19], v[40:43]
  ds_read_b128 v[8:11], v75 offset:9216
  v_mfma_f32_16x16x32_bf16 v[44:47], v[156:159], v[12:15], v[44:47]
  v_mfma_f32_16x16x32_bf16 v[48:51], v[156:159], v[16:19], v[48:51]
  s_waitcnt lgkmcnt(4)
  v_mfma_f32_16x16x32_bf16 v[36:39], a[136:139], v[20:23], v[36:39]
  ds_read_b128 v[12:15], v75 offset:10240
  v_mfma_f32_16x16x32_bf16 v[40:43], a[136:139], v[24:27], v[40:43]
  ds_read_b128 v[16:19], v75 offset:11264
  v_mfma_f32_16x16x32_bf16 v[44:47], v[160:163], v[20:23], v[44:47]
  v_mfma_f32_16x16x32_bf16 v[48:51], v[160:163], v[24:27], v[48:51]
  s_waitcnt lgkmcnt(4)
  v_mfma_f32_16x16x32_bf16 v[36:39], a[140:143], v[28:31], v[36:39]
  v_mfma_f32_16x16x32_bf16 v[40:43], a[140:143], v[32:35], v[40:43]
  v_mfma_f32_16x16x32_bf16 v[44:47], v[164:167], v[28:31], v[44:47]
  v_mfma_f32_16x16x32_bf16 v[48:51], v[164:167], v[32:35], v[48:51]
  s_waitcnt lgkmcnt(2)
  v_mfma_f32_16x16x32_bf16 v[36:39], a[144:147], v[4:7], v[36:39]
  v_mfma_f32_16x16x32_bf16 v[40:43], a[144:147], v[8:11], v[40:43]
  v_mfma_f32_16x16x32_bf16 v[44:47], v[168:171], v[4:7], v[44:47]
  v_mfma_f32_16x16x32_bf16 v[48:51], v[168:171], v[8:11], v[48:51]
  s_waitcnt lgkmcnt(0)
  v_mfma_f32_16x16x32_bf16 v[36:39], a[148:151], v[12:15], v[36:39]
  v_mfma_f32_16x16x32_bf16 v[40:43], a[148:151], v[16:19], v[40:43]
  v_mfma_f32_16x16x32_bf16 v[44:47], v[172:175], v[12:15], v[44:47]
  v_mfma_f32_16x16x32_bf16 v[48:51], v[172:175], v[16:19], v[48:51]
  s_nop 7
  s_branch L_F2_epi
L_F2_nopf:
  s_waitcnt lgkmcnt(4)
  v_mfma_f32_16x16x32_bf16 v[36:39], a[52:55], v[12:15], v[36:39]
  ds_read_b128 v[4:7], v74 offset:32768
  v_mfma_f32_16x16x32_bf16 v[40:43], a[52:55], v[16:19], v[40:43]
  ds_read_b128 v[8:11], v74 offset:33792
  v_mfma_f32_16x16x32_bf16 v[44:47], a[204:207], v[12:15], v[44:47]
  v_mfma_f32_16x16x32_bf16 v[48:51], a[204:207], v[16:19], v[48:51]
  s_waitcnt lgkmcnt(4)
  v_mfma_f32_16x16x32_bf16 v[36:39], a[56:59], v[20:23], v[36:39]
  ds_read_b128 v[12:15], v74 offset:34816
  v_mfma_f32_16x16x32_bf16 v[40:43], a[56:59], v[24:27], v[40:43]
  ds_read_b128 v[16:19], v74 offset:35840
  v_mfma_f32_16x16x32_bf16 v[44:47], a[208:211], v[20:23], v[44:47]
  v_mfma_f32_16x16x32_bf16 v[48:51], a[208:211], v[24:27], v[48:51]
  s_waitcnt lgkmcnt(4)
  v_mfma_f32_16x16x32_bf16 v[36:39], a[60:63], v[28:31], v[36:39]
  ds_read_b128 v[20:23], v74 offset:36864
  v_mfma_f32_16x16x32_bf16 v[40:43], a[60:63], v[32:35], v[40:43]
  ds_read_b128 v[24:27], v74 offset:37888
  v_mfma_f32_16x16x32_bf16 v[44:47], a[212:215], v[28:31], v[44:47]
  v_mfma_f32_16x16x32_bf16 v[48:51], a[212:215], v[32:35], v[48:51]
  s_waitcnt lgkmcnt(4)
  v_mfma_f32_16x16x32_bf16 v[36:39], a[64:67], v[4:7], v[36:39]
  ds_read_b128 v[28:31], v74 offset:38912
  v_mfma_f32_16x16x32_bf16 v[40:43], a[64:67], v[8:11], v[40:43]
  ds_read_b128 v[32:35], v74 offset:39936
  v_mfma_f32_16x16x32_bf16 v[44:47], a[216:219], v[4:7], v[44:47]
  v_mfma_f32_16x16x32_bf16 v[48:51], a[216:219], v[8:11], v[48:51]
  s_waitcnt lgkmcnt(4)
  v_mfma_f32_16x16x32_bf16 v[36:39], a[68:71], v[12:15], v[36:39]
  ds_read_b128 v[4:7], v74 offset:40960
  v_mfma_f32_16x16x32_bf16 v[40:43], a[68:71], v[16:19], v[40:43]
  ds_read_b128 v[8:11], v74 offset:41984
  v_mfma_f32_16x16x32_bf16 v[44:47], a[220:223], v[12:15], v[44:47]
  v_mfma_f32_16x16x32_bf16 v[48:51], a[220:223], v[16:19], v[48:51]
  s_waitcnt lgkmcnt(4)
  v_mfma_f32_16x16x32_bf16 v[36:39], a[72:75], v[20:23], v[36:39]
  ds_read_b128 v[12:15], v74 offset:43008
  v_mfma_f32_16x16x32_bf16 v[40:43], a[72:75], v[24:27], v[40:43]
  ds_read_b128 v[16:19], v74 offset:44032
  v_mfma_f32_16x16x32_bf16 v[44:47], a[224:227], v[20:23], v[44:47]
  v_mfma_f32_16x16x32_bf16 v[48:51], a[224:227], v[24:27], v[48:51]
  s_waitcnt lgkmcnt(4)
  v_mfma_f32_16x16x32_bf16 v[36:39], a[76:79], v[28:31], v[36:39]
  ds_read_b128 v[20:23], v74 offset:45056
  v_mfma_f32_16x16x32_bf16 v[40:43], a[76:79], v[32:35], v[40:43]
  ds_read_b128 v[24:27], v74 offset:46080
  v_mfma_f32_16x16x32_bf16 v[44:47], a[228:231], v[28:31], v[44:47]
  v_mfma_f32_16x16x32_bf16 v[48:51], a[228:231], v[32:35], v[48:51]
  s_waitcnt lgkmcnt(4)
  v_mfma_f32_16x16x32_bf16 v[36:39], a[80:83], v[4:7], v[36:39]
  ds_read_b128 v[28:31], v74 offset:47104
  v_mfma_f32_16x16x32_bf16 v[40:43], a[80:83], v[8:11], v[40:43]
  ds_read_b128 v[32:35], v74 offset:48128
  v_mfma_f32_16x16x32_bf16 v[44:47], a[232:235], v[4:7], v[44:47]
  v_mfma_f32_16x16x32_bf16 v[48:51], a[232:235], v[8:11], v[48:51]
  s_waitcnt lgkmcnt(4)
  v_mfma_f32_16x16x32_bf16 v[36:39], a[84:87], v[12:15], v[36:39]
  ds_read_b128 v[4:7], v74 offset:49152
  v_mfma_f32_16x16x32_bf16 v[40:43], a[84:87], v[16:19], v[40:43]
  ds_read_b128 v[8:11], v74 offset:50176
  v_mfma_f32_16x16x32_bf16 v[44:47], a[236:239], v[12:15], v[44:47]
  v_mfma_f32_16x16x32_bf16 v[48:51], a[236:239], v[16:19], v[48:51]
  s_waitcnt lgkmcnt(4)
  v_mfma_f32_16x16x32_bf16 v[36:39], a[88:91], v[20:23], v[36:39]
  ds_read_b128 v[12:15], v74 offset:51200
  v_mfma_f32_16x16x32_bf16 v[40:43], a[88:91], v[24:27], v[40:43]
  ds_read_b128 v[16:19], v74 offset:52224
  v_mfma_f32_16x16x32_bf16 v[44:47], a[240:243], v[20:23], v[44:47]
  v_mfma_f32_16x16x32_bf16 v[48:51], a[240:243], v[24:27], v[48:51]
  s_waitcnt lgkmcnt(4)
  v_mfma_f32_16x16x32_bf16 v[36:39], a[92:95], v[28:31], v[36:39]
  ds_read_b128 v[20:23], v74 offset:53248
  v_mfma_f32_16x16x32_bf16 v[40:43], a[92:95], v[32:35], v[40:43]
  ds_read_b128 v[24:27], v74 offset:54272
  v_mfma_f32_16x16x32_bf16 v[44:47], a[244:247], v[28:31], v[44:47]
  v_mfma_f32_16x16x32_bf16 v[48:51], a[244:247], v[32:35], v[48:51]
  s_waitcnt lgkmcnt(4)
  v_mfma_f32_16x16x32_bf16 v[36:39], a[96:99], v[4:7], v[36:39]
  ds_read_b128 v[28:31], v74 offset:55296
  v_mfma_f32_16x16x32_bf16 v[40:43], a[96:99], v[8:11], v[40:43]
  ds_read_b128 v[32:35], v74 offset:56320
  v_mfma_f32_16x16x32_bf16 v[44:47], a[248:251], v[4:7], v[44:47]
  v_mfma_f32_16x16x32_bf16 v[48:51], a[248:251], v[8:11], v[48:51]
  s_waitcnt lgkmcnt(4)
  v_mfma_f32_16x16x32_bf16 v[36:39], a[100:103], v[12:15], v[36:39]
  ds_read_b128 v[4:7], v74 offset:57344
  v_mfma_f32_16x16x32_bf16 v[40:43], a[100:103], v[16:19], v[40:43]
  ds_read_b128 v[8:11], v74 offset:58368
  v_mfma_f32_16x16x32_bf16 v[44:47], a[252:255], v[12:15], v[44:47]
  v_mfma_f32_16x16x32_bf16 v[48:51], a[252:255], v[16:19], v[48:51]
  s_waitcnt lgkmcnt(4)
  v_mfma_f32_16x16x32_bf16 v[36:39], a[104:107], v[20:23], v[36:39]
  ds_read_b128 v[12:15], v74 offset:59392
  v_mfma_f32_16x16x32_bf16 v[40:43], a[104:107], v[24:27], v[40:43]
  ds_read_b128 v[16:19], v74 offset:60416
  v_mfma_f32_16x16x32_bf16 v[44:47], v[128:131], v[20:23], v[44:47]
  v_mfma_f32_16x16x32_bf16 v[48:51], v[128:131], v[24:27], v[48:51]
  s_waitcnt lgkmcnt(4)
  v_mfma_f32_16x16x32_bf16 v[36:39], a[108:111], v[28:31], v[36:39]
  ds_read_b128 v[20:23], v74 offset:61440
  v_mfma_f32_16x16x32_bf16 v[40:43], a[108:111], v[32:35], v[40:43]
  ds_read_b128 v[24:27], v74 offset:62464
  v_mfma_f32_16x16x32_bf16 v[44:47], v[132:135], v[28:31], v[44:47]
  v_mfma_f32_16x16x32_bf16 v[48:51], v[132:135], v[32:35], v[48:51]
  s_waitcnt lgkmcnt(4)
  v_mfma_f32_16x16x32_bf16 v[36:39], a[112:115], v[4:7], v[36:39]
  ds_read_b128 v[28:31], v74 offset:63488
  v_mfma_f32_16x16x32_bf16 v[40:43], a[112:115], v[8:11], v[40:43]
  ds_read_b128 v[32:35], v74 offset:64512
  v_mfma_f32_16x16x32_bf16 v[44:47], v[136:139], v[4:7], v[44:47]
  v_mfma_f32_16x16x32_bf16 v[48:51], v[136:139], v[8:11], v[48:51]
  s_waitcnt lgkmcnt(4)
  v_mfma_f32_16x16x32_bf16 v[36:39], a[116:119], v[12:15], v[36:39]
  ds_read_b128 v[4:7], v75 offset:0
  v_mfma_f32_16x16x32_bf16 v[40:43], a[116:119], v[16:19], v[40:43]
  ds_read_b128 v[8:11], v75 offset:1024
  v_mfma_f32_16x16x32_bf16 v[44:47], v[140:143], v[12:15], v[44:47]
  v_mfma_f32_16x16x32_bf16 v[48:51], v[140:143], v[16:19], v[48:51]
  s_waitcnt lgkmcnt(4)
  v_mfma_f32_16x16x32_bf16 v[36:39], a[120:123], v[20:23], v[36:39]
  ds_read_b128 v[12:15], v75 offset:2048
  v_mfma_f32_16x16x32_bf16 v[40:43], a[120:123], v[24:27], v[40:43]
  ds_read_b128 v[16:19], v75 offset:3072
  v_mfma_f32_16x16x32_bf16 v[44:47], v[144:147], v[20:23], v[44:47]
  v_mfma_f32_16x16x32_bf16 v[48:51], v[144:147], v[24:27], v[48:51]
  s_waitcnt lgkmcnt(4)
  v_mfma_f32_16x16x32_bf16 v[36:39], a[124:127], v[28:31], v[36:39]
  ds_read_b128 v[20:23], v75 offset:4096
  v_mfma_f32_16x16x32_bf16 v[40:43], a[124:127], v[32:35], v[40:43]
  ds_read_b128 v[24:27], v75 offset:5120
  v_mfma_f32_16x16x32_bf16 v[44:47], v[148:151], v[28:31], v[44:47]
  v_mfma_f32_16x16x32_bf16 v[48:51], v[148:151], v[32:35], v[48:51]
  s_waitcnt lgkmcnt(4)
  v_mfma_f32_16x16x32_bf16 v[36:39], a[128:131], v[4:7], v[36:39]
  ds_read_b128 v[28:31], v75 offset:6144
  v_mfma_f32_16x16x32_bf16 v[40:43], a[128:131], v[8:11], v[40:43]
  ds_read_b128 v[32:35], v75 offset:7168
  v_mfma_f32_16x16x32_bf16 v[44:47], v[152:155], v[4:7], v[44:47]
  v_mfma_f32_16x16x32_bf16 v[48:51], v[152:155], v[8:11], v[48:51]
  s_waitcnt lgkmcnt(4)
  v_mfma_f32_16x16x32_bf16 v[36:39], a[132:135], v[12:15], v[36:39]
  ds_read_b128 v[4:7], v75 offset:8192
  v_mfma_f32_16x16x32_bf16 v[40:43], a[132:135], v[16:19], v[40:43]
  ds_read_b128 v[8:11], v75 offset:9216
  v_mfma_f32_16x16x32_bf16 v[44:47], v[156:159], v[12:15], v[44:47]
  v_mfma_f32_16x16x32_bf16 v[48:51], v[156:159], v[16:19], v[48:51]
  s_waitcnt lgkmcnt(4)
  v_mfma_f32_16x16x32_bf16 v[36:39], a[136:139], v[20:23], v[36:39]
  ds_read_b128 v[12:15], v75 offset:10240
  v_mfma_f32_16x16x32_bf16 v[40:43], a[136:139], v[24:27], v[40:43]
  ds_read_b128 v[16:19], v75 offset:11264
  v_mfma_f32_16x16x32_bf16 v[44:47], v[160:163], v[20:23], v[44:47]
  v_mfma_f32_16x16x32_bf16 v[48:51], v[160:163], v[24:27], v[48:51]
  s_waitcnt lgkmcnt(4)
  v_mfma_f32_16x16x32_bf16 v[36:39], a[140:143], v[28:31], v[36:39]
  v_mfma_f32_16x16x32_bf16 v[40:43], a[140:143], v[32:35], v[40:43]
  v_mfma_f32_16x16x32_bf16 v[44:47], v[164:167], v[28:31], v[44:47]
  v_mfma_f32_16x16x32_bf16 v[48:51], v[164:167], v[32:35], v[48:51]
  s_waitcnt lgkmcnt(2)
  v_mfma_f32_16x16x32_bf16 v[36:39], a[144:147], v[4:7], v[36:39]
  v_mfma_f32_16x16x32_bf16 v[40:43], a[144:147], v[8:11], v[40:43]
  v_mfma_f32_16x16x32_bf16 v[44:47], v[168:171], v[4:7], v[44:47]
  v_mfma_f32_16x16x32_bf16 v[48:51], v[168:171], v[8:11], v[48:51]
  s_waitcnt lgkmcnt(0)
  v_mfma_f32_16x16x32_bf16 v[36:39], a[148:151], v[12:15], v[36:39]
  v_mfma_f32_16x16x32_bf16 v[40:43], a[148:151], v[16:19], v[40:43]
  v_mfma_f32_16x16x32_bf16 v[44:47], v[172:175], v[12:15], v[44:47]
  v_mfma_f32_16x16x32_bf16 v[48:51], v[172:175], v[16:19], v[48:51]
L_F2_epi:
  s_nop 4
  buffer_store_dwordx4 v[36:39], v68, s[4:7], s31 offen offset:0 sc1
  buffer_store_dwordx4 v[40:43], v76, s[4:7], s31 offen offset:0 sc1
  buffer_store_dwordx4 v[44:47], v68, s[4:7], s31 offen offset:256 sc1
  buffer_store_dwordx4 v[48:51], v76, s[4:7], s31 offen offset:256 sc1
  s_add_u32 s25, s25, 1
  s_add_u32 s31, s31, 393216
  s_branch L_F2_top
L_QK:
  s_cmp_lg_u32 s21, 0
  s_cbranch_scc1 L_QK_noprobe
  s_lshl_b32 s40, s20, 13
  s_xor_b32 s40, s40, 0x4000
  s_add_u32 s40, s40, 524288
  s_mov_b32 s46, -1
  v_lshlrev_b32 v84, 2, v0
  s_mov_b32 exec_hi, 0
  s_xor_b32 s41, s40, 0
  buffer_store_dword v84, v84, s[4:7], s41 offen offset:0 sc1
  s_waitcnt vmcnt(0)
  s_memtime s[42:43]
  s_waitcnt lgkmcnt(0)
  buffer_load_dword v85, v84, s[4:7], s41 offen offset:0 sc1
  s_waitcnt vmcnt(0)
  s_memtime s[44:45]
  s_waitcnt lgkmcnt(0)
  s_sub_u32 s42, s44, s42
  s_min_u32 s46, s46, s42
  s_xor_b32 s41, s40, 4096
  buffer_store_dword v84, v84, s[4:7], s41 offen offset:256 sc1
  s_waitcnt vmcnt(0)
  s_memtime s[42:43]
  s_waitcnt lgkmcnt(0)
  buffer_load_dword v85, v84, s[4:7], s41 offen offset:256 sc1
  s_waitcnt vmcnt(0)
  s_memtime s[44:45]
  s_waitcnt lgkmcnt(0)
  s_sub_u32 s42, s44, s42
  s_min_u32 s46, s46, s42
  s_xor_b32 s41, s40, 0
  buffer_store_dword v84, v84, s[4:7], s41 offen offset:512 sc1
  s_waitcnt vmcnt(0)
  s_memtime s[42:43]
  s_waitcnt lgkmcnt(0)
  buffer_load_dword v85, v84, s[4:7], s41 offen offset:512 sc1
  s_waitcnt vmcnt(0)
  s_memtime s[44:45]
  s_waitcnt lgkmcnt(0)
  s_sub_u32 s42, s44, s42
  s_min_u32 s46, s46, s42
  s_xor_b32 s41, s40, 4096
  buffer_store_dword v84, v84, s[4:7], s41 offen offset:768 sc1
  s_waitcnt vmcnt(0)
  s_memtime s[42:43]
  s_waitcnt lgkmcnt(0)
  buffer_load_dword v85, v84, s[4:7], s41 offen offset:768 sc1
  s_waitcnt vmcnt(0)
  s_memtime s[44:45]
  s_waitcnt lgkmcnt(0)
  s_sub_u32 s42, s44, s42
  s_min_u32 s46, s46, s42
  s_xor_b32 s41, s40, 0
  buffer_store_dword v84, v84, s[4:7], s41 offen offset:1024 sc1
  s_waitcnt vmcnt(0)
  s_memtime s[42:43]
  s_waitcnt lgkmcnt(0)
  buffer_load_dword v85, v84, s[4:7], s41 offen offset:1024 sc1
  s_waitcnt vmcnt(0)
  s_memtime s[44:45]
  s_waitcnt lgkmcnt(0)
  s_sub_u32 s42, s44, s42
  s_min_u32 s46, s46, s42
  s_xor_b32 s41, s40, 4096
  buffer_store_dword v84, v84, s[4:7], s41 offen offset:1280 sc1
  s_waitcnt vmcnt(0)
  s_memtime s[42:43]
  s_waitcnt lgkmcnt(0)
  buffer_load_dword v85, v84, s[4:7], s41 offen offset:1280 sc1
  s_waitcnt vmcnt(0)
  s_memtime s[44:45]
  s_waitcnt lgkmcnt(0)
  s_sub_u32 s42, s44, s42
  s_min_u32 s46, s46, s42
  s_mov_b64 exec, -1
  s_lshl_b32 s46, s46, 2
  s_or_b32 s46, s46, s20
  s_lshl_b32 s40, s20, 2
  v_mov_b32 v84, s40
  v_mov_b32 v85, s46
  ds_write_b32 v84, v85
  v_mov_b32 v84, 0
  s_waitcnt lgkmcnt(0)
  s_barrier
  ds_read_b128 v[84:87], v84
  s_waitcnt lgkmcnt(0)
  s_barrier
  v_min3_u32 v84, v84, v85, v86
  v_min_u32 v84, v84, v87
  v_and_b32 v84, 3, v84
  v_lshlrev_b32 v84, 13, v84
  v_or_b32 v84, 1, v84
  v_mov_b32 v85, 64
  buffer_store_dword v84, v85, s[12:15], 0 offen sc1
  s_waitcnt vmcnt(0)
L_QK_noprobe:
  v_bfe_u32 v84, v0, 3, 2
  v_xor_b32 v84, s20, v84
  v_lshlrev_b32 v84, 5, v84
  v_lshrrev_b32 v1, 2, v0
  v_lshl_add_u32 v1, v1, 7, v84
  v_and_b32 v84, 3, v0
  v_lshl_add_u32 v1, v84, 3, v1
  s_lshl_b32 s40, s20, 15
  v_add_u32 v1, s40, v1
  s_lshl_b32 s40, s20, 12
  s_add_u32 s40, s40, 131072
  v_lshl_add_u32 v69, v0, 4, s40
  v_xor_b32 v2, 32768, v1
  v_xor_b32 v70, 4096, v69
  v_xor_b32 v3, 65536, v1
  v_xor_b32 v71, 8192, v69
  v_xor_b32 v68, 98304, v1
  v_xor_b32 v72, 12288, v69
  v_bfe_u32 v4, v0, 5, 1
  v_mul_u32_u24 v4, 16384, v4
  v_bfe_u32 v84, v0, 4, 1
  v_mul_u32_u24 v84, 32768, v84
  v_add_u32 v4, v4, v84
  v_bfe_u32 v84, v0, 3, 1
  v_mul_u32_u24 v84, 131072, v84
  v_add_u32 v4, v4, v84
  v_lshrrev_b32 v84, 3, v0
  v_and_b32 v84, 6, v84
  v_xor_b32 v84, v84, v0
  v_and_b32 v84, 7, v84
  v_lshl_add_u32 v4, v84, 4, v4
  s_lshl_b32 s40, s20, 19
  v_add_u32 v4, s40, v4
  s_lshl_b32 s44, s21, 8
  s_add_u32 s45, s44, 128
  s_load_dwordx2 s[8:9], s[0:1], 16
  s_mov_b32 s10, 8388608
  s_mov_b32 s11, 0x20000
  s_waitcnt lgkmcnt(0)
  v_add_u32 v5, s44, v4
  v_add_u32 v6, s45, v4
  v_add_u32 v7, s44, v4
  v_add_u32 v8, s45, v4
  s_lshl_b32 s41, s20, 15
  s_add_u32 m0, s41, 0
  s_mov_b32 s42, 0
  buffer_load_dwordx4 v5, s[8:11], s42 offen lds
  s_add_u32 m0, s41, 1024
  s_mov_b32 s42, 65536
  buffer_load_dwordx4 v5, s[8:11], s42 offen lds
  s_add_u32 m0, s41, 2048
  s_mov_b32 s42, 8192
  buffer_load_dwordx4 v5, s[8:11], s42 offen lds
  s_add_u32 m0, s41, 3072
  s_mov_b32 s42, 73728
  buffer_load_dwordx4 v5, s[8:11], s42 offen lds
  s_add_u32 m0, s41, 4096
  s_mov_b32 s42, 262144
  buffer_load_dwordx4 v5, s[8:11], s42 offen lds
  s_add_u32 m0, s41, 5120
  s_mov_b32 s42, 327680
  buffer_load_dwordx4 v5, s[8:11], s42 offen lds
  s_add_u32 m0, s41, 6144
  s_mov_b32 s42, 270336
  buffer_load_dwordx4 v5, s[8:11], s42 offen lds
  s_add_u32 m0, s41, 7168
  s_mov_b32 s42, 335872
  buffer_load_dwordx4 v5, s[8:11], s42 offen lds
  s_add_u32 m0, s41, 8192
  s_mov_b32 s42, 2097152
  buffer_load_dwordx4 v5, s[8:11], s42 offen lds
  s_add_u32 m0, s41, 9216
  s_mov_b32 s42, 2162688
  buffer_load_dwordx4 v5, s[8:11], s42 offen lds
  s_add_u32 m0, s41, 10240
  s_mov_b32 s42, 2105344
  buffer_load_dwordx4 v5, s[8:11], s42 offen lds
  s_add_u32 m0, s41, 11264
  s_mov_b32 s42, 2170880
  buffer_load_dwordx4 v5, s[8:11], s42 offen lds
  s_add_u32 m0, s41, 12288
  s_mov_b32 s42, 2359296
  buffer_load_dwordx4 v5, s[8:11], s42 offen lds
  s_add_u32 m0, s41, 13312
  s_mov_b32 s42, 2424832
  buffer_load_dwordx4 v5, s[8:11], s42 offen lds
  s_add_u32 m0, s41, 14336
  s_mov_b32 s42, 2367488
  buffer_load_dwordx4 v5, s[8:11], s42 offen lds
  s_add_u32 m0, s41, 15360
  s_mov_b32 s42, 2433024
  buffer_load_dwordx4 v5, s[8:11], s42 offen lds
  s_add_u32 m0, s41, 16384
  s_mov_b32 s42, 4194304
  buffer_load_dwordx4 v5, s[8:11], s42 offen lds
  s_add_u32 m0, s41, 17408
  s_mov_b32 s42, 4259840
  buffer_load_dwordx4 v5, s[8:11], s42 offen lds
  s_add_u32 m0, s41, 18432
  s_mov_b32 s42, 4202496
  buffer_load_dwordx4 v5, s[8:11], s42 offen lds
  s_add_u32 m0, s41, 19456
  s_mov_b32 s42, 4268032
  buffer_load_dwordx4 v5, s[8:11], s42 offen lds
  s_add_u32 m0, s41, 20480
  s_mov_b32 s42, 4456448
  buffer_load_dwordx4 v5, s[8:11], s42 offen lds
  s_add_u32 m0, s41, 21504
  s_mov_b32 s42, 4521984
  buffer_load_dwordx4 v5, s[8:11], s42 offen lds
  s_add_u32 m0, s41, 22528
  s_mov_b32 s42, 4464640
  buffer_load_dwordx4 v5, s[8:11], s42 offen lds
  s_add_u32 m0, s41, 23552
  s_mov_b32 s42, 4530176
  buffer_load_dwordx4 v5, s[8:11], s42 offen lds
  s_waitcnt vmcnt(16) lgkmcnt(0)
  s_barrier
  s_add_u32 m0, s41, 24576
  s_mov_b32 s42, 6291456
  buffer_load_dwordx4 v5, s[8:11], s42 offen lds
  s_add_u32 m0, s41, 25600
  s_mov_b32 s42, 6356992
  buffer_load_dwordx4 v5, s[8:11], s42 offen lds
  s_add_u32 m0, s41, 26624
  s_mov_b32 s42, 6299648
  buffer_load_dwordx4 v5, s[8:11], s42 offen lds
  s_add_u32 m0, s41, 27648
  s_mov_b32 s42, 6365184
  buffer_load_dwordx4 v5, s[8:11], s42 offen lds
  s_add_u32 m0, s41, 28672
  s_mov_b32 s42, 6553600
  buffer_load_dwordx4 v5, s[8:11], s42 offen lds
  s_add_u32 m0, s41, 29696
  s_mov_b32 s42, 6619136
  buffer_load_dwordx4 v5, s[8:11], s42 offen lds
  s_add_u32 m0, s41, 30720
  s_mov_b32 s42, 6561792
  buffer_load_dwordx4 v5, s[8:11], s42 offen lds
  s_add_u32 m0, s41, 31744
  s_mov_b32 s42, 6627328
  buffer_load_dwordx4 v5, s[8:11], s42 offen lds
  ds_read_b64_tr_b16 a[0:1], v1 offset:0
  ds_read_b64_tr_b16 a[2:3], v1 offset:2048
  ds_read_b64_tr_b16 a[4:5], v1 offset:4096
  ds_read_b64_tr_b16 a[6:7], v1 offset:6144
  ds_read_b64_tr_b16 a[32:33], v2 offset:0
  ds_read_b64_tr_b16 a[34:35], v2 offset:2048
  ds_read_b64_tr_b16 a[36:37], v2 offset:4096
  ds_read_b64_tr_b16 a[38:39], v2 offset:6144
  ds_read_b64_tr_b16 a[64:65], v3 offset:0
  ds_read_b64_tr_b16 a[66:67], v3 offset:2048
  ds_read_b64_tr_b16 a[68:69], v3 offset:4096
  ds_read_b64_tr_b16 a[70:71], v3 offset:6144
  ds_read_b64_tr_b16 a[96:97], v68 offset:0
  ds_read_b64_tr_b16 a[98:99], v68 offset:2048
  ds_read_b64_tr_b16 a[100:101], v68 offset:4096
  ds_read_b64_tr_b16 a[102:103], v68 offset:6144
  s_waitcnt vmcnt(16) lgkmcnt(0)
  s_barrier
  s_add_u32 m0, s41, 0
  s_mov_b32 s42, 0
  buffer_load_dwordx4 v6, s[8:11], s42 offen lds
  s_add_u32 m0, s41, 1024
  s_mov_b32 s42, 65536
  buffer_load_dwordx4 v6, s[8:11], s42 offen lds
  s_add_u32 m0, s41, 2048
  s_mov_b32 s42, 8192
  buffer_load_dwordx4 v6, s[8:11], s42 offen lds
  s_add_u32 m0, s41, 3072
  s_mov_b32 s42, 73728
  buffer_load_dwordx4 v6, s[8:11], s42 offen lds
  s_add_u32 m0, s41, 4096
  s_mov_b32 s42, 262144
  buffer_load_dwordx4 v6, s[8:11], s42 offen lds
  s_add_u32 m0, s41, 5120
  s_mov_b32 s42, 327680
  buffer_load_dwordx4 v6, s[8:11], s42 offen lds
  s_add_u32 m0, s41, 6144
  s_mov_b32 s42, 270336
  buffer_load_dwordx4 v6, s[8:11], s42 offen lds
  s_add_u32 m0, s41, 7168
  s_mov_b32 s42, 335872
  buffer_load_dwordx4 v6, s[8:11], s42 offen lds
  ds_read_b64_tr_b16 a[8:9], v1 offset:8192
  ds_read_b64_tr_b16 a[10:11], v1 offset:10240
  ds_read_b64_tr_b16 a[12:13], v1 offset:12288
  ds_read_b64_tr_b16 a[14:15], v1 offset:14336
  ds_read_b64_tr_b16 a[40:41], v2 offset:8192
  ds_read_b64_tr_b16 a[42:43], v2 offset:10240
  ds_read_b64_tr_b16 a[44:45], v2 offset:12288
  ds_read_b64_tr_b16 a[46:47], v2 offset:14336
  ds_read_b64_tr_b16 a[72:73], v3 offset:8192
  ds_read_b64_tr_b16 a[74:75], v3 offset:10240
  ds_read_b64_tr_b16 a[76:77], v3 offset:12288
  ds_read_b64_tr_b16 a[78:79], v3 offset:14336
  ds_read_b64_tr_b16 a[104:105], v68 offset:8192
  ds_read_b64_tr_b16 a[106:107], v68 offset:10240
  ds_read_b64_tr_b16 a[108:109], v68 offset:12288
  ds_read_b64_tr_b16 a[110:111], v68 offset:14336
  s_waitcnt vmcnt(16) lgkmcnt(0)
  s_barrier
  s_add_u32 m0, s41, 8192
  s_mov_b32 s42, 2097152
  buffer_load_dwordx4 v6, s[8:11], s42 offen lds
  s_add_u32 m0, s41, 9216
  s_mov_b32 s42, 2162688
  buffer_load_dwordx4 v6, s[8:11], s42 offen lds
  s_add_u32 m0, s41, 10240
  s_mov_b32 s42, 2105344
  buffer_load_dwordx4 v6, s[8:11], s42 offen lds
  s_add_u32 m0, s41, 11264
  s_mov_b32 s42, 2170880
  buffer_load_dwordx4 v6, s[8:11], s42 offen lds
  s_add_u32 m0, s41, 12288
  s_mov_b32 s42, 2359296
  buffer_load_dwordx4 v6, s[8:11], s42 offen lds
  s_add_u32 m0, s41, 13312
  s_mov_b32 s42, 2424832
  buffer_load_dwordx4 v6, s[8:11], s42 offen lds
  s_add_u32 m0, s41, 14336
  s_mov_b32 s42, 2367488
  buffer_load_dwordx4 v6, s[8:11], s42 offen lds
  s_add_u32 m0, s41, 15360
  s_mov_b32 s42, 2433024
  buffer_load_dwordx4 v6, s[8:11], s42 offen lds
  ds_read_b64_tr_b16 a[16:17], v1 offset:16384
  ds_read_b64_tr_b16 a[18:19], v1 offset:18432
  ds_read_b64_tr_b16 a[20:21], v1 offset:20480
  ds_read_b64_tr_b16 a[22:23], v1 offset:22528
  ds_read_b64_tr_b16 a[48:49], v2 offset:16384
  ds_read_b64_tr_b16 a[50:51], v2 offset:18432
  ds_read_b64_tr_b16 a[52:53], v2 offset:20480
  ds_read_b64_tr_b16 a[54:55], v2 offset:22528
  ds_read_b64_tr_b16 a[80:81], v3 offset:16384
  ds_read_b64_tr_b16 a[82:83], v3 offset:18432
  ds_read_b64_tr_b16 a[84:85], v3 offset:20480
  ds_read_b64_tr_b16 a[86:87], v3 offset:22528
  ds_read_b64_tr_b16 a[112:113], v68 offset:16384
  ds_read_b64_tr_b16 a[114:115], v68 offset:18432
  ds_read_b64_tr_b16 a[116:117], v68 offset:20480
  ds_read_b64_tr_b16 a[118:119], v68 offset:22528
  s_waitcnt vmcnt(16) lgkmcnt(0)
  s_barrier
  s_add_u32 m0, s41, 16384
  s_mov_b32 s42, 4194304
  buffer_load_dwordx4 v6, s[8:11], s42 offen lds
  s_add_u32 m0, s41, 17408
  s_mov_b32 s42, 4259840
  buffer_load_dwordx4 v6, s[8:11], s42 offen lds
  s_add_u32 m0, s41, 18432
  s_mov_b32 s42, 4202496
  buffer_load_dwordx4 v6, s[8:11], s42 offen lds
  s_add_u32 m0, s41, 19456
  s_mov_b32 s42, 4268032
  buffer_load_dwordx4 v6, s[8:11], s42 offen lds
  s_add_u32 m0, s41, 20480
  s_mov_b32 s42, 4456448
  buffer_load_dwordx4 v6, s[8:11], s42 offen lds
  s_add_u32 m0, s41, 21504
  s_mov_b32 s42, 4521984
  buffer_load_dwordx4 v6, s[8:11], s42 offen lds
  s_add_u32 m0, s41, 22528
  s_mov_b32 s42, 4464640
  buffer_load_dwordx4 v6, s[8:11], s42 offen lds
  s_add_u32 m0, s41, 23552
  s_mov_b32 s42, 4530176
  buffer_load_dwordx4 v6, s[8:11], s42 offen lds
  ds_read_b64_tr_b16 a[24:25], v1 offset:24576
  ds_read_b64_tr_b16 a[26:27], v1 offset:26624
  ds_read_b64_tr_b16 a[28:29], v1 offset:28672
  ds_read_b64_tr_b16 a[30:31], v1 offset:30720
  ds_read_b64_tr_b16 a[56:57], v2 offset:24576
  ds_read_b64_tr_b16 a[58:59], v2 offset:26624
  ds_read_b64_tr_b16 a[60:61], v2 offset:28672
  ds_read_b64_tr_b16 a[62:63], v2 offset:30720
  ds_read_b64_tr_b16 a[88:89], v3 offset:24576
  ds_read_b64_tr_b16 a[90:91], v3 offset:26624
  ds_read_b64_tr_b16 a[92:93], v3 offset:28672
  ds_read_b64_tr_b16 a[94:95], v3 offset:30720
  ds_read_b64_tr_b16 a[120:121], v68 offset:24576
  ds_read_b64_tr_b16 a[122:123], v68 offset:26624
  ds_read_b64_tr_b16 a[124:125], v68 offset:28672
  ds_read_b64_tr_b16 a[126:127], v68 offset:30720
  s_waitcnt vmcnt(16) lgkmcnt(0)
  s_barrier
  s_add_u32 m0, s41, 24576
  s_mov_b32 s42, 6291456
  buffer_load_dwordx4 v6, s[8:11], s42 offen lds
  s_add_u32 m0, s41, 25600
  s_mov_b32 s42, 6356992
  buffer_load_dwordx4 v6, s[8:11], s42 offen lds
  s_add_u32 m0, s41, 26624
  s_mov_b32 s42, 6299648
  buffer_load_dwordx4 v6, s[8:11], s42 offen lds
  s_add_u32 m0, s41, 27648
  s_mov_b32 s42, 6365184
  buffer_load_dwordx4 v6, s[8:11], s42 offen lds
  s_add_u32 m0, s41, 28672
  s_mov_b32 s42, 6553600
  buffer_load_dwordx4 v6, s[8:11], s42 offen lds
  s_add_u32 m0, s41, 29696
  s_mov_b32 s42, 6619136
  buffer_load_dwordx4 v6, s[8:11], s42 offen lds
  s_add_u32 m0, s41, 30720
  s_mov_b32 s42, 6561792
  buffer_load_dwordx4 v6, s[8:11], s42 offen lds
  s_add_u32 m0, s41, 31744
  s_mov_b32 s42, 6627328
  buffer_load_dwordx4 v6, s[8:11], s42 offen lds
  ds_read_b64_tr_b16 a[128:129], v1 offset:0
  ds_read_b64_tr_b16 a[130:131], v1 offset:2048
  ds_read_b64_tr_b16 a[132:133], v1 offset:4096
  ds_read_b64_tr_b16 a[134:135], v1 offset:6144
  ds_read_b64_tr_b16 a[160:161], v2 offset:0
  ds_read_b64_tr_b16 a[162:163], v2 offset:2048
  ds_read_b64_tr_b16 a[164:165], v2 offset:4096
  ds_read_b64_tr_b16 a[166:167], v2 offset:6144
  ds_read_b64_tr_b16 a[192:193], v3 offset:0
  ds_read_b64_tr_b16 a[194:195], v3 offset:2048
  ds_read_b64_tr_b16 a[196:197], v3 offset:4096
  ds_read_b64_tr_b16 a[198:199], v3 offset:6144
  ds_read_b64_tr_b16 a[224:225], v68 offset:0
  ds_read_b64_tr_b16 a[226:227], v68 offset:2048
  ds_read_b64_tr_b16 a[228:229], v68 offset:4096
  ds_read_b64_tr_b16 a[230:231], v68 offset:6144
  s_waitcnt vmcnt(16) lgkmcnt(0)
  s_barrier
  s_load_dwordx2 s[8:9], s[0:1], 24
  s_mov_b32 s10, 8388608
  s_mov_b32 s11, 0x20000
  s_waitcnt lgkmcnt(0)
  s_add_u32 m0, s41, 0
  s_mov_b32 s42, 0
  buffer_load_dwordx4 v7, s[8:11], s42 offen lds
  s_add_u32 m0, s41, 1024
  s_mov_b32 s42, 65536
  buffer_load_dwordx4 v7, s[8:11], s42 offen lds
  s_add_u32 m0, s41, 2048
  s_mov_b32 s42, 8192
  buffer_load_dwordx4 v7, s[8:11], s42 offen lds
  s_add_u32 m0, s41, 3072
  s_mov_b32 s42, 73728
  buffer_load_dwordx4 v7, s[8:11], s42 offen lds
  s_add_u32 m0, s41, 4096
  s_mov_b32 s42, 262144
  buffer_load_dwordx4 v7, s[8:11], s42 offen lds
  s_add_u32 m0, s41, 5120
  s_mov_b32 s42, 327680
  buffer_load_dwordx4 v7, s[8:11], s42 offen lds
  s_add_u32 m0, s41, 6144
  s_mov_b32 s42, 270336
  buffer_load_dwordx4 v7, s[8:11], s42 offen lds
  s_add_u32 m0, s41, 7168
  s_mov_b32 s42, 335872
  buffer_load_dwordx4 v7, s[8:11], s42 offen lds
  ds_read_b64_tr_b16 a[136:137], v1 offset:8192
  ds_read_b64_tr_b16 a[138:139], v1 offset:10240
  ds_read_b64_tr_b16 a[140:141], v1 offset:12288
  ds_read_b64_tr_b16 a[142:143], v1 offset:14336
  ds_read_b64_tr_b16 a[168:169], v2 offset:8192
  ds_read_b64_tr_b16 a[170:171], v2 offset:10240
  ds_read_b64_tr_b16 a[172:173], v2 offset:12288
  ds_read_b64_tr_b16 a[174:175], v2 offset:14336
  ds_read_b64_tr_b16 a[200:201], v3 offset:8192
  ds_read_b64_tr_b16 a[202:203], v3 offset:10240
  ds_read_b64_tr_b16 a[204:205], v3 offset:12288
  ds_read_b64_tr_b16 a[206:207], v3 offset:14336
  ds_read_b64_tr_b16 a[232:233], v68 offset:8192
  ds_read_b64_tr_b16 a[234:235], v68 offset:10240
  ds_read_b64_tr_b16 a[236:237], v68 offset:12288
  ds_read_b64_tr_b16 a[238:239], v68 offset:14336
  s_waitcnt vmcnt(16) lgkmcnt(0)
  s_barrier
  s_add_u32 m0, s41, 8192
  s_mov_b32 s42, 2097152
  buffer_load_dwordx4 v7, s[8:11], s42 offen lds
  s_add_u32 m0, s41, 9216
  s_mov_b32 s42, 2162688
  buffer_load_dwordx4 v7, s[8:11], s42 offen lds
  s_add_u32 m0, s41, 10240
  s_mov_b32 s42, 2105344
  buffer_load_dwordx4 v7, s[8:11], s42 offen lds
  s_add_u32 m0, s41, 11264
  s_mov_b32 s42, 2170880
  buffer_load_dwordx4 v7, s[8:11], s42 offen lds
  s_add_u32 m0, s41, 12288
  s_mov_b32 s42, 2359296
  buffer_load_dwordx4 v7, s[8:11], s42 offen lds
  s_add_u32 m0, s41, 13312
  s_mov_b32 s42, 2424832
  buffer_load_dwordx4 v7, s[8:11], s42 offen lds
  s_add_u32 m0, s41, 14336
  s_mov_b32 s42, 2367488
  buffer_load_dwordx4 v7, s[8:11], s42 offen lds
  s_add_u32 m0, s41, 15360
  s_mov_b32 s42, 2433024
  buffer_load_dwordx4 v7, s[8:11], s42 offen lds
  ds_read_b64_tr_b16 a[144:145], v1 offset:16384
  ds_read_b64_tr_b16 a[146:147], v1 offset:18432
  ds_read_b64_tr_b16 a[148:149], v1 offset:20480
  ds_read_b64_tr_b16 a[150:151], v1 offset:22528
  ds_read_b64_tr_b16 a[176:177], v2 offset:16384
  ds_read_b64_tr_b16 a[178:179], v2 offset:18432
  ds_read_b64_tr_b16 a[180:181], v2 offset:20480
  ds_read_b64_tr_b16 a[182:183], v2 offset:22528
  ds_read_b64_tr_b16 a[208:209], v3 offset:16384
  ds_read_b64_tr_b16 a[210:211], v3 offset:18432
  ds_read_b64_tr_b16 a[212:213], v3 offset:20480
  ds_read_b64_tr_b16 a[214:215], v3 offset:22528
  ds_read_b64_tr_b16 a[240:241], v68 offset:16384
  ds_read_b64_tr_b16 a[242:243], v68 offset:18432
  ds_read_b64_tr_b16 a[244:245], v68 offset:20480
  ds_read_b64_tr_b16 a[246:247], v68 offset:22528
  s_waitcnt vmcnt(16) lgkmcnt(0)
  s_barrier
  s_add_u32 m0, s41, 16384
  s_mov_b32 s42, 4194304
  buffer_load_dwordx4 v7, s[8:11], s42 offen lds
  s_add_u32 m0, s41, 17408
  s_mov_b32 s42, 4259840
  buffer_load_dwordx4 v7, s[8:11], s42 offen lds
  s_add_u32 m0, s41, 18432
  s_mov_b32 s42, 4202496
  buffer_load_dwordx4 v7, s[8:11], s42 offen lds
  s_add_u32 m0, s41, 19456
  s_mov_b32 s42, 4268032
  buffer_load_dwordx4 v7, s[8:11], s42 offen lds
  s_add_u32 m0, s41, 20480
  s_mov_b32 s42, 4456448
  buffer_load_dwordx4 v7, s[8:11], s42 offen lds
  s_add_u32 m0, s41, 21504
  s_mov_b32 s42, 4521984
  buffer_load_dwordx4 v7, s[8:11], s42 offen lds
  s_add_u32 m0, s41, 22528
  s_mov_b32 s42, 4464640
  buffer_load_dwordx4 v7, s[8:11], s42 offen lds
  s_add_u32 m0, s41, 23552
  s_mov_b32 s42, 4530176
  buffer_load_dwordx4 v7, s[8:11], s42 offen lds
  ds_read_b64_tr_b16 a[152:153], v1 offset:24576
  ds_read_b64_tr_b16 a[154:155], v1 offset:26624
  ds_read_b64_tr_b16 a[156:157], v1 offset:28672
  ds_read_b64_tr_b16 a[158:159], v1 offset:30720
  ds_read_b64_tr_b16 a[184:185], v2 offset:24576
  ds_read_b64_tr_b16 a[186:187], v2 offset:26624
  ds_read_b64_tr_b16 a[188:189], v2 offset:28672
  ds_read_b64_tr_b16 a[190:191], v2 offset:30720
  ds_read_b64_tr_b16 a[216:217], v3 offset:24576
  ds_read_b64_tr_b16 a[218:219], v3 offset:26624
  ds_read_b64_tr_b16 a[220:221], v3 offset:28672
  ds_read_b64_tr_b16 a[222:223], v3 offset:30720
  ds_read_b64_tr_b16 a[248:249], v68 offset:24576
  ds_read_b64_tr_b16 a[250:251], v68 offset:26624
  ds_read_b64_tr_b16 a[252:253], v68 offset:28672
  ds_read_b64_tr_b16 a[254:255], v68 offset:30720
  s_waitcnt vmcnt(16) lgkmcnt(0)
  s_barrier
  s_add_u32 m0, s41, 24576
  s_mov_b32 s42, 6291456
  buffer_load_dwordx4 v7, s[8:11], s42 offen lds
  s_add_u32 m0, s41, 25600
  s_mov_b32 s42, 6356992
  buffer_load_dwordx4 v7, s[8:11], s42 offen lds
  s_add_u32 m0, s41, 26624
  s_mov_b32 s42, 6299648
  buffer_load_dwordx4 v7, s[8:11], s42 offen lds
  s_add_u32 m0, s41, 27648
  s_mov_b32 s42, 6365184
  buffer_load_dwordx4 v7, s[8:11], s42 offen lds
  s_add_u32 m0, s41, 28672
  s_mov_b32 s42, 6553600
  buffer_load_dwordx4 v7, s[8:11], s42 offen lds
  s_add_u32 m0, s41, 29696
  s_mov_b32 s42, 6619136
  buffer_load_dwordx4 v7, s[8:11], s42 offen lds
  s_add_u32 m0, s41, 30720
  s_mov_b32 s42, 6561792
  buffer_load_dwordx4 v7, s[8:11], s42 offen lds
  s_add_u32 m0, s41, 31744
  s_mov_b32 s42, 6627328
  buffer_load_dwordx4 v7, s[8:11], s42 offen lds
  ds_read_b64_tr_b16 v[128:129], v1 offset:0
  ds_read_b64_tr_b16 v[130:131], v1 offset:2048
  ds_read_b64_tr_b16 v[132:133], v1 offset:4096
  ds_read_b64_tr_b16 v[134:135], v1 offset:6144
  ds_read_b64_tr_b16 v[160:161], v2 offset:0
  ds_read_b64_tr_b16 v[162:163], v2 offset:2048
  ds_read_b64_tr_b16 v[164:165], v2 offset:4096
  ds_read_b64_tr_b16 v[166:167], v2 offset:6144
  ds_read_b64_tr_b16 v[192:193], v3 offset:0
  ds_read_b64_tr_b16 v[194:195], v3 offset:2048
  ds_read_b64_tr_b16 v[196:197], v3 offset:4096
  ds_read_b64_tr_b16 v[198:199], v3 offset:6144
  ds_read_b64_tr_b16 v[224:225], v68 offset:0
  ds_read_b64_tr_b16 v[226:227], v68 offset:2048
  ds_read_b64_tr_b16 v[228:229], v68 offset:4096
  ds_read_b64_tr_b16 v[230:231], v68 offset:6144
  s_waitcnt vmcnt(16) lgkmcnt(0)
  s_barrier
  s_add_u32 m0, s41, 0
  s_mov_b32 s42, 0
  buffer_load_dwordx4 v8, s[8:11], s42 offen lds
  s_add_u32 m0, s41, 1024
  s_mov_b32 s42, 65536
  buffer_load_dwordx4 v8, s[8:11], s42 offen lds
  s_add_u32 m0, s41, 2048
  s_mov_b32 s42, 8192
  buffer_load_dwordx4 v8, s[8:11], s42 offen lds
  s_add_u32 m0, s41, 3072
  s_mov_b32 s42, 73728
  buffer_load_dwordx4 v8, s[8:11], s42 offen lds
  s_add_u32 m0, s41, 4096
  s_mov_b32 s42, 262144
  buffer_load_dwordx4 v8, s[8:11], s42 offen lds
  s_add_u32 m0, s41, 5120
  s_mov_b32 s42, 327680
  buffer_load_dwordx4 v8, s[8:11], s42 offen lds
  s_add_u32 m0, s41, 6144
  s_mov_b32 s42, 270336
  buffer_load_dwordx4 v8, s[8:11], s42 offen lds
  s_add_u32 m0, s41, 7168
  s_mov_b32 s42, 335872
  buffer_load_dwordx4 v8, s[8:11], s42 offen lds
  ds_read_b64_tr_b16 v[136:137], v1 offset:8192
  ds_read_b64_tr_b16 v[138:139], v1 offset:10240
  ds_read_b64_tr_b16 v[140:141], v1 offset:12288
  ds_read_b64_tr_b16 v[142:143], v1 offset:14336
  ds_read_b64_tr_b16 v[168:169], v2 offset:8192
  ds_read_b64_tr_b16 v[170:171], v2 offset:10240
  ds_read_b64_tr_b16 v[172:173], v2 offset:12288
  ds_read_b64_tr_b16 v[174:175], v2 offset:14336
  ds_read_b64_tr_b16 v[200:201], v3 offset:8192
  ds_read_b64_tr_b16 v[202:203], v3 offset:10240
  ds_read_b64_tr_b16 v[204:205], v3 offset:12288
  ds_read_b64_tr_b16 v[206:207], v3 offset:14336
  ds_read_b64_tr_b16 v[232:233], v68 offset:8192
  ds_read_b64_tr_b16 v[234:235], v68 offset:10240
  ds_read_b64_tr_b16 v[236:237], v68 offset:12288
  ds_read_b64_tr_b16 v[238:239], v68 offset:14336
  s_waitcnt vmcnt(16) lgkmcnt(0)
  s_barrier
  s_add_u32 m0, s41, 8192
  s_mov_b32 s42, 2097152
  buffer_load_dwordx4 v8, s[8:11], s42 offen lds
  s_add_u32 m0, s41, 9216
  s_mov_b32 s42, 2162688
  buffer_load_dwordx4 v8, s[8:11], s42 offen lds
  s_add_u32 m0, s41, 10240
  s_mov_b32 s42, 2105344
  buffer_load_dwordx4 v8, s[8:11], s42 offen lds
  s_add_u32 m0, s41, 11264
  s_mov_b32 s42, 2170880
  buffer_load_dwordx4 v8, s[8:11], s42 offen lds
  s_add_u32 m0, s41, 12288
  s_mov_b32 s42, 2359296
  buffer_load_dwordx4 v8, s[8:11], s42 offen lds
  s_add_u32 m0, s41, 13312
  s_mov_b32 s42, 2424832
  buffer_load_dwordx4 v8, s[8:11], s42 offen lds
  s_add_u32 m0, s41, 14336
  s_mov_b32 s42, 2367488
  buffer_load_dwordx4 v8, s[8:11], s42 offen lds
  s_add_u32 m0, s41, 15360
  s_mov_b32 s42, 2433024
  buffer_load_dwordx4 v8, s[8:11], s42 offen lds
  ds_read_b64_tr_b16 v[144:145], v1 offset:16384
  ds_read_b64_tr_b16 v[146:147], v1 offset:18432
  ds_read_b64_tr_b16 v[148:149], v1 offset:20480
  ds_read_b64_tr_b16 v[150:151], v1 offset:22528
  ds_read_b64_tr_b16 v[176:177], v2 offset:16384
  ds_read_b64_tr_b16 v[178:179], v2 offset:18432
  ds_read_b64_tr_b16 v[180:181], v2 offset:20480
  ds_read_b64_tr_b16 v[182:183], v2 offset:22528
  ds_read_b64_tr_b16 v[208:209], v3 offset:16384
  ds_read_b64_tr_b16 v[210:211], v3 offset:18432
  ds_read_b64_tr_b16 v[212:213], v3 offset:20480
  ds_read_b64_tr_b16 v[214:215], v3 offset:22528
  ds_read_b64_tr_b16 v[240:241], v68 offset:16384
  ds_read_b64_tr_b16 v[242:243], v68 offset:18432
  ds_read_b64_tr_b16 v[244:245], v68 offset:20480
  ds_read_b64_tr_b16 v[246:247], v68 offset:22528
  s_waitcnt vmcnt(16) lgkmcnt(0)
  s_barrier
  s_add_u32 m0, s41, 16384
  s_mov_b32 s42, 4194304
  buffer_load_dwordx4 v8, s[8:11], s42 offen lds
  s_add_u32 m0, s41, 17408
  s_mov_b32 s42, 4259840
  buffer_load_dwordx4 v8, s[8:11], s42 offen lds
  s_add_u32 m0, s41, 18432
  s_mov_b32 s42, 4202496
  buffer_load_dwordx4 v8, s[8:11], s42 offen lds
  s_add_u32 m0, s41, 19456
  s_mov_b32 s42, 4268032
  buffer_load_dwordx4 v8, s[8:11], s42 offen lds
  s_add_u32 m0, s41, 20480
  s_mov_b32 s42, 4456448
  buffer_load_dwordx4 v8, s[8:11], s42 offen lds
  s_add_u32 m0, s41, 21504
  s_mov_b32 s42, 4521984
  buffer_load_dwordx4 v8, s[8:11], s42 offen lds
  s_add_u32 m0, s41, 22528
  s_mov_b32 s42, 4464640
  buffer_load_dwordx4 v8, s[8:11], s42 offen lds
  s_add_u32 m0, s41, 23552
  s_mov_b32 s42, 4530176
  buffer_load_dwordx4 v8, s[8:11], s42 offen lds
  ds_read_b64_tr_b16 v[152:153], v1 offset:24576
  ds_read_b64_tr_b16 v[154:155], v1 offset:26624
  ds_read_b64_tr_b16 v[156:157], v1 offset:28672
  ds_read_b64_tr_b16 v[158:159], v1 offset:30720
  ds_read_b64_tr_b16 v[184:185], v2 offset:24576
  ds_read_b64_tr_b16 v[186:187], v2 offset:26624
  ds_read_b64_tr_b16 v[188:189], v2 offset:28672
  ds_read_b64_tr_b16 v[190:191], v2 offset:30720
  ds_read_b64_tr_b16 v[216:217], v3 offset:24576
  ds_read_b64_tr_b16 v[218:219], v3 offset:26624
  ds_read_b64_tr_b16 v[220:221], v3 offset:28672
  ds_read_b64_tr_b16 v[222:223], v3 offset:30720
  ds_read_b64_tr_b16 v[248:249], v68 offset:24576
  ds_read_b64_tr_b16 v[250:251], v68 offset:26624
  ds_read_b64_tr_b16 v[252:253], v68 offset:28672
  ds_read_b64_tr_b16 v[254:255], v68 offset:30720
  s_waitcnt vmcnt(16) lgkmcnt(0)
  s_barrier
  s_add_u32 m0, s41, 24576
  s_mov_b32 s42, 6291456
  buffer_load_dwordx4 v8, s[8:11], s42 offen lds
  s_add_u32 m0, s41, 25600
  s_mov_b32 s42, 6356992
  buffer_load_dwordx4 v8, s[8:11], s42 offen lds
  s_add_u32 m0, s41, 26624
  s_mov_b32 s42, 6299648
  buffer_load_dwordx4 v8, s[8:11], s42 offen lds
  s_add_u32 m0, s41, 27648
  s_mov_b32 s42, 6365184
  buffer_load_dwordx4 v8, s[8:11], s42 offen lds
  s_add_u32 m0, s41, 28672
  s_mov_b32 s42, 6553600
  buffer_load_dwordx4 v8, s[8:11], s42 offen lds
  s_add_u32 m0, s41, 29696
  s_mov_b32 s42, 6619136
  buffer_load_dwordx4 v8, s[8:11], s42 offen lds
  s_add_u32 m0, s41, 30720
  s_mov_b32 s42, 6561792
  buffer_load_dwordx4 v8, s[8:11], s42 offen lds
  s_add_u32 m0, s41, 31744
  s_mov_b32 s42, 6627328
  buffer_load_dwordx4 v8, s[8:11], s42 offen lds
  s_waitcnt vmcnt(0)
  s_barrier
  v_min_u32 v84, 31, v0
  v_lshlrev_b32 v84, 2, v84
  v_add_u32 v84, 128, v84
  s_nop 1
Lpoll_31:
  buffer_load_dword v85, v84, s[12:15], 0 offen sc1
  s_sub_u32 s24, s24, 1
  s_cbranch_scc1 L_FAIL
  s_waitcnt vmcnt(0)
  v_cmp_gt_i32 vcc, 1, v85
  s_cbranch_vccz Lpolld_32
  s_sleep 2
  s_branch Lpoll_31
Lpolld_32:
  v_mov_b32 v84, 64
  s_nop 1
Lpoll_33:
  buffer_load_dword v85, v84, s[12:15], 0 offen sc1
  s_sub_u32 s24, s24, 1
  s_cbranch_scc1 L_FAIL
  s_waitcnt vmcnt(0)
  v_cmp_gt_i32 vcc, 1, v85
  s_cbranch_vccz Lpolld_34
  s_sleep 2
  s_branch Lpoll_33
Lpolld_34:
  v_readfirstlane_b32 s26, v85
  s_and_b32 s26, s26, 0x6000
  s_lshr_b32 s40, s20, 1
  s_mul_i32 s40, s40, 32768
  s_and_b32 s41, s20, 1
  s_lshl_b32 s41, s41, 12
  s_add_u32 s40, s40, s41
  v_lshl_add_u32 v73, v0, 4, s40
  v_and_b32 v84, 2, v0
  v_cmp_eq_u32 vcc, 0, v84
  v_mov_b32 v84, 0xeeee
  v_mov_b32 v85, 0x4444
  v_cndmask_b32 v74, v84, v85, vcc
  s_lshr_b32 s40, s21, 2
  s_mul_i32 s40, s40, 32768
  s_and_b32 s41, s21, 3
  s_lshl_b32 s41, s41, 11
  s_add_u32 s47, s40, s41
  s_lshl_b32 s41, s20, 9
  s_add_u32 s47, s47, s41
  v_lshl_add_u32 v78, v0, 3, s47
  s_add_u32 s40, s26, 1310720
  v_mov_b32 v76, s40
  s_add_u32 s40, s40, 128
  s_lshl_b32 s41, s21, 2
  s_add_u32 s41, s41, s20
  s_cmp_eq_u32 s41, 3
  s_cselect_b32 s40, s40, 2147483392
  s_mov_b32 s25, 0
  v_mov_b32 v77, 2147483392
  s_mov_b64 exec, 1
  v_mov_b32 v77, s40
  s_mov_b64 exec, -1
  v_mov_b32 v88, -1
  v_mov_b32 v89, -1
  v_mov_b32 v90, -1
  v_mov_b32 v91, -1
  v_mov_b32 v110, 0
  v_mov_b32 v111, 0
  v_mov_b32 v113, 0
  v_mov_b32 v114, 0
  v_mov_b32 v115, 0
  v_mov_b32 v116, 0
  v_mov_b32 v118, 0
  v_mov_b32 v119, 0
  v_mov_b32 v120, 0x3f803f80
  v_mov_b32 v121, 0x3f803f80
  v_mov_b32 v122, 0x3f803f80
  v_mov_b32 v123, 0x3f803f80
  v_lshlrev_b32 v81, 4, v0
  v_lshlrev_b32 v124, 3, v0
  v_lshrrev_b32 v84, 4, v0
  v_lshlrev_b32 v84, 2, v84
  v_and_b32 v85, 15, v0
  v_sub_u32 v84, v85, v84
  v_mov_b32 v4, 0x3f80
  v_mov_b32 v5, 0x3f800000
  v_mov_b32 v82, 0
  v_mov_b32 v83, 0
  v_cmp_eq_u32 vcc, 0, v84
  s_nop 1
  v_cndmask_b32 v82, v82, v4, vcc
  v_cmp_eq_u32 vcc, 1, v84
  s_nop 1
  v_cndmask_b32 v82, v82, v5, vcc
  v_cmp_eq_u32 vcc, 2, v84
  s_nop 1
  v_cndmask_b32 v83, v83, v4, vcc
  v_cmp_eq_u32 vcc, 3, v84
  s_nop 1
  v_cndmask_b32 v83, v83, v5, vcc
  v_bfe_u32 v84, v0, 4, 1
  v_lshlrev_b32 v84, 1, v84
  v_and_b32 v85, 13, v0
  v_or_b32 v84, v84, v85
  v_lshl_add_u32 v125, v84, 4, s47
  v_lshrrev_b32 v84, 5, v0
  v_lshl_add_u32 v125, v84, 8, v125
  v_and_b32 v84, 2, v0
  v_cmp_eq_u32 vcc, 0, v84
  v_mov_b32 v85, 2147483392
  s_nop 0
  v_cndmask_b32 v125, v125, v85, vcc
  s_lshl_b32 s43, s21, 2
  s_add_u32 s43, s43, s20
  s_lshl_b32 s30, s43, 10
  s_add_u32 s30, s30, 14680064
  s_lshl_b32 s31, s43, 9
  s_add_u32 s31, s31, 23068672
  s_mul_i32 s32, s21, 24576
  s_lshl_b32 s40, s20, 11
  s_add_u32 s32, s32, s40
  s_add_u32 s32, s32, 58728448
  s_lshl_b32 s44, s21, 1
  s_lshl_b32 s40, s43, 7
  s_add_u32 s40, s40, 1404928
  s_mov_b32 s38, 0x3e0293ee
  s_mov_b32 s39, s38
  s_mov_b32 s60, 0
  s_mov_b32 s61, 0
  v_mov_b32 v127, 2147483392
  s_mov_b64 exec, 1
  v_mov_b32 v127, s40
  s_mov_b64 exec, -1
  v_min_u32 v126, 1, v0
  v_add_u32 v126, s44, v126
  v_lshlrev_b32 v126, 7, v126
  v_add_u32 v126, 1396736, v126
  s_nop 1
L_QK_top:
  s_add_u32 s33, s25, 1
Lpoll_35:
  buffer_load_dword v84, v126, s[4:7], 0 offen sc1
  s_sub_u32 s24, s24, 1
  s_cbranch_scc1 L_FAIL
  s_waitcnt vmcnt(0)
  v_cmp_gt_i32 vcc, s33, v84
  s_cbranch_vccz Lpolld_36
  s_sleep 2
  s_branch Lpoll_35
Lpolld_36:
  s_add_u32 s40, s32, 8192
  buffer_load_dwordx4 v[92:95], v81, s[4:7], s32 offen sc1
  buffer_load_dwordx4 v[96:99], v81, s[4:7], s32 offen offset:1024 sc1
  buffer_load_dwordx4 v[100:103], v81, s[4:7], s40 offen sc1
  buffer_load_dwordx4 v[104:107], v81, s[4:7], s40 offen offset:1024 sc1
  v_mov_b32 v80, s25
  s_and_b32 s40, s25, 3
  s_lshl_b32 s40, s40, 16
  s_add_u32 s27, s40, s26
  s_add_u32 s27, s27, 1048576
  s_and_b32 s40, s25, 1
  s_lshl_b32 s40, s40, 18
  s_add_u32 s28, s40, s26
  s_xor_b32 s29, s28, 0x4000
  s_xor_b32 s34, s28, 262144
  v_mov_b64 v[52:53], 0
  v_mov_b64 v[54:55], 0
  v_mov_b64 v[56:57], 0
  v_mov_b64 v[58:59], 0
  v_mov_b64 v[60:61], 0
  v_mov_b64 v[62:63], 0
  v_mov_b64 v[64:65], 0
  v_mov_b64 v[66:67], 0
  ds_read_b64_tr_b16 v[20:21], v1 offset:0
  ds_read_b64_tr_b16 v[22:23], v1 offset:2048
  ds_read_b64_tr_b16 v[24:25], v1 offset:4096
  ds_read_b64_tr_b16 v[26:27], v1 offset:6144
  ds_read_b64_tr_b16 v[28:29], v1 offset:8192
  ds_read_b64_tr_b16 v[30:31], v1 offset:10240
  ds_read_b64_tr_b16 v[32:33], v1 offset:12288
  ds_read_b64_tr_b16 v[34:35], v1 offset:14336
  ds_read_b64_tr_b16 v[36:37], v1 offset:16384
  ds_read_b64_tr_b16 v[38:39], v1 offset:18432
  ds_read_b64_tr_b16 v[40:41], v1 offset:20480
  ds_read_b64_tr_b16 v[42:43], v1 offset:22528
  ds_read_b64_tr_b16 v[44:45], v1 offset:24576
  ds_read_b64_tr_b16 v[46:47], v1 offset:26624
  ds_read_b64_tr_b16 v[48:49], v1 offset:28672
  ds_read_b64_tr_b16 v[50:51], v1 offset:30720
  s_cmp_lg_u32 s20, 0
  s_cbranch_scc1 Ltrigd_38
  s_mov_b64 exec, 1
  buffer_load_dword v84, v76, s[4:7], 0 offen offset:0 sc1
  s_sleep 1
  buffer_load_dword v85, v76, s[4:7], 0 offen offset:0 sc1
  s_sleep 1
  buffer_load_dword v86, v76, s[4:7], 0 offen offset:0 sc1
  s_sleep 1
Ltrig_37:
  s_sub_u32 s24, s24, 1
  s_cbranch_scc1 L_FAIL
  buffer_load_dword v87, v76, s[4:7], 0 offen offset:0 sc1
  s_waitcnt vmcnt(3)
  v_cmp_gt_i32 vcc, s25, v84
  s_cbranch_vccz Ltrigd_38
  buffer_load_dword v84, v76, s[4:7], 0 offen offset:0 sc1
  s_waitcnt vmcnt(3)
  v_cmp_gt_i32 vcc, s25, v85
  s_cbranch_vccz Ltrigd_38
  buffer_load_dword v85, v76, s[4:7], 0 offen offset:0 sc1
  s_waitcnt vmcnt(3)
  v_cmp_gt_i32 vcc, s25, v86
  s_cbranch_vccz Ltrigd_38
  buffer_load_dword v86, v76, s[4:7], 0 offen offset:0 sc1
  s_waitcnt vmcnt(3)
  v_cmp_gt_i32 vcc, s25, v87
  s_cbranch_vccnz Ltrig_37
Ltrigd_38:
  s_mov_b64 exec, -1
  s_barrier
L_QK_retry:
  buffer_load_dwordx4 v[4:7], v73, s[4:7], s27 offen offset:0 sc1
  s_nop 0
  buffer_load_dwordx4 v[8:11], v73, s[4:7], s27 offen offset:1024 sc1
  s_nop 0
  buffer_load_dwordx4 v[12:15], v73, s[4:7], s27 offen offset:2048 sc1
  s_nop 0
  buffer_load_dwordx4 v[16:19], v73, s[4:7], s27 offen offset:3072 sc1
  s_waitcnt lgkmcnt(0)
  s_waitcnt vmcnt(3)
  v_smfmac_f32_16x16x64_bf16 v[52:55], v[4:7], a[0:7], v74
  ds_write_b128 v69, v[4:7] offset:0
  v_smfmac_f32_16x16x64_bf16 v[60:63], v[4:7], v[128:135], v74
  v_max3_u32 v75, v4, v5, v6
  v_smfmac_f32_16x16x64_bf16 v[56:59], v[4:7], a[128:135], v74
  v_max3_u32 v75, v6, v7, v75
  v_smfmac_f32_16x16x64_bf16 v[64:67], v[4:7], v[20:27], v74
  s_waitcnt vmcnt(2)
  v_smfmac_f32_16x16x64_bf16 v[52:55], v[8:11], a[8:15], v74
  ds_write_b128 v69, v[8:11] offset:1024
  v_max3_u32 v75, v8, v9, v75
  v_smfmac_f32_16x16x64_bf16 v[60:63], v[8:11], v[136:143], v74
  v_max3_u32 v75, v10, v11, v75
  ds_read_b64_tr_b16 v[20:21], v2 offset:0
  v_smfmac_f32_16x16x64_bf16 v[56:59], v[8:11], a[136:143], v74
  ds_read_b64_tr_b16 v[22:23], v2 offset:2048
  ds_read_b64_tr_b16 v[24:25], v2 offset:4096
  v_smfmac_f32_16x16x64_bf16 v[64:67], v[8:11], v[28:35], v74
  ds_read_b64_tr_b16 v[26:27], v2 offset:6144
  s_waitcnt vmcnt(1)
  v_smfmac_f32_16x16x64_bf16 v[52:55], v[12:15], a[16:23], v74
  ds_write_b128 v69, v[12:15] offset:2048
  v_max3_u32 v75, v12, v13, v75
  v_smfmac_f32_16x16x64_bf16 v[60:63], v[12:15], v[144:151], v74
  v_max3_u32 v75, v14, v15, v75
  ds_read_b64_tr_b16 v[28:29], v2 offset:8192
  v_smfmac_f32_16x16x64_bf16 v[56:59], v[12:15], a[144:151], v74
  ds_read_b64_tr_b16 v[30:31], v2 offset:10240
  ds_read_b64_tr_b16 v[32:33], v2 offset:12288
  v_smfmac_f32_16x16x64_bf16 v[64:67], v[12:15], v[36:43], v74
  ds_read_b64_tr_b16 v[34:35], v2 offset:14336
  s_waitcnt vmcnt(0)
  ds_write_b128 v69, v[16:19] offset:3072
  v_max3_u32 v75, v16, v17, v75
  v_max3_u32 v75, v18, v19, v75
  v_cmp_eq_u32 vcc, -1, v75
  s_cbranch_vccnz L_QK_bad
  s_waitcnt lgkmcnt(0)
  s_barrier
  ds_read_b128 v[4:7], v70 offset:0
  ds_read_b128 v[8:11], v70 offset:1024
  ds_read_b128 v[12:15], v70 offset:2048
  v_smfmac_f32_16x16x64_bf16 v[52:55], v[16:19], a[24:31], v74
  ds_read_b64_tr_b16 v[36:37], v2 offset:16384
  ds_read_b64_tr_b16 v[38:39], v2 offset:18432
  v_smfmac_f32_16x16x64_bf16 v[60:63], v[16:19], v[152:159], v74
  ds_read_b64_tr_b16 v[40:41], v2 offset:20480
  ds_read_b64_tr_b16 v[42:43], v2 offset:22528
  v_smfmac_f32_16x16x64_bf16 v[56:59], v[16:19], a[152:159], v74
  buffer_store_dwordx4 v[88:91], v125, s[4:7], s34 offen sc1
  v_smfmac_f32_16x16x64_bf16 v[64:67], v[16:19], v[44:51], v74
  s_waitcnt lgkmcnt(6)
  v_smfmac_f32_16x16x64_bf16 v[52:55], v[4:7], a[32:39], v74
  ds_read_b128 v[16:19], v70 offset:3072
  ds_read_b64_tr_b16 v[44:45], v2 offset:24576
  v_smfmac_f32_16x16x64_bf16 v[60:63], v[4:7], v[160:167], v74
  ds_read_b64_tr_b16 v[46:47], v2 offset:26624
  ds_read_b64_tr_b16 v[48:49], v2 offset:28672
  v_smfmac_f32_16x16x64_bf16 v[56:59], v[4:7], a[160:167], v74
  ds_read_b64_tr_b16 v[50:51], v2 offset:30720
  v_smfmac_f32_16x16x64_bf16 v[64:67], v[4:7], v[20:27], v74
  s_waitcnt lgkmcnt(10)
  v_smfmac_f32_16x16x64_bf16 v[52:55], v[8:11], a[40:47], v74
  ds_read_b128 v[4:7], v71 offset:0
  ds_read_b64_tr_b16 v[20:21], v3 offset:0
  v_smfmac_f32_16x16x64_bf16 v[60:63], v[8:11], v[168:175], v74
  ds_read_b64_tr_b16 v[22:23], v3 offset:2048
  ds_read_b64_tr_b16 v[24:25], v3 offset:4096
  v_smfmac_f32_16x16x64_bf16 v[56:59], v[8:11], a[168:175], v74
  ds_read_b64_tr_b16 v[26:27], v3 offset:6144
  v_smfmac_f32_16x16x64_bf16 v[64:67], v[8:11], v[28:35], v74
  s_waitcnt lgkmcnt(10)
  v_smfmac_f32_16x16x64_bf16 v[52:55], v[12:15], a[48:55], v74
  ds_read_b128 v[8:11], v71 offset:1024
  ds_read_b64_tr_b16 v[28:29], v3 offset:8192
  v_smfmac_f32_16x16x64_bf16 v[60:63], v[12:15], v[176:183], v74
  ds_read_b64_tr_b16 v[30:31], v3 offset:10240
  ds_read_b64_tr_b16 v[32:33], v3 offset:12288
  v_smfmac_f32_16x16x64_bf16 v[56:59], v[12:15], a[176:183], v74
  ds_read_b64_tr_b16 v[34:35], v3 offset:14336
  v_smfmac_f32_16x16x64_bf16 v[64:67], v[12:15], v[36:43], v74
  s_waitcnt lgkmcnt(10)
  v_smfmac_f32_16x16x64_bf16 v[52:55], v[16:19], a[56:63], v74
  ds_read_b128 v[12:15], v71 offset:2048
  ds_read_b64_tr_b16 v[36:37], v3 offset:16384
  v_smfmac_f32_16x16x64_bf16 v[60:63], v[16:19], v[184:191], v74
  ds_read_b64_tr_b16 v[38:39], v3 offset:18432
  ds_read_b64_tr_b16 v[40:41], v3 offset:20480
  v_smfmac_f32_16x16x64_bf16 v[56:59], v[16:19], a[184:191], v74
  ds_read_b64_tr_b16 v[42:43], v3 offset:22528
  v_smfmac_f32_16x16x64_bf16 v[64:67], v[16:19], v[44:51], v74
  s_waitcnt lgkmcnt(10)
  v_smfmac_f32_16x16x64_bf16 v[52:55], v[4:7], a[64:71], v74
  ds_read_b128 v[16:19], v71 offset:3072
  ds_read_b64_tr_b16 v[44:45], v3 offset:24576
  v_smfmac_f32_16x16x64_bf16 v[60:63], v[4:7], v[192:199], v74
  ds_read_b64_tr_b16 v[46:47], v3 offset:26624
  ds_read_b64_tr_b16 v[48:49], v3 offset:28672
  v_smfmac_f32_16x16x64_bf16 v[56:59], v[4:7], a[192:199], v74
  ds_read_b64_tr_b16 v[50:51], v3 offset:30720
  v_smfmac_f32_16x16x64_bf16 v[64:67], v[4:7], v[20:27], v74
  s_waitcnt lgkmcnt(10)
  v_smfmac_f32_16x16x64_bf16 v[52:55], v[8:11], a[72:79], v74
  ds_read_b128 v[4:7], v72 offset:0
  ds_read_b64_tr_b16 v[20:21], v68 offset:0
  v_smfmac_f32_16x16x64_bf16 v[60:63], v[8:11], v[200:207], v74
  ds_read_b64_tr_b16 v[22:23], v68 offset:2048
  ds_read_b64_tr_b16 v[24:25], v68 offset:4096
  v_smfmac_f32_16x16x64_bf16 v[56:59], v[8:11], a[200:207], v74
  ds_read_b64_tr_b16 v[26:27], v68 offset:6144
  v_smfmac_f32_16x16x64_bf16 v[64:67], v[8:11], v[28:35], v74
  s_waitcnt lgkmcnt(10)
  v_smfmac_f32_16x16x64_bf16 v[52:55], v[12:15], a[80:87], v74
  ds_read_b128 v[8:11], v72 offset:1024
  ds_read_b64_tr_b16 v[28:29], v68 offset:8192
  v_smfmac_f32_16x16x64_bf16 v[60:63], v[12:15], v[208:215], v74
  ds_read_b64_tr_b16 v[30:31], v68 offset:10240
  ds_read_b64_tr_b16 v[32:33], v68 offset:12288
  v_smfmac_f32_16x16x64_bf16 v[56:59], v[12:15], a[208:215], v74
  ds_read_b64_tr_b16 v[34:35], v68 offset:14336
  v_smfmac_f32_16x16x64_bf16 v[64:67], v[12:15], v[36:43], v74
  s_waitcnt lgkmcnt(10)
  v_smfmac_f32_16x16x64_bf16 v[52:55], v[16:19], a[88:95], v74
  ds_read_b128 v[12:15], v72 offset:2048
  ds_read_b64_tr_b16 v[36:37], v68 offset:16384
  v_smfmac_f32_16x16x64_bf16 v[60:63], v[16:19], v[216:223], v74
  ds_read_b64_tr_b16 v[38:39], v68 offset:18432
  ds_read_b64_tr_b16 v[40:41], v68 offset:20480
  v_smfmac_f32_16x16x64_bf16 v[56:59], v[16:19], a[216:223], v74
  ds_read_b64_tr_b16 v[42:43], v68 offset:22528
  v_smfmac_f32_16x16x64_bf16 v[64:67], v[16:19], v[44:51], v74
  s_waitcnt lgkmcnt(10)
  v_smfmac_f32_16x16x64_bf16 v[52:55], v[4:7], a[96:103], v74
  ds_read_b128 v[16:19], v72 offset:3072
  ds_read_b64_tr_b16 v[44:45], v68 offset:24576
  v_smfmac_f32_16x16x64_bf16 v[60:63], v[4:7], v[224:231], v74
  ds_read_b64_tr_b16 v[46:47], v68 offset:26624
  ds_read_b64_tr_b16 v[48:49], v68 offset:28672
  v_smfmac_f32_16x16x64_bf16 v[56:59], v[4:7], a[224:231], v74
  ds_read_b64_tr_b16 v[50:51], v68 offset:30720
  v_smfmac_f32_16x16x64_bf16 v[64:67], v[4:7], v[20:27], v74
  s_waitcnt lgkmcnt(10)
  v_smfmac_f32_16x16x64_bf16 v[52:55], v[8:11], a[104:111], v74
  v_smfmac_f32_16x16x64_bf16 v[60:63], v[8:11], v[232:239], v74
  v_smfmac_f32_16x16x64_bf16 v[56:59], v[8:11], a[232:239], v74
  v_smfmac_f32_16x16x64_bf16 v[64:67], v[8:11], v[28:35], v74
  s_waitcnt lgkmcnt(5)
  v_smfmac_f32_16x16x64_bf16 v[52:55], v[12:15], a[112:119], v74
  v_smfmac_f32_16x16x64_bf16 v[60:63], v[12:15], v[240:247], v74
  v_smfmac_f32_16x16x64_bf16 v[56:59], v[12:15], a[240:247], v74
  v_smfmac_f32_16x16x64_bf16 v[64:67], v[12:15], v[36:43], v74
  s_waitcnt lgkmcnt(0)
  v_smfmac_f32_16x16x64_bf16 v[52:55], v[16:19], a[120:127], v74
  v_smfmac_f32_16x16x64_bf16 v[60:63], v[16:19], v[248:255], v74
  v_smfmac_f32_16x16x64_bf16 v[56:59], v[16:19], a[248:255], v74
  v_smfmac_f32_16x16x64_bf16 v[64:67], v[16:19], v[44:51], v74
  s_nop 5
  v_pk_add_f32 v[60:61], v[60:61], v[62:63]
  v_pk_add_f32 v[52:53], v[52:53], v[54:55]
  v_cvt_pk_bf16_f32 v4, v60, v61
  v_cvt_pk_bf16_f32 v5, v52, v53
  s_nop 1
  v_mfma_f32_16x16x16_bf16 v[8:11], v[4:5], v[82:83], 0
  v_pk_add_f32 v[64:65], v[64:65], v[66:67]
  v_pk_add_f32 v[56:57], v[56:57], v[58:59]
  v_cvt_pk_bf16_f32 v6, v64, v65
  v_cvt_pk_bf16_f32 v7, v56, v57
  s_nop 1
  v_mfma_f32_16x16x16_bf16 v[12:15], v[6:7], v[82:83], 0
  s_nop 0
  v_cvt_pk_bf16_f32 v16, v8, v9
  v_cvt_pk_bf16_f32 v17, v10, v11
  s_nop 4
  v_cvt_pk_bf16_f32 v18, v12, v13
  v_cvt_pk_bf16_f32 v19, v14, v15
  s_nop 1
  v_mfma_f32_16x16x32_bf16 v[52:55], v[92:95], v[16:19], 0
  v_mfma_f32_16x16x32_bf16 v[56:59], v[96:99], v[16:19], 0
  v_mfma_f32_16x16x32_bf16 v[60:63], v[16:19], v[16:19], 0
  buffer_load_dwordx2 v[108:109], v78, s[4:7], s29 offen sc1
  buffer_store_dword v80, v77, s[4:7], 0 offen sc1
  s_nop 3
  ds_write_b128 v69, v[52:55] offset:16384
  ds_write_b128 v69, v[56:59] offset:17408
  ds_write_b64 v69, v[60:61] offset:18432
  s_waitcnt lgkmcnt(0)
  s_barrier
  ds_read_b128 v[20:23], v70 offset:16384
  ds_read_b128 v[24:27], v70 offset:17408
  ds_read_b64 v[44:45], v70 offset:18432
  ds_read_b128 v[28:31], v71 offset:16384
  ds_read_b128 v[32:35], v71 offset:17408
  ds_read_b64 v[46:47], v71 offset:18432
  ds_read_b128 v[36:39], v72 offset:16384
  ds_read_b128 v[40:43], v72 offset:17408
  ds_read_b64 v[48:49], v72 offset:18432
  s_waitcnt lgkmcnt(6)
  v_pk_add_f32 v[52:53], v[52:53], v[20:21]
  v_pk_add_f32 v[54:55], v[54:55], v[22:23]
  v_pk_add_f32 v[56:57], v[56:57], v[24:25]
  v_pk_add_f32 v[58:59], v[58:59], v[26:27]
  v_pk_add_f32 v[60:61], v[60:61], v[44:45]
  s_waitcnt lgkmcnt(3)
  v_pk_add_f32 v[52:53], v[52:53], v[28:29]
  v_pk_add_f32 v[54:55], v[54:55], v[30:31]
  v_pk_add_f32 v[56:57], v[56:57], v[32:33]
  v_pk_add_f32 v[58:59], v[58:59], v[34:35]
  v_pk_add_f32 v[60:61], v[60:61], v[46:47]
  s_waitcnt lgkmcnt(0)
  v_pk_add_f32 v[52:53], v[52:53], v[36:37]
  v_pk_add_f32 v[54:55], v[54:55], v[38:39]
  v_pk_add_f32 v[56:57], v[56:57], v[40:41]
  v_pk_add_f32 v[58:59], v[58:59], v[42:43]
  v_pk_add_f32 v[60:61], v[60:61], v[48:49]
  v_max3_f32 v64, v52, v53, v54
  v_max3_f32 v65, v55, v56, v57
  v_max3_f32 v64, v64, v58, v59
  v_max3_f32 v65, v65, v60, v61
  v_max_f32 v64, v64, v65
  v_mov_b32 v65, v64
  s_nop 1
  v_permlane16_swap_b32 v65, v64
  v_max_f32 v64, v64, v65
  v_mov_b32 v65, v64
  s_nop 1
  v_permlane32_swap_b32 v65, v64
  v_max_f32 v64, v64, v65
  v_mul_f32 v64, s38, v64
  v_pk_fma_f32 v[52:53], v[52:53], s[38:39], v[64:65] op_sel_hi:[1,1,0] neg_lo:[0,0,1] neg_hi:[0,0,1]
  v_pk_fma_f32 v[54:55], v[54:55], s[38:39], v[64:65] op_sel_hi:[1,1,0] neg_lo:[0,0,1] neg_hi:[0,0,1]
  v_pk_fma_f32 v[56:57], v[56:57], s[38:39], v[64:65] op_sel_hi:[1,1,0] neg_lo:[0,0,1] neg_hi:[0,0,1]
  v_pk_fma_f32 v[58:59], v[58:59], s[38:39], v[64:65] op_sel_hi:[1,1,0] neg_lo:[0,0,1] neg_hi:[0,0,1]
  v_pk_fma_f32 v[60:61], v[60:61], s[38:39], v[64:65] op_sel_hi:[1,1,0] neg_lo:[0,0,1] neg_hi:[0,0,1]
  v_exp_f32 v52, v52
  v_exp_f32 v53, v53
  v_exp_f32 v54, v54
  v_exp_f32 v55, v55
  v_exp_f32 v56, v56
  v_exp_f32 v57, v57
  v_exp_f32 v58, v58
  v_exp_f32 v59, v59
  v_cvt_pk_bf16_f32 v4, v52, v53
  v_cvt_pk_bf16_f32 v5, v54, v55
  v_cvt_pk_bf16_f32 v6, v56, v57
  v_cvt_pk_bf16_f32 v7, v58, v59
  v_exp_f32 v60, v60
  v_exp_f32 v61, v61
  v_mfma_f32_16x16x32_bf16 v[28:31], v[120:123], v[4:7], 0
  v_cvt_pk_bf16_f32 v112, v60, v61
  v_mfma_f32_16x16x32_bf16 v[20:23], v[100:103], v[4:7], 0
  v_cvt_pk_bf16_f32 v117, v60, v61
  v_mfma_f32_16x16x32_bf16 v[24:27], v[104:107], v[4:7], 0
  v_mfma_f32_16x16x32_bf16 v[28:31], v[120:123], v[112:115], v[28:31]
L_QK_vchk:
  s_waitcnt vmcnt(1)
  v_max_u32 v75, v108, v109
  v_cmp_eq_u32 vcc, -1, v75
  s_cbranch_vccnz L_QK_vbad
  v_mfma_f32_16x16x32_bf16 v[20:23], v[108:111], v[112:115], v[20:23]
  v_mfma_f32_16x16x32_bf16 v[24:27], v[108:111], v[116:119], v[24:27]
  s_nop 1
  v_rcp_f32 v28, v28
  s_nop 3
  v_pk_mul_f32 v[20:21], v[20:21], v[28:29] op_sel_hi:[1,0]
  v_pk_mul_f32 v[22:23], v[22:23], v[28:29] op_sel_hi:[1,0]
  v_pk_mul_f32 v[24:25], v[24:25], v[28:29] op_sel_hi:[1,0]
  v_pk_mul_f32 v[26:27], v[26:27], v[28:29] op_sel_hi:[1,0]
  v_cvt_pk_bf16_f32 v8, v20, v21
  v_cvt_pk_bf16_f32 v9, v22, v23
  v_cvt_pk_bf16_f32 v10, v24, v25
  v_cvt_pk_bf16_f32 v11, v26, v27
  v_min_u32 v8, -2, v8
  v_min_u32 v9, -2, v9
  v_min_u32 v10, -2, v10
  v_min_u32 v11, -2, v11
  buffer_store_dwordx4 v[8:11], v125, s[4:7], s28 offen sc1
  buffer_store_dwordx4 v[16:19], v81, s[4:7], s30 offen sc1
  buffer_store_dwordx2 v[108:109], v124, s[4:7], s31 offen sc1
  v_mov_b32 v85, s33
  s_add_u32 s30, s30, 131072
  s_add_u32 s31, s31, 65536
  s_add_u32 s32, s32, 786432
  s_waitcnt vmcnt(0)
  buffer_store_dword v85, v127, s[4:7], 0 offen sc1
  s_add_u32 s25, s25, 1
  s_cmp_lt_u32 s25, 64
  s_cbranch_scc1 L_QK_top
  s_branch L_END
L_QK_bad:
  s_nop 7
  s_sub_u32 s24, s24, 1
  s_cbranch_scc1 L_FAIL
  s_add_u32 s60, s60, 1
  s_waitcnt lgkmcnt(0)
  v_mov_b64 v[52:53], 0
  v_mov_b64 v[54:55], 0
  v_mov_b64 v[56:57], 0
  v_mov_b64 v[58:59], 0
  v_mov_b64 v[60:61], 0
  v_mov_b64 v[62:63], 0
  v_mov_b64 v[64:65], 0
  v_mov_b64 v[66:67], 0
  ds_read_b64_tr_b16 v[20:21], v1 offset:0
  ds_read_b64_tr_b16 v[22:23], v1 offset:2048
  ds_read_b64_tr_b16 v[24:25], v1 offset:4096
  ds_read_b64_tr_b16 v[26:27], v1 offset:6144
  ds_read_b64_tr_b16 v[28:29], v1 offset:8192
  ds_read_b64_tr_b16 v[30:31], v1 offset:10240
  ds_read_b64_tr_b16 v[32:33], v1 offset:12288
  ds_read_b64_tr_b16 v[34:35], v1 offset:14336
  ds_read_b64_tr_b16 v[36:37], v1 offset:16384
  ds_read_b64_tr_b16 v[38:39], v1 offset:18432
  ds_read_b64_tr_b16 v[40:41], v1 offset:20480
  ds_read_b64_tr_b16 v[42:43], v1 offset:22528
  ds_read_b64_tr_b16 v[44:45], v1 offset:24576
  ds_read_b64_tr_b16 v[46:47], v1 offset:26624
  ds_read_b64_tr_b16 v[48:49], v1 offset:28672
  ds_read_b64_tr_b16 v[50:51], v1 offset:30720
  s_branch L_QK_retry
L_QK_vbad:
  s_sub_u32 s24, s24, 1
  s_cbranch_scc1 L_FAIL
  s_add_u32 s61, s61, 1
  buffer_load_dwordx2 v[108:109], v78, s[4:7], s29 offen sc1
  s_waitcnt vmcnt(0)
  s_branch L_QK_vchk
L_VO:
  v_bfe_u32 v84, v0, 3, 2
  v_xor_b32 v84, s20, v84
  v_lshlrev_b32 v84, 5, v84
  v_lshrrev_b32 v1, 2, v0
  v_lshl_add_u32 v1, v1, 7, v84
  v_and_b32 v84, 3, v0
  v_lshl_add_u32 v1, v84, 3, v1
  s_lshl_b32 s40, s20, 15
  v_add_u32 v1, s40, v1
  s_lshl_b32 s40, s20, 12
  s_add_u32 s40, s40, 131072
  v_lshl_add_u32 v69, v0, 4, s40
  v_xor_b32 v2, 32768, v1
  v_xor_b32 v70, 4096, v69
  v_xor_b32 v3, 65536, v1
  v_xor_b32 v71, 8192, v69
  v_xor_b32 v68, 98304, v1
  v_xor_b32 v72, 12288, v69
  v_bfe_u32 v4, v0, 5, 1
  v_mul_u32_u24 v4, 16384, v4
  v_bfe_u32 v84, v0, 4, 1
  v_mul_u32_u24 v84, 32768, v84
  v_add_u32 v4, v4, v84
  v_bfe_u32 v84, v0, 3, 1
  v_mul_u32_u24 v84, 131072, v84
  v_add_u32 v4, v4, v84
  v_lshrrev_b32 v84, 3, v0
  v_and_b32 v84, 6, v84
  v_xor_b32 v84, v84, v0
  v_and_b32 v84, 7, v84
  v_lshl_add_u32 v4, v84, 4, v4
  s_lshl_b32 s40, s20, 19
  v_add_u32 v4, s40, v4
  v_bfe_u32 v5, v0, 5, 1
  v_mul_u32_u24 v5, 131072, v5
  v_bfe_u32 v84, v0, 4, 1
  v_mul_u32_u24 v84, 8192, v84
  v_add_u32 v5, v5, v84
  v_bfe_u32 v84, v0, 3, 1
  v_mul_u32_u24 v84, 2048, v84
  v_add_u32 v5, v5, v84
  v_lshrrev_b32 v84, 3, v0
  v_and_b32 v84, 6, v84
  v_xor_b32 v84, v84, v0
  v_and_b32 v84, 3, v84
  v_lshl_add_u32 v5, v84, 4, v5
  v_lshrrev_b32 v84, 3, v0
  v_xor_b32 v84, v84, v0
  v_bfe_u32 v84, v84, 2, 1
  v_mul_u32_u24 v84, 65536, v84
  v_add_u32 v5, v5, v84
  v_bfe_u32 v84, v0, 3, 2
  v_xor_b32 v84, 0, v84
  v_lshlrev_b32 v84, 5, v84
  v_lshrrev_b32 v6, 2, v0
  v_lshl_add_u32 v6, v6, 7, v84
  v_and_b32 v84, 3, v0
  v_lshl_add_u32 v6, v84, 3, v6
  s_lshl_b32 s40, s20, 21
  s_lshl_b32 s41, s21, 6
  s_add_u32 s40, s40, s41
  v_add_u32 v5, s40, v5
  s_lshl_b32 s40, s20, 15
  v_add_u32 v6, s40, v6
  s_lshl_b32 s44, s21, 8
  s_add_u32 s45, s44, 128
  v_xor_b32 v7, 32, v6
  v_xor_b32 v8, 64, v6
  v_xor_b32 v9, 96, v6
  s_load_dwordx2 s[8:9], s[0:1], 40
  s_mov_b32 s10, 8388608
  s_mov_b32 s11, 0x20000
  s_waitcnt lgkmcnt(0)
  v_add_u32 v10, s44, v4
  v_add_u32 v11, s45, v4
  s_lshl_b32 s41, s20, 15
  s_add_u32 m0, s41, 0
  s_mov_b32 s42, 0
  buffer_load_dwordx4 v5, s[8:11], s42 offen lds
  s_add_u32 m0, s41, 1024
  s_mov_b32 s42, 16384
  buffer_load_dwordx4 v5, s[8:11], s42 offen lds
  s_add_u32 m0, s41, 2048
  s_mov_b32 s42, 4096
  buffer_load_dwordx4 v5, s[8:11], s42 offen lds
  s_add_u32 m0, s41, 3072
  s_mov_b32 s42, 20480
  buffer_load_dwordx4 v5, s[8:11], s42 offen lds
  s_add_u32 m0, s41, 4096
  s_mov_b32 s42, 32768
  buffer_load_dwordx4 v5, s[8:11], s42 offen lds
  s_add_u32 m0, s41, 5120
  s_mov_b32 s42, 49152
  buffer_load_dwordx4 v5, s[8:11], s42 offen lds
  s_add_u32 m0, s41, 6144
  s_mov_b32 s42, 36864
  buffer_load_dwordx4 v5, s[8:11], s42 offen lds
  s_add_u32 m0, s41, 7168
  s_mov_b32 s42, 53248
  buffer_load_dwordx4 v5, s[8:11], s42 offen lds
  s_add_u32 m0, s41, 8192
  s_mov_b32 s42, 262144
  buffer_load_dwordx4 v5, s[8:11], s42 offen lds
  s_add_u32 m0, s41, 9216
  s_mov_b32 s42, 278528
  buffer_load_dwordx4 v5, s[8:11], s42 offen lds
  s_add_u32 m0, s41, 10240
  s_mov_b32 s42, 266240
  buffer_load_dwordx4 v5, s[8:11], s42 offen lds
  s_add_u32 m0, s41, 11264
  s_mov_b32 s42, 282624
  buffer_load_dwordx4 v5, s[8:11], s42 offen lds
  s_add_u32 m0, s41, 12288
  s_mov_b32 s42, 294912
  buffer_load_dwordx4 v5, s[8:11], s42 offen lds
  s_add_u32 m0, s41, 13312
  s_mov_b32 s42, 311296
  buffer_load_dwordx4 v5, s[8:11], s42 offen lds
  s_add_u32 m0, s41, 14336
  s_mov_b32 s42, 299008
  buffer_load_dwordx4 v5, s[8:11], s42 offen lds
  s_add_u32 m0, s41, 15360
  s_mov_b32 s42, 315392
  buffer_load_dwordx4 v5, s[8:11], s42 offen lds
  s_add_u32 m0, s41, 16384
  s_mov_b32 s42, 524288
  buffer_load_dwordx4 v5, s[8:11], s42 offen lds
  s_add_u32 m0, s41, 17408
  s_mov_b32 s42, 540672
  buffer_load_dwordx4 v5, s[8:11], s42 offen lds
  s_add_u32 m0, s41, 18432
  s_mov_b32 s42, 528384
  buffer_load_dwordx4 v5, s[8:11], s42 offen lds
  s_add_u32 m0, s41, 19456
  s_mov_b32 s42, 544768
  buffer_load_dwordx4 v5, s[8:11], s42 offen lds
  s_add_u32 m0, s41, 20480
  s_mov_b32 s42, 557056
  buffer_load_dwordx4 v5, s[8:11], s42 offen lds
  s_add_u32 m0, s41, 21504
  s_mov_b32 s42, 573440
  buffer_load_dwordx4 v5, s[8:11], s42 offen lds
  s_add_u32 m0, s41, 22528
  s_mov_b32 s42, 561152
  buffer_load_dwordx4 v5, s[8:11], s42 offen lds
  s_add_u32 m0, s41, 23552
  s_mov_b32 s42, 577536
  buffer_load_dwordx4 v5, s[8:11], s42 offen lds
  s_waitcnt vmcnt(16) lgkmcnt(0)
  s_barrier
  s_add_u32 m0, s41, 24576
  s_mov_b32 s42, 786432
  buffer_load_dwordx4 v5, s[8:11], s42 offen lds
  s_add_u32 m0, s41, 25600
  s_mov_b32 s42, 802816
  buffer_load_dwordx4 v5, s[8:11], s42 offen lds
  s_add_u32 m0, s41, 26624
  s_mov_b32 s42, 790528
  buffer_load_dwordx4 v5, s[8:11], s42 offen lds
  s_add_u32 m0, s41, 27648
  s_mov_b32 s42, 806912
  buffer_load_dwordx4 v5, s[8:11], s42 offen lds
  s_add_u32 m0, s41, 28672
  s_mov_b32 s42, 819200
  buffer_load_dwordx4 v5, s[8:11], s42 offen lds
  s_add_u32 m0, s41, 29696
  s_mov_b32 s42, 835584
  buffer_load_dwordx4 v5, s[8:11], s42 offen lds
  s_add_u32 m0, s41, 30720
  s_mov_b32 s42, 823296
  buffer_load_dwordx4 v5, s[8:11], s42 offen lds
  s_add_u32 m0, s41, 31744
  s_mov_b32 s42, 839680
  buffer_load_dwordx4 v5, s[8:11], s42 offen lds
  ds_read_b64_tr_b16 a[0:1], v6 offset:0
  ds_read_b64_tr_b16 a[2:3], v6 offset:2048
  ds_read_b64_tr_b16 a[4:5], v6 offset:4096
  ds_read_b64_tr_b16 a[6:7], v6 offset:6144
  ds_read_b64_tr_b16 a[8:9], v7 offset:0
  ds_read_b64_tr_b16 a[10:11], v7 offset:2048
  ds_read_b64_tr_b16 a[12:13], v7 offset:4096
  ds_read_b64_tr_b16 a[14:15], v7 offset:6144
  ds_read_b64_tr_b16 a[16:17], v8 offset:0
  ds_read_b64_tr_b16 a[18:19], v8 offset:2048
  ds_read_b64_tr_b16 a[20:21], v8 offset:4096
  ds_read_b64_tr_b16 a[22:23], v8 offset:6144
  ds_read_b64_tr_b16 a[24:25], v9 offset:0
  ds_read_b64_tr_b16 a[26:27], v9 offset:2048
  ds_read_b64_tr_b16 a[28:29], v9 offset:4096
  ds_read_b64_tr_b16 a[30:31], v9 offset:6144
  s_waitcnt vmcnt(16) lgkmcnt(0)
  s_barrier
  s_add_u32 m0, s41, 0
  s_mov_b32 s42, 1048576
  buffer_load_dwordx4 v5, s[8:11], s42 offen lds
  s_add_u32 m0, s41, 1024
  s_mov_b32 s42, 1064960
  buffer_load_dwordx4 v5, s[8:11], s42 offen lds
  s_add_u32 m0, s41, 2048
  s_mov_b32 s42, 1052672
  buffer_load_dwordx4 v5, s[8:11], s42 offen lds
  s_add_u32 m0, s41, 3072
  s_mov_b32 s42, 1069056
  buffer_load_dwordx4 v5, s[8:11], s42 offen lds
  s_add_u32 m0, s41, 4096
  s_mov_b32 s42, 1081344
  buffer_load_dwordx4 v5, s[8:11], s42 offen lds
  s_add_u32 m0, s41, 5120
  s_mov_b32 s42, 1097728
  buffer_load_dwordx4 v5, s[8:11], s42 offen lds
  s_add_u32 m0, s41, 6144
  s_mov_b32 s42, 1085440
  buffer_load_dwordx4 v5, s[8:11], s42 offen lds
  s_add_u32 m0, s41, 7168
  s_mov_b32 s42, 1101824
  buffer_load_dwordx4 v5, s[8:11], s42 offen lds
  ds_read_b64_tr_b16 a[32:33], v6 offset:8192
  ds_read_b64_tr_b16 a[34:35], v6 offset:10240
  ds_read_b64_tr_b16 a[36:37], v6 offset:12288
  ds_read_b64_tr_b16 a[38:39], v6 offset:14336
  ds_read_b64_tr_b16 a[40:41], v7 offset:8192
  ds_read_b64_tr_b16 a[42:43], v7 offset:10240
  ds_read_b64_tr_b16 a[44:45], v7 offset:12288
  ds_read_b64_tr_b16 a[46:47], v7 offset:14336
  ds_read_b64_tr_b16 a[48:49], v8 offset:8192
  ds_read_b64_tr_b16 a[50:51], v8 offset:10240
  ds_read_b64_tr_b16 a[52:53], v8 offset:12288
  ds_read_b64_tr_b16 a[54:55], v8 offset:14336
  ds_read_b64_tr_b16 a[56:57], v9 offset:8192
  ds_read_b64_tr_b16 a[58:59], v9 offset:10240
  ds_read_b64_tr_b16 a[60:61], v9 offset:12288
  ds_read_b64_tr_b16 a[62:63], v9 offset:14336
  s_waitcnt vmcnt(16) lgkmcnt(0)
  s_barrier
  s_add_u32 m0, s41, 8192
  s_mov_b32 s42, 1310720
  buffer_load_dwordx4 v5, s[8:11], s42 offen lds
  s_add_u32 m0, s41, 9216
  s_mov_b32 s42, 1327104
  buffer_load_dwordx4 v5, s[8:11], s42 offen lds
  s_add_u32 m0, s41, 10240
  s_mov_b32 s42, 1314816
  buffer_load_dwordx4 v5, s[8:11], s42 offen lds
  s_add_u32 m0, s41, 11264
  s_mov_b32 s42, 1331200
  buffer_load_dwordx4 v5, s[8:11], s42 offen lds
  s_add_u32 m0, s41, 12288
  s_mov_b32 s42, 1343488
  buffer_load_dwordx4 v5, s[8:11], s42 offen lds
  s_add_u32 m0, s41, 13312
  s_mov_b32 s42, 1359872
  buffer_load_dwordx4 v5, s[8:11], s42 offen lds
  s_add_u32 m0, s41, 14336
  s_mov_b32 s42, 1347584
  buffer_load_dwordx4 v5, s[8:11], s42 offen lds
  s_add_u32 m0, s41, 15360
  s_mov_b32 s42, 1363968
  buffer_load_dwordx4 v5, s[8:11], s42 offen lds
  ds_read_b64_tr_b16 a[64:65], v6 offset:16384
  ds_read_b64_tr_b16 a[66:67], v6 offset:18432
  ds_read_b64_tr_b16 a[68:69], v6 offset:20480
  ds_read_b64_tr_b16 a[70:71], v6 offset:22528
  ds_read_b64_tr_b16 a[72:73], v7 offset:16384
  ds_read_b64_tr_b16 a[74:75], v7 offset:18432
  ds_read_b64_tr_b16 a[76:77], v7 offset:20480
  ds_read_b64_tr_b16 a[78:79], v7 offset:22528
  ds_read_b64_tr_b16 a[80:81], v8 offset:16384
  ds_read_b64_tr_b16 a[82:83], v8 offset:18432
  ds_read_b64_tr_b16 a[84:85], v8 offset:20480
  ds_read_b64_tr_b16 a[86:87], v8 offset:22528
  ds_read_b64_tr_b16 a[88:89], v9 offset:16384
  ds_read_b64_tr_b16 a[90:91], v9 offset:18432
  ds_read_b64_tr_b16 a[92:93], v9 offset:20480
  ds_read_b64_tr_b16 a[94:95], v9 offset:22528
  s_waitcnt vmcnt(16) lgkmcnt(0)
  s_barrier
  s_add_u32 m0, s41, 16384
  s_mov_b32 s42, 1572864
  buffer_load_dwordx4 v5, s[8:11], s42 offen lds
  s_add_u32 m0, s41, 17408
  s_mov_b32 s42, 1589248
  buffer_load_dwordx4 v5, s[8:11], s42 offen lds
  s_add_u32 m0, s41, 18432
  s_mov_b32 s42, 1576960
  buffer_load_dwordx4 v5, s[8:11], s42 offen lds
  s_add_u32 m0, s41, 19456
  s_mov_b32 s42, 1593344
  buffer_load_dwordx4 v5, s[8:11], s42 offen lds
  s_add_u32 m0, s41, 20480
  s_mov_b32 s42, 1605632
  buffer_load_dwordx4 v5, s[8:11], s42 offen lds
  s_add_u32 m0, s41, 21504
  s_mov_b32 s42, 1622016
  buffer_load_dwordx4 v5, s[8:11], s42 offen lds
  s_add_u32 m0, s41, 22528
  s_mov_b32 s42, 1609728
  buffer_load_dwordx4 v5, s[8:11], s42 offen lds
  s_add_u32 m0, s41, 23552
  s_mov_b32 s42, 1626112
  buffer_load_dwordx4 v5, s[8:11], s42 offen lds
  ds_read_b64_tr_b16 a[96:97], v6 offset:24576
  ds_read_b64_tr_b16 a[98:99], v6 offset:26624
  ds_read_b64_tr_b16 a[100:101], v6 offset:28672
  ds_read_b64_tr_b16 a[102:103], v6 offset:30720
  ds_read_b64_tr_b16 a[104:105], v7 offset:24576
  ds_read_b64_tr_b16 a[106:107], v7 offset:26624
  ds_read_b64_tr_b16 a[108:109], v7 offset:28672
  ds_read_b64_tr_b16 a[110:111], v7 offset:30720
  ds_read_b64_tr_b16 a[112:113], v8 offset:24576
  ds_read_b64_tr_b16 a[114:115], v8 offset:26624
  ds_read_b64_tr_b16 a[116:117], v8 offset:28672
  ds_read_b64_tr_b16 a[118:119], v8 offset:30720
  ds_read_b64_tr_b16 a[120:121], v9 offset:24576
  ds_read_b64_tr_b16 a[122:123], v9 offset:26624
  ds_read_b64_tr_b16 a[124:125], v9 offset:28672
  ds_read_b64_tr_b16 a[126:127], v9 offset:30720
  s_waitcnt vmcnt(16) lgkmcnt(0)
  s_barrier
  s_add_u32 m0, s41, 24576
  s_mov_b32 s42, 1835008
  buffer_load_dwordx4 v5, s[8:11], s42 offen lds
  s_add_u32 m0, s41, 25600
  s_mov_b32 s42, 1851392
  buffer_load_dwordx4 v5, s[8:11], s42 offen lds
  s_add_u32 m0, s41, 26624
  s_mov_b32 s42, 1839104
  buffer_load_dwordx4 v5, s[8:11], s42 offen lds
  s_add_u32 m0, s41, 27648
  s_mov_b32 s42, 1855488
  buffer_load_dwordx4 v5, s[8:11], s42 offen lds
  s_add_u32 m0, s41, 28672
  s_mov_b32 s42, 1867776
  buffer_load_dwordx4 v5, s[8:11], s42 offen lds
  s_add_u32 m0, s41, 29696
  s_mov_b32 s42, 1884160
  buffer_load_dwordx4 v5, s[8:11], s42 offen lds
  s_add_u32 m0, s41, 30720
  s_mov_b32 s42, 1871872
  buffer_load_dwordx4 v5, s[8:11], s42 offen lds
  s_add_u32 m0, s41, 31744
  s_mov_b32 s42, 1888256
  buffer_load_dwordx4 v5, s[8:11], s42 offen lds
  ds_read_b64_tr_b16 a[128:129], v6 offset:0
  ds_read_b64_tr_b16 a[130:131], v6 offset:2048
  ds_read_b64_tr_b16 a[132:133], v6 offset:4096
  ds_read_b64_tr_b16 a[134:135], v6 offset:6144
  ds_read_b64_tr_b16 a[136:137], v7 offset:0
  ds_read_b64_tr_b16 a[138:139], v7 offset:2048
  ds_read_b64_tr_b16 a[140:141], v7 offset:4096
  ds_read_b64_tr_b16 a[142:143], v7 offset:6144
  ds_read_b64_tr_b16 a[144:145], v8 offset:0
  ds_read_b64_tr_b16 a[146:147], v8 offset:2048
  ds_read_b64_tr_b16 a[148:149], v8 offset:4096
  ds_read_b64_tr_b16 a[150:151], v8 offset:6144
  ds_read_b64_tr_b16 a[152:153], v9 offset:0
  ds_read_b64_tr_b16 a[154:155], v9 offset:2048
  ds_read_b64_tr_b16 a[156:157], v9 offset:4096
  ds_read_b64_tr_b16 a[158:159], v9 offset:6144
  s_waitcnt vmcnt(16) lgkmcnt(0)
  s_barrier
  s_load_dwordx2 s[8:9], s[0:1], 32
  s_mov_b32 s10, 8388608
  s_mov_b32 s11, 0x20000
  s_waitcnt lgkmcnt(0)
  s_add_u32 m0, s41, 0
  s_mov_b32 s42, 0
  buffer_load_dwordx4 v10, s[8:11], s42 offen lds
  s_add_u32 m0, s41, 1024
  s_mov_b32 s42, 65536
  buffer_load_dwordx4 v10, s[8:11], s42 offen lds
  s_add_u32 m0, s41, 2048
  s_mov_b32 s42, 8192
  buffer_load_dwordx4 v10, s[8:11], s42 offen lds
  s_add_u32 m0, s41, 3072
  s_mov_b32 s42, 73728
  buffer_load_dwordx4 v10, s[8:11], s42 offen lds
  s_add_u32 m0, s41, 4096
  s_mov_b32 s42, 262144
  buffer_load_dwordx4 v10, s[8:11], s42 offen lds
  s_add_u32 m0, s41, 5120
  s_mov_b32 s42, 327680
  buffer_load_dwordx4 v10, s[8:11], s42 offen lds
  s_add_u32 m0, s41, 6144
  s_mov_b32 s42, 270336
  buffer_load_dwordx4 v10, s[8:11], s42 offen lds
  s_add_u32 m0, s41, 7168
  s_mov_b32 s42, 335872
  buffer_load_dwordx4 v10, s[8:11], s42 offen lds
  ds_read_b64_tr_b16 a[160:161], v6 offset:8192
  ds_read_b64_tr_b16 a[162:163], v6 offset:10240
  ds_read_b64_tr_b16 a[164:165], v6 offset:12288
  ds_read_b64_tr_b16 a[166:167], v6 offset:14336
  ds_read_b64_tr_b16 a[168:169], v7 offset:8192
  ds_read_b64_tr_b16 a[170:171], v7 offset:10240
  ds_read_b64_tr_b16 a[172:173], v7 offset:12288
  ds_read_b64_tr_b16 a[174:175], v7 offset:14336
  ds_read_b64_tr_b16 a[176:177], v8 offset:8192
  ds_read_b64_tr_b16 a[178:179], v8 offset:10240
  ds_read_b64_tr_b16 a[180:181], v8 offset:12288
  ds_read_b64_tr_b16 a[182:183], v8 offset:14336
  ds_read_b64_tr_b16 a[184:185], v9 offset:8192
  ds_read_b64_tr_b16 a[186:187], v9 offset:10240
  ds_read_b64_tr_b16 a[188:189], v9 offset:12288
  ds_read_b64_tr_b16 a[190:191], v9 offset:14336
  s_waitcnt vmcnt(16) lgkmcnt(0)
  s_barrier
  s_add_u32 m0, s41, 8192
  s_mov_b32 s42, 2097152
  buffer_load_dwordx4 v10, s[8:11], s42 offen lds
  s_add_u32 m0, s41, 9216
  s_mov_b32 s42, 2162688
  buffer_load_dwordx4 v10, s[8:11], s42 offen lds
  s_add_u32 m0, s41, 10240
  s_mov_b32 s42, 2105344
  buffer_load_dwordx4 v10, s[8:11], s42 offen lds
  s_add_u32 m0, s41, 11264
  s_mov_b32 s42, 2170880
  buffer_load_dwordx4 v10, s[8:11], s42 offen lds
  s_add_u32 m0, s41, 12288
  s_mov_b32 s42, 2359296
  buffer_load_dwordx4 v10, s[8:11], s42 offen lds
  s_add_u32 m0, s41, 13312
  s_mov_b32 s42, 2424832
  buffer_load_dwordx4 v10, s[8:11], s42 offen lds
  s_add_u32 m0, s41, 14336
  s_mov_b32 s42, 2367488
  buffer_load_dwordx4 v10, s[8:11], s42 offen lds
  s_add_u32 m0, s41, 15360
  s_mov_b32 s42, 2433024
  buffer_load_dwordx4 v10, s[8:11], s42 offen lds
  ds_read_b64_tr_b16 a[192:193], v6 offset:16384
  ds_read_b64_tr_b16 a[194:195], v6 offset:18432
  ds_read_b64_tr_b16 a[196:197], v6 offset:20480
  ds_read_b64_tr_b16 a[198:199], v6 offset:22528
  ds_read_b64_tr_b16 a[200:201], v7 offset:16384
  ds_read_b64_tr_b16 a[202:203], v7 offset:18432
  ds_read_b64_tr_b16 a[204:205], v7 offset:20480
  ds_read_b64_tr_b16 a[206:207], v7 offset:22528
  ds_read_b64_tr_b16 a[208:209], v8 offset:16384
  ds_read_b64_tr_b16 a[210:211], v8 offset:18432
  ds_read_b64_tr_b16 a[212:213], v8 offset:20480
  ds_read_b64_tr_b16 a[214:215], v8 offset:22528
  ds_read_b64_tr_b16 a[216:217], v9 offset:16384
  ds_read_b64_tr_b16 a[218:219], v9 offset:18432
  ds_read_b64_tr_b16 a[220:221], v9 offset:20480
  ds_read_b64_tr_b16 a[222:223], v9 offset:22528
  s_waitcnt vmcnt(16) lgkmcnt(0)
  s_barrier
  s_add_u32 m0, s41, 16384
  s_mov_b32 s42, 4194304
  buffer_load_dwordx4 v10, s[8:11], s42 offen lds
  s_add_u32 m0, s41, 17408
  s_mov_b32 s42, 4259840
  buffer_load_dwordx4 v10, s[8:11], s42 offen lds
  s_add_u32 m0, s41, 18432
  s_mov_b32 s42, 4202496
  buffer_load_dwordx4 v10, s[8:11], s42 offen lds
  s_add_u32 m0, s41, 19456
  s_mov_b32 s42, 4268032
  buffer_load_dwordx4 v10, s[8:11], s42 offen lds
  s_add_u32 m0, s41, 20480
  s_mov_b32 s42, 4456448
  buffer_load_dwordx4 v10, s[8:11], s42 offen lds
  s_add_u32 m0, s41, 21504
  s_mov_b32 s42, 4521984
  buffer_load_dwordx4 v10, s[8:11], s42 offen lds
  s_add_u32 m0, s41, 22528
  s_mov_b32 s42, 4464640
  buffer_load_dwordx4 v10, s[8:11], s42 offen lds
  s_add_u32 m0, s41, 23552
  s_mov_b32 s42, 4530176
  buffer_load_dwordx4 v10, s[8:11], s42 offen lds
  ds_read_b64_tr_b16 a[224:225], v6 offset:24576
  ds_read_b64_tr_b16 a[226:227], v6 offset:26624
  ds_read_b64_tr_b16 a[228:229], v6 offset:28672
  ds_read_b64_tr_b16 a[230:231], v6 offset:30720
  ds_read_b64_tr_b16 a[232:233], v7 offset:24576
  ds_read_b64_tr_b16 a[234:235], v7 offset:26624
  ds_read_b64_tr_b16 a[236:237], v7 offset:28672
  ds_read_b64_tr_b16 a[238:239], v7 offset:30720
  ds_read_b64_tr_b16 a[240:241], v8 offset:24576
  ds_read_b64_tr_b16 a[242:243], v8 offset:26624
  ds_read_b64_tr_b16 a[244:245], v8 offset:28672
  ds_read_b64_tr_b16 a[246:247], v8 offset:30720
  ds_read_b64_tr_b16 a[248:249], v9 offset:24576
  ds_read_b64_tr_b16 a[250:251], v9 offset:26624
  ds_read_b64_tr_b16 a[252:253], v9 offset:28672
  ds_read_b64_tr_b16 a[254:255], v9 offset:30720
  s_waitcnt vmcnt(16) lgkmcnt(0)
  s_barrier
  s_add_u32 m0, s41, 24576
  s_mov_b32 s42, 6291456
  buffer_load_dwordx4 v10, s[8:11], s42 offen lds
  s_add_u32 m0, s41, 25600
  s_mov_b32 s42, 6356992
  buffer_load_dwordx4 v10, s[8:11], s42 offen lds
  s_add_u32 m0, s41, 26624
  s_mov_b32 s42, 6299648
  buffer_load_dwordx4 v10, s[8:11], s42 offen lds
  s_add_u32 m0, s41, 27648
  s_mov_b32 s42, 6365184
  buffer_load_dwordx4 v10, s[8:11], s42 offen lds
  s_add_u32 m0, s41, 28672
  s_mov_b32 s42, 6553600
  buffer_load_dwordx4 v10, s[8:11], s42 offen lds
  s_add_u32 m0, s41, 29696
  s_mov_b32 s42, 6619136
  buffer_load_dwordx4 v10, s[8:11], s42 offen lds
  s_add_u32 m0, s41, 30720
  s_mov_b32 s42, 6561792
  buffer_load_dwordx4 v10, s[8:11], s42 offen lds
  s_add_u32 m0, s41, 31744
  s_mov_b32 s42, 6627328
  buffer_load_dwordx4 v10, s[8:11], s42 offen lds
  ds_read_b64_tr_b16 v[128:129], v1 offset:0
  ds_read_b64_tr_b16 v[130:131], v1 offset:2048
  ds_read_b64_tr_b16 v[132:133], v1 offset:4096
  ds_read_b64_tr_b16 v[134:135], v1 offset:6144
  ds_read_b64_tr_b16 v[160:161], v2 offset:0
  ds_read_b64_tr_b16 v[162:163], v2 offset:2048
  ds_read_b64_tr_b16 v[164:165], v2 offset:4096
  ds_read_b64_tr_b16 v[166:167], v2 offset:6144
  ds_read_b64_tr_b16 v[192:193], v3 offset:0
  ds_read_b64_tr_b16 v[194:195], v3 offset:2048
  ds_read_b64_tr_b16 v[196:197], v3 offset:4096
  ds_read_b64_tr_b16 v[198:199], v3 offset:6144
  ds_read_b64_tr_b16 v[224:225], v68 offset:0
  ds_read_b64_tr_b16 v[226:227], v68 offset:2048
  ds_read_b64_tr_b16 v[228:229], v68 offset:4096
  ds_read_b64_tr_b16 v[230:231], v68 offset:6144
  s_waitcnt vmcnt(16) lgkmcnt(0)
  s_barrier
  s_add_u32 m0, s41, 0
  s_mov_b32 s42, 0
  buffer_load_dwordx4 v11, s[8:11], s42 offen lds
  s_add_u32 m0, s41, 1024
  s_mov_b32 s42, 65536
  buffer_load_dwordx4 v11, s[8:11], s42 offen lds
  s_add_u32 m0, s41, 2048
  s_mov_b32 s42, 8192
  buffer_load_dwordx4 v11, s[8:11], s42 offen lds
  s_add_u32 m0, s41, 3072
  s_mov_b32 s42, 73728
  buffer_load_dwordx4 v11, s[8:11], s42 offen lds
  s_add_u32 m0, s41, 4096
  s_mov_b32 s42, 262144
  buffer_load_dwordx4 v11, s[8:11], s42 offen lds
  s_add_u32 m0, s41, 5120
  s_mov_b32 s42, 327680
  buffer_load_dwordx4 v11, s[8:11], s42 offen lds
  s_add_u32 m0, s41, 6144
  s_mov_b32 s42, 270336
  buffer_load_dwordx4 v11, s[8:11], s42 offen lds
  s_add_u32 m0, s41, 7168
  s_mov_b32 s42, 335872
  buffer_load_dwordx4 v11, s[8:11], s42 offen lds
  ds_read_b64_tr_b16 v[136:137], v1 offset:8192
  ds_read_b64_tr_b16 v[138:139], v1 offset:10240
  ds_read_b64_tr_b16 v[140:141], v1 offset:12288
  ds_read_b64_tr_b16 v[142:143], v1 offset:14336
  ds_read_b64_tr_b16 v[168:169], v2 offset:8192
  ds_read_b64_tr_b16 v[170:171], v2 offset:10240
  ds_read_b64_tr_b16 v[172:173], v2 offset:12288
  ds_read_b64_tr_b16 v[174:175], v2 offset:14336
  ds_read_b64_tr_b16 v[200:201], v3 offset:8192
  ds_read_b64_tr_b16 v[202:203], v3 offset:10240
  ds_read_b64_tr_b16 v[204:205], v3 offset:12288
  ds_read_b64_tr_b16 v[206:207], v3 offset:14336
  ds_read_b64_tr_b16 v[232:233], v68 offset:8192
  ds_read_b64_tr_b16 v[234:235], v68 offset:10240
  ds_read_b64_tr_b16 v[236:237], v68 offset:12288
  ds_read_b64_tr_b16 v[238:239], v68 offset:14336
  s_waitcnt vmcnt(16) lgkmcnt(0)
  s_barrier
  s_add_u32 m0, s41, 8192
  s_mov_b32 s42, 2097152
  buffer_load_dwordx4 v11, s[8:11], s42 offen lds
  s_add_u32 m0, s41, 9216
  s_mov_b32 s42, 2162688
  buffer_load_dwordx4 v11, s[8:11], s42 offen lds
  s_add_u32 m0, s41, 10240
  s_mov_b32 s42, 2105344
  buffer_load_dwordx4 v11, s[8:11], s42 offen lds
  s_add_u32 m0, s41, 11264
  s_mov_b32 s42, 2170880
  buffer_load_dwordx4 v11, s[8:11], s42 offen lds
  s_add_u32 m0, s41, 12288
  s_mov_b32 s42, 2359296
  buffer_load_dwordx4 v11, s[8:11], s42 offen lds
  s_add_u32 m0, s41, 13312
  s_mov_b32 s42, 2424832
  buffer_load_dwordx4 v11, s[8:11], s42 offen lds
  s_add_u32 m0, s41, 14336
  s_mov_b32 s42, 2367488
  buffer_load_dwordx4 v11, s[8:11], s42 offen lds
  s_add_u32 m0, s41, 15360
  s_mov_b32 s42, 2433024
  buffer_load_dwordx4 v11, s[8:11], s42 offen lds
  ds_read_b64_tr_b16 v[144:145], v1 offset:16384
  ds_read_b64_tr_b16 v[146:147], v1 offset:18432
  ds_read_b64_tr_b16 v[148:149], v1 offset:20480
  ds_read_b64_tr_b16 v[150:151], v1 offset:22528
  ds_read_b64_tr_b16 v[176:177], v2 offset:16384
  ds_read_b64_tr_b16 v[178:179], v2 offset:18432
  ds_read_b64_tr_b16 v[180:181], v2 offset:20480
  ds_read_b64_tr_b16 v[182:183], v2 offset:22528
  ds_read_b64_tr_b16 v[208:209], v3 offset:16384
  ds_read_b64_tr_b16 v[210:211], v3 offset:18432
  ds_read_b64_tr_b16 v[212:213], v3 offset:20480
  ds_read_b64_tr_b16 v[214:215], v3 offset:22528
  ds_read_b64_tr_b16 v[240:241], v68 offset:16384
  ds_read_b64_tr_b16 v[242:243], v68 offset:18432
  ds_read_b64_tr_b16 v[244:245], v68 offset:20480
  ds_read_b64_tr_b16 v[246:247], v68 offset:22528
  s_waitcnt vmcnt(16) lgkmcnt(0)
  s_barrier
  s_add_u32 m0, s41, 16384
  s_mov_b32 s42, 4194304
  buffer_load_dwordx4 v11, s[8:11], s42 offen lds
  s_add_u32 m0, s41, 17408
  s_mov_b32 s42, 4259840
  buffer_load_dwordx4 v11, s[8:11], s42 offen lds
  s_add_u32 m0, s41, 18432
  s_mov_b32 s42, 4202496
  buffer_load_dwordx4 v11, s[8:11], s42 offen lds
  s_add_u32 m0, s41, 19456
  s_mov_b32 s42, 4268032
  buffer_load_dwordx4 v11, s[8:11], s42 offen lds
  s_add_u32 m0, s41, 20480
  s_mov_b32 s42, 4456448
  buffer_load_dwordx4 v11, s[8:11], s42 offen lds
  s_add_u32 m0, s41, 21504
  s_mov_b32 s42, 4521984
  buffer_load_dwordx4 v11, s[8:11], s42 offen lds
  s_add_u32 m0, s41, 22528
  s_mov_b32 s42, 4464640
  buffer_load_dwordx4 v11, s[8:11], s42 offen lds
  s_add_u32 m0, s41, 23552
  s_mov_b32 s42, 4530176
  buffer_load_dwordx4 v11, s[8:11], s42 offen lds
  ds_read_b64_tr_b16 v[152:153], v1 offset:24576
  ds_read_b64_tr_b16 v[154:155], v1 offset:26624
  ds_read_b64_tr_b16 v[156:157], v1 offset:28672
  ds_read_b64_tr_b16 v[158:159], v1 offset:30720
  ds_read_b64_tr_b16 v[184:185], v2 offset:24576
  ds_read_b64_tr_b16 v[186:187], v2 offset:26624
  ds_read_b64_tr_b16 v[188:189], v2 offset:28672
  ds_read_b64_tr_b16 v[190:191], v2 offset:30720
  ds_read_b64_tr_b16 v[216:217], v3 offset:24576
  ds_read_b64_tr_b16 v[218:219], v3 offset:26624
  ds_read_b64_tr_b16 v[220:221], v3 offset:28672
  ds_read_b64_tr_b16 v[222:223], v3 offset:30720
  ds_read_b64_tr_b16 v[248:249], v68 offset:24576
  ds_read_b64_tr_b16 v[250:251], v68 offset:26624
  ds_read_b64_tr_b16 v[252:253], v68 offset:28672
  ds_read_b64_tr_b16 v[254:255], v68 offset:30720
  s_waitcnt vmcnt(16) lgkmcnt(0)
  s_barrier
  s_add_u32 m0, s41, 24576
  s_mov_b32 s42, 6291456
  buffer_load_dwordx4 v11, s[8:11], s42 offen lds
  s_add_u32 m0, s41, 25600
  s_mov_b32 s42, 6356992
  buffer_load_dwordx4 v11, s[8:11], s42 offen lds
  s_add_u32 m0, s41, 26624
  s_mov_b32 s42, 6299648
  buffer_load_dwordx4 v11, s[8:11], s42 offen lds
  s_add_u32 m0, s41, 27648
  s_mov_b32 s42, 6365184
  buffer_load_dwordx4 v11, s[8:11], s42 offen lds
  s_add_u32 m0, s41, 28672
  s_mov_b32 s42, 6553600
  buffer_load_dwordx4 v11, s[8:11], s42 offen lds
  s_add_u32 m0, s41, 29696
  s_mov_b32 s42, 6619136
  buffer_load_dwordx4 v11, s[8:11], s42 offen lds
  s_add_u32 m0, s41, 30720
  s_mov_b32 s42, 6561792
  buffer_load_dwordx4 v11, s[8:11], s42 offen lds
  s_add_u32 m0, s41, 31744
  s_mov_b32 s42, 6627328
  buffer_load_dwordx4 v11, s[8:11], s42 offen lds
  s_waitcnt vmcnt(0)
  s_barrier
  v_min_u32 v84, 31, v0
  v_lshlrev_b32 v84, 2, v84
  v_add_u32 v84, 128, v84
  s_nop 1
Lpoll_39:
  buffer_load_dword v85, v84, s[12:15], 0 offen sc1
  s_sub_u32 s24, s24, 1
  s_cbranch_scc1 L_FAIL
  s_waitcnt vmcnt(0)
  v_cmp_gt_i32 vcc, 1, v85
  s_cbranch_vccz Lpolld_40
  s_sleep 2
  s_branch Lpoll_39
Lpolld_40:
  v_mov_b32 v84, 64
  s_nop 1
Lpoll_41:
  buffer_load_dword v85, v84, s[12:15], 0 offen sc1
  s_sub_u32 s24, s24, 1
  s_cbranch_scc1 L_FAIL
  s_waitcnt vmcnt(0)
  v_cmp_gt_i32 vcc, 1, v85
  s_cbranch_vccz Lpolld_42
  s_sleep 2
  s_branch Lpoll_41
Lpolld_42:
  v_readfirstlane_b32 s26, v85
  s_and_b32 s26, s26, 0x6000
  s_lshr_b32 s40, s20, 1
  s_mul_i32 s40, s40, 32768
  s_and_b32 s41, s20, 1
  s_lshl_b32 s41, s41, 12
  s_add_u32 s40, s40, s41
  v_lshl_add_u32 v73, v0, 4, s40
  v_and_b32 v84, 2, v0
  v_cmp_eq_u32 vcc, 0, v84
  v_mov_b32 v84, 0xeeee
  v_mov_b32 v85, 0x4444
  v_cndmask_b32 v74, v84, v85, vcc
  s_lshr_b32 s40, s21, 2
  s_mul_i32 s40, s40, 32768
  s_and_b32 s41, s21, 3
  s_lshl_b32 s41, s41, 11
  s_add_u32 s47, s40, s41
  s_lshl_b32 s41, s20, 9
  s_add_u32 s47, s47, s41
  v_lshl_add_u32 v78, v0, 3, s47
  s_add_u32 s40, s26, 1310720
  v_mov_b32 v76, s40
  s_add_u32 s40, s40, 0
  s_lshl_b32 s41, s21, 2
  s_add_u32 s41, s41, s20
  s_cmp_eq_u32 s41, 3
  s_cselect_b32 s40, s40, 2147483392
  s_mov_b32 s25, 0
  v_mov_b32 v77, 2147483392
  s_mov_b64 exec, 1
  v_mov_b32 v77, s40
  s_mov_b64 exec, -1
  v_mov_b32 v88, -1
  v_mov_b32 v89, -1
  v_mov_b32 v90, -1
  v_mov_b32 v91, -1
  s_load_dwordx2 s[16:17], s[0:1], 8
  s_mov_b32 s18, 16384
  s_mov_b32 s19, 0x20000
  s_waitcnt lgkmcnt(0)
  s_mul_i32 s40, s20, 65536
  v_lshl_add_u32 v81, v0, 4, s40
  s_lshl_b32 s40, s20, 10
  s_add_u32 s40, s40, 147456
  v_lshl_add_u32 v82, v0, 4, s40
  s_and_b32 s40, s20, 1
  s_lshl_b32 s40, s40, 3
  v_bfe_u32 v4, v0, 2, 3
  v_add_u32 v4, s40, v4
  s_lshr_b32 s40, s20, 1
  s_lshl_b32 s40, s40, 3
  v_and_b32 v5, 3, v0
  v_add_u32 v5, s40, v5
  v_bfe_u32 v84, v4, 1, 1
  v_lshl_add_u32 v5, v84, 2, v5
  v_lshrrev_b32 v84, 2, v4
  v_and_b32 v85, 1, v4
  v_lshl_add_u32 v86, v84, 4, v5
  v_lshlrev_b32 v86, 4, v86
  v_lshl_add_u32 v86, v85, 3, v86
  v_add_u32 v83, 147456, v86
  v_lshl_add_u32 v84, v84, 1, v85
  s_lshl_b32 s40, s21, 6
  v_lshl_add_u32 v84, v84, 11, s40
  v_lshl_add_u32 v84, v5, 1, v84
  buffer_load_ushort v85, v84, s[16:19], 0 offen
  buffer_load_ushort v86, v84, s[16:19], 0 offen offset:32
  s_lshr_b32 s40, s21, 1
  s_and_b32 s41, s40, 3
  s_lshl_b32 s41, s41, 2
  s_lshr_b32 s40, s40, 2
  s_add_u32 s40, s40, s41
  s_lshr_b32 s41, s40, 3
  s_mul_i32 s41, s41, 32768
  s_and_b32 s40, s40, 7
  s_lshl_b32 s40, s40, 10
  s_add_u32 s40, s40, s41
  s_and_b32 s41, s21, 1
  s_lshl_b32 s41, s41, 9
  s_add_u32 s40, s40, s41
  s_lshl_b32 s41, s20, 7
  s_add_u32 s40, s40, s41
  v_lshl_add_u32 v124, v0, 2, s40
  s_mov_b32 exec_lo, 0
  v_mov_b32 v124, 2147483392
  s_mov_b64 exec, -1
  s_add_u32 s40, s26, 1048576
  v_mov_b32 v80, 0
  s_mov_b32 s60, 0
  s_mov_b32 s61, 0
  s_waitcnt vmcnt(0)
  v_lshl_or_b32 v85, v86, 16, v85
  v_min_u32 v85, -2, v85
  buffer_store_dword v85, v124, s[4:7], s40 offen sc1
  buffer_store_dword v80, v77, s[4:7], 0 offen sc1
L_VO_top:
  s_and_b32 s40, s25, 3
  s_lshl_b32 s40, s40, 16
  s_add_u32 s27, s40, s26
  s_add_u32 s27, s27, 1048576
  s_and_b32 s40, s25, 1
  s_lshl_b32 s40, s40, 18
  s_add_u32 s28, s40, s26
  s_xor_b32 s29, s28, 0x4000
  v_mov_b64 v[52:53], 0
  v_mov_b64 v[54:55], 0
  v_mov_b64 v[56:57], 0
  v_mov_b64 v[58:59], 0
  ds_read_b64_tr_b16 v[20:21], v1 offset:0
  ds_read_b64_tr_b16 v[22:23], v1 offset:2048
  ds_read_b64_tr_b16 v[24:25], v1 offset:4096
  ds_read_b64_tr_b16 v[26:27], v1 offset:6144
  ds_read_b64_tr_b16 v[28:29], v1 offset:8192
  ds_read_b64_tr_b16 v[30:31], v1 offset:10240
  ds_read_b64_tr_b16 v[32:33], v1 offset:12288
  ds_read_b64_tr_b16 v[34:35], v1 offset:14336
  ds_read_b64_tr_b16 v[36:37], v1 offset:16384
  ds_read_b64_tr_b16 v[38:39], v1 offset:18432
  ds_read_b64_tr_b16 v[40:41], v1 offset:20480
  ds_read_b64_tr_b16 v[42:43], v1 offset:22528
  ds_read_b64_tr_b16 v[44:45], v1 offset:24576
  ds_read_b64_tr_b16 v[46:47], v1 offset:26624
  ds_read_b64_tr_b16 v[48:49], v1 offset:28672
  ds_read_b64_tr_b16 v[50:51], v1 offset:30720
  s_cmp_lg_u32 s20, 0
  s_cbranch_scc1 Ltrigd_44
  s_mov_b64 exec, 1
  buffer_load_dword v84, v76, s[4:7], 0 offen offset:0 sc1
  s_sleep 1
  buffer_load_dword v85, v76, s[4:7], 0 offen offset:0 sc1
  s_sleep 1
  buffer_load_dword v86, v76, s[4:7], 0 offen offset:0 sc1
  s_sleep 1
Ltrig_43:
  s_sub_u32 s24, s24, 1
  s_cbranch_scc1 L_FAIL
  buffer_load_dword v87, v76, s[4:7], 0 offen offset:0 sc1
  s_waitcnt vmcnt(3)
  v_cmp_gt_i32 vcc, s25, v84
  s_cbranch_vccz Ltrigd_44
  buffer_load_dword v84, v76, s[4:7], 0 offen offset:0 sc1
  s_waitcnt vmcnt(3)
  v_cmp_gt_i32 vcc, s25, v85
  s_cbranch_vccz Ltrigd_44
  buffer_load_dword v85, v76, s[4:7], 0 offen offset:0 sc1
  s_waitcnt vmcnt(3)
  v_cmp_gt_i32 vcc, s25, v86
  s_cbranch_vccz Ltrigd_44
  buffer_load_dword v86, v76, s[4:7], 0 offen offset:0 sc1
  s_waitcnt vmcnt(3)
  v_cmp_gt_i32 vcc, s25, v87
  s_cbranch_vccnz Ltrig_43
Ltrigd_44:
  s_mov_b64 exec, -1
  s_barrier
L_VO_retry:
  buffer_load_dwordx4 v[4:7], v73, s[4:7], s27 offen offset:0 sc1
  s_nop 0
  buffer_load_dwordx4 v[8:11], v73, s[4:7], s27 offen offset:1024 sc1
  s_nop 0
  buffer_load_dwordx4 v[12:15], v73, s[4:7], s27 offen offset:2048 sc1
  s_nop 0
  buffer_load_dwordx4 v[16:19], v73, s[4:7], s27 offen offset:3072 sc1
  s_waitcnt lgkmcnt(0)
  s_waitcnt vmcnt(3)
  v_smfmac_f32_16x16x64_bf16 v[52:55], v[4:7], v[128:135], v74
  ds_write_b128 v69, v[4:7] offset:0
  v_max3_u32 v75, v4, v5, v6
  v_smfmac_f32_16x16x64_bf16 v[56:59], v[4:7], v[20:27], v74
  v_max3_u32 v75, v6, v7, v75
  s_waitcnt vmcnt(2)
  v_smfmac_f32_16x16x64_bf16 v[52:55], v[8:11], v[136:143], v74
  ds_write_b128 v69, v[8:11] offset:1024
  v_max3_u32 v75, v8, v9, v75
  v_max3_u32 v75, v10, v11, v75
  ds_read_b64_tr_b16 v[20:21], v2 offset:0
  v_smfmac_f32_16x16x64_bf16 v[56:59], v[8:11], v[28:35], v74
  ds_read_b64_tr_b16 v[22:23], v2 offset:2048
  ds_read_b64_tr_b16 v[24:25], v2 offset:4096
  ds_read_b64_tr_b16 v[26:27], v2 offset:6144
  s_waitcnt vmcnt(1)
  v_smfmac_f32_16x16x64_bf16 v[52:55], v[12:15], v[144:151], v74
  ds_write_b128 v69, v[12:15] offset:2048
  v_max3_u32 v75, v12, v13, v75
  v_max3_u32 v75, v14, v15, v75
  ds_read_b64_tr_b16 v[28:29], v2 offset:8192
  v_smfmac_f32_16x16x64_bf16 v[56:59], v[12:15], v[36:43], v74
  ds_read_b64_tr_b16 v[30:31], v2 offset:10240
  ds_read_b64_tr_b16 v[32:33], v2 offset:12288
  ds_read_b64_tr_b16 v[34:35], v2 offset:14336
  s_waitcnt vmcnt(0)
  ds_write_b128 v69, v[16:19] offset:3072
  v_max3_u32 v75, v16, v17, v75
  v_max3_u32 v75, v18, v19, v75
  v_cmp_eq_u32 vcc, -1, v75
  s_cbranch_vccnz L_VO_bad
  s_waitcnt lgkmcnt(0)
  s_barrier
  ds_read_b128 v[4:7], v70 offset:0
  ds_read_b128 v[8:11], v70 offset:1024
  ds_read_b128 v[12:15], v70 offset:2048
  v_smfmac_f32_16x16x64_bf16 v[52:55], v[16:19], v[152:159], v74
  ds_read_b64_tr_b16 v[36:37], v2 offset:16384
  ds_read_b64_tr_b16 v[38:39], v2 offset:18432
  v_smfmac_f32_16x16x64_bf16 v[56:59], v[16:19], v[44:51], v74
  ds_read_b64_tr_b16 v[40:41], v2 offset:20480
  ds_read_b64_tr_b16 v[42:43], v2 offset:22528
  s_waitcnt lgkmcnt(6)
  v_smfmac_f32_16x16x64_bf16 v[52:55], v[4:7], v[160:167], v74
  ds_read_b128 v[16:19], v70 offset:3072
  ds_read_b64_tr_b16 v[44:45], v2 offset:24576
  ds_read_b64_tr_b16 v[46:47], v2 offset:26624
  v_smfmac_f32_16x16x64_bf16 v[56:59], v[4:7], v[20:27], v74
  ds_read_b64_tr_b16 v[48:49], v2 offset:28672
  ds_read_b64_tr_b16 v[50:51], v2 offset:30720
  s_waitcnt lgkmcnt(10)
  v_smfmac_f32_16x16x64_bf16 v[52:55], v[8:11], v[168:175], v74
  ds_read_b128 v[4:7], v71 offset:0
  ds_read_b64_tr_b16 v[20:21], v3 offset:0
  ds_read_b64_tr_b16 v[22:23], v3 offset:2048
  v_smfmac_f32_16x16x64_bf16 v[56:59], v[8:11], v[28:35], v74
  ds_read_b64_tr_b16 v[24:25], v3 offset:4096
  ds_read_b64_tr_b16 v[26:27], v3 offset:6144
  s_waitcnt lgkmcnt(10)
  v_smfmac_f32_16x16x64_bf16 v[52:55], v[12:15], v[176:183], v74
  ds_read_b128 v[8:11], v71 offset:1024
  ds_read_b64_tr_b16 v[28:29], v3 offset:8192
  ds_read_b64_tr_b16 v[30:31], v3 offset:10240
  v_smfmac_f32_16x16x64_bf16 v[56:59], v[12:15], v[36:43], v74
  ds_read_b64_tr_b16 v[32:33], v3 offset:12288
  ds_read_b64_tr_b16 v[34:35], v3 offset:14336
  s_waitcnt lgkmcnt(10)
  v_smfmac_f32_16x16x64_bf16 v[52:55], v[16:19], v[184:191], v74
  ds_read_b128 v[12:15], v71 offset:2048
  ds_read_b64_tr_b16 v[36:37], v3 offset:16384
  ds_read_b64_tr_b16 v[38:39], v3 offset:18432
  v_smfmac_f32_16x16x64_bf16 v[56:59], v[16:19], v[44:51], v74
  ds_read_b64_tr_b16 v[40:41], v3 offset:20480
  ds_read_b64_tr_b16 v[42:43], v3 offset:22528
  s_waitcnt lgkmcnt(10)
  v_smfmac_f32_16x16x64_bf16 v[52:55], v[4:7], v[192:199], v74
  ds_read_b128 v[16:19], v71 offset:3072
  ds_read_b64_tr_b16 v[44:45], v3 offset:24576
  ds_read_b64_tr_b16 v[46:47], v3 offset:26624
  v_smfmac_f32_16x16x64_bf16 v[56:59], v[4:7], v[20:27], v74
  ds_read_b64_tr_b16 v[48:49], v3 offset:28672
  ds_read_b64_tr_b16 v[50:51], v3 offset:30720
  s_waitcnt lgkmcnt(10)
  v_smfmac_f32_16x16x64_bf16 v[52:55], v[8:11], v[200:207], v74
  ds_read_b128 v[4:7], v72 offset:0
  ds_read_b64_tr_b16 v[20:21], v68 offset:0
  ds_read_b64_tr_b16 v[22:23], v68 offset:2048
  v_smfmac_f32_16x16x64_bf16 v[56:59], v[8:11], v[28:35], v74
  ds_read_b64_tr_b16 v[24:25], v68 offset:4096
  ds_read_b64_tr_b16 v[26:27], v68 offset:6144
  s_waitcnt lgkmcnt(10)
  v_smfmac_f32_16x16x64_bf16 v[52:55], v[12:15], v[208:215], v74
  ds_read_b128 v[8:11], v72 offset:1024
  ds_read_b64_tr_b16 v[28:29], v68 offset:8192
  ds_read_b64_tr_b16 v[30:31], v68 offset:10240
  v_smfmac_f32_16x16x64_bf16 v[56:59], v[12:15], v[36:43], v74
  ds_read_b64_tr_b16 v[32:33], v68 offset:12288
  ds_read_b64_tr_b16 v[34:35], v68 offset:14336
  s_waitcnt lgkmcnt(10)
  v_smfmac_f32_16x16x64_bf16 v[52:55], v[16:19], v[216:223], v74
  ds_read_b128 v[12:15], v72 offset:2048
  ds_read_b64_tr_b16 v[36:37], v68 offset:16384
  ds_read_b64_tr_b16 v[38:39], v68 offset:18432
  v_smfmac_f32_16x16x64_bf16 v[56:59], v[16:19], v[44:51], v74
  ds_read_b64_tr_b16 v[40:41], v68 offset:20480
  ds_read_b64_tr_b16 v[42:43], v68 offset:22528
  s_waitcnt lgkmcnt(10)
  v_smfmac_f32_16x16x64_bf16 v[52:55], v[4:7], v[224:231], v74
  ds_read_b128 v[16:19], v72 offset:3072
  ds_read_b64_tr_b16 v[44:45], v68 offset:24576
  ds_read_b64_tr_b16 v[46:47], v68 offset:26624
  v_smfmac_f32_16x16x64_bf16 v[56:59], v[4:7], v[20:27], v74
  ds_read_b64_tr_b16 v[48:49], v68 offset:28672
  ds_read_b64_tr_b16 v[50:51], v68 offset:30720
  s_waitcnt lgkmcnt(10)
  v_smfmac_f32_16x16x64_bf16 v[52:55], v[8:11], v[232:239], v74
  v_smfmac_f32_16x16x64_bf16 v[56:59], v[8:11], v[28:35], v74
  s_waitcnt lgkmcnt(5)
  v_smfmac_f32_16x16x64_bf16 v[52:55], v[12:15], v[240:247], v74
  v_smfmac_f32_16x16x64_bf16 v[56:59], v[12:15], v[36:43], v74
  s_waitcnt lgkmcnt(0)
  v_smfmac_f32_16x16x64_bf16 v[52:55], v[16:19], v[248:255], v74
  v_smfmac_f32_16x16x64_bf16 v[56:59], v[16:19], v[44:51], v74
  s_nop 6
  v_pk_add_f32 v[52:53], v[52:53], v[54:55]
  v_pk_add_f32 v[56:57], v[56:57], v[58:59]
  v_cvt_pk_bf16_f32 v4, v52, v53
  v_cvt_pk_bf16_f32 v5, v56, v57
  v_min_u32 v4, -2, v4
  v_min_u32 v5, -2, v5
  buffer_store_dwordx2 v[4:5], v78, s[4:7], s29 offen sc1
  s_cmp_ge_u32 s25, 63
  s_cbranch_scc1 L_VO_end
  s_add_u32 s30, s28, 4096
  s_add_u32 s31, s28, 32768
  s_add_u32 s32, s28, 36864
  s_add_u32 s40, s25, 1
  v_mov_b32 v80, s40
  s_and_b32 s40, s40, 3
  s_lshl_b32 s40, s40, 16
  s_add_u32 s33, s40, s26
  s_add_u32 s33, s33, 1048576
  s_xor_b32 s34, s33, 0x20000
  s_xor_b32 s35, s29, 262144
  buffer_store_dword v88, v124, s[4:7], s34 offen sc1
  buffer_store_dwordx2 v[88:89], v78, s[4:7], s35 offen sc1
  v_mov_b64 v[60:61], 0
  v_mov_b64 v[62:63], 0
  v_mov_b64 v[64:65], 0
  v_mov_b64 v[66:67], 0
  s_nop 1
  s_cmp_lg_u32 s20, 0
  s_cbranch_scc1 Ltrigd_46
  s_mov_b64 exec, 1
  buffer_load_dword v84, v76, s[4:7], 0 offen offset:128 sc1
  s_sleep 1
  buffer_load_dword v85, v76, s[4:7], 0 offen offset:128 sc1
  s_sleep 1
  buffer_load_dword v86, v76, s[4:7], 0 offen offset:128 sc1
  s_sleep 1
Ltrig_45:
  s_sub_u32 s24, s24, 1
  s_cbranch_scc1 L_FAIL
  buffer_load_dword v87, v76, s[4:7], 0 offen offset:128 sc1
  s_waitcnt vmcnt(3)
  v_cmp_gt_i32 vcc, s25, v84
  s_cbranch_vccz Ltrigd_46
  buffer_load_dword v84, v76, s[4:7], 0 offen offset:128 sc1
  s_waitcnt vmcnt(3)
  v_cmp_gt_i32 vcc, s25, v85
  s_cbranch_vccz Ltrigd_46
  buffer_load_dword v85, v76, s[4:7], 0 offen offset:128 sc1
  s_waitcnt vmcnt(3)
  v_cmp_gt_i32 vcc, s25, v86
  s_cbranch_vccz Ltrigd_46
  buffer_load_dword v86, v76, s[4:7], 0 offen offset:128 sc1
  s_waitcnt vmcnt(3)
  v_cmp_gt_i32 vcc, s25, v87
  s_cbranch_vccnz Ltrig_45
Ltrigd_46:
  s_mov_b64 exec, -1
  s_barrier
  buffer_load_dwordx4 v[92:95], v81, s[4:7], s28 offen offset:0 sc1
  s_nop 0
  buffer_load_dwordx4 v[96:99], v81, s[4:7], s28 offen offset:1024 sc1
  s_nop 0
  buffer_load_dwordx4 v[100:103], v81, s[4:7], s28 offen offset:2048 sc1
  s_nop 0
  buffer_load_dwordx4 v[104:107], v81, s[4:7], s28 offen offset:3072 sc1
  s_nop 0
  buffer_load_dwordx4 v[108:111], v81, s[4:7], s30 offen offset:0 sc1
  s_nop 0
  buffer_load_dwordx4 v[112:115], v81, s[4:7], s30 offen offset:1024 sc1
  s_nop 0
  buffer_load_dwordx4 v[116:119], v81, s[4:7], s30 offen offset:2048 sc1
  s_nop 0
  buffer_load_dwordx4 v[120:123], v81, s[4:7], s30 offen offset:3072 sc1
  s_nop 0
L_VO_chk0:
  s_waitcnt vmcnt(7)
  v_max3_u32 v75, v92, v93, v94
  v_max_u32 v75, v75, v95
  v_cmp_eq_u32 vcc, -1, v75
  s_cbranch_vccnz L_VO_obad0
  v_smfmac_f32_16x16x64_bf16 v[60:63], v[92:95], a[0:7], v74
  v_smfmac_f32_16x16x64_bf16 v[64:67], v[92:95], a[8:15], v74
  buffer_load_dwordx4 v[92:95], v81, s[4:7], s31 offen offset:0 sc1
L_VO_chk1:
  s_waitcnt vmcnt(7)
  v_max3_u32 v75, v96, v97, v98
  v_max_u32 v75, v75, v99
  v_cmp_eq_u32 vcc, -1, v75
  s_cbranch_vccnz L_VO_obad1
  v_smfmac_f32_16x16x64_bf16 v[60:63], v[96:99], a[16:23], v74
  v_smfmac_f32_16x16x64_bf16 v[64:67], v[96:99], a[24:31], v74
  buffer_load_dwordx4 v[96:99], v81, s[4:7], s31 offen offset:1024 sc1
L_VO_chk2:
  s_waitcnt vmcnt(7)
  v_max3_u32 v75, v100, v101, v102
  v_max_u32 v75, v75, v103
  v_cmp_eq_u32 vcc, -1, v75
  s_cbranch_vccnz L_VO_obad2
  v_smfmac_f32_16x16x64_bf16 v[60:63], v[100:103], a[32:39], v74
  v_smfmac_f32_16x16x64_bf16 v[64:67], v[100:103], a[40:47], v74
  buffer_load_dwordx4 v[100:103], v81, s[4:7], s31 offen offset:2048 sc1
L_VO_chk3:
  s_waitcnt vmcnt(7)
  v_max3_u32 v75, v104, v105, v106
  v_max_u32 v75, v75, v107
  v_cmp_eq_u32 vcc, -1, v75
  s_cbranch_vccnz L_VO_obad3
  v_smfmac_f32_16x16x64_bf16 v[60:63], v[104:107], a[48:55], v74
  v_smfmac_f32_16x16x64_bf16 v[64:67], v[104:107], a[56:63], v74
  buffer_load_dwordx4 v[104:107], v81, s[4:7], s31 offen offset:3072 sc1
L_VO_chk4:
  s_waitcnt vmcnt(7)
  v_max3_u32 v75, v108, v109, v110
  v_max_u32 v75, v75, v111
  v_cmp_eq_u32 vcc, -1, v75
  s_cbranch_vccnz L_VO_obad4
  v_smfmac_f32_16x16x64_bf16 v[60:63], v[108:111], a[64:71], v74
  v_smfmac_f32_16x16x64_bf16 v[64:67], v[108:111], a[72:79], v74
  buffer_load_dwordx4 v[108:111], v81, s[4:7], s32 offen offset:0 sc1
L_VO_chk5:
  s_waitcnt vmcnt(7)
  v_max3_u32 v75, v112, v113, v114
  v_max_u32 v75, v75, v115
  v_cmp_eq_u32 vcc, -1, v75
  s_cbranch_vccnz L_VO_obad5
  v_smfmac_f32_16x16x64_bf16 v[60:63], v[112:115], a[80:87], v74
  v_smfmac_f32_16x16x64_bf16 v[64:67], v[112:115], a[88:95], v74
  buffer_load_dwordx4 v[112:115], v81, s[4:7], s32 offen offset:1024 sc1
L_VO_chk6:
  s_waitcnt vmcnt(7)
  v_max3_u32 v75, v116, v117, v118
  v_max_u32 v75, v75, v119
  v_cmp_eq_u32 vcc, -1, v75
  s_cbranch_vccnz L_VO_obad6
  v_smfmac_f32_16x16x64_bf16 v[60:63], v[116:119], a[96:103], v74
  v_smfmac_f32_16x16x64_bf16 v[64:67], v[116:119], a[104:111], v74
  buffer_load_dwordx4 v[116:119], v81, s[4:7], s32 offen offset:2048 sc1
L_VO_chk7:
  s_waitcnt vmcnt(7)
  v_max3_u32 v75, v120, v121, v122
  v_max_u32 v75, v75, v123
  v_cmp_eq_u32 vcc, -1, v75
  s_cbranch_vccnz L_VO_obad7
  v_smfmac_f32_16x16x64_bf16 v[60:63], v[120:123], a[112:119], v74
  v_smfmac_f32_16x16x64_bf16 v[64:67], v[120:123], a[120:127], v74
  buffer_load_dwordx4 v[120:123], v81, s[4:7], s32 offen offset:3072 sc1
L_VO_chk8:
  s_waitcnt vmcnt(7)
  v_max3_u32 v75, v92, v93, v94
  v_max_u32 v75, v75, v95
  v_cmp_eq_u32 vcc, -1, v75
  s_cbranch_vccnz L_VO_obad8
  v_smfmac_f32_16x16x64_bf16 v[60:63], v[92:95], a[128:135], v74
  v_smfmac_f32_16x16x64_bf16 v[64:67], v[92:95], a[136:143], v74
L_VO_chk9:
  s_waitcnt vmcnt(6)
  v_max3_u32 v75, v96, v97, v98
  v_max_u32 v75, v75, v99
  v_cmp_eq_u32 vcc, -1, v75
  s_cbranch_vccnz L_VO_obad9
  v_smfmac_f32_16x16x64_bf16 v[60:63], v[96:99], a[144:151], v74
  v_smfmac_f32_16x16x64_bf16 v[64:67], v[96:99], a[152:159], v74
L_VO_chk10:
  s_waitcnt vmcnt(5)
  v_max3_u32 v75, v100, v101, v102
  v_max_u32 v75, v75, v103
  v_cmp_eq_u32 vcc, -1, v75
  s_cbranch_vccnz L_VO_obad10
  v_smfmac_f32_16x16x64_bf16 v[60:63], v[100:103], a[160:167], v74
  v_smfmac_f32_16x16x64_bf16 v[64:67], v[100:103], a[168:175], v74
L_VO_chk11:
  s_waitcnt vmcnt(4)
  v_max3_u32 v75, v104, v105, v106
  v_max_u32 v75, v75, v107
  v_cmp_eq_u32 vcc, -1, v75
  s_cbranch_vccnz L_VO_obad11
  v_smfmac_f32_16x16x64_bf16 v[60:63], v[104:107], a[176:183], v74
  v_smfmac_f32_16x16x64_bf16 v[64:67], v[104:107], a[184:191], v74
L_VO_chk12:
  s_waitcnt vmcnt(3)
  v_max3_u32 v75, v108, v109, v110
  v_max_u32 v75, v75, v111
  v_cmp_eq_u32 vcc, -1, v75
  s_cbranch_vccnz L_VO_obad12
  v_smfmac_f32_16x16x64_bf16 v[60:63], v[108:111], a[192:199], v74
  v_smfmac_f32_16x16x64_bf16 v[64:67], v[108:111], a[200:207], v74
L_VO_chk13:
  s_waitcnt vmcnt(2)
  v_max3_u32 v75, v112, v113, v114
  v_max_u32 v75, v75, v115
  v_cmp_eq_u32 vcc, -1, v75
  s_cbranch_vccnz L_VO_obad13
  v_smfmac_f32_16x16x64_bf16 v[60:63], v[112:115], a[208:215], v74
  v_smfmac_f32_16x16x64_bf16 v[64:67], v[112:115], a[216:223], v74
L_VO_chk14:
  s_waitcnt vmcnt(1)
  v_max3_u32 v75, v116, v117, v118
  v_max_u32 v75, v75, v119
  v_cmp_eq_u32 vcc, -1, v75
  s_cbranch_vccnz L_VO_obad14
  v_smfmac_f32_16x16x64_bf16 v[60:63], v[116:119], a[224:231], v74
  v_smfmac_f32_16x16x64_bf16 v[64:67], v[116:119], a[232:239], v74
L_VO_chk15:
  s_waitcnt vmcnt(0)
  v_max3_u32 v75, v120, v121, v122
  v_max_u32 v75, v75, v123
  v_cmp_eq_u32 vcc, -1, v75
  s_cbranch_vccnz L_VO_obad15
  buffer_store_dword v80, v77, s[4:7], 0 offen sc1
  v_smfmac_f32_16x16x64_bf16 v[60:63], v[120:123], a[240:247], v74
  v_smfmac_f32_16x16x64_bf16 v[64:67], v[120:123], a[248:255], v74
  s_nop 6
  v_add_f32 v4, v60, v62
  v_add_f32 v6, v61, v63
  v_add_f32 v5, v64, v66
  v_add_f32 v7, v65, v67
  ds_write_b128 v82, v[4:7]
  s_waitcnt lgkmcnt(0)
  s_barrier
  ds_read2st64_b64 v[8:11], v83 offset0:0 offset1:2
  ds_read2st64_b64 v[12:15], v83 offset0:4 offset1:6
  s_waitcnt lgkmcnt(1)
  v_pk_add_f32 v[8:9], v[8:9], v[10:11]
  s_waitcnt lgkmcnt(0)
  v_pk_add_f32 v[12:13], v[12:13], v[14:15]
  v_pk_add_f32 v[8:9], v[8:9], v[12:13]
  v_cvt_pk_bf16_f32 v8, v8, v9
  v_min_u32 v8, -2, v8
  buffer_store_dword v8, v124, s[4:7], s33 offen sc1
  s_add_u32 s25, s25, 1
  s_branch L_VO_top
L_VO_end:
  s_branch L_END
L_VO_bad:
  s_nop 7
  s_sub_u32 s24, s24, 1
  s_cbranch_scc1 L_FAIL
  s_add_u32 s60, s60, 1
  s_waitcnt lgkmcnt(0)
  v_mov_b64 v[52:53], 0
  v_mov_b64 v[54:55], 0
  v_mov_b64 v[56:57], 0
  v_mov_b64 v[58:59], 0
  ds_read_b64_tr_b16 v[20:21], v1 offset:0
  ds_read_b64_tr_b16 v[22:23], v1 offset:2048
  ds_read_b64_tr_b16 v[24:25], v1 offset:4096
  ds_read_b64_tr_b16 v[26:27], v1 offset:6144
  ds_read_b64_tr_b16 v[28:29], v1 offset:8192
  ds_read_b64_tr_b16 v[30:31], v1 offset:10240
  ds_read_b64_tr_b16 v[32:33], v1 offset:12288
  ds_read_b64_tr_b16 v[34:35], v1 offset:14336
  ds_read_b64_tr_b16 v[36:37], v1 offset:16384
  ds_read_b64_tr_b16 v[38:39], v1 offset:18432
  ds_read_b64_tr_b16 v[40:41], v1 offset:20480
  ds_read_b64_tr_b16 v[42:43], v1 offset:22528
  ds_read_b64_tr_b16 v[44:45], v1 offset:24576
  ds_read_b64_tr_b16 v[46:47], v1 offset:26624
  ds_read_b64_tr_b16 v[48:49], v1 offset:28672
  ds_read_b64_tr_b16 v[50:51], v1 offset:30720
  s_branch L_VO_retry
L_VO_obad0:
  s_sub_u32 s24, s24, 1
  s_cbranch_scc1 L_FAIL
  s_add_u32 s61, s61, 1
  s_waitcnt vmcnt(0)
  buffer_load_dwordx4 v[92:95], v81, s[4:7], s28 offen offset:0 sc1
  buffer_load_dwordx4 v[96:99], v81, s[4:7], s28 offen offset:1024 sc1
  buffer_load_dwordx4 v[100:103], v81, s[4:7], s28 offen offset:2048 sc1
  buffer_load_dwordx4 v[104:107], v81, s[4:7], s28 offen offset:3072 sc1
  buffer_load_dwordx4 v[108:111], v81, s[4:7], s30 offen offset:0 sc1
  buffer_load_dwordx4 v[112:115], v81, s[4:7], s30 offen offset:1024 sc1
  buffer_load_dwordx4 v[116:119], v81, s[4:7], s30 offen offset:2048 sc1
  buffer_load_dwordx4 v[120:123], v81, s[4:7], s30 offen offset:3072 sc1
  s_branch L_VO_chk0
L_VO_obad1:
  s_sub_u32 s24, s24, 1
  s_cbranch_scc1 L_FAIL
  s_add_u32 s61, s61, 1
  s_waitcnt vmcnt(0)
  buffer_load_dwordx4 v[96:99], v81, s[4:7], s28 offen offset:1024 sc1
  buffer_load_dwordx4 v[100:103], v81, s[4:7], s28 offen offset:2048 sc1
  buffer_load_dwordx4 v[104:107], v81, s[4:7], s28 offen offset:3072 sc1
  buffer_load_dwordx4 v[108:111], v81, s[4:7], s30 offen offset:0 sc1
  buffer_load_dwordx4 v[112:115], v81, s[4:7], s30 offen offset:1024 sc1
  buffer_load_dwordx4 v[116:119], v81, s[4:7], s30 offen offset:2048 sc1
  buffer_load_dwordx4 v[120:123], v81, s[4:7], s30 offen offset:3072 sc1
  buffer_load_dwordx4 v[92:95], v81, s[4:7], s31 offen offset:0 sc1
  s_branch L_VO_chk1
L_VO_obad2:
  s_sub_u32 s24, s24, 1
  s_cbranch_scc1 L_FAIL
  s_add_u32 s61, s61, 1
  s_waitcnt vmcnt(0)
  buffer_load_dwordx4 v[100:103], v81, s[4:7], s28 offen offset:2048 sc1
  buffer_load_dwordx4 v[104:107], v81, s[4:7], s28 offen offset:3072 sc1
  buffer_load_dwordx4 v[108:111], v81, s[4:7], s30 offen offset:0 sc1
  buffer_load_dwordx4 v[112:115], v81, s[4:7], s30 offen offset:1024 sc1
  buffer_load_dwordx4 v[116:119], v81, s[4:7], s30 offen offset:2048 sc1
  buffer_load_dwordx4 v[120:123], v81, s[4:7], s30 offen offset:3072 sc1
  buffer_load_dwordx4 v[92:95], v81, s[4:7], s31 offen offset:0 sc1
  buffer_load_dwordx4 v[96:99], v81, s[4:7], s31 offen offset:1024 sc1
  s_branch L_VO_chk2
L_VO_obad3:
  s_sub_u32 s24, s24, 1
  s_cbranch_scc1 L_FAIL
  s_add_u32 s61, s61, 1
  s_waitcnt vmcnt(0)
  buffer_load_dwordx4 v[104:107], v81, s[4:7], s28 offen offset:3072 sc1
  buffer_load_dwordx4 v[108:111], v81, s[4:7], s30 offen offset:0 sc1
  buffer_load_dwordx4 v[112:115], v81, s[4:7], s30 offen offset:1024 sc1
  buffer_load_dwordx4 v[116:119], v81, s[4:7], s30 offen offset:2048 sc1
  buffer_load_dwordx4 v[120:123], v81, s[4:7], s30 offen offset:3072 sc1
  buffer_load_dwordx4 v[92:95], v81, s[4:7], s31 offen offset:0 sc1
  buffer_load_dwordx4 v[96:99], v81, s[4:7], s31 offen offset:1024 sc1
  buffer_load_dwordx4 v[100:103], v81, s[4:7], s31 offen offset:2048 sc1
  s_branch L_VO_chk3
L_VO_obad4:
  s_sub_u32 s24, s24, 1
  s_cbranch_scc1 L_FAIL
  s_add_u32 s61, s61, 1
  s_waitcnt vmcnt(0)
  buffer_load_dwordx4 v[108:111], v81, s[4:7], s30 offen offset:0 sc1
  buffer_load_dwordx4 v[112:115], v81, s[4:7], s30 offen offset:1024 sc1
  buffer_load_dwordx4 v[116:119], v81, s[4:7], s30 offen offset:2048 sc1
  buffer_load_dwordx4 v[120:123], v81, s[4:7], s30 offen offset:3072 sc1
  buffer_load_dwordx4 v[92:95], v81, s[4:7], s31 offen offset:0 sc1
  buffer_load_dwordx4 v[96:99], v81, s[4:7], s31 offen offset:1024 sc1
  buffer_load_dwordx4 v[100:103], v81, s[4:7], s31 offen offset:2048 sc1
  buffer_load_dwordx4 v[104:107], v81, s[4:7], s31 offen offset:3072 sc1
  s_branch L_VO_chk4
L_VO_obad5:
  s_sub_u32 s24, s24, 1
  s_cbranch_scc1 L_FAIL
  s_add_u32 s61, s61, 1
  s_waitcnt vmcnt(0)
  buffer_load_dwordx4 v[112:115], v81, s[4:7], s30 offen offset:1024 sc1
  buffer_load_dwordx4 v[116:119], v81, s[4:7], s30 offen offset:2048 sc1
  buffer_load_dwordx4 v[120:123], v81, s[4:7], s30 offen offset:3072 sc1
  buffer_load_dwordx4 v[92:95], v81, s[4:7], s31 offen offset:0 sc1
  buffer_load_dwordx4 v[96:99], v81, s[4:7], s31 offen offset:1024 sc1
  buffer_load_dwordx4 v[100:103], v81, s[4:7], s31 offen offset:2048 sc1
  buffer_load_dwordx4 v[104:107], v81, s[4:7], s31 offen offset:3072 sc1
  buffer_load_dwordx4 v[108:111], v81, s[4:7], s32 offen offset:0 sc1
  s_branch L_VO_chk5
L_VO_obad6:
  s_sub_u32 s24, s24, 1
  s_cbranch_scc1 L_FAIL
  s_add_u32 s61, s61, 1
  s_waitcnt vmcnt(0)
  buffer_load_dwordx4 v[116:119], v81, s[4:7], s30 offen offset:2048 sc1
  buffer_load_dwordx4 v[120:123], v81, s[4:7], s30 offen offset:3072 sc1
  buffer_load_dwordx4 v[92:95], v81, s[4:7], s31 offen offset:0 sc1
  buffer_load_dwordx4 v[96:99], v81, s[4:7], s31 offen offset:1024 sc1
  buffer_load_dwordx4 v[100:103], v81, s[4:7], s31 offen offset:2048 sc1
  buffer_load_dwordx4 v[104:107], v81, s[4:7], s31 offen offset:3072 sc1
  buffer_load_dwordx4 v[108:111], v81, s[4:7], s32 offen offset:0 sc1
  buffer_load_dwordx4 v[112:115], v81, s[4:7], s32 offen offset:1024 sc1
  s_branch L_VO_chk6
L_VO_obad7:
  s_sub_u32 s24, s24, 1
  s_cbranch_scc1 L_FAIL
  s_add_u32 s61, s61, 1
  s_waitcnt vmcnt(0)
  buffer_load_dwordx4 v[120:123], v81, s[4:7], s30 offen offset:3072 sc1
  buffer_load_dwordx4 v[92:95], v81, s[4:7], s31 offen offset:0 sc1
  buffer_load_dwordx4 v[96:99], v81, s[4:7], s31 offen offset:1024 sc1
  buffer_load_dwordx4 v[100:103], v81, s[4:7], s31 offen offset:2048 sc1
  buffer_load_dwordx4 v[104:107], v81, s[4:7], s31 offen offset:3072 sc1
  buffer_load_dwordx4 v[108:111], v81, s[4:7], s32 offen offset:0 sc1
  buffer_load_dwordx4 v[112:115], v81, s[4:7], s32 offen offset:1024 sc1
  buffer_load_dwordx4 v[116:119], v81, s[4:7], s32 offen offset:2048 sc1
  s_branch L_VO_chk7
L_VO_obad8:
  s_sub_u32 s24, s24, 1
  s_cbranch_scc1 L_FAIL
  s_add_u32 s61, s61, 1
  s_waitcnt vmcnt(0)
  buffer_load_dwordx4 v[92:95], v81, s[4:7], s31 offen offset:0 sc1
  buffer_load_dwordx4 v[96:99], v81, s[4:7], s31 offen offset:1024 sc1
  buffer_load_dwordx4 v[100:103], v81, s[4:7], s31 offen offset:2048 sc1
  buffer_load_dwordx4 v[104:107], v81, s[4:7], s31 offen offset:3072 sc1
  buffer_load_dwordx4 v[108:111], v81, s[4:7], s32 offen offset:0 sc1
  buffer_load_dwordx4 v[112:115], v81, s[4:7], s32 offen offset:1024 sc1
  buffer_load_dwordx4 v[116:119], v81, s[4:7], s32 offen offset:2048 sc1
  buffer_load_dwordx4 v[120:123], v81, s[4:7], s32 offen offset:3072 sc1
  s_branch L_VO_chk8
L_VO_obad9:
  s_sub_u32 s24, s24, 1
  s_cbranch_scc1 L_FAIL
  s_add_u32 s61, s61, 1
  s_waitcnt vmcnt(0)
  buffer_load_dwordx4 v[96:99], v81, s[4:7], s31 offen offset:1024 sc1
  buffer_load_dwordx4 v[100:103], v81, s[4:7], s31 offen offset:2048 sc1
  buffer_load_dwordx4 v[104:107], v81, s[4:7], s31 offen offset:3072 sc1
  buffer_load_dwordx4 v[108:111], v81, s[4:7], s32 offen offset:0 sc1
  buffer_load_dwordx4 v[112:115], v81, s[4:7], s32 offen offset:1024 sc1
  buffer_load_dwordx4 v[116:119], v81, s[4:7], s32 offen offset:2048 sc1
  buffer_load_dwordx4 v[120:123], v81, s[4:7], s32 offen offset:3072 sc1
  s_branch L_VO_chk9
L_VO_obad10:
  s_sub_u32 s24, s24, 1
  s_cbranch_scc1 L_FAIL
  s_add_u32 s61, s61, 1
  s_waitcnt vmcnt(0)
  buffer_load_dwordx4 v[100:103], v81, s[4:7], s31 offen offset:2048 sc1
  buffer_load_dwordx4 v[104:107], v81, s[4:7], s31 offen offset:3072 sc1
  buffer_load_dwordx4 v[108:111], v81, s[4:7], s32 offen offset:0 sc1
  buffer_load_dwordx4 v[112:115], v81, s[4:7], s32 offen offset:1024 sc1
  buffer_load_dwordx4 v[116:119], v81, s[4:7], s32 offen offset:2048 sc1
  buffer_load_dwordx4 v[120:123], v81, s[4:7], s32 offen offset:3072 sc1
  s_branch L_VO_chk10
L_VO_obad11:
  s_sub_u32 s24, s24, 1
  s_cbranch_scc1 L_FAIL
  s_add_u32 s61, s61, 1
  s_waitcnt vmcnt(0)
  buffer_load_dwordx4 v[104:107], v81, s[4:7], s31 offen offset:3072 sc1
  buffer_load_dwordx4 v[108:111], v81, s[4:7], s32 offen offset:0 sc1
  buffer_load_dwordx4 v[112:115], v81, s[4:7], s32 offen offset:1024 sc1
  buffer_load_dwordx4 v[116:119], v81, s[4:7], s32 offen offset:2048 sc1
  buffer_load_dwordx4 v[120:123], v81, s[4:7], s32 offen offset:3072 sc1
  s_branch L_VO_chk11
L_VO_obad12:
  s_sub_u32 s24, s24, 1
  s_cbranch_scc1 L_FAIL
  s_add_u32 s61, s61, 1
  s_waitcnt vmcnt(0)
  buffer_load_dwordx4 v[108:111], v81, s[4:7], s32 offen offset:0 sc1
  buffer_load_dwordx4 v[112:115], v81, s[4:7], s32 offen offset:1024 sc1
  buffer_load_dwordx4 v[116:119], v81, s[4:7], s32 offen offset:2048 sc1
  buffer_load_dwordx4 v[120:123], v81, s[4:7], s32 offen offset:3072 sc1
  s_branch L_VO_chk12
L_VO_obad13:
  s_sub_u32 s24, s24, 1
  s_cbranch_scc1 L_FAIL
  s_add_u32 s61, s61, 1
  s_waitcnt vmcnt(0)
  buffer_load_dwordx4 v[112:115], v81, s[4:7], s32 offen offset:1024 sc1
  buffer_load_dwordx4 v[116:119], v81, s[4:7], s32 offen offset:2048 sc1
  buffer_load_dwordx4 v[120:123], v81, s[4:7], s32 offen offset:3072 sc1
  s_branch L_VO_chk13
L_VO_obad14:
  s_sub_u32 s24, s24, 1
  s_cbranch_scc1 L_FAIL
  s_add_u32 s61, s61, 1
  s_waitcnt vmcnt(0)
  buffer_load_dwordx4 v[116:119], v81, s[4:7], s32 offen offset:2048 sc1
  buffer_load_dwordx4 v[120:123], v81, s[4:7], s32 offen offset:3072 sc1
  s_branch L_VO_chk14
L_VO_obad15:
  s_sub_u32 s24, s24, 1
  s_cbranch_scc1 L_FAIL
  s_add_u32 s61, s61, 1
  s_waitcnt vmcnt(0)
  buffer_load_dwordx4 v[120:123], v81, s[4:7], s32 offen offset:3072 sc1
  s_branch L_VO_chk15
.section .rodata,"a"
.p2align 6
.amdhsa_kernel adaLN_cond__memory_aug_recurrent_mem_tr__glu_gated_swiglu__prompt_kernel
  .amdhsa_next_free_vgpr 512
  .amdhsa_next_free_sgpr 102
  .amdhsa_accum_offset 256
  .amdhsa_group_segment_fixed_size 0
  .amdhsa_kernarg_size 128
  .amdhsa_user_sgpr_count 2
  .amdhsa_user_sgpr_kernarg_segment_ptr 1
  .amdhsa_system_sgpr_workgroup_id_x 1
  .amdhsa_float_denorm_mode_32 3
.end_amdhsa_kernel
```

```asm
; @launch grid=(256,1,1) block=(256,1,1) lds=163840
.amdgcn_target "amdgcn-amd-amdhsa--gfx950"
.text
.globl adaLN_cond__memory_aug_recurrent_mem_tr__glu_gated_swiglu__prompt_kernel
.p2align 8
.type adaLN_cond__memory_aug_recurrent_mem_tr__glu_gated_swiglu__prompt_kernel,@function
adaLN_cond__memory_aug_recurrent_mem_tr__glu_gated_swiglu__prompt_kernel:
  s_cmp_ge_u32 s2, 256
  s_cbranch_scc1 L_END
  s_load_dwordx2 s[4:5], s[0:1], 120
  s_load_dwordx2 s[12:13], s[0:1], 112
  v_lshrrev_b32 v1, 6, v0
  v_and_b32 v0, 63, v0
  v_readfirstlane_b32 s20, v1
  s_mov_b32 s6, 171966464
  s_mov_b32 s7, 0x20000
  s_mov_b32 s14, 256
  s_mov_b32 s15, 0x20000
  s_mov_b32 s24, 300000
  s_and_b32 s22, s2, 7
  s_lshr_b32 s23, s2, 3
  s_waitcnt lgkmcnt(0)
  s_add_u32 s4, s4, 0x1fffff
  s_addc_u32 s5, s5, 0
  s_and_b32 s4, s4, 0xffe00000
  s_cmp_ge_u32 s22, 4
  s_cbranch_scc1 L_TRAIL
  s_lshr_b32 s40, s22, 1
  s_bitcmp1_b32 s22, 0
  s_cbranch_scc0 L_REC
  s_lshl_b32 s40, s40, 5
  s_add_u32 s21, s40, s23
  s_branch L_QKV
L_REC:
  s_lshl_b32 s40, s40, 4
  s_lshr_b32 s41, s23, 1
  s_add_u32 s21, s40, s41
  s_bitcmp1_b32 s23, 0
  s_cbranch_scc1 L_VO
  s_branch L_QK
L_TRAIL:
  s_sub_u32 s40, s22, 4
  s_lshl_b32 s40, s40, 5
  s_add_u32 s21, s40, s23
  s_cmp_lg_u32 s22, 7
  s_cbranch_scc1 L_MOD
L_INIT:
  s_lshl_b32 s40, s23, 2
  s_add_u32 s40, s40, s20
  s_lshl_b32 s40, s40, 12
  s_add_u32 s41, s40, 1048576
  s_add_u32 s42, s40, 0x80000
  v_lshlrev_b32 v1, 4, v0
  v_mov_b32 v4, -1
  v_mov_b32 v5, -1
  v_mov_b32 v6, -1
  v_mov_b32 v7, -1
  buffer_store_dwordx4 v[4:7], v1, s[4:7], s41 offen offset:0 sc1
  buffer_store_dwordx4 v[4:7], v1, s[4:7], s41 offen offset:1024 sc1
  buffer_store_dwordx4 v[4:7], v1, s[4:7], s41 offen offset:2048 sc1
  buffer_store_dwordx4 v[4:7], v1, s[4:7], s41 offen offset:3072 sc1
  buffer_store_dwordx4 v[4:7], v1, s[4:7], s40 offen offset:0 sc1
  buffer_store_dwordx4 v[4:7], v1, s[4:7], s40 offen offset:1024 sc1
  buffer_store_dwordx4 v[4:7], v1, s[4:7], s40 offen offset:2048 sc1
  buffer_store_dwordx4 v[4:7], v1, s[4:7], s40 offen offset:3072 sc1
  buffer_store_dwordx4 v[4:7], v1, s[4:7], s42 offen offset:0 sc1
  buffer_store_dwordx4 v[4:7], v1, s[4:7], s42 offen offset:1024 sc1
  buffer_store_dwordx4 v[4:7], v1, s[4:7], s42 offen offset:2048 sc1
  buffer_store_dwordx4 v[4:7], v1, s[4:7], s42 offen offset:3072 sc1
  s_lshl_b32 s40, s23, 2
  s_add_u32 s40, s40, 128
  v_mov_b32 v2, 2147483392
  s_mov_b64 exec, 1
  v_mov_b32 v2, s40
  s_mov_b64 exec, -1
  v_mov_b32 v3, 1
  s_waitcnt vmcnt(0)
  s_barrier
  s_cmp_lg_u32 s20, 0
  s_cbranch_scc1 L_LN1
  buffer_store_dword v3, v2, s[12:15], 0 offen sc1
  s_branch L_LN1
L_MOD:
  s_load_dwordx2 s[16:17], s[0:1], 88
  s_mov_b32 s18, 2048
  s_mov_b32 s19, 0x20000
  s_waitcnt lgkmcnt(0)
  s_load_dwordx2 s[8:9], s[0:1], 96
  s_mov_b32 s10, 12582912
  s_mov_b32 s11, 0x20000
  s_waitcnt lgkmcnt(0)
  s_lshl_b32 s40, s20, 9
  v_lshl_add_u32 v1, v0, 3, s40
  buffer_load_dwordx2 v[8:9], v1, s[16:19], 0 offen
  v_bfe_u32 v2, v0, 5, 1
  v_mul_u32_u24 v2, 98304, v2
  v_bfe_u32 v3, v0, 4, 1
  v_mul_u32_u24 v3, 24576, v3
  v_add_u32 v2, v2, v3
  v_bfe_u32 v3, v0, 3, 1
  v_mul_u32_u24 v3, 12288, v3
  v_add_u32 v2, v2, v3
  v_lshrrev_b32 v3, 3, v0
  v_and_b32 v3, 6, v3
  v_xor_b32 v3, v3, v0
  v_and_b32 v3, 7, v3
  v_lshl_add_u32 v2, v3, 4, v2
  s_lshr_b32 s40, s20, 1
  s_mul_i32 s40, s40, 49152
  s_and_b32 s41, s20, 1
  s_mul_i32 s41, s41, 196608
  s_add_u32 s40, s40, s41
  s_lshl_b32 s41, s21, 7
  s_add_u32 s40, s40, s41
  v_add_u32 v2, s40, v2
  s_lshl_b32 s41, s20, 10
  s_add_u32 m0, s41, 0
  s_mov_b32 s42, 0
  buffer_load_dwordx4 v2, s[8:11], s42 offen lds
  s_add_u32 m0, s41, 4096
  s_mov_b32 s42, 393216
  buffer_load_dwordx4 v2, s[8:11], s42 offen lds
  s_add_u32 m0, s41, 8192
  s_mov_b32 s42, 786432
  buffer_load_dwordx4 v2, s[8:11], s42 offen lds
  s_add_u32 m0, s41, 12288
  s_mov_b32 s42, 1179648
  buffer_load_dwordx4 v2, s[8:11], s42 offen lds
  s_add_u32 m0, s41, 16384
  s_mov_b32 s42, 1572864
  buffer_load_dwordx4 v2, s[8:11], s42 offen lds
  s_add_u32 m0, s41, 20480
  s_mov_b32 s42, 1966080
  buffer_load_dwordx4 v2, s[8:11], s42 offen lds
  s_add_u32 m0, s41, 24576
  s_mov_b32 s42, 2359296
  buffer_load_dwordx4 v2, s[8:11], s42 offen lds
  s_add_u32 m0, s41, 28672
  s_mov_b32 s42, 2752512
  buffer_load_dwordx4 v2, s[8:11], s42 offen lds
  s_add_u32 m0, s41, 32768
  s_mov_b32 s42, 3145728
  buffer_load_dwordx4 v2, s[8:11], s42 offen lds
  s_add_u32 m0, s41, 36864
  s_mov_b32 s42, 3538944
  buffer_load_dwordx4 v2, s[8:11], s42 offen lds
  s_add_u32 m0, s41, 40960
  s_mov_b32 s42, 3932160
  buffer_load_dwordx4 v2, s[8:11], s42 offen lds
  s_add_u32 m0, s41, 45056
  s_mov_b32 s42, 4325376
  buffer_load_dwordx4 v2, s[8:11], s42 offen lds
  s_add_u32 m0, s41, 49152
  s_mov_b32 s42, 4718592
  buffer_load_dwordx4 v2, s[8:11], s42 offen lds
  s_add_u32 m0, s41, 53248
  s_mov_b32 s42, 5111808
  buffer_load_dwordx4 v2, s[8:11], s42 offen lds
  s_add_u32 m0, s41, 57344
  s_mov_b32 s42, 5505024
  buffer_load_dwordx4 v2, s[8:11], s42 offen lds
  s_add_u32 m0, s41, 61440
  s_mov_b32 s42, 5898240
  buffer_load_dwordx4 v2, s[8:11], s42 offen lds
  s_add_u32 m0, s41, 65536
  s_mov_b32 s42, 6291456
  buffer_load_dwordx4 v2, s[8:11], s42 offen lds
  s_add_u32 m0, s41, 69632
  s_mov_b32 s42, 6684672
  buffer_load_dwordx4 v2, s[8:11], s42 offen lds
  s_add_u32 m0, s41, 73728
  s_mov_b32 s42, 7077888
  buffer_load_dwordx4 v2, s[8:11], s42 offen lds
  s_add_u32 m0, s41, 77824
  s_mov_b32 s42, 7471104
  buffer_load_dwordx4 v2, s[8:11], s42 offen lds
  s_add_u32 m0, s41, 81920
  s_mov_b32 s42, 7864320
  buffer_load_dwordx4 v2, s[8:11], s42 offen lds
  s_add_u32 m0, s41, 86016
  s_mov_b32 s42, 8257536
  buffer_load_dwordx4 v2, s[8:11], s42 offen lds
  s_add_u32 m0, s41, 90112
  s_mov_b32 s42, 8650752
  buffer_load_dwordx4 v2, s[8:11], s42 offen lds
  s_add_u32 m0, s41, 94208
  s_mov_b32 s42, 9043968
  buffer_load_dwordx4 v2, s[8:11], s42 offen lds
  s_add_u32 m0, s41, 98304
  s_mov_b32 s42, 9437184
  buffer_load_dwordx4 v2, s[8:11], s42 offen lds
  s_add_u32 m0, s41, 102400
  s_mov_b32 s42, 9830400
  buffer_load_dwordx4 v2, s[8:11], s42 offen lds
  s_add_u32 m0, s41, 106496
  s_mov_b32 s42, 10223616
  buffer_load_dwordx4 v2, s[8:11], s42 offen lds
  s_add_u32 m0, s41, 110592
  s_mov_b32 s42, 10616832
  buffer_load_dwordx4 v2, s[8:11], s42 offen lds
  s_add_u32 m0, s41, 114688
  s_mov_b32 s42, 11010048
  buffer_load_dwordx4 v2, s[8:11], s42 offen lds
  s_add_u32 m0, s41, 118784
  s_mov_b32 s42, 11403264
  buffer_load_dwordx4 v2, s[8:11], s42 offen lds
  s_add_u32 m0, s41, 122880
  s_mov_b32 s42, 11796480
  buffer_load_dwordx4 v2, s[8:11], s42 offen lds
  s_add_u32 m0, s41, 126976
  s_mov_b32 s42, 12189696
  buffer_load_dwordx4 v2, s[8:11], s42 offen lds
  v_bfe_u32 v3, v0, 3, 2
  v_xor_b32 v3, s20, v3
  v_lshlrev_b32 v3, 5, v3
  v_lshrrev_b32 v4, 2, v0
  v_lshl_add_u32 v4, v4, 7, v3
  v_and_b32 v3, 3, v0
  v_lshl_add_u32 v4, v3, 3, v4
  v_add_u32 v5, 0x10000, v4
  v_lshrrev_b32 v6, 4, v0
  v_lshlrev_b32 v6, 4, v6
  v_add_u32 v6, 0x20000, v6
  v_add_u32 v1, 0x20000, v1
  s_mov_b32 s37, 0xbfb8aa3b
  s_waitcnt vmcnt(32)
  v_lshlrev_b32 v10, 16, v8
  v_and_b32 v11, 0xffff0000, v8
  v_lshlrev_b32 v12, 16, v9
  v_and_b32 v13, 0xffff0000, v9
  v_mul_f32 v14, s37, v10
  v_mul_f32 v15, s37, v11
  v_mul_f32 v16, s37, v12
  v_mul_f32 v17, s37, v13
  v_exp_f32 v14, v14
  v_exp_f32 v15, v15
  v_exp_f32 v16, v16
  v_exp_f32 v17, v17
  v_add_f32 v14, 1.0, v14
  v_add_f32 v15, 1.0, v15
  v_add_f32 v16, 1.0, v16
  v_add_f32 v17, 1.0, v17
  v_rcp_f32 v14, v14
  v_rcp_f32 v15, v15
  v_rcp_f32 v16, v16
  v_rcp_f32 v17, v17
  v_mul_f32 v10, v10, v14
  v_mul_f32 v11, v11, v15
  v_mul_f32 v12, v12, v16
  v_mul_f32 v13, v13, v17
  v_cvt_pk_bf16_f32 v8, v10, v11
  v_cvt_pk_bf16_f32 v9, v12, v13
  ds_write_b64 v1, v[8:9]
  s_waitcnt vmcnt(28) lgkmcnt(0)
  s_barrier
  ds_read_b64_tr_b16 v[24:25], v4 offset:0
  ds_read_b64_tr_b16 v[26:27], v4 offset:2048
  ds_read_b128 v[28:31], v6 offset:0
  ds_read_b64_tr_b16 v[32:33], v4 offset:4096
  ds_read_b64_tr_b16 v[34:35], v4 offset:6144
  ds_read_b128 v[36:39], v6 offset:64
  ds_read_b64_tr_b16 v[40:41], v4 offset:8192
  ds_read_b64_tr_b16 v[42:43], v4 offset:10240
  ds_read_b128 v[44:47], v6 offset:128
  ds_read_b64_tr_b16 v[48:49], v4 offset:12288
  ds_read_b64_tr_b16 v[50:51], v4 offset:14336
  ds_read_b128 v[52:55], v6 offset:192
  s_waitcnt lgkmcnt(9)
  v_mfma_f32_16x16x32_bf16 v[20:23], v[24:27], v[28:31], 0
  s_waitcnt lgkmcnt(6)
  v_mfma_f32_16x16x32_bf16 v[20:23], v[32:35], v[36:39], v[20:23]
  s_waitcnt lgkmcnt(3)
  v_mfma_f32_16x16x32_bf16 v[20:23], v[40:43], v[44:47], v[20:23]
  s_waitcnt lgkmcnt(0)
  v_mfma_f32_16x16x32_bf16 v[20:23], v[48:51], v[52:55], v[20:23]
  s_waitcnt vmcnt(24) lgkmcnt(0)
  s_barrier
  ds_read_b64_tr_b16 v[24:25], v4 offset:16384
  ds_read_b64_tr_b16 v[26:27], v4 offset:18432
  ds_read_b128 v[28:31], v6 offset:256
  ds_read_b64_tr_b16 v[32:33], v4 offset:20480
  ds_read_b64_tr_b16 v[34:35], v4 offset:22528
  ds_read_b128 v[36:39], v6 offset:320
  ds_read_b64_tr_b16 v[40:41], v4 offset:24576
  ds_read_b64_tr_b16 v[42:43], v4 offset:26624
  ds_read_b128 v[44:47], v6 offset:384
  ds_read_b64_tr_b16 v[48:49], v4 offset:28672
  ds_read_b64_tr_b16 v[50:51], v4 offset:30720
  ds_read_b128 v[52:55], v6 offset:448
  s_waitcnt lgkmcnt(9)
  v_mfma_f32_16x16x32_bf16 v[20:23], v[24:27], v[28:31], v[20:23]
  s_waitcnt lgkmcnt(6)
  v_mfma_f32_16x16x32_bf16 v[20:23], v[32:35], v[36:39], v[20:23]
  s_waitcnt lgkmcnt(3)
  v_mfma_f32_16x16x32_bf16 v[20:23], v[40:43], v[44:47], v[20:23]
  s_waitcnt lgkmcnt(0)
  v_mfma_f32_16x16x32_bf16 v[20:23], v[48:51], v[52:55], v[20:23]
  s_waitcnt vmcnt(20) lgkmcnt(0)
  s_barrier
  ds_read_b64_tr_b16 v[24:25], v4 offset:32768
  ds_read_b64_tr_b16 v[26:27], v4 offset:34816
  ds_read_b128 v[28:31], v6 offset:512
  ds_read_b64_tr_b16 v[32:33], v4 offset:36864
  ds_read_b64_tr_b16 v[34:35], v4 offset:38912
  ds_read_b128 v[36:39], v6 offset:576
  ds_read_b64_tr_b16 v[40:41], v4 offset:40960
  ds_read_b64_tr_b16 v[42:43], v4 offset:43008
  ds_read_b128 v[44:47], v6 offset:640
  ds_read_b64_tr_b16 v[48:49], v4 offset:45056
  ds_read_b64_tr_b16 v[50:51], v4 offset:47104
  ds_read_b128 v[52:55], v6 offset:704
  s_waitcnt lgkmcnt(9)
  v_mfma_f32_16x16x32_bf16 v[20:23], v[24:27], v[28:31], v[20:23]
  s_waitcnt lgkmcnt(6)
  v_mfma_f32_16x16x32_bf16 v[20:23], v[32:35], v[36:39], v[20:23]
  s_waitcnt lgkmcnt(3)
  v_mfma_f32_16x16x32_bf16 v[20:23], v[40:43], v[44:47], v[20:23]
  s_waitcnt lgkmcnt(0)
  v_mfma_f32_16x16x32_bf16 v[20:23], v[48:51], v[52:55], v[20:23]
  s_waitcnt vmcnt(16) lgkmcnt(0)
  s_barrier
  ds_read_b64_tr_b16 v[24:25], v4 offset:49152
  ds_read_b64_tr_b16 v[26:27], v4 offset:51200
  ds_read_b128 v[28:31], v6 offset:768
  ds_read_b64_tr_b16 v[32:33], v4 offset:53248
  ds_read_b64_tr_b16 v[34:35], v4 offset:55296
  ds_read_b128 v[36:39], v6 offset:832
  ds_read_b64_tr_b16 v[40:41], v4 offset:57344
  ds_read_b64_tr_b16 v[42:43], v4 offset:59392
  ds_read_b128 v[44:47], v6 offset:896
  ds_read_b64_tr_b16 v[48:49], v4 offset:61440
  ds_read_b64_tr_b16 v[50:51], v4 offset:63488
  ds_read_b128 v[52:55], v6 offset:960
  s_waitcnt lgkmcnt(9)
  v_mfma_f32_16x16x32_bf16 v[20:23], v[24:27], v[28:31], v[20:23]
  s_waitcnt lgkmcnt(6)
  v_mfma_f32_16x16x32_bf16 v[20:23], v[32:35], v[36:39], v[20:23]
  s_waitcnt lgkmcnt(3)
  v_mfma_f32_16x16x32_bf16 v[20:23], v[40:43], v[44:47], v[20:23]
  s_waitcnt lgkmcnt(0)
  v_mfma_f32_16x16x32_bf16 v[20:23], v[48:51], v[52:55], v[20:23]
  s_waitcnt vmcnt(12) lgkmcnt(0)
  s_barrier
  ds_read_b64_tr_b16 v[24:25], v5 offset:0
  ds_read_b64_tr_b16 v[26:27], v5 offset:2048
  ds_read_b128 v[28:31], v6 offset:1024
  ds_read_b64_tr_b16 v[32:33], v5 offset:4096
  ds_read_b64_tr_b16 v[34:35], v5 offset:6144
  ds_read_b128 v[36:39], v6 offset:1088
  ds_read_b64_tr_b16 v[40:41], v5 offset:8192
  ds_read_b64_tr_b16 v[42:43], v5 offset:10240
  ds_read_b128 v[44:47], v6 offset:1152
  ds_read_b64_tr_b16 v[48:49], v5 offset:12288
  ds_read_b64_tr_b16 v[50:51], v5 offset:14336
  ds_read_b128 v[52:55], v6 offset:1216
  s_waitcnt lgkmcnt(9)
  v_mfma_f32_16x16x32_bf16 v[20:23], v[24:27], v[28:31], v[20:23]
  s_waitcnt lgkmcnt(6)
  v_mfma_f32_16x16x32_bf16 v[20:23], v[32:35], v[36:39], v[20:23]
  s_waitcnt lgkmcnt(3)
  v_mfma_f32_16x16x32_bf16 v[20:23], v[40:43], v[44:47], v[20:23]
  s_waitcnt lgkmcnt(0)
  v_mfma_f32_16x16x32_bf16 v[20:23], v[48:51], v[52:55], v[20:23]
  s_waitcnt vmcnt(8) lgkmcnt(0)
  s_barrier
  ds_read_b64_tr_b16 v[24:25], v5 offset:16384
  ds_read_b64_tr_b16 v[26:27], v5 offset:18432
  ds_read_b128 v[28:31], v6 offset:1280
  ds_read_b64_tr_b16 v[32:33], v5 offset:20480
  ds_read_b64_tr_b16 v[34:35], v5 offset:22528
  ds_read_b128 v[36:39], v6 offset:1344
  ds_read_b64_tr_b16 v[40:41], v5 offset:24576
  ds_read_b64_tr_b16 v[42:43], v5 offset:26624
  ds_read_b128 v[44:47], v6 offset:1408
  ds_read_b64_tr_b16 v[48:49], v5 offset:28672
  ds_read_b64_tr_b16 v[50:51], v5 offset:30720
  ds_read_b128 v[52:55], v6 offset:1472
  s_waitcnt lgkmcnt(9)
  v_mfma_f32_16x16x32_bf16 v[20:23], v[24:27], v[28:31], v[20:23]
  s_waitcnt lgkmcnt(6)
  v_mfma_f32_16x16x32_bf16 v[20:23], v[32:35], v[36:39], v[20:23]
  s_waitcnt lgkmcnt(3)
  v_mfma_f32_16x16x32_bf16 v[20:23], v[40:43], v[44:47], v[20:23]
  s_waitcnt lgkmcnt(0)
  v_mfma_f32_16x16x32_bf16 v[20:23], v[48:51], v[52:55], v[20:23]
  s_waitcnt vmcnt(4) lgkmcnt(0)
  s_barrier
  ds_read_b64_tr_b16 v[24:25], v5 offset:32768
  ds_read_b64_tr_b16 v[26:27], v5 offset:34816
  ds_read_b128 v[28:31], v6 offset:1536
  ds_read_b64_tr_b16 v[32:33], v5 offset:36864
  ds_read_b64_tr_b16 v[34:35], v5 offset:38912
  ds_read_b128 v[36:39], v6 offset:1600
  ds_read_b64_tr_b16 v[40:41], v5 offset:40960
  ds_read_b64_tr_b16 v[42:43], v5 offset:43008
  ds_read_b128 v[44:47], v6 offset:1664
  ds_read_b64_tr_b16 v[48:49], v5 offset:45056
  ds_read_b64_tr_b16 v[50:51], v5 offset:47104
  ds_read_b128 v[52:55], v6 offset:1728
  s_waitcnt lgkmcnt(9)
  v_mfma_f32_16x16x32_bf16 v[20:23], v[24:27], v[28:31], v[20:23]
  s_waitcnt lgkmcnt(6)
  v_mfma_f32_16x16x32_bf16 v[20:23], v[32:35], v[36:39], v[20:23]
  s_waitcnt lgkmcnt(3)
  v_mfma_f32_16x16x32_bf16 v[20:23], v[40:43], v[44:47], v[20:23]
  s_waitcnt lgkmcnt(0)
  v_mfma_f32_16x16x32_bf16 v[20:23], v[48:51], v[52:55], v[20:23]
  s_waitcnt vmcnt(0) lgkmcnt(0)
  s_barrier
  ds_read_b64_tr_b16 v[24:25], v5 offset:49152
  ds_read_b64_tr_b16 v[26:27], v5 offset:51200
  ds_read_b128 v[28:31], v6 offset:1792
  ds_read_b64_tr_b16 v[32:33], v5 offset:53248
  ds_read_b64_tr_b16 v[34:35], v5 offset:55296
  ds_read_b128 v[36:39], v6 offset:1856
  ds_read_b64_tr_b16 v[40:41], v5 offset:57344
  ds_read_b64_tr_b16 v[42:43], v5 offset:59392
  ds_read_b128 v[44:47], v6 offset:1920
  ds_read_b64_tr_b16 v[48:49], v5 offset:61440
  ds_read_b64_tr_b16 v[50:51], v5 offset:63488
  ds_read_b128 v[52:55], v6 offset:1984
  s_waitcnt lgkmcnt(9)
  v_mfma_f32_16x16x32_bf16 v[20:23], v[24:27], v[28:31], v[20:23]
  s_waitcnt lgkmcnt(6)
  v_mfma_f32_16x16x32_bf16 v[20:23], v[32:35], v[36:39], v[20:23]
  s_waitcnt lgkmcnt(3)
  v_mfma_f32_16x16x32_bf16 v[20:23], v[40:43], v[44:47], v[20:23]
  s_waitcnt lgkmcnt(0)
  v_mfma_f32_16x16x32_bf16 v[20:23], v[48:51], v[52:55], v[20:23]
  s_lshl_b32 s40, s21, 8
  s_lshl_b32 s41, s20, 6
  s_add_u32 s40, s40, s41
  s_add_u32 s40, s40, 1572864
  v_and_b32 v2, 15, v0
  v_cmp_eq_u32 vcc, 0, v2
  v_mov_b32 v3, 2147483392
  s_nop 0
  v_cndmask_b32 v1, v3, v0, vcc
  v_cvt_pk_bf16_f32 v8, v20, v21
  v_cvt_pk_bf16_f32 v9, v22, v23
  v_lshlrev_b32 v20, 16, v8
  v_and_b32 v21, 0xffff0000, v8
  v_lshlrev_b32 v22, 16, v9
  v_and_b32 v23, 0xffff0000, v9
  buffer_store_dwordx4 v[20:23], v1, s[4:7], s40 offen sc1
  v_min_u32 v2, 31, v0
  v_lshlrev_b32 v2, 2, v2
  v_add_u32 v2, 128, v2
  s_nop 1
Lpoll_1:
  buffer_load_dword v3, v2, s[12:15], 0 offen sc1
  s_sub_u32 s24, s24, 1
  s_cbranch_scc1 L_FAIL
  s_waitcnt vmcnt(0)
  v_cmp_gt_i32 vcc, 1, v3
  s_cbranch_vccz Lpolld_2
  s_sleep 2
  s_branch Lpoll_1
Lpolld_2:
  s_lshl_b32 s40, s21, 7
  s_add_u32 s40, s40, 1376256
  v_mov_b32 v2, 2147483392
  s_mov_b64 exec, 1
  v_mov_b32 v2, s40
  s_mov_b64 exec, -1
  v_mov_b32 v3, 1
  s_barrier
  s_cmp_lg_u32 s20, 0
  s_cbranch_scc1 L_LN1
  buffer_store_dword v3, v2, s[4:7], 0 offen sc1
L_LN1:
  s_load_dwordx2 s[16:17], s[0:1], 0
  s_mov_b32 s18, 4194304
  s_mov_b32 s19, 0x20000
  s_waitcnt lgkmcnt(0)
  s_sub_u32 s43, s22, 4
  s_lshl_b32 s43, s43, 5
  s_add_u32 s43, s43, s23
  s_lshl_b32 s43, s43, 2
  s_add_u32 s43, s43, s20
  s_lshl_b32 s44, s43, 13
  s_add_u32 s45, s44, 4096
  v_lshlrev_b32 v1, 3, v0
  v_lshlrev_b32 v2, 4, v0
  buffer_load_dwordx2 v[8:9], v1, s[16:19], s44 offen offset:0
  buffer_load_dwordx2 v[10:11], v1, s[16:19], s44 offen offset:512
  buffer_load_dwordx2 v[12:13], v1, s[16:19], s44 offen offset:1024
  buffer_load_dwordx2 v[14:15], v1, s[16:19], s44 offen offset:1536
  buffer_load_dwordx2 v[16:17], v1, s[16:19], s44 offen offset:2048
  buffer_load_dwordx2 v[18:19], v1, s[16:19], s44 offen offset:2560
  buffer_load_dwordx2 v[20:21], v1, s[16:19], s44 offen offset:3072
  buffer_load_dwordx2 v[22:23], v1, s[16:19], s44 offen offset:3584
  buffer_load_dwordx2 v[24:25], v1, s[16:19], s45 offen offset:0
  buffer_load_dwordx2 v[26:27], v1, s[16:19], s45 offen offset:512
  buffer_load_dwordx2 v[28:29], v1, s[16:19], s45 offen offset:1024
  buffer_load_dwordx2 v[30:31], v1, s[16:19], s45 offen offset:1536
  buffer_load_dwordx2 v[32:33], v1, s[16:19], s45 offen offset:2048
  buffer_load_dwordx2 v[34:35], v1, s[16:19], s45 offen offset:2560
  buffer_load_dwordx2 v[36:37], v1, s[16:19], s45 offen offset:3072
  buffer_load_dwordx2 v[38:39], v1, s[16:19], s45 offen offset:3584
  s_waitcnt vmcnt(0)
  v_lshlrev_b32 v40, 16, v8
  v_and_b32 v41, 0xffff0000, v8
  v_lshlrev_b32 v42, 16, v9
  v_and_b32 v43, 0xffff0000, v9
  v_lshlrev_b32 v44, 16, v10
  v_and_b32 v45, 0xffff0000, v10
  v_lshlrev_b32 v46, 16, v11
  v_and_b32 v47, 0xffff0000, v11
  v_lshlrev_b32 v48, 16, v12
  v_and_b32 v49, 0xffff0000, v12
  v_lshlrev_b32 v50, 16, v13
  v_and_b32 v51, 0xffff0000, v13
  v_lshlrev_b32 v52, 16, v14
  v_and_b32 v53, 0xffff0000, v14
  v_lshlrev_b32 v54, 16, v15
  v_and_b32 v55, 0xffff0000, v15
  v_lshlrev_b32 v56, 16, v16
  v_and_b32 v57, 0xffff0000, v16
  v_lshlrev_b32 v58, 16, v17
  v_and_b32 v59, 0xffff0000, v17
  v_lshlrev_b32 v60, 16, v18
  v_and_b32 v61, 0xffff0000, v18
  v_lshlrev_b32 v62, 16, v19
  v_and_b32 v63, 0xffff0000, v19
  v_lshlrev_b32 v64, 16, v20
  v_and_b32 v65, 0xffff0000, v20
  v_lshlrev_b32 v66, 16, v21
  v_and_b32 v67, 0xffff0000, v21
  v_lshlrev_b32 v68, 16, v22
  v_and_b32 v69, 0xffff0000, v22
  v_lshlrev_b32 v70, 16, v23
  v_and_b32 v71, 0xffff0000, v23
  v_lshlrev_b32 v72, 16, v24
  v_and_b32 v73, 0xffff0000, v24
  v_lshlrev_b32 v74, 16, v25
  v_and_b32 v75, 0xffff0000, v25
  v_lshlrev_b32 v76, 16, v26
  v_and_b32 v77, 0xffff0000, v26
  v_lshlrev_b32 v78, 16, v27
  v_and_b32 v79, 0xffff0000, v27
  v_lshlrev_b32 v80, 16, v28
  v_and_b32 v81, 0xffff0000, v28
  v_lshlrev_b32 v82, 16, v29
  v_and_b32 v83, 0xffff0000, v29
  v_lshlrev_b32 v84, 16, v30
  v_and_b32 v85, 0xffff0000, v30
  v_lshlrev_b32 v86, 16, v31
  v_and_b32 v87, 0xffff0000, v31
  v_lshlrev_b32 v88, 16, v32
  v_and_b32 v89, 0xffff0000, v32
  v_lshlrev_b32 v90, 16, v33
  v_and_b32 v91, 0xffff0000, v33
  v_lshlrev_b32 v92, 16, v34
  v_and_b32 v93, 0xffff0000, v34
  v_lshlrev_b32 v94, 16, v35
  v_and_b32 v95, 0xffff0000, v35
  v_lshlrev_b32 v96, 16, v36
  v_and_b32 v97, 0xffff0000, v36
  v_lshlrev_b32 v98, 16, v37
  v_and_b32 v99, 0xffff0000, v37
  v_lshlrev_b32 v100, 16, v38
  v_and_b32 v101, 0xffff0000, v38
  v_lshlrev_b32 v102, 16, v39
  v_and_b32 v103, 0xffff0000, v39
  v_pk_add_f32 v[104:105], v[40:41], v[42:43]
  v_pk_add_f32 v[108:109], v[56:57], v[58:59]
  v_pk_add_f32 v[112:113], v[72:73], v[74:75]
  v_pk_add_f32 v[116:117], v[88:89], v[90:91]
  v_pk_add_f32 v[104:105], v[104:105], v[44:45]
  v_pk_add_f32 v[108:109], v[108:109], v[60:61]
  v_pk_add_f32 v[112:113], v[112:113], v[76:77]
  v_pk_add_f32 v[116:117], v[116:117], v[92:93]
  v_pk_add_f32 v[104:105], v[104:105], v[46:47]
  v_pk_add_f32 v[108:109], v[108:109], v[62:63]
  v_pk_add_f32 v[112:113], v[112:113], v[78:79]
  v_pk_add_f32 v[116:117], v[116:117], v[94:95]
  v_pk_add_f32 v[104:105], v[104:105], v[48:49]
  v_pk_add_f32 v[108:109], v[108:109], v[64:65]
  v_pk_add_f32 v[112:113], v[112:113], v[80:81]
  v_pk_add_f32 v[116:117], v[116:117], v[96:97]
  v_pk_add_f32 v[104:105], v[104:105], v[50:51]
  v_pk_add_f32 v[108:109], v[108:109], v[66:67]
  v_pk_add_f32 v[112:113], v[112:113], v[82:83]
  v_pk_add_f32 v[116:117], v[116:117], v[98:99]
  v_pk_add_f32 v[104:105], v[104:105], v[52:53]
  v_pk_add_f32 v[108:109], v[108:109], v[68:69]
  v_pk_add_f32 v[112:113], v[112:113], v[84:85]
  v_pk_add_f32 v[116:117], v[116:117], v[100:101]
  v_pk_add_f32 v[104:105], v[104:105], v[54:55]
  v_pk_add_f32 v[108:109], v[108:109], v[70:71]
  v_pk_add_f32 v[112:113], v[112:113], v[86:87]
  v_pk_add_f32 v[116:117], v[116:117], v[102:103]
  v_add_f32 v104, v104, v105
  v_add_f32 v108, v108, v109
  v_add_f32 v112, v112, v113
  v_add_f32 v116, v116, v117
  v_add_f32_dpp v104, v104, v104 row_ror:8 row_mask:0xf bank_mask:0xf
  v_add_f32_dpp v108, v108, v108 row_ror:8 row_mask:0xf bank_mask:0xf
  v_add_f32_dpp v112, v112, v112 row_ror:8 row_mask:0xf bank_mask:0xf
  v_add_f32_dpp v116, v116, v116 row_ror:8 row_mask:0xf bank_mask:0xf
  v_add_f32_dpp v104, v104, v104 row_ror:4 row_mask:0xf bank_mask:0xf
  v_add_f32_dpp v108, v108, v108 row_ror:4 row_mask:0xf bank_mask:0xf
  v_add_f32_dpp v112, v112, v112 row_ror:4 row_mask:0xf bank_mask:0xf
  v_add_f32_dpp v116, v116, v116 row_ror:4 row_mask:0xf bank_mask:0xf
  v_add_f32_dpp v104, v104, v104 row_ror:2 row_mask:0xf bank_mask:0xf
  v_add_f32_dpp v108, v108, v108 row_ror:2 row_mask:0xf bank_mask:0xf
  v_add_f32_dpp v112, v112, v112 row_ror:2 row_mask:0xf bank_mask:0xf
  v_add_f32_dpp v116, v116, v116 row_ror:2 row_mask:0xf bank_mask:0xf
  v_add_f32_dpp v104, v104, v104 row_ror:1 row_mask:0xf bank_mask:0xf
  v_add_f32_dpp v108, v108, v108 row_ror:1 row_mask:0xf bank_mask:0xf
  v_add_f32_dpp v112, v112, v112 row_ror:1 row_mask:0xf bank_mask:0xf
  v_add_f32_dpp v116, v116, v116 row_ror:1 row_mask:0xf bank_mask:0xf
  v_mov_b32 v105, v104
  v_mov_b32 v109, v108
  v_mov_b32 v113, v112
  v_mov_b32 v117, v116
  v_permlane16_swap_b32 v105, v104
  v_permlane16_swap_b32 v109, v108
  v_permlane16_swap_b32 v113, v112
  v_permlane16_swap_b32 v117, v116
  v_add_f32 v104, v104, v105
  v_add_f32 v108, v108, v109
  v_add_f32 v112, v112, v113
  v_add_f32 v116, v116, v117
  v_mov_b32 v105, v104
  v_mov_b32 v109, v108
  v_mov_b32 v113, v112
  v_mov_b32 v117, v116
  v_permlane32_swap_b32 v105, v104
  v_permlane32_swap_b32 v109, v108
  v_permlane32_swap_b32 v113, v112
  v_permlane32_swap_b32 v117, v116
  v_add_f32 v104, v104, v105
  v_add_f32 v108, v108, v109
  v_add_f32 v112, v112, v113
  v_add_f32 v116, v116, v117
  v_mul_f32 v104, 0xba800000, v104
  v_mul_f32 v108, 0xba800000, v108
  v_mul_f32 v112, 0xba800000, v112
  v_mul_f32 v116, 0xba800000, v116
  v_pk_add_f32 v[40:41], v[40:41], v[104:105] op_sel_hi:[1,0]
  v_pk_add_f32 v[56:57], v[56:57], v[108:109] op_sel_hi:[1,0]
  v_pk_add_f32 v[72:73], v[72:73], v[112:113] op_sel_hi:[1,0]
  v_pk_add_f32 v[88:89], v[88:89], v[116:117] op_sel_hi:[1,0]
  v_pk_add_f32 v[42:43], v[42:43], v[104:105] op_sel_hi:[1,0]
  v_pk_add_f32 v[58:59], v[58:59], v[108:109] op_sel_hi:[1,0]
  v_pk_add_f32 v[74:75], v[74:75], v[112:113] op_sel_hi:[1,0]
  v_pk_add_f32 v[90:91], v[90:91], v[116:117] op_sel_hi:[1,0]
  v_pk_add_f32 v[44:45], v[44:45], v[104:105] op_sel_hi:[1,0]
  v_pk_add_f32 v[60:61], v[60:61], v[108:109] op_sel_hi:[1,0]
  v_pk_add_f32 v[76:77], v[76:77], v[112:113] op_sel_hi:[1,0]
  v_pk_add_f32 v[92:93], v[92:93], v[116:117] op_sel_hi:[1,0]
  v_pk_add_f32 v[46:47], v[46:47], v[104:105] op_sel_hi:[1,0]
  v_pk_add_f32 v[62:63], v[62:63], v[108:109] op_sel_hi:[1,0]
  v_pk_add_f32 v[78:79], v[78:79], v[112:113] op_sel_hi:[1,0]
  v_pk_add_f32 v[94:95], v[94:95], v[116:117] op_sel_hi:[1,0]
  v_pk_add_f32 v[48:49], v[48:49], v[104:105] op_sel_hi:[1,0]
  v_pk_add_f32 v[64:65], v[64:65], v[108:109] op_sel_hi:[1,0]
  v_pk_add_f32 v[80:81], v[80:81], v[112:113] op_sel_hi:[1,0]
  v_pk_add_f32 v[96:97], v[96:97], v[116:117] op_sel_hi:[1,0]
  v_pk_add_f32 v[50:51], v[50:51], v[104:105] op_sel_hi:[1,0]
  v_pk_add_f32 v[66:67], v[66:67], v[108:109] op_sel_hi:[1,0]
  v_pk_add_f32 v[82:83], v[82:83], v[112:113] op_sel_hi:[1,0]
  v_pk_add_f32 v[98:99], v[98:99], v[116:117] op_sel_hi:[1,0]
  v_pk_add_f32 v[52:53], v[52:53], v[104:105] op_sel_hi:[1,0]
  v_pk_add_f32 v[68:69], v[68:69], v[108:109] op_sel_hi:[1,0]
  v_pk_add_f32 v[84:85], v[84:85], v[112:113] op_sel_hi:[1,0]
  v_pk_add_f32 v[100:101], v[100:101], v[116:117] op_sel_hi:[1,0]
  v_pk_add_f32 v[54:55], v[54:55], v[104:105] op_sel_hi:[1,0]
  v_pk_add_f32 v[70:71], v[70:71], v[108:109] op_sel_hi:[1,0]
  v_pk_add_f32 v[86:87], v[86:87], v[112:113] op_sel_hi:[1,0]
  v_pk_add_f32 v[102:103], v[102:103], v[116:117] op_sel_hi:[1,0]
  v_pk_mul_f32 v[104:105], v[40:41], v[40:41]
  v_pk_mul_f32 v[108:109], v[56:57], v[56:57]
  v_pk_mul_f32 v[112:113], v[72:73], v[72:73]
  v_pk_mul_f32 v[116:117], v[88:89], v[88:89]
  v_pk_fma_f32 v[104:105], v[42:43], v[42:43], v[104:105]
  v_pk_fma_f32 v[108:109], v[58:59], v[58:59], v[108:109]
  v_pk_fma_f32 v[112:113], v[74:75], v[74:75], v[112:113]
  v_pk_fma_f32 v[116:117], v[90:91], v[90:91], v[116:117]
  v_pk_fma_f32 v[104:105], v[44:45], v[44:45], v[104:105]
  v_pk_fma_f32 v[108:109], v[60:61], v[60:61], v[108:109]
  v_pk_fma_f32 v[112:113], v[76:77], v[76:77], v[112:113]
  v_pk_fma_f32 v[116:117], v[92:93], v[92:93], v[116:117]
  v_pk_fma_f32 v[104:105], v[46:47], v[46:47], v[104:105]
  v_pk_fma_f32 v[108:109], v[62:63], v[62:63], v[108:109]
  v_pk_fma_f32 v[112:113], v[78:79], v[78:79], v[112:113]
  v_pk_fma_f32 v[116:117], v[94:95], v[94:95], v[116:117]
  v_pk_fma_f32 v[104:105], v[48:49], v[48:49], v[104:105]
  v_pk_fma_f32 v[108:109], v[64:65], v[64:65], v[108:109]
  v_pk_fma_f32 v[112:113], v[80:81], v[80:81], v[112:113]
  v_pk_fma_f32 v[116:117], v[96:97], v[96:97], v[116:117]
  v_pk_fma_f32 v[104:105], v[50:51], v[50:51], v[104:105]
  v_pk_fma_f32 v[108:109], v[66:67], v[66:67], v[108:109]
  v_pk_fma_f32 v[112:113], v[82:83], v[82:83], v[112:113]
  v_pk_fma_f32 v[116:117], v[98:99], v[98:99], v[116:117]
  v_pk_fma_f32 v[104:105], v[52:53], v[52:53], v[104:105]
  v_pk_fma_f32 v[108:109], v[68:69], v[68:69], v[108:109]
  v_pk_fma_f32 v[112:113], v[84:85], v[84:85], v[112:113]
  v_pk_fma_f32 v[116:117], v[100:101], v[100:101], v[116:117]
  v_pk_fma_f32 v[104:105], v[54:55], v[54:55], v[104:105]
  v_pk_fma_f32 v[108:109], v[70:71], v[70:71], v[108:109]
  v_pk_fma_f32 v[112:113], v[86:87], v[86:87], v[112:113]
  v_pk_fma_f32 v[116:117], v[102:103], v[102:103], v[116:117]
  v_add_f32 v104, v104, v105
  v_add_f32 v108, v108, v109
  v_add_f32 v112, v112, v113
  v_add_f32 v116, v116, v117
  v_add_f32_dpp v104, v104, v104 row_ror:8 row_mask:0xf bank_mask:0xf
  v_add_f32_dpp v108, v108, v108 row_ror:8 row_mask:0xf bank_mask:0xf
  v_add_f32_dpp v112, v112, v112 row_ror:8 row_mask:0xf bank_mask:0xf
  v_add_f32_dpp v116, v116, v116 row_ror:8 row_mask:0xf bank_mask:0xf
  v_add_f32_dpp v104, v104, v104 row_ror:4 row_mask:0xf bank_mask:0xf
  v_add_f32_dpp v108, v108, v108 row_ror:4 row_mask:0xf bank_mask:0xf
  v_add_f32_dpp v112, v112, v112 row_ror:4 row_mask:0xf bank_mask:0xf
  v_add_f32_dpp v116, v116, v116 row_ror:4 row_mask:0xf bank_mask:0xf
  v_add_f32_dpp v104, v104, v104 row_ror:2 row_mask:0xf bank_mask:0xf
  v_add_f32_dpp v108, v108, v108 row_ror:2 row_mask:0xf bank_mask:0xf
  v_add_f32_dpp v112, v112, v112 row_ror:2 row_mask:0xf bank_mask:0xf
  v_add_f32_dpp v116, v116, v116 row_ror:2 row_mask:0xf bank_mask:0xf
  v_add_f32_dpp v104, v104, v104 row_ror:1 row_mask:0xf bank_mask:0xf
  v_add_f32_dpp v108, v108, v108 row_ror:1 row_mask:0xf bank_mask:0xf
  v_add_f32_dpp v112, v112, v112 row_ror:1 row_mask:0xf bank_mask:0xf
  v_add_f32_dpp v116, v116, v116 row_ror:1 row_mask:0xf bank_mask:0xf
  v_mov_b32 v105, v104
  v_mov_b32 v109, v108
  v_mov_b32 v113, v112
  v_mov_b32 v117, v116
  v_permlane16_swap_b32 v105, v104
  v_permlane16_swap_b32 v109, v108
  v_permlane16_swap_b32 v113, v112
  v_permlane16_swap_b32 v117, v116
  v_add_f32 v104, v104, v105
  v_add_f32 v108, v108, v109
  v_add_f32 v112, v112, v113
  v_add_f32 v116, v116, v117
  v_mov_b32 v105, v104
  v_mov_b32 v109, v108
  v_mov_b32 v113, v112
  v_mov_b32 v117, v116
  v_permlane32_swap_b32 v105, v104
  v_permlane32_swap_b32 v109, v108
  v_permlane32_swap_b32 v113, v112
  v_permlane32_swap_b32 v117, v116
  v_add_f32 v104, v104, v105
  v_add_f32 v108, v108, v109
  v_add_f32 v112, v112, v113
  v_add_f32 v116, v116, v117
  v_mul_f32 v104, 0x3a800000, v104
  v_mul_f32 v108, 0x3a800000, v108
  v_mul_f32 v112, 0x3a800000, v112
  v_mul_f32 v116, 0x3a800000, v116
  v_add_f32 v104, 0x3727c5ac, v104
  v_add_f32 v108, 0x3727c5ac, v108
  v_add_f32 v112, 0x3727c5ac, v112
  v_add_f32 v116, 0x3727c5ac, v116
  v_rsq_f32 v104, v104
  v_rsq_f32 v108, v108
  v_rsq_f32 v112, v112
  v_rsq_f32 v116, v116
  v_pk_mul_f32 v[40:41], v[40:41], v[104:105] op_sel_hi:[1,0]
  v_pk_mul_f32 v[56:57], v[56:57], v[108:109] op_sel_hi:[1,0]
  v_pk_mul_f32 v[72:73], v[72:73], v[112:113] op_sel_hi:[1,0]
  v_pk_mul_f32 v[88:89], v[88:89], v[116:117] op_sel_hi:[1,0]
  v_pk_mul_f32 v[42:43], v[42:43], v[104:105] op_sel_hi:[1,0]
  v_pk_mul_f32 v[58:59], v[58:59], v[108:109] op_sel_hi:[1,0]
  v_pk_mul_f32 v[74:75], v[74:75], v[112:113] op_sel_hi:[1,0]
  v_pk_mul_f32 v[90:91], v[90:91], v[116:117] op_sel_hi:[1,0]
  v_pk_mul_f32 v[44:45], v[44:45], v[104:105] op_sel_hi:[1,0]
  v_pk_mul_f32 v[60:61], v[60:61], v[108:109] op_sel_hi:[1,0]
  v_pk_mul_f32 v[76:77], v[76:77], v[112:113] op_sel_hi:[1,0]
  v_pk_mul_f32 v[92:93], v[92:93], v[116:117] op_sel_hi:[1,0]
  v_pk_mul_f32 v[46:47], v[46:47], v[104:105] op_sel_hi:[1,0]
  v_pk_mul_f32 v[62:63], v[62:63], v[108:109] op_sel_hi:[1,0]
  v_pk_mul_f32 v[78:79], v[78:79], v[112:113] op_sel_hi:[1,0]
  v_pk_mul_f32 v[94:95], v[94:95], v[116:117] op_sel_hi:[1,0]
  v_pk_mul_f32 v[48:49], v[48:49], v[104:105] op_sel_hi:[1,0]
  v_pk_mul_f32 v[64:65], v[64:65], v[108:109] op_sel_hi:[1,0]
  v_pk_mul_f32 v[80:81], v[80:81], v[112:113] op_sel_hi:[1,0]
  v_pk_mul_f32 v[96:97], v[96:97], v[116:117] op_sel_hi:[1,0]
  v_pk_mul_f32 v[50:51], v[50:51], v[104:105] op_sel_hi:[1,0]
  v_pk_mul_f32 v[66:67], v[66:67], v[108:109] op_sel_hi:[1,0]
  v_pk_mul_f32 v[82:83], v[82:83], v[112:113] op_sel_hi:[1,0]
  v_pk_mul_f32 v[98:99], v[98:99], v[116:117] op_sel_hi:[1,0]
  v_pk_mul_f32 v[52:53], v[52:53], v[104:105] op_sel_hi:[1,0]
  v_pk_mul_f32 v[68:69], v[68:69], v[108:109] op_sel_hi:[1,0]
  v_pk_mul_f32 v[84:85], v[84:85], v[112:113] op_sel_hi:[1,0]
  v_pk_mul_f32 v[100:101], v[100:101], v[116:117] op_sel_hi:[1,0]
  v_pk_mul_f32 v[54:55], v[54:55], v[104:105] op_sel_hi:[1,0]
  v_pk_mul_f32 v[70:71], v[70:71], v[108:109] op_sel_hi:[1,0]
  v_pk_mul_f32 v[86:87], v[86:87], v[112:113] op_sel_hi:[1,0]
  v_pk_mul_f32 v[102:103], v[102:103], v[116:117] op_sel_hi:[1,0]
  v_min_u32 v3, 31, v0
  v_lshlrev_b32 v3, 2, v3
  v_add_u32 v3, 128, v3
  s_nop 1
Lpoll_3:
  buffer_load_dword v4, v3, s[12:15], 0 offen sc1
  s_sub_u32 s24, s24, 1
  s_cbranch_scc1 L_FAIL
  s_waitcnt vmcnt(0)
  v_cmp_gt_i32 vcc, 1, v4
  s_cbranch_vccz Lpolld_4
  s_sleep 2
  s_branch Lpoll_3
Lpolld_4:
  v_min_u32 v3, 31, v0
  v_lshlrev_b32 v3, 7, v3
  v_add_u32 v3, 1376256, v3
  s_nop 1
Lpoll_5:
  buffer_load_dword v4, v3, s[4:7], 0 offen sc1
  s_sub_u32 s24, s24, 1
  s_cbranch_scc1 L_FAIL
  s_waitcnt vmcnt(0)
  v_cmp_gt_i32 vcc, 1, v4
  s_cbranch_vccz Lpolld_6
  s_sleep 2
  s_branch Lpoll_5
Lpolld_6:
  s_mov_b32 s40, 1572864
  buffer_load_dwordx4 v[136:139], v2, s[4:7], s40 offen offset:0 sc1
  buffer_load_dwordx4 v[140:143], v2, s[4:7], s40 offen offset:1024 sc1
  buffer_load_dwordx4 v[144:147], v2, s[4:7], s40 offen offset:2048 sc1
  buffer_load_dwordx4 v[148:151], v2, s[4:7], s40 offen offset:3072 sc1
  s_mov_b32 s40, 1576960
  buffer_load_dwordx4 v[120:123], v2, s[4:7], s40 offen offset:0 sc1
  buffer_load_dwordx4 v[124:127], v2, s[4:7], s40 offen offset:1024 sc1
  buffer_load_dwordx4 v[128:131], v2, s[4:7], s40 offen offset:2048 sc1
  buffer_load_dwordx4 v[132:135], v2, s[4:7], s40 offen offset:3072 sc1
  s_waitcnt vmcnt(0)
  v_add_f32 v120, 1.0, v120
  v_add_f32 v121, 1.0, v121
  v_add_f32 v122, 1.0, v122
  v_add_f32 v123, 1.0, v123
  v_add_f32 v124, 1.0, v124
  v_add_f32 v125, 1.0, v125
  v_add_f32 v126, 1.0, v126
  v_add_f32 v127, 1.0, v127
  v_add_f32 v128, 1.0, v128
  v_add_f32 v129, 1.0, v129
  v_add_f32 v130, 1.0, v130
  v_add_f32 v131, 1.0, v131
  v_add_f32 v132, 1.0, v132
  v_add_f32 v133, 1.0, v133
  v_add_f32 v134, 1.0, v134
  v_add_f32 v135, 1.0, v135
  s_add_u32 s44, s44, 2097152
  s_add_u32 s45, s45, 2097152
  v_pk_fma_f32 v[40:41], v[40:41], v[120:121], v[136:137]
  v_pk_fma_f32 v[42:43], v[42:43], v[122:123], v[138:139]
  v_pk_fma_f32 v[44:45], v[44:45], v[124:125], v[140:141]
  v_pk_fma_f32 v[46:47], v[46:47], v[126:127], v[142:143]
  v_pk_fma_f32 v[48:49], v[48:49], v[128:129], v[144:145]
  v_pk_fma_f32 v[50:51], v[50:51], v[130:131], v[146:147]
  v_pk_fma_f32 v[52:53], v[52:53], v[132:133], v[148:149]
  v_pk_fma_f32 v[54:55], v[54:55], v[134:135], v[150:151]
  v_cvt_pk_bf16_f32 v8, v40, v41
  v_cvt_pk_bf16_f32 v9, v42, v43
  v_cvt_pk_bf16_f32 v10, v44, v45
  v_cvt_pk_bf16_f32 v11, v46, v47
  v_cvt_pk_bf16_f32 v12, v48, v49
  v_cvt_pk_bf16_f32 v13, v50, v51
  v_cvt_pk_bf16_f32 v14, v52, v53
  v_cvt_pk_bf16_f32 v15, v54, v55
  buffer_store_dwordx4 v[8:11], v2, s[4:7], s44 offen offset:0 sc1
  buffer_store_dwordx4 v[12:15], v2, s[4:7], s44 offen offset:1024 sc1
  v_pk_fma_f32 v[56:57], v[56:57], v[120:121], v[136:137]
  v_pk_fma_f32 v[58:59], v[58:59], v[122:123], v[138:139]
  v_pk_fma_f32 v[60:61], v[60:61], v[124:125], v[140:141]
  v_pk_fma_f32 v[62:63], v[62:63], v[126:127], v[142:143]
  v_pk_fma_f32 v[64:65], v[64:65], v[128:129], v[144:145]
  v_pk_fma_f32 v[66:67], v[66:67], v[130:131], v[146:147]
  v_pk_fma_f32 v[68:69], v[68:69], v[132:133], v[148:149]
  v_pk_fma_f32 v[70:71], v[70:71], v[134:135], v[150:151]
  v_cvt_pk_bf16_f32 v16, v56, v57
  v_cvt_pk_bf16_f32 v17, v58, v59
  v_cvt_pk_bf16_f32 v18, v60, v61
  v_cvt_pk_bf16_f32 v19, v62, v63
  v_cvt_pk_bf16_f32 v20, v64, v65
  v_cvt_pk_bf16_f32 v21, v66, v67
  v_cvt_pk_bf16_f32 v22, v68, v69
  v_cvt_pk_bf16_f32 v23, v70, v71
  buffer_store_dwordx4 v[16:19], v2, s[4:7], s44 offen offset:2048 sc1
  buffer_store_dwordx4 v[20:23], v2, s[4:7], s44 offen offset:3072 sc1
  v_pk_fma_f32 v[72:73], v[72:73], v[120:121], v[136:137]
  v_pk_fma_f32 v[74:75], v[74:75], v[122:123], v[138:139]
  v_pk_fma_f32 v[76:77], v[76:77], v[124:125], v[140:141]
  v_pk_fma_f32 v[78:79], v[78:79], v[126:127], v[142:143]
  v_pk_fma_f32 v[80:81], v[80:81], v[128:129], v[144:145]
  v_pk_fma_f32 v[82:83], v[82:83], v[130:131], v[146:147]
  v_pk_fma_f32 v[84:85], v[84:85], v[132:133], v[148:149]
  v_pk_fma_f32 v[86:87], v[86:87], v[134:135], v[150:151]
  v_cvt_pk_bf16_f32 v24, v72, v73
  v_cvt_pk_bf16_f32 v25, v74, v75
  v_cvt_pk_bf16_f32 v26, v76, v77
  v_cvt_pk_bf16_f32 v27, v78, v79
  v_cvt_pk_bf16_f32 v28, v80, v81
  v_cvt_pk_bf16_f32 v29, v82, v83
  v_cvt_pk_bf16_f32 v30, v84, v85
  v_cvt_pk_bf16_f32 v31, v86, v87
  buffer_store_dwordx4 v[24:27], v2, s[4:7], s45 offen offset:0 sc1
  buffer_store_dwordx4 v[28:31], v2, s[4:7], s45 offen offset:1024 sc1
  v_pk_fma_f32 v[88:89], v[88:89], v[120:121], v[136:137]
  v_pk_fma_f32 v[90:91], v[90:91], v[122:123], v[138:139]
  v_pk_fma_f32 v[92:93], v[92:93], v[124:125], v[140:141]
  v_pk_fma_f32 v[94:95], v[94:95], v[126:127], v[142:143]
  v_pk_fma_f32 v[96:97], v[96:97], v[128:129], v[144:145]
  v_pk_fma_f32 v[98:99], v[98:99], v[130:131], v[146:147]
  v_pk_fma_f32 v[100:101], v[100:101], v[132:133], v[148:149]
  v_pk_fma_f32 v[102:103], v[102:103], v[134:135], v[150:151]
  v_cvt_pk_bf16_f32 v32, v88, v89
  v_cvt_pk_bf16_f32 v33, v90, v91
  v_cvt_pk_bf16_f32 v34, v92, v93
  v_cvt_pk_bf16_f32 v35, v94, v95
  v_cvt_pk_bf16_f32 v36, v96, v97
  v_cvt_pk_bf16_f32 v37, v98, v99
  v_cvt_pk_bf16_f32 v38, v100, v101
  v_cvt_pk_bf16_f32 v39, v102, v103
  buffer_store_dwordx4 v[32:35], v2, s[4:7], s45 offen offset:2048 sc1
  buffer_store_dwordx4 v[36:39], v2, s[4:7], s45 offen offset:3072 sc1
  s_lshr_b32 s40, s43, 3
  s_lshl_b32 s40, s40, 7
  s_and_b32 s41, s43, 7
  s_lshl_b32 s41, s41, 2
  s_add_u32 s40, s40, s41
  s_add_u32 s40, s40, 1388544
  v_mov_b32 v3, 2147483392
  s_mov_b64 exec, 1
  v_mov_b32 v3, s40
  s_mov_b64 exec, -1
  v_mov_b32 v4, 1
  s_waitcnt vmcnt(0)
  buffer_store_dword v4, v3, s[4:7], 0 offen sc1
  s_mov_b32 s43, 32
  s_cmp_eq_u32 s22, 7
  s_cselect_b32 s43, 24, s43
  s_sub_u32 s40, s22, 5
  s_cmp_lt_u32 s40, 2
  s_cselect_b32 s43, 28, s43
  s_cmp_lt_u32 s23, s43
  s_cbranch_scc1 L_HEAVY
  s_sub_u32 s21, s23, s43
  s_cmp_eq_u32 s22, 7
  s_cbranch_scc1 L_FIN
  s_lshl_b32 s40, s40, 2
  s_add_u32 s21, s21, s40
  s_branch L_LN2
L_HEAVY:
  v_mov_b32 v1, 1396736
  s_nop 1
Lpoll_7:
  buffer_load_dword v2, v1, s[4:7], 0 offen sc1
  s_sub_u32 s24, s24, 1
  s_cbranch_scc1 L_FAIL
  s_waitcnt vmcnt(0)
  v_cmp_gt_i32 vcc, 0, v2
  s_cbranch_vccz Lpolld_8
  s_sleep 8
  s_branch Lpoll_7
Lpolld_8:
  s_mov_b32 s21, s23
  s_cmp_eq_u32 s22, 4
  s_cbranch_scc1 L_WO
  s_cmp_eq_u32 s22, 7
  s_cbranch_scc1 L_F2
  s_sub_u32 s40, s22, 5
  s_mul_i32 s40, s40, 28
  s_add_u32 s21, s21, s40
  s_branch L_F1
L_FAIL:
  s_mov_b64 exec, -1
  s_lshl_b32 s40, s2, 8
  s_add_u32 s40, s40, s25
  s_add_u32 s40, s40, 0x70000000
  v_mov_b32 v1, 60
  v_mov_b32 v2, s40
  buffer_store_dword v2, v1, s[12:15], 0 offen
L_END:
  s_endpgm
L_LN2:
  s_lshr_b32 s25, s21, 2
  s_add_u32 s29, s25, 1
  s_lshl_b32 s26, s25, 16
  s_mul_i32 s27, s25, 262144
  s_add_u32 s27, s27, 109051904
  s_and_b32 s43, s21, 3
  s_lshr_b32 s40, s43, 1
  s_lshl_b32 s40, s40, 10
  s_and_b32 s41, s43, 1
  s_lshl_b32 s41, s41, 7
  s_add_u32 s40, s40, s41
  s_lshl_b32 s41, s20, 14
  s_add_u32 s40, s40, s41
  v_and_b32 v6, 7, v0
  v_lshl_add_u32 v1, v6, 4, s40
  v_bfe_u32 v7, v0, 3, 2
  v_lshl_add_u32 v1, v7, 8, v1
  v_lshrrev_b32 v7, 5, v0
  v_lshl_add_u32 v1, v7, 11, v1
  v_lshrrev_b32 v8, 3, v0
  s_lshl_b32 s40, s20, 10
  v_lshl_add_u32 v5, v8, 4, s40
  s_lshl_b32 s40, s43, 14
  s_lshl_b32 s41, s20, 9
  s_add_u32 s40, s40, s41
  v_and_b32 v9, 31, v0
  v_lshl_add_u32 v10, v9, 4, s40
  v_lshl_add_u32 v10, v7, 11, v10
  v_min_u32 v2, 63, v0
  v_lshlrev_b32 v2, 7, v2
  v_add_u32 v2, 1380352, v2
  s_nop 1
Lpoll_9:
  buffer_load_dword v3, v2, s[4:7], 0 offen sc1
  s_sub_u32 s24, s24, 1
  s_cbranch_scc1 L_FAIL
  s_waitcnt vmcnt(0)
  v_cmp_gt_i32 vcc, 1, v3
  s_cbranch_vccz Lpolld_10
  s_sleep 2
  s_branch Lpoll_9
Lpolld_10:
  s_mov_b32 s40, 1581056
  buffer_load_dwordx4 v[48:51], v5, s[4:7], s40 offen offset:0 sc1
  buffer_load_dwordx4 v[52:55], v5, s[4:7], s40 offen offset:256 sc1
  buffer_load_dwordx4 v[56:59], v5, s[4:7], s40 offen offset:128 sc1
  buffer_load_dwordx4 v[60:63], v5, s[4:7], s40 offen offset:384 sc1
  buffer_load_dwordx4 v[64:67], v5, s[4:7], s40 offen offset:512 sc1
  buffer_load_dwordx4 v[68:71], v5, s[4:7], s40 offen offset:768 sc1
  buffer_load_dwordx4 v[72:75], v5, s[4:7], s40 offen offset:640 sc1
  buffer_load_dwordx4 v[76:79], v5, s[4:7], s40 offen offset:896 sc1
  s_mov_b32 s40, 1585152
  buffer_load_dwordx4 v[80:83], v5, s[4:7], s40 offen offset:0 sc1
  buffer_load_dwordx4 v[84:87], v5, s[4:7], s40 offen offset:256 sc1
  buffer_load_dwordx4 v[88:91], v5, s[4:7], s40 offen offset:128 sc1
  buffer_load_dwordx4 v[92:95], v5, s[4:7], s40 offen offset:384 sc1
  buffer_load_dwordx4 v[96:99], v5, s[4:7], s40 offen offset:512 sc1
  buffer_load_dwordx4 v[100:103], v5, s[4:7], s40 offen offset:768 sc1
  buffer_load_dwordx4 v[104:107], v5, s[4:7], s40 offen offset:640 sc1
  buffer_load_dwordx4 v[108:111], v5, s[4:7], s40 offen offset:896 sc1
  s_mov_b32 s40, 1589248
  buffer_load_dwordx4 v[112:115], v5, s[4:7], s40 offen offset:0 sc1
  buffer_load_dwordx4 v[116:119], v5, s[4:7], s40 offen offset:256 sc1
  buffer_load_dwordx4 v[120:123], v5, s[4:7], s40 offen offset:128 sc1
  buffer_load_dwordx4 v[124:127], v5, s[4:7], s40 offen offset:384 sc1
  buffer_load_dwordx4 v[128:131], v5, s[4:7], s40 offen offset:512 sc1
  buffer_load_dwordx4 v[132:135], v5, s[4:7], s40 offen offset:768 sc1
  buffer_load_dwordx4 v[136:139], v5, s[4:7], s40 offen offset:640 sc1
  buffer_load_dwordx4 v[140:143], v5, s[4:7], s40 offen offset:896 sc1
  s_waitcnt vmcnt(0)
  v_add_f32 v112, 1.0, v112
  v_add_f32 v113, 1.0, v113
  v_add_f32 v114, 1.0, v114
  v_add_f32 v115, 1.0, v115
  v_add_f32 v116, 1.0, v116
  v_add_f32 v117, 1.0, v117
  v_add_f32 v118, 1.0, v118
  v_add_f32 v119, 1.0, v119
  v_add_f32 v120, 1.0, v120
  v_add_f32 v121, 1.0, v121
  v_add_f32 v122, 1.0, v122
  v_add_f32 v123, 1.0, v123
  v_add_f32 v124, 1.0, v124
  v_add_f32 v125, 1.0, v125
  v_add_f32 v126, 1.0, v126
  v_add_f32 v127, 1.0, v127
  v_add_f32 v128, 1.0, v128
  v_add_f32 v129, 1.0, v129
  v_add_f32 v130, 1.0, v130
  v_add_f32 v131, 1.0, v131
  v_add_f32 v132, 1.0, v132
  v_add_f32 v133, 1.0, v133
  v_add_f32 v134, 1.0, v134
  v_add_f32 v135, 1.0, v135
  v_add_f32 v136, 1.0, v136
  v_add_f32 v137, 1.0, v137
  v_add_f32 v138, 1.0, v138
  v_add_f32 v139, 1.0, v139
  v_add_f32 v140, 1.0, v140
  v_add_f32 v141, 1.0, v141
  v_add_f32 v142, 1.0, v142
  v_add_f32 v143, 1.0, v143
  v_min_u32 v2, 31, v0
  v_lshlrev_b32 v2, 7, v2
  v_add_u32 v2, 1409024, v2
  s_lshl_b32 s62, s21, 7
  s_add_u32 s62, s62, 1413120
  s_lshl_b32 s30, s20, 12
  v_lshl_add_u32 v11, v6, 9, s30
  v_lshl_add_u32 v11, v8, 3, v11
  s_lshl_b32 s40, s20, 6
  s_add_u32 s40, s40, 16384
  v_lshl_add_u32 v12, v6, 3, s40
  v_lshlrev_b32 v13, 3, v6
  v_add_u32 v13, 16384, v13
  s_nop 1
L_LN2_top:
  s_add_u32 m0, s30, 0
  s_add_u32 s40, s26, 0
  buffer_load_dwordx4 v10, s[16:19], s40 offen lds
  s_add_u32 m0, s30, 1024
  s_add_u32 s40, s26, 4096
  buffer_load_dwordx4 v10, s[16:19], s40 offen lds
  s_add_u32 m0, s30, 2048
  s_add_u32 s40, s26, 8192
  buffer_load_dwordx4 v10, s[16:19], s40 offen lds
  s_add_u32 m0, s30, 3072
  s_add_u32 s40, s26, 12288
  buffer_load_dwordx4 v10, s[16:19], s40 offen lds
  s_waitcnt vmcnt(0)
  ds_read_b64 v[16:17], v11 offset:0
  ds_read_b64 v[18:19], v11 offset:128
  ds_read_b64 v[20:21], v11 offset:64
  ds_read_b64 v[22:23], v11 offset:192
  ds_read_b64 v[24:25], v11 offset:256
  ds_read_b64 v[26:27], v11 offset:384
  ds_read_b64 v[28:29], v11 offset:320
  ds_read_b64 v[30:31], v11 offset:448
  s_waitcnt lgkmcnt(0)
  v_lshlrev_b32 v144, 16, v16
  v_and_b32 v145, 0xffff0000, v16
  v_lshlrev_b32 v146, 16, v17
  v_and_b32 v147, 0xffff0000, v17
  v_lshlrev_b32 v148, 16, v18
  v_and_b32 v149, 0xffff0000, v18
  v_lshlrev_b32 v150, 16, v19
  v_and_b32 v151, 0xffff0000, v19
  v_lshlrev_b32 v152, 16, v20
  v_and_b32 v153, 0xffff0000, v20
  v_lshlrev_b32 v154, 16, v21
  v_and_b32 v155, 0xffff0000, v21
  v_lshlrev_b32 v156, 16, v22
  v_and_b32 v157, 0xffff0000, v22
  v_lshlrev_b32 v158, 16, v23
  v_and_b32 v159, 0xffff0000, v23
  v_lshlrev_b32 v160, 16, v24
  v_and_b32 v161, 0xffff0000, v24
  v_lshlrev_b32 v162, 16, v25
  v_and_b32 v163, 0xffff0000, v25
  v_lshlrev_b32 v164, 16, v26
  v_and_b32 v165, 0xffff0000, v26
  v_lshlrev_b32 v166, 16, v27
  v_and_b32 v167, 0xffff0000, v27
  v_lshlrev_b32 v168, 16, v28
  v_and_b32 v169, 0xffff0000, v28
  v_lshlrev_b32 v170, 16, v29
  v_and_b32 v171, 0xffff0000, v29
  v_lshlrev_b32 v172, 16, v30
  v_and_b32 v173, 0xffff0000, v30
  v_lshlrev_b32 v174, 16, v31
  v_and_b32 v175, 0xffff0000, v31
  s_nop 1
Lpoll_11:
  buffer_load_dword v3, v2, s[4:7], 0 offen sc1
  s_sub_u32 s24, s24, 1
  s_cbranch_scc1 L_FAIL
  s_waitcnt vmcnt(0)
  v_cmp_gt_i32 vcc, s29, v3
  s_cbranch_vccz Lpolld_12
  s_sleep 1
  s_branch Lpoll_11
Lpolld_12:
  s_add_u32 s40, s27, 0
  buffer_load_dwordx4 v[192:195], v1, s[4:7], s40 offen sc1
  s_add_u32 s40, s27, 4096
  buffer_load_dwordx4 v[196:199], v1, s[4:7], s40 offen sc1
  s_add_u32 s40, s27, 8192
  buffer_load_dwordx4 v[200:203], v1, s[4:7], s40 offen sc1
  s_add_u32 s40, s27, 12288
  buffer_load_dwordx4 v[204:207], v1, s[4:7], s40 offen sc1
  s_add_u32 s40, s27, 65536
  buffer_load_dwordx4 v[208:211], v1, s[4:7], s40 offen sc1
  s_add_u32 s40, s27, 69632
  buffer_load_dwordx4 v[212:215], v1, s[4:7], s40 offen sc1
  s_add_u32 s40, s27, 73728
  buffer_load_dwordx4 v[216:219], v1, s[4:7], s40 offen sc1
  s_add_u32 s40, s27, 77824
  buffer_load_dwordx4 v[220:223], v1, s[4:7], s40 offen sc1
  s_add_u32 s40, s27, 131072
  buffer_load_dwordx4 v[224:227], v1, s[4:7], s40 offen sc1
  s_add_u32 s40, s27, 135168
  buffer_load_dwordx4 v[228:231], v1, s[4:7], s40 offen sc1
  s_add_u32 s40, s27, 139264
  buffer_load_dwordx4 v[232:235], v1, s[4:7], s40 offen sc1
  s_add_u32 s40, s27, 143360
  buffer_load_dwordx4 v[236:239], v1, s[4:7], s40 offen sc1
  s_add_u32 s40, s27, 196608
  buffer_load_dwordx4 v[240:243], v1, s[4:7], s40 offen sc1
  s_add_u32 s40, s27, 200704
  buffer_load_dwordx4 v[244:247], v1, s[4:7], s40 offen sc1
  s_add_u32 s40, s27, 204800
  buffer_load_dwordx4 v[248:251], v1, s[4:7], s40 offen sc1
  s_add_u32 s40, s27, 208896
  buffer_load_dwordx4 v[252:255], v1, s[4:7], s40 offen sc1
  s_waitcnt vmcnt(15)
  v_lshlrev_b32 v176, 16, v192
  v_and_b32 v177, 0xffff0000, v192
  v_lshlrev_b32 v178, 16, v193
  v_and_b32 v179, 0xffff0000, v193
  v_lshlrev_b32 v180, 16, v194
  v_and_b32 v181, 0xffff0000, v194
  v_lshlrev_b32 v182, 16, v195
  v_and_b32 v183, 0xffff0000, v195
  v_pk_fma_f32 v[144:145], v[176:177], v[48:49], v[144:145]
  v_pk_fma_f32 v[146:147], v[178:179], v[50:51], v[146:147]
  v_pk_fma_f32 v[148:149], v[180:181], v[52:53], v[148:149]
  v_pk_fma_f32 v[150:151], v[182:183], v[54:55], v[150:151]
  s_waitcnt vmcnt(14)
  v_lshlrev_b32 v184, 16, v196
  v_and_b32 v185, 0xffff0000, v196
  v_lshlrev_b32 v186, 16, v197
  v_and_b32 v187, 0xffff0000, v197
  v_lshlrev_b32 v188, 16, v198
  v_and_b32 v189, 0xffff0000, v198
  v_lshlrev_b32 v190, 16, v199
  v_and_b32 v191, 0xffff0000, v199
  v_pk_fma_f32 v[152:153], v[184:185], v[56:57], v[152:153]
  v_pk_fma_f32 v[154:155], v[186:187], v[58:59], v[154:155]
  v_pk_fma_f32 v[156:157], v[188:189], v[60:61], v[156:157]
  v_pk_fma_f32 v[158:159], v[190:191], v[62:63], v[158:159]
  s_waitcnt vmcnt(13)
  v_lshlrev_b32 v176, 16, v200
  v_and_b32 v177, 0xffff0000, v200
  v_lshlrev_b32 v178, 16, v201
  v_and_b32 v179, 0xffff0000, v201
  v_lshlrev_b32 v180, 16, v202
  v_and_b32 v181, 0xffff0000, v202
  v_lshlrev_b32 v182, 16, v203
  v_and_b32 v183, 0xffff0000, v203
  v_pk_fma_f32 v[160:161], v[176:177], v[64:65], v[160:161]
  v_pk_fma_f32 v[162:163], v[178:179], v[66:67], v[162:163]
  v_pk_fma_f32 v[164:165], v[180:181], v[68:69], v[164:165]
  v_pk_fma_f32 v[166:167], v[182:183], v[70:71], v[166:167]
  s_waitcnt vmcnt(12)
  v_lshlrev_b32 v184, 16, v204
  v_and_b32 v185, 0xffff0000, v204
  v_lshlrev_b32 v186, 16, v205
  v_and_b32 v187, 0xffff0000, v205
  v_lshlrev_b32 v188, 16, v206
  v_and_b32 v189, 0xffff0000, v206
  v_lshlrev_b32 v190, 16, v207
  v_and_b32 v191, 0xffff0000, v207
  v_pk_fma_f32 v[168:169], v[184:185], v[72:73], v[168:169]
  v_pk_fma_f32 v[170:171], v[186:187], v[74:75], v[170:171]
  v_pk_fma_f32 v[172:173], v[188:189], v[76:77], v[172:173]
  v_pk_fma_f32 v[174:175], v[190:191], v[78:79], v[174:175]
  s_waitcnt vmcnt(11)
  v_lshlrev_b32 v176, 16, v208
  v_and_b32 v177, 0xffff0000, v208
  v_lshlrev_b32 v178, 16, v209
  v_and_b32 v179, 0xffff0000, v209
  v_lshlrev_b32 v180, 16, v210
  v_and_b32 v181, 0xffff0000, v210
  v_lshlrev_b32 v182, 16, v211
  v_and_b32 v183, 0xffff0000, v211
  v_pk_fma_f32 v[144:145], v[176:177], v[48:49], v[144:145]
  v_pk_fma_f32 v[146:147], v[178:179], v[50:51], v[146:147]
  v_pk_fma_f32 v[148:149], v[180:181], v[52:53], v[148:149]
  v_pk_fma_f32 v[150:151], v[182:183], v[54:55], v[150:151]
  s_waitcnt vmcnt(10)
  v_lshlrev_b32 v184, 16, v212
  v_and_b32 v185, 0xffff0000, v212
  v_lshlrev_b32 v186, 16, v213
  v_and_b32 v187, 0xffff0000, v213
  v_lshlrev_b32 v188, 16, v214
  v_and_b32 v189, 0xffff0000, v214
  v_lshlrev_b32 v190, 16, v215
  v_and_b32 v191, 0xffff0000, v215
  v_pk_fma_f32 v[152:153], v[184:185], v[56:57], v[152:153]
  v_pk_fma_f32 v[154:155], v[186:187], v[58:59], v[154:155]
  v_pk_fma_f32 v[156:157], v[188:189], v[60:61], v[156:157]
  v_pk_fma_f32 v[158:159], v[190:191], v[62:63], v[158:159]
  s_waitcnt vmcnt(9)
  v_lshlrev_b32 v176, 16, v216
  v_and_b32 v177, 0xffff0000, v216
  v_lshlrev_b32 v178, 16, v217
  v_and_b32 v179, 0xffff0000, v217
  v_lshlrev_b32 v180, 16, v218
  v_and_b32 v181, 0xffff0000, v218
  v_lshlrev_b32 v182, 16, v219
  v_and_b32 v183, 0xffff0000, v219
  v_pk_fma_f32 v[160:161], v[176:177], v[64:65], v[160:161]
  v_pk_fma_f32 v[162:163], v[178:179], v[66:67], v[162:163]
  v_pk_fma_f32 v[164:165], v[180:181], v[68:69], v[164:165]
  v_pk_fma_f32 v[166:167], v[182:183], v[70:71], v[166:167]
  s_waitcnt vmcnt(8)
  v_lshlrev_b32 v184, 16, v220
  v_and_b32 v185, 0xffff0000, v220
  v_lshlrev_b32 v186, 16, v221
  v_and_b32 v187, 0xffff0000, v221
  v_lshlrev_b32 v188, 16, v222
  v_and_b32 v189, 0xffff0000, v222
  v_lshlrev_b32 v190, 16, v223
  v_and_b32 v191, 0xffff0000, v223
  v_pk_fma_f32 v[168:169], v[184:185], v[72:73], v[168:169]
  v_pk_fma_f32 v[170:171], v[186:187], v[74:75], v[170:171]
  v_pk_fma_f32 v[172:173], v[188:189], v[76:77], v[172:173]
  v_pk_fma_f32 v[174:175], v[190:191], v[78:79], v[174:175]
  s_waitcnt vmcnt(7)
  v_lshlrev_b32 v176, 16, v224
  v_and_b32 v177, 0xffff0000, v224
  v_lshlrev_b32 v178, 16, v225
  v_and_b32 v179, 0xffff0000, v225
  v_lshlrev_b32 v180, 16, v226
  v_and_b32 v181, 0xffff0000, v226
  v_lshlrev_b32 v182, 16, v227
  v_and_b32 v183, 0xffff0000, v227
  v_pk_fma_f32 v[144:145], v[176:177], v[48:49], v[144:145]
  v_pk_fma_f32 v[146:147], v[178:179], v[50:51], v[146:147]
  v_pk_fma_f32 v[148:149], v[180:181], v[52:53], v[148:149]
  v_pk_fma_f32 v[150:151], v[182:183], v[54:55], v[150:151]
  s_waitcnt vmcnt(6)
  v_lshlrev_b32 v184, 16, v228
  v_and_b32 v185, 0xffff0000, v228
  v_lshlrev_b32 v186, 16, v229
  v_and_b32 v187, 0xffff0000, v229
  v_lshlrev_b32 v188, 16, v230
  v_and_b32 v189, 0xffff0000, v230
  v_lshlrev_b32 v190, 16, v231
  v_and_b32 v191, 0xffff0000, v231
  v_pk_fma_f32 v[152:153], v[184:185], v[56:57], v[152:153]
  v_pk_fma_f32 v[154:155], v[186:187], v[58:59], v[154:155]
  v_pk_fma_f32 v[156:157], v[188:189], v[60:61], v[156:157]
  v_pk_fma_f32 v[158:159], v[190:191], v[62:63], v[158:159]
  s_waitcnt vmcnt(5)
  v_lshlrev_b32 v176, 16, v232
  v_and_b32 v177, 0xffff0000, v232
  v_lshlrev_b32 v178, 16, v233
  v_and_b32 v179, 0xffff0000, v233
  v_lshlrev_b32 v180, 16, v234
  v_and_b32 v181, 0xffff0000, v234
  v_lshlrev_b32 v182, 16, v235
  v_and_b32 v183, 0xffff0000, v235
  v_pk_fma_f32 v[160:161], v[176:177], v[64:65], v[160:161]
  v_pk_fma_f32 v[162:163], v[178:179], v[66:67], v[162:163]
  v_pk_fma_f32 v[164:165], v[180:181], v[68:69], v[164:165]
  v_pk_fma_f32 v[166:167], v[182:183], v[70:71], v[166:167]
  s_waitcnt vmcnt(4)
  v_lshlrev_b32 v184, 16, v236
  v_and_b32 v185, 0xffff0000, v236
  v_lshlrev_b32 v186, 16, v237
  v_and_b32 v187, 0xffff0000, v237
  v_lshlrev_b32 v188, 16, v238
  v_and_b32 v189, 0xffff0000, v238
  v_lshlrev_b32 v190, 16, v239
  v_and_b32 v191, 0xffff0000, v239
  v_pk_fma_f32 v[168:169], v[184:185], v[72:73], v[168:169]
  v_pk_fma_f32 v[170:171], v[186:187], v[74:75], v[170:171]
  v_pk_fma_f32 v[172:173], v[188:189], v[76:77], v[172:173]
  v_pk_fma_f32 v[174:175], v[190:191], v[78:79], v[174:175]
  s_waitcnt vmcnt(3)
  v_lshlrev_b32 v176, 16, v240
  v_and_b32 v177, 0xffff0000, v240
  v_lshlrev_b32 v178, 16, v241
  v_and_b32 v179, 0xffff0000, v241
  v_lshlrev_b32 v180, 16, v242
  v_and_b32 v181, 0xffff0000, v242
  v_lshlrev_b32 v182, 16, v243
  v_and_b32 v183, 0xffff0000, v243
  v_pk_fma_f32 v[144:145], v[176:177], v[48:49], v[144:145]
  v_pk_fma_f32 v[146:147], v[178:179], v[50:51], v[146:147]
  v_pk_fma_f32 v[148:149], v[180:181], v[52:53], v[148:149]
  v_pk_fma_f32 v[150:151], v[182:183], v[54:55], v[150:151]
  s_waitcnt vmcnt(2)
  v_lshlrev_b32 v184, 16, v244
  v_and_b32 v185, 0xffff0000, v244
  v_lshlrev_b32 v186, 16, v245
  v_and_b32 v187, 0xffff0000, v245
  v_lshlrev_b32 v188, 16, v246
  v_and_b32 v189, 0xffff0000, v246
  v_lshlrev_b32 v190, 16, v247
  v_and_b32 v191, 0xffff0000, v247
  v_pk_fma_f32 v[152:153], v[184:185], v[56:57], v[152:153]
  v_pk_fma_f32 v[154:155], v[186:187], v[58:59], v[154:155]
  v_pk_fma_f32 v[156:157], v[188:189], v[60:61], v[156:157]
  v_pk_fma_f32 v[158:159], v[190:191], v[62:63], v[158:159]
  s_waitcnt vmcnt(1)
  v_lshlrev_b32 v176, 16, v248
  v_and_b32 v177, 0xffff0000, v248
  v_lshlrev_b32 v178, 16, v249
  v_and_b32 v179, 0xffff0000, v249
  v_lshlrev_b32 v180, 16, v250
  v_and_b32 v181, 0xffff0000, v250
  v_lshlrev_b32 v182, 16, v251
  v_and_b32 v183, 0xffff0000, v251
  v_pk_fma_f32 v[160:161], v[176:177], v[64:65], v[160:161]
  v_pk_fma_f32 v[162:163], v[178:179], v[66:67], v[162:163]
  v_pk_fma_f32 v[164:165], v[180:181], v[68:69], v[164:165]
  v_pk_fma_f32 v[166:167], v[182:183], v[70:71], v[166:167]
  s_waitcnt vmcnt(0)
  v_lshlrev_b32 v184, 16, v252
  v_and_b32 v185, 0xffff0000, v252
  v_lshlrev_b32 v186, 16, v253
  v_and_b32 v187, 0xffff0000, v253
  v_lshlrev_b32 v188, 16, v254
  v_and_b32 v189, 0xffff0000, v254
  v_lshlrev_b32 v190, 16, v255
  v_and_b32 v191, 0xffff0000, v255
  v_pk_fma_f32 v[168:169], v[184:185], v[72:73], v[168:169]
  v_pk_fma_f32 v[170:171], v[186:187], v[74:75], v[170:171]
  v_pk_fma_f32 v[172:173], v[188:189], v[76:77], v[172:173]
  v_pk_fma_f32 v[174:175], v[190:191], v[78:79], v[174:175]
  v_cvt_pk_bf16_f32 v16, v144, v145
  v_cvt_pk_bf16_f32 v17, v146, v147
  v_cvt_pk_bf16_f32 v18, v148, v149
  v_cvt_pk_bf16_f32 v19, v150, v151
  v_cvt_pk_bf16_f32 v20, v152, v153
  v_cvt_pk_bf16_f32 v21, v154, v155
  v_cvt_pk_bf16_f32 v22, v156, v157
  v_cvt_pk_bf16_f32 v23, v158, v159
  v_cvt_pk_bf16_f32 v24, v160, v161
  v_cvt_pk_bf16_f32 v25, v162, v163
  v_cvt_pk_bf16_f32 v26, v164, v165
  v_cvt_pk_bf16_f32 v27, v166, v167
  v_cvt_pk_bf16_f32 v28, v168, v169
  v_cvt_pk_bf16_f32 v29, v170, v171
  v_cvt_pk_bf16_f32 v30, v172, v173
  v_cvt_pk_bf16_f32 v31, v174, v175
  v_pk_add_f32 v[32:33], v[144:145], v[146:147]
  v_pk_add_f32 v[34:35], v[148:149], v[150:151]
  v_pk_add_f32 v[32:33], v[32:33], v[152:153]
  v_pk_add_f32 v[34:35], v[34:35], v[154:155]
  v_pk_add_f32 v[32:33], v[32:33], v[156:157]
  v_pk_add_f32 v[34:35], v[34:35], v[158:159]
  v_pk_add_f32 v[32:33], v[32:33], v[160:161]
  v_pk_add_f32 v[34:35], v[34:35], v[162:163]
  v_pk_add_f32 v[32:33], v[32:33], v[164:165]
  v_pk_add_f32 v[34:35], v[34:35], v[166:167]
  v_pk_add_f32 v[32:33], v[32:33], v[168:169]
  v_pk_add_f32 v[34:35], v[34:35], v[170:171]
  v_pk_add_f32 v[32:33], v[32:33], v[172:173]
  v_pk_add_f32 v[34:35], v[34:35], v[174:175]
  v_pk_add_f32 v[32:33], v[32:33], v[34:35]
  v_add_f32 v32, v32, v33
  s_nop 1
  v_add_f32_dpp v32, v32, v32 row_ror:8 row_mask:0xf bank_mask:0xf
  v_mov_b32 v33, v32
  s_nop 1
  v_permlane16_swap_b32 v33, v32
  v_add_f32 v32, v32, v33
  v_mov_b32 v33, v32
  s_nop 1
  v_permlane32_swap_b32 v33, v32
  v_add_f32 v32, v32, v33
  v_mul_f32 v32, 0x3b800000, v32
  v_pk_add_f32 v[144:145], v[144:145], v[32:33] op_sel_hi:[1,0] neg_lo:[0,1] neg_hi:[0,1]
  v_pk_add_f32 v[146:147], v[146:147], v[32:33] op_sel_hi:[1,0] neg_lo:[0,1] neg_hi:[0,1]
  v_pk_add_f32 v[148:149], v[148:149], v[32:33] op_sel_hi:[1,0] neg_lo:[0,1] neg_hi:[0,1]
  v_pk_add_f32 v[150:151], v[150:151], v[32:33] op_sel_hi:[1,0] neg_lo:[0,1] neg_hi:[0,1]
  v_pk_add_f32 v[152:153], v[152:153], v[32:33] op_sel_hi:[1,0] neg_lo:[0,1] neg_hi:[0,1]
  v_pk_add_f32 v[154:155], v[154:155], v[32:33] op_sel_hi:[1,0] neg_lo:[0,1] neg_hi:[0,1]
  v_pk_add_f32 v[156:157], v[156:157], v[32:33] op_sel_hi:[1,0] neg_lo:[0,1] neg_hi:[0,1]
  v_pk_add_f32 v[158:159], v[158:159], v[32:33] op_sel_hi:[1,0] neg_lo:[0,1] neg_hi:[0,1]
  v_pk_add_f32 v[160:161], v[160:161], v[32:33] op_sel_hi:[1,0] neg_lo:[0,1] neg_hi:[0,1]
  v_pk_add_f32 v[162:163], v[162:163], v[32:33] op_sel_hi:[1,0] neg_lo:[0,1] neg_hi:[0,1]
  v_pk_add_f32 v[164:165], v[164:165], v[32:33] op_sel_hi:[1,0] neg_lo:[0,1] neg_hi:[0,1]
  v_pk_add_f32 v[166:167], v[166:167], v[32:33] op_sel_hi:[1,0] neg_lo:[0,1] neg_hi:[0,1]
  v_pk_add_f32 v[168:169], v[168:169], v[32:33] op_sel_hi:[1,0] neg_lo:[0,1] neg_hi:[0,1]
  v_pk_add_f32 v[170:171], v[170:171], v[32:33] op_sel_hi:[1,0] neg_lo:[0,1] neg_hi:[0,1]
  v_pk_add_f32 v[172:173], v[172:173], v[32:33] op_sel_hi:[1,0] neg_lo:[0,1] neg_hi:[0,1]
  v_pk_add_f32 v[174:175], v[174:175], v[32:33] op_sel_hi:[1,0] neg_lo:[0,1] neg_hi:[0,1]
  v_pk_mul_f32 v[34:35], v[144:145], v[144:145]
  v_pk_mul_f32 v[36:37], v[146:147], v[146:147]
  v_pk_fma_f32 v[34:35], v[148:149], v[148:149], v[34:35]
  v_pk_fma_f32 v[36:37], v[150:151], v[150:151], v[36:37]
  v_pk_fma_f32 v[34:35], v[152:153], v[152:153], v[34:35]
  v_pk_fma_f32 v[36:37], v[154:155], v[154:155], v[36:37]
  v_pk_fma_f32 v[34:35], v[156:157], v[156:157], v[34:35]
  v_pk_fma_f32 v[36:37], v[158:159], v[158:159], v[36:37]
  v_pk_fma_f32 v[34:35], v[160:161], v[160:161], v[34:35]
  v_pk_fma_f32 v[36:37], v[162:163], v[162:163], v[36:37]
  v_pk_fma_f32 v[34:35], v[164:165], v[164:165], v[34:35]
  v_pk_fma_f32 v[36:37], v[166:167], v[166:167], v[36:37]
  v_pk_fma_f32 v[34:35], v[168:169], v[168:169], v[34:35]
  v_pk_fma_f32 v[36:37], v[170:171], v[170:171], v[36:37]
  v_pk_fma_f32 v[34:35], v[172:173], v[172:173], v[34:35]
  v_pk_fma_f32 v[36:37], v[174:175], v[174:175], v[36:37]
  v_pk_add_f32 v[34:35], v[34:35], v[36:37]
  v_add_f32 v34, v34, v35
  s_nop 1
  v_add_f32_dpp v34, v34, v34 row_ror:8 row_mask:0xf bank_mask:0xf
  v_mov_b32 v35, v34
  s_nop 1
  v_permlane16_swap_b32 v35, v34
  v_add_f32 v34, v34, v35
  v_mov_b32 v35, v34
  s_nop 1
  v_permlane32_swap_b32 v35, v34
  v_add_f32 v34, v34, v35
  v_mov_b32 v33, v34
  ds_write_b64 v12, v[32:33]
  s_waitcnt lgkmcnt(0)
  s_barrier
  ds_read2_b64 v[36:39], v13 offset0:0 offset1:8
  ds_read2_b64 v[40:43], v13 offset0:16 offset1:24
  s_waitcnt lgkmcnt(0)
  v_pk_add_f32 v[34:35], v[36:37], v[38:39]
  v_pk_add_f32 v[44:45], v[40:41], v[42:43]
  v_pk_add_f32 v[34:35], v[34:35], v[44:45]
  v_mul_f32 v34, 0x3e800000, v34
  v_mul_f32 v35, 0x3b800000, v35
  v_sub_f32 v36, v36, v34
  v_sub_f32 v38, v38, v34
  v_sub_f32 v40, v40, v34
  v_sub_f32 v42, v42, v34
  v_fmac_f32 v35, v36, v36
  v_fmac_f32 v35, v38, v38
  v_fmac_f32 v35, v40, v40
  v_fmac_f32 v35, v42, v42
  v_mul_f32 v35, 0x3e800000, v35
  v_add_f32 v35, 0x3727c5ac, v35
  v_rsq_f32 v44, v35
  v_sub_f32 v32, v32, v34
  v_mul_f32 v32, v32, v44
  v_pk_fma_f32 v[144:145], v[144:145], v[44:45], v[32:33] op_sel_hi:[1,0,0]
  v_pk_fma_f32 v[146:147], v[146:147], v[44:45], v[32:33] op_sel_hi:[1,0,0]
  v_pk_fma_f32 v[148:149], v[148:149], v[44:45], v[32:33] op_sel_hi:[1,0,0]
  v_pk_fma_f32 v[150:151], v[150:151], v[44:45], v[32:33] op_sel_hi:[1,0,0]
  v_pk_fma_f32 v[144:145], v[144:145], v[112:113], v[80:81]
  v_pk_fma_f32 v[146:147], v[146:147], v[114:115], v[82:83]
  v_pk_fma_f32 v[148:149], v[148:149], v[116:117], v[84:85]
  v_pk_fma_f32 v[150:151], v[150:151], v[118:119], v[86:87]
  v_cvt_pk_bf16_f32 v192, v144, v145
  v_cvt_pk_bf16_f32 v193, v146, v147
  v_cvt_pk_bf16_f32 v194, v148, v149
  v_cvt_pk_bf16_f32 v195, v150, v151
  s_add_u32 s40, s26, 6291456
  buffer_store_dwordx4 v[192:195], v1, s[4:7], s40 offen sc1
  v_pk_fma_f32 v[152:153], v[152:153], v[44:45], v[32:33] op_sel_hi:[1,0,0]
  v_pk_fma_f32 v[154:155], v[154:155], v[44:45], v[32:33] op_sel_hi:[1,0,0]
  v_pk_fma_f32 v[156:157], v[156:157], v[44:45], v[32:33] op_sel_hi:[1,0,0]
  v_pk_fma_f32 v[158:159], v[158:159], v[44:45], v[32:33] op_sel_hi:[1,0,0]
  v_pk_fma_f32 v[152:153], v[152:153], v[120:121], v[88:89]
  v_pk_fma_f32 v[154:155], v[154:155], v[122:123], v[90:91]
  v_pk_fma_f32 v[156:157], v[156:157], v[124:125], v[92:93]
  v_pk_fma_f32 v[158:159], v[158:159], v[126:127], v[94:95]
  v_cvt_pk_bf16_f32 v196, v152, v153
  v_cvt_pk_bf16_f32 v197, v154, v155
  v_cvt_pk_bf16_f32 v198, v156, v157
  v_cvt_pk_bf16_f32 v199, v158, v159
  s_add_u32 s40, s26, 6295552
  buffer_store_dwordx4 v[196:199], v1, s[4:7], s40 offen sc1
  v_pk_fma_f32 v[160:161], v[160:161], v[44:45], v[32:33] op_sel_hi:[1,0,0]
  v_pk_fma_f32 v[162:163], v[162:163], v[44:45], v[32:33] op_sel_hi:[1,0,0]
  v_pk_fma_f32 v[164:165], v[164:165], v[44:45], v[32:33] op_sel_hi:[1,0,0]
  v_pk_fma_f32 v[166:167], v[166:167], v[44:45], v[32:33] op_sel_hi:[1,0,0]
  v_pk_fma_f32 v[160:161], v[160:161], v[128:129], v[96:97]
  v_pk_fma_f32 v[162:163], v[162:163], v[130:131], v[98:99]
  v_pk_fma_f32 v[164:165], v[164:165], v[132:133], v[100:101]
  v_pk_fma_f32 v[166:167], v[166:167], v[134:135], v[102:103]
  v_cvt_pk_bf16_f32 v200, v160, v161
  v_cvt_pk_bf16_f32 v201, v162, v163
  v_cvt_pk_bf16_f32 v202, v164, v165
  v_cvt_pk_bf16_f32 v203, v166, v167
  s_add_u32 s40, s26, 6299648
  buffer_store_dwordx4 v[200:203], v1, s[4:7], s40 offen sc1
  v_pk_fma_f32 v[168:169], v[168:169], v[44:45], v[32:33] op_sel_hi:[1,0,0]
  v_pk_fma_f32 v[170:171], v[170:171], v[44:45], v[32:33] op_sel_hi:[1,0,0]
  v_pk_fma_f32 v[172:173], v[172:173], v[44:45], v[32:33] op_sel_hi:[1,0,0]
  v_pk_fma_f32 v[174:175], v[174:175], v[44:45], v[32:33] op_sel_hi:[1,0,0]
  v_pk_fma_f32 v[168:169], v[168:169], v[136:137], v[104:105]
  v_pk_fma_f32 v[170:171], v[170:171], v[138:139], v[106:107]
  v_pk_fma_f32 v[172:173], v[172:173], v[140:141], v[108:109]
  v_pk_fma_f32 v[174:175], v[174:175], v[142:143], v[110:111]
  v_cvt_pk_bf16_f32 v204, v168, v169
  v_cvt_pk_bf16_f32 v205, v170, v171
  v_cvt_pk_bf16_f32 v206, v172, v173
  v_cvt_pk_bf16_f32 v207, v174, v175
  s_add_u32 s40, s26, 6303744
  buffer_store_dwordx4 v[204:207], v1, s[4:7], s40 offen sc1
  s_add_u32 s40, s26, 10485760
  buffer_store_dwordx4 v[16:19], v1, s[4:7], s40 offen sc1
  s_add_u32 s40, s26, 10489856
  buffer_store_dwordx4 v[20:23], v1, s[4:7], s40 offen sc1
  s_add_u32 s40, s26, 10493952
  buffer_store_dwordx4 v[24:27], v1, s[4:7], s40 offen sc1
  s_add_u32 s40, s26, 10498048
  buffer_store_dwordx4 v[28:31], v1, s[4:7], s40 offen sc1
  s_waitcnt vmcnt(0)
  s_barrier
  s_cmp_lg_u32 s20, 0
  s_cbranch_scc1 Lnosig_13
  s_mov_b32 s63, s29
  s_atomic_smax s63, s[4:5], s62 glc
Lnosig_13:
  s_add_u32 s25, s25, 2
  s_add_u32 s29, s29, 2
  s_add_u32 s26, s26, 131072
  s_add_u32 s27, s27, 524288
  s_cmp_lt_u32 s25, 64
  s_cbranch_scc1 L_LN2_top
  s_branch L_END
L_FIN:
  s_load_dwordx2 s[16:17], s[0:1], 104
  s_mov_b32 s18, 4194304
  s_mov_b32 s19, 0x20000
  s_waitcnt lgkmcnt(0)
  s_lshr_b32 s25, s21, 2
  s_add_u32 s29, s25, 1
  s_lshl_b32 s26, s25, 16
  s_mul_i32 s27, s25, 196608
  s_add_u32 s27, s27, 142606336
  s_and_b32 s43, s21, 3
  s_lshr_b32 s40, s43, 1
  s_lshl_b32 s40, s40, 10
  s_and_b32 s41, s43, 1
  s_lshl_b32 s41, s41, 7
  s_add_u32 s40, s40, s41
  s_lshl_b32 s41, s20, 14
  s_add_u32 s40, s40, s41
  v_and_b32 v6, 7, v0
  v_lshl_add_u32 v1, v6, 4, s40
  v_bfe_u32 v7, v0, 3, 2
  v_lshl_add_u32 v1, v7, 8, v1
  v_lshrrev_b32 v7, 5, v0
  v_lshl_add_u32 v1, v7, 11, v1
  v_lshrrev_b32 v8, 3, v0
  s_lshl_b32 s40, s20, 10
  v_lshl_add_u32 v5, v8, 4, s40
  s_lshl_b32 s40, s43, 14
  s_lshl_b32 s41, s20, 9
  s_add_u32 s40, s40, s41
  v_and_b32 v9, 31, v0
  v_lshl_add_u32 v10, v9, 4, s40
  v_lshl_add_u32 v10, v7, 11, v10
  v_min_u32 v2, 63, v0
  v_lshlrev_b32 v2, 7, v2
  v_add_u32 v2, 1380352, v2
  s_nop 1
Lpoll_14:
  buffer_load_dword v3, v2, s[4:7], 0 offen sc1
  s_sub_u32 s24, s24, 1
  s_cbranch_scc1 L_FAIL
  s_waitcnt vmcnt(0)
  v_cmp_gt_i32 vcc, 1, v3
  s_cbranch_vccz Lpolld_15
  s_sleep 2
  s_branch Lpoll_14
Lpolld_15:
  s_mov_b32 s40, 1593344
  buffer_load_dwordx4 v[48:51], v5, s[4:7], s40 offen offset:0 sc1
  buffer_load_dwordx4 v[52:55], v5, s[4:7], s40 offen offset:256 sc1
  buffer_load_dwordx4 v[56:59], v5, s[4:7], s40 offen offset:128 sc1
  buffer_load_dwordx4 v[60:63], v5, s[4:7], s40 offen offset:384 sc1
  buffer_load_dwordx4 v[64:67], v5, s[4:7], s40 offen offset:512 sc1
  buffer_load_dwordx4 v[68:71], v5, s[4:7], s40 offen offset:768 sc1
  buffer_load_dwordx4 v[72:75], v5, s[4:7], s40 offen offset:640 sc1
  buffer_load_dwordx4 v[76:79], v5, s[4:7], s40 offen offset:896 sc1
  v_min_u32 v2, 23, v0
  v_lshlrev_b32 v2, 7, v2
  v_add_u32 v2, 1421312, v2
  s_mul_i32 s30, s20, 4224
  v_mul_u32_u24 v11, 528, v6
  v_lshl_add_u32 v11, v8, 3, v11
  v_add_u32 v11, s30, v11
  v_mul_u32_u24 v12, 528, v7
  v_lshl_add_u32 v12, v9, 4, v12
  v_add_u32 v12, s30, v12
  s_nop 1
L_FIN_top:
Lpoll_16:
  buffer_load_dword v3, v2, s[4:7], 0 offen sc1
  s_sub_u32 s24, s24, 1
  s_cbranch_scc1 L_FAIL
  s_waitcnt vmcnt(0)
  v_cmp_gt_i32 vcc, s29, v3
  s_cbranch_vccz Lpolld_17
  s_sleep 1
  s_branch Lpoll_16
Lpolld_17:
  s_add_u32 s40, s26, 10485760
  buffer_load_dwordx4 v[16:19], v1, s[4:7], s40 offen sc1
  s_add_u32 s40, s26, 10489856
  buffer_load_dwordx4 v[20:23], v1, s[4:7], s40 offen sc1
  s_add_u32 s40, s26, 10493952
  buffer_load_dwordx4 v[24:27], v1, s[4:7], s40 offen sc1
  s_add_u32 s40, s26, 10498048
  buffer_load_dwordx4 v[28:31], v1, s[4:7], s40 offen sc1
  s_add_u32 s40, s27, 0
  buffer_load_dwordx4 v[192:195], v1, s[4:7], s40 offen sc1
  s_add_u32 s40, s27, 4096
  buffer_load_dwordx4 v[196:199], v1, s[4:7], s40 offen sc1
  s_add_u32 s40, s27, 8192
  buffer_load_dwordx4 v[200:203], v1, s[4:7], s40 offen sc1
  s_add_u32 s40, s27, 12288
  buffer_load_dwordx4 v[204:207], v1, s[4:7], s40 offen sc1
  s_add_u32 s40, s27, 65536
  buffer_load_dwordx4 v[208:211], v1, s[4:7], s40 offen sc1
  s_add_u32 s40, s27, 69632
  buffer_load_dwordx4 v[212:215], v1, s[4:7], s40 offen sc1
  s_add_u32 s40, s27, 73728
  buffer_load_dwordx4 v[216:219], v1, s[4:7], s40 offen sc1
  s_add_u32 s40, s27, 77824
  buffer_load_dwordx4 v[220:223], v1, s[4:7], s40 offen sc1
  s_add_u32 s40, s27, 131072
  buffer_load_dwordx4 v[224:227], v1, s[4:7], s40 offen sc1
  s_add_u32 s40, s27, 135168
  buffer_load_dwordx4 v[228:231], v1, s[4:7], s40 offen sc1
  s_add_u32 s40, s27, 139264
  buffer_load_dwordx4 v[232:235], v1, s[4:7], s40 offen sc1
  s_add_u32 s40, s27, 143360
  buffer_load_dwordx4 v[236:239], v1, s[4:7], s40 offen sc1
  s_waitcnt vmcnt(12)
  v_lshlrev_b32 v144, 16, v16
  v_and_b32 v145, 0xffff0000, v16
  v_lshlrev_b32 v146, 16, v17
  v_and_b32 v147, 0xffff0000, v17
  v_lshlrev_b32 v148, 16, v18
  v_and_b32 v149, 0xffff0000, v18
  v_lshlrev_b32 v150, 16, v19
  v_and_b32 v151, 0xffff0000, v19
  v_lshlrev_b32 v152, 16, v20
  v_and_b32 v153, 0xffff0000, v20
  v_lshlrev_b32 v154, 16, v21
  v_and_b32 v155, 0xffff0000, v21
  v_lshlrev_b32 v156, 16, v22
  v_and_b32 v157, 0xffff0000, v22
  v_lshlrev_b32 v158, 16, v23
  v_and_b32 v159, 0xffff0000, v23
  v_lshlrev_b32 v160, 16, v24
  v_and_b32 v161, 0xffff0000, v24
  v_lshlrev_b32 v162, 16, v25
  v_and_b32 v163, 0xffff0000, v25
  v_lshlrev_b32 v164, 16, v26
  v_and_b32 v165, 0xffff0000, v26
  v_lshlrev_b32 v166, 16, v27
  v_and_b32 v167, 0xffff0000, v27
  v_lshlrev_b32 v168, 16, v28
  v_and_b32 v169, 0xffff0000, v28
  v_lshlrev_b32 v170, 16, v29
  v_and_b32 v171, 0xffff0000, v29
  v_lshlrev_b32 v172, 16, v30
  v_and_b32 v173, 0xffff0000, v30
  v_lshlrev_b32 v174, 16, v31
  v_and_b32 v175, 0xffff0000, v31
  s_waitcnt vmcnt(11)
  v_lshlrev_b32 v176, 16, v192
  v_and_b32 v177, 0xffff0000, v192
  v_lshlrev_b32 v178, 16, v193
  v_and_b32 v179, 0xffff0000, v193
  v_lshlrev_b32 v180, 16, v194
  v_and_b32 v181, 0xffff0000, v194
  v_lshlrev_b32 v182, 16, v195
  v_and_b32 v183, 0xffff0000, v195
  v_pk_fma_f32 v[144:145], v[176:177], v[48:49], v[144:145]
  v_pk_fma_f32 v[146:147], v[178:179], v[50:51], v[146:147]
  v_pk_fma_f32 v[148:149], v[180:181], v[52:53], v[148:149]
  v_pk_fma_f32 v[150:151], v[182:183], v[54:55], v[150:151]
  s_waitcnt vmcnt(10)
  v_lshlrev_b32 v184, 16, v196
  v_and_b32 v185, 0xffff0000, v196
  v_lshlrev_b32 v186, 16, v197
  v_and_b32 v187, 0xffff0000, v197
  v_lshlrev_b32 v188, 16, v198
  v_and_b32 v189, 0xffff0000, v198
  v_lshlrev_b32 v190, 16, v199
  v_and_b32 v191, 0xffff0000, v199
  v_pk_fma_f32 v[152:153], v[184:185], v[56:57], v[152:153]
  v_pk_fma_f32 v[154:155], v[186:187], v[58:59], v[154:155]
  v_pk_fma_f32 v[156:157], v[188:189], v[60:61], v[156:157]
  v_pk_fma_f32 v[158:159], v[190:191], v[62:63], v[158:159]
  s_waitcnt vmcnt(9)
  v_lshlrev_b32 v176, 16, v200
  v_and_b32 v177, 0xffff0000, v200
  v_lshlrev_b32 v178, 16, v201
  v_and_b32 v179, 0xffff0000, v201
  v_lshlrev_b32 v180, 16, v202
  v_and_b32 v181, 0xffff0000, v202
  v_lshlrev_b32 v182, 16, v203
  v_and_b32 v183, 0xffff0000, v203
  v_pk_fma_f32 v[160:161], v[176:177], v[64:65], v[160:161]
  v_pk_fma_f32 v[162:163], v[178:179], v[66:67], v[162:163]
  v_pk_fma_f32 v[164:165], v[180:181], v[68:69], v[164:165]
  v_pk_fma_f32 v[166:167], v[182:183], v[70:71], v[166:167]
  s_waitcnt vmcnt(8)
  v_lshlrev_b32 v184, 16, v204
  v_and_b32 v185, 0xffff0000, v204
  v_lshlrev_b32 v186, 16, v205
  v_and_b32 v187, 0xffff0000, v205
  v_lshlrev_b32 v188, 16, v206
  v_and_b32 v189, 0xffff0000, v206
  v_lshlrev_b32 v190, 16, v207
  v_and_b32 v191, 0xffff0000, v207
  v_pk_fma_f32 v[168:169], v[184:185], v[72:73], v[168:169]
  v_pk_fma_f32 v[170:171], v[186:187], v[74:75], v[170:171]
  v_pk_fma_f32 v[172:173], v[188:189], v[76:77], v[172:173]
  v_pk_fma_f32 v[174:175], v[190:191], v[78:79], v[174:175]
  s_waitcnt vmcnt(7)
  v_lshlrev_b32 v176, 16, v208
  v_and_b32 v177, 0xffff0000, v208
  v_lshlrev_b32 v178, 16, v209
  v_and_b32 v179, 0xffff0000, v209
  v_lshlrev_b32 v180, 16, v210
  v_and_b32 v181, 0xffff0000, v210
  v_lshlrev_b32 v182, 16, v211
  v_and_b32 v183, 0xffff0000, v211
  v_pk_fma_f32 v[144:145], v[176:177], v[48:49], v[144:145]
  v_pk_fma_f32 v[146:147], v[178:179], v[50:51], v[146:147]
  v_pk_fma_f32 v[148:149], v[180:181], v[52:53], v[148:149]
  v_pk_fma_f32 v[150:151], v[182:183], v[54:55], v[150:151]
  s_waitcnt vmcnt(6)
  v_lshlrev_b32 v184, 16, v212
  v_and_b32 v185, 0xffff0000, v212
  v_lshlrev_b32 v186, 16, v213
  v_and_b32 v187, 0xffff0000, v213
  v_lshlrev_b32 v188, 16, v214
  v_and_b32 v189, 0xffff0000, v214
  v_lshlrev_b32 v190, 16, v215
  v_and_b32 v191, 0xffff0000, v215
  v_pk_fma_f32 v[152:153], v[184:185], v[56:57], v[152:153]
  v_pk_fma_f32 v[154:155], v[186:187], v[58:59], v[154:155]
  v_pk_fma_f32 v[156:157], v[188:189], v[60:61], v[156:157]
  v_pk_fma_f32 v[158:159], v[190:191], v[62:63], v[158:159]
  s_waitcnt vmcnt(5)
  v_lshlrev_b32 v176, 16, v216
  v_and_b32 v177, 0xffff0000, v216
  v_lshlrev_b32 v178, 16, v217
  v_and_b32 v179, 0xffff0000, v217
  v_lshlrev_b32 v180, 16, v218
  v_and_b32 v181, 0xffff0000, v218
  v_lshlrev_b32 v182, 16, v219
  v_and_b32 v183, 0xffff0000, v219
  v_pk_fma_f32 v[160:161], v[176:177], v[64:65], v[160:161]
  v_pk_fma_f32 v[162:163], v[178:179], v[66:67], v[162:163]
  v_pk_fma_f32 v[164:165], v[180:181], v[68:69], v[164:165]
  v_pk_fma_f32 v[166:167], v[182:183], v[70:71], v[166:167]
  s_waitcnt vmcnt(4)
  v_lshlrev_b32 v184, 16, v220
  v_and_b32 v185, 0xffff0000, v220
  v_lshlrev_b32 v186, 16, v221
  v_and_b32 v187, 0xffff0000, v221
  v_lshlrev_b32 v188, 16, v222
  v_and_b32 v189, 0xffff0000, v222
  v_lshlrev_b32 v190, 16, v223
  v_and_b32 v191, 0xffff0000, v223
  v_pk_fma_f32 v[168:169], v[184:185], v[72:73], v[168:169]
  v_pk_fma_f32 v[170:171], v[186:187], v[74:75], v[170:171]
  v_pk_fma_f32 v[172:173], v[188:189], v[76:77], v[172:173]
  v_pk_fma_f32 v[174:175], v[190:191], v[78:79], v[174:175]
  s_waitcnt vmcnt(3)
  v_lshlrev_b32 v176, 16, v224
  v_and_b32 v177, 0xffff0000, v224
  v_lshlrev_b32 v178, 16, v225
  v_and_b32 v179, 0xffff0000, v225
  v_lshlrev_b32 v180, 16, v226
  v_and_b32 v181, 0xffff0000, v226
  v_lshlrev_b32 v182, 16, v227
  v_and_b32 v183, 0xffff0000, v227
  v_pk_fma_f32 v[144:145], v[176:177], v[48:49], v[144:145]
  v_pk_fma_f32 v[146:147], v[178:179], v[50:51], v[146:147]
  v_pk_fma_f32 v[148:149], v[180:181], v[52:53], v[148:149]
  v_pk_fma_f32 v[150:151], v[182:183], v[54:55], v[150:151]
  s_waitcnt vmcnt(2)
  v_lshlrev_b32 v184, 16, v228
  v_and_b32 v185, 0xffff0000, v228
  v_lshlrev_b32 v186, 16, v229
  v_and_b32 v187, 0xffff0000, v229
  v_lshlrev_b32 v188, 16, v230
  v_and_b32 v189, 0xffff0000, v230
  v_lshlrev_b32 v190, 16, v231
  v_and_b32 v191, 0xffff0000, v231
  v_pk_fma_f32 v[152:153], v[184:185], v[56:57], v[152:153]
  v_pk_fma_f32 v[154:155], v[186:187], v[58:59], v[154:155]
  v_pk_fma_f32 v[156:157], v[188:189], v[60:61], v[156:157]
  v_pk_fma_f32 v[158:159], v[190:191], v[62:63], v[158:159]
  s_waitcnt vmcnt(1)
  v_lshlrev_b32 v176, 16, v232
  v_and_b32 v177, 0xffff0000, v232
  v_lshlrev_b32 v178, 16, v233
  v_and_b32 v179, 0xffff0000, v233
  v_lshlrev_b32 v180, 16, v234
  v_and_b32 v181, 0xffff0000, v234
  v_lshlrev_b32 v182, 16, v235
  v_and_b32 v183, 0xffff0000, v235
  v_pk_fma_f32 v[160:161], v[176:177], v[64:65], v[160:161]
  v_pk_fma_f32 v[162:163], v[178:179], v[66:67], v[162:163]
  v_pk_fma_f32 v[164:165], v[180:181], v[68:69], v[164:165]
  v_pk_fma_f32 v[166:167], v[182:183], v[70:71], v[166:167]
  s_waitcnt vmcnt(0)
  v_lshlrev_b32 v184, 16, v236
  v_and_b32 v185, 0xffff0000, v236
  v_lshlrev_b32 v186, 16, v237
  v_and_b32 v187, 0xffff0000, v237
  v_lshlrev_b32 v188, 16, v238
  v_and_b32 v189, 0xffff0000, v238
  v_lshlrev_b32 v190, 16, v239
  v_and_b32 v191, 0xffff0000, v239
  v_pk_fma_f32 v[168:169], v[184:185], v[72:73], v[168:169]
  v_pk_fma_f32 v[170:171], v[186:187], v[74:75], v[170:171]
  v_pk_fma_f32 v[172:173], v[188:189], v[76:77], v[172:173]
  v_pk_fma_f32 v[174:175], v[190:191], v[78:79], v[174:175]
  v_cvt_pk_bf16_f32 v16, v144, v145
  v_cvt_pk_bf16_f32 v17, v146, v147
  v_cvt_pk_bf16_f32 v18, v148, v149
  v_cvt_pk_bf16_f32 v19, v150, v151
  v_cvt_pk_bf16_f32 v20, v152, v153
  v_cvt_pk_bf16_f32 v21, v154, v155
  v_cvt_pk_bf16_f32 v22, v156, v157
  v_cvt_pk_bf16_f32 v23, v158, v159
  v_cvt_pk_bf16_f32 v24, v160, v161
  v_cvt_pk_bf16_f32 v25, v162, v163
  v_cvt_pk_bf16_f32 v26, v164, v165
  v_cvt_pk_bf16_f32 v27, v166, v167
  v_cvt_pk_bf16_f32 v28, v168, v169
  v_cvt_pk_bf16_f32 v29, v170, v171
  v_cvt_pk_bf16_f32 v30, v172, v173
  v_cvt_pk_bf16_f32 v31, v174, v175
  ds_write_b64 v11, v[16:17] offset:0
  ds_write_b64 v11, v[18:19] offset:128
  ds_write_b64 v11, v[20:21] offset:64
  ds_write_b64 v11, v[22:23] offset:192
  ds_write_b64 v11, v[24:25] offset:256
  ds_write_b64 v11, v[26:27] offset:384
  ds_write_b64 v11, v[28:29] offset:320
  ds_write_b64 v11, v[30:31] offset:448
  s_waitcnt lgkmcnt(0)
  ds_read_b128 v[192:195], v12 offset:0
  ds_read_b128 v[196:199], v12 offset:1056
  ds_read_b128 v[200:203], v12 offset:2112
  ds_read_b128 v[204:207], v12 offset:3168
  s_add_u32 s40, s26, 0
  s_waitcnt lgkmcnt(3)
  buffer_store_dwordx4 v[192:195], v10, s[16:19], s40 offen
  s_add_u32 s40, s26, 4096
  s_waitcnt lgkmcnt(2)
  buffer_store_dwordx4 v[196:199], v10, s[16:19], s40 offen
  s_add_u32 s40, s26, 8192
  s_waitcnt lgkmcnt(1)
  buffer_store_dwordx4 v[200:203], v10, s[16:19], s40 offen
  s_add_u32 s40, s26, 12288
  s_waitcnt lgkmcnt(0)
  buffer_store_dwordx4 v[204:207], v10, s[16:19], s40 offen
  s_add_u32 s25, s25, 2
  s_add_u32 s29, s29, 2
  s_add_u32 s26, s26, 131072
  s_add_u32 s27, s27, 393216
  s_cmp_lt_u32 s25, 64
  s_cbranch_scc1 L_FIN_top
  s_branch L_END
L_QKV:
  s_and_b32 s43, s21, 1
  s_lshr_b32 s44, s21, 1
  s_lshl_b32 s44, s44, 8
  s_add_u32 s45, s44, 128
  s_lshl_b32 s46, s43, 7
  s_add_u32 s46, s46, s44
  s_load_dwordx4 s[48:51], s[0:1], 16
  s_waitcnt lgkmcnt(0)
  s_cmp_eq_u32 s43, 0
  s_cselect_b32 s8, s48, s50
  s_cselect_b32 s9, s49, s51
  s_mov_b32 s10, 8388608
  s_mov_b32 s11, 0x20000
  v_bfe_u32 v40, v0, 5, 1
  v_mul_u32_u24 v40, 32768, v40
  v_bfe_u32 v41, v0, 4, 1
  v_mul_u32_u24 v41, 16384, v41
  v_add_u32 v40, v40, v41
  v_bfe_u32 v41, v0, 3, 1
  v_mul_u32_u24 v41, 8192, v41
  v_add_u32 v40, v40, v41
  v_lshrrev_b32 v41, 3, v0
  v_and_b32 v41, 6, v41
  v_xor_b32 v41, v41, v0
  v_and_b32 v41, 7, v41
  v_lshl_add_u32 v40, v41, 4, v40
  s_lshr_b32 s40, s20, 1
  s_mul_i32 s40, s40, 2097152
  s_and_b32 s41, s20, 1
  s_mul_i32 s41, s41, 65536
  s_add_u32 s40, s40, s41
  v_add_u32 v40, s40, v40
  v_bfe_u32 v41, v0, 3, 2
  v_xor_b32 v41, s20, v41
  v_lshlrev_b32 v41, 5, v41
  v_lshrrev_b32 v42, 2, v0
  v_lshl_add_u32 v42, v42, 7, v41
  v_and_b32 v41, 3, v0
  v_lshl_add_u32 v42, v41, 3, v42
  v_add_u32 v43, 0x10000, v42
  v_add_u32 v44, s44, v40
  v_add_u32 v45, s45, v40
  v_add_u32 v46, s46, v40
  s_lshl_b32 s41, s20, 10
  s_add_u32 m0, s41, 0
  s_mov_b32 s42, 0
  buffer_load_dwordx4 v44, s[8:11], s42 offen lds
  s_add_u32 m0, s41, 4096
  s_mov_b32 s42, 131072
  buffer_load_dwordx4 v44, s[8:11], s42 offen lds
  s_add_u32 m0, s41, 8192
  s_mov_b32 s42, 262144
  buffer_load_dwordx4 v44, s[8:11], s42 offen lds
  s_add_u32 m0, s41, 12288
  s_mov_b32 s42, 393216
  buffer_load_dwordx4 v44, s[8:11], s42 offen lds
  s_add_u32 m0, s41, 16384
  s_mov_b32 s42, 524288
  buffer_load_dwordx4 v44, s[8:11], s42 offen lds
  s_add_u32 m0, s41, 20480
  s_mov_b32 s42, 655360
  buffer_load_dwordx4 v44, s[8:11], s42 offen lds
  s_add_u32 m0, s41, 24576
  s_mov_b32 s42, 786432
  buffer_load_dwordx4 v44, s[8:11], s42 offen lds
  s_add_u32 m0, s41, 28672
  s_mov_b32 s42, 917504
  buffer_load_dwordx4 v44, s[8:11], s42 offen lds
  s_add_u32 m0, s41, 32768
  s_mov_b32 s42, 1048576
  buffer_load_dwordx4 v44, s[8:11], s42 offen lds
  s_add_u32 m0, s41, 36864
  s_mov_b32 s42, 1179648
  buffer_load_dwordx4 v44, s[8:11], s42 offen lds
  s_add_u32 m0, s41, 40960
  s_mov_b32 s42, 1310720
  buffer_load_dwordx4 v44, s[8:11], s42 offen lds
  s_add_u32 m0, s41, 45056
  s_mov_b32 s42, 1441792
  buffer_load_dwordx4 v44, s[8:11], s42 offen lds
  s_add_u32 m0, s41, 49152
  s_mov_b32 s42, 1572864
  buffer_load_dwordx4 v44, s[8:11], s42 offen lds
  s_add_u32 m0, s41, 53248
  s_mov_b32 s42, 1703936
  buffer_load_dwordx4 v44, s[8:11], s42 offen lds
  s_add_u32 m0, s41, 57344
  s_mov_b32 s42, 1835008
  buffer_load_dwordx4 v44, s[8:11], s42 offen lds
  s_add_u32 m0, s41, 61440
  s_mov_b32 s42, 1966080
  buffer_load_dwordx4 v44, s[8:11], s42 offen lds
  s_add_u32 m0, s41, 65536
  s_mov_b32 s42, 4194304
  buffer_load_dwordx4 v44, s[8:11], s42 offen lds
  s_add_u32 m0, s41, 69632
  s_mov_b32 s42, 4325376
  buffer_load_dwordx4 v44, s[8:11], s42 offen lds
  s_add_u32 m0, s41, 73728
  s_mov_b32 s42, 4456448
  buffer_load_dwordx4 v44, s[8:11], s42 offen lds
  s_add_u32 m0, s41, 77824
  s_mov_b32 s42, 4587520
  buffer_load_dwordx4 v44, s[8:11], s42 offen lds
  s_add_u32 m0, s41, 81920
  s_mov_b32 s42, 4718592
  buffer_load_dwordx4 v44, s[8:11], s42 offen lds
  s_add_u32 m0, s41, 86016
  s_mov_b32 s42, 4849664
  buffer_load_dwordx4 v44, s[8:11], s42 offen lds
  s_add_u32 m0, s41, 90112
  s_mov_b32 s42, 4980736
  buffer_load_dwordx4 v44, s[8:11], s42 offen lds
  s_add_u32 m0, s41, 94208
  s_mov_b32 s42, 5111808
  buffer_load_dwordx4 v44, s[8:11], s42 offen lds
  s_add_u32 m0, s41, 98304
  s_mov_b32 s42, 5242880
  buffer_load_dwordx4 v44, s[8:11], s42 offen lds
  s_add_u32 m0, s41, 102400
  s_mov_b32 s42, 5373952
  buffer_load_dwordx4 v44, s[8:11], s42 offen lds
  s_add_u32 m0, s41, 106496
  s_mov_b32 s42, 5505024
  buffer_load_dwordx4 v44, s[8:11], s42 offen lds
  s_add_u32 m0, s41, 110592
  s_mov_b32 s42, 5636096
  buffer_load_dwordx4 v44, s[8:11], s42 offen lds
  s_waitcnt vmcnt(24) lgkmcnt(0)
  s_barrier
  s_add_u32 m0, s41, 114688
  s_mov_b32 s42, 5767168
  buffer_load_dwordx4 v44, s[8:11], s42 offen lds
  s_add_u32 m0, s41, 118784
  s_mov_b32 s42, 5898240
  buffer_load_dwordx4 v44, s[8:11], s42 offen lds
  s_add_u32 m0, s41, 122880
  s_mov_b32 s42, 6029312
  buffer_load_dwordx4 v44, s[8:11], s42 offen lds
  s_add_u32 m0, s41, 126976
  s_mov_b32 s42, 6160384
  buffer_load_dwordx4 v44, s[8:11], s42 offen lds
  ds_read_b64_tr_b16 a[0:1], v42 offset:0
  ds_read_b64_tr_b16 a[2:3], v42 offset:2048
  ds_read_b64_tr_b16 a[4:5], v42 offset:4096
  ds_read_b64_tr_b16 a[6:7], v42 offset:6144
  ds_read_b64_tr_b16 a[8:9], v42 offset:8192
  ds_read_b64_tr_b16 a[10:11], v42 offset:10240
  ds_read_b64_tr_b16 a[12:13], v42 offset:12288
  ds_read_b64_tr_b16 a[14:15], v42 offset:14336
  s_waitcnt vmcnt(24) lgkmcnt(0)
  s_barrier
  s_add_u32 m0, s41, 0
  s_mov_b32 s42, 0
  buffer_load_dwordx4 v45, s[8:11], s42 offen lds
  s_add_u32 m0, s41, 4096
  s_mov_b32 s42, 131072
  buffer_load_dwordx4 v45, s[8:11], s42 offen lds
  s_add_u32 m0, s41, 8192
  s_mov_b32 s42, 262144
  buffer_load_dwordx4 v45, s[8:11], s42 offen lds
  s_add_u32 m0, s41, 12288
  s_mov_b32 s42, 393216
  buffer_load_dwordx4 v45, s[8:11], s42 offen lds
  ds_read_b64_tr_b16 a[16:17], v42 offset:16384
  ds_read_b64_tr_b16 a[18:19], v42 offset:18432
  ds_read_b64_tr_b16 a[20:21], v42 offset:20480
  ds_read_b64_tr_b16 a[22:23], v42 offset:22528
  ds_read_b64_tr_b16 a[24:25], v42 offset:24576
  ds_read_b64_tr_b16 a[26:27], v42 offset:26624
  ds_read_b64_tr_b16 a[28:29], v42 offset:28672
  ds_read_b64_tr_b16 a[30:31], v42 offset:30720
  s_waitcnt vmcnt(24) lgkmcnt(0)
  s_barrier
  s_add_u32 m0, s41, 16384
  s_mov_b32 s42, 524288
  buffer_load_dwordx4 v45, s[8:11], s42 offen lds
  s_add_u32 m0, s41, 20480
  s_mov_b32 s42, 655360
  buffer_load_dwordx4 v45, s[8:11], s42 offen lds
  s_add_u32 m0, s41, 24576
  s_mov_b32 s42, 786432
  buffer_load_dwordx4 v45, s[8:11], s42 offen lds
  s_add_u32 m0, s41, 28672
  s_mov_b32 s42, 917504
  buffer_load_dwordx4 v45, s[8:11], s42 offen lds
  ds_read_b64_tr_b16 a[32:33], v42 offset:32768
  ds_read_b64_tr_b16 a[34:35], v42 offset:34816
  ds_read_b64_tr_b16 a[36:37], v42 offset:36864
  ds_read_b64_tr_b16 a[38:39], v42 offset:38912
  ds_read_b64_tr_b16 a[40:41], v42 offset:40960
  ds_read_b64_tr_b16 a[42:43], v42 offset:43008
  ds_read_b64_tr_b16 a[44:45], v42 offset:45056
  ds_read_b64_tr_b16 a[46:47], v42 offset:47104
  s_waitcnt vmcnt(24) lgkmcnt(0)
  s_barrier
  s_add_u32 m0, s41, 32768
  s_mov_b32 s42, 1048576
  buffer_load_dwordx4 v45, s[8:11], s42 offen lds
  s_add_u32 m0, s41, 36864
  s_mov_b32 s42, 1179648
  buffer_load_dwordx4 v45, s[8:11], s42 offen lds
  s_add_u32 m0, s41, 40960
  s_mov_b32 s42, 1310720
  buffer_load_dwordx4 v45, s[8:11], s42 offen lds
  s_add_u32 m0, s41, 45056
  s_mov_b32 s42, 1441792
  buffer_load_dwordx4 v45, s[8:11], s42 offen lds
  ds_read_b64_tr_b16 a[48:49], v42 offset:49152
  ds_read_b64_tr_b16 a[50:51], v42 offset:51200
  ds_read_b64_tr_b16 a[52:53], v42 offset:53248
  ds_read_b64_tr_b16 a[54:55], v42 offset:55296
  ds_read_b64_tr_b16 a[56:57], v42 offset:57344
  ds_read_b64_tr_b16 a[58:59], v42 offset:59392
  ds_read_b64_tr_b16 a[60:61], v42 offset:61440
  ds_read_b64_tr_b16 a[62:63], v42 offset:63488
  s_waitcnt vmcnt(24) lgkmcnt(0)
  s_barrier
  s_add_u32 m0, s41, 49152
  s_mov_b32 s42, 1572864
  buffer_load_dwordx4 v45, s[8:11], s42 offen lds
  s_add_u32 m0, s41, 53248
  s_mov_b32 s42, 1703936
  buffer_load_dwordx4 v45, s[8:11], s42 offen lds
  s_add_u32 m0, s41, 57344
  s_mov_b32 s42, 1835008
  buffer_load_dwordx4 v45, s[8:11], s42 offen lds
  s_add_u32 m0, s41, 61440
  s_mov_b32 s42, 1966080
  buffer_load_dwordx4 v45, s[8:11], s42 offen lds
  ds_read_b64_tr_b16 a[64:65], v43 offset:0
  ds_read_b64_tr_b16 a[66:67], v43 offset:2048
  ds_read_b64_tr_b16 a[68:69], v43 offset:4096
  ds_read_b64_tr_b16 a[70:71], v43 offset:6144
  ds_read_b64_tr_b16 a[72:73], v43 offset:8192
  ds_read_b64_tr_b16 a[74:75], v43 offset:10240
  ds_read_b64_tr_b16 a[76:77], v43 offset:12288
  ds_read_b64_tr_b16 a[78:79], v43 offset:14336
  s_waitcnt vmcnt(24) lgkmcnt(0)
  s_barrier
  s_add_u32 m0, s41, 65536
  s_mov_b32 s42, 4194304
  buffer_load_dwordx4 v45, s[8:11], s42 offen lds
  s_add_u32 m0, s41, 69632
  s_mov_b32 s42, 4325376
  buffer_load_dwordx4 v45, s[8:11], s42 offen lds
  s_add_u32 m0, s41, 73728
  s_mov_b32 s42, 4456448
  buffer_load_dwordx4 v45, s[8:11], s42 offen lds
  s_add_u32 m0, s41, 77824
  s_mov_b32 s42, 4587520
  buffer_load_dwordx4 v45, s[8:11], s42 offen lds
  ds_read_b64_tr_b16 a[80:81], v43 offset:16384
  ds_read_b64_tr_b16 a[82:83], v43 offset:18432
  ds_read_b64_tr_b16 a[84:85], v43 offset:20480
  ds_read_b64_tr_b16 a[86:87], v43 offset:22528
  ds_read_b64_tr_b16 a[88:89], v43 offset:24576
  ds_read_b64_tr_b16 a[90:91], v43 offset:26624
  ds_read_b64_tr_b16 a[92:93], v43 offset:28672
  ds_read_b64_tr_b16 a[94:95], v43 offset:30720
  s_waitcnt vmcnt(24) lgkmcnt(0)
  s_barrier
  s_add_u32 m0, s41, 81920
  s_mov_b32 s42, 4718592
  buffer_load_dwordx4 v45, s[8:11], s42 offen lds
  s_add_u32 m0, s41, 86016
  s_mov_b32 s42, 4849664
  buffer_load_dwordx4 v45, s[8:11], s42 offen lds
  s_add_u32 m0, s41, 90112
  s_mov_b32 s42, 4980736
  buffer_load_dwordx4 v45, s[8:11], s42 offen lds
  s_add_u32 m0, s41, 94208
  s_mov_b32 s42, 5111808
  buffer_load_dwordx4 v45, s[8:11], s42 offen lds
  ds_read_b64_tr_b16 a[96:97], v43 offset:32768
  ds_read_b64_tr_b16 a[98:99], v43 offset:34816
  ds_read_b64_tr_b16 a[100:101], v43 offset:36864
  ds_read_b64_tr_b16 a[102:103], v43 offset:38912
  ds_read_b64_tr_b16 a[104:105], v43 offset:40960
  ds_read_b64_tr_b16 a[106:107], v43 offset:43008
  ds_read_b64_tr_b16 a[108:109], v43 offset:45056
  ds_read_b64_tr_b16 a[110:111], v43 offset:47104
  s_waitcnt vmcnt(24) lgkmcnt(0)
  s_barrier
  s_add_u32 m0, s41, 98304
  s_mov_b32 s42, 5242880
  buffer_load_dwordx4 v45, s[8:11], s42 offen lds
  s_add_u32 m0, s41, 102400
  s_mov_b32 s42, 5373952
  buffer_load_dwordx4 v45, s[8:11], s42 offen lds
  s_add_u32 m0, s41, 106496
  s_mov_b32 s42, 5505024
  buffer_load_dwordx4 v45, s[8:11], s42 offen lds
  s_add_u32 m0, s41, 110592
  s_mov_b32 s42, 5636096
  buffer_load_dwordx4 v45, s[8:11], s42 offen lds
  ds_read_b64_tr_b16 a[112:113], v43 offset:49152
  ds_read_b64_tr_b16 a[114:115], v43 offset:51200
  ds_read_b64_tr_b16 a[116:117], v43 offset:53248
  ds_read_b64_tr_b16 a[118:119], v43 offset:55296
  ds_read_b64_tr_b16 a[120:121], v43 offset:57344
  ds_read_b64_tr_b16 a[122:123], v43 offset:59392
  ds_read_b64_tr_b16 a[124:125], v43 offset:61440
  ds_read_b64_tr_b16 a[126:127], v43 offset:63488
  s_waitcnt vmcnt(24) lgkmcnt(0)
  s_barrier
  s_add_u32 m0, s41, 114688
  s_mov_b32 s42, 5767168
  buffer_load_dwordx4 v45, s[8:11], s42 offen lds
  s_add_u32 m0, s41, 118784
  s_mov_b32 s42, 5898240
  buffer_load_dwordx4 v45, s[8:11], s42 offen lds
  s_add_u32 m0, s41, 122880
  s_mov_b32 s42, 6029312
  buffer_load_dwordx4 v45, s[8:11], s42 offen lds
  s_add_u32 m0, s41, 126976
  s_mov_b32 s42, 6160384
  buffer_load_dwordx4 v45, s[8:11], s42 offen lds
  ds_read_b64_tr_b16 a[128:129], v42 offset:0
  ds_read_b64_tr_b16 a[130:131], v42 offset:2048
  ds_read_b64_tr_b16 a[132:133], v42 offset:4096
  ds_read_b64_tr_b16 a[134:135], v42 offset:6144
  ds_read_b64_tr_b16 a[136:137], v42 offset:8192
  ds_read_b64_tr_b16 a[138:139], v42 offset:10240
  ds_read_b64_tr_b16 a[140:141], v42 offset:12288
  ds_read_b64_tr_b16 a[142:143], v42 offset:14336
  s_waitcnt vmcnt(24) lgkmcnt(0)
  s_barrier
  s_load_dwordx2 s[8:9], s[0:1], 32
  s_mov_b32 s10, 8388608
  s_mov_b32 s11, 0x20000
  s_waitcnt lgkmcnt(0)
  s_add_u32 m0, s41, 0
  s_mov_b32 s42, 0
  buffer_load_dwordx4 v46, s[8:11], s42 offen lds
  s_add_u32 m0, s41, 4096
  s_mov_b32 s42, 131072
  buffer_load_dwordx4 v46, s[8:11], s42 offen lds
  s_add_u32 m0, s41, 8192
  s_mov_b32 s42, 262144
  buffer_load_dwordx4 v46, s[8:11], s42 offen lds
  s_add_u32 m0, s41, 12288
  s_mov_b32 s42, 393216
  buffer_load_dwordx4 v46, s[8:11], s42 offen lds
  ds_read_b64_tr_b16 a[144:145], v42 offset:16384
  ds_read_b64_tr_b16 a[146:147], v42 offset:18432
  ds_read_b64_tr_b16 a[148:149], v42 offset:20480
  ds_read_b64_tr_b16 a[150:151], v42 offset:22528
  ds_read_b64_tr_b16 a[152:153], v42 offset:24576
  ds_read_b64_tr_b16 a[154:155], v42 offset:26624
  ds_read_b64_tr_b16 a[156:157], v42 offset:28672
  ds_read_b64_tr_b16 a[158:159], v42 offset:30720
  s_waitcnt vmcnt(24) lgkmcnt(0)
  s_barrier
  s_add_u32 m0, s41, 16384
  s_mov_b32 s42, 524288
  buffer_load_dwordx4 v46, s[8:11], s42 offen lds
  s_add_u32 m0, s41, 20480
  s_mov_b32 s42, 655360
  buffer_load_dwordx4 v46, s[8:11], s42 offen lds
  s_add_u32 m0, s41, 24576
  s_mov_b32 s42, 786432
  buffer_load_dwordx4 v46, s[8:11], s42 offen lds
  s_add_u32 m0, s41, 28672
  s_mov_b32 s42, 917504
  buffer_load_dwordx4 v46, s[8:11], s42 offen lds
  ds_read_b64_tr_b16 a[160:161], v42 offset:32768
  ds_read_b64_tr_b16 a[162:163], v42 offset:34816
  ds_read_b64_tr_b16 a[164:165], v42 offset:36864
  ds_read_b64_tr_b16 a[166:167], v42 offset:38912
  ds_read_b64_tr_b16 a[168:169], v42 offset:40960
  ds_read_b64_tr_b16 a[170:171], v42 offset:43008
  ds_read_b64_tr_b16 a[172:173], v42 offset:45056
  ds_read_b64_tr_b16 a[174:175], v42 offset:47104
  s_waitcnt vmcnt(24) lgkmcnt(0)
  s_barrier
  s_add_u32 m0, s41, 32768
  s_mov_b32 s42, 1048576
  buffer_load_dwordx4 v46, s[8:11], s42 offen lds
  s_add_u32 m0, s41, 36864
  s_mov_b32 s42, 1179648
  buffer_load_dwordx4 v46, s[8:11], s42 offen lds
  s_add_u32 m0, s41, 40960
  s_mov_b32 s42, 1310720
  buffer_load_dwordx4 v46, s[8:11], s42 offen lds
  s_add_u32 m0, s41, 45056
  s_mov_b32 s42, 1441792
  buffer_load_dwordx4 v46, s[8:11], s42 offen lds
  ds_read_b64_tr_b16 a[176:177], v42 offset:49152
  ds_read_b64_tr_b16 a[178:179], v42 offset:51200
  ds_read_b64_tr_b16 a[180:181], v42 offset:53248
  ds_read_b64_tr_b16 a[182:183], v42 offset:55296
  ds_read_b64_tr_b16 a[184:185], v42 offset:57344
  ds_read_b64_tr_b16 a[186:187], v42 offset:59392
  ds_read_b64_tr_b16 a[188:189], v42 offset:61440
  ds_read_b64_tr_b16 a[190:191], v42 offset:63488
  s_waitcnt vmcnt(24) lgkmcnt(0)
  s_barrier
  s_add_u32 m0, s41, 49152
  s_mov_b32 s42, 1572864
  buffer_load_dwordx4 v46, s[8:11], s42 offen lds
  s_add_u32 m0, s41, 53248
  s_mov_b32 s42, 1703936
  buffer_load_dwordx4 v46, s[8:11], s42 offen lds
  s_add_u32 m0, s41, 57344
  s_mov_b32 s42, 1835008
  buffer_load_dwordx4 v46, s[8:11], s42 offen lds
  s_add_u32 m0, s41, 61440
  s_mov_b32 s42, 1966080
  buffer_load_dwordx4 v46, s[8:11], s42 offen lds
  ds_read_b64_tr_b16 a[192:193], v43 offset:0
  ds_read_b64_tr_b16 a[194:195], v43 offset:2048
  ds_read_b64_tr_b16 a[196:197], v43 offset:4096
  ds_read_b64_tr_b16 a[198:199], v43 offset:6144
  ds_read_b64_tr_b16 a[200:201], v43 offset:8192
  ds_read_b64_tr_b16 a[202:203], v43 offset:10240
  ds_read_b64_tr_b16 a[204:205], v43 offset:12288
  ds_read_b64_tr_b16 a[206:207], v43 offset:14336
  s_waitcnt vmcnt(24) lgkmcnt(0)
  s_barrier
  s_add_u32 m0, s41, 65536
  s_mov_b32 s42, 4194304
  buffer_load_dwordx4 v46, s[8:11], s42 offen lds
  s_add_u32 m0, s41, 69632
  s_mov_b32 s42, 4325376
  buffer_load_dwordx4 v46, s[8:11], s42 offen lds
  s_add_u32 m0, s41, 73728
  s_mov_b32 s42, 4456448
  buffer_load_dwordx4 v46, s[8:11], s42 offen lds
  s_add_u32 m0, s41, 77824
  s_mov_b32 s42, 4587520
  buffer_load_dwordx4 v46, s[8:11], s42 offen lds
  ds_read_b64_tr_b16 a[208:209], v43 offset:16384
  ds_read_b64_tr_b16 a[210:211], v43 offset:18432
  ds_read_b64_tr_b16 a[212:213], v43 offset:20480
  ds_read_b64_tr_b16 a[214:215], v43 offset:22528
  ds_read_b64_tr_b16 a[216:217], v43 offset:24576
  ds_read_b64_tr_b16 a[218:219], v43 offset:26624
  ds_read_b64_tr_b16 a[220:221], v43 offset:28672
  ds_read_b64_tr_b16 a[222:223], v43 offset:30720
  s_waitcnt vmcnt(24) lgkmcnt(0)
  s_barrier
  s_add_u32 m0, s41, 81920
  s_mov_b32 s42, 4718592
  buffer_load_dwordx4 v46, s[8:11], s42 offen lds
  s_add_u32 m0, s41, 86016
  s_mov_b32 s42, 4849664
  buffer_load_dwordx4 v46, s[8:11], s42 offen lds
  s_add_u32 m0, s41, 90112
  s_mov_b32 s42, 4980736
  buffer_load_dwordx4 v46, s[8:11], s42 offen lds
  s_add_u32 m0, s41, 94208
  s_mov_b32 s42, 5111808
  buffer_load_dwordx4 v46, s[8:11], s42 offen lds
  ds_read_b64_tr_b16 a[224:225], v43 offset:32768
  ds_read_b64_tr_b16 a[226:227], v43 offset:34816
  ds_read_b64_tr_b16 a[228:229], v43 offset:36864
  ds_read_b64_tr_b16 a[230:231], v43 offset:38912
  ds_read_b64_tr_b16 a[232:233], v43 offset:40960
  ds_read_b64_tr_b16 a[234:235], v43 offset:43008
  ds_read_b64_tr_b16 a[236:237], v43 offset:45056
  ds_read_b64_tr_b16 a[238:239], v43 offset:47104
  s_waitcnt vmcnt(24) lgkmcnt(0)
  s_barrier
  s_add_u32 m0, s41, 98304
  s_mov_b32 s42, 5242880
  buffer_load_dwordx4 v46, s[8:11], s42 offen lds
  s_add_u32 m0, s41, 102400
  s_mov_b32 s42, 5373952
  buffer_load_dwordx4 v46, s[8:11], s42 offen lds
  s_add_u32 m0, s41, 106496
  s_mov_b32 s42, 5505024
  buffer_load_dwordx4 v46, s[8:11], s42 offen lds
  s_add_u32 m0, s41, 110592
  s_mov_b32 s42, 5636096
  buffer_load_dwordx4 v46, s[8:11], s42 offen lds
  ds_read_b64_tr_b16 a[240:241], v43 offset:49152
  ds_read_b64_tr_b16 a[242:243], v43 offset:51200
  ds_read_b64_tr_b16 a[244:245], v43 offset:53248
  ds_read_b64_tr_b16 a[246:247], v43 offset:55296
  ds_read_b64_tr_b16 a[248:249], v43 offset:57344
  ds_read_b64_tr_b16 a[250:251], v43 offset:59392
  ds_read_b64_tr_b16 a[252:253], v43 offset:61440
  ds_read_b64_tr_b16 a[254:255], v43 offset:63488
  s_waitcnt vmcnt(24) lgkmcnt(0)
  s_barrier
  s_add_u32 m0, s41, 114688
  s_mov_b32 s42, 5767168
  buffer_load_dwordx4 v46, s[8:11], s42 offen lds
  s_add_u32 m0, s41, 118784
  s_mov_b32 s42, 5898240
  buffer_load_dwordx4 v46, s[8:11], s42 offen lds
  s_add_u32 m0, s41, 122880
  s_mov_b32 s42, 6029312
  buffer_load_dwordx4 v46, s[8:11], s42 offen lds
  s_add_u32 m0, s41, 126976
  s_mov_b32 s42, 6160384
  buffer_load_dwordx4 v46, s[8:11], s42 offen lds
  ds_read_b64_tr_b16 v[128:129], v42 offset:0
  ds_read_b64_tr_b16 v[130:131], v42 offset:2048
  ds_read_b64_tr_b16 v[132:133], v42 offset:4096
  ds_read_b64_tr_b16 v[134:135], v42 offset:6144
  ds_read_b64_tr_b16 v[136:137], v42 offset:8192
  ds_read_b64_tr_b16 v[138:139], v42 offset:10240
  ds_read_b64_tr_b16 v[140:141], v42 offset:12288
  ds_read_b64_tr_b16 v[142:143], v42 offset:14336
  s_waitcnt vmcnt(24) lgkmcnt(0)
  s_barrier
  ds_read_b64_tr_b16 v[144:145], v42 offset:16384
  ds_read_b64_tr_b16 v[146:147], v42 offset:18432
  ds_read_b64_tr_b16 v[148:149], v42 offset:20480
  ds_read_b64_tr_b16 v[150:151], v42 offset:22528
  ds_read_b64_tr_b16 v[152:153], v42 offset:24576
  ds_read_b64_tr_b16 v[154:155], v42 offset:26624
  ds_read_b64_tr_b16 v[156:157], v42 offset:28672
  ds_read_b64_tr_b16 v[158:159], v42 offset:30720
  s_waitcnt vmcnt(20) lgkmcnt(0)
  s_barrier
  ds_read_b64_tr_b16 v[160:161], v42 offset:32768
  ds_read_b64_tr_b16 v[162:163], v42 offset:34816
  ds_read_b64_tr_b16 v[164:165], v42 offset:36864
  ds_read_b64_tr_b16 v[166:167], v42 offset:38912
  ds_read_b64_tr_b16 v[168:169], v42 offset:40960
  ds_read_b64_tr_b16 v[170:171], v42 offset:43008
  ds_read_b64_tr_b16 v[172:173], v42 offset:45056
  ds_read_b64_tr_b16 v[174:175], v42 offset:47104
  s_waitcnt vmcnt(16) lgkmcnt(0)
  s_barrier
  ds_read_b64_tr_b16 v[176:177], v42 offset:49152
  ds_read_b64_tr_b16 v[178:179], v42 offset:51200
  ds_read_b64_tr_b16 v[180:181], v42 offset:53248
  ds_read_b64_tr_b16 v[182:183], v42 offset:55296
  ds_read_b64_tr_b16 v[184:185], v42 offset:57344
  ds_read_b64_tr_b16 v[186:187], v42 offset:59392
  ds_read_b64_tr_b16 v[188:189], v42 offset:61440
  ds_read_b64_tr_b16 v[190:191], v42 offset:63488
  s_waitcnt vmcnt(12) lgkmcnt(0)
  s_barrier
  ds_read_b64_tr_b16 v[192:193], v43 offset:0
  ds_read_b64_tr_b16 v[194:195], v43 offset:2048
  ds_read_b64_tr_b16 v[196:197], v43 offset:4096
  ds_read_b64_tr_b16 v[198:199], v43 offset:6144
  ds_read_b64_tr_b16 v[200:201], v43 offset:8192
  ds_read_b64_tr_b16 v[202:203], v43 offset:10240
  ds_read_b64_tr_b16 v[204:205], v43 offset:12288
  ds_read_b64_tr_b16 v[206:207], v43 offset:14336
  s_waitcnt vmcnt(8) lgkmcnt(0)
  s_barrier
  ds_read_b64_tr_b16 v[208:209], v43 offset:16384
  ds_read_b64_tr_b16 v[210:211], v43 offset:18432
  ds_read_b64_tr_b16 v[212:213], v43 offset:20480
  ds_read_b64_tr_b16 v[214:215], v43 offset:22528
  ds_read_b64_tr_b16 v[216:217], v43 offset:24576
  ds_read_b64_tr_b16 v[218:219], v43 offset:26624
  ds_read_b64_tr_b16 v[220:221], v43 offset:28672
  ds_read_b64_tr_b16 v[222:223], v43 offset:30720
  s_waitcnt vmcnt(4) lgkmcnt(0)
  s_barrier
  ds_read_b64_tr_b16 v[224:225], v43 offset:32768
  ds_read_b64_tr_b16 v[226:227], v43 offset:34816
  ds_read_b64_tr_b16 v[228:229], v43 offset:36864
  ds_read_b64_tr_b16 v[230:231], v43 offset:38912
  ds_read_b64_tr_b16 v[232:233], v43 offset:40960
  ds_read_b64_tr_b16 v[234:235], v43 offset:43008
  ds_read_b64_tr_b16 v[236:237], v43 offset:45056
  ds_read_b64_tr_b16 v[238:239], v43 offset:47104
  s_waitcnt vmcnt(0) lgkmcnt(0)
  s_barrier
  ds_read_b64_tr_b16 v[240:241], v43 offset:49152
  ds_read_b64_tr_b16 v[242:243], v43 offset:51200
  ds_read_b64_tr_b16 v[244:245], v43 offset:53248
  ds_read_b64_tr_b16 v[246:247], v43 offset:55296
  ds_read_b64_tr_b16 v[248:249], v43 offset:57344
  ds_read_b64_tr_b16 v[250:251], v43 offset:59392
  ds_read_b64_tr_b16 v[252:253], v43 offset:61440
  ds_read_b64_tr_b16 v[254:255], v43 offset:63488
  s_waitcnt lgkmcnt(0)
  s_barrier
  v_min_u32 v2, 31, v0
  v_lshlrev_b32 v2, 2, v2
  v_add_u32 v2, 128, v2
  s_nop 1
Lpoll_18:
  buffer_load_dword v3, v2, s[12:15], 0 offen sc1
  s_sub_u32 s24, s24, 1
  s_cbranch_scc1 L_FAIL
  s_waitcnt vmcnt(0)
  v_cmp_gt_i32 vcc, 1, v3
  s_cbranch_vccz Lpolld_19
  s_sleep 2
  s_branch Lpoll_18
Lpolld_19:
  v_min_u32 v2, 7, v0
  v_lshlrev_b32 v2, 2, v2
  v_add_u32 v2, 1388544, v2
  s_lshl_b32 s62, s21, 7
  s_add_u32 s62, s62, 1396736
  s_mov_b32 s27, 2097152
  s_lshr_b32 s40, s21, 1
  s_mul_i32 s40, s40, 24576
  s_add_u32 s31, s40, 58720256
  s_and_b32 s41, s21, 1
  s_lshl_b32 s42, s20, 11
  s_lshl_b32 s40, s41, 13
  s_add_u32 s40, s40, s42
  v_lshl_add_u32 v76, v0, 4, s40
  s_lshl_b32 s40, s41, 10
  s_add_u32 s40, s40, s42
  s_add_u32 s40, s40, 16384
  v_lshl_add_u32 v83, v0, 4, s40
  v_lshrrev_b32 v60, 3, v0
  v_and_b32 v61, 6, v60
  v_xor_b32 v61, v61, v0
  v_and_b32 v61, 7, v61
  v_lshlrev_b32 v61, 4, v61
  v_lshl_add_u32 v1, v60, 11, v61
  s_lshl_b32 s40, s20, 14
  v_add_u32 v1, s40, v1
  s_lshl_b32 s32, s20, 10
  v_and_b32 v60, 6, v0
  v_lshrrev_b32 v61, 4, v0
  v_xor_b32 v60, v60, v61
  v_lshlrev_b32 v60, 4, v60
  v_and_b32 v61, 15, v0
  v_lshl_add_u32 v77, v61, 7, v60
  v_xor_b32 v78, 64, v77
  s_lshl_b32 s40, s20, 2
  s_add_u32 s40, s40, 131072
  v_mov_b32 v79, s40
  v_mov_b32 v60, 0
  ds_write_b32 v79, v60
  s_mov_b32 s25, 0
  s_mov_b32 s26, 0
  s_mov_b32 s29, 1
  s_mov_b32 s30, 0
  s_mov_b32 s28, 1
  s_waitcnt lgkmcnt(0)
  s_barrier
  s_branch L_QKV_poll
L_QKV_top:
  s_cmp_lg_u32 s28, 0
  s_cbranch_scc1 L_QKV_go
  buffer_load_dword v3, v2, s[4:7], s30 offen sc1
  v_mov_b32 v60, s25
  v_and_b32 v61, 3, v0
  v_lshlrev_b32 v61, 2, v61
  v_add_u32 v61, 131072, v61
  s_waitcnt vmcnt(1)
  ds_write_b32 v79, v60
  ds_read_b32 v61, v61
  s_waitcnt lgkmcnt(0)
  v_cmp_gt_i32 vcc, s25, v61
  s_cbranch_vccnz L_QKV_nosig
  s_mov_b32 s63, s25
  s_atomic_smax s63, s[4:5], s62 glc
Lnosig_20:
L_QKV_nosig:
  s_cmp_ge_u32 s25, 64
  s_cbranch_scc1 L_END
  s_waitcnt vmcnt(0)
  v_cmp_gt_i32 vcc, s29, v3
  s_cbranch_vccz L_QKV_issue
L_QKV_poll:
  s_nop 3
Lpoll_21:
  buffer_load_dword v3, v2, s[4:7], s30 offen sc1
  s_sub_u32 s24, s24, 1
  s_cbranch_scc1 L_FAIL
  s_waitcnt vmcnt(0)
  v_cmp_gt_i32 vcc, s29, v3
  s_cbranch_vccz Lpolld_22
  s_sleep 2
  s_branch Lpoll_21
Lpolld_22:
L_QKV_issue:
  s_add_u32 s34, s26, s32
  s_mov_b32 s35, s27
  s_add_u32 m0, s34, 0
  s_nop 0
  buffer_load_dwordx4 v1, s[4:7], s35 offen offset:0 sc1 lds
  s_add_u32 m0, s34, 3968
  s_nop 0
  buffer_load_dwordx4 v1, s[4:7], s35 offen offset:128 sc1 lds
  s_add_u32 m0, s34, 7936
  s_nop 0
  buffer_load_dwordx4 v1, s[4:7], s35 offen offset:256 sc1 lds
  s_add_u32 m0, s34, 11904
  s_nop 0
  buffer_load_dwordx4 v1, s[4:7], s35 offen offset:384 sc1 lds
  s_add_u32 m0, s34, 15872
  s_nop 0
  buffer_load_dwordx4 v1, s[4:7], s35 offen offset:512 sc1 lds
  s_add_u32 m0, s34, 19840
  s_nop 0
  buffer_load_dwordx4 v1, s[4:7], s35 offen offset:640 sc1 lds
  s_add_u32 m0, s34, 23808
  s_nop 0
  buffer_load_dwordx4 v1, s[4:7], s35 offen offset:768 sc1 lds
  s_add_u32 m0, s34, 27776
  s_nop 0
  buffer_load_dwordx4 v1, s[4:7], s35 offen offset:896 sc1 lds
  s_add_u32 m0, s34, 31744
  s_nop 0
  buffer_load_dwordx4 v1, s[4:7], s35 offen offset:1024 sc1 lds
  s_add_u32 m0, s34, 35712
  s_nop 0
  buffer_load_dwordx4 v1, s[4:7], s35 offen offset:1152 sc1 lds
  s_add_u32 m0, s34, 39680
  s_nop 0
  buffer_load_dwordx4 v1, s[4:7], s35 offen offset:1280 sc1 lds
  s_add_u32 m0, s34, 43648
  s_nop 0
  buffer_load_dwordx4 v1, s[4:7], s35 offen offset:1408 sc1 lds
  s_add_u32 m0, s34, 47616
  s_nop 0
  buffer_load_dwordx4 v1, s[4:7], s35 offen offset:1536 sc1 lds
  s_add_u32 m0, s34, 51584
  s_nop 0
  buffer_load_dwordx4 v1, s[4:7], s35 offen offset:1664 sc1 lds
  s_add_u32 m0, s34, 55552
  s_nop 0
  buffer_load_dwordx4 v1, s[4:7], s35 offen offset:1792 sc1 lds
  s_add_u32 m0, s34, 59520
  s_nop 0
  buffer_load_dwordx4 v1, s[4:7], s35 offen offset:1920 sc1 lds
L_QKV_go:
  v_add_u32 v81, s26, v77
  v_add_u32 v82, s26, v78
  s_sub_u32 s26, 65536, s26
  s_add_u32 s27, s27, 65536
  s_add_u32 s34, s26, s32
  s_mov_b32 s35, s27
  s_add_u32 s30, s30, 128
  s_waitcnt vmcnt(12)
  s_barrier
  ds_read_b128 v[4:7], v81 offset:0
  ds_read_b128 v[8:11], v81 offset:2048
  ds_read_b128 v[12:15], v82 offset:0
  ds_read_b128 v[16:19], v82 offset:2048
  ds_read_b128 v[20:23], v81 offset:4096
  ds_read_b128 v[24:27], v81 offset:6144
  buffer_load_dword v3, v2, s[4:7], s30 offen sc1
  s_waitcnt lgkmcnt(4)
  v_mfma_f32_16x16x32_bf16 v[36:39], a[0:3], v[4:7], 0
  ds_read_b128 v[28:31], v82 offset:4096
  v_mfma_f32_16x16x32_bf16 v[40:43], a[0:3], v[8:11], 0
  ds_read_b128 v[32:35], v82 offset:6144
  v_mfma_f32_16x16x32_bf16 v[44:47], a[128:131], v[4:7], 0
  v_mfma_f32_16x16x32_bf16 v[48:51], a[128:131], v[8:11], 0
  v_mfma_f32_16x16x32_bf16 v[52:55], v[4:7], v[128:131], 0
  v_mfma_f32_16x16x32_bf16 v[56:59], v[8:11], v[128:131], 0
  s_waitcnt lgkmcnt(4)
  v_mfma_f32_16x16x32_bf16 v[36:39], a[4:7], v[12:15], v[36:39]
  ds_read_b128 v[4:7], v81 offset:8192
  v_mfma_f32_16x16x32_bf16 v[40:43], a[4:7], v[16:19], v[40:43]
  ds_read_b128 v[8:11], v81 offset:10240
  v_mfma_f32_16x16x32_bf16 v[44:47], a[132:135], v[12:15], v[44:47]
  v_mfma_f32_16x16x32_bf16 v[48:51], a[132:135], v[16:19], v[48:51]
  v_mfma_f32_16x16x32_bf16 v[52:55], v[12:15], v[132:135], v[52:55]
  v_mfma_f32_16x16x32_bf16 v[56:59], v[16:19], v[132:135], v[56:59]
  s_waitcnt lgkmcnt(4)
  v_mfma_f32_16x16x32_bf16 v[36:39], a[8:11], v[20:23], v[36:39]
  ds_read_b128 v[12:15], v82 offset:8192
  v_mfma_f32_16x16x32_bf16 v[40:43], a[8:11], v[24:27], v[40:43]
  ds_read_b128 v[16:19], v82 offset:10240
  v_mfma_f32_16x16x32_bf16 v[44:47], a[136:139], v[20:23], v[44:47]
  v_mfma_f32_16x16x32_bf16 v[48:51], a[136:139], v[24:27], v[48:51]
  v_mfma_f32_16x16x32_bf16 v[52:55], v[20:23], v[136:139], v[52:55]
  v_mfma_f32_16x16x32_bf16 v[56:59], v[24:27], v[136:139], v[56:59]
  s_waitcnt lgkmcnt(4)
  v_mfma_f32_16x16x32_bf16 v[36:39], a[12:15], v[28:31], v[36:39]
  ds_read_b128 v[20:23], v81 offset:12288
  v_mfma_f32_16x16x32_bf16 v[40:43], a[12:15], v[32:35], v[40:43]
  ds_read_b128 v[24:27], v81 offset:14336
  v_mfma_f32_16x16x32_bf16 v[44:47], a[140:143], v[28:31], v[44:47]
  v_mfma_f32_16x16x32_bf16 v[48:51], a[140:143], v[32:35], v[48:51]
  v_mfma_f32_16x16x32_bf16 v[52:55], v[28:31], v[140:143], v[52:55]
  v_mfma_f32_16x16x32_bf16 v[56:59], v[32:35], v[140:143], v[56:59]
  s_waitcnt lgkmcnt(4)
  v_mfma_f32_16x16x32_bf16 v[36:39], a[16:19], v[4:7], v[36:39]
  ds_read_b128 v[28:31], v82 offset:12288
  v_mfma_f32_16x16x32_bf16 v[40:43], a[16:19], v[8:11], v[40:43]
  ds_read_b128 v[32:35], v82 offset:14336
  v_mfma_f32_16x16x32_bf16 v[44:47], a[144:147], v[4:7], v[44:47]
  v_mfma_f32_16x16x32_bf16 v[48:51], a[144:147], v[8:11], v[48:51]
  v_mfma_f32_16x16x32_bf16 v[52:55], v[4:7], v[144:147], v[52:55]
  v_mfma_f32_16x16x32_bf16 v[56:59], v[8:11], v[144:147], v[56:59]
  s_waitcnt vmcnt(9)
  s_barrier
  s_waitcnt lgkmcnt(4)
  v_mfma_f32_16x16x32_bf16 v[36:39], a[20:23], v[12:15], v[36:39]
  ds_read_b128 v[4:7], v81 offset:16384
  v_mfma_f32_16x16x32_bf16 v[40:43], a[20:23], v[16:19], v[40:43]
  ds_read_b128 v[8:11], v81 offset:18432
  v_mfma_f32_16x16x32_bf16 v[44:47], a[148:151], v[12:15], v[44:47]
  v_mfma_f32_16x16x32_bf16 v[48:51], a[148:151], v[16:19], v[48:51]
  v_mfma_f32_16x16x32_bf16 v[52:55], v[12:15], v[148:151], v[52:55]
  v_mfma_f32_16x16x32_bf16 v[56:59], v[16:19], v[148:151], v[56:59]
  s_waitcnt lgkmcnt(4)
  v_mfma_f32_16x16x32_bf16 v[36:39], a[24:27], v[20:23], v[36:39]
  ds_read_b128 v[12:15], v82 offset:16384
  v_mfma_f32_16x16x32_bf16 v[40:43], a[24:27], v[24:27], v[40:43]
  ds_read_b128 v[16:19], v82 offset:18432
  v_mfma_f32_16x16x32_bf16 v[44:47], a[152:155], v[20:23], v[44:47]
  v_mfma_f32_16x16x32_bf16 v[48:51], a[152:155], v[24:27], v[48:51]
  v_mfma_f32_16x16x32_bf16 v[52:55], v[20:23], v[152:155], v[52:55]
  v_mfma_f32_16x16x32_bf16 v[56:59], v[24:27], v[152:155], v[56:59]
  s_waitcnt lgkmcnt(4)
  v_mfma_f32_16x16x32_bf16 v[36:39], a[28:31], v[28:31], v[36:39]
  ds_read_b128 v[20:23], v81 offset:20480
  v_mfma_f32_16x16x32_bf16 v[40:43], a[28:31], v[32:35], v[40:43]
  ds_read_b128 v[24:27], v81 offset:22528
  v_mfma_f32_16x16x32_bf16 v[44:47], a[156:159], v[28:31], v[44:47]
  v_mfma_f32_16x16x32_bf16 v[48:51], a[156:159], v[32:35], v[48:51]
  v_mfma_f32_16x16x32_bf16 v[52:55], v[28:31], v[156:159], v[52:55]
  v_mfma_f32_16x16x32_bf16 v[56:59], v[32:35], v[156:159], v[56:59]
  s_waitcnt lgkmcnt(4)
  v_mfma_f32_16x16x32_bf16 v[36:39], a[32:35], v[4:7], v[36:39]
  ds_read_b128 v[28:31], v82 offset:20480
  v_mfma_f32_16x16x32_bf16 v[40:43], a[32:35], v[8:11], v[40:43]
  ds_read_b128 v[32:35], v82 offset:22528
  v_mfma_f32_16x16x32_bf16 v[44:47], a[160:163], v[4:7], v[44:47]
  v_mfma_f32_16x16x32_bf16 v[48:51], a[160:163], v[8:11], v[48:51]
  v_mfma_f32_16x16x32_bf16 v[52:55], v[4:7], v[160:163], v[52:55]
  v_mfma_f32_16x16x32_bf16 v[56:59], v[8:11], v[160:163], v[56:59]
  s_waitcnt lgkmcnt(4)
  v_mfma_f32_16x16x32_bf16 v[36:39], a[36:39], v[12:15], v[36:39]
  ds_read_b128 v[4:7], v81 offset:24576
  v_mfma_f32_16x16x32_bf16 v[40:43], a[36:39], v[16:19], v[40:43]
  ds_read_b128 v[8:11], v81 offset:26624
  v_mfma_f32_16x16x32_bf16 v[44:47], a[164:167], v[12:15], v[44:47]
  v_mfma_f32_16x16x32_bf16 v[48:51], a[164:167], v[16:19], v[48:51]
  v_mfma_f32_16x16x32_bf16 v[52:55], v[12:15], v[164:167], v[52:55]
  v_mfma_f32_16x16x32_bf16 v[56:59], v[16:19], v[164:167], v[56:59]
  s_waitcnt lgkmcnt(4)
  v_mfma_f32_16x16x32_bf16 v[36:39], a[40:43], v[20:23], v[36:39]
  ds_read_b128 v[12:15], v82 offset:24576
  v_mfma_f32_16x16x32_bf16 v[40:43], a[40:43], v[24:27], v[40:43]
  ds_read_b128 v[16:19], v82 offset:26624
  v_mfma_f32_16x16x32_bf16 v[44:47], a[168:171], v[20:23], v[44:47]
  v_mfma_f32_16x16x32_bf16 v[48:51], a[168:171], v[24:27], v[48:51]
  v_mfma_f32_16x16x32_bf16 v[52:55], v[20:23], v[168:171], v[52:55]
  v_mfma_f32_16x16x32_bf16 v[56:59], v[24:27], v[168:171], v[56:59]
  s_waitcnt lgkmcnt(4)
  v_mfma_f32_16x16x32_bf16 v[36:39], a[44:47], v[28:31], v[36:39]
  ds_read_b128 v[20:23], v81 offset:28672
  v_mfma_f32_16x16x32_bf16 v[40:43], a[44:47], v[32:35], v[40:43]
  ds_read_b128 v[24:27], v81 offset:30720
  v_mfma_f32_16x16x32_bf16 v[44:47], a[172:175], v[28:31], v[44:47]
  v_mfma_f32_16x16x32_bf16 v[48:51], a[172:175], v[32:35], v[48:51]
  v_mfma_f32_16x16x32_bf16 v[52:55], v[28:31], v[172:175], v[52:55]
  v_mfma_f32_16x16x32_bf16 v[56:59], v[32:35], v[172:175], v[56:59]
  s_waitcnt lgkmcnt(4)
  v_mfma_f32_16x16x32_bf16 v[36:39], a[48:51], v[4:7], v[36:39]
  ds_read_b128 v[28:31], v82 offset:28672
  v_mfma_f32_16x16x32_bf16 v[40:43], a[48:51], v[8:11], v[40:43]
  ds_read_b128 v[32:35], v82 offset:30720
  v_mfma_f32_16x16x32_bf16 v[44:47], a[176:179], v[4:7], v[44:47]
  v_mfma_f32_16x16x32_bf16 v[48:51], a[176:179], v[8:11], v[48:51]
  v_mfma_f32_16x16x32_bf16 v[52:55], v[4:7], v[176:179], v[52:55]
  v_mfma_f32_16x16x32_bf16 v[56:59], v[8:11], v[176:179], v[56:59]
  s_waitcnt vmcnt(0)
  s_barrier
  v_cmp_gt_i32 vcc, s29, v3
  s_cmp_eq_u32 s28, 0
  s_cbranch_scc1 L_QKV_s2
  s_mov_b32 s63, s25
  s_atomic_smax s63, s[4:5], s62 glc
Lnosig_23:
L_QKV_s2:
  s_mov_b32 s28, 0
  s_cbranch_vccnz L_QKV_nopf
  s_cmp_ge_u32 s25, 63
  s_cbranch_scc1 L_QKV_nopf
  s_mov_b32 s28, 1
  s_waitcnt lgkmcnt(4)
  v_mfma_f32_16x16x32_bf16 v[36:39], a[52:55], v[12:15], v[36:39]
  ds_read_b128 v[4:7], v81 offset:32768
  v_mfma_f32_16x16x32_bf16 v[40:43], a[52:55], v[16:19], v[40:43]
  ds_read_b128 v[8:11], v81 offset:34816
  v_mfma_f32_16x16x32_bf16 v[44:47], a[180:183], v[12:15], v[44:47]
  s_add_u32 m0, s34, 0
  s_nop 0
  buffer_load_dwordx4 v1, s[4:7], s35 offen offset:0 sc1 lds
  v_mfma_f32_16x16x32_bf16 v[48:51], a[180:183], v[16:19], v[48:51]
  v_mfma_f32_16x16x32_bf16 v[52:55], v[12:15], v[180:183], v[52:55]
  v_mfma_f32_16x16x32_bf16 v[56:59], v[16:19], v[180:183], v[56:59]
  s_waitcnt lgkmcnt(4)
  v_mfma_f32_16x16x32_bf16 v[36:39], a[56:59], v[20:23], v[36:39]
  ds_read_b128 v[12:15], v82 offset:32768
  v_mfma_f32_16x16x32_bf16 v[40:43], a[56:59], v[24:27], v[40:43]
  ds_read_b128 v[16:19], v82 offset:34816
  v_mfma_f32_16x16x32_bf16 v[44:47], a[184:187], v[20:23], v[44:47]
  s_add_u32 m0, s34, 3968
  s_nop 0
  buffer_load_dwordx4 v1, s[4:7], s35 offen offset:128 sc1 lds
  v_mfma_f32_16x16x32_bf16 v[48:51], a[184:187], v[24:27], v[48:51]
  v_mfma_f32_16x16x32_bf16 v[52:55], v[20:23], v[184:187], v[52:55]
  v_mfma_f32_16x16x32_bf16 v[56:59], v[24:27], v[184:187], v[56:59]
  s_waitcnt lgkmcnt(4)
  v_mfma_f32_16x16x32_bf16 v[36:39], a[60:63], v[28:31], v[36:39]
  ds_read_b128 v[20:23], v81 offset:36864
  v_mfma_f32_16x16x32_bf16 v[40:43], a[60:63], v[32:35], v[40:43]
  ds_read_b128 v[24:27], v81 offset:38912
  v_mfma_f32_16x16x32_bf16 v[44:47], a[188:191], v[28:31], v[44:47]
  s_add_u32 m0, s34, 7936
  s_nop 0
  buffer_load_dwordx4 v1, s[4:7], s35 offen offset:256 sc1 lds
  v_mfma_f32_16x16x32_bf16 v[48:51], a[188:191], v[32:35], v[48:51]
  v_mfma_f32_16x16x32_bf16 v[52:55], v[28:31], v[188:191], v[52:55]
  v_mfma_f32_16x16x32_bf16 v[56:59], v[32:35], v[188:191], v[56:59]
  s_waitcnt lgkmcnt(4)
  v_mfma_f32_16x16x32_bf16 v[36:39], a[64:67], v[4:7], v[36:39]
  ds_read_b128 v[28:31], v82 offset:36864
  v_mfma_f32_16x16x32_bf16 v[40:43], a[64:67], v[8:11], v[40:43]
  ds_read_b128 v[32:35], v82 offset:38912
  v_mfma_f32_16x16x32_bf16 v[44:47], a[192:195], v[4:7], v[44:47]
  s_add_u32 m0, s34, 11904
  s_nop 0
  buffer_load_dwordx4 v1, s[4:7], s35 offen offset:384 sc1 lds
  v_mfma_f32_16x16x32_bf16 v[48:51], a[192:195], v[8:11], v[48:51]
  v_mfma_f32_16x16x32_bf16 v[52:55], v[4:7], v[192:195], v[52:55]
  v_mfma_f32_16x16x32_bf16 v[56:59], v[8:11], v[192:195], v[56:59]
  s_waitcnt lgkmcnt(4)
  v_mfma_f32_16x16x32_bf16 v[36:39], a[68:71], v[12:15], v[36:39]
  ds_read_b128 v[4:7], v81 offset:40960
  v_mfma_f32_16x16x32_bf16 v[40:43], a[68:71], v[16:19], v[40:43]
  ds_read_b128 v[8:11], v81 offset:43008
  v_mfma_f32_16x16x32_bf16 v[44:47], a[196:199], v[12:15], v[44:47]
  s_add_u32 m0, s34, 15872
  s_nop 0
  buffer_load_dwordx4 v1, s[4:7], s35 offen offset:512 sc1 lds
  v_mfma_f32_16x16x32_bf16 v[48:51], a[196:199], v[16:19], v[48:51]
  v_mfma_f32_16x16x32_bf16 v[52:55], v[12:15], v[196:199], v[52:55]
  v_mfma_f32_16x16x32_bf16 v[56:59], v[16:19], v[196:199], v[56:59]
  s_waitcnt lgkmcnt(4)
  v_mfma_f32_16x16x32_bf16 v[36:39], a[72:75], v[20:23], v[36:39]
  ds_read_b128 v[12:15], v82 offset:40960
  v_mfma_f32_16x16x32_bf16 v[40:43], a[72:75], v[24:27], v[40:43]
  ds_read_b128 v[16:19], v82 offset:43008
  v_mfma_f32_16x16x32_bf16 v[44:47], a[200:203], v[20:23], v[44:47]
  s_add_u32 m0, s34, 19840
  s_nop 0
  buffer_load_dwordx4 v1, s[4:7], s35 offen offset:640 sc1 lds
  v_mfma_f32_16x16x32_bf16 v[48:51], a[200:203], v[24:27], v[48:51]
  v_mfma_f32_16x16x32_bf16 v[52:55], v[20:23], v[200:203], v[52:55]
  v_mfma_f32_16x16x32_bf16 v[56:59], v[24:27], v[200:203], v[56:59]
  s_waitcnt lgkmcnt(4)
  v_mfma_f32_16x16x32_bf16 v[36:39], a[76:79], v[28:31], v[36:39]
  ds_read_b128 v[20:23], v81 offset:45056
  v_mfma_f32_16x16x32_bf16 v[40:43], a[76:79], v[32:35], v[40:43]
  ds_read_b128 v[24:27], v81 offset:47104
  v_mfma_f32_16x16x32_bf16 v[44:47], a[204:207], v[28:31], v[44:47]
  s_add_u32 m0, s34, 23808
  s_nop 0
  buffer_load_dwordx4 v1, s[4:7], s35 offen offset:768 sc1 lds
  v_mfma_f32_16x16x32_bf16 v[48:51], a[204:207], v[32:35], v[48:51]
  v_mfma_f32_16x16x32_bf16 v[52:55], v[28:31], v[204:207], v[52:55]
  v_mfma_f32_16x16x32_bf16 v[56:59], v[32:35], v[204:207], v[56:59]
  s_waitcnt lgkmcnt(4)
  v_mfma_f32_16x16x32_bf16 v[36:39], a[80:83], v[4:7], v[36:39]
  ds_read_b128 v[28:31], v82 offset:45056
  v_mfma_f32_16x16x32_bf16 v[40:43], a[80:83], v[8:11], v[40:43]
  ds_read_b128 v[32:35], v82 offset:47104
  v_mfma_f32_16x16x32_bf16 v[44:47], a[208:211], v[4:7], v[44:47]
  s_add_u32 m0, s34, 27776
  s_nop 0
  buffer_load_dwordx4 v1, s[4:7], s35 offen offset:896 sc1 lds
  v_mfma_f32_16x16x32_bf16 v[48:51], a[208:211], v[8:11], v[48:51]
  v_mfma_f32_16x16x32_bf16 v[52:55], v[4:7], v[208:211], v[52:55]
  v_mfma_f32_16x16x32_bf16 v[56:59], v[8:11], v[208:211], v[56:59]
  s_waitcnt lgkmcnt(4)
  v_mfma_f32_16x16x32_bf16 v[36:39], a[84:87], v[12:15], v[36:39]
  ds_read_b128 v[4:7], v81 offset:49152
  v_mfma_f32_16x16x32_bf16 v[40:43], a[84:87], v[16:19], v[40:43]
  ds_read_b128 v[8:11], v81 offset:51200
  v_mfma_f32_16x16x32_bf16 v[44:47], a[212:215], v[12:15], v[44:47]
  s_add_u32 m0, s34, 31744
  s_nop 0
  buffer_load_dwordx4 v1, s[4:7], s35 offen offset:1024 sc1 lds
  v_mfma_f32_16x16x32_bf16 v[48:51], a[212:215], v[16:19], v[48:51]
  v_mfma_f32_16x16x32_bf16 v[52:55], v[12:15], v[212:215], v[52:55]
  v_mfma_f32_16x16x32_bf16 v[56:59], v[16:19], v[212:215], v[56:59]
  s_waitcnt lgkmcnt(4)
  v_mfma_f32_16x16x32_bf16 v[36:39], a[88:91], v[20:23], v[36:39]
  ds_read_b128 v[12:15], v82 offset:49152
  v_mfma_f32_16x16x32_bf16 v[40:43], a[88:91], v[24:27], v[40:43]
  ds_read_b128 v[16:19], v82 offset:51200
  v_mfma_f32_16x16x32_bf16 v[44:47], a[216:219], v[20:23], v[44:47]
  s_add_u32 m0, s34, 35712
  s_nop 0
  buffer_load_dwordx4 v1, s[4:7], s35 offen offset:1152 sc1 lds
  v_mfma_f32_16x16x32_bf16 v[48:51], a[216:219], v[24:27], v[48:51]
  v_mfma_f32_16x16x32_bf16 v[52:55], v[20:23], v[216:219], v[52:55]
  v_mfma_f32_16x16x32_bf16 v[56:59], v[24:27], v[216:219], v[56:59]
  s_waitcnt lgkmcnt(4)
  v_mfma_f32_16x16x32_bf16 v[36:39], a[92:95], v[28:31], v[36:39]
  ds_read_b128 v[20:23], v81 offset:53248
  v_mfma_f32_16x16x32_bf16 v[40:43], a[92:95], v[32:35], v[40:43]
  ds_read_b128 v[24:27], v81 offset:55296
  v_mfma_f32_16x16x32_bf16 v[44:47], a[220:223], v[28:31], v[44:47]
  s_add_u32 m0, s34, 39680
  s_nop 0
  buffer_load_dwordx4 v1, s[4:7], s35 offen offset:1280 sc1 lds
  v_mfma_f32_16x16x32_bf16 v[48:51], a[220:223], v[32:35], v[48:51]
  v_mfma_f32_16x16x32_bf16 v[52:55], v[28:31], v[220:223], v[52:55]
  v_mfma_f32_16x16x32_bf16 v[56:59], v[32:35], v[220:223], v[56:59]
  s_waitcnt lgkmcnt(4)
  v_mfma_f32_16x16x32_bf16 v[36:39], a[96:99], v[4:7], v[36:39]
  ds_read_b128 v[28:31], v82 offset:53248
  v_mfma_f32_16x16x32_bf16 v[40:43], a[96:99], v[8:11], v[40:43]
  ds_read_b128 v[32:35], v82 offset:55296
  v_mfma_f32_16x16x32_bf16 v[44:47], a[224:227], v[4:7], v[44:47]
  s_add_u32 m0, s34, 43648
  s_nop 0
  buffer_load_dwordx4 v1, s[4:7], s35 offen offset:1408 sc1 lds
  v_mfma_f32_16x16x32_bf16 v[48:51], a[224:227], v[8:11], v[48:51]
  v_mfma_f32_16x16x32_bf16 v[52:55], v[4:7], v[224:227], v[52:55]
  v_mfma_f32_16x16x32_bf16 v[56:59], v[8:11], v[224:227], v[56:59]
  s_waitcnt lgkmcnt(4)
  v_mfma_f32_16x16x32_bf16 v[36:39], a[100:103], v[12:15], v[36:39]
  ds_read_b128 v[4:7], v81 offset:57344
  v_mfma_f32_16x16x32_bf16 v[40:43], a[100:103], v[16:19], v[40:43]
  ds_read_b128 v[8:11], v81 offset:59392
  v_mfma_f32_16x16x32_bf16 v[44:47], a[228:231], v[12:15], v[44:47]
  s_add_u32 m0, s34, 47616
  s_nop 0
  buffer_load_dwordx4 v1, s[4:7], s35 offen offset:1536 sc1 lds
  v_mfma_f32_16x16x32_bf16 v[48:51], a[228:231], v[16:19], v[48:51]
  v_mfma_f32_16x16x32_bf16 v[52:55], v[12:15], v[228:231], v[52:55]
  v_mfma_f32_16x16x32_bf16 v[56:59], v[16:19], v[228:231], v[56:59]
  s_waitcnt lgkmcnt(4)
  v_mfma_f32_16x16x32_bf16 v[36:39], a[104:107], v[20:23], v[36:39]
  ds_read_b128 v[12:15], v82 offset:57344
  v_mfma_f32_16x16x32_bf16 v[40:43], a[104:107], v[24:27], v[40:43]
  ds_read_b128 v[16:19], v82 offset:59392
  v_mfma_f32_16x16x32_bf16 v[44:47], a[232:235], v[20:23], v[44:47]
  s_add_u32 m0, s34, 51584
  s_nop 0
  buffer_load_dwordx4 v1, s[4:7], s35 offen offset:1664 sc1 lds
  v_mfma_f32_16x16x32_bf16 v[48:51], a[232:235], v[24:27], v[48:51]
  v_mfma_f32_16x16x32_bf16 v[52:55], v[20:23], v[232:235], v[52:55]
  v_mfma_f32_16x16x32_bf16 v[56:59], v[24:27], v[232:235], v[56:59]
  s_waitcnt lgkmcnt(4)
  v_mfma_f32_16x16x32_bf16 v[36:39], a[108:111], v[28:31], v[36:39]
  ds_read_b128 v[20:23], v81 offset:61440
  v_mfma_f32_16x16x32_bf16 v[40:43], a[108:111], v[32:35], v[40:43]
  ds_read_b128 v[24:27], v81 offset:63488
  v_mfma_f32_16x16x32_bf16 v[44:47], a[236:239], v[28:31], v[44:47]
  s_add_u32 m0, s34, 55552
  s_nop 0
  buffer_load_dwordx4 v1, s[4:7], s35 offen offset:1792 sc1 lds
  v_mfma_f32_16x16x32_bf16 v[48:51], a[236:239], v[32:35], v[48:51]
  v_mfma_f32_16x16x32_bf16 v[52:55], v[28:31], v[236:239], v[52:55]
  v_mfma_f32_16x16x32_bf16 v[56:59], v[32:35], v[236:239], v[56:59]
  s_waitcnt lgkmcnt(4)
  v_mfma_f32_16x16x32_bf16 v[36:39], a[112:115], v[4:7], v[36:39]
  ds_read_b128 v[28:31], v82 offset:61440
  v_mfma_f32_16x16x32_bf16 v[40:43], a[112:115], v[8:11], v[40:43]
  ds_read_b128 v[32:35], v82 offset:63488
  v_mfma_f32_16x16x32_bf16 v[44:47], a[240:243], v[4:7], v[44:47]
  s_add_u32 m0, s34, 59520
  s_nop 0
  buffer_load_dwordx4 v1, s[4:7], s35 offen offset:1920 sc1 lds
  v_mfma_f32_16x16x32_bf16 v[48:51], a[240:243], v[8:11], v[48:51]
  v_mfma_f32_16x16x32_bf16 v[52:55], v[4:7], v[240:243], v[52:55]
  v_mfma_f32_16x16x32_bf16 v[56:59], v[8:11], v[240:243], v[56:59]
  s_waitcnt lgkmcnt(4)
  v_mfma_f32_16x16x32_bf16 v[36:39], a[116:119], v[12:15], v[36:39]
  v_mfma_f32_16x16x32_bf16 v[40:43], a[116:119], v[16:19], v[40:43]
  v_mfma_f32_16x16x32_bf16 v[44:47], a[244:247], v[12:15], v[44:47]
  v_mfma_f32_16x16x32_bf16 v[48:51], a[244:247], v[16:19], v[48:51]
  v_mfma_f32_16x16x32_bf16 v[52:55], v[12:15], v[244:247], v[52:55]
  v_mfma_f32_16x16x32_bf16 v[56:59], v[16:19], v[244:247], v[56:59]
  s_waitcnt lgkmcnt(2)
  v_mfma_f32_16x16x32_bf16 v[36:39], a[120:123], v[20:23], v[36:39]
  v_mfma_f32_16x16x32_bf16 v[40:43], a[120:123], v[24:27], v[40:43]
  v_mfma_f32_16x16x32_bf16 v[44:47], a[248:251], v[20:23], v[44:47]
  v_mfma_f32_16x16x32_bf16 v[48:51], a[248:251], v[24:27], v[48:51]
  v_mfma_f32_16x16x32_bf16 v[52:55], v[20:23], v[248:251], v[52:55]
  v_mfma_f32_16x16x32_bf16 v[56:59], v[24:27], v[248:251], v[56:59]
  s_waitcnt lgkmcnt(0)
  v_mfma_f32_16x16x32_bf16 v[36:39], a[124:127], v[28:31], v[36:39]
  v_mfma_f32_16x16x32_bf16 v[40:43], a[124:127], v[32:35], v[40:43]
  v_mfma_f32_16x16x32_bf16 v[44:47], a[252:255], v[28:31], v[44:47]
  v_mfma_f32_16x16x32_bf16 v[48:51], a[252:255], v[32:35], v[48:51]
  v_mfma_f32_16x16x32_bf16 v[52:55], v[28:31], v[252:255], v[52:55]
  v_mfma_f32_16x16x32_bf16 v[56:59], v[32:35], v[252:255], v[56:59]
  s_nop 7
  s_branch L_QKV_epi
L_QKV_nopf:
  s_waitcnt lgkmcnt(4)
  v_mfma_f32_16x16x32_bf16 v[36:39], a[52:55], v[12:15], v[36:39]
  ds_read_b128 v[4:7], v81 offset:32768
  v_mfma_f32_16x16x32_bf16 v[40:43], a[52:55], v[16:19], v[40:43]
  ds_read_b128 v[8:11], v81 offset:34816
  v_mfma_f32_16x16x32_bf16 v[44:47], a[180:183], v[12:15], v[44:47]
  v_mfma_f32_16x16x32_bf16 v[48:51], a[180:183], v[16:19], v[48:51]
  v_mfma_f32_16x16x32_bf16 v[52:55], v[12:15], v[180:183], v[52:55]
  v_mfma_f32_16x16x32_bf16 v[56:59], v[16:19], v[180:183], v[56:59]
  s_waitcnt lgkmcnt(4)
  v_mfma_f32_16x16x32_bf16 v[36:39], a[56:59], v[20:23], v[36:39]
  ds_read_b128 v[12:15], v82 offset:32768
  v_mfma_f32_16x16x32_bf16 v[40:43], a[56:59], v[24:27], v[40:43]
  ds_read_b128 v[16:19], v82 offset:34816
  v_mfma_f32_16x16x32_bf16 v[44:47], a[184:187], v[20:23], v[44:47]
  v_mfma_f32_16x16x32_bf16 v[48:51], a[184:187], v[24:27], v[48:51]
  v_mfma_f32_16x16x32_bf16 v[52:55], v[20:23], v[184:187], v[52:55]
  v_mfma_f32_16x16x32_bf16 v[56:59], v[24:27], v[184:187], v[56:59]
  s_waitcnt lgkmcnt(4)
  v_mfma_f32_16x16x32_bf16 v[36:39], a[60:63], v[28:31], v[36:39]
  ds_read_b128 v[20:23], v81 offset:36864
  v_mfma_f32_16x16x32_bf16 v[40:43], a[60:63], v[32:35], v[40:43]
  ds_read_b128 v[24:27], v81 offset:38912
  v_mfma_f32_16x16x32_bf16 v[44:47], a[188:191], v[28:31], v[44:47]
  v_mfma_f32_16x16x32_bf16 v[48:51], a[188:191], v[32:35], v[48:51]
  v_mfma_f32_16x16x32_bf16 v[52:55], v[28:31], v[188:191], v[52:55]
  v_mfma_f32_16x16x32_bf16 v[56:59], v[32:35], v[188:191], v[56:59]
  s_waitcnt lgkmcnt(4)
  v_mfma_f32_16x16x32_bf16 v[36:39], a[64:67], v[4:7], v[36:39]
  ds_read_b128 v[28:31], v82 offset:36864
  v_mfma_f32_16x16x32_bf16 v[40:43], a[64:67], v[8:11], v[40:43]
  ds_read_b128 v[32:35], v82 offset:38912
  v_mfma_f32_16x16x32_bf16 v[44:47], a[192:195], v[4:7], v[44:47]
  v_mfma_f32_16x16x32_bf16 v[48:51], a[192:195], v[8:11], v[48:51]
  v_mfma_f32_16x16x32_bf16 v[52:55], v[4:7], v[192:195], v[52:55]
  v_mfma_f32_16x16x32_bf16 v[56:59], v[8:11], v[192:195], v[56:59]
  s_waitcnt lgkmcnt(4)
  v_mfma_f32_16x16x32_bf16 v[36:39], a[68:71], v[12:15], v[36:39]
  ds_read_b128 v[4:7], v81 offset:40960
  v_mfma_f32_16x16x32_bf16 v[40:43], a[68:71], v[16:19], v[40:43]
  ds_read_b128 v[8:11], v81 offset:43008
  v_mfma_f32_16x16x32_bf16 v[44:47], a[196:199], v[12:15], v[44:47]
  v_mfma_f32_16x16x32_bf16 v[48:51], a[196:199], v[16:19], v[48:51]
  v_mfma_f32_16x16x32_bf16 v[52:55], v[12:15], v[196:199], v[52:55]
  v_mfma_f32_16x16x32_bf16 v[56:59], v[16:19], v[196:199], v[56:59]
  s_waitcnt lgkmcnt(4)
  v_mfma_f32_16x16x32_bf16 v[36:39], a[72:75], v[20:23], v[36:39]
  ds_read_b128 v[12:15], v82 offset:40960
  v_mfma_f32_16x16x32_bf16 v[40:43], a[72:75], v[24:27], v[40:43]
  ds_read_b128 v[16:19], v82 offset:43008
  v_mfma_f32_16x16x32_bf16 v[44:47], a[200:203], v[20:23], v[44:47]
  v_mfma_f32_16x16x32_bf16 v[48:51], a[200:203], v[24:27], v[48:51]
  v_mfma_f32_16x16x32_bf16 v[52:55], v[20:23], v[200:203], v[52:55]
  v_mfma_f32_16x16x32_bf16 v[56:59], v[24:27], v[200:203], v[56:59]
  s_waitcnt lgkmcnt(4)
  v_mfma_f32_16x16x32_bf16 v[36:39], a[76:79], v[28:31], v[36:39]
  ds_read_b128 v[20:23], v81 offset:45056
  v_mfma_f32_16x16x32_bf16 v[40:43], a[76:79], v[32:35], v[40:43]
  ds_read_b128 v[24:27], v81 offset:47104
  v_mfma_f32_16x16x32_bf16 v[44:47], a[204:207], v[28:31], v[44:47]
  v_mfma_f32_16x16x32_bf16 v[48:51], a[204:207], v[32:35], v[48:51]
  v_mfma_f32_16x16x32_bf16 v[52:55], v[28:31], v[204:207], v[52:55]
  v_mfma_f32_16x16x32_bf16 v[56:59], v[32:35], v[204:207], v[56:59]
  s_waitcnt lgkmcnt(4)
  v_mfma_f32_16x16x32_bf16 v[36:39], a[80:83], v[4:7], v[36:39]
  ds_read_b128 v[28:31], v82 offset:45056
  v_mfma_f32_16x16x32_bf16 v[40:43], a[80:83], v[8:11], v[40:43]
  ds_read_b128 v[32:35], v82 offset:47104
  v_mfma_f32_16x16x32_bf16 v[44:47], a[208:211], v[4:7], v[44:47]
  v_mfma_f32_16x16x32_bf16 v[48:51], a[208:211], v[8:11], v[48:51]
  v_mfma_f32_16x16x32_bf16 v[52:55], v[4:7], v[208:211], v[52:55]
  v_mfma_f32_16x16x32_bf16 v[56:59], v[8:11], v[208:211], v[56:59]
  s_waitcnt lgkmcnt(4)
  v_mfma_f32_16x16x32_bf16 v[36:39], a[84:87], v[12:15], v[36:39]
  ds_read_b128 v[4:7], v81 offset:49152
  v_mfma_f32_16x16x32_bf16 v[40:43], a[84:87], v[16:19], v[40:43]
  ds_read_b128 v[8:11], v81 offset:51200
  v_mfma_f32_16x16x32_bf16 v[44:47], a[212:215], v[12:15], v[44:47]
  v_mfma_f32_16x16x32_bf16 v[48:51], a[212:215], v[16:19], v[48:51]
  v_mfma_f32_16x16x32_bf16 v[52:55], v[12:15], v[212:215], v[52:55]
  v_mfma_f32_16x16x32_bf16 v[56:59], v[16:19], v[212:215], v[56:59]
  s_waitcnt lgkmcnt(4)
  v_mfma_f32_16x16x32_bf16 v[36:39], a[88:91], v[20:23], v[36:39]
  ds_read_b128 v[12:15], v82 offset:49152
  v_mfma_f32_16x16x32_bf16 v[40:43], a[88:91], v[24:27], v[40:43]
  ds_read_b128 v[16:19], v82 offset:51200
  v_mfma_f32_16x16x32_bf16 v[44:47], a[216:219], v[20:23], v[44:47]
  v_mfma_f32_16x16x32_bf16 v[48:51], a[216:219], v[24:27], v[48:51]
  v_mfma_f32_16x16x32_bf16 v[52:55], v[20:23], v[216:219], v[52:55]
  v_mfma_f32_16x16x32_bf16 v[56:59], v[24:27], v[216:219], v[56:59]
  s_waitcnt lgkmcnt(4)
  v_mfma_f32_16x16x32_bf16 v[36:39], a[92:95], v[28:31], v[36:39]
  ds_read_b128 v[20:23], v81 offset:53248
  v_mfma_f32_16x16x32_bf16 v[40:43], a[92:95], v[32:35], v[40:43]
  ds_read_b128 v[24:27], v81 offset:55296
  v_mfma_f32_16x16x32_bf16 v[44:47], a[220:223], v[28:31], v[44:47]
  v_mfma_f32_16x16x32_bf16 v[48:51], a[220:223], v[32:35], v[48:51]
  v_mfma_f32_16x16x32_bf16 v[52:55], v[28:31], v[220:223], v[52:55]
  v_mfma_f32_16x16x32_bf16 v[56:59], v[32:35], v[220:223], v[56:59]
  s_waitcnt lgkmcnt(4)
  v_mfma_f32_16x16x32_bf16 v[36:39], a[96:99], v[4:7], v[36:39]
  ds_read_b128 v[28:31], v82 offset:53248
  v_mfma_f32_16x16x32_bf16 v[40:43], a[96:99], v[8:11], v[40:43]
  ds_read_b128 v[32:35], v82 offset:55296
  v_mfma_f32_16x16x32_bf16 v[44:47], a[224:227], v[4:7], v[44:47]
  v_mfma_f32_16x16x32_bf16 v[48:51], a[224:227], v[8:11], v[48:51]
  v_mfma_f32_16x16x32_bf16 v[52:55], v[4:7], v[224:227], v[52:55]
  v_mfma_f32_16x16x32_bf16 v[56:59], v[8:11], v[224:227], v[56:59]
  s_waitcnt lgkmcnt(4)
  v_mfma_f32_16x16x32_bf16 v[36:39], a[100:103], v[12:15], v[36:39]
  ds_read_b128 v[4:7], v81 offset:57344
  v_mfma_f32_16x16x32_bf16 v[40:43], a[100:103], v[16:19], v[40:43]
  ds_read_b128 v[8:11], v81 offset:59392
  v_mfma_f32_16x16x32_bf16 v[44:47], a[228:231], v[12:15], v[44:47]
  v_mfma_f32_16x16x32_bf16 v[48:51], a[228:231], v[16:19], v[48:51]
  v_mfma_f32_16x16x32_bf16 v[52:55], v[12:15], v[228:231], v[52:55]
  v_mfma_f32_16x16x32_bf16 v[56:59], v[16:19], v[228:231], v[56:59]
  s_waitcnt lgkmcnt(4)
  v_mfma_f32_16x16x32_bf16 v[36:39], a[104:107], v[20:23], v[36:39]
  ds_read_b128 v[12:15], v82 offset:57344
  v_mfma_f32_16x16x32_bf16 v[40:43], a[104:107], v[24:27], v[40:43]
  ds_read_b128 v[16:19], v82 offset:59392
  v_mfma_f32_16x16x32_bf16 v[44:47], a[232:235], v[20:23], v[44:47]
  v_mfma_f32_16x16x32_bf16 v[48:51], a[232:235], v[24:27], v[48:51]
  v_mfma_f32_16x16x32_bf16 v[52:55], v[20:23], v[232:235], v[52:55]
  v_mfma_f32_16x16x32_bf16 v[56:59], v[24:27], v[232:235], v[56:59]
  s_waitcnt lgkmcnt(4)
  v_mfma_f32_16x16x32_bf16 v[36:39], a[108:111], v[28:31], v[36:39]
  ds_read_b128 v[20:23], v81 offset:61440
  v_mfma_f32_16x16x32_bf16 v[40:43], a[108:111], v[32:35], v[40:43]
  ds_read_b128 v[24:27], v81 offset:63488
  v_mfma_f32_16x16x32_bf16 v[44:47], a[236:239], v[28:31], v[44:47]
  v_mfma_f32_16x16x32_bf16 v[48:51], a[236:239], v[32:35], v[48:51]
  v_mfma_f32_16x16x32_bf16 v[52:55], v[28:31], v[236:239], v[52:55]
  v_mfma_f32_16x16x32_bf16 v[56:59], v[32:35], v[236:239], v[56:59]
  s_waitcnt lgkmcnt(4)
  v_mfma_f32_16x16x32_bf16 v[36:39], a[112:115], v[4:7], v[36:39]
  ds_read_b128 v[28:31], v82 offset:61440
  v_mfma_f32_16x16x32_bf16 v[40:43], a[112:115], v[8:11], v[40:43]
  ds_read_b128 v[32:35], v82 offset:63488
  v_mfma_f32_16x16x32_bf16 v[44:47], a[240:243], v[4:7], v[44:47]
  v_mfma_f32_16x16x32_bf16 v[48:51], a[240:243], v[8:11], v[48:51]
  v_mfma_f32_16x16x32_bf16 v[52:55], v[4:7], v[240:243], v[52:55]
  v_mfma_f32_16x16x32_bf16 v[56:59], v[8:11], v[240:243], v[56:59]
  s_waitcnt lgkmcnt(4)
  v_mfma_f32_16x16x32_bf16 v[36:39], a[116:119], v[12:15], v[36:39]
  v_mfma_f32_16x16x32_bf16 v[40:43], a[116:119], v[16:19], v[40:43]
  v_mfma_f32_16x16x32_bf16 v[44:47], a[244:247], v[12:15], v[44:47]
  v_mfma_f32_16x16x32_bf16 v[48:51], a[244:247], v[16:19], v[48:51]
  v_mfma_f32_16x16x32_bf16 v[52:55], v[12:15], v[244:247], v[52:55]
  v_mfma_f32_16x16x32_bf16 v[56:59], v[16:19], v[244:247], v[56:59]
  s_waitcnt lgkmcnt(2)
  v_mfma_f32_16x16x32_bf16 v[36:39], a[120:123], v[20:23], v[36:39]
  v_mfma_f32_16x16x32_bf16 v[40:43], a[120:123], v[24:27], v[40:43]
  v_mfma_f32_16x16x32_bf16 v[44:47], a[248:251], v[20:23], v[44:47]
  v_mfma_f32_16x16x32_bf16 v[48:51], a[248:251], v[24:27], v[48:51]
  v_mfma_f32_16x16x32_bf16 v[52:55], v[20:23], v[248:251], v[52:55]
  v_mfma_f32_16x16x32_bf16 v[56:59], v[24:27], v[248:251], v[56:59]
  s_waitcnt lgkmcnt(0)
  v_mfma_f32_16x16x32_bf16 v[36:39], a[124:127], v[28:31], v[36:39]
  v_mfma_f32_16x16x32_bf16 v[40:43], a[124:127], v[32:35], v[40:43]
  v_mfma_f32_16x16x32_bf16 v[44:47], a[252:255], v[28:31], v[44:47]
  v_mfma_f32_16x16x32_bf16 v[48:51], a[252:255], v[32:35], v[48:51]
  v_mfma_f32_16x16x32_bf16 v[52:55], v[28:31], v[252:255], v[52:55]
  v_mfma_f32_16x16x32_bf16 v[56:59], v[32:35], v[252:255], v[56:59]
L_QKV_epi:
  s_nop 2
  v_cvt_pk_bf16_f32 v60, v36, v37
  v_cvt_pk_bf16_f32 v61, v38, v39
  v_cvt_pk_bf16_f32 v62, v44, v45
  v_cvt_pk_bf16_f32 v63, v46, v47
  buffer_store_dwordx4 v[60:63], v76, s[4:7], s31 offen offset:0 sc1
  v_cvt_pk_bf16_f32 v64, v40, v41
  v_cvt_pk_bf16_f32 v65, v42, v43
  v_cvt_pk_bf16_f32 v66, v48, v49
  v_cvt_pk_bf16_f32 v67, v50, v51
  buffer_store_dwordx4 v[64:67], v76, s[4:7], s31 offen offset:1024 sc1
  v_cvt_pk_bf16_f32 v68, v52, v53
  v_cvt_pk_bf16_f32 v69, v54, v55
  v_cvt_pk_bf16_f32 v70, v56, v57
  v_cvt_pk_bf16_f32 v71, v58, v59
  buffer_store_dwordx4 v[68:71], v83, s[4:7], s31 offen sc1
  s_add_u32 s25, s25, 1
  s_add_u32 s31, s31, 786432
  s_branch L_QKV_top
L_WO:
  s_load_dwordx2 s[8:9], s[0:1], 40
  s_mov_b32 s10, 8388608
  s_mov_b32 s11, 0x20000
  s_waitcnt lgkmcnt(0)
  s_lshr_b32 s44, s21, 3
  s_mul_i32 s44, s44, 2097152
  s_and_b32 s45, s21, 7
  s_lshl_b32 s45, s45, 8
  s_add_u32 s44, s44, s45
  s_add_u32 s45, s44, 128
  v_bfe_u32 v40, v0, 5, 1
  v_mul_u32_u24 v40, 8192, v40
  v_bfe_u32 v41, v0, 4, 1
  v_mul_u32_u24 v41, 4096, v41
  v_add_u32 v40, v40, v41
  v_bfe_u32 v41, v0, 3, 1
  v_mul_u32_u24 v41, 2048, v41
  v_add_u32 v40, v40, v41
  v_lshrrev_b32 v41, 3, v0
  v_and_b32 v41, 6, v41
  v_xor_b32 v41, v41, v0
  v_and_b32 v41, 7, v41
  v_lshl_add_u32 v40, v41, 4, v40
  s_lshr_b32 s40, s20, 1
  s_mul_i32 s40, s40, 131072
  s_and_b32 s41, s20, 1
  s_mul_i32 s41, s41, 16384
  s_add_u32 s40, s40, s41
  v_add_u32 v40, s40, v40
  v_bfe_u32 v41, v0, 3, 2
  v_xor_b32 v41, s20, v41
  v_lshlrev_b32 v41, 5, v41
  v_lshrrev_b32 v42, 2, v0
  v_lshl_add_u32 v42, v42, 7, v41
  v_and_b32 v41, 3, v0
  v_lshl_add_u32 v42, v41, 3, v42
  v_add_u32 v43, 0x10000, v42
  v_add_u32 v44, s44, v40
  v_add_u32 v45, s45, v40
  s_lshl_b32 s41, s20, 10
  s_add_u32 m0, s41, 0
  s_mov_b32 s42, 0
  buffer_load_dwordx4 v44, s[8:11], s42 offen lds
  s_add_u32 m0, s41, 4096
  s_mov_b32 s42, 32768
  buffer_load_dwordx4 v44, s[8:11], s42 offen lds
  s_add_u32 m0, s41, 8192
  s_mov_b32 s42, 65536
  buffer_load_dwordx4 v44, s[8:11], s42 offen lds
  s_add_u32 m0, s41, 12288
  s_mov_b32 s42, 98304
  buffer_load_dwordx4 v44, s[8:11], s42 offen lds
  s_add_u32 m0, s41, 16384
  s_mov_b32 s42, 262144
  buffer_load_dwordx4 v44, s[8:11], s42 offen lds
  s_add_u32 m0, s41, 20480
  s_mov_b32 s42, 294912
  buffer_load_dwordx4 v44, s[8:11], s42 offen lds
  s_add_u32 m0, s41, 24576
  s_mov_b32 s42, 327680
  buffer_load_dwordx4 v44, s[8:11], s42 offen lds
  s_add_u32 m0, s41, 28672
  s_mov_b32 s42, 360448
  buffer_load_dwordx4 v44, s[8:11], s42 offen lds
  s_add_u32 m0, s41, 32768
  s_mov_b32 s42, 524288
  buffer_load_dwordx4 v44, s[8:11], s42 offen lds
  s_add_u32 m0, s41, 36864
  s_mov_b32 s42, 557056
  buffer_load_dwordx4 v44, s[8:11], s42 offen lds
  s_add_u32 m0, s41, 40960
  s_mov_b32 s42, 589824
  buffer_load_dwordx4 v44, s[8:11], s42 offen lds
  s_add_u32 m0, s41, 45056
  s_mov_b32 s42, 622592
  buffer_load_dwordx4 v44, s[8:11], s42 offen lds
  s_add_u32 m0, s41, 49152
  s_mov_b32 s42, 786432
  buffer_load_dwordx4 v44, s[8:11], s42 offen lds
  s_add_u32 m0, s41, 53248
  s_mov_b32 s42, 819200
  buffer_load_dwordx4 v44, s[8:11], s42 offen lds
  s_add_u32 m0, s41, 57344
  s_mov_b32 s42, 851968
  buffer_load_dwordx4 v44, s[8:11], s42 offen lds
  s_add_u32 m0, s41, 61440
  s_mov_b32 s42, 884736
  buffer_load_dwordx4 v44, s[8:11], s42 offen lds
  s_add_u32 m0, s41, 65536
  s_mov_b32 s42, 1048576
  buffer_load_dwordx4 v44, s[8:11], s42 offen lds
  s_add_u32 m0, s41, 69632
  s_mov_b32 s42, 1081344
  buffer_load_dwordx4 v44, s[8:11], s42 offen lds
  s_add_u32 m0, s41, 73728
  s_mov_b32 s42, 1114112
  buffer_load_dwordx4 v44, s[8:11], s42 offen lds
  s_add_u32 m0, s41, 77824
  s_mov_b32 s42, 1146880
  buffer_load_dwordx4 v44, s[8:11], s42 offen lds
  s_add_u32 m0, s41, 81920
  s_mov_b32 s42, 1310720
  buffer_load_dwordx4 v44, s[8:11], s42 offen lds
  s_add_u32 m0, s41, 86016
  s_mov_b32 s42, 1343488
  buffer_load_dwordx4 v44, s[8:11], s42 offen lds
  s_add_u32 m0, s41, 90112
  s_mov_b32 s42, 1376256
  buffer_load_dwordx4 v44, s[8:11], s42 offen lds
  s_add_u32 m0, s41, 94208
  s_mov_b32 s42, 1409024
  buffer_load_dwordx4 v44, s[8:11], s42 offen lds
  s_add_u32 m0, s41, 98304
  s_mov_b32 s42, 1572864
  buffer_load_dwordx4 v44, s[8:11], s42 offen lds
  s_add_u32 m0, s41, 102400
  s_mov_b32 s42, 1605632
  buffer_load_dwordx4 v44, s[8:11], s42 offen lds
  s_add_u32 m0, s41, 106496
  s_mov_b32 s42, 1638400
  buffer_load_dwordx4 v44, s[8:11], s42 offen lds
  s_add_u32 m0, s41, 110592
  s_mov_b32 s42, 1671168
  buffer_load_dwordx4 v44, s[8:11], s42 offen lds
  s_waitcnt vmcnt(24) lgkmcnt(0)
  s_barrier
  s_add_u32 m0, s41, 114688
  s_mov_b32 s42, 1835008
  buffer_load_dwordx4 v44, s[8:11], s42 offen lds
  s_add_u32 m0, s41, 118784
  s_mov_b32 s42, 1867776
  buffer_load_dwordx4 v44, s[8:11], s42 offen lds
  s_add_u32 m0, s41, 122880
  s_mov_b32 s42, 1900544
  buffer_load_dwordx4 v44, s[8:11], s42 offen lds
  s_add_u32 m0, s41, 126976
  s_mov_b32 s42, 1933312
  buffer_load_dwordx4 v44, s[8:11], s42 offen lds
  ds_read_b64_tr_b16 a[0:1], v42 offset:0
  ds_read_b64_tr_b16 a[2:3], v42 offset:2048
  ds_read_b64_tr_b16 a[4:5], v42 offset:4096
  ds_read_b64_tr_b16 a[6:7], v42 offset:6144
  ds_read_b64_tr_b16 a[8:9], v42 offset:8192
  ds_read_b64_tr_b16 a[10:11], v42 offset:10240
  ds_read_b64_tr_b16 a[12:13], v42 offset:12288
  ds_read_b64_tr_b16 a[14:15], v42 offset:14336
  s_waitcnt vmcnt(24) lgkmcnt(0)
  s_barrier
  s_add_u32 m0, s41, 0
  s_mov_b32 s42, 0
  buffer_load_dwordx4 v45, s[8:11], s42 offen lds
  s_add_u32 m0, s41, 4096
  s_mov_b32 s42, 32768
  buffer_load_dwordx4 v45, s[8:11], s42 offen lds
  s_add_u32 m0, s41, 8192
  s_mov_b32 s42, 65536
  buffer_load_dwordx4 v45, s[8:11], s42 offen lds
  s_add_u32 m0, s41, 12288
  s_mov_b32 s42, 98304
  buffer_load_dwordx4 v45, s[8:11], s42 offen lds
  ds_read_b64_tr_b16 a[16:17], v42 offset:16384
  ds_read_b64_tr_b16 a[18:19], v42 offset:18432
  ds_read_b64_tr_b16 a[20:21], v42 offset:20480
  ds_read_b64_tr_b16 a[22:23], v42 offset:22528
  ds_read_b64_tr_b16 a[24:25], v42 offset:24576
  ds_read_b64_tr_b16 a[26:27], v42 offset:26624
  ds_read_b64_tr_b16 a[28:29], v42 offset:28672
  ds_read_b64_tr_b16 a[30:31], v42 offset:30720
  s_waitcnt vmcnt(24) lgkmcnt(0)
  s_barrier
  s_add_u32 m0, s41, 16384
  s_mov_b32 s42, 262144
  buffer_load_dwordx4 v45, s[8:11], s42 offen lds
  s_add_u32 m0, s41, 20480
  s_mov_b32 s42, 294912
  buffer_load_dwordx4 v45, s[8:11], s42 offen lds
  s_add_u32 m0, s41, 24576
  s_mov_b32 s42, 327680
  buffer_load_dwordx4 v45, s[8:11], s42 offen lds
  s_add_u32 m0, s41, 28672
  s_mov_b32 s42, 360448
  buffer_load_dwordx4 v45, s[8:11], s42 offen lds
  ds_read_b64_tr_b16 a[32:33], v42 offset:32768
  ds_read_b64_tr_b16 a[34:35], v42 offset:34816
  ds_read_b64_tr_b16 a[36:37], v42 offset:36864
  ds_read_b64_tr_b16 a[38:39], v42 offset:38912
  ds_read_b64_tr_b16 a[40:41], v42 offset:40960
  ds_read_b64_tr_b16 a[42:43], v42 offset:43008
  ds_read_b64_tr_b16 a[44:45], v42 offset:45056
  ds_read_b64_tr_b16 a[46:47], v42 offset:47104
  s_waitcnt vmcnt(24) lgkmcnt(0)
  s_barrier
  s_add_u32 m0, s41, 32768
  s_mov_b32 s42, 524288
  buffer_load_dwordx4 v45, s[8:11], s42 offen lds
  s_add_u32 m0, s41, 36864
  s_mov_b32 s42, 557056
  buffer_load_dwordx4 v45, s[8:11], s42 offen lds
  s_add_u32 m0, s41, 40960
  s_mov_b32 s42, 589824
  buffer_load_dwordx4 v45, s[8:11], s42 offen lds
  s_add_u32 m0, s41, 45056
  s_mov_b32 s42, 622592
  buffer_load_dwordx4 v45, s[8:11], s42 offen lds
  ds_read_b64_tr_b16 a[48:49], v42 offset:49152
  ds_read_b64_tr_b16 a[50:51], v42 offset:51200
  ds_read_b64_tr_b16 a[52:53], v42 offset:53248
  ds_read_b64_tr_b16 a[54:55], v42 offset:55296
  ds_read_b64_tr_b16 a[56:57], v42 offset:57344
  ds_read_b64_tr_b16 a[58:59], v42 offset:59392
  ds_read_b64_tr_b16 a[60:61], v42 offset:61440
  ds_read_b64_tr_b16 a[62:63], v42 offset:63488
  s_waitcnt vmcnt(24) lgkmcnt(0)
  s_barrier
  s_add_u32 m0, s41, 49152
  s_mov_b32 s42, 786432
  buffer_load_dwordx4 v45, s[8:11], s42 offen lds
  s_add_u32 m0, s41, 53248
  s_mov_b32 s42, 819200
  buffer_load_dwordx4 v45, s[8:11], s42 offen lds
  s_add_u32 m0, s41, 57344
  s_mov_b32 s42, 851968
  buffer_load_dwordx4 v45, s[8:11], s42 offen lds
  s_add_u32 m0, s41, 61440
  s_mov_b32 s42, 884736
  buffer_load_dwordx4 v45, s[8:11], s42 offen lds
  ds_read_b64_tr_b16 a[64:65], v43 offset:0
  ds_read_b64_tr_b16 a[66:67], v43 offset:2048
  ds_read_b64_tr_b16 a[68:69], v43 offset:4096
  ds_read_b64_tr_b16 a[70:71], v43 offset:6144
  ds_read_b64_tr_b16 a[72:73], v43 offset:8192
  ds_read_b64_tr_b16 a[74:75], v43 offset:10240
  ds_read_b64_tr_b16 a[76:77], v43 offset:12288
  ds_read_b64_tr_b16 a[78:79], v43 offset:14336
  s_waitcnt vmcnt(24) lgkmcnt(0)
  s_barrier
  s_add_u32 m0, s41, 65536
  s_mov_b32 s42, 1048576
  buffer_load_dwordx4 v45, s[8:11], s42 offen lds
  s_add_u32 m0, s41, 69632
  s_mov_b32 s42, 1081344
  buffer_load_dwordx4 v45, s[8:11], s42 offen lds
  s_add_u32 m0, s41, 73728
  s_mov_b32 s42, 1114112
  buffer_load_dwordx4 v45, s[8:11], s42 offen lds
  s_add_u32 m0, s41, 77824
  s_mov_b32 s42, 1146880
  buffer_load_dwordx4 v45, s[8:11], s42 offen lds
  ds_read_b64_tr_b16 a[80:81], v43 offset:16384
  ds_read_b64_tr_b16 a[82:83], v43 offset:18432
  ds_read_b64_tr_b16 a[84:85], v43 offset:20480
  ds_read_b64_tr_b16 a[86:87], v43 offset:22528
  ds_read_b64_tr_b16 a[88:89], v43 offset:24576
  ds_read_b64_tr_b16 a[90:91], v43 offset:26624
  ds_read_b64_tr_b16 a[92:93], v43 offset:28672
  ds_read_b64_tr_b16 a[94:95], v43 offset:30720
  s_waitcnt vmcnt(24) lgkmcnt(0)
  s_barrier
  s_add_u32 m0, s41, 81920
  s_mov_b32 s42, 1310720
  buffer_load_dwordx4 v45, s[8:11], s42 offen lds
  s_add_u32 m0, s41, 86016
  s_mov_b32 s42, 1343488
  buffer_load_dwordx4 v45, s[8:11], s42 offen lds
  s_add_u32 m0, s41, 90112
  s_mov_b32 s42, 1376256
  buffer_load_dwordx4 v45, s[8:11], s42 offen lds
  s_add_u32 m0, s41, 94208
  s_mov_b32 s42, 1409024
  buffer_load_dwordx4 v45, s[8:11], s42 offen lds
  ds_read_b64_tr_b16 a[96:97], v43 offset:32768
  ds_read_b64_tr_b16 a[98:99], v43 offset:34816
  ds_read_b64_tr_b16 a[100:101], v43 offset:36864
  ds_read_b64_tr_b16 a[102:103], v43 offset:38912
  ds_read_b64_tr_b16 a[104:105], v43 offset:40960
  ds_read_b64_tr_b16 a[106:107], v43 offset:43008
  ds_read_b64_tr_b16 a[108:109], v43 offset:45056
  ds_read_b64_tr_b16 a[110:111], v43 offset:47104
  s_waitcnt vmcnt(24) lgkmcnt(0)
  s_barrier
  s_add_u32 m0, s41, 98304
  s_mov_b32 s42, 1572864
  buffer_load_dwordx4 v45, s[8:11], s42 offen lds
  s_add_u32 m0, s41, 102400
  s_mov_b32 s42, 1605632
  buffer_load_dwordx4 v45, s[8:11], s42 offen lds
  s_add_u32 m0, s41, 106496
  s_mov_b32 s42, 1638400
  buffer_load_dwordx4 v45, s[8:11], s42 offen lds
  s_add_u32 m0, s41, 110592
  s_mov_b32 s42, 1671168
  buffer_load_dwordx4 v45, s[8:11], s42 offen lds
  ds_read_b64_tr_b16 a[112:113], v43 offset:49152
  ds_read_b64_tr_b16 a[114:115], v43 offset:51200
  ds_read_b64_tr_b16 a[116:117], v43 offset:53248
  ds_read_b64_tr_b16 a[118:119], v43 offset:55296
  ds_read_b64_tr_b16 a[120:121], v43 offset:57344
  ds_read_b64_tr_b16 a[122:123], v43 offset:59392
  ds_read_b64_tr_b16 a[124:125], v43 offset:61440
  ds_read_b64_tr_b16 a[126:127], v43 offset:63488
  s_waitcnt vmcnt(24) lgkmcnt(0)
  s_barrier
  s_add_u32 m0, s41, 114688
  s_mov_b32 s42, 1835008
  buffer_load_dwordx4 v45, s[8:11], s42 offen lds
  s_add_u32 m0, s41, 118784
  s_mov_b32 s42, 1867776
  buffer_load_dwordx4 v45, s[8:11], s42 offen lds
  s_add_u32 m0, s41, 122880
  s_mov_b32 s42, 1900544
  buffer_load_dwordx4 v45, s[8:11], s42 offen lds
  s_add_u32 m0, s41, 126976
  s_mov_b32 s42, 1933312
  buffer_load_dwordx4 v45, s[8:11], s42 offen lds
  ds_read_b64_tr_b16 a[128:129], v42 offset:0
  ds_read_b64_tr_b16 a[130:131], v42 offset:2048
  ds_read_b64_tr_b16 a[132:133], v42 offset:4096
  ds_read_b64_tr_b16 a[134:135], v42 offset:6144
  ds_read_b64_tr_b16 a[136:137], v42 offset:8192
  ds_read_b64_tr_b16 a[138:139], v42 offset:10240
  ds_read_b64_tr_b16 a[140:141], v42 offset:12288
  ds_read_b64_tr_b16 a[142:143], v42 offset:14336
  s_waitcnt vmcnt(24) lgkmcnt(0)
  s_barrier
  ds_read_b64_tr_b16 a[144:145], v42 offset:16384
  ds_read_b64_tr_b16 a[146:147], v42 offset:18432
  ds_read_b64_tr_b16 a[148:149], v42 offset:20480
  ds_read_b64_tr_b16 a[150:151], v42 offset:22528
  ds_read_b64_tr_b16 a[152:153], v42 offset:24576
  ds_read_b64_tr_b16 a[154:155], v42 offset:26624
  ds_read_b64_tr_b16 a[156:157], v42 offset:28672
  ds_read_b64_tr_b16 a[158:159], v42 offset:30720
  s_waitcnt vmcnt(20) lgkmcnt(0)
  s_barrier
  ds_read_b64_tr_b16 a[160:161], v42 offset:32768
  ds_read_b64_tr_b16 a[162:163], v42 offset:34816
  ds_read_b64_tr_b16 a[164:165], v42 offset:36864
  ds_read_b64_tr_b16 a[166:167], v42 offset:38912
  ds_read_b64_tr_b16 a[168:169], v42 offset:40960
  ds_read_b64_tr_b16 a[170:171], v42 offset:43008
  ds_read_b64_tr_b16 a[172:173], v42 offset:45056
  ds_read_b64_tr_b16 a[174:175], v42 offset:47104
  s_waitcnt vmcnt(16) lgkmcnt(0)
  s_barrier
  ds_read_b64_tr_b16 a[176:177], v42 offset:49152
  ds_read_b64_tr_b16 a[178:179], v42 offset:51200
  ds_read_b64_tr_b16 a[180:181], v42 offset:53248
  ds_read_b64_tr_b16 a[182:183], v42 offset:55296
  ds_read_b64_tr_b16 a[184:185], v42 offset:57344
  ds_read_b64_tr_b16 a[186:187], v42 offset:59392
  ds_read_b64_tr_b16 a[188:189], v42 offset:61440
  ds_read_b64_tr_b16 a[190:191], v42 offset:63488
  s_waitcnt vmcnt(12) lgkmcnt(0)
  s_barrier
  ds_read_b64_tr_b16 a[192:193], v43 offset:0
  ds_read_b64_tr_b16 a[194:195], v43 offset:2048
  ds_read_b64_tr_b16 a[196:197], v43 offset:4096
  ds_read_b64_tr_b16 a[198:199], v43 offset:6144
  ds_read_b64_tr_b16 a[200:201], v43 offset:8192
  ds_read_b64_tr_b16 a[202:203], v43 offset:10240
  ds_read_b64_tr_b16 a[204:205], v43 offset:12288
  ds_read_b64_tr_b16 a[206:207], v43 offset:14336
  s_waitcnt vmcnt(8) lgkmcnt(0)
  s_barrier
  ds_read_b64_tr_b16 a[208:209], v43 offset:16384
  ds_read_b64_tr_b16 a[210:211], v43 offset:18432
  ds_read_b64_tr_b16 a[212:213], v43 offset:20480
  ds_read_b64_tr_b16 a[214:215], v43 offset:22528
  ds_read_b64_tr_b16 a[216:217], v43 offset:24576
  ds_read_b64_tr_b16 a[218:219], v43 offset:26624
  ds_read_b64_tr_b16 a[220:221], v43 offset:28672
  ds_read_b64_tr_b16 a[222:223], v43 offset:30720
  s_waitcnt vmcnt(4) lgkmcnt(0)
  s_barrier
  ds_read_b64_tr_b16 a[224:225], v43 offset:32768
  ds_read_b64_tr_b16 a[226:227], v43 offset:34816
  ds_read_b64_tr_b16 a[228:229], v43 offset:36864
  ds_read_b64_tr_b16 a[230:231], v43 offset:38912
  ds_read_b64_tr_b16 a[232:233], v43 offset:40960
  ds_read_b64_tr_b16 a[234:235], v43 offset:43008
  ds_read_b64_tr_b16 a[236:237], v43 offset:45056
  ds_read_b64_tr_b16 a[238:239], v43 offset:47104
  s_waitcnt vmcnt(0) lgkmcnt(0)
  s_barrier
  ds_read_b64_tr_b16 a[240:241], v43 offset:49152
  ds_read_b64_tr_b16 a[242:243], v43 offset:51200
  ds_read_b64_tr_b16 a[244:245], v43 offset:53248
  ds_read_b64_tr_b16 a[246:247], v43 offset:55296
  ds_read_b64_tr_b16 a[248:249], v43 offset:57344
  ds_read_b64_tr_b16 a[250:251], v43 offset:59392
  ds_read_b64_tr_b16 a[252:253], v43 offset:61440
  ds_read_b64_tr_b16 a[254:255], v43 offset:63488
  s_waitcnt lgkmcnt(0)
  s_barrier
  s_and_b32 s43, s21, 24
  v_min_u32 v2, 7, v0
  v_add_u32 v2, s43, v2
  v_lshlrev_b32 v2, 7, v2
  v_add_u32 v2, 1404928, v2
  s_lshl_b32 s62, s21, 7
  s_add_u32 s62, s62, 1409024
  s_lshl_b32 s40, s43, 13
  s_add_u32 s27, s40, 27262976
  s_lshl_b32 s40, s21, 13
  s_add_u32 s31, s40, 109051904
  s_lshl_b32 s40, s20, 11
  v_lshl_add_u32 v68, v0, 4, s40
  v_lshlrev_b32 v1, 4, v0
  s_lshl_b32 s32, s20, 12
  s_mul_i32 s33, s20, 3072
  v_mov_b32 v69, v1
  v_add_u32 v70, 0x10000, v69
  s_lshl_b32 s40, s20, 2
  s_add_u32 s40, s40, 131072
  v_mov_b32 v71, s40
  v_mov_b32 v52, 0
  ds_write_b32 v71, v52
  s_mov_b32 s25, 0
  s_mov_b32 s26, 0
  s_mov_b32 s29, 1
  s_mov_b32 s30, 0
  s_mov_b32 s28, 1
  s_waitcnt lgkmcnt(0)
  s_barrier
  s_branch L_WO_poll
L_WO_top:
  s_cmp_lg_u32 s28, 0
  s_cbranch_scc1 L_WO_go
  buffer_load_dword v3, v2, s[4:7], s30 offen sc1
  v_mov_b32 v52, s25
  v_and_b32 v53, 3, v0
  v_lshlrev_b32 v53, 2, v53
  v_add_u32 v53, 131072, v53
  s_waitcnt vmcnt(1)
  ds_write_b32 v71, v52
  ds_read_b32 v53, v53
  s_waitcnt lgkmcnt(0)
  v_cmp_gt_i32 vcc, s25, v53
  s_cbranch_vccnz L_WO_nosig
  s_mov_b32 s63, s25
  s_atomic_smax s63, s[4:5], s62 glc
Lnosig_24:
L_WO_nosig:
  s_cmp_ge_u32 s25, 64
  s_cbranch_scc1 L_END
  s_waitcnt vmcnt(0)
  v_cmp_gt_i32 vcc, s29, v3
  s_cbranch_vccz L_WO_issue
L_WO_poll:
  s_nop 3
Lpoll_25:
  buffer_load_dword v3, v2, s[4:7], s30 offen sc1
  s_sub_u32 s24, s24, 1
  s_cbranch_scc1 L_FAIL
  s_waitcnt vmcnt(0)
  v_cmp_gt_i32 vcc, s29, v3
  s_cbranch_vccz Lpolld_26
  s_sleep 2
  s_branch Lpoll_25
Lpolld_26:
L_WO_issue:
  s_mov_b32 s34, s26
  s_mov_b32 s35, s27
  s_add_u32 s36, s32, 0
  s_add_u32 m0, s34, s36
  s_add_u32 s36, s35, s36
  buffer_load_dwordx4 v1, s[4:7], s36 offen offset:0 sc1 lds
  buffer_load_dwordx4 v1, s[4:7], s36 offen offset:1024 sc1 lds
  buffer_load_dwordx4 v1, s[4:7], s36 offen offset:2048 sc1 lds
  buffer_load_dwordx4 v1, s[4:7], s36 offen offset:3072 sc1 lds
  s_add_u32 s36, s32, 16384
  s_add_u32 m0, s34, s36
  s_add_u32 s36, s35, s36
  buffer_load_dwordx4 v1, s[4:7], s36 offen offset:0 sc1 lds
  buffer_load_dwordx4 v1, s[4:7], s36 offen offset:1024 sc1 lds
  buffer_load_dwordx4 v1, s[4:7], s36 offen offset:2048 sc1 lds
  buffer_load_dwordx4 v1, s[4:7], s36 offen offset:3072 sc1 lds
  s_add_u32 s36, s32, 32768
  s_add_u32 m0, s34, s36
  s_add_u32 s36, s35, s36
  buffer_load_dwordx4 v1, s[4:7], s36 offen offset:0 sc1 lds
  buffer_load_dwordx4 v1, s[4:7], s36 offen offset:1024 sc1 lds
  buffer_load_dwordx4 v1, s[4:7], s36 offen offset:2048 sc1 lds
  buffer_load_dwordx4 v1, s[4:7], s36 offen offset:3072 sc1 lds
  s_add_u32 s36, s32, 49152
  s_add_u32 m0, s34, s36
  s_add_u32 s36, s35, s36
  buffer_load_dwordx4 v1, s[4:7], s36 offen offset:0 sc1 lds
  buffer_load_dwordx4 v1, s[4:7], s36 offen offset:1024 sc1 lds
  buffer_load_dwordx4 v1, s[4:7], s36 offen offset:2048 sc1 lds
  buffer_load_dwordx4 v1, s[4:7], s36 offen offset:3072 sc1 lds
L_WO_go:
  v_add_u32 v73, s26, v69
  v_add_u32 v74, s26, v70
  s_sub_u32 s26, 65536, s26
  s_add_u32 s27, s27, 262144
  s_mov_b32 s34, s26
  s_mov_b32 s35, s27
  s_add_u32 s29, s29, 1
  s_waitcnt vmcnt(12)
  s_barrier
  ds_read_b128 v[4:7], v73 offset:0
  ds_read_b128 v[8:11], v73 offset:1024
  ds_read_b128 v[12:15], v73 offset:2048
  ds_read_b128 v[16:19], v73 offset:3072
  ds_read_b128 v[20:23], v73 offset:4096
  ds_read_b128 v[24:27], v73 offset:5120
  buffer_load_dword v3, v2, s[4:7], s30 offen sc1
  s_waitcnt lgkmcnt(4)
  v_mfma_f32_16x16x32_bf16 v[36:39], a[0:3], v[4:7], 0
  ds_read_b128 v[28:31], v73 offset:6144
  v_mfma_f32_16x16x32_bf16 v[40:43], a[0:3], v[8:11], 0
  ds_read_b128 v[32:35], v73 offset:7168
  v_mfma_f32_16x16x32_bf16 v[44:47], a[128:131], v[4:7], 0
  v_mfma_f32_16x16x32_bf16 v[48:51], a[128:131], v[8:11], 0
  s_waitcnt lgkmcnt(4)
  v_mfma_f32_16x16x32_bf16 v[36:39], a[4:7], v[12:15], v[36:39]
  ds_read_b128 v[4:7], v73 offset:8192
  v_mfma_f32_16x16x32_bf16 v[40:43], a[4:7], v[16:19], v[40:43]
  ds_read_b128 v[8:11], v73 offset:9216
  v_mfma_f32_16x16x32_bf16 v[44:47], a[132:135], v[12:15], v[44:47]
  v_mfma_f32_16x16x32_bf16 v[48:51], a[132:135], v[16:19], v[48:51]
  s_waitcnt lgkmcnt(4)
  v_mfma_f32_16x16x32_bf16 v[36:39], a[8:11], v[20:23], v[36:39]
  ds_read_b128 v[12:15], v73 offset:10240
  v_mfma_f32_16x16x32_bf16 v[40:43], a[8:11], v[24:27], v[40:43]
  ds_read_b128 v[16:19], v73 offset:11264
  v_mfma_f32_16x16x32_bf16 v[44:47], a[136:139], v[20:23], v[44:47]
  v_mfma_f32_16x16x32_bf16 v[48:51], a[136:139], v[24:27], v[48:51]
  s_waitcnt lgkmcnt(4)
  v_mfma_f32_16x16x32_bf16 v[36:39], a[12:15], v[28:31], v[36:39]
  ds_read_b128 v[20:23], v73 offset:12288
  v_mfma_f32_16x16x32_bf16 v[40:43], a[12:15], v[32:35], v[40:43]
  ds_read_b128 v[24:27], v73 offset:13312
  v_mfma_f32_16x16x32_bf16 v[44:47], a[140:143], v[28:31], v[44:47]
  v_mfma_f32_16x16x32_bf16 v[48:51], a[140:143], v[32:35], v[48:51]
  s_waitcnt lgkmcnt(4)
  v_mfma_f32_16x16x32_bf16 v[36:39], a[16:19], v[4:7], v[36:39]
  ds_read_b128 v[28:31], v73 offset:14336
  v_mfma_f32_16x16x32_bf16 v[40:43], a[16:19], v[8:11], v[40:43]
  ds_read_b128 v[32:35], v73 offset:15360
  v_mfma_f32_16x16x32_bf16 v[44:47], a[144:147], v[4:7], v[44:47]
  v_mfma_f32_16x16x32_bf16 v[48:51], a[144:147], v[8:11], v[48:51]
  s_waitcnt vmcnt(9)
  s_barrier
  s_waitcnt lgkmcnt(4)
  v_mfma_f32_16x16x32_bf16 v[36:39], a[20:23], v[12:15], v[36:39]
  ds_read_b128 v[4:7], v73 offset:16384
  v_mfma_f32_16x16x32_bf16 v[40:43], a[20:23], v[16:19], v[40:43]
  ds_read_b128 v[8:11], v73 offset:17408
  v_mfma_f32_16x16x32_bf16 v[44:47], a[148:151], v[12:15], v[44:47]
  v_mfma_f32_16x16x32_bf16 v[48:51], a[148:151], v[16:19], v[48:51]
  s_waitcnt lgkmcnt(4)
  v_mfma_f32_16x16x32_bf16 v[36:39], a[24:27], v[20:23], v[36:39]
  ds_read_b128 v[12:15], v73 offset:18432
  v_mfma_f32_16x16x32_bf16 v[40:43], a[24:27], v[24:27], v[40:43]
  ds_read_b128 v[16:19], v73 offset:19456
  v_mfma_f32_16x16x32_bf16 v[44:47], a[152:155], v[20:23], v[44:47]
  v_mfma_f32_16x16x32_bf16 v[48:51], a[152:155], v[24:27], v[48:51]
  s_waitcnt lgkmcnt(4)
  v_mfma_f32_16x16x32_bf16 v[36:39], a[28:31], v[28:31], v[36:39]
  ds_read_b128 v[20:23], v73 offset:20480
  v_mfma_f32_16x16x32_bf16 v[40:43], a[28:31], v[32:35], v[40:43]
  ds_read_b128 v[24:27], v73 offset:21504
  v_mfma_f32_16x16x32_bf16 v[44:47], a[156:159], v[28:31], v[44:47]
  v_mfma_f32_16x16x32_bf16 v[48:51], a[156:159], v[32:35], v[48:51]
  s_waitcnt lgkmcnt(4)
  v_mfma_f32_16x16x32_bf16 v[36:39], a[32:35], v[4:7], v[36:39]
  ds_read_b128 v[28:31], v73 offset:22528
  v_mfma_f32_16x16x32_bf16 v[40:43], a[32:35], v[8:11], v[40:43]
  ds_read_b128 v[32:35], v73 offset:23552
  v_mfma_f32_16x16x32_bf16 v[44:47], a[160:163], v[4:7], v[44:47]
  v_mfma_f32_16x16x32_bf16 v[48:51], a[160:163], v[8:11], v[48:51]
  s_waitcnt lgkmcnt(4)
  v_mfma_f32_16x16x32_bf16 v[36:39], a[36:39], v[12:15], v[36:39]
  ds_read_b128 v[4:7], v73 offset:24576
  v_mfma_f32_16x16x32_bf16 v[40:43], a[36:39], v[16:19], v[40:43]
  ds_read_b128 v[8:11], v73 offset:25600
  v_mfma_f32_16x16x32_bf16 v[44:47], a[164:167], v[12:15], v[44:47]
  v_mfma_f32_16x16x32_bf16 v[48:51], a[164:167], v[16:19], v[48:51]
  s_waitcnt lgkmcnt(4)
  v_mfma_f32_16x16x32_bf16 v[36:39], a[40:43], v[20:23], v[36:39]
  ds_read_b128 v[12:15], v73 offset:26624
  v_mfma_f32_16x16x32_bf16 v[40:43], a[40:43], v[24:27], v[40:43]
  ds_read_b128 v[16:19], v73 offset:27648
  v_mfma_f32_16x16x32_bf16 v[44:47], a[168:171], v[20:23], v[44:47]
  v_mfma_f32_16x16x32_bf16 v[48:51], a[168:171], v[24:27], v[48:51]
  s_waitcnt lgkmcnt(4)
  v_mfma_f32_16x16x32_bf16 v[36:39], a[44:47], v[28:31], v[36:39]
  ds_read_b128 v[20:23], v73 offset:28672
  v_mfma_f32_16x16x32_bf16 v[40:43], a[44:47], v[32:35], v[40:43]
  ds_read_b128 v[24:27], v73 offset:29696
  v_mfma_f32_16x16x32_bf16 v[44:47], a[172:175], v[28:31], v[44:47]
  v_mfma_f32_16x16x32_bf16 v[48:51], a[172:175], v[32:35], v[48:51]
  s_waitcnt lgkmcnt(4)
  v_mfma_f32_16x16x32_bf16 v[36:39], a[48:51], v[4:7], v[36:39]
  ds_read_b128 v[28:31], v73 offset:30720
  v_mfma_f32_16x16x32_bf16 v[40:43], a[48:51], v[8:11], v[40:43]
  ds_read_b128 v[32:35], v73 offset:31744
  v_mfma_f32_16x16x32_bf16 v[44:47], a[176:179], v[4:7], v[44:47]
  v_mfma_f32_16x16x32_bf16 v[48:51], a[176:179], v[8:11], v[48:51]
  s_waitcnt vmcnt(0)
  s_barrier
  v_cmp_gt_i32 vcc, s29, v3
  s_cmp_eq_u32 s28, 0
  s_cbranch_scc1 L_WO_s2
  s_mov_b32 s63, s25
  s_atomic_smax s63, s[4:5], s62 glc
Lnosig_27:
L_WO_s2:
  s_mov_b32 s28, 0
  s_cbranch_vccnz L_WO_nopf
  s_cmp_ge_u32 s25, 63
  s_cbranch_scc1 L_WO_nopf
  s_mov_b32 s28, 1
  s_waitcnt lgkmcnt(4)
  v_mfma_f32_16x16x32_bf16 v[36:39], a[52:55], v[12:15], v[36:39]
  ds_read_b128 v[4:7], v73 offset:32768
  v_mfma_f32_16x16x32_bf16 v[40:43], a[52:55], v[16:19], v[40:43]
  ds_read_b128 v[8:11], v73 offset:33792
  v_mfma_f32_16x16x32_bf16 v[44:47], a[180:183], v[12:15], v[44:47]
  s_add_u32 s36, s32, 0
  s_add_u32 m0, s34, s36
  s_add_u32 s36, s35, s36
  buffer_load_dwordx4 v1, s[4:7], s36 offen offset:0 sc1 lds
  v_mfma_f32_16x16x32_bf16 v[48:51], a[180:183], v[16:19], v[48:51]
  s_waitcnt lgkmcnt(4)
  v_mfma_f32_16x16x32_bf16 v[36:39], a[56:59], v[20:23], v[36:39]
  ds_read_b128 v[12:15], v73 offset:34816
  v_mfma_f32_16x16x32_bf16 v[40:43], a[56:59], v[24:27], v[40:43]
  ds_read_b128 v[16:19], v73 offset:35840
  v_mfma_f32_16x16x32_bf16 v[44:47], a[184:187], v[20:23], v[44:47]
  buffer_load_dwordx4 v1, s[4:7], s36 offen offset:1024 sc1 lds
  v_mfma_f32_16x16x32_bf16 v[48:51], a[184:187], v[24:27], v[48:51]
  s_waitcnt lgkmcnt(4)
  v_mfma_f32_16x16x32_bf16 v[36:39], a[60:63], v[28:31], v[36:39]
  ds_read_b128 v[20:23], v73 offset:36864
  v_mfma_f32_16x16x32_bf16 v[40:43], a[60:63], v[32:35], v[40:43]
  ds_read_b128 v[24:27], v73 offset:37888
  v_mfma_f32_16x16x32_bf16 v[44:47], a[188:191], v[28:31], v[44:47]
  buffer_load_dwordx4 v1, s[4:7], s36 offen offset:2048 sc1 lds
  v_mfma_f32_16x16x32_bf16 v[48:51], a[188:191], v[32:35], v[48:51]
  s_waitcnt lgkmcnt(4)
  v_mfma_f32_16x16x32_bf16 v[36:39], a[64:67], v[4:7], v[36:39]
  ds_read_b128 v[28:31], v73 offset:38912
  v_mfma_f32_16x16x32_bf16 v[40:43], a[64:67], v[8:11], v[40:43]
  ds_read_b128 v[32:35], v73 offset:39936
  v_mfma_f32_16x16x32_bf16 v[44:47], a[192:195], v[4:7], v[44:47]
  buffer_load_dwordx4 v1, s[4:7], s36 offen offset:3072 sc1 lds
  v_mfma_f32_16x16x32_bf16 v[48:51], a[192:195], v[8:11], v[48:51]
  s_waitcnt lgkmcnt(4)
  v_mfma_f32_16x16x32_bf16 v[36:39], a[68:71], v[12:15], v[36:39]
  ds_read_b128 v[4:7], v73 offset:40960
  v_mfma_f32_16x16x32_bf16 v[40:43], a[68:71], v[16:19], v[40:43]
  ds_read_b128 v[8:11], v73 offset:41984
  v_mfma_f32_16x16x32_bf16 v[44:47], a[196:199], v[12:15], v[44:47]
  s_add_u32 s36, s32, 16384
  s_add_u32 m0, s34, s36
  s_add_u32 s36, s35, s36
  buffer_load_dwordx4 v1, s[4:7], s36 offen offset:0 sc1 lds
  v_mfma_f32_16x16x32_bf16 v[48:51], a[196:199], v[16:19], v[48:51]
  s_waitcnt lgkmcnt(4)
  v_mfma_f32_16x16x32_bf16 v[36:39], a[72:75], v[20:23], v[36:39]
  ds_read_b128 v[12:15], v73 offset:43008
  v_mfma_f32_16x16x32_bf16 v[40:43], a[72:75], v[24:27], v[40:43]
  ds_read_b128 v[16:19], v73 offset:44032
  v_mfma_f32_16x16x32_bf16 v[44:47], a[200:203], v[20:23], v[44:47]
  buffer_load_dwordx4 v1, s[4:7], s36 offen offset:1024 sc1 lds
  v_mfma_f32_16x16x32_bf16 v[48:51], a[200:203], v[24:27], v[48:51]
  s_waitcnt lgkmcnt(4)
  v_mfma_f32_16x16x32_bf16 v[36:39], a[76:79], v[28:31], v[36:39]
  ds_read_b128 v[20:23], v73 offset:45056
  v_mfma_f32_16x16x32_bf16 v[40:43], a[76:79], v[32:35], v[40:43]
  ds_read_b128 v[24:27], v73 offset:46080
  v_mfma_f32_16x16x32_bf16 v[44:47], a[204:207], v[28:31], v[44:47]
  buffer_load_dwordx4 v1, s[4:7], s36 offen offset:2048 sc1 lds
  v_mfma_f32_16x16x32_bf16 v[48:51], a[204:207], v[32:35], v[48:51]
  s_waitcnt lgkmcnt(4)
  v_mfma_f32_16x16x32_bf16 v[36:39], a[80:83], v[4:7], v[36:39]
  ds_read_b128 v[28:31], v73 offset:47104
  v_mfma_f32_16x16x32_bf16 v[40:43], a[80:83], v[8:11], v[40:43]
  ds_read_b128 v[32:35], v73 offset:48128
  v_mfma_f32_16x16x32_bf16 v[44:47], a[208:211], v[4:7], v[44:47]
  buffer_load_dwordx4 v1, s[4:7], s36 offen offset:3072 sc1 lds
  v_mfma_f32_16x16x32_bf16 v[48:51], a[208:211], v[8:11], v[48:51]
  s_waitcnt lgkmcnt(4)
  v_mfma_f32_16x16x32_bf16 v[36:39], a[84:87], v[12:15], v[36:39]
  ds_read_b128 v[4:7], v73 offset:49152
  v_mfma_f32_16x16x32_bf16 v[40:43], a[84:87], v[16:19], v[40:43]
  ds_read_b128 v[8:11], v73 offset:50176
  v_mfma_f32_16x16x32_bf16 v[44:47], a[212:215], v[12:15], v[44:47]
  s_add_u32 s36, s32, 32768
  s_add_u32 m0, s34, s36
  s_add_u32 s36, s35, s36
  buffer_load_dwordx4 v1, s[4:7], s36 offen offset:0 sc1 lds
  v_mfma_f32_16x16x32_bf16 v[48:51], a[212:215], v[16:19], v[48:51]
  s_waitcnt lgkmcnt(4)
  v_mfma_f32_16x16x32_bf16 v[36:39], a[88:91], v[20:23], v[36:39]
  ds_read_b128 v[12:15], v73 offset:51200
  v_mfma_f32_16x16x32_bf16 v[40:43], a[88:91], v[24:27], v[40:43]
  ds_read_b128 v[16:19], v73 offset:52224
  v_mfma_f32_16x16x32_bf16 v[44:47], a[216:219], v[20:23], v[44:47]
  buffer_load_dwordx4 v1, s[4:7], s36 offen offset:1024 sc1 lds
  v_mfma_f32_16x16x32_bf16 v[48:51], a[216:219], v[24:27], v[48:51]
  s_waitcnt lgkmcnt(4)
  v_mfma_f32_16x16x32_bf16 v[36:39], a[92:95], v[28:31], v[36:39]
  ds_read_b128 v[20:23], v73 offset:53248
  v_mfma_f32_16x16x32_bf16 v[40:43], a[92:95], v[32:35], v[40:43]
  ds_read_b128 v[24:27], v73 offset:54272
  v_mfma_f32_16x16x32_bf16 v[44:47], a[220:223], v[28:31], v[44:47]
  buffer_load_dwordx4 v1, s[4:7], s36 offen offset:2048 sc1 lds
  v_mfma_f32_16x16x32_bf16 v[48:51], a[220:223], v[32:35], v[48:51]
  s_waitcnt lgkmcnt(4)
  v_mfma_f32_16x16x32_bf16 v[36:39], a[96:99], v[4:7], v[36:39]
  ds_read_b128 v[28:31], v73 offset:55296
  v_mfma_f32_16x16x32_bf16 v[40:43], a[96:99], v[8:11], v[40:43]
  ds_read_b128 v[32:35], v73 offset:56320
  v_mfma_f32_16x16x32_bf16 v[44:47], a[224:227], v[4:7], v[44:47]
  buffer_load_dwordx4 v1, s[4:7], s36 offen offset:3072 sc1 lds
  v_mfma_f32_16x16x32_bf16 v[48:51], a[224:227], v[8:11], v[48:51]
  s_waitcnt lgkmcnt(4)
  v_mfma_f32_16x16x32_bf16 v[36:39], a[100:103], v[12:15], v[36:39]
  ds_read_b128 v[4:7], v73 offset:57344
  v_mfma_f32_16x16x32_bf16 v[40:43], a[100:103], v[16:19], v[40:43]
  ds_read_b128 v[8:11], v73 offset:58368
  v_mfma_f32_16x16x32_bf16 v[44:47], a[228:231], v[12:15], v[44:47]
  s_add_u32 s36, s32, 49152
  s_add_u32 m0, s34, s36
  s_add_u32 s36, s35, s36
  buffer_load_dwordx4 v1, s[4:7], s36 offen offset:0 sc1 lds
  v_mfma_f32_16x16x32_bf16 v[48:51], a[228:231], v[16:19], v[48:51]
  s_waitcnt lgkmcnt(4)
  v_mfma_f32_16x16x32_bf16 v[36:39], a[104:107], v[20:23], v[36:39]
  ds_read_b128 v[12:15], v73 offset:59392
  v_mfma_f32_16x16x32_bf16 v[40:43], a[104:107], v[24:27], v[40:43]
  ds_read_b128 v[16:19], v73 offset:60416
  v_mfma_f32_16x16x32_bf16 v[44:47], a[232:235], v[20:23], v[44:47]
  buffer_load_dwordx4 v1, s[4:7], s36 offen offset:1024 sc1 lds
  v_mfma_f32_16x16x32_bf16 v[48:51], a[232:235], v[24:27], v[48:51]
  s_waitcnt lgkmcnt(4)
  v_mfma_f32_16x16x32_bf16 v[36:39], a[108:111], v[28:31], v[36:39]
  ds_read_b128 v[20:23], v73 offset:61440
  v_mfma_f32_16x16x32_bf16 v[40:43], a[108:111], v[32:35], v[40:43]
  ds_read_b128 v[24:27], v73 offset:62464
  v_mfma_f32_16x16x32_bf16 v[44:47], a[236:239], v[28:31], v[44:47]
  buffer_load_dwordx4 v1, s[4:7], s36 offen offset:2048 sc1 lds
  v_mfma_f32_16x16x32_bf16 v[48:51], a[236:239], v[32:35], v[48:51]
  s_waitcnt lgkmcnt(4)
  v_mfma_f32_16x16x32_bf16 v[36:39], a[112:115], v[4:7], v[36:39]
  ds_read_b128 v[28:31], v73 offset:63488
  v_mfma_f32_16x16x32_bf16 v[40:43], a[112:115], v[8:11], v[40:43]
  ds_read_b128 v[32:35], v73 offset:64512
  v_mfma_f32_16x16x32_bf16 v[44:47], a[240:243], v[4:7], v[44:47]
  buffer_load_dwordx4 v1, s[4:7], s36 offen offset:3072 sc1 lds
  v_mfma_f32_16x16x32_bf16 v[48:51], a[240:243], v[8:11], v[48:51]
  s_waitcnt lgkmcnt(4)
  v_mfma_f32_16x16x32_bf16 v[36:39], a[116:119], v[12:15], v[36:39]
  v_mfma_f32_16x16x32_bf16 v[40:43], a[116:119], v[16:19], v[40:43]
  v_mfma_f32_16x16x32_bf16 v[44:47], a[244:247], v[12:15], v[44:47]
  v_mfma_f32_16x16x32_bf16 v[48:51], a[244:247], v[16:19], v[48:51]
  s_waitcnt lgkmcnt(2)
  v_mfma_f32_16x16x32_bf16 v[36:39], a[120:123], v[20:23], v[36:39]
  v_mfma_f32_16x16x32_bf16 v[40:43], a[120:123], v[24:27], v[40:43]
  v_mfma_f32_16x16x32_bf16 v[44:47], a[248:251], v[20:23], v[44:47]
  v_mfma_f32_16x16x32_bf16 v[48:51], a[248:251], v[24:27], v[48:51]
  s_waitcnt lgkmcnt(0)
  v_mfma_f32_16x16x32_bf16 v[36:39], a[124:127], v[28:31], v[36:39]
  v_mfma_f32_16x16x32_bf16 v[40:43], a[124:127], v[32:35], v[40:43]
  v_mfma_f32_16x16x32_bf16 v[44:47], a[252:255], v[28:31], v[44:47]
  v_mfma_f32_16x16x32_bf16 v[48:51], a[252:255], v[32:35], v[48:51]
  s_nop 7
  s_branch L_WO_epi
L_WO_nopf:
  s_waitcnt lgkmcnt(4)
  v_mfma_f32_16x16x32_bf16 v[36:39], a[52:55], v[12:15], v[36:39]
  ds_read_b128 v[4:7], v73 offset:32768
  v_mfma_f32_16x16x32_bf16 v[40:43], a[52:55], v[16:19], v[40:43]
  ds_read_b128 v[8:11], v73 offset:33792
  v_mfma_f32_16x16x32_bf16 v[44:47], a[180:183], v[12:15], v[44:47]
  v_mfma_f32_16x16x32_bf16 v[48:51], a[180:183], v[16:19], v[48:51]
  s_waitcnt lgkmcnt(4)
  v_mfma_f32_16x16x32_bf16 v[36:39], a[56:59], v[20:23], v[36:39]
  ds_read_b128 v[12:15], v73 offset:34816
  v_mfma_f32_16x16x32_bf16 v[40:43], a[56:59], v[24:27], v[40:43]
  ds_read_b128 v[16:19], v73 offset:35840
  v_mfma_f32_16x16x32_bf16 v[44:47], a[184:187], v[20:23], v[44:47]
  v_mfma_f32_16x16x32_bf16 v[48:51], a[184:187], v[24:27], v[48:51]
  s_waitcnt lgkmcnt(4)
  v_mfma_f32_16x16x32_bf16 v[36:39], a[60:63], v[28:31], v[36:39]
  ds_read_b128 v[20:23], v73 offset:36864
  v_mfma_f32_16x16x32_bf16 v[40:43], a[60:63], v[32:35], v[40:43]
  ds_read_b128 v[24:27], v73 offset:37888
  v_mfma_f32_16x16x32_bf16 v[44:47], a[188:191], v[28:31], v[44:47]
  v_mfma_f32_16x16x32_bf16 v[48:51], a[188:191], v[32:35], v[48:51]
  s_waitcnt lgkmcnt(4)
  v_mfma_f32_16x16x32_bf16 v[36:39], a[64:67], v[4:7], v[36:39]
  ds_read_b128 v[28:31], v73 offset:38912
  v_mfma_f32_16x16x32_bf16 v[40:43], a[64:67], v[8:11], v[40:43]
  ds_read_b128 v[32:35], v73 offset:39936
  v_mfma_f32_16x16x32_bf16 v[44:47], a[192:195], v[4:7], v[44:47]
  v_mfma_f32_16x16x32_bf16 v[48:51], a[192:195], v[8:11], v[48:51]
  s_waitcnt lgkmcnt(4)
  v_mfma_f32_16x16x32_bf16 v[36:39], a[68:71], v[12:15], v[36:39]
  ds_read_b128 v[4:7], v73 offset:40960
  v_mfma_f32_16x16x32_bf16 v[40:43], a[68:71], v[16:19], v[40:43]
  ds_read_b128 v[8:11], v73 offset:41984
  v_mfma_f32_16x16x32_bf16 v[44:47], a[196:199], v[12:15], v[44:47]
  v_mfma_f32_16x16x32_bf16 v[48:51], a[196:199], v[16:19], v[48:51]
  s_waitcnt lgkmcnt(4)
  v_mfma_f32_16x16x32_bf16 v[36:39], a[72:75], v[20:23], v[36:39]
  ds_read_b128 v[12:15], v73 offset:43008
  v_mfma_f32_16x16x32_bf16 v[40:43], a[72:75], v[24:27], v[40:43]
  ds_read_b128 v[16:19], v73 offset:44032
  v_mfma_f32_16x16x32_bf16 v[44:47], a[200:203], v[20:23], v[44:47]
  v_mfma_f32_16x16x32_bf16 v[48:51], a[200:203], v[24:27], v[48:51]
  s_waitcnt lgkmcnt(4)
  v_mfma_f32_16x16x32_bf16 v[36:39], a[76:79], v[28:31], v[36:39]
  ds_read_b128 v[20:23], v73 offset:45056
  v_mfma_f32_16x16x32_bf16 v[40:43], a[76:79], v[32:35], v[40:43]
  ds_read_b128 v[24:27], v73 offset:46080
  v_mfma_f32_16x16x32_bf16 v[44:47], a[204:207], v[28:31], v[44:47]
  v_mfma_f32_16x16x32_bf16 v[48:51], a[204:207], v[32:35], v[48:51]
  s_waitcnt lgkmcnt(4)
  v_mfma_f32_16x16x32_bf16 v[36:39], a[80:83], v[4:7], v[36:39]
  ds_read_b128 v[28:31], v73 offset:47104
  v_mfma_f32_16x16x32_bf16 v[40:43], a[80:83], v[8:11], v[40:43]
  ds_read_b128 v[32:35], v73 offset:48128
  v_mfma_f32_16x16x32_bf16 v[44:47], a[208:211], v[4:7], v[44:47]
  v_mfma_f32_16x16x32_bf16 v[48:51], a[208:211], v[8:11], v[48:51]
  s_waitcnt lgkmcnt(4)
  v_mfma_f32_16x16x32_bf16 v[36:39], a[84:87], v[12:15], v[36:39]
  ds_read_b128 v[4:7], v73 offset:49152
  v_mfma_f32_16x16x32_bf16 v[40:43], a[84:87], v[16:19], v[40:43]
  ds_read_b128 v[8:11], v73 offset:50176
  v_mfma_f32_16x16x32_bf16 v[44:47], a[212:215], v[12:15], v[44:47]
  v_mfma_f32_16x16x32_bf16 v[48:51], a[212:215], v[16:19], v[48:51]
  s_waitcnt lgkmcnt(4)
  v_mfma_f32_16x16x32_bf16 v[36:39], a[88:91], v[20:23], v[36:39]
  ds_read_b128 v[12:15], v73 offset:51200
  v_mfma_f32_16x16x32_bf16 v[40:43], a[88:91], v[24:27], v[40:43]
  ds_read_b128 v[16:19], v73 offset:52224
  v_mfma_f32_16x16x32_bf16 v[44:47], a[216:219], v[20:23], v[44:47]
  v_mfma_f32_16x16x32_bf16 v[48:51], a[216:219], v[24:27], v[48:51]
  s_waitcnt lgkmcnt(4)
  v_mfma_f32_16x16x32_bf16 v[36:39], a[92:95], v[28:31], v[36:39]
  ds_read_b128 v[20:23], v73 offset:53248
  v_mfma_f32_16x16x32_bf16 v[40:43], a[92:95], v[32:35], v[40:43]
  ds_read_b128 v[24:27], v73 offset:54272
  v_mfma_f32_16x16x32_bf16 v[44:47], a[220:223], v[28:31], v[44:47]
  v_mfma_f32_16x16x32_bf16 v[48:51], a[220:223], v[32:35], v[48:51]
  s_waitcnt lgkmcnt(4)
  v_mfma_f32_16x16x32_bf16 v[36:39], a[96:99], v[4:7], v[36:39]
  ds_read_b128 v[28:31], v73 offset:55296
  v_mfma_f32_16x16x32_bf16 v[40:43], a[96:99], v[8:11], v[40:43]
  ds_read_b128 v[32:35], v73 offset:56320
  v_mfma_f32_16x16x32_bf16 v[44:47], a[224:227], v[4:7], v[44:47]
  v_mfma_f32_16x16x32_bf16 v[48:51], a[224:227], v[8:11], v[48:51]
  s_waitcnt lgkmcnt(4)
  v_mfma_f32_16x16x32_bf16 v[36:39], a[100:103], v[12:15], v[36:39]
  ds_read_b128 v[4:7], v73 offset:57344
  v_mfma_f32_16x16x32_bf16 v[40:43], a[100:103], v[16:19], v[40:43]
  ds_read_b128 v[8:11], v73 offset:58368
  v_mfma_f32_16x16x32_bf16 v[44:47], a[228:231], v[12:15], v[44:47]
  v_mfma_f32_16x16x32_bf16 v[48:51], a[228:231], v[16:19], v[48:51]
  s_waitcnt lgkmcnt(4)
  v_mfma_f32_16x16x32_bf16 v[36:39], a[104:107], v[20:23], v[36:39]
  ds_read_b128 v[12:15], v73 offset:59392
  v_mfma_f32_16x16x32_bf16 v[40:43], a[104:107], v[24:27], v[40:43]
  ds_read_b128 v[16:19], v73 offset:60416
  v_mfma_f32_16x16x32_bf16 v[44:47], a[232:235], v[20:23], v[44:47]
  v_mfma_f32_16x16x32_bf16 v[48:51], a[232:235], v[24:27], v[48:51]
  s_waitcnt lgkmcnt(4)
  v_mfma_f32_16x16x32_bf16 v[36:39], a[108:111], v[28:31], v[36:39]
  ds_read_b128 v[20:23], v73 offset:61440
  v_mfma_f32_16x16x32_bf16 v[40:43], a[108:111], v[32:35], v[40:43]
  ds_read_b128 v[24:27], v73 offset:62464
  v_mfma_f32_16x16x32_bf16 v[44:47], a[236:239], v[28:31], v[44:47]
  v_mfma_f32_16x16x32_bf16 v[48:51], a[236:239], v[32:35], v[48:51]
  s_waitcnt lgkmcnt(4)
  v_mfma_f32_16x16x32_bf16 v[36:39], a[112:115], v[4:7], v[36:39]
  ds_read_b128 v[28:31], v73 offset:63488
  v_mfma_f32_16x16x32_bf16 v[40:43], a[112:115], v[8:11], v[40:43]
  ds_read_b128 v[32:35], v73 offset:64512
  v_mfma_f32_16x16x32_bf16 v[44:47], a[240:243], v[4:7], v[44:47]
  v_mfma_f32_16x16x32_bf16 v[48:51], a[240:243], v[8:11], v[48:51]
  s_waitcnt lgkmcnt(4)
  v_mfma_f32_16x16x32_bf16 v[36:39], a[116:119], v[12:15], v[36:39]
  v_mfma_f32_16x16x32_bf16 v[40:43], a[116:119], v[16:19], v[40:43]
  v_mfma_f32_16x16x32_bf16 v[44:47], a[244:247], v[12:15], v[44:47]
  v_mfma_f32_16x16x32_bf16 v[48:51], a[244:247], v[16:19], v[48:51]
  s_waitcnt lgkmcnt(2)
  v_mfma_f32_16x16x32_bf16 v[36:39], a[120:123], v[20:23], v[36:39]
  v_mfma_f32_16x16x32_bf16 v[40:43], a[120:123], v[24:27], v[40:43]
  v_mfma_f32_16x16x32_bf16 v[44:47], a[248:251], v[20:23], v[44:47]
  v_mfma_f32_16x16x32_bf16 v[48:51], a[248:251], v[24:27], v[48:51]
  s_waitcnt lgkmcnt(0)
  v_mfma_f32_16x16x32_bf16 v[36:39], a[124:127], v[28:31], v[36:39]
  v_mfma_f32_16x16x32_bf16 v[40:43], a[124:127], v[32:35], v[40:43]
  v_mfma_f32_16x16x32_bf16 v[44:47], a[252:255], v[28:31], v[44:47]
  v_mfma_f32_16x16x32_bf16 v[48:51], a[252:255], v[32:35], v[48:51]
L_WO_epi:
  s_nop 4
  v_cvt_pk_bf16_f32 v52, v36, v37
  v_cvt_pk_bf16_f32 v53, v38, v39
  v_cvt_pk_bf16_f32 v54, v44, v45
  v_cvt_pk_bf16_f32 v55, v46, v47
  buffer_store_dwordx4 v[52:55], v68, s[4:7], s31 offen offset:0 sc1
  v_cvt_pk_bf16_f32 v56, v40, v41
  v_cvt_pk_bf16_f32 v57, v42, v43
  v_cvt_pk_bf16_f32 v58, v48, v49
  v_cvt_pk_bf16_f32 v59, v50, v51
  buffer_store_dwordx4 v[56:59], v68, s[4:7], s31 offen offset:1024 sc1
  s_add_u32 s25, s25, 1
  s_add_u32 s31, s31, 262144
  s_branch L_WO_top
L_F1:
  s_load_dwordx2 s[8:9], s[0:1], 64
  s_mov_b32 s10, 7340032
  s_mov_b32 s11, 0x20000
  s_waitcnt lgkmcnt(0)
  s_lshl_b32 s44, s21, 7
  v_bfe_u32 v40, v0, 5, 1
  v_mul_u32_u24 v40, 28672, v40
  v_bfe_u32 v41, v0, 4, 1
  v_mul_u32_u24 v41, 14336, v41
  v_add_u32 v40, v40, v41
  v_bfe_u32 v41, v0, 3, 1
  v_mul_u32_u24 v41, 7168, v41
  v_add_u32 v40, v40, v41
  v_lshrrev_b32 v41, 3, v0
  v_and_b32 v41, 6, v41
  v_xor_b32 v41, v41, v0
  v_and_b32 v41, 7, v41
  v_lshl_add_u32 v40, v41, 4, v40
  s_lshr_b32 s40, s20, 1
  s_mul_i32 s40, s40, 458752
  s_and_b32 s41, s20, 1
  s_mul_i32 s41, s41, 57344
  s_add_u32 s40, s40, s41
  v_add_u32 v40, s40, v40
  v_bfe_u32 v41, v0, 3, 2
  v_xor_b32 v41, s20, v41
  v_lshlrev_b32 v41, 5, v41
  v_lshrrev_b32 v42, 2, v0
  v_lshl_add_u32 v42, v42, 7, v41
  v_and_b32 v41, 3, v0
  v_lshl_add_u32 v42, v41, 3, v42
  v_add_u32 v43, 0x10000, v42
  v_add_u32 v44, s44, v40
  v_add_u32 v45, s44, v40
  s_lshl_b32 s41, s20, 10
  s_add_u32 m0, s41, 0
  s_mov_b32 s42, 0
  buffer_load_dwordx4 v44, s[8:11], s42 offen lds
  s_add_u32 m0, s41, 4096
  s_mov_b32 s42, 114688
  buffer_load_dwordx4 v44, s[8:11], s42 offen lds
  s_add_u32 m0, s41, 8192
  s_mov_b32 s42, 229376
  buffer_load_dwordx4 v44, s[8:11], s42 offen lds
  s_add_u32 m0, s41, 12288
  s_mov_b32 s42, 344064
  buffer_load_dwordx4 v44, s[8:11], s42 offen lds
  s_add_u32 m0, s41, 16384
  s_mov_b32 s42, 917504
  buffer_load_dwordx4 v44, s[8:11], s42 offen lds
  s_add_u32 m0, s41, 20480
  s_mov_b32 s42, 1032192
  buffer_load_dwordx4 v44, s[8:11], s42 offen lds
  s_add_u32 m0, s41, 24576
  s_mov_b32 s42, 1146880
  buffer_load_dwordx4 v44, s[8:11], s42 offen lds
  s_add_u32 m0, s41, 28672
  s_mov_b32 s42, 1261568
  buffer_load_dwordx4 v44, s[8:11], s42 offen lds
  s_add_u32 m0, s41, 32768
  s_mov_b32 s42, 1835008
  buffer_load_dwordx4 v44, s[8:11], s42 offen lds
  s_add_u32 m0, s41, 36864
  s_mov_b32 s42, 1949696
  buffer_load_dwordx4 v44, s[8:11], s42 offen lds
  s_add_u32 m0, s41, 40960
  s_mov_b32 s42, 2064384
  buffer_load_dwordx4 v44, s[8:11], s42 offen lds
  s_add_u32 m0, s41, 45056
  s_mov_b32 s42, 2179072
  buffer_load_dwordx4 v44, s[8:11], s42 offen lds
  s_add_u32 m0, s41, 49152
  s_mov_b32 s42, 2752512
  buffer_load_dwordx4 v44, s[8:11], s42 offen lds
  s_add_u32 m0, s41, 53248
  s_mov_b32 s42, 2867200
  buffer_load_dwordx4 v44, s[8:11], s42 offen lds
  s_add_u32 m0, s41, 57344
  s_mov_b32 s42, 2981888
  buffer_load_dwordx4 v44, s[8:11], s42 offen lds
  s_add_u32 m0, s41, 61440
  s_mov_b32 s42, 3096576
  buffer_load_dwordx4 v44, s[8:11], s42 offen lds
  s_add_u32 m0, s41, 65536
  s_mov_b32 s42, 3670016
  buffer_load_dwordx4 v44, s[8:11], s42 offen lds
  s_add_u32 m0, s41, 69632
  s_mov_b32 s42, 3784704
  buffer_load_dwordx4 v44, s[8:11], s42 offen lds
  s_add_u32 m0, s41, 73728
  s_mov_b32 s42, 3899392
  buffer_load_dwordx4 v44, s[8:11], s42 offen lds
  s_add_u32 m0, s41, 77824
  s_mov_b32 s42, 4014080
  buffer_load_dwordx4 v44, s[8:11], s42 offen lds
  s_add_u32 m0, s41, 81920
  s_mov_b32 s42, 4587520
  buffer_load_dwordx4 v44, s[8:11], s42 offen lds
  s_add_u32 m0, s41, 86016
  s_mov_b32 s42, 4702208
  buffer_load_dwordx4 v44, s[8:11], s42 offen lds
  s_add_u32 m0, s41, 90112
  s_mov_b32 s42, 4816896
  buffer_load_dwordx4 v44, s[8:11], s42 offen lds
  s_add_u32 m0, s41, 94208
  s_mov_b32 s42, 4931584
  buffer_load_dwordx4 v44, s[8:11], s42 offen lds
  s_add_u32 m0, s41, 98304
  s_mov_b32 s42, 5505024
  buffer_load_dwordx4 v44, s[8:11], s42 offen lds
  s_add_u32 m0, s41, 102400
  s_mov_b32 s42, 5619712
  buffer_load_dwordx4 v44, s[8:11], s42 offen lds
  s_add_u32 m0, s41, 106496
  s_mov_b32 s42, 5734400
  buffer_load_dwordx4 v44, s[8:11], s42 offen lds
  s_add_u32 m0, s41, 110592
  s_mov_b32 s42, 5849088
  buffer_load_dwordx4 v44, s[8:11], s42 offen lds
  s_waitcnt vmcnt(24) lgkmcnt(0)
  s_barrier
  s_add_u32 m0, s41, 114688
  s_mov_b32 s42, 6422528
  buffer_load_dwordx4 v44, s[8:11], s42 offen lds
  s_add_u32 m0, s41, 118784
  s_mov_b32 s42, 6537216
  buffer_load_dwordx4 v44, s[8:11], s42 offen lds
  s_add_u32 m0, s41, 122880
  s_mov_b32 s42, 6651904
  buffer_load_dwordx4 v44, s[8:11], s42 offen lds
  s_add_u32 m0, s41, 126976
  s_mov_b32 s42, 6766592
  buffer_load_dwordx4 v44, s[8:11], s42 offen lds
  ds_read_b64_tr_b16 a[0:1], v42 offset:0
  ds_read_b64_tr_b16 a[2:3], v42 offset:2048
  ds_read_b64_tr_b16 a[4:5], v42 offset:4096
  ds_read_b64_tr_b16 a[6:7], v42 offset:6144
  ds_read_b64_tr_b16 a[8:9], v42 offset:8192
  ds_read_b64_tr_b16 a[10:11], v42 offset:10240
  ds_read_b64_tr_b16 a[12:13], v42 offset:12288
  ds_read_b64_tr_b16 a[14:15], v42 offset:14336
  s_waitcnt vmcnt(24) lgkmcnt(0)
  s_barrier
  s_load_dwordx2 s[8:9], s[0:1], 72
  s_mov_b32 s10, 7340032
  s_mov_b32 s11, 0x20000
  s_waitcnt lgkmcnt(0)
  s_add_u32 m0, s41, 0
  s_mov_b32 s42, 0
  buffer_load_dwordx4 v45, s[8:11], s42 offen lds
  s_add_u32 m0, s41, 4096
  s_mov_b32 s42, 114688
  buffer_load_dwordx4 v45, s[8:11], s42 offen lds
  s_add_u32 m0, s41, 8192
  s_mov_b32 s42, 229376
  buffer_load_dwordx4 v45, s[8:11], s42 offen lds
  s_add_u32 m0, s41, 12288
  s_mov_b32 s42, 344064
  buffer_load_dwordx4 v45, s[8:11], s42 offen lds
  ds_read_b64_tr_b16 a[16:17], v42 offset:16384
  ds_read_b64_tr_b16 a[18:19], v42 offset:18432
  ds_read_b64_tr_b16 a[20:21], v42 offset:20480
  ds_read_b64_tr_b16 a[22:23], v42 offset:22528
  ds_read_b64_tr_b16 a[24:25], v42 offset:24576
  ds_read_b64_tr_b16 a[26:27], v42 offset:26624
  ds_read_b64_tr_b16 a[28:29], v42 offset:28672
  ds_read_b64_tr_b16 a[30:31], v42 offset:30720
  s_waitcnt vmcnt(24) lgkmcnt(0)
  s_barrier
  s_add_u32 m0, s41, 16384
  s_mov_b32 s42, 917504
  buffer_load_dwordx4 v45, s[8:11], s42 offen lds
  s_add_u32 m0, s41, 20480
  s_mov_b32 s42, 1032192
  buffer_load_dwordx4 v45, s[8:11], s42 offen lds
  s_add_u32 m0, s41, 24576
  s_mov_b32 s42, 1146880
  buffer_load_dwordx4 v45, s[8:11], s42 offen lds
  s_add_u32 m0, s41, 28672
  s_mov_b32 s42, 1261568
  buffer_load_dwordx4 v45, s[8:11], s42 offen lds
  ds_read_b64_tr_b16 a[32:33], v42 offset:32768
  ds_read_b64_tr_b16 a[34:35], v42 offset:34816
  ds_read_b64_tr_b16 a[36:37], v42 offset:36864
  ds_read_b64_tr_b16 a[38:39], v42 offset:38912
  ds_read_b64_tr_b16 a[40:41], v42 offset:40960
  ds_read_b64_tr_b16 a[42:43], v42 offset:43008
  ds_read_b64_tr_b16 a[44:45], v42 offset:45056
  ds_read_b64_tr_b16 a[46:47], v42 offset:47104
  s_waitcnt vmcnt(24) lgkmcnt(0)
  s_barrier
  s_add_u32 m0, s41, 32768
  s_mov_b32 s42, 1835008
  buffer_load_dwordx4 v45, s[8:11], s42 offen lds
  s_add_u32 m0, s41, 36864
  s_mov_b32 s42, 1949696
  buffer_load_dwordx4 v45, s[8:11], s42 offen lds
  s_add_u32 m0, s41, 40960
  s_mov_b32 s42, 2064384
  buffer_load_dwordx4 v45, s[8:11], s42 offen lds
  s_add_u32 m0, s41, 45056
  s_mov_b32 s42, 2179072
  buffer_load_dwordx4 v45, s[8:11], s42 offen lds
  ds_read_b64_tr_b16 a[48:49], v42 offset:49152
  ds_read_b64_tr_b16 a[50:51], v42 offset:51200
  ds_read_b64_tr_b16 a[52:53], v42 offset:53248
  ds_read_b64_tr_b16 a[54:55], v42 offset:55296
  ds_read_b64_tr_b16 a[56:57], v42 offset:57344
  ds_read_b64_tr_b16 a[58:59], v42 offset:59392
  ds_read_b64_tr_b16 a[60:61], v42 offset:61440
  ds_read_b64_tr_b16 a[62:63], v42 offset:63488
  s_waitcnt vmcnt(24) lgkmcnt(0)
  s_barrier
  s_add_u32 m0, s41, 49152
  s_mov_b32 s42, 2752512
  buffer_load_dwordx4 v45, s[8:11], s42 offen lds
  s_add_u32 m0, s41, 53248
  s_mov_b32 s42, 2867200
  buffer_load_dwordx4 v45, s[8:11], s42 offen lds
  s_add_u32 m0, s41, 57344
  s_mov_b32 s42, 2981888
  buffer_load_dwordx4 v45, s[8:11], s42 offen lds
  s_add_u32 m0, s41, 61440
  s_mov_b32 s42, 3096576
  buffer_load_dwordx4 v45, s[8:11], s42 offen lds
  ds_read_b64_tr_b16 a[64:65], v43 offset:0
  ds_read_b64_tr_b16 a[66:67], v43 offset:2048
  ds_read_b64_tr_b16 a[68:69], v43 offset:4096
  ds_read_b64_tr_b16 a[70:71], v43 offset:6144
  ds_read_b64_tr_b16 a[72:73], v43 offset:8192
  ds_read_b64_tr_b16 a[74:75], v43 offset:10240
  ds_read_b64_tr_b16 a[76:77], v43 offset:12288
  ds_read_b64_tr_b16 a[78:79], v43 offset:14336
  s_waitcnt vmcnt(24) lgkmcnt(0)
  s_barrier
  s_add_u32 m0, s41, 65536
  s_mov_b32 s42, 3670016
  buffer_load_dwordx4 v45, s[8:11], s42 offen lds
  s_add_u32 m0, s41, 69632
  s_mov_b32 s42, 3784704
  buffer_load_dwordx4 v45, s[8:11], s42 offen lds
  s_add_u32 m0, s41, 73728
  s_mov_b32 s42, 3899392
  buffer_load_dwordx4 v45, s[8:11], s42 offen lds
  s_add_u32 m0, s41, 77824
  s_mov_b32 s42, 4014080
  buffer_load_dwordx4 v45, s[8:11], s42 offen lds
  ds_read_b64_tr_b16 a[80:81], v43 offset:16384
  ds_read_b64_tr_b16 a[82:83], v43 offset:18432
  ds_read_b64_tr_b16 a[84:85], v43 offset:20480
  ds_read_b64_tr_b16 a[86:87], v43 offset:22528
  ds_read_b64_tr_b16 a[88:89], v43 offset:24576
  ds_read_b64_tr_b16 a[90:91], v43 offset:26624
  ds_read_b64_tr_b16 a[92:93], v43 offset:28672
  ds_read_b64_tr_b16 a[94:95], v43 offset:30720
  s_waitcnt vmcnt(24) lgkmcnt(0)
  s_barrier
  s_add_u32 m0, s41, 81920
  s_mov_b32 s42, 4587520
  buffer_load_dwordx4 v45, s[8:11], s42 offen lds
  s_add_u32 m0, s41, 86016
  s_mov_b32 s42, 4702208
  buffer_load_dwordx4 v45, s[8:11], s42 offen lds
  s_add_u32 m0, s41, 90112
  s_mov_b32 s42, 4816896
  buffer_load_dwordx4 v45, s[8:11], s42 offen lds
  s_add_u32 m0, s41, 94208
  s_mov_b32 s42, 4931584
  buffer_load_dwordx4 v45, s[8:11], s42 offen lds
  ds_read_b64_tr_b16 a[96:97], v43 offset:32768
  ds_read_b64_tr_b16 a[98:99], v43 offset:34816
  ds_read_b64_tr_b16 a[100:101], v43 offset:36864
  ds_read_b64_tr_b16 a[102:103], v43 offset:38912
  ds_read_b64_tr_b16 a[104:105], v43 offset:40960
  ds_read_b64_tr_b16 a[106:107], v43 offset:43008
  ds_read_b64_tr_b16 a[108:109], v43 offset:45056
  ds_read_b64_tr_b16 a[110:111], v43 offset:47104
  s_waitcnt vmcnt(24) lgkmcnt(0)
  s_barrier
  s_add_u32 m0, s41, 98304
  s_mov_b32 s42, 5505024
  buffer_load_dwordx4 v45, s[8:11], s42 offen lds
  s_add_u32 m0, s41, 102400
  s_mov_b32 s42, 5619712
  buffer_load_dwordx4 v45, s[8:11], s42 offen lds
  s_add_u32 m0, s41, 106496
  s_mov_b32 s42, 5734400
  buffer_load_dwordx4 v45, s[8:11], s42 offen lds
  s_add_u32 m0, s41, 110592
  s_mov_b32 s42, 5849088
  buffer_load_dwordx4 v45, s[8:11], s42 offen lds
  ds_read_b64_tr_b16 a[112:113], v43 offset:49152
  ds_read_b64_tr_b16 a[114:115], v43 offset:51200
  ds_read_b64_tr_b16 a[116:117], v43 offset:53248
  ds_read_b64_tr_b16 a[118:119], v43 offset:55296
  ds_read_b64_tr_b16 a[120:121], v43 offset:57344
  ds_read_b64_tr_b16 a[122:123], v43 offset:59392
  ds_read_b64_tr_b16 a[124:125], v43 offset:61440
  ds_read_b64_tr_b16 a[126:127], v43 offset:63488
  s_waitcnt vmcnt(24) lgkmcnt(0)
  s_barrier
  s_add_u32 m0, s41, 114688
  s_mov_b32 s42, 6422528
  buffer_load_dwordx4 v45, s[8:11], s42 offen lds
  s_add_u32 m0, s41, 118784
  s_mov_b32 s42, 6537216
  buffer_load_dwordx4 v45, s[8:11], s42 offen lds
  s_add_u32 m0, s41, 122880
  s_mov_b32 s42, 6651904
  buffer_load_dwordx4 v45, s[8:11], s42 offen lds
  s_add_u32 m0, s41, 126976
  s_mov_b32 s42, 6766592
  buffer_load_dwordx4 v45, s[8:11], s42 offen lds
  ds_read_b64_tr_b16 a[128:129], v42 offset:0
  ds_read_b64_tr_b16 a[130:131], v42 offset:2048
  ds_read_b64_tr_b16 a[132:133], v42 offset:4096
  ds_read_b64_tr_b16 a[134:135], v42 offset:6144
  ds_read_b64_tr_b16 a[136:137], v42 offset:8192
  ds_read_b64_tr_b16 a[138:139], v42 offset:10240
  ds_read_b64_tr_b16 a[140:141], v42 offset:12288
  ds_read_b64_tr_b16 a[142:143], v42 offset:14336
  s_waitcnt vmcnt(24) lgkmcnt(0)
  s_barrier
  ds_read_b64_tr_b16 a[144:145], v42 offset:16384
  ds_read_b64_tr_b16 a[146:147], v42 offset:18432
  ds_read_b64_tr_b16 a[148:149], v42 offset:20480
  ds_read_b64_tr_b16 a[150:151], v42 offset:22528
  ds_read_b64_tr_b16 a[152:153], v42 offset:24576
  ds_read_b64_tr_b16 a[154:155], v42 offset:26624
  ds_read_b64_tr_b16 a[156:157], v42 offset:28672
  ds_read_b64_tr_b16 a[158:159], v42 offset:30720
  s_waitcnt vmcnt(20) lgkmcnt(0)
  s_barrier
  ds_read_b64_tr_b16 a[160:161], v42 offset:32768
  ds_read_b64_tr_b16 a[162:163], v42 offset:34816
  ds_read_b64_tr_b16 a[164:165], v42 offset:36864
  ds_read_b64_tr_b16 a[166:167], v42 offset:38912
  ds_read_b64_tr_b16 a[168:169], v42 offset:40960
  ds_read_b64_tr_b16 a[170:171], v42 offset:43008
  ds_read_b64_tr_b16 a[172:173], v42 offset:45056
  ds_read_b64_tr_b16 a[174:175], v42 offset:47104
  s_waitcnt vmcnt(16) lgkmcnt(0)
  s_barrier
  ds_read_b64_tr_b16 a[176:177], v42 offset:49152
  ds_read_b64_tr_b16 a[178:179], v42 offset:51200
  ds_read_b64_tr_b16 a[180:181], v42 offset:53248
  ds_read_b64_tr_b16 a[182:183], v42 offset:55296
  ds_read_b64_tr_b16 a[184:185], v42 offset:57344
  ds_read_b64_tr_b16 a[186:187], v42 offset:59392
  ds_read_b64_tr_b16 a[188:189], v42 offset:61440
  ds_read_b64_tr_b16 a[190:191], v42 offset:63488
  s_waitcnt vmcnt(12) lgkmcnt(0)
  s_barrier
  ds_read_b64_tr_b16 a[192:193], v43 offset:0
  ds_read_b64_tr_b16 a[194:195], v43 offset:2048
  ds_read_b64_tr_b16 a[196:197], v43 offset:4096
  ds_read_b64_tr_b16 a[198:199], v43 offset:6144
  ds_read_b64_tr_b16 a[200:201], v43 offset:8192
  ds_read_b64_tr_b16 a[202:203], v43 offset:10240
  ds_read_b64_tr_b16 a[204:205], v43 offset:12288
  ds_read_b64_tr_b16 a[206:207], v43 offset:14336
  s_waitcnt vmcnt(8) lgkmcnt(0)
  s_barrier
  ds_read_b64_tr_b16 a[208:209], v43 offset:16384
  ds_read_b64_tr_b16 a[210:211], v43 offset:18432
  ds_read_b64_tr_b16 a[212:213], v43 offset:20480
  ds_read_b64_tr_b16 a[214:215], v43 offset:22528
  ds_read_b64_tr_b16 a[216:217], v43 offset:24576
  ds_read_b64_tr_b16 a[218:219], v43 offset:26624
  ds_read_b64_tr_b16 a[220:221], v43 offset:28672
  ds_read_b64_tr_b16 a[222:223], v43 offset:30720
  s_waitcnt vmcnt(4) lgkmcnt(0)
  s_barrier
  ds_read_b64_tr_b16 a[224:225], v43 offset:32768
  ds_read_b64_tr_b16 a[226:227], v43 offset:34816
  ds_read_b64_tr_b16 a[228:229], v43 offset:36864
  ds_read_b64_tr_b16 a[230:231], v43 offset:38912
  ds_read_b64_tr_b16 a[232:233], v43 offset:40960
  ds_read_b64_tr_b16 a[234:235], v43 offset:43008
  ds_read_b64_tr_b16 a[236:237], v43 offset:45056
  ds_read_b64_tr_b16 a[238:239], v43 offset:47104
  s_waitcnt vmcnt(0) lgkmcnt(0)
  s_barrier
  ds_read_b64_tr_b16 a[240:241], v43 offset:49152
  ds_read_b64_tr_b16 a[242:243], v43 offset:51200
  ds_read_b64_tr_b16 a[244:245], v43 offset:53248
  ds_read_b64_tr_b16 a[246:247], v43 offset:55296
  ds_read_b64_tr_b16 a[248:249], v43 offset:57344
  ds_read_b64_tr_b16 a[250:251], v43 offset:59392
  ds_read_b64_tr_b16 a[252:253], v43 offset:61440
  ds_read_b64_tr_b16 a[254:255], v43 offset:63488
  s_waitcnt lgkmcnt(0)
  s_barrier
  v_min_u32 v2, 3, v0
  v_lshlrev_b32 v2, 7, v2
  v_add_u32 v2, 1413120, v2
  s_lshl_b32 s62, s21, 7
  s_add_u32 s62, s62, 1414144
  s_mov_b32 s27, 6291456
  s_lshl_b32 s40, s21, 12
  s_add_u32 s31, s40, 44040192
  s_lshr_b32 s40, s20, 1
  s_lshl_b32 s40, s40, 11
  s_and_b32 s41, s20, 1
  s_lshl_b32 s41, s41, 9
  s_add_u32 s40, s40, s41
  v_and_b32 v52, 31, v0
  v_lshl_add_u32 v68, v52, 4, s40
  v_lshrrev_b32 v52, 5, v0
  v_lshl_add_u32 v68, v52, 10, v68
  s_mov_b32 s37, 0xbfb8aa3b
  v_lshlrev_b32 v1, 4, v0
  s_lshl_b32 s32, s20, 12
  s_mul_i32 s33, s20, 3072
  v_mov_b32 v69, v1
  v_add_u32 v70, 0x10000, v69
  s_lshl_b32 s40, s20, 2
  s_add_u32 s40, s40, 131072
  v_mov_b32 v71, s40
  v_mov_b32 v52, 0
  ds_write_b32 v71, v52
  s_mov_b32 s25, 0
  s_mov_b32 s26, 0
  s_mov_b32 s29, 1
  s_mov_b32 s30, 0
  s_mov_b32 s28, 1
  s_waitcnt lgkmcnt(0)
  s_barrier
  s_branch L_F1_poll
L_F1_top:
  s_cmp_lg_u32 s28, 0
  s_cbranch_scc1 L_F1_go
  buffer_load_dword v3, v2, s[4:7], s30 offen sc1
  v_mov_b32 v52, s25
  v_and_b32 v53, 3, v0
  v_lshlrev_b32 v53, 2, v53
  v_add_u32 v53, 131072, v53
  s_waitcnt vmcnt(1)
  ds_write_b32 v71, v52
  ds_read_b32 v53, v53
  s_waitcnt lgkmcnt(0)
  v_cmp_gt_i32 vcc, s25, v53
  s_cbranch_vccnz L_F1_nosig
  s_mov_b32 s63, s25
  s_atomic_smax s63, s[4:5], s62 glc
Lnosig_28:
L_F1_nosig:
  s_cmp_ge_u32 s25, 64
  s_cbranch_scc1 L_END
  s_waitcnt vmcnt(0)
  v_cmp_gt_i32 vcc, s29, v3
  s_cbranch_vccz L_F1_issue
L_F1_poll:
  s_nop 3
Lpoll_29:
  buffer_load_dword v3, v2, s[4:7], s30 offen sc1
  s_sub_u32 s24, s24, 1
  s_cbranch_scc1 L_FAIL
  s_waitcnt vmcnt(0)
  v_cmp_gt_i32 vcc, s29, v3
  s_cbranch_vccz Lpolld_30
  s_sleep 2
  s_branch Lpoll_29
Lpolld_30:
L_F1_issue:
  s_mov_b32 s34, s26
  s_mov_b32 s35, s27
  s_add_u32 s36, s32, 0
  s_add_u32 m0, s34, s36
  s_add_u32 s36, s35, s36
  buffer_load_dwordx4 v1, s[4:7], s36 offen offset:0 sc1 lds
  buffer_load_dwordx4 v1, s[4:7], s36 offen offset:1024 sc1 lds
  buffer_load_dwordx4 v1, s[4:7], s36 offen offset:2048 sc1 lds
  buffer_load_dwordx4 v1, s[4:7], s36 offen offset:3072 sc1 lds
  s_add_u32 s36, s32, 16384
  s_add_u32 m0, s34, s36
  s_add_u32 s36, s35, s36
  buffer_load_dwordx4 v1, s[4:7], s36 offen offset:0 sc1 lds
  buffer_load_dwordx4 v1, s[4:7], s36 offen offset:1024 sc1 lds
  buffer_load_dwordx4 v1, s[4:7], s36 offen offset:2048 sc1 lds
  buffer_load_dwordx4 v1, s[4:7], s36 offen offset:3072 sc1 lds
  s_add_u32 s36, s32, 32768
  s_add_u32 m0, s34, s36
  s_add_u32 s36, s35, s36
  buffer_load_dwordx4 v1, s[4:7], s36 offen offset:0 sc1 lds
  buffer_load_dwordx4 v1, s[4:7], s36 offen offset:1024 sc1 lds
  buffer_load_dwordx4 v1, s[4:7], s36 offen offset:2048 sc1 lds
  buffer_load_dwordx4 v1, s[4:7], s36 offen offset:3072 sc1 lds
  s_add_u32 s36, s32, 49152
  s_add_u32 m0, s34, s36
  s_add_u32 s36, s35, s36
  buffer_load_dwordx4 v1, s[4:7], s36 offen offset:0 sc1 lds
  buffer_load_dwordx4 v1, s[4:7], s36 offen offset:1024 sc1 lds
  buffer_load_dwordx4 v1, s[4:7], s36 offen offset:2048 sc1 lds
  buffer_load_dwordx4 v1, s[4:7], s36 offen offset:3072 sc1 lds
L_F1_go:
  v_add_u32 v73, s26, v69
  v_add_u32 v74, s26, v70
  s_sub_u32 s26, 65536, s26
  s_add_u32 s27, s27, 65536
  s_mov_b32 s34, s26
  s_mov_b32 s35, s27
  s_add_u32 s29, s29, 1
  s_xor_b32 s30, s30, 512
  s_waitcnt vmcnt(12)
  s_barrier
  ds_read_b128 v[4:7], v73 offset:0
  ds_read_b128 v[8:11], v73 offset:1024
  ds_read_b128 v[12:15], v73 offset:2048
  ds_read_b128 v[16:19], v73 offset:3072
  ds_read_b128 v[20:23], v73 offset:4096
  ds_read_b128 v[24:27], v73 offset:5120
  buffer_load_dword v3, v2, s[4:7], s30 offen sc1
  s_waitcnt lgkmcnt(4)
  v_mfma_f32_16x16x32_bf16 v[36:39], a[0:3], v[4:7], 0
  ds_read_b128 v[28:31], v73 offset:6144
  v_mfma_f32_16x16x32_bf16 v[40:43], a[0:3], v[8:11], 0
  ds_read_b128 v[32:35], v73 offset:7168
  v_mfma_f32_16x16x32_bf16 v[44:47], a[128:131], v[4:7], 0
  v_mfma_f32_16x16x32_bf16 v[48:51], a[128:131], v[8:11], 0
  s_waitcnt lgkmcnt(4)
  v_mfma_f32_16x16x32_bf16 v[36:39], a[4:7], v[12:15], v[36:39]
  ds_read_b128 v[4:7], v73 offset:8192
  v_mfma_f32_16x16x32_bf16 v[40:43], a[4:7], v[16:19], v[40:43]
  ds_read_b128 v[8:11], v73 offset:9216
  v_mfma_f32_16x16x32_bf16 v[44:47], a[132:135], v[12:15], v[44:47]
  v_mfma_f32_16x16x32_bf16 v[48:51], a[132:135], v[16:19], v[48:51]
  s_waitcnt lgkmcnt(4)
  v_mfma_f32_16x16x32_bf16 v[36:39], a[8:11], v[20:23], v[36:39]
  ds_read_b128 v[12:15], v73 offset:10240
  v_mfma_f32_16x16x32_bf16 v[40:43], a[8:11], v[24:27], v[40:43]
  ds_read_b128 v[16:19], v73 offset:11264
  v_mfma_f32_16x16x32_bf16 v[44:47], a[136:139], v[20:23], v[44:47]
  v_mfma_f32_16x16x32_bf16 v[48:51], a[136:139], v[24:27], v[48:51]
  s_waitcnt lgkmcnt(4)
  v_mfma_f32_16x16x32_bf16 v[36:39], a[12:15], v[28:31], v[36:39]
  ds_read_b128 v[20:23], v73 offset:12288
  v_mfma_f32_16x16x32_bf16 v[40:43], a[12:15], v[32:35], v[40:43]
  ds_read_b128 v[24:27], v73 offset:13312
  v_mfma_f32_16x16x32_bf16 v[44:47], a[140:143], v[28:31], v[44:47]
  v_mfma_f32_16x16x32_bf16 v[48:51], a[140:143], v[32:35], v[48:51]
  s_waitcnt lgkmcnt(4)
  v_mfma_f32_16x16x32_bf16 v[36:39], a[16:19], v[4:7], v[36:39]
  ds_read_b128 v[28:31], v73 offset:14336
  v_mfma_f32_16x16x32_bf16 v[40:43], a[16:19], v[8:11], v[40:43]
  ds_read_b128 v[32:35], v73 offset:15360
  v_mfma_f32_16x16x32_bf16 v[44:47], a[144:147], v[4:7], v[44:47]
  v_mfma_f32_16x16x32_bf16 v[48:51], a[144:147], v[8:11], v[48:51]
  s_waitcnt vmcnt(9)
  s_barrier
  s_waitcnt lgkmcnt(4)
  v_mfma_f32_16x16x32_bf16 v[36:39], a[20:23], v[12:15], v[36:39]
  ds_read_b128 v[4:7], v73 offset:16384
  v_mfma_f32_16x16x32_bf16 v[40:43], a[20:23], v[16:19], v[40:43]
  ds_read_b128 v[8:11], v73 offset:17408
  v_mfma_f32_16x16x32_bf16 v[44:47], a[148:151], v[12:15], v[44:47]
  v_mfma_f32_16x16x32_bf16 v[48:51], a[148:151], v[16:19], v[48:51]
  s_waitcnt lgkmcnt(4)
  v_mfma_f32_16x16x32_bf16 v[36:39], a[24:27], v[20:23], v[36:39]
  ds_read_b128 v[12:15], v73 offset:18432
  v_mfma_f32_16x16x32_bf16 v[40:43], a[24:27], v[24:27], v[40:43]
  ds_read_b128 v[16:19], v73 offset:19456
  v_mfma_f32_16x16x32_bf16 v[44:47], a[152:155], v[20:23], v[44:47]
  v_mfma_f32_16x16x32_bf16 v[48:51], a[152:155], v[24:27], v[48:51]
  s_waitcnt lgkmcnt(4)
  v_mfma_f32_16x16x32_bf16 v[36:39], a[28:31], v[28:31], v[36:39]
  ds_read_b128 v[20:23], v73 offset:20480
  v_mfma_f32_16x16x32_bf16 v[40:43], a[28:31], v[32:35], v[40:43]
  ds_read_b128 v[24:27], v73 offset:21504
  v_mfma_f32_16x16x32_bf16 v[44:47], a[156:159], v[28:31], v[44:47]
  v_mfma_f32_16x16x32_bf16 v[48:51], a[156:159], v[32:35], v[48:51]
  s_waitcnt lgkmcnt(4)
  v_mfma_f32_16x16x32_bf16 v[36:39], a[32:35], v[4:7], v[36:39]
  ds_read_b128 v[28:31], v73 offset:22528
  v_mfma_f32_16x16x32_bf16 v[40:43], a[32:35], v[8:11], v[40:43]
  ds_read_b128 v[32:35], v73 offset:23552
  v_mfma_f32_16x16x32_bf16 v[44:47], a[160:163], v[4:7], v[44:47]
  v_mfma_f32_16x16x32_bf16 v[48:51], a[160:163], v[8:11], v[48:51]
  s_waitcnt lgkmcnt(4)
  v_mfma_f32_16x16x32_bf16 v[36:39], a[36:39], v[12:15], v[36:39]
  ds_read_b128 v[4:7], v73 offset:24576
  v_mfma_f32_16x16x32_bf16 v[40:43], a[36:39], v[16:19], v[40:43]
  ds_read_b128 v[8:11], v73 offset:25600
  v_mfma_f32_16x16x32_bf16 v[44:47], a[164:167], v[12:15], v[44:47]
  v_mfma_f32_16x16x32_bf16 v[48:51], a[164:167], v[16:19], v[48:51]
  s_waitcnt lgkmcnt(4)
  v_mfma_f32_16x16x32_bf16 v[36:39], a[40:43], v[20:23], v[36:39]
  ds_read_b128 v[12:15], v73 offset:26624
  v_mfma_f32_16x16x32_bf16 v[40:43], a[40:43], v[24:27], v[40:43]
  ds_read_b128 v[16:19], v73 offset:27648
  v_mfma_f32_16x16x32_bf16 v[44:47], a[168:171], v[20:23], v[44:47]
  v_mfma_f32_16x16x32_bf16 v[48:51], a[168:171], v[24:27], v[48:51]
  s_waitcnt lgkmcnt(4)
  v_mfma_f32_16x16x32_bf16 v[36:39], a[44:47], v[28:31], v[36:39]
  ds_read_b128 v[20:23], v73 offset:28672
  v_mfma_f32_16x16x32_bf16 v[40:43], a[44:47], v[32:35], v[40:43]
  ds_read_b128 v[24:27], v73 offset:29696
  v_mfma_f32_16x16x32_bf16 v[44:47], a[172:175], v[28:31], v[44:47]
  v_mfma_f32_16x16x32_bf16 v[48:51], a[172:175], v[32:35], v[48:51]
  s_waitcnt lgkmcnt(4)
  v_mfma_f32_16x16x32_bf16 v[36:39], a[48:51], v[4:7], v[36:39]
  ds_read_b128 v[28:31], v73 offset:30720
  v_mfma_f32_16x16x32_bf16 v[40:43], a[48:51], v[8:11], v[40:43]
  ds_read_b128 v[32:35], v73 offset:31744
  v_mfma_f32_16x16x32_bf16 v[44:47], a[176:179], v[4:7], v[44:47]
  v_mfma_f32_16x16x32_bf16 v[48:51], a[176:179], v[8:11], v[48:51]
  s_waitcnt vmcnt(0)
  s_barrier
  v_cmp_gt_i32 vcc, s29, v3
  s_cmp_eq_u32 s28, 0
  s_cbranch_scc1 L_F1_s2
  s_mov_b32 s63, s25
  s_atomic_smax s63, s[4:5], s62 glc
Lnosig_31:
L_F1_s2:
  s_mov_b32 s28, 0
  s_cbranch_vccnz L_F1_nopf
  s_cmp_ge_u32 s25, 63
  s_cbranch_scc1 L_F1_nopf
  s_mov_b32 s28, 1
  s_waitcnt lgkmcnt(4)
  v_mfma_f32_16x16x32_bf16 v[36:39], a[52:55], v[12:15], v[36:39]
  ds_read_b128 v[4:7], v73 offset:32768
  v_mfma_f32_16x16x32_bf16 v[40:43], a[52:55], v[16:19], v[40:43]
  ds_read_b128 v[8:11], v73 offset:33792
  v_mfma_f32_16x16x32_bf16 v[44:47], a[180:183], v[12:15], v[44:47]
  s_add_u32 s36, s32, 0
  s_add_u32 m0, s34, s36
  s_add_u32 s36, s35, s36
  buffer_load_dwordx4 v1, s[4:7], s36 offen offset:0 sc1 lds
  v_mfma_f32_16x16x32_bf16 v[48:51], a[180:183], v[16:19], v[48:51]
  s_waitcnt lgkmcnt(4)
  v_mfma_f32_16x16x32_bf16 v[36:39], a[56:59], v[20:23], v[36:39]
  ds_read_b128 v[12:15], v73 offset:34816
  v_mfma_f32_16x16x32_bf16 v[40:43], a[56:59], v[24:27], v[40:43]
  ds_read_b128 v[16:19], v73 offset:35840
  v_mfma_f32_16x16x32_bf16 v[44:47], a[184:187], v[20:23], v[44:47]
  buffer_load_dwordx4 v1, s[4:7], s36 offen offset:1024 sc1 lds
  v_mfma_f32_16x16x32_bf16 v[48:51], a[184:187], v[24:27], v[48:51]
  s_waitcnt lgkmcnt(4)
  v_mfma_f32_16x16x32_bf16 v[36:39], a[60:63], v[28:31], v[36:39]
  ds_read_b128 v[20:23], v73 offset:36864
  v_mfma_f32_16x16x32_bf16 v[40:43], a[60:63], v[32:35], v[40:43]
  ds_read_b128 v[24:27], v73 offset:37888
  v_mfma_f32_16x16x32_bf16 v[44:47], a[188:191], v[28:31], v[44:47]
  buffer_load_dwordx4 v1, s[4:7], s36 offen offset:2048 sc1 lds
  v_mfma_f32_16x16x32_bf16 v[48:51], a[188:191], v[32:35], v[48:51]
  s_waitcnt lgkmcnt(4)
  v_mfma_f32_16x16x32_bf16 v[36:39], a[64:67], v[4:7], v[36:39]
  ds_read_b128 v[28:31], v73 offset:38912
  v_mfma_f32_16x16x32_bf16 v[40:43], a[64:67], v[8:11], v[40:43]
  ds_read_b128 v[32:35], v73 offset:39936
  v_mfma_f32_16x16x32_bf16 v[44:47], a[192:195], v[4:7], v[44:47]
  buffer_load_dwordx4 v1, s[4:7], s36 offen offset:3072 sc1 lds
  v_mfma_f32_16x16x32_bf16 v[48:51], a[192:195], v[8:11], v[48:51]
  s_waitcnt lgkmcnt(4)
  v_mfma_f32_16x16x32_bf16 v[36:39], a[68:71], v[12:15], v[36:39]
  ds_read_b128 v[4:7], v73 offset:40960
  v_mfma_f32_16x16x32_bf16 v[40:43], a[68:71], v[16:19], v[40:43]
  ds_read_b128 v[8:11], v73 offset:41984
  v_mfma_f32_16x16x32_bf16 v[44:47], a[196:199], v[12:15], v[44:47]
  s_add_u32 s36, s32, 16384
  s_add_u32 m0, s34, s36
  s_add_u32 s36, s35, s36
  buffer_load_dwordx4 v1, s[4:7], s36 offen offset:0 sc1 lds
  v_mfma_f32_16x16x32_bf16 v[48:51], a[196:199], v[16:19], v[48:51]
  s_waitcnt lgkmcnt(4)
  v_mfma_f32_16x16x32_bf16 v[36:39], a[72:75], v[20:23], v[36:39]
  ds_read_b128 v[12:15], v73 offset:43008
  v_mfma_f32_16x16x32_bf16 v[40:43], a[72:75], v[24:27], v[40:43]
  ds_read_b128 v[16:19], v73 offset:44032
  v_mfma_f32_16x16x32_bf16 v[44:47], a[200:203], v[20:23], v[44:47]
  buffer_load_dwordx4 v1, s[4:7], s36 offen offset:1024 sc1 lds
  v_mfma_f32_16x16x32_bf16 v[48:51], a[200:203], v[24:27], v[48:51]
  s_waitcnt lgkmcnt(4)
  v_mfma_f32_16x16x32_bf16 v[36:39], a[76:79], v[28:31], v[36:39]
  ds_read_b128 v[20:23], v73 offset:45056
  v_mfma_f32_16x16x32_bf16 v[40:43], a[76:79], v[32:35], v[40:43]
  ds_read_b128 v[24:27], v73 offset:46080
  v_mfma_f32_16x16x32_bf16 v[44:47], a[204:207], v[28:31], v[44:47]
  buffer_load_dwordx4 v1, s[4:7], s36 offen offset:2048 sc1 lds
  v_mfma_f32_16x16x32_bf16 v[48:51], a[204:207], v[32:35], v[48:51]
  s_waitcnt lgkmcnt(4)
  v_mfma_f32_16x16x32_bf16 v[36:39], a[80:83], v[4:7], v[36:39]
  ds_read_b128 v[28:31], v73 offset:47104
  v_mfma_f32_16x16x32_bf16 v[40:43], a[80:83], v[8:11], v[40:43]
  ds_read_b128 v[32:35], v73 offset:48128
  v_mfma_f32_16x16x32_bf16 v[44:47], a[208:211], v[4:7], v[44:47]
  buffer_load_dwordx4 v1, s[4:7], s36 offen offset:3072 sc1 lds
  v_mfma_f32_16x16x32_bf16 v[48:51], a[208:211], v[8:11], v[48:51]
  s_waitcnt lgkmcnt(4)
  v_mfma_f32_16x16x32_bf16 v[36:39], a[84:87], v[12:15], v[36:39]
  ds_read_b128 v[4:7], v73 offset:49152
  v_mfma_f32_16x16x32_bf16 v[40:43], a[84:87], v[16:19], v[40:43]
  ds_read_b128 v[8:11], v73 offset:50176
  v_mfma_f32_16x16x32_bf16 v[44:47], a[212:215], v[12:15], v[44:47]
  s_add_u32 s36, s32, 32768
  s_add_u32 m0, s34, s36
  s_add_u32 s36, s35, s36
  buffer_load_dwordx4 v1, s[4:7], s36 offen offset:0 sc1 lds
  v_mfma_f32_16x16x32_bf16 v[48:51], a[212:215], v[16:19], v[48:51]
  s_waitcnt lgkmcnt(4)
  v_mfma_f32_16x16x32_bf16 v[36:39], a[88:91], v[20:23], v[36:39]
  ds_read_b128 v[12:15], v73 offset:51200
  v_mfma_f32_16x16x32_bf16 v[40:43], a[88:91], v[24:27], v[40:43]
  ds_read_b128 v[16:19], v73 offset:52224
  v_mfma_f32_16x16x32_bf16 v[44:47], a[216:219], v[20:23], v[44:47]
  buffer_load_dwordx4 v1, s[4:7], s36 offen offset:1024 sc1 lds
  v_mfma_f32_16x16x32_bf16 v[48:51], a[216:219], v[24:27], v[48:51]
  s_waitcnt lgkmcnt(4)
  v_mfma_f32_16x16x32_bf16 v[36:39], a[92:95], v[28:31], v[36:39]
  ds_read_b128 v[20:23], v73 offset:53248
  v_mfma_f32_16x16x32_bf16 v[40:43], a[92:95], v[32:35], v[40:43]
  ds_read_b128 v[24:27], v73 offset:54272
  v_mfma_f32_16x16x32_bf16 v[44:47], a[220:223], v[28:31], v[44:47]
  buffer_load_dwordx4 v1, s[4:7], s36 offen offset:2048 sc1 lds
  v_mfma_f32_16x16x32_bf16 v[48:51], a[220:223], v[32:35], v[48:51]
  s_waitcnt lgkmcnt(4)
  v_mfma_f32_16x16x32_bf16 v[36:39], a[96:99], v[4:7], v[36:39]
  ds_read_b128 v[28:31], v73 offset:55296
  v_mfma_f32_16x16x32_bf16 v[40:43], a[96:99], v[8:11], v[40:43]
  ds_read_b128 v[32:35], v73 offset:56320
  v_mfma_f32_16x16x32_bf16 v[44:47], a[224:227], v[4:7], v[44:47]
  buffer_load_dwordx4 v1, s[4:7], s36 offen offset:3072 sc1 lds
  v_mfma_f32_16x16x32_bf16 v[48:51], a[224:227], v[8:11], v[48:51]
  s_waitcnt lgkmcnt(4)
  v_mfma_f32_16x16x32_bf16 v[36:39], a[100:103], v[12:15], v[36:39]
  ds_read_b128 v[4:7], v73 offset:57344
  v_mfma_f32_16x16x32_bf16 v[40:43], a[100:103], v[16:19], v[40:43]
  ds_read_b128 v[8:11], v73 offset:58368
  v_mfma_f32_16x16x32_bf16 v[44:47], a[228:231], v[12:15], v[44:47]
  s_add_u32 s36, s32, 49152
  s_add_u32 m0, s34, s36
  s_add_u32 s36, s35, s36
  buffer_load_dwordx4 v1, s[4:7], s36 offen offset:0 sc1 lds
  v_mfma_f32_16x16x32_bf16 v[48:51], a[228:231], v[16:19], v[48:51]
  s_waitcnt lgkmcnt(4)
  v_mfma_f32_16x16x32_bf16 v[36:39], a[104:107], v[20:23], v[36:39]
  ds_read_b128 v[12:15], v73 offset:59392
  v_mfma_f32_16x16x32_bf16 v[40:43], a[104:107], v[24:27], v[40:43]
  ds_read_b128 v[16:19], v73 offset:60416
  v_mfma_f32_16x16x32_bf16 v[44:47], a[232:235], v[20:23], v[44:47]
  buffer_load_dwordx4 v1, s[4:7], s36 offen offset:1024 sc1 lds
  v_mfma_f32_16x16x32_bf16 v[48:51], a[232:235], v[24:27], v[48:51]
  s_waitcnt lgkmcnt(4)
  v_mfma_f32_16x16x32_bf16 v[36:39], a[108:111], v[28:31], v[36:39]
  ds_read_b128 v[20:23], v73 offset:61440
  v_mfma_f32_16x16x32_bf16 v[40:43], a[108:111], v[32:35], v[40:43]
  ds_read_b128 v[24:27], v73 offset:62464
  v_mfma_f32_16x16x32_bf16 v[44:47], a[236:239], v[28:31], v[44:47]
  buffer_load_dwordx4 v1, s[4:7], s36 offen offset:2048 sc1 lds
  v_mfma_f32_16x16x32_bf16 v[48:51], a[236:239], v[32:35], v[48:51]
  s_waitcnt lgkmcnt(4)
  v_mfma_f32_16x16x32_bf16 v[36:39], a[112:115], v[4:7], v[36:39]
  ds_read_b128 v[28:31], v73 offset:63488
  v_mfma_f32_16x16x32_bf16 v[40:43], a[112:115], v[8:11], v[40:43]
  ds_read_b128 v[32:35], v73 offset:64512
  v_mfma_f32_16x16x32_bf16 v[44:47], a[240:243], v[4:7], v[44:47]
  buffer_load_dwordx4 v1, s[4:7], s36 offen offset:3072 sc1 lds
  v_mfma_f32_16x16x32_bf16 v[48:51], a[240:243], v[8:11], v[48:51]
  s_waitcnt lgkmcnt(4)
  v_mfma_f32_16x16x32_bf16 v[36:39], a[116:119], v[12:15], v[36:39]
  v_mfma_f32_16x16x32_bf16 v[40:43], a[116:119], v[16:19], v[40:43]
  v_mfma_f32_16x16x32_bf16 v[44:47], a[244:247], v[12:15], v[44:47]
  v_mfma_f32_16x16x32_bf16 v[48:51], a[244:247], v[16:19], v[48:51]
  s_waitcnt lgkmcnt(2)
  v_mfma_f32_16x16x32_bf16 v[36:39], a[120:123], v[20:23], v[36:39]
  v_mfma_f32_16x16x32_bf16 v[40:43], a[120:123], v[24:27], v[40:43]
  v_mfma_f32_16x16x32_bf16 v[44:47], a[248:251], v[20:23], v[44:47]
  v_mfma_f32_16x16x32_bf16 v[48:51], a[248:251], v[24:27], v[48:51]
  s_waitcnt lgkmcnt(0)
  v_mfma_f32_16x16x32_bf16 v[36:39], a[124:127], v[28:31], v[36:39]
  v_mfma_f32_16x16x32_bf16 v[40:43], a[124:127], v[32:35], v[40:43]
  v_mfma_f32_16x16x32_bf16 v[44:47], a[252:255], v[28:31], v[44:47]
  v_mfma_f32_16x16x32_bf16 v[48:51], a[252:255], v[32:35], v[48:51]
  s_nop 7
  s_branch L_F1_epi
L_F1_nopf:
  s_waitcnt lgkmcnt(4)
  v_mfma_f32_16x16x32_bf16 v[36:39], a[52:55], v[12:15], v[36:39]
  ds_read_b128 v[4:7], v73 offset:32768
  v_mfma_f32_16x16x32_bf16 v[40:43], a[52:55], v[16:19], v[40:43]
  ds_read_b128 v[8:11], v73 offset:33792
  v_mfma_f32_16x16x32_bf16 v[44:47], a[180:183], v[12:15], v[44:47]
  v_mfma_f32_16x16x32_bf16 v[48:51], a[180:183], v[16:19], v[48:51]
  s_waitcnt lgkmcnt(4)
  v_mfma_f32_16x16x32_bf16 v[36:39], a[56:59], v[20:23], v[36:39]
  ds_read_b128 v[12:15], v73 offset:34816
  v_mfma_f32_16x16x32_bf16 v[40:43], a[56:59], v[24:27], v[40:43]
  ds_read_b128 v[16:19], v73 offset:35840
  v_mfma_f32_16x16x32_bf16 v[44:47], a[184:187], v[20:23], v[44:47]
  v_mfma_f32_16x16x32_bf16 v[48:51], a[184:187], v[24:27], v[48:51]
  s_waitcnt lgkmcnt(4)
  v_mfma_f32_16x16x32_bf16 v[36:39], a[60:63], v[28:31], v[36:39]
  ds_read_b128 v[20:23], v73 offset:36864
  v_mfma_f32_16x16x32_bf16 v[40:43], a[60:63], v[32:35], v[40:43]
  ds_read_b128 v[24:27], v73 offset:37888
  v_mfma_f32_16x16x32_bf16 v[44:47], a[188:191], v[28:31], v[44:47]
  v_mfma_f32_16x16x32_bf16 v[48:51], a[188:191], v[32:35], v[48:51]
  s_waitcnt lgkmcnt(4)
  v_mfma_f32_16x16x32_bf16 v[36:39], a[64:67], v[4:7], v[36:39]
  ds_read_b128 v[28:31], v73 offset:38912
  v_mfma_f32_16x16x32_bf16 v[40:43], a[64:67], v[8:11], v[40:43]
  ds_read_b128 v[32:35], v73 offset:39936
  v_mfma_f32_16x16x32_bf16 v[44:47], a[192:195], v[4:7], v[44:47]
  v_mfma_f32_16x16x32_bf16 v[48:51], a[192:195], v[8:11], v[48:51]
  s_waitcnt lgkmcnt(4)
  v_mfma_f32_16x16x32_bf16 v[36:39], a[68:71], v[12:15], v[36:39]
  ds_read_b128 v[4:7], v73 offset:40960
  v_mfma_f32_16x16x32_bf16 v[40:43], a[68:71], v[16:19], v[40:43]
  ds_read_b128 v[8:11], v73 offset:41984
  v_mfma_f32_16x16x32_bf16 v[44:47], a[196:199], v[12:15], v[44:47]
  v_mfma_f32_16x16x32_bf16 v[48:51], a[196:199], v[16:19], v[48:51]
  s_waitcnt lgkmcnt(4)
  v_mfma_f32_16x16x32_bf16 v[36:39], a[72:75], v[20:23], v[36:39]
  ds_read_b128 v[12:15], v73 offset:43008
  v_mfma_f32_16x16x32_bf16 v[40:43], a[72:75], v[24:27], v[40:43]
  ds_read_b128 v[16:19], v73 offset:44032
  v_mfma_f32_16x16x32_bf16 v[44:47], a[200:203], v[20:23], v[44:47]
  v_mfma_f32_16x16x32_bf16 v[48:51], a[200:203], v[24:27], v[48:51]
  s_waitcnt lgkmcnt(4)
  v_mfma_f32_16x16x32_bf16 v[36:39], a[76:79], v[28:31], v[36:39]
  ds_read_b128 v[20:23], v73 offset:45056
  v_mfma_f32_16x16x32_bf16 v[40:43], a[76:79], v[32:35], v[40:43]
  ds_read_b128 v[24:27], v73 offset:46080
  v_mfma_f32_16x16x32_bf16 v[44:47], a[204:207], v[28:31], v[44:47]
  v_mfma_f32_16x16x32_bf16 v[48:51], a[204:207], v[32:35], v[48:51]
  s_waitcnt lgkmcnt(4)
  v_mfma_f32_16x16x32_bf16 v[36:39], a[80:83], v[4:7], v[36:39]
  ds_read_b128 v[28:31], v73 offset:47104
  v_mfma_f32_16x16x32_bf16 v[40:43], a[80:83], v[8:11], v[40:43]
  ds_read_b128 v[32:35], v73 offset:48128
  v_mfma_f32_16x16x32_bf16 v[44:47], a[208:211], v[4:7], v[44:47]
  v_mfma_f32_16x16x32_bf16 v[48:51], a[208:211], v[8:11], v[48:51]
  s_waitcnt lgkmcnt(4)
  v_mfma_f32_16x16x32_bf16 v[36:39], a[84:87], v[12:15], v[36:39]
  ds_read_b128 v[4:7], v73 offset:49152
  v_mfma_f32_16x16x32_bf16 v[40:43], a[84:87], v[16:19], v[40:43]
  ds_read_b128 v[8:11], v73 offset:50176
  v_mfma_f32_16x16x32_bf16 v[44:47], a[212:215], v[12:15], v[44:47]
  v_mfma_f32_16x16x32_bf16 v[48:51], a[212:215], v[16:19], v[48:51]
  s_waitcnt lgkmcnt(4)
  v_mfma_f32_16x16x32_bf16 v[36:39], a[88:91], v[20:23], v[36:39]
  ds_read_b128 v[12:15], v73 offset:51200
  v_mfma_f32_16x16x32_bf16 v[40:43], a[88:91], v[24:27], v[40:43]
  ds_read_b128 v[16:19], v73 offset:52224
  v_mfma_f32_16x16x32_bf16 v[44:47], a[216:219], v[20:23], v[44:47]
  v_mfma_f32_16x16x32_bf16 v[48:51], a[216:219], v[24:27], v[48:51]
  s_waitcnt lgkmcnt(4)
  v_mfma_f32_16x16x32_bf16 v[36:39], a[92:95], v[28:31], v[36:39]
  ds_read_b128 v[20:23], v73 offset:53248
  v_mfma_f32_16x16x32_bf16 v[40:43], a[92:95], v[32:35], v[40:43]
  ds_read_b128 v[24:27], v73 offset:54272
  v_mfma_f32_16x16x32_bf16 v[44:47], a[220:223], v[28:31], v[44:47]
  v_mfma_f32_16x16x32_bf16 v[48:51], a[220:223], v[32:35], v[48:51]
  s_waitcnt lgkmcnt(4)
  v_mfma_f32_16x16x32_bf16 v[36:39], a[96:99], v[4:7], v[36:39]
  ds_read_b128 v[28:31], v73 offset:55296
  v_mfma_f32_16x16x32_bf16 v[40:43], a[96:99], v[8:11], v[40:43]
  ds_read_b128 v[32:35], v73 offset:56320
  v_mfma_f32_16x16x32_bf16 v[44:47], a[224:227], v[4:7], v[44:47]
  v_mfma_f32_16x16x32_bf16 v[48:51], a[224:227], v[8:11], v[48:51]
  s_waitcnt lgkmcnt(4)
  v_mfma_f32_16x16x32_bf16 v[36:39], a[100:103], v[12:15], v[36:39]
  ds_read_b128 v[4:7], v73 offset:57344
  v_mfma_f32_16x16x32_bf16 v[40:43], a[100:103], v[16:19], v[40:43]
  ds_read_b128 v[8:11], v73 offset:58368
  v_mfma_f32_16x16x32_bf16 v[44:47], a[228:231], v[12:15], v[44:47]
  v_mfma_f32_16x16x32_bf16 v[48:51], a[228:231], v[16:19], v[48:51]
  s_waitcnt lgkmcnt(4)
  v_mfma_f32_16x16x32_bf16 v[36:39], a[104:107], v[20:23], v[36:39]
  ds_read_b128 v[12:15], v73 offset:59392
  v_mfma_f32_16x16x32_bf16 v[40:43], a[104:107], v[24:27], v[40:43]
  ds_read_b128 v[16:19], v73 offset:60416
  v_mfma_f32_16x16x32_bf16 v[44:47], a[232:235], v[20:23], v[44:47]
  v_mfma_f32_16x16x32_bf16 v[48:51], a[232:235], v[24:27], v[48:51]
  s_waitcnt lgkmcnt(4)
  v_mfma_f32_16x16x32_bf16 v[36:39], a[108:111], v[28:31], v[36:39]
  ds_read_b128 v[20:23], v73 offset:61440
  v_mfma_f32_16x16x32_bf16 v[40:43], a[108:111], v[32:35], v[40:43]
  ds_read_b128 v[24:27], v73 offset:62464
  v_mfma_f32_16x16x32_bf16 v[44:47], a[236:239], v[28:31], v[44:47]
  v_mfma_f32_16x16x32_bf16 v[48:51], a[236:239], v[32:35], v[48:51]
  s_waitcnt lgkmcnt(4)
  v_mfma_f32_16x16x32_bf16 v[36:39], a[112:115], v[4:7], v[36:39]
  ds_read_b128 v[28:31], v73 offset:63488
  v_mfma_f32_16x16x32_bf16 v[40:43], a[112:115], v[8:11], v[40:43]
  ds_read_b128 v[32:35], v73 offset:64512
  v_mfma_f32_16x16x32_bf16 v[44:47], a[240:243], v[4:7], v[44:47]
  v_mfma_f32_16x16x32_bf16 v[48:51], a[240:243], v[8:11], v[48:51]
  s_waitcnt lgkmcnt(4)
  v_mfma_f32_16x16x32_bf16 v[36:39], a[116:119], v[12:15], v[36:39]
  v_mfma_f32_16x16x32_bf16 v[40:43], a[116:119], v[16:19], v[40:43]
  v_mfma_f32_16x16x32_bf16 v[44:47], a[244:247], v[12:15], v[44:47]
  v_mfma_f32_16x16x32_bf16 v[48:51], a[244:247], v[16:19], v[48:51]
  s_waitcnt lgkmcnt(2)
  v_mfma_f32_16x16x32_bf16 v[36:39], a[120:123], v[20:23], v[36:39]
  v_mfma_f32_16x16x32_bf16 v[40:43], a[120:123], v[24:27], v[40:43]
  v_mfma_f32_16x16x32_bf16 v[44:47], a[248:251], v[20:23], v[44:47]
  v_mfma_f32_16x16x32_bf16 v[48:51], a[248:251], v[24:27], v[48:51]
  s_waitcnt lgkmcnt(0)
  v_mfma_f32_16x16x32_bf16 v[36:39], a[124:127], v[28:31], v[36:39]
  v_mfma_f32_16x16x32_bf16 v[40:43], a[124:127], v[32:35], v[40:43]
  v_mfma_f32_16x16x32_bf16 v[44:47], a[252:255], v[28:31], v[44:47]
  v_mfma_f32_16x16x32_bf16 v[48:51], a[252:255], v[32:35], v[48:51]
L_F1_epi:
  s_nop 4
  v_mul_f32 v52, s37, v36
  v_mul_f32 v53, s37, v37
  v_mul_f32 v54, s37, v38
  v_mul_f32 v55, s37, v39
  v_mul_f32 v56, s37, v40
  v_mul_f32 v57, s37, v41
  v_mul_f32 v58, s37, v42
  v_mul_f32 v59, s37, v43
  v_exp_f32 v52, v52
  v_exp_f32 v53, v53
  v_exp_f32 v54, v54
  v_exp_f32 v55, v55
  v_exp_f32 v56, v56
  v_exp_f32 v57, v57
  v_exp_f32 v58, v58
  v_exp_f32 v59, v59
  v_pk_mul_f32 v[36:37], v[36:37], v[44:45]
  v_pk_mul_f32 v[38:39], v[38:39], v[46:47]
  v_pk_mul_f32 v[40:41], v[40:41], v[48:49]
  v_pk_mul_f32 v[42:43], v[42:43], v[50:51]
  v_add_f32 v52, 1.0, v52
  v_add_f32 v53, 1.0, v53
  v_add_f32 v54, 1.0, v54
  v_add_f32 v55, 1.0, v55
  v_add_f32 v56, 1.0, v56
  v_add_f32 v57, 1.0, v57
  v_add_f32 v58, 1.0, v58
  v_add_f32 v59, 1.0, v59
  v_rcp_f32 v52, v52
  v_rcp_f32 v53, v53
  v_rcp_f32 v54, v54
  v_rcp_f32 v55, v55
  v_rcp_f32 v56, v56
  v_rcp_f32 v57, v57
  v_rcp_f32 v58, v58
  v_rcp_f32 v59, v59
  v_pk_mul_f32 v[36:37], v[36:37], v[52:53]
  v_pk_mul_f32 v[38:39], v[38:39], v[54:55]
  v_pk_mul_f32 v[40:41], v[40:41], v[56:57]
  v_pk_mul_f32 v[42:43], v[42:43], v[58:59]
  v_cvt_pk_bf16_f32 v60, v36, v37
  v_cvt_pk_bf16_f32 v61, v38, v39
  v_cvt_pk_bf16_f32 v62, v40, v41
  v_cvt_pk_bf16_f32 v63, v42, v43
  s_nop 0
  v_permlane32_swap_b32 v60, v62
  v_permlane32_swap_b32 v61, v63
  buffer_store_dwordx4 v[60:63], v68, s[4:7], s31 offen sc1
  s_add_u32 s25, s25, 1
  s_add_u32 s31, s31, 229376
  s_branch L_F1_top
L_F2:
  s_load_dwordx2 s[8:9], s[0:1], 80
  s_mov_b32 s10, 7340032
  s_mov_b32 s11, 0x20000
  s_waitcnt lgkmcnt(0)
  s_lshr_b32 s44, s21, 3
  s_mul_i32 s44, s44, 2424832
  s_and_b32 s45, s21, 7
  s_lshl_b32 s45, s45, 8
  s_add_u32 s44, s44, s45
  s_add_u32 s45, s44, 128
  v_bfe_u32 v40, v0, 5, 1
  v_mul_u32_u24 v40, 8192, v40
  v_bfe_u32 v41, v0, 4, 1
  v_mul_u32_u24 v41, 4096, v41
  v_add_u32 v40, v40, v41
  v_bfe_u32 v41, v0, 3, 1
  v_mul_u32_u24 v41, 2048, v41
  v_add_u32 v40, v40, v41
  v_lshrrev_b32 v41, 3, v0
  v_and_b32 v41, 6, v41
  v_xor_b32 v41, v41, v0
  v_and_b32 v41, 7, v41
  v_lshl_add_u32 v40, v41, 4, v40
  s_lshr_b32 s40, s20, 1
  s_mul_i32 s40, s40, 16384
  s_and_b32 s41, s20, 1
  s_mul_i32 s41, s41, 32768
  s_add_u32 s40, s40, s41
  v_add_u32 v40, s40, v40
  v_bfe_u32 v41, v0, 3, 2
  v_xor_b32 v41, s20, v41
  v_lshlrev_b32 v41, 5, v41
  v_lshrrev_b32 v42, 2, v0
  v_lshl_add_u32 v42, v42, 7, v41
  v_and_b32 v41, 3, v0
  v_lshl_add_u32 v42, v41, 3, v42
  v_add_u32 v43, 0x10000, v42
  v_add_u32 v44, s44, v40
  v_add_u32 v45, s45, v40
  s_lshl_b32 s41, s20, 10
  s_add_u32 m0, s41, 0
  s_mov_b32 s42, 0
  buffer_load_dwordx4 v44, s[8:11], s42 offen lds
  s_add_u32 m0, s41, 4096
  s_mov_b32 s42, 65536
  buffer_load_dwordx4 v44, s[8:11], s42 offen lds
  s_add_u32 m0, s41, 8192
  s_mov_b32 s42, 131072
  buffer_load_dwordx4 v44, s[8:11], s42 offen lds
  s_add_u32 m0, s41, 12288
  s_mov_b32 s42, 196608
  buffer_load_dwordx4 v44, s[8:11], s42 offen lds
  s_add_u32 m0, s41, 16384
  s_mov_b32 s42, 262144
  buffer_load_dwordx4 v44, s[8:11], s42 offen lds
  s_add_u32 m0, s41, 20480
  s_mov_b32 s42, 327680
  buffer_load_dwordx4 v44, s[8:11], s42 offen lds
  s_add_u32 m0, s41, 24576
  s_mov_b32 s42, 393216
  buffer_load_dwordx4 v44, s[8:11], s42 offen lds
  s_add_u32 m0, s41, 28672
  s_mov_b32 s42, 458752
  buffer_load_dwordx4 v44, s[8:11], s42 offen lds
  s_add_u32 m0, s41, 32768
  s_mov_b32 s42, 524288
  buffer_load_dwordx4 v44, s[8:11], s42 offen lds
  s_add_u32 m0, s41, 36864
  s_mov_b32 s42, 589824
  buffer_load_dwordx4 v44, s[8:11], s42 offen lds
  s_add_u32 m0, s41, 40960
  s_mov_b32 s42, 655360
  buffer_load_dwordx4 v44, s[8:11], s42 offen lds
  s_add_u32 m0, s41, 45056
  s_mov_b32 s42, 720896
  buffer_load_dwordx4 v44, s[8:11], s42 offen lds
  s_add_u32 m0, s41, 49152
  s_mov_b32 s42, 786432
  buffer_load_dwordx4 v44, s[8:11], s42 offen lds
  s_add_u32 m0, s41, 53248
  s_mov_b32 s42, 851968
  buffer_load_dwordx4 v44, s[8:11], s42 offen lds
  s_add_u32 m0, s41, 57344
  s_mov_b32 s42, 917504
  buffer_load_dwordx4 v44, s[8:11], s42 offen lds
  s_add_u32 m0, s41, 61440
  s_mov_b32 s42, 983040
  buffer_load_dwordx4 v44, s[8:11], s42 offen lds
  s_add_u32 m0, s41, 65536
  s_mov_b32 s42, 1048576
  buffer_load_dwordx4 v44, s[8:11], s42 offen lds
  s_add_u32 m0, s41, 69632
  s_mov_b32 s42, 1114112
  buffer_load_dwordx4 v44, s[8:11], s42 offen lds
  s_add_u32 m0, s41, 73728
  s_mov_b32 s42, 1179648
  buffer_load_dwordx4 v44, s[8:11], s42 offen lds
  s_add_u32 m0, s41, 77824
  s_mov_b32 s42, 1245184
  buffer_load_dwordx4 v44, s[8:11], s42 offen lds
  s_add_u32 m0, s41, 81920
  s_mov_b32 s42, 1310720
  buffer_load_dwordx4 v44, s[8:11], s42 offen lds
  s_add_u32 m0, s41, 86016
  s_mov_b32 s42, 1376256
  buffer_load_dwordx4 v44, s[8:11], s42 offen lds
  s_add_u32 m0, s41, 90112
  s_mov_b32 s42, 1441792
  buffer_load_dwordx4 v44, s[8:11], s42 offen lds
  s_add_u32 m0, s41, 94208
  s_mov_b32 s42, 1507328
  buffer_load_dwordx4 v44, s[8:11], s42 offen lds
  s_add_u32 m0, s41, 98304
  s_mov_b32 s42, 1572864
  buffer_load_dwordx4 v44, s[8:11], s42 offen lds
  s_add_u32 m0, s41, 102400
  s_mov_b32 s42, 1638400
  buffer_load_dwordx4 v44, s[8:11], s42 offen lds
  s_add_u32 m0, s41, 106496
  s_mov_b32 s42, 1703936
  buffer_load_dwordx4 v44, s[8:11], s42 offen lds
  s_add_u32 m0, s41, 110592
  s_mov_b32 s42, 1769472
  buffer_load_dwordx4 v44, s[8:11], s42 offen lds
  s_waitcnt vmcnt(24) lgkmcnt(0)
  s_barrier
  s_add_u32 m0, s41, 114688
  s_mov_b32 s42, 1835008
  buffer_load_dwordx4 v44, s[8:11], s42 offen lds
  s_add_u32 m0, s41, 118784
  s_mov_b32 s42, 1900544
  buffer_load_dwordx4 v44, s[8:11], s42 offen lds
  s_add_u32 m0, s41, 122880
  s_mov_b32 s42, 1966080
  buffer_load_dwordx4 v44, s[8:11], s42 offen lds
  s_add_u32 m0, s41, 126976
  s_mov_b32 s42, 2031616
  buffer_load_dwordx4 v44, s[8:11], s42 offen lds
  ds_read_b64_tr_b16 a[0:1], v42 offset:0
  ds_read_b64_tr_b16 a[2:3], v42 offset:2048
  ds_read_b64_tr_b16 a[4:5], v42 offset:4096
  ds_read_b64_tr_b16 a[6:7], v42 offset:6144
  ds_read_b64_tr_b16 a[8:9], v42 offset:8192
  ds_read_b64_tr_b16 a[10:11], v42 offset:10240
  ds_read_b64_tr_b16 a[12:13], v42 offset:12288
  ds_read_b64_tr_b16 a[14:15], v42 offset:14336
  s_waitcnt vmcnt(24) lgkmcnt(0)
  s_barrier
  s_add_u32 m0, s41, 0
  s_mov_b32 s42, 2097152
  buffer_load_dwordx4 v44, s[8:11], s42 offen lds
  s_add_u32 m0, s41, 4096
  s_mov_b32 s42, 2162688
  buffer_load_dwordx4 v44, s[8:11], s42 offen lds
  s_add_u32 m0, s41, 8192
  s_mov_b32 s42, 2228224
  buffer_load_dwordx4 v44, s[8:11], s42 offen lds
  s_add_u32 m0, s41, 12288
  s_mov_b32 s42, 2293760
  buffer_load_dwordx4 v44, s[8:11], s42 offen lds
  ds_read_b64_tr_b16 a[16:17], v42 offset:16384
  ds_read_b64_tr_b16 a[18:19], v42 offset:18432
  ds_read_b64_tr_b16 a[20:21], v42 offset:20480
  ds_read_b64_tr_b16 a[22:23], v42 offset:22528
  ds_read_b64_tr_b16 a[24:25], v42 offset:24576
  ds_read_b64_tr_b16 a[26:27], v42 offset:26624
  ds_read_b64_tr_b16 a[28:29], v42 offset:28672
  ds_read_b64_tr_b16 a[30:31], v42 offset:30720
  s_waitcnt vmcnt(24) lgkmcnt(0)
  s_barrier
  s_add_u32 m0, s41, 16384
  s_mov_b32 s42, 2359296
  buffer_load_dwordx4 v44, s[8:11], s42 offen lds
  s_add_u32 m0, s41, 20480
  s_mov_b32 s42, 2424832
  buffer_load_dwordx4 v44, s[8:11], s42 offen lds
  s_add_u32 m0, s41, 24576
  s_mov_b32 s42, 0
  buffer_load_dwordx4 v45, s[8:11], s42 offen lds
  s_add_u32 m0, s41, 28672
  s_mov_b32 s42, 65536
  buffer_load_dwordx4 v45, s[8:11], s42 offen lds
  ds_read_b64_tr_b16 a[32:33], v42 offset:32768
  ds_read_b64_tr_b16 a[34:35], v42 offset:34816
  ds_read_b64_tr_b16 a[36:37], v42 offset:36864
  ds_read_b64_tr_b16 a[38:39], v42 offset:38912
  ds_read_b64_tr_b16 a[40:41], v42 offset:40960
  ds_read_b64_tr_b16 a[42:43], v42 offset:43008
  ds_read_b64_tr_b16 a[44:45], v42 offset:45056
  ds_read_b64_tr_b16 a[46:47], v42 offset:47104
  s_waitcnt vmcnt(24) lgkmcnt(0)
  s_barrier
  s_add_u32 m0, s41, 32768
  s_mov_b32 s42, 131072
  buffer_load_dwordx4 v45, s[8:11], s42 offen lds
  s_add_u32 m0, s41, 36864
  s_mov_b32 s42, 196608
  buffer_load_dwordx4 v45, s[8:11], s42 offen lds
  s_add_u32 m0, s41, 40960
  s_mov_b32 s42, 262144
  buffer_load_dwordx4 v45, s[8:11], s42 offen lds
  s_add_u32 m0, s41, 45056
  s_mov_b32 s42, 327680
  buffer_load_dwordx4 v45, s[8:11], s42 offen lds
  ds_read_b64_tr_b16 a[48:49], v42 offset:49152
  ds_read_b64_tr_b16 a[50:51], v42 offset:51200
  ds_read_b64_tr_b16 a[52:53], v42 offset:53248
  ds_read_b64_tr_b16 a[54:55], v42 offset:55296
  ds_read_b64_tr_b16 a[56:57], v42 offset:57344
  ds_read_b64_tr_b16 a[58:59], v42 offset:59392
  ds_read_b64_tr_b16 a[60:61], v42 offset:61440
  ds_read_b64_tr_b16 a[62:63], v42 offset:63488
  s_waitcnt vmcnt(24) lgkmcnt(0)
  s_barrier
  s_add_u32 m0, s41, 49152
  s_mov_b32 s42, 393216
  buffer_load_dwordx4 v45, s[8:11], s42 offen lds
  s_add_u32 m0, s41, 53248
  s_mov_b32 s42, 458752
  buffer_load_dwordx4 v45, s[8:11], s42 offen lds
  s_add_u32 m0, s41, 57344
  s_mov_b32 s42, 524288
  buffer_load_dwordx4 v45, s[8:11], s42 offen lds
  s_add_u32 m0, s41, 61440
  s_mov_b32 s42, 589824
  buffer_load_dwordx4 v45, s[8:11], s42 offen lds
  ds_read_b64_tr_b16 a[64:65], v43 offset:0
  ds_read_b64_tr_b16 a[66:67], v43 offset:2048
  ds_read_b64_tr_b16 a[68:69], v43 offset:4096
  ds_read_b64_tr_b16 a[70:71], v43 offset:6144
  ds_read_b64_tr_b16 a[72:73], v43 offset:8192
  ds_read_b64_tr_b16 a[74:75], v43 offset:10240
  ds_read_b64_tr_b16 a[76:77], v43 offset:12288
  ds_read_b64_tr_b16 a[78:79], v43 offset:14336
  s_waitcnt vmcnt(24) lgkmcnt(0)
  s_barrier
  s_add_u32 m0, s41, 65536
  s_mov_b32 s42, 655360
  buffer_load_dwordx4 v45, s[8:11], s42 offen lds
  s_add_u32 m0, s41, 69632
  s_mov_b32 s42, 720896
  buffer_load_dwordx4 v45, s[8:11], s42 offen lds
  s_add_u32 m0, s41, 73728
  s_mov_b32 s42, 786432
  buffer_load_dwordx4 v45, s[8:11], s42 offen lds
  s_add_u32 m0, s41, 77824
  s_mov_b32 s42, 851968
  buffer_load_dwordx4 v45, s[8:11], s42 offen lds
  ds_read_b64_tr_b16 a[80:81], v43 offset:16384
  ds_read_b64_tr_b16 a[82:83], v43 offset:18432
  ds_read_b64_tr_b16 a[84:85], v43 offset:20480
  ds_read_b64_tr_b16 a[86:87], v43 offset:22528
  ds_read_b64_tr_b16 a[88:89], v43 offset:24576
  ds_read_b64_tr_b16 a[90:91], v43 offset:26624
  ds_read_b64_tr_b16 a[92:93], v43 offset:28672
  ds_read_b64_tr_b16 a[94:95], v43 offset:30720
  s_waitcnt vmcnt(24) lgkmcnt(0)
  s_barrier
  s_add_u32 m0, s41, 81920
  s_mov_b32 s42, 917504
  buffer_load_dwordx4 v45, s[8:11], s42 offen lds
  s_add_u32 m0, s41, 86016
  s_mov_b32 s42, 983040
  buffer_load_dwordx4 v45, s[8:11], s42 offen lds
  s_add_u32 m0, s41, 90112
  s_mov_b32 s42, 1048576
  buffer_load_dwordx4 v45, s[8:11], s42 offen lds
  s_add_u32 m0, s41, 94208
  s_mov_b32 s42, 1114112
  buffer_load_dwordx4 v45, s[8:11], s42 offen lds
  ds_read_b64_tr_b16 a[96:97], v43 offset:32768
  ds_read_b64_tr_b16 a[98:99], v43 offset:34816
  ds_read_b64_tr_b16 a[100:101], v43 offset:36864
  ds_read_b64_tr_b16 a[102:103], v43 offset:38912
  ds_read_b64_tr_b16 a[104:105], v43 offset:40960
  ds_read_b64_tr_b16 a[106:107], v43 offset:43008
  ds_read_b64_tr_b16 a[108:109], v43 offset:45056
  ds_read_b64_tr_b16 a[110:111], v43 offset:47104
  s_waitcnt vmcnt(24) lgkmcnt(0)
  s_barrier
  s_add_u32 m0, s41, 98304
  s_mov_b32 s42, 1179648
  buffer_load_dwordx4 v45, s[8:11], s42 offen lds
  s_add_u32 m0, s41, 102400
  s_mov_b32 s42, 1245184
  buffer_load_dwordx4 v45, s[8:11], s42 offen lds
  s_add_u32 m0, s41, 106496
  s_mov_b32 s42, 1310720
  buffer_load_dwordx4 v45, s[8:11], s42 offen lds
  s_add_u32 m0, s41, 110592
  s_mov_b32 s42, 1376256
  buffer_load_dwordx4 v45, s[8:11], s42 offen lds
  ds_read_b64_tr_b16 a[112:113], v43 offset:49152
  ds_read_b64_tr_b16 a[114:115], v43 offset:51200
  ds_read_b64_tr_b16 a[116:117], v43 offset:53248
  ds_read_b64_tr_b16 a[118:119], v43 offset:55296
  ds_read_b64_tr_b16 a[120:121], v43 offset:57344
  ds_read_b64_tr_b16 a[122:123], v43 offset:59392
  ds_read_b64_tr_b16 a[124:125], v43 offset:61440
  ds_read_b64_tr_b16 a[126:127], v43 offset:63488
  s_waitcnt vmcnt(24) lgkmcnt(0)
  s_barrier
  s_add_u32 m0, s41, 114688
  s_mov_b32 s42, 1441792
  buffer_load_dwordx4 v45, s[8:11], s42 offen lds
  s_add_u32 m0, s41, 118784
  s_mov_b32 s42, 1507328
  buffer_load_dwordx4 v45, s[8:11], s42 offen lds
  s_add_u32 m0, s41, 122880
  s_mov_b32 s42, 1572864
  buffer_load_dwordx4 v45, s[8:11], s42 offen lds
  s_add_u32 m0, s41, 126976
  s_mov_b32 s42, 1638400
  buffer_load_dwordx4 v45, s[8:11], s42 offen lds
  ds_read_b64_tr_b16 a[128:129], v42 offset:0
  ds_read_b64_tr_b16 a[130:131], v42 offset:2048
  ds_read_b64_tr_b16 a[132:133], v42 offset:4096
  ds_read_b64_tr_b16 a[134:135], v42 offset:6144
  ds_read_b64_tr_b16 a[136:137], v42 offset:8192
  ds_read_b64_tr_b16 a[138:139], v42 offset:10240
  ds_read_b64_tr_b16 a[140:141], v42 offset:12288
  ds_read_b64_tr_b16 a[142:143], v42 offset:14336
  s_waitcnt vmcnt(24) lgkmcnt(0)
  s_barrier
  s_add_u32 m0, s41, 0
  s_mov_b32 s42, 1703936
  buffer_load_dwordx4 v45, s[8:11], s42 offen lds
  s_add_u32 m0, s41, 4096
  s_mov_b32 s42, 1769472
  buffer_load_dwordx4 v45, s[8:11], s42 offen lds
  s_add_u32 m0, s41, 8192
  s_mov_b32 s42, 1835008
  buffer_load_dwordx4 v45, s[8:11], s42 offen lds
  s_add_u32 m0, s41, 12288
  s_mov_b32 s42, 1900544
  buffer_load_dwordx4 v45, s[8:11], s42 offen lds
  ds_read_b64_tr_b16 a[144:145], v42 offset:16384
  ds_read_b64_tr_b16 a[146:147], v42 offset:18432
  ds_read_b64_tr_b16 a[148:149], v42 offset:20480
  ds_read_b64_tr_b16 a[150:151], v42 offset:22528
  ds_read_b64_tr_b16 a[152:153], v42 offset:24576
  ds_read_b64_tr_b16 a[154:155], v42 offset:26624
  ds_read_b64_tr_b16 a[156:157], v42 offset:28672
  ds_read_b64_tr_b16 a[158:159], v42 offset:30720
  s_waitcnt vmcnt(24) lgkmcnt(0)
  s_barrier
  s_add_u32 m0, s41, 16384
  s_mov_b32 s42, 1966080
  buffer_load_dwordx4 v45, s[8:11], s42 offen lds
  s_add_u32 m0, s41, 20480
  s_mov_b32 s42, 2031616
  buffer_load_dwordx4 v45, s[8:11], s42 offen lds
  s_add_u32 m0, s41, 24576
  s_mov_b32 s42, 2097152
  buffer_load_dwordx4 v45, s[8:11], s42 offen lds
  s_add_u32 m0, s41, 28672
  s_mov_b32 s42, 2162688
  buffer_load_dwordx4 v45, s[8:11], s42 offen lds
  ds_read_b64_tr_b16 a[160:161], v42 offset:32768
  ds_read_b64_tr_b16 a[162:163], v42 offset:34816
  ds_read_b64_tr_b16 a[164:165], v42 offset:36864
  ds_read_b64_tr_b16 a[166:167], v42 offset:38912
  ds_read_b64_tr_b16 a[168:169], v42 offset:40960
  ds_read_b64_tr_b16 a[170:171], v42 offset:43008
  ds_read_b64_tr_b16 a[172:173], v42 offset:45056
  ds_read_b64_tr_b16 a[174:175], v42 offset:47104
  s_waitcnt vmcnt(24) lgkmcnt(0)
  s_barrier
  s_add_u32 m0, s41, 32768
  s_mov_b32 s42, 2228224
  buffer_load_dwordx4 v45, s[8:11], s42 offen lds
  s_add_u32 m0, s41, 36864
  s_mov_b32 s42, 2293760
  buffer_load_dwordx4 v45, s[8:11], s42 offen lds
  s_add_u32 m0, s41, 40960
  s_mov_b32 s42, 2359296
  buffer_load_dwordx4 v45, s[8:11], s42 offen lds
  s_add_u32 m0, s41, 45056
  s_mov_b32 s42, 2424832
  buffer_load_dwordx4 v45, s[8:11], s42 offen lds
  ds_read_b64_tr_b16 a[176:177], v42 offset:49152
  ds_read_b64_tr_b16 a[178:179], v42 offset:51200
  ds_read_b64_tr_b16 a[180:181], v42 offset:53248
  ds_read_b64_tr_b16 a[182:183], v42 offset:55296
  ds_read_b64_tr_b16 a[184:185], v42 offset:57344
  ds_read_b64_tr_b16 a[186:187], v42 offset:59392
  ds_read_b64_tr_b16 a[188:189], v42 offset:61440
  ds_read_b64_tr_b16 a[190:191], v42 offset:63488
  s_waitcnt vmcnt(24) lgkmcnt(0)
  s_barrier
  ds_read_b64_tr_b16 a[192:193], v43 offset:0
  ds_read_b64_tr_b16 a[194:195], v43 offset:2048
  ds_read_b64_tr_b16 a[196:197], v43 offset:4096
  ds_read_b64_tr_b16 a[198:199], v43 offset:6144
  ds_read_b64_tr_b16 a[200:201], v43 offset:8192
  ds_read_b64_tr_b16 a[202:203], v43 offset:10240
  ds_read_b64_tr_b16 a[204:205], v43 offset:12288
  ds_read_b64_tr_b16 a[206:207], v43 offset:14336
  s_waitcnt vmcnt(20) lgkmcnt(0)
  s_barrier
  ds_read_b64_tr_b16 a[208:209], v43 offset:16384
  ds_read_b64_tr_b16 a[210:211], v43 offset:18432
  ds_read_b64_tr_b16 a[212:213], v43 offset:20480
  ds_read_b64_tr_b16 a[214:215], v43 offset:22528
  ds_read_b64_tr_b16 a[216:217], v43 offset:24576
  ds_read_b64_tr_b16 a[218:219], v43 offset:26624
  ds_read_b64_tr_b16 a[220:221], v43 offset:28672
  ds_read_b64_tr_b16 a[222:223], v43 offset:30720
  s_waitcnt vmcnt(16) lgkmcnt(0)
  s_barrier
  ds_read_b64_tr_b16 a[224:225], v43 offset:32768
  ds_read_b64_tr_b16 a[226:227], v43 offset:34816
  ds_read_b64_tr_b16 a[228:229], v43 offset:36864
  ds_read_b64_tr_b16 a[230:231], v43 offset:38912
  ds_read_b64_tr_b16 a[232:233], v43 offset:40960
  ds_read_b64_tr_b16 a[234:235], v43 offset:43008
  ds_read_b64_tr_b16 a[236:237], v43 offset:45056
  ds_read_b64_tr_b16 a[238:239], v43 offset:47104
  s_waitcnt vmcnt(12) lgkmcnt(0)
  s_barrier
  ds_read_b64_tr_b16 a[240:241], v43 offset:49152
  ds_read_b64_tr_b16 a[242:243], v43 offset:51200
  ds_read_b64_tr_b16 a[244:245], v43 offset:53248
  ds_read_b64_tr_b16 a[246:247], v43 offset:55296
  ds_read_b64_tr_b16 a[248:249], v43 offset:57344
  ds_read_b64_tr_b16 a[250:251], v43 offset:59392
  ds_read_b64_tr_b16 a[252:253], v43 offset:61440
  ds_read_b64_tr_b16 a[254:255], v43 offset:63488
  s_waitcnt vmcnt(8) lgkmcnt(0)
  s_barrier
  ds_read_b64_tr_b16 v[128:129], v42 offset:0
  ds_read_b64_tr_b16 v[130:131], v42 offset:2048
  ds_read_b64_tr_b16 v[132:133], v42 offset:4096
  ds_read_b64_tr_b16 v[134:135], v42 offset:6144
  ds_read_b64_tr_b16 v[136:137], v42 offset:8192
  ds_read_b64_tr_b16 v[138:139], v42 offset:10240
  ds_read_b64_tr_b16 v[140:141], v42 offset:12288
  ds_read_b64_tr_b16 v[142:143], v42 offset:14336
  s_waitcnt vmcnt(4) lgkmcnt(0)
  s_barrier
  ds_read_b64_tr_b16 v[144:145], v42 offset:16384
  ds_read_b64_tr_b16 v[146:147], v42 offset:18432
  ds_read_b64_tr_b16 v[148:149], v42 offset:20480
  ds_read_b64_tr_b16 v[150:151], v42 offset:22528
  ds_read_b64_tr_b16 v[152:153], v42 offset:24576
  ds_read_b64_tr_b16 v[154:155], v42 offset:26624
  ds_read_b64_tr_b16 v[156:157], v42 offset:28672
  ds_read_b64_tr_b16 v[158:159], v42 offset:30720
  s_waitcnt vmcnt(0) lgkmcnt(0)
  s_barrier
  ds_read_b64_tr_b16 v[160:161], v42 offset:32768
  ds_read_b64_tr_b16 v[162:163], v42 offset:34816
  ds_read_b64_tr_b16 v[164:165], v42 offset:36864
  ds_read_b64_tr_b16 v[166:167], v42 offset:38912
  ds_read_b64_tr_b16 v[168:169], v42 offset:40960
  ds_read_b64_tr_b16 v[170:171], v42 offset:43008
  ds_read_b64_tr_b16 v[172:173], v42 offset:45056
  ds_read_b64_tr_b16 v[174:175], v42 offset:47104
  s_waitcnt lgkmcnt(0)
  s_barrier
  s_cmp_lt_u32 s21, 8
  s_cbranch_scc1 L_F2_keep
  v_accvgpr_write_b32 a0, 0
  v_accvgpr_write_b32 a1, 0
  v_accvgpr_write_b32 a2, 0
  v_accvgpr_write_b32 a3, 0
  v_accvgpr_write_b32 a152, 0
  v_accvgpr_write_b32 a153, 0
  v_accvgpr_write_b32 a154, 0
  v_accvgpr_write_b32 a155, 0
  s_nop 1
L_F2_keep:
  s_lshr_b32 s43, s21, 3
  s_mul_i32 s43, s43, 37
  s_lshr_b32 s44, s43, 1
  v_min_u32 v52, 19, v0
  v_add_u32 v52, s44, v52
  v_min_u32 v52, 55, v52
  v_lshlrev_b32 v52, 7, v52
  v_add_u32 v2, 1414144, v52
  s_lshl_b32 s40, s43, 11
  s_add_u32 s27, s40, 44040192
  s_lshl_b32 s62, s21, 7
  s_add_u32 s62, s62, 1421312
  s_lshl_b32 s40, s21, 13
  s_add_u32 s31, s40, 142606336
  s_lshl_b32 s40, s20, 11
  v_lshl_add_u32 v68, v0, 4, s40
  v_lshlrev_b32 v1, 4, v0
  s_lshl_b32 s32, s20, 12
  s_mul_i32 s33, s20, 3072
  v_mov_b32 v69, v1
  v_add_u32 v70, 0x10000, v69
  s_lshl_b32 s40, s20, 2
  s_add_u32 s40, s40, 155648
  v_mov_b32 v71, s40
  v_mov_b32 v52, 0
  ds_write_b32 v71, v52
  s_mov_b32 s25, 0
  s_mov_b32 s26, 0
  s_mov_b32 s29, 1
  s_mov_b32 s30, 0
  s_mov_b32 s28, 1
  s_waitcnt lgkmcnt(0)
  s_barrier
  s_branch L_F2_poll
L_F2_top:
  s_cmp_lg_u32 s28, 0
  s_cbranch_scc1 L_F2_go
  buffer_load_dword v3, v2, s[4:7], s30 offen sc1
  v_mov_b32 v52, s25
  v_and_b32 v53, 3, v0
  v_lshlrev_b32 v53, 2, v53
  v_add_u32 v53, 155648, v53
  s_waitcnt vmcnt(1)
  ds_write_b32 v71, v52
  ds_read_b32 v53, v53
  s_waitcnt lgkmcnt(0)
  v_cmp_gt_i32 vcc, s25, v53
  s_cbranch_vccnz L_F2_nosig
  s_mov_b32 s63, s25
  s_atomic_smax s63, s[4:5], s62 glc
Lnosig_32:
L_F2_nosig:
  s_cmp_ge_u32 s25, 64
  s_cbranch_scc1 L_END
  s_waitcnt vmcnt(0)
  v_cmp_gt_i32 vcc, s29, v3
  s_cbranch_vccz L_F2_issue
L_F2_poll:
  s_nop 3
Lpoll_33:
  buffer_load_dword v3, v2, s[4:7], s30 offen sc1
  s_sub_u32 s24, s24, 1
  s_cbranch_scc1 L_FAIL
  s_waitcnt vmcnt(0)
  v_cmp_gt_i32 vcc, s29, v3
  s_cbranch_vccz Lpolld_34
  s_sleep 2
  s_branch Lpoll_33
Lpolld_34:
L_F2_issue:
  s_mov_b32 s34, s26
  s_mov_b32 s35, s27
  s_add_u32 s36, s32, 0
  s_add_u32 m0, s34, s36
  s_add_u32 s36, s35, s36
  buffer_load_dwordx4 v1, s[4:7], s36 offen offset:0 sc1 lds
  buffer_load_dwordx4 v1, s[4:7], s36 offen offset:1024 sc1 lds
  buffer_load_dwordx4 v1, s[4:7], s36 offen offset:2048 sc1 lds
  buffer_load_dwordx4 v1, s[4:7], s36 offen offset:3072 sc1 lds
  s_add_u32 s36, s32, 16384
  s_add_u32 m0, s34, s36
  s_add_u32 s36, s35, s36
  buffer_load_dwordx4 v1, s[4:7], s36 offen offset:0 sc1 lds
  buffer_load_dwordx4 v1, s[4:7], s36 offen offset:1024 sc1 lds
  buffer_load_dwordx4 v1, s[4:7], s36 offen offset:2048 sc1 lds
  buffer_load_dwordx4 v1, s[4:7], s36 offen offset:3072 sc1 lds
  s_add_u32 s36, s32, 32768
  s_add_u32 m0, s34, s36
  s_add_u32 s36, s35, s36
  buffer_load_dwordx4 v1, s[4:7], s36 offen offset:0 sc1 lds
  buffer_load_dwordx4 v1, s[4:7], s36 offen offset:1024 sc1 lds
  buffer_load_dwordx4 v1, s[4:7], s36 offen offset:2048 sc1 lds
  buffer_load_dwordx4 v1, s[4:7], s36 offen offset:3072 sc1 lds
  s_add_u32 s36, s32, 49152
  s_add_u32 m0, s34, s36
  s_add_u32 s36, s35, s36
  buffer_load_dwordx4 v1, s[4:7], s36 offen offset:0 sc1 lds
  buffer_load_dwordx4 v1, s[4:7], s36 offen offset:1024 sc1 lds
  buffer_load_dwordx4 v1, s[4:7], s36 offen offset:2048 sc1 lds
  buffer_load_dwordx4 v1, s[4:7], s36 offen offset:3072 sc1 lds
  s_add_u32 s36, s33, 65536
  s_add_u32 m0, s34, s36
  s_add_u32 s36, s35, s36
  buffer_load_dwordx4 v1, s[4:7], s36 offen offset:0 sc1 lds
  buffer_load_dwordx4 v1, s[4:7], s36 offen offset:1024 sc1 lds
  buffer_load_dwordx4 v1, s[4:7], s36 offen offset:2048 sc1 lds
L_F2_go:
  v_add_u32 v73, s26, v69
  v_add_u32 v74, s26, v70
  s_sub_u32 s26, 77824, s26
  s_add_u32 s27, s27, 229376
  s_mov_b32 s34, s26
  s_mov_b32 s35, s27
  s_add_u32 s29, s29, 1
  s_waitcnt vmcnt(15)
  s_barrier
  ds_read_b128 v[4:7], v73 offset:0
  ds_read_b128 v[8:11], v73 offset:1024
  ds_read_b128 v[12:15], v73 offset:2048
  ds_read_b128 v[16:19], v73 offset:3072
  ds_read_b128 v[20:23], v73 offset:4096
  ds_read_b128 v[24:27], v73 offset:5120
  buffer_load_dword v3, v2, s[4:7], s30 offen sc1
  s_waitcnt lgkmcnt(4)
  v_mfma_f32_16x16x32_bf16 v[36:39], a[0:3], v[4:7], 0
  ds_read_b128 v[28:31], v73 offset:6144
  v_mfma_f32_16x16x32_bf16 v[40:43], a[0:3], v[8:11], 0
  ds_read_b128 v[32:35], v73 offset:7168
  v_mfma_f32_16x16x32_bf16 v[44:47], a[152:155], v[4:7], 0
  v_mfma_f32_16x16x32_bf16 v[48:51], a[152:155], v[8:11], 0
  s_waitcnt lgkmcnt(4)
  v_mfma_f32_16x16x32_bf16 v[36:39], a[4:7], v[12:15], v[36:39]
  ds_read_b128 v[4:7], v73 offset:8192
  v_mfma_f32_16x16x32_bf16 v[40:43], a[4:7], v[16:19], v[40:43]
  ds_read_b128 v[8:11], v73 offset:9216
  v_mfma_f32_16x16x32_bf16 v[44:47], a[156:159], v[12:15], v[44:47]
  v_mfma_f32_16x16x32_bf16 v[48:51], a[156:159], v[16:19], v[48:51]
  s_waitcnt lgkmcnt(4)
  v_mfma_f32_16x16x32_bf16 v[36:39], a[8:11], v[20:23], v[36:39]
  ds_read_b128 v[12:15], v73 offset:10240
  v_mfma_f32_16x16x32_bf16 v[40:43], a[8:11], v[24:27], v[40:43]
  ds_read_b128 v[16:19], v73 offset:11264
  v_mfma_f32_16x16x32_bf16 v[44:47], a[160:163], v[20:23], v[44:47]
  v_mfma_f32_16x16x32_bf16 v[48:51], a[160:163], v[24:27], v[48:51]
  s_waitcnt lgkmcnt(4)
  v_mfma_f32_16x16x32_bf16 v[36:39], a[12:15], v[28:31], v[36:39]
  ds_read_b128 v[20:23], v73 offset:12288
  v_mfma_f32_16x16x32_bf16 v[40:43], a[12:15], v[32:35], v[40:43]
  ds_read_b128 v[24:27], v73 offset:13312
  v_mfma_f32_16x16x32_bf16 v[44:47], a[164:167], v[28:31], v[44:47]
  v_mfma_f32_16x16x32_bf16 v[48:51], a[164:167], v[32:35], v[48:51]
  s_waitcnt lgkmcnt(4)
  v_mfma_f32_16x16x32_bf16 v[36:39], a[16:19], v[4:7], v[36:39]
  ds_read_b128 v[28:31], v73 offset:14336
  v_mfma_f32_16x16x32_bf16 v[40:43], a[16:19], v[8:11], v[40:43]
  ds_read_b128 v[32:35], v73 offset:15360
  v_mfma_f32_16x16x32_bf16 v[44:47], a[168:171], v[4:7], v[44:47]
  v_mfma_f32_16x16x32_bf16 v[48:51], a[168:171], v[8:11], v[48:51]
  s_waitcnt vmcnt(12)
  s_barrier
  s_waitcnt lgkmcnt(4)
  v_mfma_f32_16x16x32_bf16 v[36:39], a[20:23], v[12:15], v[36:39]
  ds_read_b128 v[4:7], v73 offset:16384
  v_mfma_f32_16x16x32_bf16 v[40:43], a[20:23], v[16:19], v[40:43]
  ds_read_b128 v[8:11], v73 offset:17408
  v_mfma_f32_16x16x32_bf16 v[44:47], a[172:175], v[12:15], v[44:47]
  v_mfma_f32_16x16x32_bf16 v[48:51], a[172:175], v[16:19], v[48:51]
  s_waitcnt lgkmcnt(4)
  v_mfma_f32_16x16x32_bf16 v[36:39], a[24:27], v[20:23], v[36:39]
  ds_read_b128 v[12:15], v73 offset:18432
  v_mfma_f32_16x16x32_bf16 v[40:43], a[24:27], v[24:27], v[40:43]
  ds_read_b128 v[16:19], v73 offset:19456
  v_mfma_f32_16x16x32_bf16 v[44:47], a[176:179], v[20:23], v[44:47]
  v_mfma_f32_16x16x32_bf16 v[48:51], a[176:179], v[24:27], v[48:51]
  s_waitcnt lgkmcnt(4)
  v_mfma_f32_16x16x32_bf16 v[36:39], a[28:31], v[28:31], v[36:39]
  ds_read_b128 v[20:23], v73 offset:20480
  v_mfma_f32_16x16x32_bf16 v[40:43], a[28:31], v[32:35], v[40:43]
  ds_read_b128 v[24:27], v73 offset:21504
  v_mfma_f32_16x16x32_bf16 v[44:47], a[180:183], v[28:31], v[44:47]
  v_mfma_f32_16x16x32_bf16 v[48:51], a[180:183], v[32:35], v[48:51]
  s_waitcnt lgkmcnt(4)
  v_mfma_f32_16x16x32_bf16 v[36:39], a[32:35], v[4:7], v[36:39]
  ds_read_b128 v[28:31], v73 offset:22528
  v_mfma_f32_16x16x32_bf16 v[40:43], a[32:35], v[8:11], v[40:43]
  ds_read_b128 v[32:35], v73 offset:23552
  v_mfma_f32_16x16x32_bf16 v[44:47], a[184:187], v[4:7], v[44:47]
  v_mfma_f32_16x16x32_bf16 v[48:51], a[184:187], v[8:11], v[48:51]
  s_waitcnt lgkmcnt(4)
  v_mfma_f32_16x16x32_bf16 v[36:39], a[36:39], v[12:15], v[36:39]
  ds_read_b128 v[4:7], v73 offset:24576
  v_mfma_f32_16x16x32_bf16 v[40:43], a[36:39], v[16:19], v[40:43]
  ds_read_b128 v[8:11], v73 offset:25600
  v_mfma_f32_16x16x32_bf16 v[44:47], a[188:191], v[12:15], v[44:47]
  v_mfma_f32_16x16x32_bf16 v[48:51], a[188:191], v[16:19], v[48:51]
  s_waitcnt lgkmcnt(4)
  v_mfma_f32_16x16x32_bf16 v[36:39], a[40:43], v[20:23], v[36:39]
  ds_read_b128 v[12:15], v73 offset:26624
  v_mfma_f32_16x16x32_bf16 v[40:43], a[40:43], v[24:27], v[40:43]
  ds_read_b128 v[16:19], v73 offset:27648
  v_mfma_f32_16x16x32_bf16 v[44:47], a[192:195], v[20:23], v[44:47]
  v_mfma_f32_16x16x32_bf16 v[48:51], a[192:195], v[24:27], v[48:51]
  s_waitcnt lgkmcnt(4)
  v_mfma_f32_16x16x32_bf16 v[36:39], a[44:47], v[28:31], v[36:39]
  ds_read_b128 v[20:23], v73 offset:28672
  v_mfma_f32_16x16x32_bf16 v[40:43], a[44:47], v[32:35], v[40:43]
  ds_read_b128 v[24:27], v73 offset:29696
  v_mfma_f32_16x16x32_bf16 v[44:47], a[196:199], v[28:31], v[44:47]
  v_mfma_f32_16x16x32_bf16 v[48:51], a[196:199], v[32:35], v[48:51]
  s_waitcnt lgkmcnt(4)
  v_mfma_f32_16x16x32_bf16 v[36:39], a[48:51], v[4:7], v[36:39]
  ds_read_b128 v[28:31], v73 offset:30720
  v_mfma_f32_16x16x32_bf16 v[40:43], a[48:51], v[8:11], v[40:43]
  ds_read_b128 v[32:35], v73 offset:31744
  v_mfma_f32_16x16x32_bf16 v[44:47], a[200:203], v[4:7], v[44:47]
  v_mfma_f32_16x16x32_bf16 v[48:51], a[200:203], v[8:11], v[48:51]
  s_waitcnt vmcnt(0)
  s_barrier
  v_cmp_gt_i32 vcc, s29, v3
  s_cmp_eq_u32 s28, 0
  s_cbranch_scc1 L_F2_s2
  s_mov_b32 s63, s25
  s_atomic_smax s63, s[4:5], s62 glc
Lnosig_35:
L_F2_s2:
  s_mov_b32 s28, 0
  s_cbranch_vccnz L_F2_nopf
  s_cmp_ge_u32 s25, 63
  s_cbranch_scc1 L_F2_nopf
  s_mov_b32 s28, 1
  s_waitcnt lgkmcnt(4)
  v_mfma_f32_16x16x32_bf16 v[36:39], a[52:55], v[12:15], v[36:39]
  ds_read_b128 v[4:7], v73 offset:32768
  v_mfma_f32_16x16x32_bf16 v[40:43], a[52:55], v[16:19], v[40:43]
  ds_read_b128 v[8:11], v73 offset:33792
  v_mfma_f32_16x16x32_bf16 v[44:47], a[204:207], v[12:15], v[44:47]
  s_add_u32 s36, s32, 0
  s_add_u32 m0, s34, s36
  s_add_u32 s36, s35, s36
  buffer_load_dwordx4 v1, s[4:7], s36 offen offset:0 sc1 lds
  v_mfma_f32_16x16x32_bf16 v[48:51], a[204:207], v[16:19], v[48:51]
  s_waitcnt lgkmcnt(4)
  v_mfma_f32_16x16x32_bf16 v[36:39], a[56:59], v[20:23], v[36:39]
  ds_read_b128 v[12:15], v73 offset:34816
  v_mfma_f32_16x16x32_bf16 v[40:43], a[56:59], v[24:27], v[40:43]
  ds_read_b128 v[16:19], v73 offset:35840
  v_mfma_f32_16x16x32_bf16 v[44:47], a[208:211], v[20:23], v[44:47]
  buffer_load_dwordx4 v1, s[4:7], s36 offen offset:1024 sc1 lds
  v_mfma_f32_16x16x32_bf16 v[48:51], a[208:211], v[24:27], v[48:51]
  s_waitcnt lgkmcnt(4)
  v_mfma_f32_16x16x32_bf16 v[36:39], a[60:63], v[28:31], v[36:39]
  ds_read_b128 v[20:23], v73 offset:36864
  v_mfma_f32_16x16x32_bf16 v[40:43], a[60:63], v[32:35], v[40:43]
  ds_read_b128 v[24:27], v73 offset:37888
  v_mfma_f32_16x16x32_bf16 v[44:47], a[212:215], v[28:31], v[44:47]
  buffer_load_dwordx4 v1, s[4:7], s36 offen offset:2048 sc1 lds
  v_mfma_f32_16x16x32_bf16 v[48:51], a[212:215], v[32:35], v[48:51]
  s_waitcnt lgkmcnt(4)
  v_mfma_f32_16x16x32_bf16 v[36:39], a[64:67], v[4:7], v[36:39]
  ds_read_b128 v[28:31], v73 offset:38912
  v_mfma_f32_16x16x32_bf16 v[40:43], a[64:67], v[8:11], v[40:43]
  ds_read_b128 v[32:35], v73 offset:39936
  v_mfma_f32_16x16x32_bf16 v[44:47], a[216:219], v[4:7], v[44:47]
  buffer_load_dwordx4 v1, s[4:7], s36 offen offset:3072 sc1 lds
  v_mfma_f32_16x16x32_bf16 v[48:51], a[216:219], v[8:11], v[48:51]
  s_waitcnt lgkmcnt(4)
  v_mfma_f32_16x16x32_bf16 v[36:39], a[68:71], v[12:15], v[36:39]
  ds_read_b128 v[4:7], v73 offset:40960
  v_mfma_f32_16x16x32_bf16 v[40:43], a[68:71], v[16:19], v[40:43]
  ds_read_b128 v[8:11], v73 offset:41984
  v_mfma_f32_16x16x32_bf16 v[44:47], a[220:223], v[12:15], v[44:47]
  s_add_u32 s36, s32, 16384
  s_add_u32 m0, s34, s36
  s_add_u32 s36, s35, s36
  buffer_load_dwordx4 v1, s[4:7], s36 offen offset:0 sc1 lds
  v_mfma_f32_16x16x32_bf16 v[48:51], a[220:223], v[16:19], v[48:51]
  s_waitcnt lgkmcnt(4)
  v_mfma_f32_16x16x32_bf16 v[36:39], a[72:75], v[20:23], v[36:39]
  ds_read_b128 v[12:15], v73 offset:43008
  v_mfma_f32_16x16x32_bf16 v[40:43], a[72:75], v[24:27], v[40:43]
  ds_read_b128 v[16:19], v73 offset:44032
  v_mfma_f32_16x16x32_bf16 v[44:47], a[224:227], v[20:23], v[44:47]
  buffer_load_dwordx4 v1, s[4:7], s36 offen offset:1024 sc1 lds
  v_mfma_f32_16x16x32_bf16 v[48:51], a[224:227], v[24:27], v[48:51]
  s_waitcnt lgkmcnt(4)
  v_mfma_f32_16x16x32_bf16 v[36:39], a[76:79], v[28:31], v[36:39]
  ds_read_b128 v[20:23], v73 offset:45056
  v_mfma_f32_16x16x32_bf16 v[40:43], a[76:79], v[32:35], v[40:43]
  ds_read_b128 v[24:27], v73 offset:46080
  v_mfma_f32_16x16x32_bf16 v[44:47], a[228:231], v[28:31], v[44:47]
  buffer_load_dwordx4 v1, s[4:7], s36 offen offset:2048 sc1 lds
  v_mfma_f32_16x16x32_bf16 v[48:51], a[228:231], v[32:35], v[48:51]
  s_waitcnt lgkmcnt(4)
  v_mfma_f32_16x16x32_bf16 v[36:39], a[80:83], v[4:7], v[36:39]
  ds_read_b128 v[28:31], v73 offset:47104
  v_mfma_f32_16x16x32_bf16 v[40:43], a[80:83], v[8:11], v[40:43]
  ds_read_b128 v[32:35], v73 offset:48128
  v_mfma_f32_16x16x32_bf16 v[44:47], a[232:235], v[4:7], v[44:47]
  buffer_load_dwordx4 v1, s[4:7], s36 offen offset:3072 sc1 lds
  v_mfma_f32_16x16x32_bf16 v[48:51], a[232:235], v[8:11], v[48:51]
  s_waitcnt lgkmcnt(4)
  v_mfma_f32_16x16x32_bf16 v[36:39], a[84:87], v[12:15], v[36:39]
  ds_read_b128 v[4:7], v73 offset:49152
  v_mfma_f32_16x16x32_bf16 v[40:43], a[84:87], v[16:19], v[40:43]
  ds_read_b128 v[8:11], v73 offset:50176
  v_mfma_f32_16x16x32_bf16 v[44:47], a[236:239], v[12:15], v[44:47]
  s_add_u32 s36, s32, 32768
  s_add_u32 m0, s34, s36
  s_add_u32 s36, s35, s36
  buffer_load_dwordx4 v1, s[4:7], s36 offen offset:0 sc1 lds
  v_mfma_f32_16x16x32_bf16 v[48:51], a[236:239], v[16:19], v[48:51]
  s_waitcnt lgkmcnt(4)
  v_mfma_f32_16x16x32_bf16 v[36:39], a[88:91], v[20:23], v[36:39]
  ds_read_b128 v[12:15], v73 offset:51200
  v_mfma_f32_16x16x32_bf16 v[40:43], a[88:91], v[24:27], v[40:43]
  ds_read_b128 v[16:19], v73 offset:52224
  v_mfma_f32_16x16x32_bf16 v[44:47], a[240:243], v[20:23], v[44:47]
  buffer_load_dwordx4 v1, s[4:7], s36 offen offset:1024 sc1 lds
  v_mfma_f32_16x16x32_bf16 v[48:51], a[240:243], v[24:27], v[48:51]
  s_waitcnt lgkmcnt(4)
  v_mfma_f32_16x16x32_bf16 v[36:39], a[92:95], v[28:31], v[36:39]
  ds_read_b128 v[20:23], v73 offset:53248
  v_mfma_f32_16x16x32_bf16 v[40:43], a[92:95], v[32:35], v[40:43]
  ds_read_b128 v[24:27], v73 offset:54272
  v_mfma_f32_16x16x32_bf16 v[44:47], a[244:247], v[28:31], v[44:47]
  buffer_load_dwordx4 v1, s[4:7], s36 offen offset:2048 sc1 lds
  v_mfma_f32_16x16x32_bf16 v[48:51], a[244:247], v[32:35], v[48:51]
  s_waitcnt lgkmcnt(4)
  v_mfma_f32_16x16x32_bf16 v[36:39], a[96:99], v[4:7], v[36:39]
  ds_read_b128 v[28:31], v73 offset:55296
  v_mfma_f32_16x16x32_bf16 v[40:43], a[96:99], v[8:11], v[40:43]
  ds_read_b128 v[32:35], v73 offset:56320
  v_mfma_f32_16x16x32_bf16 v[44:47], a[248:251], v[4:7], v[44:47]
  buffer_load_dwordx4 v1, s[4:7], s36 offen offset:3072 sc1 lds
  v_mfma_f32_16x16x32_bf16 v[48:51], a[248:251], v[8:11], v[48:51]
  s_waitcnt lgkmcnt(4)
  v_mfma_f32_16x16x32_bf16 v[36:39], a[100:103], v[12:15], v[36:39]
  ds_read_b128 v[4:7], v73 offset:57344
  v_mfma_f32_16x16x32_bf16 v[40:43], a[100:103], v[16:19], v[40:43]
  ds_read_b128 v[8:11], v73 offset:58368
  v_mfma_f32_16x16x32_bf16 v[44:47], a[252:255], v[12:15], v[44:47]
  s_add_u32 s36, s32, 49152
  s_add_u32 m0, s34, s36
  s_add_u32 s36, s35, s36
  buffer_load_dwordx4 v1, s[4:7], s36 offen offset:0 sc1 lds
  v_mfma_f32_16x16x32_bf16 v[48:51], a[252:255], v[16:19], v[48:51]
  s_waitcnt lgkmcnt(4)
  v_mfma_f32_16x16x32_bf16 v[36:39], a[104:107], v[20:23], v[36:39]
  ds_read_b128 v[12:15], v73 offset:59392
  v_mfma_f32_16x16x32_bf16 v[40:43], a[104:107], v[24:27], v[40:43]
  ds_read_b128 v[16:19], v73 offset:60416
  v_mfma_f32_16x16x32_bf16 v[44:47], v[128:131], v[20:23], v[44:47]
  buffer_load_dwordx4 v1, s[4:7], s36 offen offset:1024 sc1 lds
  v_mfma_f32_16x16x32_bf16 v[48:51], v[128:131], v[24:27], v[48:51]
  s_waitcnt lgkmcnt(4)
  v_mfma_f32_16x16x32_bf16 v[36:39], a[108:111], v[28:31], v[36:39]
  ds_read_b128 v[20:23], v73 offset:61440
  v_mfma_f32_16x16x32_bf16 v[40:43], a[108:111], v[32:35], v[40:43]
  ds_read_b128 v[24:27], v73 offset:62464
  v_mfma_f32_16x16x32_bf16 v[44:47], v[132:135], v[28:31], v[44:47]
  buffer_load_dwordx4 v1, s[4:7], s36 offen offset:2048 sc1 lds
  v_mfma_f32_16x16x32_bf16 v[48:51], v[132:135], v[32:35], v[48:51]
  s_waitcnt lgkmcnt(4)
  v_mfma_f32_16x16x32_bf16 v[36:39], a[112:115], v[4:7], v[36:39]
  ds_read_b128 v[28:31], v73 offset:63488
  v_mfma_f32_16x16x32_bf16 v[40:43], a[112:115], v[8:11], v[40:43]
  ds_read_b128 v[32:35], v73 offset:64512
  v_mfma_f32_16x16x32_bf16 v[44:47], v[136:139], v[4:7], v[44:47]
  buffer_load_dwordx4 v1, s[4:7], s36 offen offset:3072 sc1 lds
  v_mfma_f32_16x16x32_bf16 v[48:51], v[136:139], v[8:11], v[48:51]
  s_waitcnt lgkmcnt(4)
  v_mfma_f32_16x16x32_bf16 v[36:39], a[116:119], v[12:15], v[36:39]
  ds_read_b128 v[4:7], v74 offset:0
  v_mfma_f32_16x16x32_bf16 v[40:43], a[116:119], v[16:19], v[40:43]
  ds_read_b128 v[8:11], v74 offset:1024
  v_mfma_f32_16x16x32_bf16 v[44:47], v[140:143], v[12:15], v[44:47]
  s_add_u32 s36, s33, 65536
  s_add_u32 m0, s34, s36
  s_add_u32 s36, s35, s36
  buffer_load_dwordx4 v1, s[4:7], s36 offen offset:0 sc1 lds
  v_mfma_f32_16x16x32_bf16 v[48:51], v[140:143], v[16:19], v[48:51]
  s_waitcnt lgkmcnt(4)
  v_mfma_f32_16x16x32_bf16 v[36:39], a[120:123], v[20:23], v[36:39]
  ds_read_b128 v[12:15], v74 offset:2048
  v_mfma_f32_16x16x32_bf16 v[40:43], a[120:123], v[24:27], v[40:43]
  ds_read_b128 v[16:19], v74 offset:3072
  v_mfma_f32_16x16x32_bf16 v[44:47], v[144:147], v[20:23], v[44:47]
  buffer_load_dwordx4 v1, s[4:7], s36 offen offset:1024 sc1 lds
  v_mfma_f32_16x16x32_bf16 v[48:51], v[144:147], v[24:27], v[48:51]
  s_waitcnt lgkmcnt(4)
  v_mfma_f32_16x16x32_bf16 v[36:39], a[124:127], v[28:31], v[36:39]
  ds_read_b128 v[20:23], v74 offset:4096
  v_mfma_f32_16x16x32_bf16 v[40:43], a[124:127], v[32:35], v[40:43]
  ds_read_b128 v[24:27], v74 offset:5120
  v_mfma_f32_16x16x32_bf16 v[44:47], v[148:151], v[28:31], v[44:47]
  buffer_load_dwordx4 v1, s[4:7], s36 offen offset:2048 sc1 lds
  v_mfma_f32_16x16x32_bf16 v[48:51], v[148:151], v[32:35], v[48:51]
  s_waitcnt lgkmcnt(4)
  v_mfma_f32_16x16x32_bf16 v[36:39], a[128:131], v[4:7], v[36:39]
  ds_read_b128 v[28:31], v74 offset:6144
  v_mfma_f32_16x16x32_bf16 v[40:43], a[128:131], v[8:11], v[40:43]
  ds_read_b128 v[32:35], v74 offset:7168
  v_mfma_f32_16x16x32_bf16 v[44:47], v[152:155], v[4:7], v[44:47]
  v_mfma_f32_16x16x32_bf16 v[48:51], v[152:155], v[8:11], v[48:51]
  s_waitcnt lgkmcnt(4)
  v_mfma_f32_16x16x32_bf16 v[36:39], a[132:135], v[12:15], v[36:39]
  ds_read_b128 v[4:7], v74 offset:8192
  v_mfma_f32_16x16x32_bf16 v[40:43], a[132:135], v[16:19], v[40:43]
  ds_read_b128 v[8:11], v74 offset:9216
  v_mfma_f32_16x16x32_bf16 v[44:47], v[156:159], v[12:15], v[44:47]
  v_mfma_f32_16x16x32_bf16 v[48:51], v[156:159], v[16:19], v[48:51]
  s_waitcnt lgkmcnt(4)
  v_mfma_f32_16x16x32_bf16 v[36:39], a[136:139], v[20:23], v[36:39]
  ds_read_b128 v[12:15], v74 offset:10240
  v_mfma_f32_16x16x32_bf16 v[40:43], a[136:139], v[24:27], v[40:43]
  ds_read_b128 v[16:19], v74 offset:11264
  v_mfma_f32_16x16x32_bf16 v[44:47], v[160:163], v[20:23], v[44:47]
  v_mfma_f32_16x16x32_bf16 v[48:51], v[160:163], v[24:27], v[48:51]
  s_waitcnt lgkmcnt(4)
  v_mfma_f32_16x16x32_bf16 v[36:39], a[140:143], v[28:31], v[36:39]
  v_mfma_f32_16x16x32_bf16 v[40:43], a[140:143], v[32:35], v[40:43]
  v_mfma_f32_16x16x32_bf16 v[44:47], v[164:167], v[28:31], v[44:47]
  v_mfma_f32_16x16x32_bf16 v[48:51], v[164:167], v[32:35], v[48:51]
  s_waitcnt lgkmcnt(2)
  v_mfma_f32_16x16x32_bf16 v[36:39], a[144:147], v[4:7], v[36:39]
  v_mfma_f32_16x16x32_bf16 v[40:43], a[144:147], v[8:11], v[40:43]
  v_mfma_f32_16x16x32_bf16 v[44:47], v[168:171], v[4:7], v[44:47]
  v_mfma_f32_16x16x32_bf16 v[48:51], v[168:171], v[8:11], v[48:51]
  s_waitcnt lgkmcnt(0)
  v_mfma_f32_16x16x32_bf16 v[36:39], a[148:151], v[12:15], v[36:39]
  v_mfma_f32_16x16x32_bf16 v[40:43], a[148:151], v[16:19], v[40:43]
  v_mfma_f32_16x16x32_bf16 v[44:47], v[172:175], v[12:15], v[44:47]
  v_mfma_f32_16x16x32_bf16 v[48:51], v[172:175], v[16:19], v[48:51]
  s_nop 7
  s_branch L_F2_epi
L_F2_nopf:
  s_waitcnt lgkmcnt(4)
  v_mfma_f32_16x16x32_bf16 v[36:39], a[52:55], v[12:15], v[36:39]
  ds_read_b128 v[4:7], v73 offset:32768
  v_mfma_f32_16x16x32_bf16 v[40:43], a[52:55], v[16:19], v[40:43]
  ds_read_b128 v[8:11], v73 offset:33792
  v_mfma_f32_16x16x32_bf16 v[44:47], a[204:207], v[12:15], v[44:47]
  v_mfma_f32_16x16x32_bf16 v[48:51], a[204:207], v[16:19], v[48:51]
  s_waitcnt lgkmcnt(4)
  v_mfma_f32_16x16x32_bf16 v[36:39], a[56:59], v[20:23], v[36:39]
  ds_read_b128 v[12:15], v73 offset:34816
  v_mfma_f32_16x16x32_bf16 v[40:43], a[56:59], v[24:27], v[40:43]
  ds_read_b128 v[16:19], v73 offset:35840
  v_mfma_f32_16x16x32_bf16 v[44:47], a[208:211], v[20:23], v[44:47]
  v_mfma_f32_16x16x32_bf16 v[48:51], a[208:211], v[24:27], v[48:51]
  s_waitcnt lgkmcnt(4)
  v_mfma_f32_16x16x32_bf16 v[36:39], a[60:63], v[28:31], v[36:39]
  ds_read_b128 v[20:23], v73 offset:36864
  v_mfma_f32_16x16x32_bf16 v[40:43], a[60:63], v[32:35], v[40:43]
  ds_read_b128 v[24:27], v73 offset:37888
  v_mfma_f32_16x16x32_bf16 v[44:47], a[212:215], v[28:31], v[44:47]
  v_mfma_f32_16x16x32_bf16 v[48:51], a[212:215], v[32:35], v[48:51]
  s_waitcnt lgkmcnt(4)
  v_mfma_f32_16x16x32_bf16 v[36:39], a[64:67], v[4:7], v[36:39]
  ds_read_b128 v[28:31], v73 offset:38912
  v_mfma_f32_16x16x32_bf16 v[40:43], a[64:67], v[8:11], v[40:43]
  ds_read_b128 v[32:35], v73 offset:39936
  v_mfma_f32_16x16x32_bf16 v[44:47], a[216:219], v[4:7], v[44:47]
  v_mfma_f32_16x16x32_bf16 v[48:51], a[216:219], v[8:11], v[48:51]
  s_waitcnt lgkmcnt(4)
  v_mfma_f32_16x16x32_bf16 v[36:39], a[68:71], v[12:15], v[36:39]
  ds_read_b128 v[4:7], v73 offset:40960
  v_mfma_f32_16x16x32_bf16 v[40:43], a[68:71], v[16:19], v[40:43]
  ds_read_b128 v[8:11], v73 offset:41984
  v_mfma_f32_16x16x32_bf16 v[44:47], a[220:223], v[12:15], v[44:47]
  v_mfma_f32_16x16x32_bf16 v[48:51], a[220:223], v[16:19], v[48:51]
  s_waitcnt lgkmcnt(4)
  v_mfma_f32_16x16x32_bf16 v[36:39], a[72:75], v[20:23], v[36:39]
  ds_read_b128 v[12:15], v73 offset:43008
  v_mfma_f32_16x16x32_bf16 v[40:43], a[72:75], v[24:27], v[40:43]
  ds_read_b128 v[16:19], v73 offset:44032
  v_mfma_f32_16x16x32_bf16 v[44:47], a[224:227], v[20:23], v[44:47]
  v_mfma_f32_16x16x32_bf16 v[48:51], a[224:227], v[24:27], v[48:51]
  s_waitcnt lgkmcnt(4)
  v_mfma_f32_16x16x32_bf16 v[36:39], a[76:79], v[28:31], v[36:39]
  ds_read_b128 v[20:23], v73 offset:45056
  v_mfma_f32_16x16x32_bf16 v[40:43], a[76:79], v[32:35], v[40:43]
  ds_read_b128 v[24:27], v73 offset:46080
  v_mfma_f32_16x16x32_bf16 v[44:47], a[228:231], v[28:31], v[44:47]
  v_mfma_f32_16x16x32_bf16 v[48:51], a[228:231], v[32:35], v[48:51]
  s_waitcnt lgkmcnt(4)
  v_mfma_f32_16x16x32_bf16 v[36:39], a[80:83], v[4:7], v[36:39]
  ds_read_b128 v[28:31], v73 offset:47104
  v_mfma_f32_16x16x32_bf16 v[40:43], a[80:83], v[8:11], v[40:43]
  ds_read_b128 v[32:35], v73 offset:48128
  v_mfma_f32_16x16x32_bf16 v[44:47], a[232:235], v[4:7], v[44:47]
  v_mfma_f32_16x16x32_bf16 v[48:51], a[232:235], v[8:11], v[48:51]
  s_waitcnt lgkmcnt(4)
  v_mfma_f32_16x16x32_bf16 v[36:39], a[84:87], v[12:15], v[36:39]
  ds_read_b128 v[4:7], v73 offset:49152
  v_mfma_f32_16x16x32_bf16 v[40:43], a[84:87], v[16:19], v[40:43]
  ds_read_b128 v[8:11], v73 offset:50176
  v_mfma_f32_16x16x32_bf16 v[44:47], a[236:239], v[12:15], v[44:47]
  v_mfma_f32_16x16x32_bf16 v[48:51], a[236:239], v[16:19], v[48:51]
  s_waitcnt lgkmcnt(4)
  v_mfma_f32_16x16x32_bf16 v[36:39], a[88:91], v[20:23], v[36:39]
  ds_read_b128 v[12:15], v73 offset:51200
  v_mfma_f32_16x16x32_bf16 v[40:43], a[88:91], v[24:27], v[40:43]
  ds_read_b128 v[16:19], v73 offset:52224
  v_mfma_f32_16x16x32_bf16 v[44:47], a[240:243], v[20:23], v[44:47]
  v_mfma_f32_16x16x32_bf16 v[48:51], a[240:243], v[24:27], v[48:51]
  s_waitcnt lgkmcnt(4)
  v_mfma_f32_16x16x32_bf16 v[36:39], a[92:95], v[28:31], v[36:39]
  ds_read_b128 v[20:23], v73 offset:53248
  v_mfma_f32_16x16x32_bf16 v[40:43], a[92:95], v[32:35], v[40:43]
  ds_read_b128 v[24:27], v73 offset:54272
  v_mfma_f32_16x16x32_bf16 v[44:47], a[244:247], v[28:31], v[44:47]
  v_mfma_f32_16x16x32_bf16 v[48:51], a[244:247], v[32:35], v[48:51]
  s_waitcnt lgkmcnt(4)
  v_mfma_f32_16x16x32_bf16 v[36:39], a[96:99], v[4:7], v[36:39]
  ds_read_b128 v[28:31], v73 offset:55296
  v_mfma_f32_16x16x32_bf16 v[40:43], a[96:99], v[8:11], v[40:43]
  ds_read_b128 v[32:35], v73 offset:56320
  v_mfma_f32_16x16x32_bf16 v[44:47], a[248:251], v[4:7], v[44:47]
  v_mfma_f32_16x16x32_bf16 v[48:51], a[248:251], v[8:11], v[48:51]
  s_waitcnt lgkmcnt(4)
  v_mfma_f32_16x16x32_bf16 v[36:39], a[100:103], v[12:15], v[36:39]
  ds_read_b128 v[4:7], v73 offset:57344
  v_mfma_f32_16x16x32_bf16 v[40:43], a[100:103], v[16:19], v[40:43]
  ds_read_b128 v[8:11], v73 offset:58368
  v_mfma_f32_16x16x32_bf16 v[44:47], a[252:255], v[12:15], v[44:47]
  v_mfma_f32_16x16x32_bf16 v[48:51], a[252:255], v[16:19], v[48:51]
  s_waitcnt lgkmcnt(4)
  v_mfma_f32_16x16x32_bf16 v[36:39], a[104:107], v[20:23], v[36:39]
  ds_read_b128 v[12:15], v73 offset:59392
  v_mfma_f32_16x16x32_bf16 v[40:43], a[104:107], v[24:27], v[40:43]
  ds_read_b128 v[16:19], v73 offset:60416
  v_mfma_f32_16x16x32_bf16 v[44:47], v[128:131], v[20:23], v[44:47]
  v_mfma_f32_16x16x32_bf16 v[48:51], v[128:131], v[24:27], v[48:51]
  s_waitcnt lgkmcnt(4)
  v_mfma_f32_16x16x32_bf16 v[36:39], a[108:111], v[28:31], v[36:39]
  ds_read_b128 v[20:23], v73 offset:61440
  v_mfma_f32_16x16x32_bf16 v[40:43], a[108:111], v[32:35], v[40:43]
  ds_read_b128 v[24:27], v73 offset:62464
  v_mfma_f32_16x16x32_bf16 v[44:47], v[132:135], v[28:31], v[44:47]
  v_mfma_f32_16x16x32_bf16 v[48:51], v[132:135], v[32:35], v[48:51]
  s_waitcnt lgkmcnt(4)
  v_mfma_f32_16x16x32_bf16 v[36:39], a[112:115], v[4:7], v[36:39]
  ds_read_b128 v[28:31], v73 offset:63488
  v_mfma_f32_16x16x32_bf16 v[40:43], a[112:115], v[8:11], v[40:43]
  ds_read_b128 v[32:35], v73 offset:64512
  v_mfma_f32_16x16x32_bf16 v[44:47], v[136:139], v[4:7], v[44:47]
  v_mfma_f32_16x16x32_bf16 v[48:51], v[136:139], v[8:11], v[48:51]
  s_waitcnt lgkmcnt(4)
  v_mfma_f32_16x16x32_bf16 v[36:39], a[116:119], v[12:15], v[36:39]
  ds_read_b128 v[4:7], v74 offset:0
  v_mfma_f32_16x16x32_bf16 v[40:43], a[116:119], v[16:19], v[40:43]
  ds_read_b128 v[8:11], v74 offset:1024
  v_mfma_f32_16x16x32_bf16 v[44:47], v[140:143], v[12:15], v[44:47]
  v_mfma_f32_16x16x32_bf16 v[48:51], v[140:143], v[16:19], v[48:51]
  s_waitcnt lgkmcnt(4)
  v_mfma_f32_16x16x32_bf16 v[36:39], a[120:123], v[20:23], v[36:39]
  ds_read_b128 v[12:15], v74 offset:2048
  v_mfma_f32_16x16x32_bf16 v[40:43], a[120:123], v[24:27], v[40:43]
  ds_read_b128 v[16:19], v74 offset:3072
  v_mfma_f32_16x16x32_bf16 v[44:47], v[144:147], v[20:23], v[44:47]
  v_mfma_f32_16x16x32_bf16 v[48:51], v[144:147], v[24:27], v[48:51]
  s_waitcnt lgkmcnt(4)
  v_mfma_f32_16x16x32_bf16 v[36:39], a[124:127], v[28:31], v[36:39]
  ds_read_b128 v[20:23], v74 offset:4096
  v_mfma_f32_16x16x32_bf16 v[40:43], a[124:127], v[32:35], v[40:43]
  ds_read_b128 v[24:27], v74 offset:5120
  v_mfma_f32_16x16x32_bf16 v[44:47], v[148:151], v[28:31], v[44:47]
  v_mfma_f32_16x16x32_bf16 v[48:51], v[148:151], v[32:35], v[48:51]
  s_waitcnt lgkmcnt(4)
  v_mfma_f32_16x16x32_bf16 v[36:39], a[128:131], v[4:7], v[36:39]
  ds_read_b128 v[28:31], v74 offset:6144
  v_mfma_f32_16x16x32_bf16 v[40:43], a[128:131], v[8:11], v[40:43]
  ds_read_b128 v[32:35], v74 offset:7168
  v_mfma_f32_16x16x32_bf16 v[44:47], v[152:155], v[4:7], v[44:47]
  v_mfma_f32_16x16x32_bf16 v[48:51], v[152:155], v[8:11], v[48:51]
  s_waitcnt lgkmcnt(4)
  v_mfma_f32_16x16x32_bf16 v[36:39], a[132:135], v[12:15], v[36:39]
  ds_read_b128 v[4:7], v74 offset:8192
  v_mfma_f32_16x16x32_bf16 v[40:43], a[132:135], v[16:19], v[40:43]
  ds_read_b128 v[8:11], v74 offset:9216
  v_mfma_f32_16x16x32_bf16 v[44:47], v[156:159], v[12:15], v[44:47]
  v_mfma_f32_16x16x32_bf16 v[48:51], v[156:159], v[16:19], v[48:51]
  s_waitcnt lgkmcnt(4)
  v_mfma_f32_16x16x32_bf16 v[36:39], a[136:139], v[20:23], v[36:39]
  ds_read_b128 v[12:15], v74 offset:10240
  v_mfma_f32_16x16x32_bf16 v[40:43], a[136:139], v[24:27], v[40:43]
  ds_read_b128 v[16:19], v74 offset:11264
  v_mfma_f32_16x16x32_bf16 v[44:47], v[160:163], v[20:23], v[44:47]
  v_mfma_f32_16x16x32_bf16 v[48:51], v[160:163], v[24:27], v[48:51]
  s_waitcnt lgkmcnt(4)
  v_mfma_f32_16x16x32_bf16 v[36:39], a[140:143], v[28:31], v[36:39]
  v_mfma_f32_16x16x32_bf16 v[40:43], a[140:143], v[32:35], v[40:43]
  v_mfma_f32_16x16x32_bf16 v[44:47], v[164:167], v[28:31], v[44:47]
  v_mfma_f32_16x16x32_bf16 v[48:51], v[164:167], v[32:35], v[48:51]
  s_waitcnt lgkmcnt(2)
  v_mfma_f32_16x16x32_bf16 v[36:39], a[144:147], v[4:7], v[36:39]
  v_mfma_f32_16x16x32_bf16 v[40:43], a[144:147], v[8:11], v[40:43]
  v_mfma_f32_16x16x32_bf16 v[44:47], v[168:171], v[4:7], v[44:47]
  v_mfma_f32_16x16x32_bf16 v[48:51], v[168:171], v[8:11], v[48:51]
  s_waitcnt lgkmcnt(0)
  v_mfma_f32_16x16x32_bf16 v[36:39], a[148:151], v[12:15], v[36:39]
  v_mfma_f32_16x16x32_bf16 v[40:43], a[148:151], v[16:19], v[40:43]
  v_mfma_f32_16x16x32_bf16 v[44:47], v[172:175], v[12:15], v[44:47]
  v_mfma_f32_16x16x32_bf16 v[48:51], v[172:175], v[16:19], v[48:51]
L_F2_epi:
  s_nop 4
  v_cvt_pk_bf16_f32 v52, v36, v37
  v_cvt_pk_bf16_f32 v53, v38, v39
  v_cvt_pk_bf16_f32 v54, v44, v45
  v_cvt_pk_bf16_f32 v55, v46, v47
  buffer_store_dwordx4 v[52:55], v68, s[4:7], s31 offen offset:0 sc1
  v_cvt_pk_bf16_f32 v56, v40, v41
  v_cvt_pk_bf16_f32 v57, v42, v43
  v_cvt_pk_bf16_f32 v58, v48, v49
  v_cvt_pk_bf16_f32 v59, v50, v51
  buffer_store_dwordx4 v[56:59], v68, s[4:7], s31 offen offset:1024 sc1
  s_add_u32 s25, s25, 1
  s_add_u32 s31, s31, 196608
  s_branch L_F2_top
L_QK:
  v_bfe_u32 v76, v0, 3, 2
  v_xor_b32 v76, s20, v76
  v_lshlrev_b32 v76, 5, v76
  v_lshrrev_b32 v4, 2, v0
  v_lshl_add_u32 v4, v4, 7, v76
  v_and_b32 v76, 3, v0
  v_lshl_add_u32 v4, v76, 3, v4
  s_lshl_b32 s40, s20, 15
  v_add_u32 v4, s40, v4
  v_lshl_add_u32 v85, v0, 4, s40
  s_lshl_b32 s40, s20, 12
  s_add_u32 s40, s40, 131072
  v_lshl_add_u32 v1, v0, 4, s40
  s_lshr_b32 s54, s21, 4
  s_lshl_b32 s52, s54, 22
  s_sub_u32 s53, 0, s52
  v_xor_b32 v5, 32768, v4
  v_xor_b32 v2, 4096, v1
  v_xor_b32 v6, 65536, v4
  v_xor_b32 v3, 8192, v1
  v_xor_b32 v7, 98304, v4
  v_xor_b32 v84, 12288, v1
  v_bfe_u32 v8, v0, 5, 1
  v_mul_u32_u24 v8, 16384, v8
  v_bfe_u32 v76, v0, 4, 1
  v_mul_u32_u24 v76, 32768, v76
  v_add_u32 v8, v8, v76
  v_bfe_u32 v76, v0, 3, 1
  v_mul_u32_u24 v76, 131072, v76
  v_add_u32 v8, v8, v76
  v_lshrrev_b32 v76, 3, v0
  v_and_b32 v76, 6, v76
  v_xor_b32 v76, v76, v0
  v_and_b32 v76, 7, v76
  v_lshl_add_u32 v8, v76, 4, v8
  s_lshl_b32 s40, s20, 19
  v_add_u32 v8, s40, v8
  s_lshl_b32 s44, s21, 8
  s_add_u32 s45, s44, 128
  s_load_dwordx2 s[8:9], s[0:1], 16
  s_mov_b32 s10, 8388608
  s_mov_b32 s11, 0x20000
  s_waitcnt lgkmcnt(0)
  v_add_u32 v9, s44, v8
  v_add_u32 v10, s45, v8
  v_add_u32 v11, s44, v8
  v_add_u32 v12, s45, v8
  s_lshl_b32 s41, s20, 15
  s_add_u32 m0, s41, 0
  s_add_u32 s42, s52, 0
  buffer_load_dwordx4 v9, s[8:11], s42 offen lds
  s_add_u32 m0, s41, 1024
  s_add_u32 s42, s52, 65536
  buffer_load_dwordx4 v9, s[8:11], s42 offen lds
  s_add_u32 m0, s41, 2048
  s_add_u32 s42, s52, 8192
  buffer_load_dwordx4 v9, s[8:11], s42 offen lds
  s_add_u32 m0, s41, 3072
  s_add_u32 s42, s52, 73728
  buffer_load_dwordx4 v9, s[8:11], s42 offen lds
  s_add_u32 m0, s41, 4096
  s_add_u32 s42, s52, 262144
  buffer_load_dwordx4 v9, s[8:11], s42 offen lds
  s_add_u32 m0, s41, 5120
  s_add_u32 s42, s52, 327680
  buffer_load_dwordx4 v9, s[8:11], s42 offen lds
  s_add_u32 m0, s41, 6144
  s_add_u32 s42, s52, 270336
  buffer_load_dwordx4 v9, s[8:11], s42 offen lds
  s_add_u32 m0, s41, 7168
  s_add_u32 s42, s52, 335872
  buffer_load_dwordx4 v9, s[8:11], s42 offen lds
  s_add_u32 m0, s41, 8192
  s_add_u32 s42, s52, 2097152
  buffer_load_dwordx4 v9, s[8:11], s42 offen lds
  s_add_u32 m0, s41, 9216
  s_add_u32 s42, s52, 2162688
  buffer_load_dwordx4 v9, s[8:11], s42 offen lds
  s_add_u32 m0, s41, 10240
  s_add_u32 s42, s52, 2105344
  buffer_load_dwordx4 v9, s[8:11], s42 offen lds
  s_add_u32 m0, s41, 11264
  s_add_u32 s42, s52, 2170880
  buffer_load_dwordx4 v9, s[8:11], s42 offen lds
  s_add_u32 m0, s41, 12288
  s_add_u32 s42, s52, 2359296
  buffer_load_dwordx4 v9, s[8:11], s42 offen lds
  s_add_u32 m0, s41, 13312
  s_add_u32 s42, s52, 2424832
  buffer_load_dwordx4 v9, s[8:11], s42 offen lds
  s_add_u32 m0, s41, 14336
  s_add_u32 s42, s52, 2367488
  buffer_load_dwordx4 v9, s[8:11], s42 offen lds
  s_add_u32 m0, s41, 15360
  s_add_u32 s42, s52, 2433024
  buffer_load_dwordx4 v9, s[8:11], s42 offen lds
  s_add_u32 m0, s41, 16384
  s_add_u32 s42, s53, 4194304
  buffer_load_dwordx4 v9, s[8:11], s42 offen lds
  s_add_u32 m0, s41, 17408
  s_add_u32 s42, s53, 4259840
  buffer_load_dwordx4 v9, s[8:11], s42 offen lds
  s_add_u32 m0, s41, 18432
  s_add_u32 s42, s53, 4202496
  buffer_load_dwordx4 v9, s[8:11], s42 offen lds
  s_add_u32 m0, s41, 19456
  s_add_u32 s42, s53, 4268032
  buffer_load_dwordx4 v9, s[8:11], s42 offen lds
  s_add_u32 m0, s41, 20480
  s_add_u32 s42, s53, 4456448
  buffer_load_dwordx4 v9, s[8:11], s42 offen lds
  s_add_u32 m0, s41, 21504
  s_add_u32 s42, s53, 4521984
  buffer_load_dwordx4 v9, s[8:11], s42 offen lds
  s_add_u32 m0, s41, 22528
  s_add_u32 s42, s53, 4464640
  buffer_load_dwordx4 v9, s[8:11], s42 offen lds
  s_add_u32 m0, s41, 23552
  s_add_u32 s42, s53, 4530176
  buffer_load_dwordx4 v9, s[8:11], s42 offen lds
  s_waitcnt vmcnt(16) lgkmcnt(0)
  s_barrier
  s_add_u32 m0, s41, 24576
  s_add_u32 s42, s53, 6291456
  buffer_load_dwordx4 v9, s[8:11], s42 offen lds
  s_add_u32 m0, s41, 25600
  s_add_u32 s42, s53, 6356992
  buffer_load_dwordx4 v9, s[8:11], s42 offen lds
  s_add_u32 m0, s41, 26624
  s_add_u32 s42, s53, 6299648
  buffer_load_dwordx4 v9, s[8:11], s42 offen lds
  s_add_u32 m0, s41, 27648
  s_add_u32 s42, s53, 6365184
  buffer_load_dwordx4 v9, s[8:11], s42 offen lds
  s_add_u32 m0, s41, 28672
  s_add_u32 s42, s53, 6553600
  buffer_load_dwordx4 v9, s[8:11], s42 offen lds
  s_add_u32 m0, s41, 29696
  s_add_u32 s42, s53, 6619136
  buffer_load_dwordx4 v9, s[8:11], s42 offen lds
  s_add_u32 m0, s41, 30720
  s_add_u32 s42, s53, 6561792
  buffer_load_dwordx4 v9, s[8:11], s42 offen lds
  s_add_u32 m0, s41, 31744
  s_add_u32 s42, s53, 6627328
  buffer_load_dwordx4 v9, s[8:11], s42 offen lds
  ds_read_b64_tr_b16 a[0:1], v4 offset:0
  ds_read_b64_tr_b16 a[2:3], v4 offset:2048
  ds_read_b64_tr_b16 a[4:5], v4 offset:4096
  ds_read_b64_tr_b16 a[6:7], v4 offset:6144
  ds_read_b64_tr_b16 a[16:17], v5 offset:0
  ds_read_b64_tr_b16 a[18:19], v5 offset:2048
  ds_read_b64_tr_b16 a[20:21], v5 offset:4096
  ds_read_b64_tr_b16 a[22:23], v5 offset:6144
  ds_read_b64_tr_b16 a[32:33], v6 offset:0
  ds_read_b64_tr_b16 a[34:35], v6 offset:2048
  ds_read_b64_tr_b16 a[36:37], v6 offset:4096
  ds_read_b64_tr_b16 a[38:39], v6 offset:6144
  ds_read_b64_tr_b16 a[48:49], v7 offset:0
  ds_read_b64_tr_b16 a[50:51], v7 offset:2048
  ds_read_b64_tr_b16 a[52:53], v7 offset:4096
  ds_read_b64_tr_b16 a[54:55], v7 offset:6144
  s_waitcnt vmcnt(16) lgkmcnt(0)
  s_barrier
  s_add_u32 m0, s41, 0
  s_add_u32 s42, s52, 0
  buffer_load_dwordx4 v10, s[8:11], s42 offen lds
  s_add_u32 m0, s41, 1024
  s_add_u32 s42, s52, 65536
  buffer_load_dwordx4 v10, s[8:11], s42 offen lds
  s_add_u32 m0, s41, 2048
  s_add_u32 s42, s52, 8192
  buffer_load_dwordx4 v10, s[8:11], s42 offen lds
  s_add_u32 m0, s41, 3072
  s_add_u32 s42, s52, 73728
  buffer_load_dwordx4 v10, s[8:11], s42 offen lds
  s_add_u32 m0, s41, 4096
  s_add_u32 s42, s52, 262144
  buffer_load_dwordx4 v10, s[8:11], s42 offen lds
  s_add_u32 m0, s41, 5120
  s_add_u32 s42, s52, 327680
  buffer_load_dwordx4 v10, s[8:11], s42 offen lds
  s_add_u32 m0, s41, 6144
  s_add_u32 s42, s52, 270336
  buffer_load_dwordx4 v10, s[8:11], s42 offen lds
  s_add_u32 m0, s41, 7168
  s_add_u32 s42, s52, 335872
  buffer_load_dwordx4 v10, s[8:11], s42 offen lds
  ds_read_b64_tr_b16 a[8:9], v4 offset:8192
  ds_read_b64_tr_b16 a[10:11], v4 offset:10240
  ds_read_b64_tr_b16 a[12:13], v4 offset:12288
  ds_read_b64_tr_b16 a[14:15], v4 offset:14336
  ds_read_b64_tr_b16 a[24:25], v5 offset:8192
  ds_read_b64_tr_b16 a[26:27], v5 offset:10240
  ds_read_b64_tr_b16 a[28:29], v5 offset:12288
  ds_read_b64_tr_b16 a[30:31], v5 offset:14336
  ds_read_b64_tr_b16 a[40:41], v6 offset:8192
  ds_read_b64_tr_b16 a[42:43], v6 offset:10240
  ds_read_b64_tr_b16 a[44:45], v6 offset:12288
  ds_read_b64_tr_b16 a[46:47], v6 offset:14336
  ds_read_b64_tr_b16 a[56:57], v7 offset:8192
  ds_read_b64_tr_b16 a[58:59], v7 offset:10240
  ds_read_b64_tr_b16 a[60:61], v7 offset:12288
  ds_read_b64_tr_b16 a[62:63], v7 offset:14336
  s_waitcnt vmcnt(16) lgkmcnt(0)
  s_barrier
  s_add_u32 m0, s41, 8192
  s_add_u32 s42, s52, 2097152
  buffer_load_dwordx4 v10, s[8:11], s42 offen lds
  s_add_u32 m0, s41, 9216
  s_add_u32 s42, s52, 2162688
  buffer_load_dwordx4 v10, s[8:11], s42 offen lds
  s_add_u32 m0, s41, 10240
  s_add_u32 s42, s52, 2105344
  buffer_load_dwordx4 v10, s[8:11], s42 offen lds
  s_add_u32 m0, s41, 11264
  s_add_u32 s42, s52, 2170880
  buffer_load_dwordx4 v10, s[8:11], s42 offen lds
  s_add_u32 m0, s41, 12288
  s_add_u32 s42, s52, 2359296
  buffer_load_dwordx4 v10, s[8:11], s42 offen lds
  s_add_u32 m0, s41, 13312
  s_add_u32 s42, s52, 2424832
  buffer_load_dwordx4 v10, s[8:11], s42 offen lds
  s_add_u32 m0, s41, 14336
  s_add_u32 s42, s52, 2367488
  buffer_load_dwordx4 v10, s[8:11], s42 offen lds
  s_add_u32 m0, s41, 15360
  s_add_u32 s42, s52, 2433024
  buffer_load_dwordx4 v10, s[8:11], s42 offen lds
  ds_read_b64_tr_b16 a[64:65], v4 offset:16384
  ds_read_b64_tr_b16 a[66:67], v4 offset:18432
  ds_read_b64_tr_b16 a[68:69], v4 offset:20480
  ds_read_b64_tr_b16 a[70:71], v4 offset:22528
  ds_read_b64_tr_b16 a[80:81], v5 offset:16384
  ds_read_b64_tr_b16 a[82:83], v5 offset:18432
  ds_read_b64_tr_b16 a[84:85], v5 offset:20480
  ds_read_b64_tr_b16 a[86:87], v5 offset:22528
  ds_read_b64_tr_b16 a[96:97], v6 offset:16384
  ds_read_b64_tr_b16 a[98:99], v6 offset:18432
  ds_read_b64_tr_b16 a[100:101], v6 offset:20480
  ds_read_b64_tr_b16 a[102:103], v6 offset:22528
  ds_read_b64_tr_b16 a[112:113], v7 offset:16384
  ds_read_b64_tr_b16 a[114:115], v7 offset:18432
  ds_read_b64_tr_b16 a[116:117], v7 offset:20480
  ds_read_b64_tr_b16 a[118:119], v7 offset:22528
  s_waitcnt vmcnt(16) lgkmcnt(0)
  s_barrier
  s_add_u32 m0, s41, 16384
  s_add_u32 s42, s53, 4194304
  buffer_load_dwordx4 v10, s[8:11], s42 offen lds
  s_add_u32 m0, s41, 17408
  s_add_u32 s42, s53, 4259840
  buffer_load_dwordx4 v10, s[8:11], s42 offen lds
  s_add_u32 m0, s41, 18432
  s_add_u32 s42, s53, 4202496
  buffer_load_dwordx4 v10, s[8:11], s42 offen lds
  s_add_u32 m0, s41, 19456
  s_add_u32 s42, s53, 4268032
  buffer_load_dwordx4 v10, s[8:11], s42 offen lds
  s_add_u32 m0, s41, 20480
  s_add_u32 s42, s53, 4456448
  buffer_load_dwordx4 v10, s[8:11], s42 offen lds
  s_add_u32 m0, s41, 21504
  s_add_u32 s42, s53, 4521984
  buffer_load_dwordx4 v10, s[8:11], s42 offen lds
  s_add_u32 m0, s41, 22528
  s_add_u32 s42, s53, 4464640
  buffer_load_dwordx4 v10, s[8:11], s42 offen lds
  s_add_u32 m0, s41, 23552
  s_add_u32 s42, s53, 4530176
  buffer_load_dwordx4 v10, s[8:11], s42 offen lds
  ds_read_b64_tr_b16 a[72:73], v4 offset:24576
  ds_read_b64_tr_b16 a[74:75], v4 offset:26624
  ds_read_b64_tr_b16 a[76:77], v4 offset:28672
  ds_read_b64_tr_b16 a[78:79], v4 offset:30720
  ds_read_b64_tr_b16 a[88:89], v5 offset:24576
  ds_read_b64_tr_b16 a[90:91], v5 offset:26624
  ds_read_b64_tr_b16 a[92:93], v5 offset:28672
  ds_read_b64_tr_b16 a[94:95], v5 offset:30720
  ds_read_b64_tr_b16 a[104:105], v6 offset:24576
  ds_read_b64_tr_b16 a[106:107], v6 offset:26624
  ds_read_b64_tr_b16 a[108:109], v6 offset:28672
  ds_read_b64_tr_b16 a[110:111], v6 offset:30720
  ds_read_b64_tr_b16 a[120:121], v7 offset:24576
  ds_read_b64_tr_b16 a[122:123], v7 offset:26624
  ds_read_b64_tr_b16 a[124:125], v7 offset:28672
  ds_read_b64_tr_b16 a[126:127], v7 offset:30720
  s_waitcnt vmcnt(16) lgkmcnt(0)
  s_barrier
  s_add_u32 m0, s41, 24576
  s_add_u32 s42, s53, 6291456
  buffer_load_dwordx4 v10, s[8:11], s42 offen lds
  s_add_u32 m0, s41, 25600
  s_add_u32 s42, s53, 6356992
  buffer_load_dwordx4 v10, s[8:11], s42 offen lds
  s_add_u32 m0, s41, 26624
  s_add_u32 s42, s53, 6299648
  buffer_load_dwordx4 v10, s[8:11], s42 offen lds
  s_add_u32 m0, s41, 27648
  s_add_u32 s42, s53, 6365184
  buffer_load_dwordx4 v10, s[8:11], s42 offen lds
  s_add_u32 m0, s41, 28672
  s_add_u32 s42, s53, 6553600
  buffer_load_dwordx4 v10, s[8:11], s42 offen lds
  s_add_u32 m0, s41, 29696
  s_add_u32 s42, s53, 6619136
  buffer_load_dwordx4 v10, s[8:11], s42 offen lds
  s_add_u32 m0, s41, 30720
  s_add_u32 s42, s53, 6561792
  buffer_load_dwordx4 v10, s[8:11], s42 offen lds
  s_add_u32 m0, s41, 31744
  s_add_u32 s42, s53, 6627328
  buffer_load_dwordx4 v10, s[8:11], s42 offen lds
  ds_read_b64_tr_b16 a[128:129], v4 offset:0
  ds_read_b64_tr_b16 a[130:131], v4 offset:2048
  ds_read_b64_tr_b16 a[132:133], v4 offset:4096
  ds_read_b64_tr_b16 a[134:135], v4 offset:6144
  ds_read_b64_tr_b16 a[144:145], v5 offset:0
  ds_read_b64_tr_b16 a[146:147], v5 offset:2048
  ds_read_b64_tr_b16 a[148:149], v5 offset:4096
  ds_read_b64_tr_b16 a[150:151], v5 offset:6144
  ds_read_b64_tr_b16 a[160:161], v6 offset:0
  ds_read_b64_tr_b16 a[162:163], v6 offset:2048
  ds_read_b64_tr_b16 a[164:165], v6 offset:4096
  ds_read_b64_tr_b16 a[166:167], v6 offset:6144
  ds_read_b64_tr_b16 a[176:177], v7 offset:0
  ds_read_b64_tr_b16 a[178:179], v7 offset:2048
  ds_read_b64_tr_b16 a[180:181], v7 offset:4096
  ds_read_b64_tr_b16 a[182:183], v7 offset:6144
  s_waitcnt vmcnt(16) lgkmcnt(0)
  s_barrier
  s_load_dwordx2 s[8:9], s[0:1], 24
  s_mov_b32 s10, 8388608
  s_mov_b32 s11, 0x20000
  s_waitcnt lgkmcnt(0)
  s_add_u32 m0, s41, 0
  s_add_u32 s42, s52, 0
  buffer_load_dwordx4 v11, s[8:11], s42 offen lds
  s_add_u32 m0, s41, 1024
  s_add_u32 s42, s52, 65536
  buffer_load_dwordx4 v11, s[8:11], s42 offen lds
  s_add_u32 m0, s41, 2048
  s_add_u32 s42, s52, 8192
  buffer_load_dwordx4 v11, s[8:11], s42 offen lds
  s_add_u32 m0, s41, 3072
  s_add_u32 s42, s52, 73728
  buffer_load_dwordx4 v11, s[8:11], s42 offen lds
  s_add_u32 m0, s41, 4096
  s_add_u32 s42, s52, 262144
  buffer_load_dwordx4 v11, s[8:11], s42 offen lds
  s_add_u32 m0, s41, 5120
  s_add_u32 s42, s52, 327680
  buffer_load_dwordx4 v11, s[8:11], s42 offen lds
  s_add_u32 m0, s41, 6144
  s_add_u32 s42, s52, 270336
  buffer_load_dwordx4 v11, s[8:11], s42 offen lds
  s_add_u32 m0, s41, 7168
  s_add_u32 s42, s52, 335872
  buffer_load_dwordx4 v11, s[8:11], s42 offen lds
  ds_read_b64_tr_b16 a[136:137], v4 offset:8192
  ds_read_b64_tr_b16 a[138:139], v4 offset:10240
  ds_read_b64_tr_b16 a[140:141], v4 offset:12288
  ds_read_b64_tr_b16 a[142:143], v4 offset:14336
  ds_read_b64_tr_b16 a[152:153], v5 offset:8192
  ds_read_b64_tr_b16 a[154:155], v5 offset:10240
  ds_read_b64_tr_b16 a[156:157], v5 offset:12288
  ds_read_b64_tr_b16 a[158:159], v5 offset:14336
  ds_read_b64_tr_b16 a[168:169], v6 offset:8192
  ds_read_b64_tr_b16 a[170:171], v6 offset:10240
  ds_read_b64_tr_b16 a[172:173], v6 offset:12288
  ds_read_b64_tr_b16 a[174:175], v6 offset:14336
  ds_read_b64_tr_b16 a[184:185], v7 offset:8192
  ds_read_b64_tr_b16 a[186:187], v7 offset:10240
  ds_read_b64_tr_b16 a[188:189], v7 offset:12288
  ds_read_b64_tr_b16 a[190:191], v7 offset:14336
  s_waitcnt vmcnt(16) lgkmcnt(0)
  s_barrier
  s_add_u32 m0, s41, 8192
  s_add_u32 s42, s52, 2097152
  buffer_load_dwordx4 v11, s[8:11], s42 offen lds
  s_add_u32 m0, s41, 9216
  s_add_u32 s42, s52, 2162688
  buffer_load_dwordx4 v11, s[8:11], s42 offen lds
  s_add_u32 m0, s41, 10240
  s_add_u32 s42, s52, 2105344
  buffer_load_dwordx4 v11, s[8:11], s42 offen lds
  s_add_u32 m0, s41, 11264
  s_add_u32 s42, s52, 2170880
  buffer_load_dwordx4 v11, s[8:11], s42 offen lds
  s_add_u32 m0, s41, 12288
  s_add_u32 s42, s52, 2359296
  buffer_load_dwordx4 v11, s[8:11], s42 offen lds
  s_add_u32 m0, s41, 13312
  s_add_u32 s42, s52, 2424832
  buffer_load_dwordx4 v11, s[8:11], s42 offen lds
  s_add_u32 m0, s41, 14336
  s_add_u32 s42, s52, 2367488
  buffer_load_dwordx4 v11, s[8:11], s42 offen lds
  s_add_u32 m0, s41, 15360
  s_add_u32 s42, s52, 2433024
  buffer_load_dwordx4 v11, s[8:11], s42 offen lds
  ds_read_b64_tr_b16 a[192:193], v4 offset:16384
  ds_read_b64_tr_b16 a[194:195], v4 offset:18432
  ds_read_b64_tr_b16 a[196:197], v4 offset:20480
  ds_read_b64_tr_b16 a[198:199], v4 offset:22528
  ds_read_b64_tr_b16 a[208:209], v5 offset:16384
  ds_read_b64_tr_b16 a[210:211], v5 offset:18432
  ds_read_b64_tr_b16 a[212:213], v5 offset:20480
  ds_read_b64_tr_b16 a[214:215], v5 offset:22528
  ds_read_b64_tr_b16 a[224:225], v6 offset:16384
  ds_read_b64_tr_b16 a[226:227], v6 offset:18432
  ds_read_b64_tr_b16 a[228:229], v6 offset:20480
  ds_read_b64_tr_b16 a[230:231], v6 offset:22528
  ds_read_b64_tr_b16 a[240:241], v7 offset:16384
  ds_read_b64_tr_b16 a[242:243], v7 offset:18432
  ds_read_b64_tr_b16 a[244:245], v7 offset:20480
  ds_read_b64_tr_b16 a[246:247], v7 offset:22528
  s_waitcnt vmcnt(16) lgkmcnt(0)
  s_barrier
  s_add_u32 m0, s41, 16384
  s_add_u32 s42, s53, 4194304
  buffer_load_dwordx4 v11, s[8:11], s42 offen lds
  s_add_u32 m0, s41, 17408
  s_add_u32 s42, s53, 4259840
  buffer_load_dwordx4 v11, s[8:11], s42 offen lds
  s_add_u32 m0, s41, 18432
  s_add_u32 s42, s53, 4202496
  buffer_load_dwordx4 v11, s[8:11], s42 offen lds
  s_add_u32 m0, s41, 19456
  s_add_u32 s42, s53, 4268032
  buffer_load_dwordx4 v11, s[8:11], s42 offen lds
  s_add_u32 m0, s41, 20480
  s_add_u32 s42, s53, 4456448
  buffer_load_dwordx4 v11, s[8:11], s42 offen lds
  s_add_u32 m0, s41, 21504
  s_add_u32 s42, s53, 4521984
  buffer_load_dwordx4 v11, s[8:11], s42 offen lds
  s_add_u32 m0, s41, 22528
  s_add_u32 s42, s53, 4464640
  buffer_load_dwordx4 v11, s[8:11], s42 offen lds
  s_add_u32 m0, s41, 23552
  s_add_u32 s42, s53, 4530176
  buffer_load_dwordx4 v11, s[8:11], s42 offen lds
  ds_read_b64_tr_b16 a[200:201], v4 offset:24576
  ds_read_b64_tr_b16 a[202:203], v4 offset:26624
  ds_read_b64_tr_b16 a[204:205], v4 offset:28672
  ds_read_b64_tr_b16 a[206:207], v4 offset:30720
  ds_read_b64_tr_b16 a[216:217], v5 offset:24576
  ds_read_b64_tr_b16 a[218:219], v5 offset:26624
  ds_read_b64_tr_b16 a[220:221], v5 offset:28672
  ds_read_b64_tr_b16 a[222:223], v5 offset:30720
  ds_read_b64_tr_b16 a[232:233], v6 offset:24576
  ds_read_b64_tr_b16 a[234:235], v6 offset:26624
  ds_read_b64_tr_b16 a[236:237], v6 offset:28672
  ds_read_b64_tr_b16 a[238:239], v6 offset:30720
  ds_read_b64_tr_b16 a[248:249], v7 offset:24576
  ds_read_b64_tr_b16 a[250:251], v7 offset:26624
  ds_read_b64_tr_b16 a[252:253], v7 offset:28672
  ds_read_b64_tr_b16 a[254:255], v7 offset:30720
  s_waitcnt vmcnt(16) lgkmcnt(0)
  s_barrier
  s_add_u32 m0, s41, 24576
  s_add_u32 s42, s53, 6291456
  buffer_load_dwordx4 v11, s[8:11], s42 offen lds
  s_add_u32 m0, s41, 25600
  s_add_u32 s42, s53, 6356992
  buffer_load_dwordx4 v11, s[8:11], s42 offen lds
  s_add_u32 m0, s41, 26624
  s_add_u32 s42, s53, 6299648
  buffer_load_dwordx4 v11, s[8:11], s42 offen lds
  s_add_u32 m0, s41, 27648
  s_add_u32 s42, s53, 6365184
  buffer_load_dwordx4 v11, s[8:11], s42 offen lds
  s_add_u32 m0, s41, 28672
  s_add_u32 s42, s53, 6553600
  buffer_load_dwordx4 v11, s[8:11], s42 offen lds
  s_add_u32 m0, s41, 29696
  s_add_u32 s42, s53, 6619136
  buffer_load_dwordx4 v11, s[8:11], s42 offen lds
  s_add_u32 m0, s41, 30720
  s_add_u32 s42, s53, 6561792
  buffer_load_dwordx4 v11, s[8:11], s42 offen lds
  s_add_u32 m0, s41, 31744
  s_add_u32 s42, s53, 6627328
  buffer_load_dwordx4 v11, s[8:11], s42 offen lds
  ds_read_b64_tr_b16 v[128:129], v4 offset:0
  ds_read_b64_tr_b16 v[130:131], v4 offset:2048
  ds_read_b64_tr_b16 v[132:133], v4 offset:4096
  ds_read_b64_tr_b16 v[134:135], v4 offset:6144
  ds_read_b64_tr_b16 v[144:145], v5 offset:0
  ds_read_b64_tr_b16 v[146:147], v5 offset:2048
  ds_read_b64_tr_b16 v[148:149], v5 offset:4096
  ds_read_b64_tr_b16 v[150:151], v5 offset:6144
  ds_read_b64_tr_b16 v[160:161], v6 offset:0
  ds_read_b64_tr_b16 v[162:163], v6 offset:2048
  ds_read_b64_tr_b16 v[164:165], v6 offset:4096
  ds_read_b64_tr_b16 v[166:167], v6 offset:6144
  ds_read_b64_tr_b16 v[176:177], v7 offset:0
  ds_read_b64_tr_b16 v[178:179], v7 offset:2048
  ds_read_b64_tr_b16 v[180:181], v7 offset:4096
  ds_read_b64_tr_b16 v[182:183], v7 offset:6144
  s_waitcnt vmcnt(16) lgkmcnt(0)
  s_barrier
  s_add_u32 m0, s41, 0
  s_add_u32 s42, s52, 0
  buffer_load_dwordx4 v12, s[8:11], s42 offen lds
  s_add_u32 m0, s41, 1024
  s_add_u32 s42, s52, 65536
  buffer_load_dwordx4 v12, s[8:11], s42 offen lds
  s_add_u32 m0, s41, 2048
  s_add_u32 s42, s52, 8192
  buffer_load_dwordx4 v12, s[8:11], s42 offen lds
  s_add_u32 m0, s41, 3072
  s_add_u32 s42, s52, 73728
  buffer_load_dwordx4 v12, s[8:11], s42 offen lds
  s_add_u32 m0, s41, 4096
  s_add_u32 s42, s52, 262144
  buffer_load_dwordx4 v12, s[8:11], s42 offen lds
  s_add_u32 m0, s41, 5120
  s_add_u32 s42, s52, 327680
  buffer_load_dwordx4 v12, s[8:11], s42 offen lds
  s_add_u32 m0, s41, 6144
  s_add_u32 s42, s52, 270336
  buffer_load_dwordx4 v12, s[8:11], s42 offen lds
  s_add_u32 m0, s41, 7168
  s_add_u32 s42, s52, 335872
  buffer_load_dwordx4 v12, s[8:11], s42 offen lds
  ds_read_b64_tr_b16 v[136:137], v4 offset:8192
  ds_read_b64_tr_b16 v[138:139], v4 offset:10240
  ds_read_b64_tr_b16 v[140:141], v4 offset:12288
  ds_read_b64_tr_b16 v[142:143], v4 offset:14336
  ds_read_b64_tr_b16 v[152:153], v5 offset:8192
  ds_read_b64_tr_b16 v[154:155], v5 offset:10240
  ds_read_b64_tr_b16 v[156:157], v5 offset:12288
  ds_read_b64_tr_b16 v[158:159], v5 offset:14336
  ds_read_b64_tr_b16 v[168:169], v6 offset:8192
  ds_read_b64_tr_b16 v[170:171], v6 offset:10240
  ds_read_b64_tr_b16 v[172:173], v6 offset:12288
  ds_read_b64_tr_b16 v[174:175], v6 offset:14336
  ds_read_b64_tr_b16 v[184:185], v7 offset:8192
  ds_read_b64_tr_b16 v[186:187], v7 offset:10240
  ds_read_b64_tr_b16 v[188:189], v7 offset:12288
  ds_read_b64_tr_b16 v[190:191], v7 offset:14336
  s_waitcnt vmcnt(16) lgkmcnt(0)
  s_barrier
  s_add_u32 m0, s41, 8192
  s_add_u32 s42, s52, 2097152
  buffer_load_dwordx4 v12, s[8:11], s42 offen lds
  s_add_u32 m0, s41, 9216
  s_add_u32 s42, s52, 2162688
  buffer_load_dwordx4 v12, s[8:11], s42 offen lds
  s_add_u32 m0, s41, 10240
  s_add_u32 s42, s52, 2105344
  buffer_load_dwordx4 v12, s[8:11], s42 offen lds
  s_add_u32 m0, s41, 11264
  s_add_u32 s42, s52, 2170880
  buffer_load_dwordx4 v12, s[8:11], s42 offen lds
  s_add_u32 m0, s41, 12288
  s_add_u32 s42, s52, 2359296
  buffer_load_dwordx4 v12, s[8:11], s42 offen lds
  s_add_u32 m0, s41, 13312
  s_add_u32 s42, s52, 2424832
  buffer_load_dwordx4 v12, s[8:11], s42 offen lds
  s_add_u32 m0, s41, 14336
  s_add_u32 s42, s52, 2367488
  buffer_load_dwordx4 v12, s[8:11], s42 offen lds
  s_add_u32 m0, s41, 15360
  s_add_u32 s42, s52, 2433024
  buffer_load_dwordx4 v12, s[8:11], s42 offen lds
  ds_read_b64_tr_b16 v[192:193], v4 offset:16384
  ds_read_b64_tr_b16 v[194:195], v4 offset:18432
  ds_read_b64_tr_b16 v[196:197], v4 offset:20480
  ds_read_b64_tr_b16 v[198:199], v4 offset:22528
  ds_read_b64_tr_b16 v[208:209], v5 offset:16384
  ds_read_b64_tr_b16 v[210:211], v5 offset:18432
  ds_read_b64_tr_b16 v[212:213], v5 offset:20480
  ds_read_b64_tr_b16 v[214:215], v5 offset:22528
  ds_read_b64_tr_b16 v[224:225], v6 offset:16384
  ds_read_b64_tr_b16 v[226:227], v6 offset:18432
  ds_read_b64_tr_b16 v[228:229], v6 offset:20480
  ds_read_b64_tr_b16 v[230:231], v6 offset:22528
  ds_read_b64_tr_b16 v[240:241], v7 offset:16384
  ds_read_b64_tr_b16 v[242:243], v7 offset:18432
  ds_read_b64_tr_b16 v[244:245], v7 offset:20480
  ds_read_b64_tr_b16 v[246:247], v7 offset:22528
  s_waitcnt vmcnt(16) lgkmcnt(0)
  s_barrier
  s_add_u32 m0, s41, 16384
  s_add_u32 s42, s53, 4194304
  buffer_load_dwordx4 v12, s[8:11], s42 offen lds
  s_add_u32 m0, s41, 17408
  s_add_u32 s42, s53, 4259840
  buffer_load_dwordx4 v12, s[8:11], s42 offen lds
  s_add_u32 m0, s41, 18432
  s_add_u32 s42, s53, 4202496
  buffer_load_dwordx4 v12, s[8:11], s42 offen lds
  s_add_u32 m0, s41, 19456
  s_add_u32 s42, s53, 4268032
  buffer_load_dwordx4 v12, s[8:11], s42 offen lds
  s_add_u32 m0, s41, 20480
  s_add_u32 s42, s53, 4456448
  buffer_load_dwordx4 v12, s[8:11], s42 offen lds
  s_add_u32 m0, s41, 21504
  s_add_u32 s42, s53, 4521984
  buffer_load_dwordx4 v12, s[8:11], s42 offen lds
  s_add_u32 m0, s41, 22528
  s_add_u32 s42, s53, 4464640
  buffer_load_dwordx4 v12, s[8:11], s42 offen lds
  s_add_u32 m0, s41, 23552
  s_add_u32 s42, s53, 4530176
  buffer_load_dwordx4 v12, s[8:11], s42 offen lds
  ds_read_b64_tr_b16 v[200:201], v4 offset:24576
  ds_read_b64_tr_b16 v[202:203], v4 offset:26624
  ds_read_b64_tr_b16 v[204:205], v4 offset:28672
  ds_read_b64_tr_b16 v[206:207], v4 offset:30720
  ds_read_b64_tr_b16 v[216:217], v5 offset:24576
  ds_read_b64_tr_b16 v[218:219], v5 offset:26624
  ds_read_b64_tr_b16 v[220:221], v5 offset:28672
  ds_read_b64_tr_b16 v[222:223], v5 offset:30720
  ds_read_b64_tr_b16 v[232:233], v6 offset:24576
  ds_read_b64_tr_b16 v[234:235], v6 offset:26624
  ds_read_b64_tr_b16 v[236:237], v6 offset:28672
  ds_read_b64_tr_b16 v[238:239], v6 offset:30720
  ds_read_b64_tr_b16 v[248:249], v7 offset:24576
  ds_read_b64_tr_b16 v[250:251], v7 offset:26624
  ds_read_b64_tr_b16 v[252:253], v7 offset:28672
  ds_read_b64_tr_b16 v[254:255], v7 offset:30720
  s_waitcnt vmcnt(16) lgkmcnt(0)
  s_barrier
  s_add_u32 m0, s41, 24576
  s_add_u32 s42, s53, 6291456
  buffer_load_dwordx4 v12, s[8:11], s42 offen lds
  s_add_u32 m0, s41, 25600
  s_add_u32 s42, s53, 6356992
  buffer_load_dwordx4 v12, s[8:11], s42 offen lds
  s_add_u32 m0, s41, 26624
  s_add_u32 s42, s53, 6299648
  buffer_load_dwordx4 v12, s[8:11], s42 offen lds
  s_add_u32 m0, s41, 27648
  s_add_u32 s42, s53, 6365184
  buffer_load_dwordx4 v12, s[8:11], s42 offen lds
  s_add_u32 m0, s41, 28672
  s_add_u32 s42, s53, 6553600
  buffer_load_dwordx4 v12, s[8:11], s42 offen lds
  s_add_u32 m0, s41, 29696
  s_add_u32 s42, s53, 6619136
  buffer_load_dwordx4 v12, s[8:11], s42 offen lds
  s_add_u32 m0, s41, 30720
  s_add_u32 s42, s53, 6561792
  buffer_load_dwordx4 v12, s[8:11], s42 offen lds
  s_add_u32 m0, s41, 31744
  s_add_u32 s42, s53, 6627328
  buffer_load_dwordx4 v12, s[8:11], s42 offen lds
  ds_read_b64_tr_b16 v[20:21], v4 offset:0
  ds_read_b64_tr_b16 v[22:23], v4 offset:2048
  ds_read_b64_tr_b16 v[24:25], v4 offset:4096
  ds_read_b64_tr_b16 v[26:27], v4 offset:6144
  ds_read_b64_tr_b16 v[28:29], v5 offset:0
  ds_read_b64_tr_b16 v[30:31], v5 offset:2048
  ds_read_b64_tr_b16 v[32:33], v5 offset:4096
  ds_read_b64_tr_b16 v[34:35], v5 offset:6144
  ds_read_b64_tr_b16 v[36:37], v6 offset:0
  ds_read_b64_tr_b16 v[38:39], v6 offset:2048
  ds_read_b64_tr_b16 v[40:41], v6 offset:4096
  ds_read_b64_tr_b16 v[42:43], v6 offset:6144
  ds_read_b64_tr_b16 v[44:45], v7 offset:0
  ds_read_b64_tr_b16 v[46:47], v7 offset:2048
  ds_read_b64_tr_b16 v[48:49], v7 offset:4096
  ds_read_b64_tr_b16 v[50:51], v7 offset:6144
  s_waitcnt lgkmcnt(0)
  s_barrier
  ds_write_b128 v85, v[20:23] offset:0
  ds_write_b128 v85, v[24:27] offset:1024
  ds_write_b128 v85, v[28:31] offset:2048
  ds_write_b128 v85, v[32:35] offset:3072
  ds_write_b128 v85, v[36:39] offset:4096
  ds_write_b128 v85, v[40:43] offset:5120
  ds_write_b128 v85, v[44:47] offset:6144
  ds_write_b128 v85, v[48:51] offset:7168
  s_waitcnt vmcnt(16) lgkmcnt(0)
  s_barrier
  ds_read_b64_tr_b16 v[20:21], v4 offset:8192
  ds_read_b64_tr_b16 v[22:23], v4 offset:10240
  ds_read_b64_tr_b16 v[24:25], v4 offset:12288
  ds_read_b64_tr_b16 v[26:27], v4 offset:14336
  ds_read_b64_tr_b16 v[28:29], v5 offset:8192
  ds_read_b64_tr_b16 v[30:31], v5 offset:10240
  ds_read_b64_tr_b16 v[32:33], v5 offset:12288
  ds_read_b64_tr_b16 v[34:35], v5 offset:14336
  ds_read_b64_tr_b16 v[36:37], v6 offset:8192
  ds_read_b64_tr_b16 v[38:39], v6 offset:10240
  ds_read_b64_tr_b16 v[40:41], v6 offset:12288
  ds_read_b64_tr_b16 v[42:43], v6 offset:14336
  ds_read_b64_tr_b16 v[44:45], v7 offset:8192
  ds_read_b64_tr_b16 v[46:47], v7 offset:10240
  ds_read_b64_tr_b16 v[48:49], v7 offset:12288
  ds_read_b64_tr_b16 v[50:51], v7 offset:14336
  s_waitcnt lgkmcnt(0)
  s_barrier
  ds_write_b128 v85, v[20:23] offset:8192
  ds_write_b128 v85, v[24:27] offset:9216
  ds_write_b128 v85, v[28:31] offset:10240
  ds_write_b128 v85, v[32:35] offset:11264
  ds_write_b128 v85, v[36:39] offset:12288
  ds_write_b128 v85, v[40:43] offset:13312
  ds_write_b128 v85, v[44:47] offset:14336
  ds_write_b128 v85, v[48:51] offset:15360
  s_waitcnt vmcnt(8) lgkmcnt(0)
  s_barrier
  ds_read_b64_tr_b16 v[20:21], v4 offset:16384
  ds_read_b64_tr_b16 v[22:23], v4 offset:18432
  ds_read_b64_tr_b16 v[24:25], v4 offset:20480
  ds_read_b64_tr_b16 v[26:27], v4 offset:22528
  ds_read_b64_tr_b16 v[28:29], v5 offset:16384
  ds_read_b64_tr_b16 v[30:31], v5 offset:18432
  ds_read_b64_tr_b16 v[32:33], v5 offset:20480
  ds_read_b64_tr_b16 v[34:35], v5 offset:22528
  ds_read_b64_tr_b16 v[36:37], v6 offset:16384
  ds_read_b64_tr_b16 v[38:39], v6 offset:18432
  ds_read_b64_tr_b16 v[40:41], v6 offset:20480
  ds_read_b64_tr_b16 v[42:43], v6 offset:22528
  ds_read_b64_tr_b16 v[44:45], v7 offset:16384
  ds_read_b64_tr_b16 v[46:47], v7 offset:18432
  ds_read_b64_tr_b16 v[48:49], v7 offset:20480
  ds_read_b64_tr_b16 v[50:51], v7 offset:22528
  s_waitcnt lgkmcnt(0)
  s_barrier
  ds_write_b128 v85, v[20:23] offset:16384
  ds_write_b128 v85, v[24:27] offset:17408
  ds_write_b128 v85, v[28:31] offset:18432
  ds_write_b128 v85, v[32:35] offset:19456
  ds_write_b128 v85, v[36:39] offset:20480
  ds_write_b128 v85, v[40:43] offset:21504
  ds_write_b128 v85, v[44:47] offset:22528
  ds_write_b128 v85, v[48:51] offset:23552
  s_waitcnt vmcnt(0) lgkmcnt(0)
  s_barrier
  ds_read_b64_tr_b16 v[20:21], v4 offset:24576
  ds_read_b64_tr_b16 v[22:23], v4 offset:26624
  ds_read_b64_tr_b16 v[24:25], v4 offset:28672
  ds_read_b64_tr_b16 v[26:27], v4 offset:30720
  ds_read_b64_tr_b16 v[28:29], v5 offset:24576
  ds_read_b64_tr_b16 v[30:31], v5 offset:26624
  ds_read_b64_tr_b16 v[32:33], v5 offset:28672
  ds_read_b64_tr_b16 v[34:35], v5 offset:30720
  ds_read_b64_tr_b16 v[36:37], v6 offset:24576
  ds_read_b64_tr_b16 v[38:39], v6 offset:26624
  ds_read_b64_tr_b16 v[40:41], v6 offset:28672
  ds_read_b64_tr_b16 v[42:43], v6 offset:30720
  ds_read_b64_tr_b16 v[44:45], v7 offset:24576
  ds_read_b64_tr_b16 v[46:47], v7 offset:26624
  ds_read_b64_tr_b16 v[48:49], v7 offset:28672
  ds_read_b64_tr_b16 v[50:51], v7 offset:30720
  s_waitcnt lgkmcnt(0)
  s_barrier
  ds_write_b128 v85, v[20:23] offset:24576
  ds_write_b128 v85, v[24:27] offset:25600
  ds_write_b128 v85, v[28:31] offset:26624
  ds_write_b128 v85, v[32:35] offset:27648
  ds_write_b128 v85, v[36:39] offset:28672
  ds_write_b128 v85, v[40:43] offset:29696
  ds_write_b128 v85, v[44:47] offset:30720
  ds_write_b128 v85, v[48:51] offset:31744
  s_waitcnt lgkmcnt(0)
  v_min_u32 v76, 31, v0
  v_lshlrev_b32 v76, 2, v76
  v_add_u32 v76, 128, v76
  s_nop 1
Lpoll_36:
  buffer_load_dword v77, v76, s[12:15], 0 offen sc1
  s_sub_u32 s24, s24, 1
  s_cbranch_scc1 L_FAIL
  s_waitcnt vmcnt(0)
  v_cmp_gt_i32 vcc, 1, v77
  s_cbranch_vccz Lpolld_37
  s_sleep 2
  s_branch Lpoll_36
Lpolld_37:
  s_mov_b32 s46, 0xffff
  s_barrier
  s_cmp_lg_u32 s20, 0
  s_cbranch_scc1 L_QK_noprobe
  s_and_b32 s40, s21, 3
  s_lshl_b32 s40, s40, 13
  s_lshr_b32 s41, s21, 2
  s_lshl_b32 s41, s41, 10
  s_add_u32 s40, s40, s41
  s_add_u32 s40, s40, 1343488
  v_mov_b32 v76, 0
  s_memtime s[42:43]
  s_waitcnt lgkmcnt(0)
  buffer_load_dword v77, v76, s[4:7], s40 offen offset:0 sc1
  s_waitcnt vmcnt(0)
  s_memtime s[44:45]
  s_waitcnt lgkmcnt(0)
  s_sub_u32 s42, s44, s42
  s_min_u32 s46, s46, s42
  s_memtime s[42:43]
  s_waitcnt lgkmcnt(0)
  buffer_load_dword v77, v76, s[4:7], s40 offen offset:256 sc1
  s_waitcnt vmcnt(0)
  s_memtime s[44:45]
  s_waitcnt lgkmcnt(0)
  s_sub_u32 s42, s44, s42
  s_min_u32 s46, s46, s42
  s_memtime s[42:43]
  s_waitcnt lgkmcnt(0)
  buffer_load_dword v77, v76, s[4:7], s40 offen offset:512 sc1
  s_waitcnt vmcnt(0)
  s_memtime s[44:45]
  s_waitcnt lgkmcnt(0)
  s_sub_u32 s42, s44, s42
  s_min_u32 s46, s46, s42
  s_memtime s[42:43]
  s_waitcnt lgkmcnt(0)
  buffer_load_dword v77, v76, s[4:7], s40 offen offset:768 sc1
  s_waitcnt vmcnt(0)
  s_memtime s[44:45]
  s_waitcnt lgkmcnt(0)
  s_sub_u32 s42, s44, s42
  s_min_u32 s46, s46, s42
L_QK_noprobe:
  s_barrier
  s_getreg_b32 s55, hwreg(HW_REG_XCC_ID)
  s_and_b32 s55, s55, 15
  s_min_u32 s46, s46, 0xffff
  s_lshl_b32 s46, s46, 8
  s_or_b32 s46, s46, s55
  s_add_u32 s40, s21, 0
  s_lshl_b32 s40, s40, 7
  s_add_u32 s40, s40, 1424384
  s_cmp_eq_u32 s20, 0
  s_cselect_b32 s40, s40, 2147483392
  v_mov_b32 v76, 2147483392
  s_mov_b64 exec, 1
  v_mov_b32 v76, s40
  s_mov_b64 exec, -1
  v_mov_b32 v77, s46
  buffer_store_dword v77, v76, s[4:7], 0 offen sc1
  v_min_u32 v76, 63, v0
  v_lshlrev_b32 v76, 7, v76
  v_add_u32 v76, 1424384, v76
  s_nop 1
Lpoll_38:
  buffer_load_dword v77, v76, s[4:7], 0 offen sc1
  s_sub_u32 s24, s24, 1
  s_cbranch_scc1 L_FAIL
  s_waitcnt vmcnt(0)
  v_cmp_gt_i32 vcc, 0, v77
  s_cbranch_vccz Lpolld_39
  s_sleep 4
  s_branch Lpoll_38
Lpolld_39:
  v_and_b32 v78, 15, v77
  v_cmp_ne_u32 vcc, s55, v78
  s_lshl_b32 s40, s54, 4
  s_lshl_b32 s40, 0xffff, s40
  s_or_b32 s41, vcc_lo, vcc_hi
  s_and_b32 s40, s40, s41
  s_cselect_b32 s36, 0, 8192
  v_lshrrev_b32 v77, 8, v77
  v_and_b32 v78, 3, v0
  v_lshl_or_b32 v77, v77, 2, v78
  s_nop 1
  v_min_u32_dpp v77, v77, v77 row_ror:8 row_mask:0xf bank_mask:0xf
  s_nop 1
  v_min_u32_dpp v77, v77, v77 row_ror:4 row_mask:0xf bank_mask:0xf
  v_mov_b32 v78, v77
  s_nop 1
  v_permlane16_swap_b32 v78, v77
  v_min_u32 v77, v77, v78
  s_nop 1
  v_min_u32_dpp v77, v77, v77 row_ror:2 row_mask:0xf bank_mask:0xf
  s_nop 1
  v_min_u32_dpp v77, v77, v77 row_ror:1 row_mask:0xf bank_mask:0xf
  s_nop 0
  v_readfirstlane_b32 s26, v77
  s_and_b32 s26, s26, 3
  s_lshl_b32 s26, s26, 13
  s_lshr_b32 s40, s20, 1
  s_mul_i32 s40, s40, 32768
  s_and_b32 s41, s20, 1
  s_lshl_b32 s41, s41, 12
  s_add_u32 s40, s40, s41
  s_lshl_b32 s41, s54, 11
  s_add_u32 s40, s40, s41
  v_lshl_add_u32 v86, v0, 4, s40
  v_xor_b32 v87, 0x800, v86
  v_and_b32 v76, 2, v0
  v_cmp_eq_u32 vcc, 0, v76
  v_mov_b32 v76, 0xeeee
  v_mov_b32 v77, 0x4444
  v_cndmask_b32 v88, v76, v77, vcc
  s_lshr_b32 s40, s21, 2
  s_mul_i32 s40, s40, 32768
  s_and_b32 s41, s21, 3
  s_lshl_b32 s41, s41, 11
  s_add_u32 s47, s40, s41
  s_lshl_b32 s41, s20, 9
  s_add_u32 s47, s47, s41
  v_lshl_add_u32 v92, v0, 3, s47
  s_lshl_b32 s41, s54, 12
  s_add_u32 s40, s41, 1310720
  s_add_u32 s40, s40, s26
  v_lshrrev_b32 v76, 2, v0
  v_lshl_add_u32 v76, v76, 7, s40
  v_and_b32 v77, 3, v0
  v_lshl_add_u32 v90, v77, 2, v76
  s_mov_b32 s57, s40
  s_cmp_eq_u32 s36, 0
  s_cselect_b32 s56, 1, s20
  s_and_b32 s41, s21, 15
  s_lshl_b32 s41, s41, 7
  s_lshl_b32 s40, s20, 2
  s_add_u32 s40, s40, s41
  s_add_u32 s40, s40, 2048
  s_mov_b32 s25, 0
  s_mov_b32 s60, 0
  s_mov_b32 s61, 0
  v_mov_b32 v91, 2147483392
  s_mov_b64 exec, 1
  v_mov_b32 v91, s40
  s_mov_b64 exec, -1
  v_mov_b32 v80, -1
  v_mov_b32 v81, -1
  v_mov_b32 v82, -1
  v_mov_b32 v83, -1
  v_mov_b32 v106, 0
  v_mov_b32 v107, 0
  v_mov_b32 v109, 0
  v_mov_b32 v110, 0
  v_mov_b32 v111, 0
  v_mov_b32 v112, 0
  v_mov_b32 v114, 0
  v_mov_b32 v115, 0
  v_mov_b32 v116, 0x3f803f80
  v_mov_b32 v117, 0x3f803f80
  v_mov_b32 v118, 0x3f803f80
  v_mov_b32 v119, 0x3f803f80
  v_lshlrev_b32 v95, 4, v0
  s_lshl_b32 s58, s20, 12
  s_add_u32 s40, s58, 149504
  s_add_u32 s58, s58, 131072
  v_lshrrev_b32 v76, 4, v0
  v_bfe_u32 v77, v0, 1, 2
  v_xor_b32 v76, v76, v77
  v_lshl_add_u32 v76, v76, 4, s40
  v_and_b32 v77, 15, v0
  v_lshl_add_u32 v122, v77, 6, v76
  v_bfe_u32 v76, v0, 3, 2
  v_xor_b32 v76, v76, v0
  v_lshl_add_u32 v123, v76, 4, s40
  v_bfe_u32 v76, v0, 4, 1
  v_lshlrev_b32 v76, 1, v76
  v_and_b32 v77, 13, v0
  v_or_b32 v76, v76, v77
  v_lshl_add_u32 v120, v76, 4, s47
  v_lshrrev_b32 v76, 5, v0
  v_lshl_add_u32 v120, v76, 8, v120
  v_and_b32 v76, 2, v0
  v_cmp_eq_u32 vcc, 0, v76
  v_mov_b32 v77, 2147483392
  s_nop 0
  v_cndmask_b32 v120, v120, v77, vcc
  s_lshl_b32 s43, s21, 2
  s_add_u32 s43, s43, s20
  s_lshl_b32 s30, s43, 11
  s_add_u32 s30, s30, 27262976
  s_mul_i32 s32, s21, 24576
  s_lshl_b32 s40, s20, 11
  s_add_u32 s32, s32, s40
  s_add_u32 s32, s32, 58720256
  s_lshl_b32 s44, s21, 1
  s_lshl_b32 s62, s21, 7
  s_add_u32 s62, s62, 1404928
  s_mov_b32 s38, 0x3e0293ee
  s_mov_b32 s39, s38
  s_mov_b32 s59, 0
  v_xor_b32 v124, 4096, v123
  v_xor_b32 v125, 8192, v123
  v_xor_b32 v126, 12288, v123
  v_readfirstlane_b32 s88, v86
  s_xor_b32 s41, s47, 131072
  v_min_u32 v76, 3, v0
  v_lshl_add_u32 v87, v76, 7, s41
  v_lshrrev_b32 v76, 4, v0
  v_lshlrev_b32 v76, 2, v76
  v_and_b32 v77, 15, v0
  v_sub_u32 v76, v77, v76
  v_mov_b32 v86, 0xd028965f
  v_cmp_le_i32 s[8:9], 0, v76
  v_cmp_le_i32 s[10:11], 1, v76
  v_cmp_le_i32 s[16:17], 2, v76
  v_cmp_le_i32 s[18:19], 3, v76
  s_xor_b32 s89, s88, 4096
  s_xor_b32 s90, s88, 32768
  s_xor_b32 s91, s88, 36864
  v_min_u32 v121, 1, v0
  v_add_u32 v121, s44, v121
  v_lshlrev_b32 v121, 7, v121
  v_add_u32 v121, 1396736, v121
  s_nop 1
  s_mov_b32 s33, 1
  s_cmp_ge_i32 s59, s33
  s_cbranch_scc1 Lhave_40
Lpoll_41:
  buffer_load_dword v89, v121, s[4:7], 0 offen sc1
  s_sub_u32 s24, s24, 1
  s_cbranch_scc1 L_FAIL
  s_waitcnt vmcnt(0)
  v_cmp_gt_i32 vcc, s33, v89
  s_cbranch_vccz Lpolld_42
  s_sleep 2
  s_branch Lpoll_41
Lpolld_42:
  v_readlane_b32 s59, v89, 0
  v_readlane_b32 s40, v89, 1
  s_min_i32 s59, s59, s40
Lhave_40:
  s_add_u32 m0, s58, 16384
  s_add_u32 s31, s32, 8192
  buffer_load_dwordx4 v95, s[4:7], s31 offen sc1 lds
  buffer_load_dwordx4 v95, s[4:7], s31 offen offset:1024 sc1 lds
  s_add_u32 m0, s58, 2048
  s_add_u32 s31, s32, 16384
  buffer_load_dwordx4 v95, s[4:7], s31 offen sc1 lds
  buffer_load_dwordx4 v95, s[4:7], s31 offen offset:1024 sc1 lds
  s_add_u32 m0, s58, 0
  s_add_u32 s31, s32, 0
  buffer_load_dwordx4 v95, s[4:7], s31 offen sc1 lds
  buffer_load_dwordx4 v95, s[4:7], s31 offen offset:1024 sc1 lds
L_QK_top:
  v_mov_b32 v94, s25
  s_and_b32 s40, s25, 3
  s_lshl_b32 s40, s40, 16
  s_add_u32 s27, s40, s26
  s_add_u32 s27, s27, 1048576
  s_xor_b32 s37, s27, s36
  s_lshl_b32 s40, s40, 2
  s_add_u32 s28, s40, s26
  s_lshr_b32 s40, s40, 5
  s_and_b32 s40, s40, 0x4000
  s_xor_b32 s28, s28, s40
  s_xor_b32 s29, s28, 0x4000
  s_xor_b32 s34, s28, 0x84000
  s_xor_b32 s48, s28, 8192
  s_add_u32 s92, s37, s88
  s_add_u32 s96, s27, s88
  s_xor_b32 s96, s96, 0x800
  s_add_u32 s93, s37, s89
  s_add_u32 s97, s27, s89
  s_xor_b32 s97, s97, 0x800
  s_add_u32 s94, s37, s90
  s_add_u32 s98, s27, s90
  s_xor_b32 s98, s98, 0x800
  s_add_u32 s95, s37, s91
  s_add_u32 s99, s27, s91
  s_xor_b32 s99, s99, 0x800
  v_mov_b64 v[52:53], 0
  v_mov_b64 v[54:55], 0
  v_mov_b64 v[56:57], 0
  v_mov_b64 v[58:59], 0
  v_mov_b64 v[60:61], 0
  v_mov_b64 v[62:63], 0
  v_mov_b64 v[64:65], 0
  v_mov_b64 v[66:67], 0
  ds_read_b128 v[20:23], v85 offset:0
  ds_read_b128 v[24:27], v85 offset:1024
  ds_read_b128 v[28:31], v85 offset:8192
  ds_read_b128 v[32:35], v85 offset:9216
  ds_read_b128 v[36:39], v85 offset:2048
  ds_read_b128 v[40:43], v85 offset:3072
  ds_read_b128 v[44:47], v85 offset:10240
  ds_read_b128 v[48:51], v85 offset:11264
  s_waitcnt vmcnt(0)
  ds_read_b128 v[96:99], v1 offset:2048
  ds_read_b128 v[100:103], v1 offset:3072
  s_waitcnt lgkmcnt(0)
  s_barrier
  s_cmp_lg_u32 s20, 3
  s_cbranch_scc1 Lnosig_43
  s_mov_b32 s63, s25
  s_atomic_smax s63, s[4:5], s62 glc
Lnosig_43:
  s_cmp_ge_u32 s25, 64
  s_cbranch_scc1 L_QK_end
  s_cmp_lg_u32 s56, 0
  s_cbranch_scc1 Ltrigd_45
  buffer_load_dword v76, v90, s[4:7], 0 offen offset:0 sc1
  s_sleep 1
  buffer_load_dword v77, v90, s[4:7], 0 offen offset:0 sc1
  s_sleep 1
  buffer_load_dword v78, v90, s[4:7], 0 offen offset:0 sc1
  s_sleep 1
Ltrig_44:
  s_sub_u32 s24, s24, 1
  s_cbranch_scc1 L_FAIL
  buffer_load_dword v79, v90, s[4:7], 0 offen offset:0 sc1
  s_waitcnt vmcnt(3)
  v_cmp_gt_i32 vcc, s25, v76
  s_cbranch_vccz Ltrigd_45
  buffer_load_dword v76, v90, s[4:7], 0 offen offset:0 sc1
  s_waitcnt vmcnt(3)
  v_cmp_gt_i32 vcc, s25, v77
  s_cbranch_vccz Ltrigd_45
  buffer_load_dword v77, v90, s[4:7], 0 offen offset:0 sc1
  s_waitcnt vmcnt(3)
  v_cmp_gt_i32 vcc, s25, v78
  s_cbranch_vccz Ltrigd_45
  buffer_load_dword v78, v90, s[4:7], 0 offen offset:0 sc1
  s_waitcnt vmcnt(3)
  v_cmp_gt_i32 vcc, s25, v79
  s_cbranch_vccnz Ltrig_44
Ltrigd_45:
  s_barrier
L_QKM_again:
  buffer_load_dwordx4 v[4:7], v95, s[4:7], s92 offen offset:0 sc1
  s_nop 0
  buffer_load_dwordx4 v[8:11], v95, s[4:7], s92 offen offset:1024 sc1
  s_nop 0
  buffer_load_dwordx4 v[12:15], v95, s[4:7], s93 offen offset:0 sc1
  s_nop 0
  buffer_load_dwordx4 v[16:19], v95, s[4:7], s93 offen offset:1024 sc1
  s_nop 0
  buffer_load_dwordx4 v[68:71], v95, s[4:7], s94 offen offset:0 sc1
  s_nop 0
  s_waitcnt vmcnt(4)
  v_smfmac_f32_16x16x64_bf16 v[52:55], v[4:7], a[0:7], v88
  buffer_load_dwordx4 v[72:75], v95, s[4:7], s94 offen offset:1024 sc1
  v_max3_u32 v89, v4, v5, v6
  v_smfmac_f32_16x16x64_bf16 v[60:63], v[4:7], v[128:135], v88
  v_max3_u32 v89, v6, v7, v89
  v_smfmac_f32_16x16x64_bf16 v[56:59], v[4:7], a[128:135], v88
  v_smfmac_f32_16x16x64_bf16 v[64:67], v[4:7], v[20:27], v88
  s_waitcnt vmcnt(4)
  v_smfmac_f32_16x16x64_bf16 v[52:55], v[8:11], a[8:15], v88
  buffer_load_dwordx4 v[4:7], v95, s[4:7], s95 offen offset:0 sc1
  v_max3_u32 v89, v8, v9, v89
  v_max3_u32 v89, v10, v11, v89
  v_smfmac_f32_16x16x64_bf16 v[60:63], v[8:11], v[136:143], v88
  v_cmp_eq_u32 vcc, -1, v89
  v_smfmac_f32_16x16x64_bf16 v[56:59], v[8:11], a[136:143], v88
  ds_read_b128 v[20:23], v85 offset:4096
  v_smfmac_f32_16x16x64_bf16 v[64:67], v[8:11], v[28:35], v88
  ds_read_b128 v[24:27], v85 offset:5120
  s_cbranch_vccnz L_QKM_redo
  s_waitcnt vmcnt(4)
  v_smfmac_f32_16x16x64_bf16 v[52:55], v[12:15], a[16:23], v88
  buffer_load_dwordx4 v[8:11], v95, s[4:7], s95 offen offset:1024 sc1
  v_max3_u32 v89, v12, v13, v89
  v_smfmac_f32_16x16x64_bf16 v[60:63], v[12:15], v[144:151], v88
  v_max3_u32 v89, v14, v15, v89
  v_smfmac_f32_16x16x64_bf16 v[56:59], v[12:15], a[144:151], v88
  ds_read_b128 v[28:31], v85 offset:12288
  v_smfmac_f32_16x16x64_bf16 v[64:67], v[12:15], v[36:43], v88
  ds_read_b128 v[32:35], v85 offset:13312
  s_waitcnt vmcnt(4)
  v_smfmac_f32_16x16x64_bf16 v[52:55], v[16:19], a[24:31], v88
  buffer_load_dwordx4 v[12:15], v95, s[4:7], s96 offen offset:0 sc1
  v_max3_u32 v89, v16, v17, v89
  v_smfmac_f32_16x16x64_bf16 v[60:63], v[16:19], v[152:159], v88
  v_max3_u32 v89, v18, v19, v89
  v_smfmac_f32_16x16x64_bf16 v[56:59], v[16:19], a[152:159], v88
  ds_read_b128 v[36:39], v85 offset:6144
  v_smfmac_f32_16x16x64_bf16 v[64:67], v[16:19], v[44:51], v88
  ds_read_b128 v[40:43], v85 offset:7168
  s_waitcnt vmcnt(4)
  s_waitcnt lgkmcnt(4)
  v_smfmac_f32_16x16x64_bf16 v[52:55], v[68:71], a[32:39], v88
  buffer_load_dwordx4 v[16:19], v95, s[4:7], s96 offen offset:1024 sc1
  v_max3_u32 v89, v68, v69, v89
  v_smfmac_f32_16x16x64_bf16 v[60:63], v[68:71], v[160:167], v88
  v_max3_u32 v89, v70, v71, v89
  v_smfmac_f32_16x16x64_bf16 v[56:59], v[68:71], a[160:167], v88
  ds_read_b128 v[44:47], v85 offset:14336
  v_smfmac_f32_16x16x64_bf16 v[64:67], v[68:71], v[20:27], v88
  ds_read_b128 v[48:51], v85 offset:15360
  s_waitcnt vmcnt(4)
  s_waitcnt lgkmcnt(4)
  v_smfmac_f32_16x16x64_bf16 v[52:55], v[72:75], a[40:47], v88
  buffer_load_dwordx4 v[68:71], v95, s[4:7], s97 offen offset:0 sc1
  v_max3_u32 v89, v72, v73, v89
  v_smfmac_f32_16x16x64_bf16 v[60:63], v[72:75], v[168:175], v88
  v_max3_u32 v89, v74, v75, v89
  v_smfmac_f32_16x16x64_bf16 v[56:59], v[72:75], a[168:175], v88
  ds_read_b128 v[20:23], v85 offset:16384
  v_smfmac_f32_16x16x64_bf16 v[64:67], v[72:75], v[28:35], v88
  ds_read_b128 v[24:27], v85 offset:17408
  s_waitcnt vmcnt(4)
  s_waitcnt lgkmcnt(4)
  v_smfmac_f32_16x16x64_bf16 v[52:55], v[4:7], a[48:55], v88
  buffer_load_dwordx4 v[72:75], v95, s[4:7], s97 offen offset:1024 sc1
  v_max3_u32 v89, v4, v5, v89
  v_smfmac_f32_16x16x64_bf16 v[60:63], v[4:7], v[176:183], v88
  v_max3_u32 v89, v6, v7, v89
  v_smfmac_f32_16x16x64_bf16 v[56:59], v[4:7], a[176:183], v88
  ds_read_b128 v[28:31], v85 offset:24576
  v_smfmac_f32_16x16x64_bf16 v[64:67], v[4:7], v[36:43], v88
  ds_read_b128 v[32:35], v85 offset:25600
  s_waitcnt vmcnt(3)
  s_waitcnt lgkmcnt(4)
  v_smfmac_f32_16x16x64_bf16 v[52:55], v[8:11], a[56:63], v88
  buffer_load_dwordx4 v[4:7], v95, s[4:7], s98 offen offset:0 sc1
  v_max3_u32 v76, v12, v13, v14
  v_max_u32 v76, v76, v15
  v_smfmac_f32_16x16x64_bf16 v[60:63], v[8:11], v[184:191], v88
  v_cmp_eq_u32 vcc, -1, v76
  v_max3_u32 v89, v8, v9, v89
  v_smfmac_f32_16x16x64_bf16 v[56:59], v[8:11], a[184:191], v88
  v_max3_u32 v89, v10, v11, v89
  ds_read_b128 v[36:39], v85 offset:18432
  v_smfmac_f32_16x16x64_bf16 v[64:67], v[8:11], v[44:51], v88
  ds_read_b128 v[40:43], v85 offset:19456
  s_cbranch_vccnz L_QKM_g8
L_QKM_ok8:
  s_waitcnt lgkmcnt(4)
  v_smfmac_f32_16x16x64_bf16 v[52:55], v[12:15], a[64:71], v88
  buffer_load_dwordx4 v[8:11], v95, s[4:7], s98 offen offset:1024 sc1
  ds_read_b128 v[44:47], v85 offset:26624
  v_smfmac_f32_16x16x64_bf16 v[60:63], v[12:15], v[192:199], v88
  ds_read_b128 v[48:51], v85 offset:27648
  v_smfmac_f32_16x16x64_bf16 v[56:59], v[12:15], a[192:199], v88
  v_smfmac_f32_16x16x64_bf16 v[64:67], v[12:15], v[20:27], v88
  s_waitcnt vmcnt(4)
  s_waitcnt lgkmcnt(4)
  v_smfmac_f32_16x16x64_bf16 v[52:55], v[16:19], a[72:79], v88
  buffer_load_dwordx4 v[12:15], v95, s[4:7], s99 offen offset:0 sc1
  v_max3_u32 v89, v16, v17, v89
  v_smfmac_f32_16x16x64_bf16 v[60:63], v[16:19], v[200:207], v88
  v_max3_u32 v89, v18, v19, v89
  v_smfmac_f32_16x16x64_bf16 v[56:59], v[16:19], a[200:207], v88
  ds_read_b128 v[20:23], v85 offset:20480
  v_smfmac_f32_16x16x64_bf16 v[64:67], v[16:19], v[28:35], v88
  ds_read_b128 v[24:27], v85 offset:21504
  s_waitcnt vmcnt(4)
  s_waitcnt lgkmcnt(4)
  v_smfmac_f32_16x16x64_bf16 v[52:55], v[68:71], a[80:87], v88
  buffer_load_dwordx4 v[16:19], v95, s[4:7], s99 offen offset:1024 sc1
  v_max3_u32 v89, v68, v69, v89
  v_smfmac_f32_16x16x64_bf16 v[60:63], v[68:71], v[208:215], v88
  v_max3_u32 v89, v70, v71, v89
  v_smfmac_f32_16x16x64_bf16 v[56:59], v[68:71], a[208:215], v88
  ds_read_b128 v[28:31], v85 offset:28672
  v_smfmac_f32_16x16x64_bf16 v[64:67], v[68:71], v[36:43], v88
  ds_read_b128 v[32:35], v85 offset:29696
  s_waitcnt vmcnt(4)
  s_waitcnt lgkmcnt(4)
  v_smfmac_f32_16x16x64_bf16 v[52:55], v[72:75], a[88:95], v88
  v_max3_u32 v89, v72, v73, v89
  v_smfmac_f32_16x16x64_bf16 v[60:63], v[72:75], v[216:223], v88
  v_max3_u32 v89, v74, v75, v89
  v_smfmac_f32_16x16x64_bf16 v[56:59], v[72:75], a[216:223], v88
  ds_read_b128 v[36:39], v85 offset:22528
  v_smfmac_f32_16x16x64_bf16 v[64:67], v[72:75], v[44:51], v88
  ds_read_b128 v[40:43], v85 offset:23552
  s_waitcnt vmcnt(3)
  s_waitcnt lgkmcnt(4)
  v_smfmac_f32_16x16x64_bf16 v[52:55], v[4:7], a[96:103], v88
  v_max3_u32 v89, v4, v5, v89
  v_smfmac_f32_16x16x64_bf16 v[60:63], v[4:7], v[224:231], v88
  v_max3_u32 v89, v6, v7, v89
  v_smfmac_f32_16x16x64_bf16 v[56:59], v[4:7], a[224:231], v88
  ds_read_b128 v[44:47], v85 offset:30720
  v_smfmac_f32_16x16x64_bf16 v[64:67], v[4:7], v[20:27], v88
  ds_read_b128 v[48:51], v85 offset:31744
  s_waitcnt vmcnt(2)
  s_waitcnt lgkmcnt(4)
  v_smfmac_f32_16x16x64_bf16 v[52:55], v[8:11], a[104:111], v88
  v_max3_u32 v89, v8, v9, v89
  v_smfmac_f32_16x16x64_bf16 v[60:63], v[8:11], v[232:239], v88
  v_max3_u32 v89, v10, v11, v89
  v_smfmac_f32_16x16x64_bf16 v[56:59], v[8:11], a[232:239], v88
  ds_read_b128 v[20:23], v1 offset:16384
  v_smfmac_f32_16x16x64_bf16 v[64:67], v[8:11], v[28:35], v88
  ds_read_b128 v[24:27], v1 offset:17408
  s_waitcnt vmcnt(1)
  s_waitcnt lgkmcnt(4)
  v_smfmac_f32_16x16x64_bf16 v[52:55], v[12:15], a[112:119], v88
  v_max3_u32 v89, v12, v13, v89
  v_smfmac_f32_16x16x64_bf16 v[60:63], v[12:15], v[240:247], v88
  v_max3_u32 v89, v14, v15, v89
  v_smfmac_f32_16x16x64_bf16 v[56:59], v[12:15], a[240:247], v88
  ds_read_b128 v[28:31], v2 offset:16384
  v_smfmac_f32_16x16x64_bf16 v[64:67], v[12:15], v[36:43], v88
  ds_read_b128 v[32:35], v2 offset:17408
  s_waitcnt vmcnt(0)
  s_waitcnt lgkmcnt(4)
  v_smfmac_f32_16x16x64_bf16 v[52:55], v[16:19], a[120:127], v88
  v_max3_u32 v89, v16, v17, v89
  v_max3_u32 v89, v18, v19, v89
  v_smfmac_f32_16x16x64_bf16 v[60:63], v[16:19], v[248:255], v88
  v_cmp_eq_u32 vcc, -1, v89
  v_smfmac_f32_16x16x64_bf16 v[56:59], v[16:19], a[248:255], v88
  ds_read_b128 v[36:39], v3 offset:16384
  v_smfmac_f32_16x16x64_bf16 v[64:67], v[16:19], v[44:51], v88
  ds_read_b128 v[40:43], v3 offset:17408
  s_cbranch_vccnz L_QKM_redo
  ds_read_b128 v[44:47], v84 offset:16384
  ds_read_b128 v[48:51], v84 offset:17408
  v_pk_add_f32 v[60:61], v[60:61], v[62:63]
  v_pk_add_f32 v[52:53], v[52:53], v[54:55]
  v_cvt_pk_bf16_f32 v68, v60, v61
  v_cvt_pk_bf16_f32 v69, v52, v53
  v_pk_add_f32 v[64:65], v[64:65], v[66:67]
  v_pk_add_f32 v[56:57], v[56:57], v[58:59]
  v_cvt_pk_bf16_f32 v70, v64, v65
  v_cvt_pk_bf16_f32 v71, v56, v57
  ds_write_b128 v122, v[68:71]
  s_waitcnt lgkmcnt(0)
  s_barrier
  ds_read_b64_tr_b16 v[4:5], v123 offset:0
  ds_read_b64_tr_b16 v[6:7], v123 offset:8
  ds_read_b64_tr_b16 v[8:9], v124 offset:0
  ds_read_b64_tr_b16 v[10:11], v124 offset:8
  ds_read_b64_tr_b16 v[12:13], v125 offset:0
  ds_read_b64_tr_b16 v[14:15], v125 offset:8
  ds_read_b64_tr_b16 v[16:17], v126 offset:0
  ds_read_b64_tr_b16 v[18:19], v126 offset:8
  s_waitcnt lgkmcnt(6)
  v_mfma_f32_16x16x32_bf16 v[52:55], v[20:23], v[4:7], 0
  v_mfma_f32_16x16x32_bf16 v[56:59], v[24:27], v[4:7], 0
  v_mfma_f32_16x16x32_bf16 v[60:63], v[4:7], v[4:7], 0
  s_waitcnt lgkmcnt(4)
  v_mfma_f32_16x16x32_bf16 v[52:55], v[28:31], v[8:11], v[52:55]
  v_mfma_f32_16x16x32_bf16 v[56:59], v[32:35], v[8:11], v[56:59]
  v_mfma_f32_16x16x32_bf16 v[60:63], v[8:11], v[8:11], v[60:63]
  s_waitcnt lgkmcnt(2)
  v_mfma_f32_16x16x32_bf16 v[52:55], v[36:39], v[12:15], v[52:55]
  v_mfma_f32_16x16x32_bf16 v[56:59], v[40:43], v[12:15], v[56:59]
  v_mfma_f32_16x16x32_bf16 v[60:63], v[12:15], v[12:15], v[60:63]
  s_waitcnt lgkmcnt(0)
  v_mfma_f32_16x16x32_bf16 v[52:55], v[44:47], v[16:19], v[52:55]
  v_mfma_f32_16x16x32_bf16 v[56:59], v[48:51], v[16:19], v[56:59]
  v_mfma_f32_16x16x32_bf16 v[60:63], v[16:19], v[16:19], v[60:63]
  buffer_load_dwordx2 v[104:105], v92, s[4:7], s29 offen sc1
  s_nop 4
  v_max3_f32 v64, v52, v53, v54
  v_max3_f32 v65, v55, v56, v57
  v_max3_f32 v64, v64, v58, v59
  v_max3_f32 v65, v65, v60, v61
  v_max_f32 v66, v64, v65
  v_max_f32 v67, v64, v65
  s_nop 1
  v_permlane16_swap_b32 v66, v67
  v_max_f32 v64, v66, v67
  v_max_f32 v65, v66, v67
  s_nop 1
  v_permlane32_swap_b32 v64, v65
  v_max_f32 v64, v64, v65
  v_mul_f32 v64, s38, v64
  v_pk_fma_f32 v[52:53], v[52:53], s[38:39], v[64:65] op_sel_hi:[1,1,0] neg_lo:[0,0,1] neg_hi:[0,0,1]
  v_pk_fma_f32 v[54:55], v[54:55], s[38:39], v[64:65] op_sel_hi:[1,1,0] neg_lo:[0,0,1] neg_hi:[0,0,1]
  v_pk_fma_f32 v[56:57], v[56:57], s[38:39], v[64:65] op_sel_hi:[1,1,0] neg_lo:[0,0,1] neg_hi:[0,0,1]
  v_pk_fma_f32 v[58:59], v[58:59], s[38:39], v[64:65] op_sel_hi:[1,1,0] neg_lo:[0,0,1] neg_hi:[0,0,1]
  v_pk_fma_f32 v[60:61], v[60:61], s[38:39], v[64:65] op_sel_hi:[1,1,0] neg_lo:[0,0,1] neg_hi:[0,0,1]
  v_exp_f32 v52, v52
  v_exp_f32 v53, v53
  v_exp_f32 v54, v54
  v_exp_f32 v55, v55
  v_exp_f32 v56, v56
  v_exp_f32 v57, v57
  v_exp_f32 v58, v58
  v_exp_f32 v59, v59
  v_cvt_pk_bf16_f32 v68, v52, v53
  v_cvt_pk_bf16_f32 v69, v54, v55
  v_cvt_pk_bf16_f32 v70, v56, v57
  v_cvt_pk_bf16_f32 v71, v58, v59
  v_exp_f32 v60, v60
  v_exp_f32 v61, v61
  v_mfma_f32_16x16x32_bf16 v[64:67], v[116:119], v[68:71], 0
  v_cvt_pk_bf16_f32 v108, v60, v61
  v_mfma_f32_16x16x32_bf16 v[52:55], v[96:99], v[68:71], 0
  v_cvt_pk_bf16_f32 v113, v60, v61
L_QK_vchk:
  s_waitcnt vmcnt(0)
  v_mfma_f32_16x16x32_bf16 v[56:59], v[100:103], v[68:71], 0
  v_max_u32 v89, v104, v105
  v_cmp_eq_u32 vcc, -1, v89
  s_cbranch_vccnz L_QK_vbad
  v_mfma_f32_16x16x32_bf16 v[64:67], v[116:119], v[108:111], v[64:67]
  v_mfma_f32_16x16x32_bf16 v[52:55], v[104:107], v[108:111], v[52:55]
  v_mfma_f32_16x16x32_bf16 v[56:59], v[104:107], v[112:115], v[56:59]
  buffer_store_dword v94, v91, s[4:7], s57 offen
  s_nop 4
  v_rcp_f32 v64, v64
  s_nop 0
  v_pk_mul_f32 v[52:53], v[52:53], v[64:65] op_sel_hi:[1,0]
  v_pk_mul_f32 v[54:55], v[54:55], v[64:65] op_sel_hi:[1,0]
  v_pk_mul_f32 v[56:57], v[56:57], v[64:65] op_sel_hi:[1,0]
  v_pk_mul_f32 v[58:59], v[58:59], v[64:65] op_sel_hi:[1,0]
  v_cvt_pk_bf16_f32 v72, v52, v53
  v_cvt_pk_bf16_f32 v73, v54, v55
  v_cvt_pk_bf16_f32 v74, v56, v57
  v_cvt_pk_bf16_f32 v75, v58, v59
  v_min_u32 v72, -2, v72
  v_min_u32 v73, -2, v73
  v_min_u32 v74, -2, v74
  v_min_u32 v75, -2, v75
  buffer_store_dwordx4 v[72:75], v120, s[4:7], s48 offen
  ds_read_b128 v[68:71], v1 offset:0
  ds_read_b128 v[80:83], v1 offset:1024
  ds_read_b128 v[116:119], v2 offset:1024
  s_add_u32 s32, s32, 786432
  s_add_u32 s33, s25, 2
  s_min_u32 s33, s33, 64
  s_waitcnt lgkmcnt(0)
  buffer_store_dwordx4 v[72:75], v120, s[4:7], s28 offen sc1
  s_nop 1
  ds_read_b128 v[72:75], v2 offset:0
  v_mfma_f32_16x16x32_bf16 v[52:55], v[20:23], v[68:71], 0
  v_mfma_f32_16x16x32_bf16 v[56:59], v[20:23], v[80:83], 0
  v_mfma_f32_16x16x32_bf16 v[60:63], v[24:27], v[80:83], 0
  v_mfma_f32_16x16x32_bf16 v[64:67], v[4:7], v[68:71], 0
  v_mfma_f32_16x16x32_bf16 v[76:79], v[4:7], v[80:83], 0
  ds_read_b128 v[20:23], v3 offset:0
  ds_read_b128 v[24:27], v3 offset:1024
  s_waitcnt lgkmcnt(2)
  v_mfma_f32_16x16x32_bf16 v[52:55], v[28:31], v[72:75], v[52:55]
  v_mfma_f32_16x16x32_bf16 v[56:59], v[28:31], v[116:119], v[56:59]
  v_mfma_f32_16x16x32_bf16 v[60:63], v[32:35], v[116:119], v[60:63]
  v_mfma_f32_16x16x32_bf16 v[64:67], v[8:11], v[72:75], v[64:67]
  v_mfma_f32_16x16x32_bf16 v[76:79], v[8:11], v[116:119], v[76:79]
  ds_read_b128 v[28:31], v84 offset:0
  ds_read_b128 v[32:35], v84 offset:1024
  s_waitcnt lgkmcnt(2)
  v_mfma_f32_16x16x32_bf16 v[52:55], v[36:39], v[20:23], v[52:55]
  v_mfma_f32_16x16x32_bf16 v[56:59], v[36:39], v[24:27], v[56:59]
  v_mfma_f32_16x16x32_bf16 v[60:63], v[40:43], v[24:27], v[60:63]
  v_mfma_f32_16x16x32_bf16 v[64:67], v[12:15], v[20:23], v[64:67]
  v_mfma_f32_16x16x32_bf16 v[76:79], v[12:15], v[24:27], v[76:79]
  s_waitcnt lgkmcnt(0)
  v_mfma_f32_16x16x32_bf16 v[52:55], v[44:47], v[28:31], v[52:55]
  v_mfma_f32_16x16x32_bf16 v[56:59], v[44:47], v[32:35], v[56:59]
  v_mfma_f32_16x16x32_bf16 v[60:63], v[48:51], v[32:35], v[60:63]
  v_mfma_f32_16x16x32_bf16 v[64:67], v[16:19], v[28:31], v[64:67]
  v_mfma_f32_16x16x32_bf16 v[76:79], v[16:19], v[32:35], v[76:79]
  buffer_load_dword v89, v87, s[4:7], s28 offen sc1
  s_barrier
  s_cmp_ge_i32 s59, s33
  s_cbranch_scc1 Lhave_46
  s_nop 3
Lpoll_47:
  buffer_load_dword v89, v121, s[4:7], 0 offen sc1
  s_sub_u32 s24, s24, 1
  s_cbranch_scc1 L_FAIL
  s_waitcnt vmcnt(0)
  v_cmp_gt_i32 vcc, s33, v89
  s_cbranch_vccz Lpolld_48
  s_sleep 2
  s_branch Lpoll_47
Lpolld_48:
  v_readlane_b32 s59, v89, 0
  v_readlane_b32 s40, v89, 1
  s_min_i32 s59, s59, s40
Lhave_46:
  v_mov_b32 v80, -1
  v_mov_b32 v81, -1
  v_mov_b32 v82, -1
  v_mov_b32 v83, -1
  s_add_u32 m0, s58, 16384
  s_add_u32 s31, s32, 8192
  buffer_load_dwordx4 v95, s[4:7], s31 offen sc1 lds
  v_mov_b32 v116, 0x3f803f80
  v_mov_b32 v117, 0x3f803f80
  v_mov_b32 v118, 0x3f803f80
  v_mov_b32 v119, 0x3f803f80
  v_mov_b64 v[70:71], 0
  v_mov_b64 v[20:21], 0
  buffer_load_dwordx4 v95, s[4:7], s31 offen offset:1024 sc1 lds
  v_mov_b64 v[22:23], 0
  v_mov_b64 v[24:25], 0
  v_mov_b64 v[26:27], 0
  v_cndmask_b32 v52, v86, v52, s[8:9]
  v_cndmask_b32 v53, v86, v53, s[10:11]
  v_cndmask_b32 v54, v86, v54, s[16:17]
  s_add_u32 m0, s58, 2048
  s_add_u32 s31, s32, 16384
  buffer_load_dwordx4 v95, s[4:7], s31 offen sc1 lds
  v_cndmask_b32 v55, v86, v55, s[18:19]
  v_cndmask_b32 v60, v86, v60, s[8:9]
  v_cndmask_b32 v61, v86, v61, s[10:11]
  v_cndmask_b32 v62, v86, v62, s[16:17]
  v_cndmask_b32 v63, v86, v63, s[18:19]
  v_max3_f32 v28, v52, v53, v54
  buffer_load_dwordx4 v95, s[4:7], s31 offen offset:1024 sc1 lds
  v_max3_f32 v30, v56, v57, v58
  v_max3_f32 v28, v28, v55, v64
  v_max3_f32 v30, v30, v59, v60
  v_max_f32 v28, v28, v65
  v_max3_f32 v30, v30, v61, v62
  v_max3_f32 v30, v30, v63, v76
  s_add_u32 m0, s58, 0
  s_add_u32 s31, s32, 0
  buffer_load_dwordx4 v95, s[4:7], s31 offen sc1 lds
  v_max_f32 v30, v30, v77
  v_mov_b32 v29, v28
  v_mov_b32 v31, v30
  s_nop 0
  v_permlane16_swap_b32 v29, v28
  v_permlane16_swap_b32 v31, v30
  v_max_f32 v28, v28, v29
  buffer_load_dwordx4 v95, s[4:7], s31 offen offset:1024 sc1 lds
  v_max_f32 v30, v30, v31
  v_mov_b32 v29, v28
  v_mov_b32 v31, v30
  s_nop 0
  v_permlane32_swap_b32 v29, v28
  v_permlane32_swap_b32 v31, v30
  v_max_f32 v28, v28, v29
  buffer_store_dwordx4 v[80:83], v120, s[4:7], s34 offen sc1
  v_max_f32 v30, v30, v31
  v_mul_f32 v28, s38, v28
  v_mul_f32 v30, s38, v30
  v_pk_fma_f32 v[52:53], v[52:53], s[38:39], v[28:29] op_sel_hi:[1,1,0] neg_lo:[0,0,1] neg_hi:[0,0,1]
  v_pk_fma_f32 v[54:55], v[54:55], s[38:39], v[28:29] op_sel_hi:[1,1,0] neg_lo:[0,0,1] neg_hi:[0,0,1]
  v_pk_fma_f32 v[64:65], v[64:65], s[38:39], v[28:29] op_sel_hi:[1,1,0] neg_lo:[0,0,1] neg_hi:[0,0,1]
  s_xor_b32 s40, s34, 8192
  buffer_store_dwordx4 v[80:83], v120, s[4:7], s40 offen
  v_pk_fma_f32 v[56:57], v[56:57], s[38:39], v[30:31] op_sel_hi:[1,1,0] neg_lo:[0,0,1] neg_hi:[0,0,1]
  v_pk_fma_f32 v[58:59], v[58:59], s[38:39], v[30:31] op_sel_hi:[1,1,0] neg_lo:[0,0,1] neg_hi:[0,0,1]
  v_pk_fma_f32 v[60:61], v[60:61], s[38:39], v[30:31] op_sel_hi:[1,1,0] neg_lo:[0,0,1] neg_hi:[0,0,1]
  v_pk_fma_f32 v[62:63], v[62:63], s[38:39], v[30:31] op_sel_hi:[1,1,0] neg_lo:[0,0,1] neg_hi:[0,0,1]
  v_pk_fma_f32 v[76:77], v[76:77], s[38:39], v[30:31] op_sel_hi:[1,1,0] neg_lo:[0,0,1] neg_hi:[0,0,1]
  v_exp_f32 v52, v52
  v_exp_f32 v53, v53
  v_exp_f32 v54, v54
  v_exp_f32 v55, v55
  v_exp_f32 v64, v64
  v_exp_f32 v65, v65
  v_exp_f32 v56, v56
  v_exp_f32 v57, v57
  v_exp_f32 v58, v58
  v_exp_f32 v59, v59
  v_exp_f32 v60, v60
  v_exp_f32 v61, v61
  v_exp_f32 v62, v62
  v_exp_f32 v63, v63
  v_exp_f32 v76, v76
  v_exp_f32 v77, v77
  v_cvt_pk_bf16_f32 v68, v52, v53
  v_cvt_pk_bf16_f32 v69, v54, v55
  v_cvt_pk_bf16_f32 v108, v64, v65
  v_cvt_pk_bf16_f32 v113, v64, v65
  v_cvt_pk_bf16_f32 v72, v56, v57
  v_cvt_pk_bf16_f32 v73, v58, v59
  v_cvt_pk_bf16_f32 v74, v60, v61
  v_cvt_pk_bf16_f32 v75, v62, v63
  v_cvt_pk_bf16_f32 v20, v76, v77
  v_cvt_pk_bf16_f32 v25, v76, v77
  v_mfma_f32_16x16x32_bf16 v[32:35], v[116:119], v[68:71], 0
  v_mfma_f32_16x16x32_bf16 v[52:55], v[96:99], v[68:71], 0
  v_mfma_f32_16x16x32_bf16 v[56:59], v[100:103], v[68:71], 0
  v_mfma_f32_16x16x32_bf16 v[32:35], v[116:119], v[108:111], v[32:35]
  v_mfma_f32_16x16x32_bf16 v[52:55], v[104:107], v[108:111], v[52:55]
  v_mfma_f32_16x16x32_bf16 v[56:59], v[104:107], v[112:115], v[56:59]
  v_mfma_f32_16x16x32_bf16 v[36:39], v[116:119], v[72:75], 0
  v_mfma_f32_16x16x32_bf16 v[60:63], v[96:99], v[72:75], 0
  v_mfma_f32_16x16x32_bf16 v[64:67], v[100:103], v[72:75], 0
  v_mfma_f32_16x16x32_bf16 v[36:39], v[116:119], v[20:23], v[36:39]
  v_mfma_f32_16x16x32_bf16 v[60:63], v[104:107], v[20:23], v[60:63]
  v_mfma_f32_16x16x32_bf16 v[64:67], v[104:107], v[24:27], v[64:67]
  v_rcp_f32 v32, v32
  s_nop 0
  v_pk_mul_f32 v[52:53], v[52:53], v[32:33] op_sel_hi:[1,0]
  v_pk_mul_f32 v[54:55], v[54:55], v[32:33] op_sel_hi:[1,0]
  v_pk_mul_f32 v[56:57], v[56:57], v[32:33] op_sel_hi:[1,0]
  v_pk_mul_f32 v[58:59], v[58:59], v[32:33] op_sel_hi:[1,0]
  v_cvt_pk_bf16_f32 v4, v52, v53
  v_cvt_pk_bf16_f32 v5, v54, v55
  v_cvt_pk_bf16_f32 v6, v56, v57
  v_cvt_pk_bf16_f32 v7, v58, v59
  buffer_store_dwordx4 v[4:7], v95, s[4:7], s30 offen offset:0 sc1
  v_rcp_f32 v36, v36
  s_nop 0
  v_pk_mul_f32 v[60:61], v[60:61], v[36:37] op_sel_hi:[1,0]
  v_pk_mul_f32 v[62:63], v[62:63], v[36:37] op_sel_hi:[1,0]
  v_pk_mul_f32 v[64:65], v[64:65], v[36:37] op_sel_hi:[1,0]
  v_pk_mul_f32 v[66:67], v[66:67], v[36:37] op_sel_hi:[1,0]
  v_cvt_pk_bf16_f32 v8, v60, v61
  v_cvt_pk_bf16_f32 v9, v62, v63
  v_cvt_pk_bf16_f32 v10, v64, v65
  v_cvt_pk_bf16_f32 v11, v66, v67
  buffer_store_dwordx4 v[8:11], v95, s[4:7], s30 offen offset:1024 sc1
  s_add_u32 s30, s30, 262144
  s_add_u32 s25, s25, 1
  s_branch L_QK_top
L_QK_end:
  s_branch L_END
L_QKM_redo:
  s_nop 7
  s_sub_u32 s24, s24, 1
  s_cbranch_scc1 L_FAIL
  s_add_u32 s60, s60, 0x10000
  s_waitcnt vmcnt(0) lgkmcnt(0)
  v_mov_b64 v[52:53], 0
  v_mov_b64 v[54:55], 0
  v_mov_b64 v[56:57], 0
  v_mov_b64 v[58:59], 0
  v_mov_b64 v[60:61], 0
  v_mov_b64 v[62:63], 0
  v_mov_b64 v[64:65], 0
  v_mov_b64 v[66:67], 0
  ds_read_b128 v[20:23], v85 offset:0
  ds_read_b128 v[24:27], v85 offset:1024
  ds_read_b128 v[28:31], v85 offset:8192
  ds_read_b128 v[32:35], v85 offset:9216
  ds_read_b128 v[36:39], v85 offset:2048
  ds_read_b128 v[40:43], v85 offset:3072
  ds_read_b128 v[44:47], v85 offset:10240
  ds_read_b128 v[48:51], v85 offset:11264
  s_waitcnt lgkmcnt(0)
  s_branch L_QKM_again
L_QKM_g8:
  s_sub_u32 s24, s24, 1
  s_cbranch_scc1 L_FAIL
  s_add_u32 s60, s60, 256
  s_waitcnt vmcnt(0)
  buffer_load_dwordx4 v[12:15], v95, s[4:7], s96 offen offset:0 sc1
  buffer_load_dwordx4 v[16:19], v95, s[4:7], s96 offen offset:1024 sc1
  buffer_load_dwordx4 v[68:71], v95, s[4:7], s97 offen offset:0 sc1
  buffer_load_dwordx4 v[72:75], v95, s[4:7], s97 offen offset:1024 sc1
  buffer_load_dwordx4 v[4:7], v95, s[4:7], s98 offen offset:0 sc1
  s_waitcnt vmcnt(4)
  v_max3_u32 v76, v12, v13, v14
  v_max_u32 v76, v76, v15
  v_cmp_eq_u32 vcc, -1, v76
  s_cbranch_vccnz L_QKM_g8
  s_branch L_QKM_ok8
L_QK_vbad:
  s_sub_u32 s24, s24, 1
  s_cbranch_scc1 L_FAIL
  s_add_u32 s61, s61, 1
  buffer_load_dwordx2 v[104:105], v92, s[4:7], s29 offen sc1
  s_waitcnt vmcnt(0)
  s_branch L_QK_vchk
L_VO:
  v_bfe_u32 v76, v0, 3, 2
  v_xor_b32 v76, s20, v76
  v_lshlrev_b32 v76, 5, v76
  v_lshrrev_b32 v4, 2, v0
  v_lshl_add_u32 v4, v4, 7, v76
  v_and_b32 v76, 3, v0
  v_lshl_add_u32 v4, v76, 3, v4
  s_lshl_b32 s40, s20, 15
  v_add_u32 v4, s40, v4
  v_lshl_add_u32 v85, v0, 4, s40
  s_lshl_b32 s40, s20, 12
  s_add_u32 s40, s40, 131072
  v_lshl_add_u32 v1, v0, 4, s40
  s_lshr_b32 s54, s21, 4
  s_lshl_b32 s52, s54, 22
  s_sub_u32 s53, 0, s52
  v_xor_b32 v5, 32768, v4
  v_xor_b32 v2, 4096, v1
  v_xor_b32 v6, 65536, v4
  v_xor_b32 v3, 8192, v1
  v_xor_b32 v7, 98304, v4
  v_xor_b32 v84, 12288, v1
  v_bfe_u32 v8, v0, 5, 1
  v_mul_u32_u24 v8, 16384, v8
  v_bfe_u32 v76, v0, 4, 1
  v_mul_u32_u24 v76, 32768, v76
  v_add_u32 v8, v8, v76
  v_bfe_u32 v76, v0, 3, 1
  v_mul_u32_u24 v76, 131072, v76
  v_add_u32 v8, v8, v76
  v_lshrrev_b32 v76, 3, v0
  v_and_b32 v76, 6, v76
  v_xor_b32 v76, v76, v0
  v_and_b32 v76, 7, v76
  v_lshl_add_u32 v8, v76, 4, v8
  s_lshl_b32 s40, s20, 19
  v_add_u32 v8, s40, v8
  v_bfe_u32 v9, v0, 5, 1
  v_mul_u32_u24 v9, 131072, v9
  v_bfe_u32 v76, v0, 4, 1
  v_mul_u32_u24 v76, 8192, v76
  v_add_u32 v9, v9, v76
  v_bfe_u32 v76, v0, 3, 1
  v_mul_u32_u24 v76, 2048, v76
  v_add_u32 v9, v9, v76
  v_lshrrev_b32 v76, 3, v0
  v_and_b32 v76, 6, v76
  v_xor_b32 v76, v76, v0
  v_and_b32 v76, 3, v76
  v_lshl_add_u32 v9, v76, 4, v9
  v_lshrrev_b32 v76, 3, v0
  v_xor_b32 v76, v76, v0
  v_bfe_u32 v76, v76, 2, 1
  v_mul_u32_u24 v76, 65536, v76
  v_add_u32 v9, v9, v76
  v_bfe_u32 v76, v0, 3, 2
  v_xor_b32 v76, 0, v76
  v_lshlrev_b32 v76, 5, v76
  v_lshrrev_b32 v10, 2, v0
  v_lshl_add_u32 v10, v10, 7, v76
  v_and_b32 v76, 3, v0
  v_lshl_add_u32 v10, v76, 3, v10
  s_lshl_b32 s40, s20, 20
  s_lshl_b32 s41, s21, 6
  s_add_u32 s40, s40, s41
  v_add_u32 v9, s40, v9
  s_lshl_b32 s40, s20, 15
  v_add_u32 v10, s40, v10
  s_lshl_b32 s44, s21, 8
  s_add_u32 s45, s44, 128
  v_xor_b32 v11, 32, v10
  v_xor_b32 v12, 64, v10
  v_xor_b32 v13, 96, v10
  s_load_dwordx2 s[8:9], s[0:1], 40
  s_mov_b32 s10, 8388608
  s_mov_b32 s11, 0x20000
  s_waitcnt lgkmcnt(0)
  v_add_u32 v14, s44, v8
  v_add_u32 v15, s45, v8
  s_lshl_b32 s41, s20, 15
  s_add_u32 m0, s41, 0
  s_add_u32 s42, s52, 0
  buffer_load_dwordx4 v9, s[8:11], s42 offen lds
  s_add_u32 m0, s41, 1024
  s_add_u32 s42, s52, 16384
  buffer_load_dwordx4 v9, s[8:11], s42 offen lds
  s_add_u32 m0, s41, 2048
  s_add_u32 s42, s52, 4096
  buffer_load_dwordx4 v9, s[8:11], s42 offen lds
  s_add_u32 m0, s41, 3072
  s_add_u32 s42, s52, 20480
  buffer_load_dwordx4 v9, s[8:11], s42 offen lds
  s_add_u32 m0, s41, 4096
  s_add_u32 s42, s52, 32768
  buffer_load_dwordx4 v9, s[8:11], s42 offen lds
  s_add_u32 m0, s41, 5120
  s_add_u32 s42, s52, 49152
  buffer_load_dwordx4 v9, s[8:11], s42 offen lds
  s_add_u32 m0, s41, 6144
  s_add_u32 s42, s52, 36864
  buffer_load_dwordx4 v9, s[8:11], s42 offen lds
  s_add_u32 m0, s41, 7168
  s_add_u32 s42, s52, 53248
  buffer_load_dwordx4 v9, s[8:11], s42 offen lds
  s_add_u32 m0, s41, 8192
  s_add_u32 s42, s52, 262144
  buffer_load_dwordx4 v9, s[8:11], s42 offen lds
  s_add_u32 m0, s41, 9216
  s_add_u32 s42, s52, 278528
  buffer_load_dwordx4 v9, s[8:11], s42 offen lds
  s_add_u32 m0, s41, 10240
  s_add_u32 s42, s52, 266240
  buffer_load_dwordx4 v9, s[8:11], s42 offen lds
  s_add_u32 m0, s41, 11264
  s_add_u32 s42, s52, 282624
  buffer_load_dwordx4 v9, s[8:11], s42 offen lds
  s_add_u32 m0, s41, 12288
  s_add_u32 s42, s52, 294912
  buffer_load_dwordx4 v9, s[8:11], s42 offen lds
  s_add_u32 m0, s41, 13312
  s_add_u32 s42, s52, 311296
  buffer_load_dwordx4 v9, s[8:11], s42 offen lds
  s_add_u32 m0, s41, 14336
  s_add_u32 s42, s52, 299008
  buffer_load_dwordx4 v9, s[8:11], s42 offen lds
  s_add_u32 m0, s41, 15360
  s_add_u32 s42, s52, 315392
  buffer_load_dwordx4 v9, s[8:11], s42 offen lds
  s_add_u32 m0, s41, 16384
  s_add_u32 s42, s52, 524288
  buffer_load_dwordx4 v9, s[8:11], s42 offen lds
  s_add_u32 m0, s41, 17408
  s_add_u32 s42, s52, 540672
  buffer_load_dwordx4 v9, s[8:11], s42 offen lds
  s_add_u32 m0, s41, 18432
  s_add_u32 s42, s52, 528384
  buffer_load_dwordx4 v9, s[8:11], s42 offen lds
  s_add_u32 m0, s41, 19456
  s_add_u32 s42, s52, 544768
  buffer_load_dwordx4 v9, s[8:11], s42 offen lds
  s_add_u32 m0, s41, 20480
  s_add_u32 s42, s52, 557056
  buffer_load_dwordx4 v9, s[8:11], s42 offen lds
  s_add_u32 m0, s41, 21504
  s_add_u32 s42, s52, 573440
  buffer_load_dwordx4 v9, s[8:11], s42 offen lds
  s_add_u32 m0, s41, 22528
  s_add_u32 s42, s52, 561152
  buffer_load_dwordx4 v9, s[8:11], s42 offen lds
  s_add_u32 m0, s41, 23552
  s_add_u32 s42, s52, 577536
  buffer_load_dwordx4 v9, s[8:11], s42 offen lds
  s_waitcnt vmcnt(16) lgkmcnt(0)
  s_barrier
  s_add_u32 m0, s41, 24576
  s_add_u32 s42, s52, 786432
  buffer_load_dwordx4 v9, s[8:11], s42 offen lds
  s_add_u32 m0, s41, 25600
  s_add_u32 s42, s52, 802816
  buffer_load_dwordx4 v9, s[8:11], s42 offen lds
  s_add_u32 m0, s41, 26624
  s_add_u32 s42, s52, 790528
  buffer_load_dwordx4 v9, s[8:11], s42 offen lds
  s_add_u32 m0, s41, 27648
  s_add_u32 s42, s52, 806912
  buffer_load_dwordx4 v9, s[8:11], s42 offen lds
  s_add_u32 m0, s41, 28672
  s_add_u32 s42, s52, 819200
  buffer_load_dwordx4 v9, s[8:11], s42 offen lds
  s_add_u32 m0, s41, 29696
  s_add_u32 s42, s52, 835584
  buffer_load_dwordx4 v9, s[8:11], s42 offen lds
  s_add_u32 m0, s41, 30720
  s_add_u32 s42, s52, 823296
  buffer_load_dwordx4 v9, s[8:11], s42 offen lds
  s_add_u32 m0, s41, 31744
  s_add_u32 s42, s52, 839680
  buffer_load_dwordx4 v9, s[8:11], s42 offen lds
  ds_read_b64_tr_b16 a[0:1], v10 offset:0
  ds_read_b64_tr_b16 a[2:3], v10 offset:2048
  ds_read_b64_tr_b16 a[4:5], v10 offset:4096
  ds_read_b64_tr_b16 a[6:7], v10 offset:6144
  ds_read_b64_tr_b16 a[8:9], v11 offset:0
  ds_read_b64_tr_b16 a[10:11], v11 offset:2048
  ds_read_b64_tr_b16 a[12:13], v11 offset:4096
  ds_read_b64_tr_b16 a[14:15], v11 offset:6144
  ds_read_b64_tr_b16 a[16:17], v12 offset:0
  ds_read_b64_tr_b16 a[18:19], v12 offset:2048
  ds_read_b64_tr_b16 a[20:21], v12 offset:4096
  ds_read_b64_tr_b16 a[22:23], v12 offset:6144
  ds_read_b64_tr_b16 a[24:25], v13 offset:0
  ds_read_b64_tr_b16 a[26:27], v13 offset:2048
  ds_read_b64_tr_b16 a[28:29], v13 offset:4096
  ds_read_b64_tr_b16 a[30:31], v13 offset:6144
  s_waitcnt vmcnt(16) lgkmcnt(0)
  s_barrier
  s_add_u32 m0, s41, 0
  s_add_u32 s42, s53, 4194304
  buffer_load_dwordx4 v9, s[8:11], s42 offen lds
  s_add_u32 m0, s41, 1024
  s_add_u32 s42, s53, 4210688
  buffer_load_dwordx4 v9, s[8:11], s42 offen lds
  s_add_u32 m0, s41, 2048
  s_add_u32 s42, s53, 4198400
  buffer_load_dwordx4 v9, s[8:11], s42 offen lds
  s_add_u32 m0, s41, 3072
  s_add_u32 s42, s53, 4214784
  buffer_load_dwordx4 v9, s[8:11], s42 offen lds
  s_add_u32 m0, s41, 4096
  s_add_u32 s42, s53, 4227072
  buffer_load_dwordx4 v9, s[8:11], s42 offen lds
  s_add_u32 m0, s41, 5120
  s_add_u32 s42, s53, 4243456
  buffer_load_dwordx4 v9, s[8:11], s42 offen lds
  s_add_u32 m0, s41, 6144
  s_add_u32 s42, s53, 4231168
  buffer_load_dwordx4 v9, s[8:11], s42 offen lds
  s_add_u32 m0, s41, 7168
  s_add_u32 s42, s53, 4247552
  buffer_load_dwordx4 v9, s[8:11], s42 offen lds
  ds_read_b64_tr_b16 a[32:33], v10 offset:8192
  ds_read_b64_tr_b16 a[34:35], v10 offset:10240
  ds_read_b64_tr_b16 a[36:37], v10 offset:12288
  ds_read_b64_tr_b16 a[38:39], v10 offset:14336
  ds_read_b64_tr_b16 a[40:41], v11 offset:8192
  ds_read_b64_tr_b16 a[42:43], v11 offset:10240
  ds_read_b64_tr_b16 a[44:45], v11 offset:12288
  ds_read_b64_tr_b16 a[46:47], v11 offset:14336
  ds_read_b64_tr_b16 a[48:49], v12 offset:8192
  ds_read_b64_tr_b16 a[50:51], v12 offset:10240
  ds_read_b64_tr_b16 a[52:53], v12 offset:12288
  ds_read_b64_tr_b16 a[54:55], v12 offset:14336
  ds_read_b64_tr_b16 a[56:57], v13 offset:8192
  ds_read_b64_tr_b16 a[58:59], v13 offset:10240
  ds_read_b64_tr_b16 a[60:61], v13 offset:12288
  ds_read_b64_tr_b16 a[62:63], v13 offset:14336
  s_waitcnt vmcnt(16) lgkmcnt(0)
  s_barrier
  s_add_u32 m0, s41, 8192
  s_add_u32 s42, s53, 4456448
  buffer_load_dwordx4 v9, s[8:11], s42 offen lds
  s_add_u32 m0, s41, 9216
  s_add_u32 s42, s53, 4472832
  buffer_load_dwordx4 v9, s[8:11], s42 offen lds
  s_add_u32 m0, s41, 10240
  s_add_u32 s42, s53, 4460544
  buffer_load_dwordx4 v9, s[8:11], s42 offen lds
  s_add_u32 m0, s41, 11264
  s_add_u32 s42, s53, 4476928
  buffer_load_dwordx4 v9, s[8:11], s42 offen lds
  s_add_u32 m0, s41, 12288
  s_add_u32 s42, s53, 4489216
  buffer_load_dwordx4 v9, s[8:11], s42 offen lds
  s_add_u32 m0, s41, 13312
  s_add_u32 s42, s53, 4505600
  buffer_load_dwordx4 v9, s[8:11], s42 offen lds
  s_add_u32 m0, s41, 14336
  s_add_u32 s42, s53, 4493312
  buffer_load_dwordx4 v9, s[8:11], s42 offen lds
  s_add_u32 m0, s41, 15360
  s_add_u32 s42, s53, 4509696
  buffer_load_dwordx4 v9, s[8:11], s42 offen lds
  ds_read_b64_tr_b16 a[64:65], v10 offset:16384
  ds_read_b64_tr_b16 a[66:67], v10 offset:18432
  ds_read_b64_tr_b16 a[68:69], v10 offset:20480
  ds_read_b64_tr_b16 a[70:71], v10 offset:22528
  ds_read_b64_tr_b16 a[72:73], v11 offset:16384
  ds_read_b64_tr_b16 a[74:75], v11 offset:18432
  ds_read_b64_tr_b16 a[76:77], v11 offset:20480
  ds_read_b64_tr_b16 a[78:79], v11 offset:22528
  ds_read_b64_tr_b16 a[80:81], v12 offset:16384
  ds_read_b64_tr_b16 a[82:83], v12 offset:18432
  ds_read_b64_tr_b16 a[84:85], v12 offset:20480
  ds_read_b64_tr_b16 a[86:87], v12 offset:22528
  ds_read_b64_tr_b16 a[88:89], v13 offset:16384
  ds_read_b64_tr_b16 a[90:91], v13 offset:18432
  ds_read_b64_tr_b16 a[92:93], v13 offset:20480
  ds_read_b64_tr_b16 a[94:95], v13 offset:22528
  s_waitcnt vmcnt(16) lgkmcnt(0)
  s_barrier
  s_add_u32 m0, s41, 16384
  s_add_u32 s42, s53, 4718592
  buffer_load_dwordx4 v9, s[8:11], s42 offen lds
  s_add_u32 m0, s41, 17408
  s_add_u32 s42, s53, 4734976
  buffer_load_dwordx4 v9, s[8:11], s42 offen lds
  s_add_u32 m0, s41, 18432
  s_add_u32 s42, s53, 4722688
  buffer_load_dwordx4 v9, s[8:11], s42 offen lds
  s_add_u32 m0, s41, 19456
  s_add_u32 s42, s53, 4739072
  buffer_load_dwordx4 v9, s[8:11], s42 offen lds
  s_add_u32 m0, s41, 20480
  s_add_u32 s42, s53, 4751360
  buffer_load_dwordx4 v9, s[8:11], s42 offen lds
  s_add_u32 m0, s41, 21504
  s_add_u32 s42, s53, 4767744
  buffer_load_dwordx4 v9, s[8:11], s42 offen lds
  s_add_u32 m0, s41, 22528
  s_add_u32 s42, s53, 4755456
  buffer_load_dwordx4 v9, s[8:11], s42 offen lds
  s_add_u32 m0, s41, 23552
  s_add_u32 s42, s53, 4771840
  buffer_load_dwordx4 v9, s[8:11], s42 offen lds
  ds_read_b64_tr_b16 a[96:97], v10 offset:24576
  ds_read_b64_tr_b16 a[98:99], v10 offset:26624
  ds_read_b64_tr_b16 a[100:101], v10 offset:28672
  ds_read_b64_tr_b16 a[102:103], v10 offset:30720
  ds_read_b64_tr_b16 a[104:105], v11 offset:24576
  ds_read_b64_tr_b16 a[106:107], v11 offset:26624
  ds_read_b64_tr_b16 a[108:109], v11 offset:28672
  ds_read_b64_tr_b16 a[110:111], v11 offset:30720
  ds_read_b64_tr_b16 a[112:113], v12 offset:24576
  ds_read_b64_tr_b16 a[114:115], v12 offset:26624
  ds_read_b64_tr_b16 a[116:117], v12 offset:28672
  ds_read_b64_tr_b16 a[118:119], v12 offset:30720
  ds_read_b64_tr_b16 a[120:121], v13 offset:24576
  ds_read_b64_tr_b16 a[122:123], v13 offset:26624
  ds_read_b64_tr_b16 a[124:125], v13 offset:28672
  ds_read_b64_tr_b16 a[126:127], v13 offset:30720
  s_waitcnt vmcnt(16) lgkmcnt(0)
  s_barrier
  s_add_u32 m0, s41, 24576
  s_add_u32 s42, s53, 4980736
  buffer_load_dwordx4 v9, s[8:11], s42 offen lds
  s_add_u32 m0, s41, 25600
  s_add_u32 s42, s53, 4997120
  buffer_load_dwordx4 v9, s[8:11], s42 offen lds
  s_add_u32 m0, s41, 26624
  s_add_u32 s42, s53, 4984832
  buffer_load_dwordx4 v9, s[8:11], s42 offen lds
  s_add_u32 m0, s41, 27648
  s_add_u32 s42, s53, 5001216
  buffer_load_dwordx4 v9, s[8:11], s42 offen lds
  s_add_u32 m0, s41, 28672
  s_add_u32 s42, s53, 5013504
  buffer_load_dwordx4 v9, s[8:11], s42 offen lds
  s_add_u32 m0, s41, 29696
  s_add_u32 s42, s53, 5029888
  buffer_load_dwordx4 v9, s[8:11], s42 offen lds
  s_add_u32 m0, s41, 30720
  s_add_u32 s42, s53, 5017600
  buffer_load_dwordx4 v9, s[8:11], s42 offen lds
  s_add_u32 m0, s41, 31744
  s_add_u32 s42, s53, 5033984
  buffer_load_dwordx4 v9, s[8:11], s42 offen lds
  ds_read_b64_tr_b16 a[128:129], v10 offset:0
  ds_read_b64_tr_b16 a[130:131], v10 offset:2048
  ds_read_b64_tr_b16 a[132:133], v10 offset:4096
  ds_read_b64_tr_b16 a[134:135], v10 offset:6144
  ds_read_b64_tr_b16 a[136:137], v11 offset:0
  ds_read_b64_tr_b16 a[138:139], v11 offset:2048
  ds_read_b64_tr_b16 a[140:141], v11 offset:4096
  ds_read_b64_tr_b16 a[142:143], v11 offset:6144
  ds_read_b64_tr_b16 a[144:145], v12 offset:0
  ds_read_b64_tr_b16 a[146:147], v12 offset:2048
  ds_read_b64_tr_b16 a[148:149], v12 offset:4096
  ds_read_b64_tr_b16 a[150:151], v12 offset:6144
  ds_read_b64_tr_b16 a[152:153], v13 offset:0
  ds_read_b64_tr_b16 a[154:155], v13 offset:2048
  ds_read_b64_tr_b16 a[156:157], v13 offset:4096
  ds_read_b64_tr_b16 a[158:159], v13 offset:6144
  s_waitcnt vmcnt(16) lgkmcnt(0)
  s_barrier
  s_load_dwordx2 s[8:9], s[0:1], 32
  s_mov_b32 s10, 8388608
  s_mov_b32 s11, 0x20000
  s_waitcnt lgkmcnt(0)
  s_add_u32 m0, s41, 0
  s_add_u32 s42, s52, 0
  buffer_load_dwordx4 v14, s[8:11], s42 offen lds
  s_add_u32 m0, s41, 1024
  s_add_u32 s42, s52, 65536
  buffer_load_dwordx4 v14, s[8:11], s42 offen lds
  s_add_u32 m0, s41, 2048
  s_add_u32 s42, s52, 8192
  buffer_load_dwordx4 v14, s[8:11], s42 offen lds
  s_add_u32 m0, s41, 3072
  s_add_u32 s42, s52, 73728
  buffer_load_dwordx4 v14, s[8:11], s42 offen lds
  s_add_u32 m0, s41, 4096
  s_add_u32 s42, s52, 262144
  buffer_load_dwordx4 v14, s[8:11], s42 offen lds
  s_add_u32 m0, s41, 5120
  s_add_u32 s42, s52, 327680
  buffer_load_dwordx4 v14, s[8:11], s42 offen lds
  s_add_u32 m0, s41, 6144
  s_add_u32 s42, s52, 270336
  buffer_load_dwordx4 v14, s[8:11], s42 offen lds
  s_add_u32 m0, s41, 7168
  s_add_u32 s42, s52, 335872
  buffer_load_dwordx4 v14, s[8:11], s42 offen lds
  ds_read_b64_tr_b16 a[160:161], v10 offset:8192
  ds_read_b64_tr_b16 a[162:163], v10 offset:10240
  ds_read_b64_tr_b16 a[164:165], v10 offset:12288
  ds_read_b64_tr_b16 a[166:167], v10 offset:14336
  ds_read_b64_tr_b16 a[168:169], v11 offset:8192
  ds_read_b64_tr_b16 a[170:171], v11 offset:10240
  ds_read_b64_tr_b16 a[172:173], v11 offset:12288
  ds_read_b64_tr_b16 a[174:175], v11 offset:14336
  ds_read_b64_tr_b16 a[176:177], v12 offset:8192
  ds_read_b64_tr_b16 a[178:179], v12 offset:10240
  ds_read_b64_tr_b16 a[180:181], v12 offset:12288
  ds_read_b64_tr_b16 a[182:183], v12 offset:14336
  ds_read_b64_tr_b16 a[184:185], v13 offset:8192
  ds_read_b64_tr_b16 a[186:187], v13 offset:10240
  ds_read_b64_tr_b16 a[188:189], v13 offset:12288
  ds_read_b64_tr_b16 a[190:191], v13 offset:14336
  s_waitcnt vmcnt(16) lgkmcnt(0)
  s_barrier
  s_add_u32 m0, s41, 8192
  s_add_u32 s42, s52, 2097152
  buffer_load_dwordx4 v14, s[8:11], s42 offen lds
  s_add_u32 m0, s41, 9216
  s_add_u32 s42, s52, 2162688
  buffer_load_dwordx4 v14, s[8:11], s42 offen lds
  s_add_u32 m0, s41, 10240
  s_add_u32 s42, s52, 2105344
  buffer_load_dwordx4 v14, s[8:11], s42 offen lds
  s_add_u32 m0, s41, 11264
  s_add_u32 s42, s52, 2170880
  buffer_load_dwordx4 v14, s[8:11], s42 offen lds
  s_add_u32 m0, s41, 12288
  s_add_u32 s42, s52, 2359296
  buffer_load_dwordx4 v14, s[8:11], s42 offen lds
  s_add_u32 m0, s41, 13312
  s_add_u32 s42, s52, 2424832
  buffer_load_dwordx4 v14, s[8:11], s42 offen lds
  s_add_u32 m0, s41, 14336
  s_add_u32 s42, s52, 2367488
  buffer_load_dwordx4 v14, s[8:11], s42 offen lds
  s_add_u32 m0, s41, 15360
  s_add_u32 s42, s52, 2433024
  buffer_load_dwordx4 v14, s[8:11], s42 offen lds
  ds_read_b64_tr_b16 a[192:193], v10 offset:16384
  ds_read_b64_tr_b16 a[194:195], v10 offset:18432
  ds_read_b64_tr_b16 a[196:197], v10 offset:20480
  ds_read_b64_tr_b16 a[198:199], v10 offset:22528
  ds_read_b64_tr_b16 a[200:201], v11 offset:16384
  ds_read_b64_tr_b16 a[202:203], v11 offset:18432
  ds_read_b64_tr_b16 a[204:205], v11 offset:20480
  ds_read_b64_tr_b16 a[206:207], v11 offset:22528
  ds_read_b64_tr_b16 a[208:209], v12 offset:16384
  ds_read_b64_tr_b16 a[210:211], v12 offset:18432
  ds_read_b64_tr_b16 a[212:213], v12 offset:20480
  ds_read_b64_tr_b16 a[214:215], v12 offset:22528
  ds_read_b64_tr_b16 a[216:217], v13 offset:16384
  ds_read_b64_tr_b16 a[218:219], v13 offset:18432
  ds_read_b64_tr_b16 a[220:221], v13 offset:20480
  ds_read_b64_tr_b16 a[222:223], v13 offset:22528
  s_waitcnt vmcnt(16) lgkmcnt(0)
  s_barrier
  s_add_u32 m0, s41, 16384
  s_add_u32 s42, s53, 4194304
  buffer_load_dwordx4 v14, s[8:11], s42 offen lds
  s_add_u32 m0, s41, 17408
  s_add_u32 s42, s53, 4259840
  buffer_load_dwordx4 v14, s[8:11], s42 offen lds
  s_add_u32 m0, s41, 18432
  s_add_u32 s42, s53, 4202496
  buffer_load_dwordx4 v14, s[8:11], s42 offen lds
  s_add_u32 m0, s41, 19456
  s_add_u32 s42, s53, 4268032
  buffer_load_dwordx4 v14, s[8:11], s42 offen lds
  s_add_u32 m0, s41, 20480
  s_add_u32 s42, s53, 4456448
  buffer_load_dwordx4 v14, s[8:11], s42 offen lds
  s_add_u32 m0, s41, 21504
  s_add_u32 s42, s53, 4521984
  buffer_load_dwordx4 v14, s[8:11], s42 offen lds
  s_add_u32 m0, s41, 22528
  s_add_u32 s42, s53, 4464640
  buffer_load_dwordx4 v14, s[8:11], s42 offen lds
  s_add_u32 m0, s41, 23552
  s_add_u32 s42, s53, 4530176
  buffer_load_dwordx4 v14, s[8:11], s42 offen lds
  ds_read_b64_tr_b16 a[224:225], v10 offset:24576
  ds_read_b64_tr_b16 a[226:227], v10 offset:26624
  ds_read_b64_tr_b16 a[228:229], v10 offset:28672
  ds_read_b64_tr_b16 a[230:231], v10 offset:30720
  ds_read_b64_tr_b16 a[232:233], v11 offset:24576
  ds_read_b64_tr_b16 a[234:235], v11 offset:26624
  ds_read_b64_tr_b16 a[236:237], v11 offset:28672
  ds_read_b64_tr_b16 a[238:239], v11 offset:30720
  ds_read_b64_tr_b16 a[240:241], v12 offset:24576
  ds_read_b64_tr_b16 a[242:243], v12 offset:26624
  ds_read_b64_tr_b16 a[244:245], v12 offset:28672
  ds_read_b64_tr_b16 a[246:247], v12 offset:30720
  ds_read_b64_tr_b16 a[248:249], v13 offset:24576
  ds_read_b64_tr_b16 a[250:251], v13 offset:26624
  ds_read_b64_tr_b16 a[252:253], v13 offset:28672
  ds_read_b64_tr_b16 a[254:255], v13 offset:30720
  s_waitcnt vmcnt(16) lgkmcnt(0)
  s_barrier
  s_add_u32 m0, s41, 24576
  s_add_u32 s42, s53, 6291456
  buffer_load_dwordx4 v14, s[8:11], s42 offen lds
  s_add_u32 m0, s41, 25600
  s_add_u32 s42, s53, 6356992
  buffer_load_dwordx4 v14, s[8:11], s42 offen lds
  s_add_u32 m0, s41, 26624
  s_add_u32 s42, s53, 6299648
  buffer_load_dwordx4 v14, s[8:11], s42 offen lds
  s_add_u32 m0, s41, 27648
  s_add_u32 s42, s53, 6365184
  buffer_load_dwordx4 v14, s[8:11], s42 offen lds
  s_add_u32 m0, s41, 28672
  s_add_u32 s42, s53, 6553600
  buffer_load_dwordx4 v14, s[8:11], s42 offen lds
  s_add_u32 m0, s41, 29696
  s_add_u32 s42, s53, 6619136
  buffer_load_dwordx4 v14, s[8:11], s42 offen lds
  s_add_u32 m0, s41, 30720
  s_add_u32 s42, s53, 6561792
  buffer_load_dwordx4 v14, s[8:11], s42 offen lds
  s_add_u32 m0, s41, 31744
  s_add_u32 s42, s53, 6627328
  buffer_load_dwordx4 v14, s[8:11], s42 offen lds
  ds_read_b64_tr_b16 v[128:129], v4 offset:0
  ds_read_b64_tr_b16 v[130:131], v4 offset:2048
  ds_read_b64_tr_b16 v[132:133], v4 offset:4096
  ds_read_b64_tr_b16 v[134:135], v4 offset:6144
  ds_read_b64_tr_b16 v[144:145], v5 offset:0
  ds_read_b64_tr_b16 v[146:147], v5 offset:2048
  ds_read_b64_tr_b16 v[148:149], v5 offset:4096
  ds_read_b64_tr_b16 v[150:151], v5 offset:6144
  ds_read_b64_tr_b16 v[160:161], v6 offset:0
  ds_read_b64_tr_b16 v[162:163], v6 offset:2048
  ds_read_b64_tr_b16 v[164:165], v6 offset:4096
  ds_read_b64_tr_b16 v[166:167], v6 offset:6144
  ds_read_b64_tr_b16 v[176:177], v7 offset:0
  ds_read_b64_tr_b16 v[178:179], v7 offset:2048
  ds_read_b64_tr_b16 v[180:181], v7 offset:4096
  ds_read_b64_tr_b16 v[182:183], v7 offset:6144
  s_waitcnt vmcnt(16) lgkmcnt(0)
  s_barrier
  s_add_u32 m0, s41, 0
  s_add_u32 s42, s52, 0
  buffer_load_dwordx4 v15, s[8:11], s42 offen lds
  s_add_u32 m0, s41, 1024
  s_add_u32 s42, s52, 65536
  buffer_load_dwordx4 v15, s[8:11], s42 offen lds
  s_add_u32 m0, s41, 2048
  s_add_u32 s42, s52, 8192
  buffer_load_dwordx4 v15, s[8:11], s42 offen lds
  s_add_u32 m0, s41, 3072
  s_add_u32 s42, s52, 73728
  buffer_load_dwordx4 v15, s[8:11], s42 offen lds
  s_add_u32 m0, s41, 4096
  s_add_u32 s42, s52, 262144
  buffer_load_dwordx4 v15, s[8:11], s42 offen lds
  s_add_u32 m0, s41, 5120
  s_add_u32 s42, s52, 327680
  buffer_load_dwordx4 v15, s[8:11], s42 offen lds
  s_add_u32 m0, s41, 6144
  s_add_u32 s42, s52, 270336
  buffer_load_dwordx4 v15, s[8:11], s42 offen lds
  s_add_u32 m0, s41, 7168
  s_add_u32 s42, s52, 335872
  buffer_load_dwordx4 v15, s[8:11], s42 offen lds
  ds_read_b64_tr_b16 v[136:137], v4 offset:8192
  ds_read_b64_tr_b16 v[138:139], v4 offset:10240
  ds_read_b64_tr_b16 v[140:141], v4 offset:12288
  ds_read_b64_tr_b16 v[142:143], v4 offset:14336
  ds_read_b64_tr_b16 v[152:153], v5 offset:8192
  ds_read_b64_tr_b16 v[154:155], v5 offset:10240
  ds_read_b64_tr_b16 v[156:157], v5 offset:12288
  ds_read_b64_tr_b16 v[158:159], v5 offset:14336
  ds_read_b64_tr_b16 v[168:169], v6 offset:8192
  ds_read_b64_tr_b16 v[170:171], v6 offset:10240
  ds_read_b64_tr_b16 v[172:173], v6 offset:12288
  ds_read_b64_tr_b16 v[174:175], v6 offset:14336
  ds_read_b64_tr_b16 v[184:185], v7 offset:8192
  ds_read_b64_tr_b16 v[186:187], v7 offset:10240
  ds_read_b64_tr_b16 v[188:189], v7 offset:12288
  ds_read_b64_tr_b16 v[190:191], v7 offset:14336
  s_waitcnt vmcnt(16) lgkmcnt(0)
  s_barrier
  s_add_u32 m0, s41, 8192
  s_add_u32 s42, s52, 2097152
  buffer_load_dwordx4 v15, s[8:11], s42 offen lds
  s_add_u32 m0, s41, 9216
  s_add_u32 s42, s52, 2162688
  buffer_load_dwordx4 v15, s[8:11], s42 offen lds
  s_add_u32 m0, s41, 10240
  s_add_u32 s42, s52, 2105344
  buffer_load_dwordx4 v15, s[8:11], s42 offen lds
  s_add_u32 m0, s41, 11264
  s_add_u32 s42, s52, 2170880
  buffer_load_dwordx4 v15, s[8:11], s42 offen lds
  s_add_u32 m0, s41, 12288
  s_add_u32 s42, s52, 2359296
  buffer_load_dwordx4 v15, s[8:11], s42 offen lds
  s_add_u32 m0, s41, 13312
  s_add_u32 s42, s52, 2424832
  buffer_load_dwordx4 v15, s[8:11], s42 offen lds
  s_add_u32 m0, s41, 14336
  s_add_u32 s42, s52, 2367488
  buffer_load_dwordx4 v15, s[8:11], s42 offen lds
  s_add_u32 m0, s41, 15360
  s_add_u32 s42, s52, 2433024
  buffer_load_dwordx4 v15, s[8:11], s42 offen lds
  ds_read_b64_tr_b16 v[192:193], v4 offset:16384
  ds_read_b64_tr_b16 v[194:195], v4 offset:18432
  ds_read_b64_tr_b16 v[196:197], v4 offset:20480
  ds_read_b64_tr_b16 v[198:199], v4 offset:22528
  ds_read_b64_tr_b16 v[208:209], v5 offset:16384
  ds_read_b64_tr_b16 v[210:211], v5 offset:18432
  ds_read_b64_tr_b16 v[212:213], v5 offset:20480
  ds_read_b64_tr_b16 v[214:215], v5 offset:22528
  ds_read_b64_tr_b16 v[224:225], v6 offset:16384
  ds_read_b64_tr_b16 v[226:227], v6 offset:18432
  ds_read_b64_tr_b16 v[228:229], v6 offset:20480
  ds_read_b64_tr_b16 v[230:231], v6 offset:22528
  ds_read_b64_tr_b16 v[240:241], v7 offset:16384
  ds_read_b64_tr_b16 v[242:243], v7 offset:18432
  ds_read_b64_tr_b16 v[244:245], v7 offset:20480
  ds_read_b64_tr_b16 v[246:247], v7 offset:22528
  s_waitcnt vmcnt(16) lgkmcnt(0)
  s_barrier
  s_add_u32 m0, s41, 16384
  s_add_u32 s42, s53, 4194304
  buffer_load_dwordx4 v15, s[8:11], s42 offen lds
  s_add_u32 m0, s41, 17408
  s_add_u32 s42, s53, 4259840
  buffer_load_dwordx4 v15, s[8:11], s42 offen lds
  s_add_u32 m0, s41, 18432
  s_add_u32 s42, s53, 4202496
  buffer_load_dwordx4 v15, s[8:11], s42 offen lds
  s_add_u32 m0, s41, 19456
  s_add_u32 s42, s53, 4268032
  buffer_load_dwordx4 v15, s[8:11], s42 offen lds
  s_add_u32 m0, s41, 20480
  s_add_u32 s42, s53, 4456448
  buffer_load_dwordx4 v15, s[8:11], s42 offen lds
  s_add_u32 m0, s41, 21504
  s_add_u32 s42, s53, 4521984
  buffer_load_dwordx4 v15, s[8:11], s42 offen lds
  s_add_u32 m0, s41, 22528
  s_add_u32 s42, s53, 4464640
  buffer_load_dwordx4 v15, s[8:11], s42 offen lds
  s_add_u32 m0, s41, 23552
  s_add_u32 s42, s53, 4530176
  buffer_load_dwordx4 v15, s[8:11], s42 offen lds
  ds_read_b64_tr_b16 v[200:201], v4 offset:24576
  ds_read_b64_tr_b16 v[202:203], v4 offset:26624
  ds_read_b64_tr_b16 v[204:205], v4 offset:28672
  ds_read_b64_tr_b16 v[206:207], v4 offset:30720
  ds_read_b64_tr_b16 v[216:217], v5 offset:24576
  ds_read_b64_tr_b16 v[218:219], v5 offset:26624
  ds_read_b64_tr_b16 v[220:221], v5 offset:28672
  ds_read_b64_tr_b16 v[222:223], v5 offset:30720
  ds_read_b64_tr_b16 v[232:233], v6 offset:24576
  ds_read_b64_tr_b16 v[234:235], v6 offset:26624
  ds_read_b64_tr_b16 v[236:237], v6 offset:28672
  ds_read_b64_tr_b16 v[238:239], v6 offset:30720
  ds_read_b64_tr_b16 v[248:249], v7 offset:24576
  ds_read_b64_tr_b16 v[250:251], v7 offset:26624
  ds_read_b64_tr_b16 v[252:253], v7 offset:28672
  ds_read_b64_tr_b16 v[254:255], v7 offset:30720
  s_waitcnt vmcnt(16) lgkmcnt(0)
  s_barrier
  s_add_u32 m0, s41, 24576
  s_add_u32 s42, s53, 6291456
  buffer_load_dwordx4 v15, s[8:11], s42 offen lds
  s_add_u32 m0, s41, 25600
  s_add_u32 s42, s53, 6356992
  buffer_load_dwordx4 v15, s[8:11], s42 offen lds
  s_add_u32 m0, s41, 26624
  s_add_u32 s42, s53, 6299648
  buffer_load_dwordx4 v15, s[8:11], s42 offen lds
  s_add_u32 m0, s41, 27648
  s_add_u32 s42, s53, 6365184
  buffer_load_dwordx4 v15, s[8:11], s42 offen lds
  s_add_u32 m0, s41, 28672
  s_add_u32 s42, s53, 6553600
  buffer_load_dwordx4 v15, s[8:11], s42 offen lds
  s_add_u32 m0, s41, 29696
  s_add_u32 s42, s53, 6619136
  buffer_load_dwordx4 v15, s[8:11], s42 offen lds
  s_add_u32 m0, s41, 30720
  s_add_u32 s42, s53, 6561792
  buffer_load_dwordx4 v15, s[8:11], s42 offen lds
  s_add_u32 m0, s41, 31744
  s_add_u32 s42, s53, 6627328
  buffer_load_dwordx4 v15, s[8:11], s42 offen lds
  ds_read_b64_tr_b16 v[20:21], v4 offset:0
  ds_read_b64_tr_b16 v[22:23], v4 offset:2048
  ds_read_b64_tr_b16 v[24:25], v4 offset:4096
  ds_read_b64_tr_b16 v[26:27], v4 offset:6144
  ds_read_b64_tr_b16 v[28:29], v5 offset:0
  ds_read_b64_tr_b16 v[30:31], v5 offset:2048
  ds_read_b64_tr_b16 v[32:33], v5 offset:4096
  ds_read_b64_tr_b16 v[34:35], v5 offset:6144
  ds_read_b64_tr_b16 v[36:37], v6 offset:0
  ds_read_b64_tr_b16 v[38:39], v6 offset:2048
  ds_read_b64_tr_b16 v[40:41], v6 offset:4096
  ds_read_b64_tr_b16 v[42:43], v6 offset:6144
  ds_read_b64_tr_b16 v[44:45], v7 offset:0
  ds_read_b64_tr_b16 v[46:47], v7 offset:2048
  ds_read_b64_tr_b16 v[48:49], v7 offset:4096
  ds_read_b64_tr_b16 v[50:51], v7 offset:6144
  s_waitcnt lgkmcnt(0)
  s_barrier
  ds_write_b128 v85, v[20:23] offset:0
  ds_write_b128 v85, v[24:27] offset:1024
  ds_write_b128 v85, v[28:31] offset:2048
  ds_write_b128 v85, v[32:35] offset:3072
  ds_write_b128 v85, v[36:39] offset:4096
  ds_write_b128 v85, v[40:43] offset:5120
  ds_write_b128 v85, v[44:47] offset:6144
  ds_write_b128 v85, v[48:51] offset:7168
  s_waitcnt vmcnt(16) lgkmcnt(0)
  s_barrier
  ds_read_b64_tr_b16 v[20:21], v4 offset:8192
  ds_read_b64_tr_b16 v[22:23], v4 offset:10240
  ds_read_b64_tr_b16 v[24:25], v4 offset:12288
  ds_read_b64_tr_b16 v[26:27], v4 offset:14336
  ds_read_b64_tr_b16 v[28:29], v5 offset:8192
  ds_read_b64_tr_b16 v[30:31], v5 offset:10240
  ds_read_b64_tr_b16 v[32:33], v5 offset:12288
  ds_read_b64_tr_b16 v[34:35], v5 offset:14336
  ds_read_b64_tr_b16 v[36:37], v6 offset:8192
  ds_read_b64_tr_b16 v[38:39], v6 offset:10240
  ds_read_b64_tr_b16 v[40:41], v6 offset:12288
  ds_read_b64_tr_b16 v[42:43], v6 offset:14336
  ds_read_b64_tr_b16 v[44:45], v7 offset:8192
  ds_read_b64_tr_b16 v[46:47], v7 offset:10240
  ds_read_b64_tr_b16 v[48:49], v7 offset:12288
  ds_read_b64_tr_b16 v[50:51], v7 offset:14336
  s_waitcnt lgkmcnt(0)
  s_barrier
  ds_write_b128 v85, v[20:23] offset:8192
  ds_write_b128 v85, v[24:27] offset:9216
  ds_write_b128 v85, v[28:31] offset:10240
  ds_write_b128 v85, v[32:35] offset:11264
  ds_write_b128 v85, v[36:39] offset:12288
  ds_write_b128 v85, v[40:43] offset:13312
  ds_write_b128 v85, v[44:47] offset:14336
  ds_write_b128 v85, v[48:51] offset:15360
  s_waitcnt vmcnt(8) lgkmcnt(0)
  s_barrier
  ds_read_b64_tr_b16 v[20:21], v4 offset:16384
  ds_read_b64_tr_b16 v[22:23], v4 offset:18432
  ds_read_b64_tr_b16 v[24:25], v4 offset:20480
  ds_read_b64_tr_b16 v[26:27], v4 offset:22528
  ds_read_b64_tr_b16 v[28:29], v5 offset:16384
  ds_read_b64_tr_b16 v[30:31], v5 offset:18432
  ds_read_b64_tr_b16 v[32:33], v5 offset:20480
  ds_read_b64_tr_b16 v[34:35], v5 offset:22528
  ds_read_b64_tr_b16 v[36:37], v6 offset:16384
  ds_read_b64_tr_b16 v[38:39], v6 offset:18432
  ds_read_b64_tr_b16 v[40:41], v6 offset:20480
  ds_read_b64_tr_b16 v[42:43], v6 offset:22528
  ds_read_b64_tr_b16 v[44:45], v7 offset:16384
  ds_read_b64_tr_b16 v[46:47], v7 offset:18432
  ds_read_b64_tr_b16 v[48:49], v7 offset:20480
  ds_read_b64_tr_b16 v[50:51], v7 offset:22528
  s_waitcnt lgkmcnt(0)
  s_barrier
  ds_write_b128 v85, v[20:23] offset:16384
  ds_write_b128 v85, v[24:27] offset:17408
  ds_write_b128 v85, v[28:31] offset:18432
  ds_write_b128 v85, v[32:35] offset:19456
  ds_write_b128 v85, v[36:39] offset:20480
  ds_write_b128 v85, v[40:43] offset:21504
  ds_write_b128 v85, v[44:47] offset:22528
  ds_write_b128 v85, v[48:51] offset:23552
  s_waitcnt vmcnt(0) lgkmcnt(0)
  s_barrier
  ds_read_b64_tr_b16 v[20:21], v4 offset:24576
  ds_read_b64_tr_b16 v[22:23], v4 offset:26624
  ds_read_b64_tr_b16 v[24:25], v4 offset:28672
  ds_read_b64_tr_b16 v[26:27], v4 offset:30720
  ds_read_b64_tr_b16 v[28:29], v5 offset:24576
  ds_read_b64_tr_b16 v[30:31], v5 offset:26624
  ds_read_b64_tr_b16 v[32:33], v5 offset:28672
  ds_read_b64_tr_b16 v[34:35], v5 offset:30720
  ds_read_b64_tr_b16 v[36:37], v6 offset:24576
  ds_read_b64_tr_b16 v[38:39], v6 offset:26624
  ds_read_b64_tr_b16 v[40:41], v6 offset:28672
  ds_read_b64_tr_b16 v[42:43], v6 offset:30720
  ds_read_b64_tr_b16 v[44:45], v7 offset:24576
  ds_read_b64_tr_b16 v[46:47], v7 offset:26624
  ds_read_b64_tr_b16 v[48:49], v7 offset:28672
  ds_read_b64_tr_b16 v[50:51], v7 offset:30720
  s_waitcnt lgkmcnt(0)
  s_barrier
  ds_write_b128 v85, v[20:23] offset:24576
  ds_write_b128 v85, v[24:27] offset:25600
  ds_write_b128 v85, v[28:31] offset:26624
  ds_write_b128 v85, v[32:35] offset:27648
  ds_write_b128 v85, v[36:39] offset:28672
  ds_write_b128 v85, v[40:43] offset:29696
  ds_write_b128 v85, v[44:47] offset:30720
  ds_write_b128 v85, v[48:51] offset:31744
  s_waitcnt lgkmcnt(0)
  v_min_u32 v76, 31, v0
  v_lshlrev_b32 v76, 2, v76
  v_add_u32 v76, 128, v76
  s_nop 1
Lpoll_49:
  buffer_load_dword v77, v76, s[12:15], 0 offen sc1
  s_sub_u32 s24, s24, 1
  s_cbranch_scc1 L_FAIL
  s_waitcnt vmcnt(0)
  v_cmp_gt_i32 vcc, 1, v77
  s_cbranch_vccz Lpolld_50
  s_sleep 2
  s_branch Lpoll_49
Lpolld_50:
  s_mov_b32 s46, 0xffff
  s_getreg_b32 s55, hwreg(HW_REG_XCC_ID)
  s_and_b32 s55, s55, 15
  s_min_u32 s46, s46, 0xffff
  s_lshl_b32 s46, s46, 8
  s_or_b32 s46, s46, s55
  s_add_u32 s40, s21, 32
  s_lshl_b32 s40, s40, 7
  s_add_u32 s40, s40, 1424384
  s_cmp_eq_u32 s20, 0
  s_cselect_b32 s40, s40, 2147483392
  v_mov_b32 v76, 2147483392
  s_mov_b64 exec, 1
  v_mov_b32 v76, s40
  s_mov_b64 exec, -1
  v_mov_b32 v77, s46
  buffer_store_dword v77, v76, s[4:7], 0 offen sc1
  v_min_u32 v76, 63, v0
  v_lshlrev_b32 v76, 7, v76
  v_add_u32 v76, 1424384, v76
  s_nop 1
Lpoll_51:
  buffer_load_dword v77, v76, s[4:7], 0 offen sc1
  s_sub_u32 s24, s24, 1
  s_cbranch_scc1 L_FAIL
  s_waitcnt vmcnt(0)
  v_cmp_gt_i32 vcc, 0, v77
  s_cbranch_vccz Lpolld_52
  s_sleep 4
  s_branch Lpoll_51
Lpolld_52:
  v_and_b32 v78, 15, v77
  v_cmp_ne_u32 vcc, s55, v78
  s_lshl_b32 s40, s54, 4
  s_lshl_b32 s40, 0xffff, s40
  s_or_b32 s41, vcc_lo, vcc_hi
  s_and_b32 s40, s40, s41
  s_cselect_b32 s36, 0, 8192
  v_lshrrev_b32 v77, 8, v77
  v_and_b32 v78, 3, v0
  v_lshl_or_b32 v77, v77, 2, v78
  s_nop 1
  v_min_u32_dpp v77, v77, v77 row_ror:8 row_mask:0xf bank_mask:0xf
  s_nop 1
  v_min_u32_dpp v77, v77, v77 row_ror:4 row_mask:0xf bank_mask:0xf
  v_mov_b32 v78, v77
  s_nop 1
  v_permlane16_swap_b32 v78, v77
  v_min_u32 v77, v77, v78
  s_nop 1
  v_min_u32_dpp v77, v77, v77 row_ror:2 row_mask:0xf bank_mask:0xf
  s_nop 1
  v_min_u32_dpp v77, v77, v77 row_ror:1 row_mask:0xf bank_mask:0xf
  s_nop 0
  v_readfirstlane_b32 s26, v77
  s_and_b32 s26, s26, 3
  s_lshl_b32 s26, s26, 13
  s_lshr_b32 s40, s20, 1
  s_mul_i32 s40, s40, 32768
  s_and_b32 s41, s20, 1
  s_lshl_b32 s41, s41, 12
  s_add_u32 s40, s40, s41
  s_lshl_b32 s41, s54, 11
  s_add_u32 s40, s40, s41
  v_lshl_add_u32 v86, v0, 4, s40
  v_xor_b32 v87, 0x800, v86
  v_and_b32 v76, 2, v0
  v_cmp_eq_u32 vcc, 0, v76
  v_mov_b32 v76, 0xeeee
  v_mov_b32 v77, 0x4444
  v_cndmask_b32 v88, v76, v77, vcc
  s_lshr_b32 s40, s21, 2
  s_mul_i32 s40, s40, 32768
  s_and_b32 s41, s21, 3
  s_lshl_b32 s41, s41, 11
  s_add_u32 s47, s40, s41
  s_lshl_b32 s41, s20, 9
  s_add_u32 s47, s47, s41
  v_lshl_add_u32 v92, v0, 3, s47
  s_lshl_b32 s41, s54, 12
  s_add_u32 s40, s41, 1310720
  s_add_u32 s40, s40, s26
  v_lshrrev_b32 v76, 2, v0
  v_lshl_add_u32 v76, v76, 7, s40
  v_and_b32 v77, 3, v0
  v_lshl_add_u32 v90, v77, 2, v76
  s_mov_b32 s57, s40
  s_cmp_eq_u32 s36, 0
  s_cselect_b32 s56, 1, s20
  s_and_b32 s41, s21, 15
  s_lshl_b32 s41, s41, 7
  s_lshl_b32 s40, s20, 2
  s_add_u32 s40, s40, s41
  s_add_u32 s40, s40, 0
  s_mov_b32 s25, 0
  s_mov_b32 s60, 0
  s_mov_b32 s61, 0
  v_mov_b32 v91, 2147483392
  s_mov_b64 exec, 1
  v_mov_b32 v91, s40
  s_mov_b64 exec, -1
  v_mov_b32 v80, -1
  v_mov_b32 v81, -1
  v_mov_b32 v82, -1
  v_mov_b32 v83, -1
  s_load_dwordx2 s[16:17], s[0:1], 8
  s_mov_b32 s18, 16384
  s_mov_b32 s19, 0x20000
  s_waitcnt lgkmcnt(0)
  s_mul_i32 s40, s20, 32768
  v_lshl_add_u32 v95, v0, 4, s40
  s_mul_i32 s58, s54, 131072
  s_lshl_b32 s40, s20, 10
  s_add_u32 s40, s40, 147456
  v_lshl_add_u32 v116, v0, 4, s40
  s_and_b32 s40, s20, 1
  s_lshl_b32 s40, s40, 3
  v_bfe_u32 v4, v0, 2, 3
  v_add_u32 v4, s40, v4
  s_lshr_b32 s40, s20, 1
  s_lshl_b32 s40, s40, 3
  v_and_b32 v5, 3, v0
  v_add_u32 v5, s40, v5
  v_bfe_u32 v76, v4, 1, 1
  v_lshl_add_u32 v5, v76, 2, v5
  v_lshrrev_b32 v76, 2, v4
  v_and_b32 v77, 1, v4
  v_lshl_add_u32 v78, v76, 4, v5
  v_lshlrev_b32 v78, 4, v78
  v_lshl_add_u32 v78, v77, 3, v78
  v_add_u32 v117, 147456, v78
  v_lshl_add_u32 v76, v76, 1, v77
  s_lshl_b32 s40, s21, 6
  v_lshl_add_u32 v76, v76, 11, s40
  v_lshl_add_u32 v76, v5, 1, v76
  buffer_load_ushort v77, v76, s[16:19], 0 offen
  buffer_load_ushort v78, v76, s[16:19], 0 offen offset:32
  s_lshr_b32 s40, s21, 1
  s_and_b32 s41, s40, 3
  s_lshl_b32 s41, s41, 2
  s_lshr_b32 s40, s40, 2
  s_add_u32 s40, s40, s41
  s_lshr_b32 s41, s40, 3
  s_mul_i32 s41, s41, 32768
  s_and_b32 s40, s40, 7
  s_lshl_b32 s40, s40, 10
  s_add_u32 s40, s40, s41
  s_and_b32 s41, s21, 1
  s_lshl_b32 s41, s41, 9
  s_add_u32 s40, s40, s41
  s_lshl_b32 s41, s20, 7
  s_add_u32 s40, s40, s41
  v_lshl_add_u32 v118, v0, 2, s40
  s_mov_b32 exec_lo, 0
  v_mov_b32 v118, 2147483392
  s_mov_b64 exec, -1
  s_add_u32 s41, s26, 1048576
  v_mov_b32 v94, 0
  s_waitcnt vmcnt(0)
  v_lshl_or_b32 v77, v78, 16, v77
  v_min_u32 v77, -2, v77
  buffer_store_dword v77, v118, s[4:7], s41 offen sc1
  s_xor_b32 s40, s41, 8192
  buffer_store_dword v77, v118, s[4:7], s40 offen
  buffer_store_dword v94, v91, s[4:7], s57 offen
  v_mov_b64 v[52:53], 0
  v_mov_b64 v[54:55], 0
  v_mov_b64 v[56:57], 0
  v_mov_b64 v[58:59], 0
  ds_read_b128 v[20:23], v85 offset:0
  ds_read_b128 v[24:27], v85 offset:1024
  ds_read_b128 v[28:31], v85 offset:8192
  ds_read_b128 v[32:35], v85 offset:9216
  ds_read_b128 v[36:39], v85 offset:2048
  ds_read_b128 v[40:43], v85 offset:3072
  ds_read_b128 v[44:47], v85 offset:10240
  ds_read_b128 v[48:51], v85 offset:11264
L_VO_top:
  s_and_b32 s40, s25, 3
  s_lshl_b32 s40, s40, 16
  s_add_u32 s27, s40, s26
  s_add_u32 s27, s27, 1048576
  s_xor_b32 s37, s27, s36
  s_lshl_b32 s40, s40, 2
  s_add_u32 s28, s40, s26
  s_lshr_b32 s40, s40, 5
  s_and_b32 s40, s40, 0x4000
  s_xor_b32 s28, s28, s40
  s_xor_b32 s29, s28, 0x4000
  s_sleep 2
L_VO_retry:
  buffer_load_dwordx4 v[4:7], v86, s[4:7], s37 offen offset:0 sc1
  s_nop 0
  buffer_load_dwordx4 v[8:11], v86, s[4:7], s37 offen offset:1024 sc1
  s_nop 0
  s_waitcnt vmcnt(1) lgkmcnt(0)
  v_smfmac_f32_16x16x64_bf16 v[52:55], v[4:7], v[128:135], v88
  ds_write_b128 v1, v[4:7] offset:0
  v_max3_u32 v89, v4, v5, v6
  v_smfmac_f32_16x16x64_bf16 v[56:59], v[4:7], v[20:27], v88
  v_max3_u32 v89, v6, v7, v89
  s_waitcnt vmcnt(0)
  ds_write_b128 v1, v[8:11] offset:1024
  v_max3_u32 v89, v8, v9, v89
  v_max3_u32 v89, v10, v11, v89
  v_cmp_eq_u32 vcc, -1, v89
  s_cbranch_vccnz L_VO_bad
  s_waitcnt lgkmcnt(0)
  s_barrier
  ds_read_b128 v[12:15], v2 offset:0
  ds_read_b128 v[16:19], v2 offset:1024
  v_smfmac_f32_16x16x64_bf16 v[52:55], v[8:11], v[136:143], v88
  buffer_load_dwordx4 v[68:71], v87, s[4:7], s27 offen offset:0 sc1
  buffer_load_dwordx4 v[72:75], v87, s[4:7], s27 offen offset:1024 sc1
  ds_read_b128 v[4:7], v3 offset:0
  v_smfmac_f32_16x16x64_bf16 v[56:59], v[8:11], v[28:35], v88
  ds_read_b128 v[20:23], v85 offset:4096
  ds_read_b128 v[24:27], v85 offset:5120
  s_waitcnt lgkmcnt(4)
  v_smfmac_f32_16x16x64_bf16 v[52:55], v[12:15], v[144:151], v88
  ds_read_b128 v[8:11], v3 offset:1024
  ds_read_b128 v[28:31], v85 offset:12288
  v_smfmac_f32_16x16x64_bf16 v[56:59], v[12:15], v[36:43], v88
  ds_read_b128 v[32:35], v85 offset:13312
  s_waitcnt lgkmcnt(6)
  v_smfmac_f32_16x16x64_bf16 v[52:55], v[16:19], v[152:159], v88
  ds_read_b128 v[12:15], v84 offset:0
  ds_read_b128 v[36:39], v85 offset:6144
  v_smfmac_f32_16x16x64_bf16 v[56:59], v[16:19], v[44:51], v88
  ds_read_b128 v[40:43], v85 offset:7168
  s_waitcnt lgkmcnt(6)
  v_smfmac_f32_16x16x64_bf16 v[52:55], v[4:7], v[160:167], v88
  ds_read_b128 v[16:19], v84 offset:1024
  ds_read_b128 v[44:47], v85 offset:14336
  v_smfmac_f32_16x16x64_bf16 v[56:59], v[4:7], v[20:27], v88
  ds_read_b128 v[48:51], v85 offset:15360
  s_waitcnt lgkmcnt(6)
  v_smfmac_f32_16x16x64_bf16 v[52:55], v[8:11], v[168:175], v88
  ds_read_b128 v[20:23], v85 offset:16384
  v_smfmac_f32_16x16x64_bf16 v[56:59], v[8:11], v[28:35], v88
  ds_read_b128 v[24:27], v85 offset:17408
  s_waitcnt lgkmcnt(5)
  v_smfmac_f32_16x16x64_bf16 v[52:55], v[12:15], v[176:183], v88
  ds_read_b128 v[28:31], v85 offset:24576
  v_smfmac_f32_16x16x64_bf16 v[56:59], v[12:15], v[36:43], v88
  ds_read_b128 v[32:35], v85 offset:25600
  s_waitcnt lgkmcnt(4)
L_VO_rchk:
  s_waitcnt vmcnt(0)
  ds_write_b128 v1, v[68:71] offset:2048
  ds_write_b128 v1, v[72:75] offset:3072
  v_max3_u32 v89, v68, v69, v70
  v_max3_u32 v89, v70, v71, v89
  v_max3_u32 v89, v72, v73, v89
  v_max3_u32 v89, v74, v75, v89
  v_cmp_eq_u32 vcc, -1, v89
  s_cbranch_vccnz L_VO_rbad
  v_smfmac_f32_16x16x64_bf16 v[52:55], v[16:19], v[184:191], v88
  ds_read_b128 v[36:39], v85 offset:18432
  v_smfmac_f32_16x16x64_bf16 v[56:59], v[16:19], v[44:51], v88
  ds_read_b128 v[40:43], v85 offset:19456
  s_waitcnt lgkmcnt(6)
  s_waitcnt lgkmcnt(2)
  s_barrier
  v_smfmac_f32_16x16x64_bf16 v[52:55], v[68:71], v[192:199], v88
  ds_read_b128 v[12:15], v2 offset:2048
  ds_read_b128 v[16:19], v2 offset:3072
  v_smfmac_f32_16x16x64_bf16 v[56:59], v[68:71], v[20:27], v88
  ds_read_b128 v[44:47], v85 offset:26624
  ds_read_b128 v[48:51], v85 offset:27648
  v_smfmac_f32_16x16x64_bf16 v[52:55], v[72:75], v[200:207], v88
  ds_read_b128 v[4:7], v3 offset:2048
  ds_read_b128 v[20:23], v85 offset:20480
  v_smfmac_f32_16x16x64_bf16 v[56:59], v[72:75], v[28:35], v88
  ds_read_b128 v[24:27], v85 offset:21504
  s_waitcnt lgkmcnt(6)
  v_smfmac_f32_16x16x64_bf16 v[52:55], v[12:15], v[208:215], v88
  ds_read_b128 v[8:11], v3 offset:3072
  ds_read_b128 v[28:31], v85 offset:28672
  v_smfmac_f32_16x16x64_bf16 v[56:59], v[12:15], v[36:43], v88
  ds_read_b128 v[32:35], v85 offset:29696
  s_waitcnt lgkmcnt(6)
  v_smfmac_f32_16x16x64_bf16 v[52:55], v[16:19], v[216:223], v88
  ds_read_b128 v[12:15], v84 offset:2048
  ds_read_b128 v[36:39], v85 offset:22528
  v_smfmac_f32_16x16x64_bf16 v[56:59], v[16:19], v[44:51], v88
  ds_read_b128 v[40:43], v85 offset:23552
  s_waitcnt lgkmcnt(6)
  v_smfmac_f32_16x16x64_bf16 v[52:55], v[4:7], v[224:231], v88
  ds_read_b128 v[16:19], v84 offset:3072
  ds_read_b128 v[44:47], v85 offset:30720
  v_smfmac_f32_16x16x64_bf16 v[56:59], v[4:7], v[20:27], v88
  ds_read_b128 v[48:51], v85 offset:31744
  s_waitcnt lgkmcnt(6)
  v_smfmac_f32_16x16x64_bf16 v[52:55], v[8:11], v[232:239], v88
  v_smfmac_f32_16x16x64_bf16 v[56:59], v[8:11], v[28:35], v88
  s_waitcnt lgkmcnt(3)
  v_smfmac_f32_16x16x64_bf16 v[52:55], v[12:15], v[240:247], v88
  v_smfmac_f32_16x16x64_bf16 v[56:59], v[12:15], v[36:43], v88
  s_waitcnt lgkmcnt(0)
  v_smfmac_f32_16x16x64_bf16 v[52:55], v[16:19], v[248:255], v88
  v_smfmac_f32_16x16x64_bf16 v[56:59], v[16:19], v[44:51], v88
  s_nop 6
  v_pk_add_f32 v[52:53], v[52:53], v[54:55]
  v_pk_add_f32 v[56:57], v[56:57], v[58:59]
  v_cvt_pk_bf16_f32 v108, v52, v53
  v_cvt_pk_bf16_f32 v109, v56, v57
  v_min_u32 v108, -2, v108
  v_min_u32 v109, -2, v109
  s_cmp_eq_u32 s36, 0
  s_cbranch_scc1 Lwt_53
  buffer_store_dwordx2 v[108:109], v92, s[4:7], s29 offen
  s_branch Lwtd_54
Lwt_53:
  buffer_store_dwordx2 v[108:109], v92, s[4:7], s29 offen sc1
Lwtd_54:
  s_cmp_ge_u32 s25, 63
  s_cbranch_scc1 L_VO_end
  s_add_u32 s42, s28, s58
  s_xor_b32 s30, s42, s36
  s_add_u32 s31, s30, 4096
  s_xor_b32 s32, s42, 131072
  s_add_u32 s48, s32, 4096
  s_add_u32 s41, s25, 1
  v_mov_b32 v94, s41
  s_and_b32 s41, s41, 3
  s_lshl_b32 s41, s41, 16
  s_add_u32 s33, s41, s26
  s_add_u32 s33, s33, 1048576
  s_xor_b32 s49, s33, 8192
  s_xor_b32 s34, s33, 0x20000
  s_xor_b32 s35, s29, 0x84000
  buffer_store_dword v80, v118, s[4:7], s34 offen sc1
  s_xor_b32 s40, s34, 8192
  buffer_store_dword v80, v118, s[4:7], s40 offen
  s_cmp_eq_u32 s36, 0
  s_cbranch_scc1 Lwt_55
  buffer_store_dwordx2 v[80:81], v92, s[4:7], s35 offen
  s_branch Lwtd_56
Lwt_55:
  buffer_store_dwordx2 v[80:81], v92, s[4:7], s35 offen sc1
Lwtd_56:
  v_mov_b64 v[60:61], 0
  v_mov_b64 v[62:63], 0
  v_mov_b64 v[64:65], 0
  v_mov_b64 v[66:67], 0
  v_mov_b64 v[52:53], 0
  v_mov_b64 v[54:55], 0
  v_mov_b64 v[56:57], 0
  v_mov_b64 v[58:59], 0
  ds_read_b128 v[20:23], v85 offset:0
  ds_read_b128 v[24:27], v85 offset:1024
  ds_read_b128 v[28:31], v85 offset:8192
  ds_read_b128 v[32:35], v85 offset:9216
  ds_read_b128 v[36:39], v85 offset:2048
  ds_read_b128 v[40:43], v85 offset:3072
  ds_read_b128 v[44:47], v85 offset:10240
  ds_read_b128 v[48:51], v85 offset:11264
  s_cmp_lg_u32 s56, 0
  s_cbranch_scc1 Ltrigd_58
  buffer_load_dword v76, v90, s[4:7], 0 offen offset:2048 sc1
  s_sleep 1
  buffer_load_dword v77, v90, s[4:7], 0 offen offset:2048 sc1
  s_sleep 1
  buffer_load_dword v78, v90, s[4:7], 0 offen offset:2048 sc1
  s_sleep 1
Ltrig_57:
  s_sub_u32 s24, s24, 1
  s_cbranch_scc1 L_FAIL
  buffer_load_dword v79, v90, s[4:7], 0 offen offset:2048 sc1
  s_waitcnt vmcnt(3)
  v_cmp_gt_i32 vcc, s25, v76
  s_cbranch_vccz Ltrigd_58
  buffer_load_dword v76, v90, s[4:7], 0 offen offset:2048 sc1
  s_waitcnt vmcnt(3)
  v_cmp_gt_i32 vcc, s25, v77
  s_cbranch_vccz Ltrigd_58
  buffer_load_dword v77, v90, s[4:7], 0 offen offset:2048 sc1
  s_waitcnt vmcnt(3)
  v_cmp_gt_i32 vcc, s25, v78
  s_cbranch_vccz Ltrigd_58
  buffer_load_dword v78, v90, s[4:7], 0 offen offset:2048 sc1
  s_waitcnt vmcnt(3)
  v_cmp_gt_i32 vcc, s25, v79
  s_cbranch_vccnz Ltrig_57
Ltrigd_58:
  s_barrier
L_VOO_again:
  buffer_load_dwordx4 v[4:7], v95, s[4:7], s30 offen offset:0 sc1
  s_nop 0
  buffer_load_dwordx4 v[8:11], v95, s[4:7], s30 offen offset:1024 sc1
  s_nop 0
  buffer_load_dwordx4 v[12:15], v95, s[4:7], s30 offen offset:2048 sc1
  s_nop 0
  buffer_load_dwordx4 v[16:19], v95, s[4:7], s30 offen offset:3072 sc1
  s_nop 0
  buffer_load_dwordx4 v[68:71], v95, s[4:7], s31 offen offset:0 sc1
  s_nop 0
  buffer_load_dwordx4 v[72:75], v95, s[4:7], s31 offen offset:1024 sc1
  s_nop 0
  buffer_load_dwordx4 v[96:99], v95, s[4:7], s31 offen offset:2048 sc1
  s_nop 0
  buffer_load_dwordx4 v[100:103], v95, s[4:7], s31 offen offset:3072 sc1
  s_nop 0
  s_waitcnt vmcnt(7)
  v_max3_u32 v76, v4, v5, v6
  v_max_u32 v76, v76, v7
  v_cmp_eq_u32 vcc, -1, v76
  s_cbranch_vccnz L_VOO_g0
L_VOO_ok0:
  v_smfmac_f32_16x16x64_bf16 v[60:63], v[4:7], a[0:7], v88
  buffer_load_dwordx4 v[104:107], v95, s[4:7], s32 offen offset:0 sc1
  v_smfmac_f32_16x16x64_bf16 v[64:67], v[4:7], a[8:15], v88
  s_waitcnt vmcnt(7)
  v_smfmac_f32_16x16x64_bf16 v[60:63], v[8:11], a[16:23], v88
  buffer_load_dwordx4 v[4:7], v95, s[4:7], s32 offen offset:1024 sc1
  v_max3_u32 v89, v8, v9, v10
  v_smfmac_f32_16x16x64_bf16 v[64:67], v[8:11], a[24:31], v88
  v_max3_u32 v89, v10, v11, v89
  s_waitcnt vmcnt(7)
  v_smfmac_f32_16x16x64_bf16 v[60:63], v[12:15], a[32:39], v88
  buffer_load_dwordx4 v[8:11], v95, s[4:7], s32 offen offset:2048 sc1
  v_max3_u32 v89, v12, v13, v89
  v_smfmac_f32_16x16x64_bf16 v[64:67], v[12:15], a[40:47], v88
  v_max3_u32 v89, v14, v15, v89
  s_waitcnt vmcnt(7)
  v_smfmac_f32_16x16x64_bf16 v[60:63], v[16:19], a[48:55], v88
  buffer_load_dwordx4 v[12:15], v95, s[4:7], s32 offen offset:3072 sc1
  v_max3_u32 v89, v16, v17, v89
  v_max3_u32 v89, v18, v19, v89
  v_smfmac_f32_16x16x64_bf16 v[64:67], v[16:19], a[56:63], v88
  v_cmp_eq_u32 vcc, -1, v89
  s_cbranch_vccnz L_VOO_redo
  s_waitcnt vmcnt(7)
  v_smfmac_f32_16x16x64_bf16 v[60:63], v[68:71], a[64:71], v88
  buffer_load_dwordx4 v[16:19], v95, s[4:7], s48 offen offset:0 sc1
  v_max3_u32 v89, v68, v69, v89
  v_smfmac_f32_16x16x64_bf16 v[64:67], v[68:71], a[72:79], v88
  v_max3_u32 v89, v70, v71, v89
  s_waitcnt vmcnt(7)
  v_smfmac_f32_16x16x64_bf16 v[60:63], v[72:75], a[80:87], v88
  buffer_load_dwordx4 v[68:71], v95, s[4:7], s48 offen offset:1024 sc1
  v_max3_u32 v89, v72, v73, v89
  v_smfmac_f32_16x16x64_bf16 v[64:67], v[72:75], a[88:95], v88
  v_max3_u32 v89, v74, v75, v89
  s_waitcnt vmcnt(7)
  v_smfmac_f32_16x16x64_bf16 v[60:63], v[96:99], a[96:103], v88
  buffer_load_dwordx4 v[72:75], v95, s[4:7], s48 offen offset:2048 sc1
  v_max3_u32 v89, v96, v97, v89
  v_smfmac_f32_16x16x64_bf16 v[64:67], v[96:99], a[104:111], v88
  v_max3_u32 v89, v98, v99, v89
  s_waitcnt vmcnt(6)
  v_smfmac_f32_16x16x64_bf16 v[60:63], v[100:103], a[112:119], v88
  buffer_load_dwordx4 v[96:99], v95, s[4:7], s48 offen offset:3072 sc1
  v_max3_u32 v76, v104, v105, v106
  v_max_u32 v76, v76, v107
  v_cmp_eq_u32 vcc, -1, v76
  v_smfmac_f32_16x16x64_bf16 v[64:67], v[100:103], a[120:127], v88
  v_max3_u32 v89, v100, v101, v89
  v_max3_u32 v89, v102, v103, v89
  s_cbranch_vccnz L_VOO_g8
L_VOO_ok8:
  v_smfmac_f32_16x16x64_bf16 v[60:63], v[104:107], a[128:135], v88
  v_smfmac_f32_16x16x64_bf16 v[64:67], v[104:107], a[136:143], v88
  s_waitcnt vmcnt(6)
  v_smfmac_f32_16x16x64_bf16 v[60:63], v[4:7], a[144:151], v88
  v_max3_u32 v89, v4, v5, v89
  v_smfmac_f32_16x16x64_bf16 v[64:67], v[4:7], a[152:159], v88
  v_max3_u32 v89, v6, v7, v89
  s_waitcnt vmcnt(5)
  v_smfmac_f32_16x16x64_bf16 v[60:63], v[8:11], a[160:167], v88
  v_max3_u32 v89, v8, v9, v89
  v_smfmac_f32_16x16x64_bf16 v[64:67], v[8:11], a[168:175], v88
  v_max3_u32 v89, v10, v11, v89
  s_waitcnt vmcnt(4)
  v_smfmac_f32_16x16x64_bf16 v[60:63], v[12:15], a[176:183], v88
  v_max3_u32 v89, v12, v13, v89
  v_smfmac_f32_16x16x64_bf16 v[64:67], v[12:15], a[184:191], v88
  v_max3_u32 v89, v14, v15, v89
  s_waitcnt vmcnt(3)
  v_smfmac_f32_16x16x64_bf16 v[60:63], v[16:19], a[192:199], v88
  v_max3_u32 v89, v16, v17, v89
  v_smfmac_f32_16x16x64_bf16 v[64:67], v[16:19], a[200:207], v88
  v_max3_u32 v89, v18, v19, v89
  s_waitcnt vmcnt(2)
  v_smfmac_f32_16x16x64_bf16 v[60:63], v[68:71], a[208:215], v88
  v_max3_u32 v89, v68, v69, v89
  v_smfmac_f32_16x16x64_bf16 v[64:67], v[68:71], a[216:223], v88
  v_max3_u32 v89, v70, v71, v89
  s_waitcnt vmcnt(1)
  v_smfmac_f32_16x16x64_bf16 v[60:63], v[72:75], a[224:231], v88
  v_max3_u32 v89, v72, v73, v89
  v_smfmac_f32_16x16x64_bf16 v[64:67], v[72:75], a[232:239], v88
  v_max3_u32 v89, v74, v75, v89
  s_waitcnt vmcnt(0)
  v_smfmac_f32_16x16x64_bf16 v[60:63], v[96:99], a[240:247], v88
  v_max3_u32 v89, v96, v97, v89
  v_max3_u32 v89, v98, v99, v89
  v_smfmac_f32_16x16x64_bf16 v[64:67], v[96:99], a[248:255], v88
  v_cmp_eq_u32 vcc, -1, v89
  s_cbranch_vccnz L_VOO_redo
  s_nop 2
  v_add_f32 v108, v60, v62
  v_add_f32 v110, v61, v63
  s_nop 0
  v_add_f32 v109, v64, v66
  v_add_f32 v111, v65, v67
  ds_write_b128 v116, v[108:111]
  s_waitcnt lgkmcnt(0)
  s_barrier
  ds_read2st64_b64 v[108:111], v117 offset0:0 offset1:2
  ds_read2st64_b64 v[112:115], v117 offset0:4 offset1:6
  buffer_store_dword v94, v91, s[4:7], s57 offen
  s_waitcnt lgkmcnt(1)
  v_pk_add_f32 v[108:109], v[108:109], v[110:111]
  s_waitcnt lgkmcnt(0)
  v_pk_add_f32 v[112:113], v[112:113], v[114:115]
  v_pk_add_f32 v[108:109], v[108:109], v[112:113]
  v_cvt_pk_bf16_f32 v108, v108, v109
  v_min_u32 v108, -2, v108
  buffer_store_dword v108, v118, s[4:7], s49 offen
  buffer_store_dword v108, v118, s[4:7], s33 offen sc1
  s_add_u32 s25, s25, 1
  s_branch L_VO_top
L_VO_end:
  s_branch L_END
L_VO_bad:
  s_nop 7
  s_sub_u32 s24, s24, 1
  s_cbranch_scc1 L_FAIL
  s_add_u32 s60, s60, 1
  v_mov_b64 v[52:53], 0
  v_mov_b64 v[54:55], 0
  v_mov_b64 v[56:57], 0
  v_mov_b64 v[58:59], 0
  s_nop 1
  s_branch L_VO_retry
L_VO_rbad:
  s_sub_u32 s24, s24, 1
  s_cbranch_scc1 L_FAIL
  s_add_u32 s60, s60, 0x10000
  s_waitcnt lgkmcnt(0)
  buffer_load_dwordx4 v[68:71], v87, s[4:7], s27 offen offset:0 sc1
  buffer_load_dwordx4 v[72:75], v87, s[4:7], s27 offen offset:1024 sc1
  s_branch L_VO_rchk
L_VOO_redo:
  s_nop 7
  s_sub_u32 s24, s24, 1
  s_cbranch_scc1 L_FAIL
  s_add_u32 s61, s61, 0x10000
  s_waitcnt vmcnt(0) lgkmcnt(0)
  v_mov_b64 v[60:61], 0
  v_mov_b64 v[62:63], 0
  v_mov_b64 v[64:65], 0
  v_mov_b64 v[66:67], 0
  s_nop 1
  s_branch L_VOO_again
L_VOO_g0:
  s_sub_u32 s24, s24, 1
  s_cbranch_scc1 L_FAIL
  s_add_u32 s61, s61, 1
  s_waitcnt vmcnt(0)
  buffer_load_dwordx4 v[4:7], v95, s[4:7], s30 offen offset:0 sc1
  buffer_load_dwordx4 v[8:11], v95, s[4:7], s30 offen offset:1024 sc1
  buffer_load_dwordx4 v[12:15], v95, s[4:7], s30 offen offset:2048 sc1
  buffer_load_dwordx4 v[16:19], v95, s[4:7], s30 offen offset:3072 sc1
  buffer_load_dwordx4 v[68:71], v95, s[4:7], s31 offen offset:0 sc1
  buffer_load_dwordx4 v[72:75], v95, s[4:7], s31 offen offset:1024 sc1
  buffer_load_dwordx4 v[96:99], v95, s[4:7], s31 offen offset:2048 sc1
  buffer_load_dwordx4 v[100:103], v95, s[4:7], s31 offen offset:3072 sc1
  s_waitcnt vmcnt(7)
  v_max3_u32 v76, v4, v5, v6
  v_max_u32 v76, v76, v7
  v_cmp_eq_u32 vcc, -1, v76
  s_cbranch_vccnz L_VOO_g0
  s_branch L_VOO_ok0
L_VOO_g8:
  s_sub_u32 s24, s24, 1
  s_cbranch_scc1 L_FAIL
  s_add_u32 s61, s61, 256
  s_waitcnt vmcnt(0)
  buffer_load_dwordx4 v[104:107], v95, s[4:7], s32 offen offset:0 sc1
  buffer_load_dwordx4 v[4:7], v95, s[4:7], s32 offen offset:1024 sc1
  buffer_load_dwordx4 v[8:11], v95, s[4:7], s32 offen offset:2048 sc1
  buffer_load_dwordx4 v[12:15], v95, s[4:7], s32 offen offset:3072 sc1
  buffer_load_dwordx4 v[16:19], v95, s[4:7], s48 offen offset:0 sc1
  buffer_load_dwordx4 v[68:71], v95, s[4:7], s48 offen offset:1024 sc1
  buffer_load_dwordx4 v[72:75], v95, s[4:7], s48 offen offset:2048 sc1
  buffer_load_dwordx4 v[96:99], v95, s[4:7], s48 offen offset:3072 sc1
  s_waitcnt vmcnt(7)
  v_max3_u32 v76, v104, v105, v106
  v_max_u32 v76, v76, v107
  v_cmp_eq_u32 vcc, -1, v76
  s_cbranch_vccnz L_VOO_g8
  s_branch L_VOO_ok8
.section .rodata,"a"
.p2align 6
.amdhsa_kernel adaLN_cond__memory_aug_recurrent_mem_tr__glu_gated_swiglu__prompt_kernel
  .amdhsa_next_free_vgpr 512
  .amdhsa_next_free_sgpr 102
  .amdhsa_accum_offset 256
  .amdhsa_group_segment_fixed_size 0
  .amdhsa_kernarg_size 128
  .amdhsa_user_sgpr_count 2
  .amdhsa_user_sgpr_kernarg_segment_ptr 1
  .amdhsa_system_sgpr_workgroup_id_x 1
  .amdhsa_float_denorm_mode_32 3
.end_amdhsa_kernel
```

```asm
; @launch grid=(256,1,1) block=(256,1,1) lds=163840
.amdgcn_target "amdgcn-amd-amdhsa--gfx950"
.text
.globl adaLN_cond__memory_aug_recurrent_mem_tr__glu_gated_swiglu__prompt_kernel
.p2align 8
.type adaLN_cond__memory_aug_recurrent_mem_tr__glu_gated_swiglu__prompt_kernel,@function
adaLN_cond__memory_aug_recurrent_mem_tr__glu_gated_swiglu__prompt_kernel:
  s_cmp_ge_u32 s2, 256
  s_cbranch_scc1 L_END
  s_load_dwordx2 s[4:5], s[0:1], 120
  s_load_dwordx2 s[12:13], s[0:1], 112
  v_lshrrev_b32 v1, 6, v0
  v_and_b32 v0, 63, v0
  v_readfirstlane_b32 s20, v1
  s_mov_b32 s6, 171966464
  s_mov_b32 s7, 0x20000
  s_mov_b32 s14, 256
  s_mov_b32 s15, 0x20000
  s_mov_b32 s24, 300000
  s_and_b32 s40, s2, 7
  s_lshl_b32 s40, s40, 2
  s_lshr_b32 s22, 0x53417260, s40
  s_and_b32 s22, s22, 7
  s_lshr_b32 s23, s2, 3
  s_waitcnt lgkmcnt(0)
  s_add_u32 s4, s4, 0x1fffff
  s_addc_u32 s5, s5, 0
  s_and_b32 s4, s4, 0xffe00000
  s_cmp_ge_u32 s22, 4
  s_cbranch_scc1 L_TRAIL
  s_lshr_b32 s40, s22, 1
  s_bitcmp1_b32 s22, 0
  s_cbranch_scc0 L_REC
  s_lshl_b32 s40, s40, 5
  s_add_u32 s21, s40, s23
  s_branch L_QKV
L_REC:
  s_lshl_b32 s40, s40, 4
  s_lshr_b32 s41, s23, 1
  s_add_u32 s21, s40, s41
  s_bitcmp1_b32 s23, 0
  s_cbranch_scc1 L_VO
  s_branch L_QK
L_TRAIL:
  s_mov_b32 s21, s23
  s_cmp_eq_u32 s22, 6
  s_cbranch_scc1 L_MOD
  s_sub_u32 s40, s22, 4
  s_lshl_b32 s40, s40, 5
  s_add_u32 s21, s40, s23
  s_cmp_lg_u32 s22, 7
  s_cbranch_scc1 L_WOF
L_INIT:
  s_lshl_b32 s40, s23, 2
  s_add_u32 s40, s40, s20
  s_lshl_b32 s40, s40, 12
  s_add_u32 s41, s40, 1048576
  s_add_u32 s42, s40, 0x80000
  v_lshlrev_b32 v1, 4, v0
  v_mov_b32 v4, -1
  v_mov_b32 v5, -1
  v_mov_b32 v6, -1
  v_mov_b32 v7, -1
  s_cmp_lt_u32 s23, 4
  s_cselect_b32 s41, 2147483392, s41
  buffer_store_dwordx4 v[4:7], v1, s[4:7], s41 offen offset:0 sc1
  buffer_store_dwordx4 v[4:7], v1, s[4:7], s41 offen offset:1024 sc1
  buffer_store_dwordx4 v[4:7], v1, s[4:7], s41 offen offset:2048 sc1
  buffer_store_dwordx4 v[4:7], v1, s[4:7], s41 offen offset:3072 sc1
  buffer_store_dwordx4 v[4:7], v1, s[4:7], s40 offen offset:0 sc1
  buffer_store_dwordx4 v[4:7], v1, s[4:7], s40 offen offset:1024 sc1
  buffer_store_dwordx4 v[4:7], v1, s[4:7], s40 offen offset:2048 sc1
  buffer_store_dwordx4 v[4:7], v1, s[4:7], s40 offen offset:3072 sc1
  buffer_store_dwordx4 v[4:7], v1, s[4:7], s42 offen offset:0 sc1
  buffer_store_dwordx4 v[4:7], v1, s[4:7], s42 offen offset:1024 sc1
  buffer_store_dwordx4 v[4:7], v1, s[4:7], s42 offen offset:2048 sc1
  buffer_store_dwordx4 v[4:7], v1, s[4:7], s42 offen offset:3072 sc1
  s_load_dwordx2 s[16:17], s[0:1], 8
  s_mov_b32 s18, 16384
  s_mov_b32 s19, 0x20000
  s_waitcnt lgkmcnt(0)
  s_and_b32 s40, s20, 1
  s_lshl_b32 s40, s40, 3
  v_bfe_u32 v8, v0, 2, 3
  v_add_u32 v8, s40, v8
  s_lshr_b32 s40, s20, 1
  s_lshl_b32 s40, s40, 3
  v_and_b32 v9, 3, v0
  v_add_u32 v9, s40, v9
  v_bfe_u32 v10, v8, 1, 1
  v_lshl_add_u32 v9, v10, 2, v9
  v_lshrrev_b32 v10, 2, v8
  v_and_b32 v11, 1, v8
  v_lshl_add_u32 v10, v10, 1, v11
  s_lshl_b32 s40, s23, 6
  v_lshl_add_u32 v10, v10, 11, s40
  v_lshl_add_u32 v10, v9, 1, v10
  buffer_load_ushort v11, v10, s[16:19], 0 offen
  buffer_load_ushort v12, v10, s[16:19], 0 offen offset:32
  s_bfe_u32 s41, s23, 0x10002
  s_mul_i32 s41, s41, 32768
  s_lshr_b32 s40, s23, 3
  s_lshl_b32 s40, s40, 11
  s_add_u32 s40, s40, s41
  s_and_b32 s41, s23, 3
  s_lshl_b32 s41, s41, 9
  s_add_u32 s40, s40, s41
  s_lshl_b32 s41, s20, 7
  s_add_u32 s40, s40, s41
  s_add_u32 s40, s40, 1048576
  s_add_u32 s41, s40, 0x4000
  v_and_b32 v8, 31, v0
  v_lshlrev_b32 v8, 2, v8
  v_lshrrev_b32 v9, 5, v0
  v_lshl_add_u32 v8, v9, 13, v8
  s_waitcnt vmcnt(0)
  v_lshl_or_b32 v11, v12, 16, v11
  v_min_u32 v11, -2, v11
  buffer_store_dword v11, v8, s[4:7], s40 offen sc1
  buffer_store_dword v11, v8, s[4:7], s41 offen sc1
  s_lshl_b32 s40, s23, 2
  s_add_u32 s40, s40, 128
  v_mov_b32 v2, 2147483392
  s_mov_b64 exec, 1
  v_mov_b32 v2, s40
  s_mov_b64 exec, -1
  v_mov_b32 v3, 1
  s_waitcnt vmcnt(0)
  s_barrier
  s_cmp_lg_u32 s20, 0
  s_cbranch_scc1 L_LN1
  buffer_store_dword v3, v2, s[12:15], 0 offen sc1
  s_branch L_LN1
L_MOD:
  s_load_dwordx2 s[16:17], s[0:1], 88
  s_mov_b32 s18, 2048
  s_mov_b32 s19, 0x20000
  s_waitcnt lgkmcnt(0)
  s_load_dwordx2 s[8:9], s[0:1], 96
  s_mov_b32 s10, 12582912
  s_mov_b32 s11, 0x20000
  s_waitcnt lgkmcnt(0)
  s_lshl_b32 s40, s20, 9
  v_lshl_add_u32 v1, v0, 3, s40
  buffer_load_dwordx2 v[8:9], v1, s[16:19], 0 offen
  v_bfe_u32 v2, v0, 5, 1
  v_mul_u32_u24 v2, 98304, v2
  v_bfe_u32 v3, v0, 4, 1
  v_mul_u32_u24 v3, 24576, v3
  v_add_u32 v2, v2, v3
  v_bfe_u32 v3, v0, 3, 1
  v_mul_u32_u24 v3, 12288, v3
  v_add_u32 v2, v2, v3
  v_lshrrev_b32 v3, 3, v0
  v_and_b32 v3, 6, v3
  v_xor_b32 v3, v3, v0
  v_and_b32 v3, 7, v3
  v_lshl_add_u32 v2, v3, 4, v2
  s_lshr_b32 s40, s20, 1
  s_mul_i32 s40, s40, 49152
  s_and_b32 s41, s20, 1
  s_mul_i32 s41, s41, 196608
  s_add_u32 s40, s40, s41
  s_lshl_b32 s41, s21, 7
  s_add_u32 s40, s40, s41
  v_add_u32 v2, s40, v2
  s_lshl_b32 s41, s20, 10
  s_add_u32 m0, s41, 0
  s_mov_b32 s42, 0
  buffer_load_dwordx4 v2, s[8:11], s42 offen nt lds
  s_add_u32 m0, s41, 4096
  s_mov_b32 s42, 393216
  buffer_load_dwordx4 v2, s[8:11], s42 offen nt lds
  s_add_u32 m0, s41, 8192
  s_mov_b32 s42, 786432
  buffer_load_dwordx4 v2, s[8:11], s42 offen nt lds
  s_add_u32 m0, s41, 12288
  s_mov_b32 s42, 1179648
  buffer_load_dwordx4 v2, s[8:11], s42 offen nt lds
  s_add_u32 m0, s41, 16384
  s_mov_b32 s42, 1572864
  buffer_load_dwordx4 v2, s[8:11], s42 offen nt lds
  s_add_u32 m0, s41, 20480
  s_mov_b32 s42, 1966080
  buffer_load_dwordx4 v2, s[8:11], s42 offen nt lds
  s_add_u32 m0, s41, 24576
  s_mov_b32 s42, 2359296
  buffer_load_dwordx4 v2, s[8:11], s42 offen nt lds
  s_add_u32 m0, s41, 28672
  s_mov_b32 s42, 2752512
  buffer_load_dwordx4 v2, s[8:11], s42 offen nt lds
  s_add_u32 m0, s41, 32768
  s_mov_b32 s42, 3145728
  buffer_load_dwordx4 v2, s[8:11], s42 offen nt lds
  s_add_u32 m0, s41, 36864
  s_mov_b32 s42, 3538944
  buffer_load_dwordx4 v2, s[8:11], s42 offen nt lds
  s_add_u32 m0, s41, 40960
  s_mov_b32 s42, 3932160
  buffer_load_dwordx4 v2, s[8:11], s42 offen nt lds
  s_add_u32 m0, s41, 45056
  s_mov_b32 s42, 4325376
  buffer_load_dwordx4 v2, s[8:11], s42 offen nt lds
  s_add_u32 m0, s41, 49152
  s_mov_b32 s42, 4718592
  buffer_load_dwordx4 v2, s[8:11], s42 offen nt lds
  s_add_u32 m0, s41, 53248
  s_mov_b32 s42, 5111808
  buffer_load_dwordx4 v2, s[8:11], s42 offen nt lds
  s_add_u32 m0, s41, 57344
  s_mov_b32 s42, 5505024
  buffer_load_dwordx4 v2, s[8:11], s42 offen nt lds
  s_add_u32 m0, s41, 61440
  s_mov_b32 s42, 5898240
  buffer_load_dwordx4 v2, s[8:11], s42 offen nt lds
  s_add_u32 m0, s41, 65536
  s_mov_b32 s42, 6291456
  buffer_load_dwordx4 v2, s[8:11], s42 offen nt lds
  s_add_u32 m0, s41, 69632
  s_mov_b32 s42, 6684672
  buffer_load_dwordx4 v2, s[8:11], s42 offen nt lds
  s_add_u32 m0, s41, 73728
  s_mov_b32 s42, 7077888
  buffer_load_dwordx4 v2, s[8:11], s42 offen nt lds
  s_add_u32 m0, s41, 77824
  s_mov_b32 s42, 7471104
  buffer_load_dwordx4 v2, s[8:11], s42 offen nt lds
  s_add_u32 m0, s41, 81920
  s_mov_b32 s42, 7864320
  buffer_load_dwordx4 v2, s[8:11], s42 offen nt lds
  s_add_u32 m0, s41, 86016
  s_mov_b32 s42, 8257536
  buffer_load_dwordx4 v2, s[8:11], s42 offen nt lds
  s_add_u32 m0, s41, 90112
  s_mov_b32 s42, 8650752
  buffer_load_dwordx4 v2, s[8:11], s42 offen nt lds
  s_add_u32 m0, s41, 94208
  s_mov_b32 s42, 9043968
  buffer_load_dwordx4 v2, s[8:11], s42 offen nt lds
  s_add_u32 m0, s41, 98304
  s_mov_b32 s42, 9437184
  buffer_load_dwordx4 v2, s[8:11], s42 offen nt lds
  s_add_u32 m0, s41, 102400
  s_mov_b32 s42, 9830400
  buffer_load_dwordx4 v2, s[8:11], s42 offen nt lds
  s_add_u32 m0, s41, 106496
  s_mov_b32 s42, 10223616
  buffer_load_dwordx4 v2, s[8:11], s42 offen nt lds
  s_add_u32 m0, s41, 110592
  s_mov_b32 s42, 10616832
  buffer_load_dwordx4 v2, s[8:11], s42 offen nt lds
  s_add_u32 m0, s41, 114688
  s_mov_b32 s42, 11010048
  buffer_load_dwordx4 v2, s[8:11], s42 offen nt lds
  s_add_u32 m0, s41, 118784
  s_mov_b32 s42, 11403264
  buffer_load_dwordx4 v2, s[8:11], s42 offen nt lds
  s_add_u32 m0, s41, 122880
  s_mov_b32 s42, 11796480
  buffer_load_dwordx4 v2, s[8:11], s42 offen nt lds
  s_add_u32 m0, s41, 126976
  s_mov_b32 s42, 12189696
  buffer_load_dwordx4 v2, s[8:11], s42 offen nt lds
  v_bfe_u32 v3, v0, 3, 2
  v_xor_b32 v3, s20, v3
  v_lshlrev_b32 v3, 5, v3
  v_lshrrev_b32 v4, 2, v0
  v_lshl_add_u32 v4, v4, 7, v3
  v_and_b32 v3, 3, v0
  v_lshl_add_u32 v4, v3, 3, v4
  v_add_u32 v5, 0x10000, v4
  v_lshrrev_b32 v6, 4, v0
  v_lshlrev_b32 v6, 4, v6
  v_add_u32 v6, 0x20000, v6
  v_add_u32 v1, 0x20000, v1
  s_mov_b32 s37, 0xbfb8aa3b
  s_waitcnt vmcnt(32)
  v_lshlrev_b32 v10, 16, v8
  v_and_b32 v11, 0xffff0000, v8
  v_lshlrev_b32 v12, 16, v9
  v_and_b32 v13, 0xffff0000, v9
  v_mul_f32 v14, s37, v10
  v_mul_f32 v15, s37, v11
  v_mul_f32 v16, s37, v12
  v_mul_f32 v17, s37, v13
  v_exp_f32 v14, v14
  v_exp_f32 v15, v15
  v_exp_f32 v16, v16
  v_exp_f32 v17, v17
  v_add_f32 v14, 1.0, v14
  v_add_f32 v15, 1.0, v15
  v_add_f32 v16, 1.0, v16
  v_add_f32 v17, 1.0, v17
  v_rcp_f32 v14, v14
  v_rcp_f32 v15, v15
  v_rcp_f32 v16, v16
  v_rcp_f32 v17, v17
  v_mul_f32 v10, v10, v14
  v_mul_f32 v11, v11, v15
  v_mul_f32 v12, v12, v16
  v_mul_f32 v13, v13, v17
  v_cvt_pk_bf16_f32 v8, v10, v11
  v_cvt_pk_bf16_f32 v9, v12, v13
  ds_write_b64 v1, v[8:9]
  s_waitcnt vmcnt(28) lgkmcnt(0)
  s_barrier
  ds_read_b64_tr_b16 v[24:25], v4 offset:0
  ds_read_b64_tr_b16 v[26:27], v4 offset:2048
  ds_read_b128 v[28:31], v6 offset:0
  ds_read_b64_tr_b16 v[32:33], v4 offset:4096
  ds_read_b64_tr_b16 v[34:35], v4 offset:6144
  ds_read_b128 v[36:39], v6 offset:64
  ds_read_b64_tr_b16 v[40:41], v4 offset:8192
  ds_read_b64_tr_b16 v[42:43], v4 offset:10240
  ds_read_b128 v[44:47], v6 offset:128
  ds_read_b64_tr_b16 v[48:49], v4 offset:12288
  ds_read_b64_tr_b16 v[50:51], v4 offset:14336
  ds_read_b128 v[52:55], v6 offset:192
  s_waitcnt lgkmcnt(9)
  v_mfma_f32_16x16x32_bf16 v[20:23], v[24:27], v[28:31], 0
  s_waitcnt lgkmcnt(6)
  v_mfma_f32_16x16x32_bf16 v[20:23], v[32:35], v[36:39], v[20:23]
  s_waitcnt lgkmcnt(3)
  v_mfma_f32_16x16x32_bf16 v[20:23], v[40:43], v[44:47], v[20:23]
  s_waitcnt lgkmcnt(0)
  v_mfma_f32_16x16x32_bf16 v[20:23], v[48:51], v[52:55], v[20:23]
  s_waitcnt vmcnt(24) lgkmcnt(0)
  s_barrier
  ds_read_b64_tr_b16 v[24:25], v4 offset:16384
  ds_read_b64_tr_b16 v[26:27], v4 offset:18432
  ds_read_b128 v[28:31], v6 offset:256
  ds_read_b64_tr_b16 v[32:33], v4 offset:20480
  ds_read_b64_tr_b16 v[34:35], v4 offset:22528
  ds_read_b128 v[36:39], v6 offset:320
  ds_read_b64_tr_b16 v[40:41], v4 offset:24576
  ds_read_b64_tr_b16 v[42:43], v4 offset:26624
  ds_read_b128 v[44:47], v6 offset:384
  ds_read_b64_tr_b16 v[48:49], v4 offset:28672
  ds_read_b64_tr_b16 v[50:51], v4 offset:30720
  ds_read_b128 v[52:55], v6 offset:448
  s_waitcnt lgkmcnt(9)
  v_mfma_f32_16x16x32_bf16 v[20:23], v[24:27], v[28:31], v[20:23]
  s_waitcnt lgkmcnt(6)
  v_mfma_f32_16x16x32_bf16 v[20:23], v[32:35], v[36:39], v[20:23]
  s_waitcnt lgkmcnt(3)
  v_mfma_f32_16x16x32_bf16 v[20:23], v[40:43], v[44:47], v[20:23]
  s_waitcnt lgkmcnt(0)
  v_mfma_f32_16x16x32_bf16 v[20:23], v[48:51], v[52:55], v[20:23]
  s_waitcnt vmcnt(20) lgkmcnt(0)
  s_barrier
  ds_read_b64_tr_b16 v[24:25], v4 offset:32768
  ds_read_b64_tr_b16 v[26:27], v4 offset:34816
  ds_read_b128 v[28:31], v6 offset:512
  ds_read_b64_tr_b16 v[32:33], v4 offset:36864
  ds_read_b64_tr_b16 v[34:35], v4 offset:38912
  ds_read_b128 v[36:39], v6 offset:576
  ds_read_b64_tr_b16 v[40:41], v4 offset:40960
  ds_read_b64_tr_b16 v[42:43], v4 offset:43008
  ds_read_b128 v[44:47], v6 offset:640
  ds_read_b64_tr_b16 v[48:49], v4 offset:45056
  ds_read_b64_tr_b16 v[50:51], v4 offset:47104
  ds_read_b128 v[52:55], v6 offset:704
  s_waitcnt lgkmcnt(9)
  v_mfma_f32_16x16x32_bf16 v[20:23], v[24:27], v[28:31], v[20:23]
  s_waitcnt lgkmcnt(6)
  v_mfma_f32_16x16x32_bf16 v[20:23], v[32:35], v[36:39], v[20:23]
  s_waitcnt lgkmcnt(3)
  v_mfma_f32_16x16x32_bf16 v[20:23], v[40:43], v[44:47], v[20:23]
  s_waitcnt lgkmcnt(0)
  v_mfma_f32_16x16x32_bf16 v[20:23], v[48:51], v[52:55], v[20:23]
  s_waitcnt vmcnt(16) lgkmcnt(0)
  s_barrier
  ds_read_b64_tr_b16 v[24:25], v4 offset:49152
  ds_read_b64_tr_b16 v[26:27], v4 offset:51200
  ds_read_b128 v[28:31], v6 offset:768
  ds_read_b64_tr_b16 v[32:33], v4 offset:53248
  ds_read_b64_tr_b16 v[34:35], v4 offset:55296
  ds_read_b128 v[36:39], v6 offset:832
  ds_read_b64_tr_b16 v[40:41], v4 offset:57344
  ds_read_b64_tr_b16 v[42:43], v4 offset:59392
  ds_read_b128 v[44:47], v6 offset:896
  ds_read_b64_tr_b16 v[48:49], v4 offset:61440
  ds_read_b64_tr_b16 v[50:51], v4 offset:63488
  ds_read_b128 v[52:55], v6 offset:960
  s_waitcnt lgkmcnt(9)
  v_mfma_f32_16x16x32_bf16 v[20:23], v[24:27], v[28:31], v[20:23]
  s_waitcnt lgkmcnt(6)
  v_mfma_f32_16x16x32_bf16 v[20:23], v[32:35], v[36:39], v[20:23]
  s_waitcnt lgkmcnt(3)
  v_mfma_f32_16x16x32_bf16 v[20:23], v[40:43], v[44:47], v[20:23]
  s_waitcnt lgkmcnt(0)
  v_mfma_f32_16x16x32_bf16 v[20:23], v[48:51], v[52:55], v[20:23]
  s_waitcnt vmcnt(12) lgkmcnt(0)
  s_barrier
  ds_read_b64_tr_b16 v[24:25], v5 offset:0
  ds_read_b64_tr_b16 v[26:27], v5 offset:2048
  ds_read_b128 v[28:31], v6 offset:1024
  ds_read_b64_tr_b16 v[32:33], v5 offset:4096
  ds_read_b64_tr_b16 v[34:35], v5 offset:6144
  ds_read_b128 v[36:39], v6 offset:1088
  ds_read_b64_tr_b16 v[40:41], v5 offset:8192
  ds_read_b64_tr_b16 v[42:43], v5 offset:10240
  ds_read_b128 v[44:47], v6 offset:1152
  ds_read_b64_tr_b16 v[48:49], v5 offset:12288
  ds_read_b64_tr_b16 v[50:51], v5 offset:14336
  ds_read_b128 v[52:55], v6 offset:1216
  s_waitcnt lgkmcnt(9)
  v_mfma_f32_16x16x32_bf16 v[20:23], v[24:27], v[28:31], v[20:23]
  s_waitcnt lgkmcnt(6)
  v_mfma_f32_16x16x32_bf16 v[20:23], v[32:35], v[36:39], v[20:23]
  s_waitcnt lgkmcnt(3)
  v_mfma_f32_16x16x32_bf16 v[20:23], v[40:43], v[44:47], v[20:23]
  s_waitcnt lgkmcnt(0)
  v_mfma_f32_16x16x32_bf16 v[20:23], v[48:51], v[52:55], v[20:23]
  s_waitcnt vmcnt(8) lgkmcnt(0)
  s_barrier
  ds_read_b64_tr_b16 v[24:25], v5 offset:16384
  ds_read_b64_tr_b16 v[26:27], v5 offset:18432
  ds_read_b128 v[28:31], v6 offset:1280
  ds_read_b64_tr_b16 v[32:33], v5 offset:20480
  ds_read_b64_tr_b16 v[34:35], v5 offset:22528
  ds_read_b128 v[36:39], v6 offset:1344
  ds_read_b64_tr_b16 v[40:41], v5 offset:24576
  ds_read_b64_tr_b16 v[42:43], v5 offset:26624
  ds_read_b128 v[44:47], v6 offset:1408
  ds_read_b64_tr_b16 v[48:49], v5 offset:28672
  ds_read_b64_tr_b16 v[50:51], v5 offset:30720
  ds_read_b128 v[52:55], v6 offset:1472
  s_waitcnt lgkmcnt(9)
  v_mfma_f32_16x16x32_bf16 v[20:23], v[24:27], v[28:31], v[20:23]
  s_waitcnt lgkmcnt(6)
  v_mfma_f32_16x16x32_bf16 v[20:23], v[32:35], v[36:39], v[20:23]
  s_waitcnt lgkmcnt(3)
  v_mfma_f32_16x16x32_bf16 v[20:23], v[40:43], v[44:47], v[20:23]
  s_waitcnt lgkmcnt(0)
  v_mfma_f32_16x16x32_bf16 v[20:23], v[48:51], v[52:55], v[20:23]
  s_waitcnt vmcnt(4) lgkmcnt(0)
  s_barrier
  ds_read_b64_tr_b16 v[24:25], v5 offset:32768
  ds_read_b64_tr_b16 v[26:27], v5 offset:34816
  ds_read_b128 v[28:31], v6 offset:1536
  ds_read_b64_tr_b16 v[32:33], v5 offset:36864
  ds_read_b64_tr_b16 v[34:35], v5 offset:38912
  ds_read_b128 v[36:39], v6 offset:1600
  ds_read_b64_tr_b16 v[40:41], v5 offset:40960
  ds_read_b64_tr_b16 v[42:43], v5 offset:43008
  ds_read_b128 v[44:47], v6 offset:1664
  ds_read_b64_tr_b16 v[48:49], v5 offset:45056
  ds_read_b64_tr_b16 v[50:51], v5 offset:47104
  ds_read_b128 v[52:55], v6 offset:1728
  s_waitcnt lgkmcnt(9)
  v_mfma_f32_16x16x32_bf16 v[20:23], v[24:27], v[28:31], v[20:23]
  s_waitcnt lgkmcnt(6)
  v_mfma_f32_16x16x32_bf16 v[20:23], v[32:35], v[36:39], v[20:23]
  s_waitcnt lgkmcnt(3)
  v_mfma_f32_16x16x32_bf16 v[20:23], v[40:43], v[44:47], v[20:23]
  s_waitcnt lgkmcnt(0)
  v_mfma_f32_16x16x32_bf16 v[20:23], v[48:51], v[52:55], v[20:23]
  s_waitcnt vmcnt(0) lgkmcnt(0)
  s_barrier
  ds_read_b64_tr_b16 v[24:25], v5 offset:49152
  ds_read_b64_tr_b16 v[26:27], v5 offset:51200
  ds_read_b128 v[28:31], v6 offset:1792
  ds_read_b64_tr_b16 v[32:33], v5 offset:53248
  ds_read_b64_tr_b16 v[34:35], v5 offset:55296
  ds_read_b128 v[36:39], v6 offset:1856
  ds_read_b64_tr_b16 v[40:41], v5 offset:57344
  ds_read_b64_tr_b16 v[42:43], v5 offset:59392
  ds_read_b128 v[44:47], v6 offset:1920
  ds_read_b64_tr_b16 v[48:49], v5 offset:61440
  ds_read_b64_tr_b16 v[50:51], v5 offset:63488
  ds_read_b128 v[52:55], v6 offset:1984
  s_waitcnt lgkmcnt(9)
  v_mfma_f32_16x16x32_bf16 v[20:23], v[24:27], v[28:31], v[20:23]
  s_waitcnt lgkmcnt(6)
  v_mfma_f32_16x16x32_bf16 v[20:23], v[32:35], v[36:39], v[20:23]
  s_waitcnt lgkmcnt(3)
  v_mfma_f32_16x16x32_bf16 v[20:23], v[40:43], v[44:47], v[20:23]
  s_waitcnt lgkmcnt(0)
  v_mfma_f32_16x16x32_bf16 v[20:23], v[48:51], v[52:55], v[20:23]
  s_lshl_b32 s40, s21, 8
  s_lshl_b32 s41, s20, 6
  s_add_u32 s40, s40, s41
  s_add_u32 s40, s40, 1572864
  v_and_b32 v2, 15, v0
  v_cmp_eq_u32 vcc, 0, v2
  v_mov_b32 v3, 2147483392
  s_nop 0
  v_cndmask_b32 v1, v3, v0, vcc
  v_cvt_pk_bf16_f32 v8, v20, v21
  v_cvt_pk_bf16_f32 v9, v22, v23
  v_lshlrev_b32 v20, 16, v8
  v_and_b32 v21, 0xffff0000, v8
  v_lshlrev_b32 v22, 16, v9
  v_and_b32 v23, 0xffff0000, v9
  buffer_store_dwordx4 v[20:23], v1, s[4:7], s40 offen sc1
  v_min_u32 v2, 31, v0
  v_lshlrev_b32 v2, 2, v2
  v_add_u32 v2, 128, v2
  s_nop 1
Lpoll_1:
  buffer_load_dword v3, v2, s[12:15], 0 offen sc1
  s_sub_u32 s24, s24, 1
  s_cbranch_scc1 L_FAIL
  s_waitcnt vmcnt(0)
  v_cmp_gt_i32 vcc, 1, v3
  s_cbranch_vccz Lpolld_2
  s_sleep 2
  s_branch Lpoll_1
Lpolld_2:
  s_lshl_b32 s40, s21, 7
  s_add_u32 s40, s40, 1376256
  v_mov_b32 v2, 2147483392
  s_mov_b64 exec, 1
  v_mov_b32 v2, s40
  s_mov_b64 exec, -1
  v_mov_b32 v3, 1
  s_barrier
  s_cmp_lg_u32 s20, 0
  s_cbranch_scc1 L_MOD_done
  buffer_store_dword v3, v2, s[4:7], 0 offen sc1
L_MOD_done:
  s_cmp_lg_u32 s22, 6
  s_cbranch_scc1 L_ROLE
L_LN1:
  s_load_dwordx2 s[16:17], s[0:1], 0
  s_mov_b32 s18, 4194304
  s_mov_b32 s19, 0x20000
  s_waitcnt lgkmcnt(0)
  s_sub_u32 s43, 7, s22
  s_lshl_b32 s43, s43, 5
  s_add_u32 s43, s43, s23
  s_lshl_b32 s43, s43, 2
  s_add_u32 s43, s43, s20
  s_lshl_b32 s44, s43, 13
  s_add_u32 s45, s44, 4096
  v_lshlrev_b32 v1, 3, v0
  v_lshlrev_b32 v2, 4, v0
  buffer_load_dwordx2 v[8:9], v1, s[16:19], s44 offen offset:0 nt
  buffer_load_dwordx2 v[10:11], v1, s[16:19], s44 offen offset:512 nt
  buffer_load_dwordx2 v[12:13], v1, s[16:19], s44 offen offset:1024 nt
  buffer_load_dwordx2 v[14:15], v1, s[16:19], s44 offen offset:1536 nt
  buffer_load_dwordx2 v[16:17], v1, s[16:19], s44 offen offset:2048 nt
  buffer_load_dwordx2 v[18:19], v1, s[16:19], s44 offen offset:2560 nt
  buffer_load_dwordx2 v[20:21], v1, s[16:19], s44 offen offset:3072 nt
  buffer_load_dwordx2 v[22:23], v1, s[16:19], s44 offen offset:3584 nt
  buffer_load_dwordx2 v[24:25], v1, s[16:19], s45 offen offset:0 nt
  buffer_load_dwordx2 v[26:27], v1, s[16:19], s45 offen offset:512 nt
  buffer_load_dwordx2 v[28:29], v1, s[16:19], s45 offen offset:1024 nt
  buffer_load_dwordx2 v[30:31], v1, s[16:19], s45 offen offset:1536 nt
  buffer_load_dwordx2 v[32:33], v1, s[16:19], s45 offen offset:2048 nt
  buffer_load_dwordx2 v[34:35], v1, s[16:19], s45 offen offset:2560 nt
  buffer_load_dwordx2 v[36:37], v1, s[16:19], s45 offen offset:3072 nt
  buffer_load_dwordx2 v[38:39], v1, s[16:19], s45 offen offset:3584 nt
  s_waitcnt vmcnt(0)
  v_lshlrev_b32 v40, 16, v8
  v_and_b32 v41, 0xffff0000, v8
  v_lshlrev_b32 v42, 16, v9
  v_and_b32 v43, 0xffff0000, v9
  v_lshlrev_b32 v44, 16, v10
  v_and_b32 v45, 0xffff0000, v10
  v_lshlrev_b32 v46, 16, v11
  v_and_b32 v47, 0xffff0000, v11
  v_lshlrev_b32 v48, 16, v12
  v_and_b32 v49, 0xffff0000, v12
  v_lshlrev_b32 v50, 16, v13
  v_and_b32 v51, 0xffff0000, v13
  v_lshlrev_b32 v52, 16, v14
  v_and_b32 v53, 0xffff0000, v14
  v_lshlrev_b32 v54, 16, v15
  v_and_b32 v55, 0xffff0000, v15
  v_lshlrev_b32 v56, 16, v16
  v_and_b32 v57, 0xffff0000, v16
  v_lshlrev_b32 v58, 16, v17
  v_and_b32 v59, 0xffff0000, v17
  v_lshlrev_b32 v60, 16, v18
  v_and_b32 v61, 0xffff0000, v18
  v_lshlrev_b32 v62, 16, v19
  v_and_b32 v63, 0xffff0000, v19
  v_lshlrev_b32 v64, 16, v20
  v_and_b32 v65, 0xffff0000, v20
  v_lshlrev_b32 v66, 16, v21
  v_and_b32 v67, 0xffff0000, v21
  v_lshlrev_b32 v68, 16, v22
  v_and_b32 v69, 0xffff0000, v22
  v_lshlrev_b32 v70, 16, v23
  v_and_b32 v71, 0xffff0000, v23
  v_lshlrev_b32 v72, 16, v24
  v_and_b32 v73, 0xffff0000, v24
  v_lshlrev_b32 v74, 16, v25
  v_and_b32 v75, 0xffff0000, v25
  v_lshlrev_b32 v76, 16, v26
  v_and_b32 v77, 0xffff0000, v26
  v_lshlrev_b32 v78, 16, v27
  v_and_b32 v79, 0xffff0000, v27
  v_lshlrev_b32 v80, 16, v28
  v_and_b32 v81, 0xffff0000, v28
  v_lshlrev_b32 v82, 16, v29
  v_and_b32 v83, 0xffff0000, v29
  v_lshlrev_b32 v84, 16, v30
  v_and_b32 v85, 0xffff0000, v30
  v_lshlrev_b32 v86, 16, v31
  v_and_b32 v87, 0xffff0000, v31
  v_lshlrev_b32 v88, 16, v32
  v_and_b32 v89, 0xffff0000, v32
  v_lshlrev_b32 v90, 16, v33
  v_and_b32 v91, 0xffff0000, v33
  v_lshlrev_b32 v92, 16, v34
  v_and_b32 v93, 0xffff0000, v34
  v_lshlrev_b32 v94, 16, v35
  v_and_b32 v95, 0xffff0000, v35
  v_lshlrev_b32 v96, 16, v36
  v_and_b32 v97, 0xffff0000, v36
  v_lshlrev_b32 v98, 16, v37
  v_and_b32 v99, 0xffff0000, v37
  v_lshlrev_b32 v100, 16, v38
  v_and_b32 v101, 0xffff0000, v38
  v_lshlrev_b32 v102, 16, v39
  v_and_b32 v103, 0xffff0000, v39
  v_pk_add_f32 v[104:105], v[40:41], v[42:43]
  v_pk_add_f32 v[108:109], v[56:57], v[58:59]
  v_pk_add_f32 v[112:113], v[72:73], v[74:75]
  v_pk_add_f32 v[116:117], v[88:89], v[90:91]
  v_pk_add_f32 v[104:105], v[104:105], v[44:45]
  v_pk_add_f32 v[108:109], v[108:109], v[60:61]
  v_pk_add_f32 v[112:113], v[112:113], v[76:77]
  v_pk_add_f32 v[116:117], v[116:117], v[92:93]
  v_pk_add_f32 v[104:105], v[104:105], v[46:47]
  v_pk_add_f32 v[108:109], v[108:109], v[62:63]
  v_pk_add_f32 v[112:113], v[112:113], v[78:79]
  v_pk_add_f32 v[116:117], v[116:117], v[94:95]
  v_pk_add_f32 v[104:105], v[104:105], v[48:49]
  v_pk_add_f32 v[108:109], v[108:109], v[64:65]
  v_pk_add_f32 v[112:113], v[112:113], v[80:81]
  v_pk_add_f32 v[116:117], v[116:117], v[96:97]
  v_pk_add_f32 v[104:105], v[104:105], v[50:51]
  v_pk_add_f32 v[108:109], v[108:109], v[66:67]
  v_pk_add_f32 v[112:113], v[112:113], v[82:83]
  v_pk_add_f32 v[116:117], v[116:117], v[98:99]
  v_pk_add_f32 v[104:105], v[104:105], v[52:53]
  v_pk_add_f32 v[108:109], v[108:109], v[68:69]
  v_pk_add_f32 v[112:113], v[112:113], v[84:85]
  v_pk_add_f32 v[116:117], v[116:117], v[100:101]
  v_pk_add_f32 v[104:105], v[104:105], v[54:55]
  v_pk_add_f32 v[108:109], v[108:109], v[70:71]
  v_pk_add_f32 v[112:113], v[112:113], v[86:87]
  v_pk_add_f32 v[116:117], v[116:117], v[102:103]
  v_add_f32 v104, v104, v105
  v_add_f32 v108, v108, v109
  v_add_f32 v112, v112, v113
  v_add_f32 v116, v116, v117
  v_add_f32_dpp v104, v104, v104 row_ror:8 row_mask:0xf bank_mask:0xf
  v_add_f32_dpp v108, v108, v108 row_ror:8 row_mask:0xf bank_mask:0xf
  v_add_f32_dpp v112, v112, v112 row_ror:8 row_mask:0xf bank_mask:0xf
  v_add_f32_dpp v116, v116, v116 row_ror:8 row_mask:0xf bank_mask:0xf
  v_add_f32_dpp v104, v104, v104 row_ror:4 row_mask:0xf bank_mask:0xf
  v_add_f32_dpp v108, v108, v108 row_ror:4 row_mask:0xf bank_mask:0xf
  v_add_f32_dpp v112, v112, v112 row_ror:4 row_mask:0xf bank_mask:0xf
  v_add_f32_dpp v116, v116, v116 row_ror:4 row_mask:0xf bank_mask:0xf
  v_add_f32_dpp v104, v104, v104 row_ror:2 row_mask:0xf bank_mask:0xf
  v_add_f32_dpp v108, v108, v108 row_ror:2 row_mask:0xf bank_mask:0xf
  v_add_f32_dpp v112, v112, v112 row_ror:2 row_mask:0xf bank_mask:0xf
  v_add_f32_dpp v116, v116, v116 row_ror:2 row_mask:0xf bank_mask:0xf
  v_add_f32_dpp v104, v104, v104 row_ror:1 row_mask:0xf bank_mask:0xf
  v_add_f32_dpp v108, v108, v108 row_ror:1 row_mask:0xf bank_mask:0xf
  v_add_f32_dpp v112, v112, v112 row_ror:1 row_mask:0xf bank_mask:0xf
  v_add_f32_dpp v116, v116, v116 row_ror:1 row_mask:0xf bank_mask:0xf
  v_mov_b32 v105, v104
  v_mov_b32 v109, v108
  v_mov_b32 v113, v112
  v_mov_b32 v117, v116
  v_permlane16_swap_b32 v105, v104
  v_permlane16_swap_b32 v109, v108
  v_permlane16_swap_b32 v113, v112
  v_permlane16_swap_b32 v117, v116
  v_add_f32 v104, v104, v105
  v_add_f32 v108, v108, v109
  v_add_f32 v112, v112, v113
  v_add_f32 v116, v116, v117
  v_mov_b32 v105, v104
  v_mov_b32 v109, v108
  v_mov_b32 v113, v112
  v_mov_b32 v117, v116
  v_permlane32_swap_b32 v105, v104
  v_permlane32_swap_b32 v109, v108
  v_permlane32_swap_b32 v113, v112
  v_permlane32_swap_b32 v117, v116
  v_add_f32 v104, v104, v105
  v_add_f32 v108, v108, v109
  v_add_f32 v112, v112, v113
  v_add_f32 v116, v116, v117
  v_mul_f32 v104, 0xba800000, v104
  v_mul_f32 v108, 0xba800000, v108
  v_mul_f32 v112, 0xba800000, v112
  v_mul_f32 v116, 0xba800000, v116
  v_pk_add_f32 v[40:41], v[40:41], v[104:105] op_sel_hi:[1,0]
  v_pk_add_f32 v[56:57], v[56:57], v[108:109] op_sel_hi:[1,0]
  v_pk_add_f32 v[72:73], v[72:73], v[112:113] op_sel_hi:[1,0]
  v_pk_add_f32 v[88:89], v[88:89], v[116:117] op_sel_hi:[1,0]
  v_pk_add_f32 v[42:43], v[42:43], v[104:105] op_sel_hi:[1,0]
  v_pk_add_f32 v[58:59], v[58:59], v[108:109] op_sel_hi:[1,0]
  v_pk_add_f32 v[74:75], v[74:75], v[112:113] op_sel_hi:[1,0]
  v_pk_add_f32 v[90:91], v[90:91], v[116:117] op_sel_hi:[1,0]
  v_pk_add_f32 v[44:45], v[44:45], v[104:105] op_sel_hi:[1,0]
  v_pk_add_f32 v[60:61], v[60:61], v[108:109] op_sel_hi:[1,0]
  v_pk_add_f32 v[76:77], v[76:77], v[112:113] op_sel_hi:[1,0]
  v_pk_add_f32 v[92:93], v[92:93], v[116:117] op_sel_hi:[1,0]
  v_pk_add_f32 v[46:47], v[46:47], v[104:105] op_sel_hi:[1,0]
  v_pk_add_f32 v[62:63], v[62:63], v[108:109] op_sel_hi:[1,0]
  v_pk_add_f32 v[78:79], v[78:79], v[112:113] op_sel_hi:[1,0]
  v_pk_add_f32 v[94:95], v[94:95], v[116:117] op_sel_hi:[1,0]
  v_pk_add_f32 v[48:49], v[48:49], v[104:105] op_sel_hi:[1,0]
  v_pk_add_f32 v[64:65], v[64:65], v[108:109] op_sel_hi:[1,0]
  v_pk_add_f32 v[80:81], v[80:81], v[112:113] op_sel_hi:[1,0]
  v_pk_add_f32 v[96:97], v[96:97], v[116:117] op_sel_hi:[1,0]
  v_pk_add_f32 v[50:51], v[50:51], v[104:105] op_sel_hi:[1,0]
  v_pk_add_f32 v[66:67], v[66:67], v[108:109] op_sel_hi:[1,0]
  v_pk_add_f32 v[82:83], v[82:83], v[112:113] op_sel_hi:[1,0]
  v_pk_add_f32 v[98:99], v[98:99], v[116:117] op_sel_hi:[1,0]
  v_pk_add_f32 v[52:53], v[52:53], v[104:105] op_sel_hi:[1,0]
  v_pk_add_f32 v[68:69], v[68:69], v[108:109] op_sel_hi:[1,0]
  v_pk_add_f32 v[84:85], v[84:85], v[112:113] op_sel_hi:[1,0]
  v_pk_add_f32 v[100:101], v[100:101], v[116:117] op_sel_hi:[1,0]
  v_pk_add_f32 v[54:55], v[54:55], v[104:105] op_sel_hi:[1,0]
  v_pk_add_f32 v[70:71], v[70:71], v[108:109] op_sel_hi:[1,0]
  v_pk_add_f32 v[86:87], v[86:87], v[112:113] op_sel_hi:[1,0]
  v_pk_add_f32 v[102:103], v[102:103], v[116:117] op_sel_hi:[1,0]
  v_pk_mul_f32 v[104:105], v[40:41], v[40:41]
  v_pk_mul_f32 v[108:109], v[56:57], v[56:57]
  v_pk_mul_f32 v[112:113], v[72:73], v[72:73]
  v_pk_mul_f32 v[116:117], v[88:89], v[88:89]
  v_pk_fma_f32 v[104:105], v[42:43], v[42:43], v[104:105]
  v_pk_fma_f32 v[108:109], v[58:59], v[58:59], v[108:109]
  v_pk_fma_f32 v[112:113], v[74:75], v[74:75], v[112:113]
  v_pk_fma_f32 v[116:117], v[90:91], v[90:91], v[116:117]
  v_pk_fma_f32 v[104:105], v[44:45], v[44:45], v[104:105]
  v_pk_fma_f32 v[108:109], v[60:61], v[60:61], v[108:109]
  v_pk_fma_f32 v[112:113], v[76:77], v[76:77], v[112:113]
  v_pk_fma_f32 v[116:117], v[92:93], v[92:93], v[116:117]
  v_pk_fma_f32 v[104:105], v[46:47], v[46:47], v[104:105]
  v_pk_fma_f32 v[108:109], v[62:63], v[62:63], v[108:109]
  v_pk_fma_f32 v[112:113], v[78:79], v[78:79], v[112:113]
  v_pk_fma_f32 v[116:117], v[94:95], v[94:95], v[116:117]
  v_pk_fma_f32 v[104:105], v[48:49], v[48:49], v[104:105]
  v_pk_fma_f32 v[108:109], v[64:65], v[64:65], v[108:109]
  v_pk_fma_f32 v[112:113], v[80:81], v[80:81], v[112:113]
  v_pk_fma_f32 v[116:117], v[96:97], v[96:97], v[116:117]
  v_pk_fma_f32 v[104:105], v[50:51], v[50:51], v[104:105]
  v_pk_fma_f32 v[108:109], v[66:67], v[66:67], v[108:109]
  v_pk_fma_f32 v[112:113], v[82:83], v[82:83], v[112:113]
  v_pk_fma_f32 v[116:117], v[98:99], v[98:99], v[116:117]
  v_pk_fma_f32 v[104:105], v[52:53], v[52:53], v[104:105]
  v_pk_fma_f32 v[108:109], v[68:69], v[68:69], v[108:109]
  v_pk_fma_f32 v[112:113], v[84:85], v[84:85], v[112:113]
  v_pk_fma_f32 v[116:117], v[100:101], v[100:101], v[116:117]
  v_pk_fma_f32 v[104:105], v[54:55], v[54:55], v[104:105]
  v_pk_fma_f32 v[108:109], v[70:71], v[70:71], v[108:109]
  v_pk_fma_f32 v[112:113], v[86:87], v[86:87], v[112:113]
  v_pk_fma_f32 v[116:117], v[102:103], v[102:103], v[116:117]
  v_add_f32 v104, v104, v105
  v_add_f32 v108, v108, v109
  v_add_f32 v112, v112, v113
  v_add_f32 v116, v116, v117
  v_add_f32_dpp v104, v104, v104 row_ror:8 row_mask:0xf bank_mask:0xf
  v_add_f32_dpp v108, v108, v108 row_ror:8 row_mask:0xf bank_mask:0xf
  v_add_f32_dpp v112, v112, v112 row_ror:8 row_mask:0xf bank_mask:0xf
  v_add_f32_dpp v116, v116, v116 row_ror:8 row_mask:0xf bank_mask:0xf
  v_add_f32_dpp v104, v104, v104 row_ror:4 row_mask:0xf bank_mask:0xf
  v_add_f32_dpp v108, v108, v108 row_ror:4 row_mask:0xf bank_mask:0xf
  v_add_f32_dpp v112, v112, v112 row_ror:4 row_mask:0xf bank_mask:0xf
  v_add_f32_dpp v116, v116, v116 row_ror:4 row_mask:0xf bank_mask:0xf
  v_add_f32_dpp v104, v104, v104 row_ror:2 row_mask:0xf bank_mask:0xf
  v_add_f32_dpp v108, v108, v108 row_ror:2 row_mask:0xf bank_mask:0xf
  v_add_f32_dpp v112, v112, v112 row_ror:2 row_mask:0xf bank_mask:0xf
  v_add_f32_dpp v116, v116, v116 row_ror:2 row_mask:0xf bank_mask:0xf
  v_add_f32_dpp v104, v104, v104 row_ror:1 row_mask:0xf bank_mask:0xf
  v_add_f32_dpp v108, v108, v108 row_ror:1 row_mask:0xf bank_mask:0xf
  v_add_f32_dpp v112, v112, v112 row_ror:1 row_mask:0xf bank_mask:0xf
  v_add_f32_dpp v116, v116, v116 row_ror:1 row_mask:0xf bank_mask:0xf
  v_mov_b32 v105, v104
  v_mov_b32 v109, v108
  v_mov_b32 v113, v112
  v_mov_b32 v117, v116
  v_permlane16_swap_b32 v105, v104
  v_permlane16_swap_b32 v109, v108
  v_permlane16_swap_b32 v113, v112
  v_permlane16_swap_b32 v117, v116
  v_add_f32 v104, v104, v105
  v_add_f32 v108, v108, v109
  v_add_f32 v112, v112, v113
  v_add_f32 v116, v116, v117
  v_mov_b32 v105, v104
  v_mov_b32 v109, v108
  v_mov_b32 v113, v112
  v_mov_b32 v117, v116
  v_permlane32_swap_b32 v105, v104
  v_permlane32_swap_b32 v109, v108
  v_permlane32_swap_b32 v113, v112
  v_permlane32_swap_b32 v117, v116
  v_add_f32 v104, v104, v105
  v_add_f32 v108, v108, v109
  v_add_f32 v112, v112, v113
  v_add_f32 v116, v116, v117
  v_mul_f32 v104, 0x3a800000, v104
  v_mul_f32 v108, 0x3a800000, v108
  v_mul_f32 v112, 0x3a800000, v112
  v_mul_f32 v116, 0x3a800000, v116
  v_add_f32 v104, 0x3727c5ac, v104
  v_add_f32 v108, 0x3727c5ac, v108
  v_add_f32 v112, 0x3727c5ac, v112
  v_add_f32 v116, 0x3727c5ac, v116
  v_rsq_f32 v104, v104
  v_rsq_f32 v108, v108
  v_rsq_f32 v112, v112
  v_rsq_f32 v116, v116
  v_pk_mul_f32 v[40:41], v[40:41], v[104:105] op_sel_hi:[1,0]
  v_pk_mul_f32 v[56:57], v[56:57], v[108:109] op_sel_hi:[1,0]
  v_pk_mul_f32 v[72:73], v[72:73], v[112:113] op_sel_hi:[1,0]
  v_pk_mul_f32 v[88:89], v[88:89], v[116:117] op_sel_hi:[1,0]
  v_pk_mul_f32 v[42:43], v[42:43], v[104:105] op_sel_hi:[1,0]
  v_pk_mul_f32 v[58:59], v[58:59], v[108:109] op_sel_hi:[1,0]
  v_pk_mul_f32 v[74:75], v[74:75], v[112:113] op_sel_hi:[1,0]
  v_pk_mul_f32 v[90:91], v[90:91], v[116:117] op_sel_hi:[1,0]
  v_pk_mul_f32 v[44:45], v[44:45], v[104:105] op_sel_hi:[1,0]
  v_pk_mul_f32 v[60:61], v[60:61], v[108:109] op_sel_hi:[1,0]
  v_pk_mul_f32 v[76:77], v[76:77], v[112:113] op_sel_hi:[1,0]
  v_pk_mul_f32 v[92:93], v[92:93], v[116:117] op_sel_hi:[1,0]
  v_pk_mul_f32 v[46:47], v[46:47], v[104:105] op_sel_hi:[1,0]
  v_pk_mul_f32 v[62:63], v[62:63], v[108:109] op_sel_hi:[1,0]
  v_pk_mul_f32 v[78:79], v[78:79], v[112:113] op_sel_hi:[1,0]
  v_pk_mul_f32 v[94:95], v[94:95], v[116:117] op_sel_hi:[1,0]
  v_pk_mul_f32 v[48:49], v[48:49], v[104:105] op_sel_hi:[1,0]
  v_pk_mul_f32 v[64:65], v[64:65], v[108:109] op_sel_hi:[1,0]
  v_pk_mul_f32 v[80:81], v[80:81], v[112:113] op_sel_hi:[1,0]
  v_pk_mul_f32 v[96:97], v[96:97], v[116:117] op_sel_hi:[1,0]
  v_pk_mul_f32 v[50:51], v[50:51], v[104:105] op_sel_hi:[1,0]
  v_pk_mul_f32 v[66:67], v[66:67], v[108:109] op_sel_hi:[1,0]
  v_pk_mul_f32 v[82:83], v[82:83], v[112:113] op_sel_hi:[1,0]
  v_pk_mul_f32 v[98:99], v[98:99], v[116:117] op_sel_hi:[1,0]
  v_pk_mul_f32 v[52:53], v[52:53], v[104:105] op_sel_hi:[1,0]
  v_pk_mul_f32 v[68:69], v[68:69], v[108:109] op_sel_hi:[1,0]
  v_pk_mul_f32 v[84:85], v[84:85], v[112:113] op_sel_hi:[1,0]
  v_pk_mul_f32 v[100:101], v[100:101], v[116:117] op_sel_hi:[1,0]
  v_pk_mul_f32 v[54:55], v[54:55], v[104:105] op_sel_hi:[1,0]
  v_pk_mul_f32 v[70:71], v[70:71], v[108:109] op_sel_hi:[1,0]
  v_pk_mul_f32 v[86:87], v[86:87], v[112:113] op_sel_hi:[1,0]
  v_pk_mul_f32 v[102:103], v[102:103], v[116:117] op_sel_hi:[1,0]
  v_min_u32 v3, 31, v0
  v_lshlrev_b32 v3, 2, v3
  v_add_u32 v3, 128, v3
  s_nop 1
Lpoll_3:
  buffer_load_dword v4, v3, s[12:15], 0 offen sc1
  s_sub_u32 s24, s24, 1
  s_cbranch_scc1 L_FAIL
  s_waitcnt vmcnt(0)
  v_cmp_gt_i32 vcc, 1, v4
  s_cbranch_vccz Lpolld_4
  s_sleep 2
  s_branch Lpoll_3
Lpolld_4:
  v_min_u32 v3, 31, v0
  v_lshlrev_b32 v3, 7, v3
  v_add_u32 v3, 1376256, v3
  s_nop 1
Lpoll_5:
  buffer_load_dword v4, v3, s[4:7], 0 offen sc1
  s_sub_u32 s24, s24, 1
  s_cbranch_scc1 L_FAIL
  s_waitcnt vmcnt(0)
  v_cmp_gt_i32 vcc, 1, v4
  s_cbranch_vccz Lpolld_6
  s_sleep 2
  s_branch Lpoll_5
Lpolld_6:
  s_mov_b32 s40, 1572864
  buffer_load_dwordx4 v[136:139], v2, s[4:7], s40 offen offset:0 sc1
  buffer_load_dwordx4 v[140:143], v2, s[4:7], s40 offen offset:1024 sc1
  buffer_load_dwordx4 v[144:147], v2, s[4:7], s40 offen offset:2048 sc1
  buffer_load_dwordx4 v[148:151], v2, s[4:7], s40 offen offset:3072 sc1
  s_mov_b32 s40, 1576960
  buffer_load_dwordx4 v[120:123], v2, s[4:7], s40 offen offset:0 sc1
  buffer_load_dwordx4 v[124:127], v2, s[4:7], s40 offen offset:1024 sc1
  buffer_load_dwordx4 v[128:131], v2, s[4:7], s40 offen offset:2048 sc1
  buffer_load_dwordx4 v[132:135], v2, s[4:7], s40 offen offset:3072 sc1
  s_waitcnt vmcnt(0)
  v_add_f32 v120, 1.0, v120
  v_add_f32 v121, 1.0, v121
  v_add_f32 v122, 1.0, v122
  v_add_f32 v123, 1.0, v123
  v_add_f32 v124, 1.0, v124
  v_add_f32 v125, 1.0, v125
  v_add_f32 v126, 1.0, v126
  v_add_f32 v127, 1.0, v127
  v_add_f32 v128, 1.0, v128
  v_add_f32 v129, 1.0, v129
  v_add_f32 v130, 1.0, v130
  v_add_f32 v131, 1.0, v131
  v_add_f32 v132, 1.0, v132
  v_add_f32 v133, 1.0, v133
  v_add_f32 v134, 1.0, v134
  v_add_f32 v135, 1.0, v135
  s_add_u32 s44, s44, 2097152
  s_add_u32 s45, s45, 2097152
  v_pk_fma_f32 v[40:41], v[40:41], v[120:121], v[136:137]
  v_pk_fma_f32 v[42:43], v[42:43], v[122:123], v[138:139]
  v_pk_fma_f32 v[44:45], v[44:45], v[124:125], v[140:141]
  v_pk_fma_f32 v[46:47], v[46:47], v[126:127], v[142:143]
  v_pk_fma_f32 v[48:49], v[48:49], v[128:129], v[144:145]
  v_pk_fma_f32 v[50:51], v[50:51], v[130:131], v[146:147]
  v_pk_fma_f32 v[52:53], v[52:53], v[132:133], v[148:149]
  v_pk_fma_f32 v[54:55], v[54:55], v[134:135], v[150:151]
  v_cvt_pk_bf16_f32 v8, v40, v41
  v_cvt_pk_bf16_f32 v9, v42, v43
  v_cvt_pk_bf16_f32 v10, v44, v45
  v_cvt_pk_bf16_f32 v11, v46, v47
  v_cvt_pk_bf16_f32 v12, v48, v49
  v_cvt_pk_bf16_f32 v13, v50, v51
  v_cvt_pk_bf16_f32 v14, v52, v53
  v_cvt_pk_bf16_f32 v15, v54, v55
  buffer_store_dwordx4 v[8:11], v2, s[4:7], s44 offen offset:0 sc1
  buffer_store_dwordx4 v[12:15], v2, s[4:7], s44 offen offset:1024 sc1
  v_pk_fma_f32 v[56:57], v[56:57], v[120:121], v[136:137]
  v_pk_fma_f32 v[58:59], v[58:59], v[122:123], v[138:139]
  v_pk_fma_f32 v[60:61], v[60:61], v[124:125], v[140:141]
  v_pk_fma_f32 v[62:63], v[62:63], v[126:127], v[142:143]
  v_pk_fma_f32 v[64:65], v[64:65], v[128:129], v[144:145]
  v_pk_fma_f32 v[66:67], v[66:67], v[130:131], v[146:147]
  v_pk_fma_f32 v[68:69], v[68:69], v[132:133], v[148:149]
  v_pk_fma_f32 v[70:71], v[70:71], v[134:135], v[150:151]
  v_cvt_pk_bf16_f32 v16, v56, v57
  v_cvt_pk_bf16_f32 v17, v58, v59
  v_cvt_pk_bf16_f32 v18, v60, v61
  v_cvt_pk_bf16_f32 v19, v62, v63
  v_cvt_pk_bf16_f32 v20, v64, v65
  v_cvt_pk_bf16_f32 v21, v66, v67
  v_cvt_pk_bf16_f32 v22, v68, v69
  v_cvt_pk_bf16_f32 v23, v70, v71
  buffer_store_dwordx4 v[16:19], v2, s[4:7], s44 offen offset:2048 sc1
  buffer_store_dwordx4 v[20:23], v2, s[4:7], s44 offen offset:3072 sc1
  v_pk_fma_f32 v[72:73], v[72:73], v[120:121], v[136:137]
  v_pk_fma_f32 v[74:75], v[74:75], v[122:123], v[138:139]
  v_pk_fma_f32 v[76:77], v[76:77], v[124:125], v[140:141]
  v_pk_fma_f32 v[78:79], v[78:79], v[126:127], v[142:143]
  v_pk_fma_f32 v[80:81], v[80:81], v[128:129], v[144:145]
  v_pk_fma_f32 v[82:83], v[82:83], v[130:131], v[146:147]
  v_pk_fma_f32 v[84:85], v[84:85], v[132:133], v[148:149]
  v_pk_fma_f32 v[86:87], v[86:87], v[134:135], v[150:151]
  v_cvt_pk_bf16_f32 v24, v72, v73
  v_cvt_pk_bf16_f32 v25, v74, v75
  v_cvt_pk_bf16_f32 v26, v76, v77
  v_cvt_pk_bf16_f32 v27, v78, v79
  v_cvt_pk_bf16_f32 v28, v80, v81
  v_cvt_pk_bf16_f32 v29, v82, v83
  v_cvt_pk_bf16_f32 v30, v84, v85
  v_cvt_pk_bf16_f32 v31, v86, v87
  buffer_store_dwordx4 v[24:27], v2, s[4:7], s45 offen offset:0 sc1
  buffer_store_dwordx4 v[28:31], v2, s[4:7], s45 offen offset:1024 sc1
  v_pk_fma_f32 v[88:89], v[88:89], v[120:121], v[136:137]
  v_pk_fma_f32 v[90:91], v[90:91], v[122:123], v[138:139]
  v_pk_fma_f32 v[92:93], v[92:93], v[124:125], v[140:141]
  v_pk_fma_f32 v[94:95], v[94:95], v[126:127], v[142:143]
  v_pk_fma_f32 v[96:97], v[96:97], v[128:129], v[144:145]
  v_pk_fma_f32 v[98:99], v[98:99], v[130:131], v[146:147]
  v_pk_fma_f32 v[100:101], v[100:101], v[132:133], v[148:149]
  v_pk_fma_f32 v[102:103], v[102:103], v[134:135], v[150:151]
  v_cvt_pk_bf16_f32 v32, v88, v89
  v_cvt_pk_bf16_f32 v33, v90, v91
  v_cvt_pk_bf16_f32 v34, v92, v93
  v_cvt_pk_bf16_f32 v35, v94, v95
  v_cvt_pk_bf16_f32 v36, v96, v97
  v_cvt_pk_bf16_f32 v37, v98, v99
  v_cvt_pk_bf16_f32 v38, v100, v101
  v_cvt_pk_bf16_f32 v39, v102, v103
  buffer_store_dwordx4 v[32:35], v2, s[4:7], s45 offen offset:2048 sc1
  buffer_store_dwordx4 v[36:39], v2, s[4:7], s45 offen offset:3072 sc1
  s_lshr_b32 s40, s43, 3
  s_lshl_b32 s40, s40, 7
  s_and_b32 s41, s43, 7
  s_lshl_b32 s41, s41, 2
  s_add_u32 s40, s40, s41
  s_add_u32 s40, s40, 1388544
  v_mov_b32 v3, 2147483392
  s_mov_b64 exec, 1
  v_mov_b32 v3, s40
  s_mov_b64 exec, -1
  v_mov_b32 v4, 1
  s_waitcnt vmcnt(0)
  buffer_store_dword v4, v3, s[4:7], 0 offen sc1
  s_mov_b32 s40, 1396736
  s_cmp_lt_u32 s22, 6
  s_cselect_b32 s40, 1424384, s40
  v_mov_b32 v1, s40
  s_nop 1
Lpoll_7:
  buffer_load_dword v2, v1, s[4:7], 0 offen sc1
  s_sub_u32 s24, s24, 1
  s_cbranch_scc1 L_FAIL
  s_waitcnt vmcnt(0)
  v_cmp_gt_i32 vcc, 0, v2
  s_cbranch_vccz Lpolld_8
  s_sleep 8
  s_branch Lpoll_7
Lpolld_8:
  s_sub_u32 s40, s22, 3
  s_lshl_b32 s40, s40, 5
  s_add_u32 s21, s40, s23
  s_cmp_lt_u32 s22, 6
  s_cbranch_scc1 L_MOD
L_ROLE:
  s_mov_b32 s43, 32
  s_cmp_eq_u32 s22, 7
  s_cselect_b32 s43, 24, s43
  s_sub_u32 s40, s22, 5
  s_cmp_lt_u32 s40, 2
  s_cselect_b32 s43, 28, s43
  s_cmp_lt_u32 s23, s43
  s_cbranch_scc1 L_HEAVY
  s_sub_u32 s21, s23, s43
  s_cmp_eq_u32 s22, 7
  s_cbranch_scc1 L_FIN
  s_lshl_b32 s40, s40, 2
  s_add_u32 s21, s21, s40
  s_branch L_LN2
L_HEAVY:
  s_mov_b32 s21, s23
  s_cmp_eq_u32 s22, 4
  s_cbranch_scc1 L_WO
  s_cmp_eq_u32 s22, 7
  s_cbranch_scc1 L_F2
  s_sub_u32 s40, s22, 5
  s_mul_i32 s40, s40, 28
  s_add_u32 s21, s21, s40
  s_branch L_F1
L_FAIL:
  s_mov_b64 exec, -1
  s_lshl_b32 s40, s2, 8
  s_add_u32 s40, s40, s25
  s_add_u32 s40, s40, 0x70000000
  v_mov_b32 v1, 60
  v_mov_b32 v2, s40
  buffer_store_dword v2, v1, s[12:15], 0 offen
L_END:
  s_endpgm
L_LN2:
  s_load_dwordx2 s[16:17], s[0:1], 0
  s_mov_b32 s18, 4194304
  s_mov_b32 s19, 0x20000
  s_waitcnt lgkmcnt(0)
  s_lshr_b32 s25, s21, 2
  s_add_u32 s29, s25, 1
  s_lshl_b32 s26, s25, 16
  s_mul_i32 s27, s25, 262144
  s_add_u32 s27, s27, 109051904
  s_and_b32 s43, s21, 3
  s_lshr_b32 s40, s43, 1
  s_lshl_b32 s40, s40, 10
  s_and_b32 s41, s43, 1
  s_lshl_b32 s41, s41, 7
  s_add_u32 s40, s40, s41
  s_lshl_b32 s41, s20, 14
  s_add_u32 s40, s40, s41
  v_and_b32 v6, 7, v0
  v_lshl_add_u32 v1, v6, 4, s40
  v_bfe_u32 v7, v0, 3, 2
  v_lshl_add_u32 v1, v7, 8, v1
  v_lshrrev_b32 v7, 5, v0
  v_lshl_add_u32 v1, v7, 11, v1
  v_lshrrev_b32 v8, 3, v0
  s_lshl_b32 s40, s20, 10
  v_lshl_add_u32 v5, v8, 4, s40
  s_lshl_b32 s40, s43, 14
  s_lshl_b32 s41, s20, 9
  s_add_u32 s40, s40, s41
  v_and_b32 v9, 31, v0
  v_lshl_add_u32 v10, v9, 4, s40
  v_lshl_add_u32 v10, v7, 11, v10
  v_min_u32 v2, 63, v0
  v_lshlrev_b32 v2, 7, v2
  v_add_u32 v2, 1380352, v2
  s_nop 1
Lpoll_9:
  buffer_load_dword v3, v2, s[4:7], 0 offen sc1
  s_sub_u32 s24, s24, 1
  s_cbranch_scc1 L_FAIL
  s_waitcnt vmcnt(0)
  v_cmp_gt_i32 vcc, 1, v3
  s_cbranch_vccz Lpolld_10
  s_sleep 2
  s_branch Lpoll_9
Lpolld_10:
  s_mov_b32 s40, 1581056
  buffer_load_dwordx4 v[48:51], v5, s[4:7], s40 offen offset:0 sc1
  buffer_load_dwordx4 v[52:55], v5, s[4:7], s40 offen offset:256 sc1
  buffer_load_dwordx4 v[56:59], v5, s[4:7], s40 offen offset:128 sc1
  buffer_load_dwordx4 v[60:63], v5, s[4:7], s40 offen offset:384 sc1
  buffer_load_dwordx4 v[64:67], v5, s[4:7], s40 offen offset:512 sc1
  buffer_load_dwordx4 v[68:71], v5, s[4:7], s40 offen offset:768 sc1
  buffer_load_dwordx4 v[72:75], v5, s[4:7], s40 offen offset:640 sc1
  buffer_load_dwordx4 v[76:79], v5, s[4:7], s40 offen offset:896 sc1
  s_mov_b32 s40, 1585152
  buffer_load_dwordx4 v[80:83], v5, s[4:7], s40 offen offset:0 sc1
  buffer_load_dwordx4 v[84:87], v5, s[4:7], s40 offen offset:256 sc1
  buffer_load_dwordx4 v[88:91], v5, s[4:7], s40 offen offset:128 sc1
  buffer_load_dwordx4 v[92:95], v5, s[4:7], s40 offen offset:384 sc1
  buffer_load_dwordx4 v[96:99], v5, s[4:7], s40 offen offset:512 sc1
  buffer_load_dwordx4 v[100:103], v5, s[4:7], s40 offen offset:768 sc1
  buffer_load_dwordx4 v[104:107], v5, s[4:7], s40 offen offset:640 sc1
  buffer_load_dwordx4 v[108:111], v5, s[4:7], s40 offen offset:896 sc1
  s_mov_b32 s40, 1589248
  buffer_load_dwordx4 v[112:115], v5, s[4:7], s40 offen offset:0 sc1
  buffer_load_dwordx4 v[116:119], v5, s[4:7], s40 offen offset:256 sc1
  buffer_load_dwordx4 v[120:123], v5, s[4:7], s40 offen offset:128 sc1
  buffer_load_dwordx4 v[124:127], v5, s[4:7], s40 offen offset:384 sc1
  buffer_load_dwordx4 v[128:131], v5, s[4:7], s40 offen offset:512 sc1
  buffer_load_dwordx4 v[132:135], v5, s[4:7], s40 offen offset:768 sc1
  buffer_load_dwordx4 v[136:139], v5, s[4:7], s40 offen offset:640 sc1
  buffer_load_dwordx4 v[140:143], v5, s[4:7], s40 offen offset:896 sc1
  s_waitcnt vmcnt(0)
  v_add_f32 v112, 1.0, v112
  v_add_f32 v113, 1.0, v113
  v_add_f32 v114, 1.0, v114
  v_add_f32 v115, 1.0, v115
  v_add_f32 v116, 1.0, v116
  v_add_f32 v117, 1.0, v117
  v_add_f32 v118, 1.0, v118
  v_add_f32 v119, 1.0, v119
  v_add_f32 v120, 1.0, v120
  v_add_f32 v121, 1.0, v121
  v_add_f32 v122, 1.0, v122
  v_add_f32 v123, 1.0, v123
  v_add_f32 v124, 1.0, v124
  v_add_f32 v125, 1.0, v125
  v_add_f32 v126, 1.0, v126
  v_add_f32 v127, 1.0, v127
  v_add_f32 v128, 1.0, v128
  v_add_f32 v129, 1.0, v129
  v_add_f32 v130, 1.0, v130
  v_add_f32 v131, 1.0, v131
  v_add_f32 v132, 1.0, v132
  v_add_f32 v133, 1.0, v133
  v_add_f32 v134, 1.0, v134
  v_add_f32 v135, 1.0, v135
  v_add_f32 v136, 1.0, v136
  v_add_f32 v137, 1.0, v137
  v_add_f32 v138, 1.0, v138
  v_add_f32 v139, 1.0, v139
  v_add_f32 v140, 1.0, v140
  v_add_f32 v141, 1.0, v141
  v_add_f32 v142, 1.0, v142
  v_add_f32 v143, 1.0, v143
  v_min_u32 v2, 31, v0
  v_lshlrev_b32 v2, 7, v2
  v_add_u32 v2, 1409024, v2
  s_lshl_b32 s62, s21, 7
  s_add_u32 s62, s62, 1413120
  s_lshl_b32 s30, s20, 12
  v_lshl_add_u32 v11, v6, 9, s30
  v_lshl_add_u32 v11, v8, 3, v11
  s_lshl_b32 s40, s20, 6
  s_add_u32 s40, s40, 16384
  v_lshl_add_u32 v12, v6, 3, s40
  v_lshlrev_b32 v13, 3, v6
  v_add_u32 v13, 16384, v13
  s_nop 1
L_LN2_top:
  s_add_u32 m0, s30, 0
  s_add_u32 s40, s26, 0
  buffer_load_dwordx4 v10, s[16:19], s40 offen lds
  s_add_u32 m0, s30, 1024
  s_add_u32 s40, s26, 4096
  buffer_load_dwordx4 v10, s[16:19], s40 offen lds
  s_add_u32 m0, s30, 2048
  s_add_u32 s40, s26, 8192
  buffer_load_dwordx4 v10, s[16:19], s40 offen lds
  s_add_u32 m0, s30, 3072
  s_add_u32 s40, s26, 12288
  buffer_load_dwordx4 v10, s[16:19], s40 offen lds
  s_waitcnt vmcnt(0)
  ds_read_b64 v[16:17], v11 offset:0
  ds_read_b64 v[18:19], v11 offset:128
  ds_read_b64 v[20:21], v11 offset:64
  ds_read_b64 v[22:23], v11 offset:192
  ds_read_b64 v[24:25], v11 offset:256
  ds_read_b64 v[26:27], v11 offset:384
  ds_read_b64 v[28:29], v11 offset:320
  ds_read_b64 v[30:31], v11 offset:448
  s_waitcnt lgkmcnt(0)
  v_lshlrev_b32 v144, 16, v16
  v_and_b32 v145, 0xffff0000, v16
  v_lshlrev_b32 v146, 16, v17
  v_and_b32 v147, 0xffff0000, v17
  v_lshlrev_b32 v148, 16, v18
  v_and_b32 v149, 0xffff0000, v18
  v_lshlrev_b32 v150, 16, v19
  v_and_b32 v151, 0xffff0000, v19
  v_lshlrev_b32 v152, 16, v20
  v_and_b32 v153, 0xffff0000, v20
  v_lshlrev_b32 v154, 16, v21
  v_and_b32 v155, 0xffff0000, v21
  v_lshlrev_b32 v156, 16, v22
  v_and_b32 v157, 0xffff0000, v22
  v_lshlrev_b32 v158, 16, v23
  v_and_b32 v159, 0xffff0000, v23
  v_lshlrev_b32 v160, 16, v24
  v_and_b32 v161, 0xffff0000, v24
  v_lshlrev_b32 v162, 16, v25
  v_and_b32 v163, 0xffff0000, v25
  v_lshlrev_b32 v164, 16, v26
  v_and_b32 v165, 0xffff0000, v26
  v_lshlrev_b32 v166, 16, v27
  v_and_b32 v167, 0xffff0000, v27
  v_lshlrev_b32 v168, 16, v28
  v_and_b32 v169, 0xffff0000, v28
  v_lshlrev_b32 v170, 16, v29
  v_and_b32 v171, 0xffff0000, v29
  v_lshlrev_b32 v172, 16, v30
  v_and_b32 v173, 0xffff0000, v30
  v_lshlrev_b32 v174, 16, v31
  v_and_b32 v175, 0xffff0000, v31
  s_nop 1
Lpoll_11:
  buffer_load_dword v3, v2, s[4:7], 0 offen sc1
  s_sub_u32 s24, s24, 1
  s_cbranch_scc1 L_FAIL
  s_waitcnt vmcnt(0)
  v_cmp_gt_i32 vcc, s29, v3
  s_cbranch_vccz Lpolld_12
  s_sleep 1
  s_branch Lpoll_11
Lpolld_12:
  s_add_u32 s40, s27, 0
  buffer_load_dwordx4 v[192:195], v1, s[4:7], s40 offen sc1
  s_add_u32 s40, s27, 4096
  buffer_load_dwordx4 v[196:199], v1, s[4:7], s40 offen sc1
  s_add_u32 s40, s27, 8192
  buffer_load_dwordx4 v[200:203], v1, s[4:7], s40 offen sc1
  s_add_u32 s40, s27, 12288
  buffer_load_dwordx4 v[204:207], v1, s[4:7], s40 offen sc1
  s_add_u32 s40, s27, 65536
  buffer_load_dwordx4 v[208:211], v1, s[4:7], s40 offen sc1
  s_add_u32 s40, s27, 69632
  buffer_load_dwordx4 v[212:215], v1, s[4:7], s40 offen sc1
  s_add_u32 s40, s27, 73728
  buffer_load_dwordx4 v[216:219], v1, s[4:7], s40 offen sc1
  s_add_u32 s40, s27, 77824
  buffer_load_dwordx4 v[220:223], v1, s[4:7], s40 offen sc1
  s_add_u32 s40, s27, 131072
  buffer_load_dwordx4 v[224:227], v1, s[4:7], s40 offen sc1
  s_add_u32 s40, s27, 135168
  buffer_load_dwordx4 v[228:231], v1, s[4:7], s40 offen sc1
  s_add_u32 s40, s27, 139264
  buffer_load_dwordx4 v[232:235], v1, s[4:7], s40 offen sc1
  s_add_u32 s40, s27, 143360
  buffer_load_dwordx4 v[236:239], v1, s[4:7], s40 offen sc1
  s_add_u32 s40, s27, 196608
  buffer_load_dwordx4 v[240:243], v1, s[4:7], s40 offen sc1
  s_add_u32 s40, s27, 200704
  buffer_load_dwordx4 v[244:247], v1, s[4:7], s40 offen sc1
  s_add_u32 s40, s27, 204800
  buffer_load_dwordx4 v[248:251], v1, s[4:7], s40 offen sc1
  s_add_u32 s40, s27, 208896
  buffer_load_dwordx4 v[252:255], v1, s[4:7], s40 offen sc1
  s_waitcnt vmcnt(15)
  v_lshlrev_b32 v176, 16, v192
  v_and_b32 v177, 0xffff0000, v192
  v_lshlrev_b32 v178, 16, v193
  v_and_b32 v179, 0xffff0000, v193
  v_lshlrev_b32 v180, 16, v194
  v_and_b32 v181, 0xffff0000, v194
  v_lshlrev_b32 v182, 16, v195
  v_and_b32 v183, 0xffff0000, v195
  v_pk_fma_f32 v[144:145], v[176:177], v[48:49], v[144:145]
  v_pk_fma_f32 v[146:147], v[178:179], v[50:51], v[146:147]
  v_pk_fma_f32 v[148:149], v[180:181], v[52:53], v[148:149]
  v_pk_fma_f32 v[150:151], v[182:183], v[54:55], v[150:151]
  s_waitcnt vmcnt(14)
  v_lshlrev_b32 v184, 16, v196
  v_and_b32 v185, 0xffff0000, v196
  v_lshlrev_b32 v186, 16, v197
  v_and_b32 v187, 0xffff0000, v197
  v_lshlrev_b32 v188, 16, v198
  v_and_b32 v189, 0xffff0000, v198
  v_lshlrev_b32 v190, 16, v199
  v_and_b32 v191, 0xffff0000, v199
  v_pk_fma_f32 v[152:153], v[184:185], v[56:57], v[152:153]
  v_pk_fma_f32 v[154:155], v[186:187], v[58:59], v[154:155]
  v_pk_fma_f32 v[156:157], v[188:189], v[60:61], v[156:157]
  v_pk_fma_f32 v[158:159], v[190:191], v[62:63], v[158:159]
  s_waitcnt vmcnt(13)
  v_lshlrev_b32 v176, 16, v200
  v_and_b32 v177, 0xffff0000, v200
  v_lshlrev_b32 v178, 16, v201
  v_and_b32 v179, 0xffff0000, v201
  v_lshlrev_b32 v180, 16, v202
  v_and_b32 v181, 0xffff0000, v202
  v_lshlrev_b32 v182, 16, v203
  v_and_b32 v183, 0xffff0000, v203
  v_pk_fma_f32 v[160:161], v[176:177], v[64:65], v[160:161]
  v_pk_fma_f32 v[162:163], v[178:179], v[66:67], v[162:163]
  v_pk_fma_f32 v[164:165], v[180:181], v[68:69], v[164:165]
  v_pk_fma_f32 v[166:167], v[182:183], v[70:71], v[166:167]
  s_waitcnt vmcnt(12)
  v_lshlrev_b32 v184, 16, v204
  v_and_b32 v185, 0xffff0000, v204
  v_lshlrev_b32 v186, 16, v205
  v_and_b32 v187, 0xffff0000, v205
  v_lshlrev_b32 v188, 16, v206
  v_and_b32 v189, 0xffff0000, v206
  v_lshlrev_b32 v190, 16, v207
  v_and_b32 v191, 0xffff0000, v207
  v_pk_fma_f32 v[168:169], v[184:185], v[72:73], v[168:169]
  v_pk_fma_f32 v[170:171], v[186:187], v[74:75], v[170:171]
  v_pk_fma_f32 v[172:173], v[188:189], v[76:77], v[172:173]
  v_pk_fma_f32 v[174:175], v[190:191], v[78:79], v[174:175]
  s_waitcnt vmcnt(11)
  v_lshlrev_b32 v176, 16, v208
  v_and_b32 v177, 0xffff0000, v208
  v_lshlrev_b32 v178, 16, v209
  v_and_b32 v179, 0xffff0000, v209
  v_lshlrev_b32 v180, 16, v210
  v_and_b32 v181, 0xffff0000, v210
  v_lshlrev_b32 v182, 16, v211
  v_and_b32 v183, 0xffff0000, v211
  v_pk_fma_f32 v[144:145], v[176:177], v[48:49], v[144:145]
  v_pk_fma_f32 v[146:147], v[178:179], v[50:51], v[146:147]
  v_pk_fma_f32 v[148:149], v[180:181], v[52:53], v[148:149]
  v_pk_fma_f32 v[150:151], v[182:183], v[54:55], v[150:151]
  s_waitcnt vmcnt(10)
  v_lshlrev_b32 v184, 16, v212
  v_and_b32 v185, 0xffff0000, v212
  v_lshlrev_b32 v186, 16, v213
  v_and_b32 v187, 0xffff0000, v213
  v_lshlrev_b32 v188, 16, v214
  v_and_b32 v189, 0xffff0000, v214
  v_lshlrev_b32 v190, 16, v215
  v_and_b32 v191, 0xffff0000, v215
  v_pk_fma_f32 v[152:153], v[184:185], v[56:57], v[152:153]
  v_pk_fma_f32 v[154:155], v[186:187], v[58:59], v[154:155]
  v_pk_fma_f32 v[156:157], v[188:189], v[60:61], v[156:157]
  v_pk_fma_f32 v[158:159], v[190:191], v[62:63], v[158:159]
  s_waitcnt vmcnt(9)
  v_lshlrev_b32 v176, 16, v216
  v_and_b32 v177, 0xffff0000, v216
  v_lshlrev_b32 v178, 16, v217
  v_and_b32 v179, 0xffff0000, v217
  v_lshlrev_b32 v180, 16, v218
  v_and_b32 v181, 0xffff0000, v218
  v_lshlrev_b32 v182, 16, v219
  v_and_b32 v183, 0xffff0000, v219
  v_pk_fma_f32 v[160:161], v[176:177], v[64:65], v[160:161]
  v_pk_fma_f32 v[162:163], v[178:179], v[66:67], v[162:163]
  v_pk_fma_f32 v[164:165], v[180:181], v[68:69], v[164:165]
  v_pk_fma_f32 v[166:167], v[182:183], v[70:71], v[166:167]
  s_waitcnt vmcnt(8)
  v_lshlrev_b32 v184, 16, v220
  v_and_b32 v185, 0xffff0000, v220
  v_lshlrev_b32 v186, 16, v221
  v_and_b32 v187, 0xffff0000, v221
  v_lshlrev_b32 v188, 16, v222
  v_and_b32 v189, 0xffff0000, v222
  v_lshlrev_b32 v190, 16, v223
  v_and_b32 v191, 0xffff0000, v223
  v_pk_fma_f32 v[168:169], v[184:185], v[72:73], v[168:169]
  v_pk_fma_f32 v[170:171], v[186:187], v[74:75], v[170:171]
  v_pk_fma_f32 v[172:173], v[188:189], v[76:77], v[172:173]
  v_pk_fma_f32 v[174:175], v[190:191], v[78:79], v[174:175]
  s_waitcnt vmcnt(7)
  v_lshlrev_b32 v176, 16, v224
  v_and_b32 v177, 0xffff0000, v224
  v_lshlrev_b32 v178, 16, v225
  v_and_b32 v179, 0xffff0000, v225
  v_lshlrev_b32 v180, 16, v226
  v_and_b32 v181, 0xffff0000, v226
  v_lshlrev_b32 v182, 16, v227
  v_and_b32 v183, 0xffff0000, v227
  v_pk_fma_f32 v[144:145], v[176:177], v[48:49], v[144:145]
  v_pk_fma_f32 v[146:147], v[178:179], v[50:51], v[146:147]
  v_pk_fma_f32 v[148:149], v[180:181], v[52:53], v[148:149]
  v_pk_fma_f32 v[150:151], v[182:183], v[54:55], v[150:151]
  s_waitcnt vmcnt(6)
  v_lshlrev_b32 v184, 16, v228
  v_and_b32 v185, 0xffff0000, v228
  v_lshlrev_b32 v186, 16, v229
  v_and_b32 v187, 0xffff0000, v229
  v_lshlrev_b32 v188, 16, v230
  v_and_b32 v189, 0xffff0000, v230
  v_lshlrev_b32 v190, 16, v231
  v_and_b32 v191, 0xffff0000, v231
  v_pk_fma_f32 v[152:153], v[184:185], v[56:57], v[152:153]
  v_pk_fma_f32 v[154:155], v[186:187], v[58:59], v[154:155]
  v_pk_fma_f32 v[156:157], v[188:189], v[60:61], v[156:157]
  v_pk_fma_f32 v[158:159], v[190:191], v[62:63], v[158:159]
  s_waitcnt vmcnt(5)
  v_lshlrev_b32 v176, 16, v232
  v_and_b32 v177, 0xffff0000, v232
  v_lshlrev_b32 v178, 16, v233
  v_and_b32 v179, 0xffff0000, v233
  v_lshlrev_b32 v180, 16, v234
  v_and_b32 v181, 0xffff0000, v234
  v_lshlrev_b32 v182, 16, v235
  v_and_b32 v183, 0xffff0000, v235
  v_pk_fma_f32 v[160:161], v[176:177], v[64:65], v[160:161]
  v_pk_fma_f32 v[162:163], v[178:179], v[66:67], v[162:163]
  v_pk_fma_f32 v[164:165], v[180:181], v[68:69], v[164:165]
  v_pk_fma_f32 v[166:167], v[182:183], v[70:71], v[166:167]
  s_waitcnt vmcnt(4)
  v_lshlrev_b32 v184, 16, v236
  v_and_b32 v185, 0xffff0000, v236
  v_lshlrev_b32 v186, 16, v237
  v_and_b32 v187, 0xffff0000, v237
  v_lshlrev_b32 v188, 16, v238
  v_and_b32 v189, 0xffff0000, v238
  v_lshlrev_b32 v190, 16, v239
  v_and_b32 v191, 0xffff0000, v239
  v_pk_fma_f32 v[168:169], v[184:185], v[72:73], v[168:169]
  v_pk_fma_f32 v[170:171], v[186:187], v[74:75], v[170:171]
  v_pk_fma_f32 v[172:173], v[188:189], v[76:77], v[172:173]
  v_pk_fma_f32 v[174:175], v[190:191], v[78:79], v[174:175]
  s_waitcnt vmcnt(3)
  v_lshlrev_b32 v176, 16, v240
  v_and_b32 v177, 0xffff0000, v240
  v_lshlrev_b32 v178, 16, v241
  v_and_b32 v179, 0xffff0000, v241
  v_lshlrev_b32 v180, 16, v242
  v_and_b32 v181, 0xffff0000, v242
  v_lshlrev_b32 v182, 16, v243
  v_and_b32 v183, 0xffff0000, v243
  v_pk_fma_f32 v[144:145], v[176:177], v[48:49], v[144:145]
  v_pk_fma_f32 v[146:147], v[178:179], v[50:51], v[146:147]
  v_pk_fma_f32 v[148:149], v[180:181], v[52:53], v[148:149]
  v_pk_fma_f32 v[150:151], v[182:183], v[54:55], v[150:151]
  s_waitcnt vmcnt(2)
  v_lshlrev_b32 v184, 16, v244
  v_and_b32 v185, 0xffff0000, v244
  v_lshlrev_b32 v186, 16, v245
  v_and_b32 v187, 0xffff0000, v245
  v_lshlrev_b32 v188, 16, v246
  v_and_b32 v189, 0xffff0000, v246
  v_lshlrev_b32 v190, 16, v247
  v_and_b32 v191, 0xffff0000, v247
  v_pk_fma_f32 v[152:153], v[184:185], v[56:57], v[152:153]
  v_pk_fma_f32 v[154:155], v[186:187], v[58:59], v[154:155]
  v_pk_fma_f32 v[156:157], v[188:189], v[60:61], v[156:157]
  v_pk_fma_f32 v[158:159], v[190:191], v[62:63], v[158:159]
  s_waitcnt vmcnt(1)
  v_lshlrev_b32 v176, 16, v248
  v_and_b32 v177, 0xffff0000, v248
  v_lshlrev_b32 v178, 16, v249
  v_and_b32 v179, 0xffff0000, v249
  v_lshlrev_b32 v180, 16, v250
  v_and_b32 v181, 0xffff0000, v250
  v_lshlrev_b32 v182, 16, v251
  v_and_b32 v183, 0xffff0000, v251
  v_pk_fma_f32 v[160:161], v[176:177], v[64:65], v[160:161]
  v_pk_fma_f32 v[162:163], v[178:179], v[66:67], v[162:163]
  v_pk_fma_f32 v[164:165], v[180:181], v[68:69], v[164:165]
  v_pk_fma_f32 v[166:167], v[182:183], v[70:71], v[166:167]
  s_waitcnt vmcnt(0)
  v_lshlrev_b32 v184, 16, v252
  v_and_b32 v185, 0xffff0000, v252
  v_lshlrev_b32 v186, 16, v253
  v_and_b32 v187, 0xffff0000, v253
  v_lshlrev_b32 v188, 16, v254
  v_and_b32 v189, 0xffff0000, v254
  v_lshlrev_b32 v190, 16, v255
  v_and_b32 v191, 0xffff0000, v255
  v_pk_fma_f32 v[168:169], v[184:185], v[72:73], v[168:169]
  v_pk_fma_f32 v[170:171], v[186:187], v[74:75], v[170:171]
  v_pk_fma_f32 v[172:173], v[188:189], v[76:77], v[172:173]
  v_pk_fma_f32 v[174:175], v[190:191], v[78:79], v[174:175]
  v_cvt_pk_bf16_f32 v16, v144, v145
  v_cvt_pk_bf16_f32 v17, v146, v147
  v_cvt_pk_bf16_f32 v18, v148, v149
  v_cvt_pk_bf16_f32 v19, v150, v151
  v_cvt_pk_bf16_f32 v20, v152, v153
  v_cvt_pk_bf16_f32 v21, v154, v155
  v_cvt_pk_bf16_f32 v22, v156, v157
  v_cvt_pk_bf16_f32 v23, v158, v159
  v_cvt_pk_bf16_f32 v24, v160, v161
  v_cvt_pk_bf16_f32 v25, v162, v163
  v_cvt_pk_bf16_f32 v26, v164, v165
  v_cvt_pk_bf16_f32 v27, v166, v167
  v_cvt_pk_bf16_f32 v28, v168, v169
  v_cvt_pk_bf16_f32 v29, v170, v171
  v_cvt_pk_bf16_f32 v30, v172, v173
  v_cvt_pk_bf16_f32 v31, v174, v175
  v_pk_add_f32 v[32:33], v[144:145], v[146:147]
  v_pk_add_f32 v[34:35], v[148:149], v[150:151]
  v_pk_add_f32 v[32:33], v[32:33], v[152:153]
  v_pk_add_f32 v[34:35], v[34:35], v[154:155]
  v_pk_add_f32 v[32:33], v[32:33], v[156:157]
  v_pk_add_f32 v[34:35], v[34:35], v[158:159]
  v_pk_add_f32 v[32:33], v[32:33], v[160:161]
  v_pk_add_f32 v[34:35], v[34:35], v[162:163]
  v_pk_add_f32 v[32:33], v[32:33], v[164:165]
  v_pk_add_f32 v[34:35], v[34:35], v[166:167]
  v_pk_add_f32 v[32:33], v[32:33], v[168:169]
  v_pk_add_f32 v[34:35], v[34:35], v[170:171]
  v_pk_add_f32 v[32:33], v[32:33], v[172:173]
  v_pk_add_f32 v[34:35], v[34:35], v[174:175]
  v_pk_add_f32 v[32:33], v[32:33], v[34:35]
  v_add_f32 v32, v32, v33
  s_nop 1
  v_add_f32_dpp v32, v32, v32 row_ror:8 row_mask:0xf bank_mask:0xf
  v_mov_b32 v33, v32
  s_nop 1
  v_permlane16_swap_b32 v33, v32
  v_add_f32 v32, v32, v33
  v_mov_b32 v33, v32
  s_nop 1
  v_permlane32_swap_b32 v33, v32
  v_add_f32 v32, v32, v33
  v_mul_f32 v32, 0x3b800000, v32
  v_pk_add_f32 v[144:145], v[144:145], v[32:33] op_sel_hi:[1,0] neg_lo:[0,1] neg_hi:[0,1]
  v_pk_add_f32 v[146:147], v[146:147], v[32:33] op_sel_hi:[1,0] neg_lo:[0,1] neg_hi:[0,1]
  v_pk_add_f32 v[148:149], v[148:149], v[32:33] op_sel_hi:[1,0] neg_lo:[0,1] neg_hi:[0,1]
  v_pk_add_f32 v[150:151], v[150:151], v[32:33] op_sel_hi:[1,0] neg_lo:[0,1] neg_hi:[0,1]
  v_pk_add_f32 v[152:153], v[152:153], v[32:33] op_sel_hi:[1,0] neg_lo:[0,1] neg_hi:[0,1]
  v_pk_add_f32 v[154:155], v[154:155], v[32:33] op_sel_hi:[1,0] neg_lo:[0,1] neg_hi:[0,1]
  v_pk_add_f32 v[156:157], v[156:157], v[32:33] op_sel_hi:[1,0] neg_lo:[0,1] neg_hi:[0,1]
  v_pk_add_f32 v[158:159], v[158:159], v[32:33] op_sel_hi:[1,0] neg_lo:[0,1] neg_hi:[0,1]
  v_pk_add_f32 v[160:161], v[160:161], v[32:33] op_sel_hi:[1,0] neg_lo:[0,1] neg_hi:[0,1]
  v_pk_add_f32 v[162:163], v[162:163], v[32:33] op_sel_hi:[1,0] neg_lo:[0,1] neg_hi:[0,1]
  v_pk_add_f32 v[164:165], v[164:165], v[32:33] op_sel_hi:[1,0] neg_lo:[0,1] neg_hi:[0,1]
  v_pk_add_f32 v[166:167], v[166:167], v[32:33] op_sel_hi:[1,0] neg_lo:[0,1] neg_hi:[0,1]
  v_pk_add_f32 v[168:169], v[168:169], v[32:33] op_sel_hi:[1,0] neg_lo:[0,1] neg_hi:[0,1]
  v_pk_add_f32 v[170:171], v[170:171], v[32:33] op_sel_hi:[1,0] neg_lo:[0,1] neg_hi:[0,1]
  v_pk_add_f32 v[172:173], v[172:173], v[32:33] op_sel_hi:[1,0] neg_lo:[0,1] neg_hi:[0,1]
  v_pk_add_f32 v[174:175], v[174:175], v[32:33] op_sel_hi:[1,0] neg_lo:[0,1] neg_hi:[0,1]
  v_pk_mul_f32 v[34:35], v[144:145], v[144:145]
  v_pk_mul_f32 v[36:37], v[146:147], v[146:147]
  v_pk_fma_f32 v[34:35], v[148:149], v[148:149], v[34:35]
  v_pk_fma_f32 v[36:37], v[150:151], v[150:151], v[36:37]
  v_pk_fma_f32 v[34:35], v[152:153], v[152:153], v[34:35]
  v_pk_fma_f32 v[36:37], v[154:155], v[154:155], v[36:37]
  v_pk_fma_f32 v[34:35], v[156:157], v[156:157], v[34:35]
  v_pk_fma_f32 v[36:37], v[158:159], v[158:159], v[36:37]
  v_pk_fma_f32 v[34:35], v[160:161], v[160:161], v[34:35]
  v_pk_fma_f32 v[36:37], v[162:163], v[162:163], v[36:37]
  v_pk_fma_f32 v[34:35], v[164:165], v[164:165], v[34:35]
  v_pk_fma_f32 v[36:37], v[166:167], v[166:167], v[36:37]
  v_pk_fma_f32 v[34:35], v[168:169], v[168:169], v[34:35]
  v_pk_fma_f32 v[36:37], v[170:171], v[170:171], v[36:37]
  v_pk_fma_f32 v[34:35], v[172:173], v[172:173], v[34:35]
  v_pk_fma_f32 v[36:37], v[174:175], v[174:175], v[36:37]
  v_pk_add_f32 v[34:35], v[34:35], v[36:37]
  v_add_f32 v34, v34, v35
  s_nop 1
  v_add_f32_dpp v34, v34, v34 row_ror:8 row_mask:0xf bank_mask:0xf
  v_mov_b32 v35, v34
  s_nop 1
  v_permlane16_swap_b32 v35, v34
  v_add_f32 v34, v34, v35
  v_mov_b32 v35, v34
  s_nop 1
  v_permlane32_swap_b32 v35, v34
  v_add_f32 v34, v34, v35
  v_mov_b32 v33, v34
  ds_write_b64 v12, v[32:33]
  s_waitcnt lgkmcnt(0)
  s_barrier
  ds_read2_b64 v[36:39], v13 offset0:0 offset1:8
  ds_read2_b64 v[40:43], v13 offset0:16 offset1:24
  s_waitcnt lgkmcnt(0)
  v_pk_add_f32 v[34:35], v[36:37], v[38:39]
  v_pk_add_f32 v[44:45], v[40:41], v[42:43]
  v_pk_add_f32 v[34:35], v[34:35], v[44:45]
  v_mul_f32 v34, 0x3e800000, v34
  v_mul_f32 v35, 0x3b800000, v35
  v_sub_f32 v36, v36, v34
  v_sub_f32 v38, v38, v34
  v_sub_f32 v40, v40, v34
  v_sub_f32 v42, v42, v34
  v_fmac_f32 v35, v36, v36
  v_fmac_f32 v35, v38, v38
  v_fmac_f32 v35, v40, v40
  v_fmac_f32 v35, v42, v42
  v_mul_f32 v35, 0x3e800000, v35
  v_add_f32 v35, 0x3727c5ac, v35
  v_rsq_f32 v44, v35
  v_sub_f32 v32, v32, v34
  v_mul_f32 v32, v32, v44
  v_pk_fma_f32 v[144:145], v[144:145], v[44:45], v[32:33] op_sel_hi:[1,0,0]
  v_pk_fma_f32 v[146:147], v[146:147], v[44:45], v[32:33] op_sel_hi:[1,0,0]
  v_pk_fma_f32 v[148:149], v[148:149], v[44:45], v[32:33] op_sel_hi:[1,0,0]
  v_pk_fma_f32 v[150:151], v[150:151], v[44:45], v[32:33] op_sel_hi:[1,0,0]
  v_pk_fma_f32 v[144:145], v[144:145], v[112:113], v[80:81]
  v_pk_fma_f32 v[146:147], v[146:147], v[114:115], v[82:83]
  v_pk_fma_f32 v[148:149], v[148:149], v[116:117], v[84:85]
  v_pk_fma_f32 v[150:151], v[150:151], v[118:119], v[86:87]
  v_cvt_pk_bf16_f32 v192, v144, v145
  v_cvt_pk_bf16_f32 v193, v146, v147
  v_cvt_pk_bf16_f32 v194, v148, v149
  v_cvt_pk_bf16_f32 v195, v150, v151
  s_add_u32 s40, s26, 6291456
  buffer_store_dwordx4 v[192:195], v1, s[4:7], s40 offen sc1
  v_pk_fma_f32 v[152:153], v[152:153], v[44:45], v[32:33] op_sel_hi:[1,0,0]
  v_pk_fma_f32 v[154:155], v[154:155], v[44:45], v[32:33] op_sel_hi:[1,0,0]
  v_pk_fma_f32 v[156:157], v[156:157], v[44:45], v[32:33] op_sel_hi:[1,0,0]
  v_pk_fma_f32 v[158:159], v[158:159], v[44:45], v[32:33] op_sel_hi:[1,0,0]
  v_pk_fma_f32 v[152:153], v[152:153], v[120:121], v[88:89]
  v_pk_fma_f32 v[154:155], v[154:155], v[122:123], v[90:91]
  v_pk_fma_f32 v[156:157], v[156:157], v[124:125], v[92:93]
  v_pk_fma_f32 v[158:159], v[158:159], v[126:127], v[94:95]
  v_cvt_pk_bf16_f32 v196, v152, v153
  v_cvt_pk_bf16_f32 v197, v154, v155
  v_cvt_pk_bf16_f32 v198, v156, v157
  v_cvt_pk_bf16_f32 v199, v158, v159
  s_add_u32 s40, s26, 6295552
  buffer_store_dwordx4 v[196:199], v1, s[4:7], s40 offen sc1
  v_pk_fma_f32 v[160:161], v[160:161], v[44:45], v[32:33] op_sel_hi:[1,0,0]
  v_pk_fma_f32 v[162:163], v[162:163], v[44:45], v[32:33] op_sel_hi:[1,0,0]
  v_pk_fma_f32 v[164:165], v[164:165], v[44:45], v[32:33] op_sel_hi:[1,0,0]
  v_pk_fma_f32 v[166:167], v[166:167], v[44:45], v[32:33] op_sel_hi:[1,0,0]
  v_pk_fma_f32 v[160:161], v[160:161], v[128:129], v[96:97]
  v_pk_fma_f32 v[162:163], v[162:163], v[130:131], v[98:99]
  v_pk_fma_f32 v[164:165], v[164:165], v[132:133], v[100:101]
  v_pk_fma_f32 v[166:167], v[166:167], v[134:135], v[102:103]
  v_cvt_pk_bf16_f32 v200, v160, v161
  v_cvt_pk_bf16_f32 v201, v162, v163
  v_cvt_pk_bf16_f32 v202, v164, v165
  v_cvt_pk_bf16_f32 v203, v166, v167
  s_add_u32 s40, s26, 6299648
  buffer_store_dwordx4 v[200:203], v1, s[4:7], s40 offen sc1
  v_pk_fma_f32 v[168:169], v[168:169], v[44:45], v[32:33] op_sel_hi:[1,0,0]
  v_pk_fma_f32 v[170:171], v[170:171], v[44:45], v[32:33] op_sel_hi:[1,0,0]
  v_pk_fma_f32 v[172:173], v[172:173], v[44:45], v[32:33] op_sel_hi:[1,0,0]
  v_pk_fma_f32 v[174:175], v[174:175], v[44:45], v[32:33] op_sel_hi:[1,0,0]
  v_pk_fma_f32 v[168:169], v[168:169], v[136:137], v[104:105]
  v_pk_fma_f32 v[170:171], v[170:171], v[138:139], v[106:107]
  v_pk_fma_f32 v[172:173], v[172:173], v[140:141], v[108:109]
  v_pk_fma_f32 v[174:175], v[174:175], v[142:143], v[110:111]
  v_cvt_pk_bf16_f32 v204, v168, v169
  v_cvt_pk_bf16_f32 v205, v170, v171
  v_cvt_pk_bf16_f32 v206, v172, v173
  v_cvt_pk_bf16_f32 v207, v174, v175
  s_add_u32 s40, s26, 6303744
  buffer_store_dwordx4 v[204:207], v1, s[4:7], s40 offen sc1
  s_add_u32 s40, s26, 10485760
  buffer_store_dwordx4 v[16:19], v1, s[4:7], s40 offen sc1
  s_add_u32 s40, s26, 10489856
  buffer_store_dwordx4 v[20:23], v1, s[4:7], s40 offen sc1
  s_add_u32 s40, s26, 10493952
  buffer_store_dwordx4 v[24:27], v1, s[4:7], s40 offen sc1
  s_add_u32 s40, s26, 10498048
  buffer_store_dwordx4 v[28:31], v1, s[4:7], s40 offen sc1
  s_waitcnt vmcnt(0)
  s_barrier
  s_cmp_lg_u32 s20, 0
  s_cbranch_scc1 Lnosig_13
  s_mov_b32 s63, s29
  s_atomic_smax s63, s[4:5], s62 glc
Lnosig_13:
  s_add_u32 s25, s25, 2
  s_add_u32 s29, s29, 2
  s_add_u32 s26, s26, 131072
  s_add_u32 s27, s27, 524288
  s_cmp_lt_u32 s25, 64
  s_cbranch_scc1 L_LN2_top
  s_branch L_END
L_FIN:
  s_load_dwordx2 s[16:17], s[0:1], 104
  s_mov_b32 s18, 4194304
  s_mov_b32 s19, 0x20000
  s_waitcnt lgkmcnt(0)
  s_lshr_b32 s25, s21, 2
  s_add_u32 s29, s25, 1
  s_lshl_b32 s26, s25, 16
  s_mul_i32 s27, s25, 196608
  s_add_u32 s27, s27, 142606336
  s_and_b32 s43, s21, 3
  s_lshr_b32 s40, s43, 1
  s_lshl_b32 s40, s40, 10
  s_and_b32 s41, s43, 1
  s_lshl_b32 s41, s41, 7
  s_add_u32 s40, s40, s41
  s_lshl_b32 s41, s20, 14
  s_add_u32 s40, s40, s41
  v_and_b32 v6, 7, v0
  v_lshl_add_u32 v1, v6, 4, s40
  v_bfe_u32 v7, v0, 3, 2
  v_lshl_add_u32 v1, v7, 8, v1
  v_lshrrev_b32 v7, 5, v0
  v_lshl_add_u32 v1, v7, 11, v1
  v_lshrrev_b32 v8, 3, v0
  s_lshl_b32 s40, s20, 10
  v_lshl_add_u32 v5, v8, 4, s40
  s_lshl_b32 s40, s43, 14
  s_lshl_b32 s41, s20, 9
  s_add_u32 s40, s40, s41
  v_and_b32 v9, 31, v0
  v_lshl_add_u32 v10, v9, 4, s40
  v_lshl_add_u32 v10, v7, 11, v10
  v_min_u32 v2, 63, v0
  v_lshlrev_b32 v2, 7, v2
  v_add_u32 v2, 1380352, v2
  s_nop 1
Lpoll_14:
  buffer_load_dword v3, v2, s[4:7], 0 offen sc1
  s_sub_u32 s24, s24, 1
  s_cbranch_scc1 L_FAIL
  s_waitcnt vmcnt(0)
  v_cmp_gt_i32 vcc, 1, v3
  s_cbranch_vccz Lpolld_15
  s_sleep 2
  s_branch Lpoll_14
Lpolld_15:
  s_mov_b32 s40, 1593344
  buffer_load_dwordx4 v[48:51], v5, s[4:7], s40 offen offset:0 sc1
  buffer_load_dwordx4 v[52:55], v5, s[4:7], s40 offen offset:256 sc1
  buffer_load_dwordx4 v[56:59], v5, s[4:7], s40 offen offset:128 sc1
  buffer_load_dwordx4 v[60:63], v5, s[4:7], s40 offen offset:384 sc1
  buffer_load_dwordx4 v[64:67], v5, s[4:7], s40 offen offset:512 sc1
  buffer_load_dwordx4 v[68:71], v5, s[4:7], s40 offen offset:768 sc1
  buffer_load_dwordx4 v[72:75], v5, s[4:7], s40 offen offset:640 sc1
  buffer_load_dwordx4 v[76:79], v5, s[4:7], s40 offen offset:896 sc1
  v_min_u32 v2, 23, v0
  v_lshlrev_b32 v2, 7, v2
  v_add_u32 v2, 1421312, v2
  s_mul_i32 s30, s20, 4224
  v_mul_u32_u24 v11, 528, v6
  v_lshl_add_u32 v11, v8, 3, v11
  v_add_u32 v11, s30, v11
  v_mul_u32_u24 v12, 528, v7
  v_lshl_add_u32 v12, v9, 4, v12
  v_add_u32 v12, s30, v12
  s_nop 1
L_FIN_top:
Lpoll_16:
  buffer_load_dword v3, v2, s[4:7], 0 offen sc1
  s_sub_u32 s24, s24, 1
  s_cbranch_scc1 L_FAIL
  s_waitcnt vmcnt(0)
  v_cmp_gt_i32 vcc, s29, v3
  s_cbranch_vccz Lpolld_17
  s_sleep 1
  s_branch Lpoll_16
Lpolld_17:
  s_add_u32 s40, s26, 10485760
  buffer_load_dwordx4 v[16:19], v1, s[4:7], s40 offen sc1
  s_add_u32 s40, s26, 10489856
  buffer_load_dwordx4 v[20:23], v1, s[4:7], s40 offen sc1
  s_add_u32 s40, s26, 10493952
  buffer_load_dwordx4 v[24:27], v1, s[4:7], s40 offen sc1
  s_add_u32 s40, s26, 10498048
  buffer_load_dwordx4 v[28:31], v1, s[4:7], s40 offen sc1
  s_add_u32 s40, s27, 0
  buffer_load_dwordx4 v[192:195], v1, s[4:7], s40 offen sc1
  s_add_u32 s40, s27, 4096
  buffer_load_dwordx4 v[196:199], v1, s[4:7], s40 offen sc1
  s_add_u32 s40, s27, 8192
  buffer_load_dwordx4 v[200:203], v1, s[4:7], s40 offen sc1
  s_add_u32 s40, s27, 12288
  buffer_load_dwordx4 v[204:207], v1, s[4:7], s40 offen sc1
  s_add_u32 s40, s27, 65536
  buffer_load_dwordx4 v[208:211], v1, s[4:7], s40 offen sc1
  s_add_u32 s40, s27, 69632
  buffer_load_dwordx4 v[212:215], v1, s[4:7], s40 offen sc1
  s_add_u32 s40, s27, 73728
  buffer_load_dwordx4 v[216:219], v1, s[4:7], s40 offen sc1
  s_add_u32 s40, s27, 77824
  buffer_load_dwordx4 v[220:223], v1, s[4:7], s40 offen sc1
  s_add_u32 s40, s27, 131072
  buffer_load_dwordx4 v[224:227], v1, s[4:7], s40 offen sc1
  s_add_u32 s40, s27, 135168
  buffer_load_dwordx4 v[228:231], v1, s[4:7], s40 offen sc1
  s_add_u32 s40, s27, 139264
  buffer_load_dwordx4 v[232:235], v1, s[4:7], s40 offen sc1
  s_add_u32 s40, s27, 143360
  buffer_load_dwordx4 v[236:239], v1, s[4:7], s40 offen sc1
  s_waitcnt vmcnt(12)
  v_lshlrev_b32 v144, 16, v16
  v_and_b32 v145, 0xffff0000, v16
  v_lshlrev_b32 v146, 16, v17
  v_and_b32 v147, 0xffff0000, v17
  v_lshlrev_b32 v148, 16, v18
  v_and_b32 v149, 0xffff0000, v18
  v_lshlrev_b32 v150, 16, v19
  v_and_b32 v151, 0xffff0000, v19
  v_lshlrev_b32 v152, 16, v20
  v_and_b32 v153, 0xffff0000, v20
  v_lshlrev_b32 v154, 16, v21
  v_and_b32 v155, 0xffff0000, v21
  v_lshlrev_b32 v156, 16, v22
  v_and_b32 v157, 0xffff0000, v22
  v_lshlrev_b32 v158, 16, v23
  v_and_b32 v159, 0xffff0000, v23
  v_lshlrev_b32 v160, 16, v24
  v_and_b32 v161, 0xffff0000, v24
  v_lshlrev_b32 v162, 16, v25
  v_and_b32 v163, 0xffff0000, v25
  v_lshlrev_b32 v164, 16, v26
  v_and_b32 v165, 0xffff0000, v26
  v_lshlrev_b32 v166, 16, v27
  v_and_b32 v167, 0xffff0000, v27
  v_lshlrev_b32 v168, 16, v28
  v_and_b32 v169, 0xffff0000, v28
  v_lshlrev_b32 v170, 16, v29
  v_and_b32 v171, 0xffff0000, v29
  v_lshlrev_b32 v172, 16, v30
  v_and_b32 v173, 0xffff0000, v30
  v_lshlrev_b32 v174, 16, v31
  v_and_b32 v175, 0xffff0000, v31
  s_waitcnt vmcnt(11)
  v_lshlrev_b32 v176, 16, v192
  v_and_b32 v177, 0xffff0000, v192
  v_lshlrev_b32 v178, 16, v193
  v_and_b32 v179, 0xffff0000, v193
  v_lshlrev_b32 v180, 16, v194
  v_and_b32 v181, 0xffff0000, v194
  v_lshlrev_b32 v182, 16, v195
  v_and_b32 v183, 0xffff0000, v195
  v_pk_fma_f32 v[144:145], v[176:177], v[48:49], v[144:145]
  v_pk_fma_f32 v[146:147], v[178:179], v[50:51], v[146:147]
  v_pk_fma_f32 v[148:149], v[180:181], v[52:53], v[148:149]
  v_pk_fma_f32 v[150:151], v[182:183], v[54:55], v[150:151]
  s_waitcnt vmcnt(10)
  v_lshlrev_b32 v184, 16, v196
  v_and_b32 v185, 0xffff0000, v196
  v_lshlrev_b32 v186, 16, v197
  v_and_b32 v187, 0xffff0000, v197
  v_lshlrev_b32 v188, 16, v198
  v_and_b32 v189, 0xffff0000, v198
  v_lshlrev_b32 v190, 16, v199
  v_and_b32 v191, 0xffff0000, v199
  v_pk_fma_f32 v[152:153], v[184:185], v[56:57], v[152:153]
  v_pk_fma_f32 v[154:155], v[186:187], v[58:59], v[154:155]
  v_pk_fma_f32 v[156:157], v[188:189], v[60:61], v[156:157]
  v_pk_fma_f32 v[158:159], v[190:191], v[62:63], v[158:159]
  s_waitcnt vmcnt(9)
  v_lshlrev_b32 v176, 16, v200
  v_and_b32 v177, 0xffff0000, v200
  v_lshlrev_b32 v178, 16, v201
  v_and_b32 v179, 0xffff0000, v201
  v_lshlrev_b32 v180, 16, v202
  v_and_b32 v181, 0xffff0000, v202
  v_lshlrev_b32 v182, 16, v203
  v_and_b32 v183, 0xffff0000, v203
  v_pk_fma_f32 v[160:161], v[176:177], v[64:65], v[160:161]
  v_pk_fma_f32 v[162:163], v[178:179], v[66:67], v[162:163]
  v_pk_fma_f32 v[164:165], v[180:181], v[68:69], v[164:165]
  v_pk_fma_f32 v[166:167], v[182:183], v[70:71], v[166:167]
  s_waitcnt vmcnt(8)
  v_lshlrev_b32 v184, 16, v204
  v_and_b32 v185, 0xffff0000, v204
  v_lshlrev_b32 v186, 16, v205
  v_and_b32 v187, 0xffff0000, v205
  v_lshlrev_b32 v188, 16, v206
  v_and_b32 v189, 0xffff0000, v206
  v_lshlrev_b32 v190, 16, v207
  v_and_b32 v191, 0xffff0000, v207
  v_pk_fma_f32 v[168:169], v[184:185], v[72:73], v[168:169]
  v_pk_fma_f32 v[170:171], v[186:187], v[74:75], v[170:171]
  v_pk_fma_f32 v[172:173], v[188:189], v[76:77], v[172:173]
  v_pk_fma_f32 v[174:175], v[190:191], v[78:79], v[174:175]
  s_waitcnt vmcnt(7)
  v_lshlrev_b32 v176, 16, v208
  v_and_b32 v177, 0xffff0000, v208
  v_lshlrev_b32 v178, 16, v209
  v_and_b32 v179, 0xffff0000, v209
  v_lshlrev_b32 v180, 16, v210
  v_and_b32 v181, 0xffff0000, v210
  v_lshlrev_b32 v182, 16, v211
  v_and_b32 v183, 0xffff0000, v211
  v_pk_fma_f32 v[144:145], v[176:177], v[48:49], v[144:145]
  v_pk_fma_f32 v[146:147], v[178:179], v[50:51], v[146:147]
  v_pk_fma_f32 v[148:149], v[180:181], v[52:53], v[148:149]
  v_pk_fma_f32 v[150:151], v[182:183], v[54:55], v[150:151]
  s_waitcnt vmcnt(6)
  v_lshlrev_b32 v184, 16, v212
  v_and_b32 v185, 0xffff0000, v212
  v_lshlrev_b32 v186, 16, v213
  v_and_b32 v187, 0xffff0000, v213
  v_lshlrev_b32 v188, 16, v214
  v_and_b32 v189, 0xffff0000, v214
  v_lshlrev_b32 v190, 16, v215
  v_and_b32 v191, 0xffff0000, v215
  v_pk_fma_f32 v[152:153], v[184:185], v[56:57], v[152:153]
  v_pk_fma_f32 v[154:155], v[186:187], v[58:59], v[154:155]
  v_pk_fma_f32 v[156:157], v[188:189], v[60:61], v[156:157]
  v_pk_fma_f32 v[158:159], v[190:191], v[62:63], v[158:159]
  s_waitcnt vmcnt(5)
  v_lshlrev_b32 v176, 16, v216
  v_and_b32 v177, 0xffff0000, v216
  v_lshlrev_b32 v178, 16, v217
  v_and_b32 v179, 0xffff0000, v217
  v_lshlrev_b32 v180, 16, v218
  v_and_b32 v181, 0xffff0000, v218
  v_lshlrev_b32 v182, 16, v219
  v_and_b32 v183, 0xffff0000, v219
  v_pk_fma_f32 v[160:161], v[176:177], v[64:65], v[160:161]
  v_pk_fma_f32 v[162:163], v[178:179], v[66:67], v[162:163]
  v_pk_fma_f32 v[164:165], v[180:181], v[68:69], v[164:165]
  v_pk_fma_f32 v[166:167], v[182:183], v[70:71], v[166:167]
  s_waitcnt vmcnt(4)
  v_lshlrev_b32 v184, 16, v220
  v_and_b32 v185, 0xffff0000, v220
  v_lshlrev_b32 v186, 16, v221
  v_and_b32 v187, 0xffff0000, v221
  v_lshlrev_b32 v188, 16, v222
  v_and_b32 v189, 0xffff0000, v222
  v_lshlrev_b32 v190, 16, v223
  v_and_b32 v191, 0xffff0000, v223
  v_pk_fma_f32 v[168:169], v[184:185], v[72:73], v[168:169]
  v_pk_fma_f32 v[170:171], v[186:187], v[74:75], v[170:171]
  v_pk_fma_f32 v[172:173], v[188:189], v[76:77], v[172:173]
  v_pk_fma_f32 v[174:175], v[190:191], v[78:79], v[174:175]
  s_waitcnt vmcnt(3)
  v_lshlrev_b32 v176, 16, v224
  v_and_b32 v177, 0xffff0000, v224
  v_lshlrev_b32 v178, 16, v225
  v_and_b32 v179, 0xffff0000, v225
  v_lshlrev_b32 v180, 16, v226
  v_and_b32 v181, 0xffff0000, v226
  v_lshlrev_b32 v182, 16, v227
  v_and_b32 v183, 0xffff0000, v227
  v_pk_fma_f32 v[144:145], v[176:177], v[48:49], v[144:145]
  v_pk_fma_f32 v[146:147], v[178:179], v[50:51], v[146:147]
  v_pk_fma_f32 v[148:149], v[180:181], v[52:53], v[148:149]
  v_pk_fma_f32 v[150:151], v[182:183], v[54:55], v[150:151]
  s_waitcnt vmcnt(2)
  v_lshlrev_b32 v184, 16, v228
  v_and_b32 v185, 0xffff0000, v228
  v_lshlrev_b32 v186, 16, v229
  v_and_b32 v187, 0xffff0000, v229
  v_lshlrev_b32 v188, 16, v230
  v_and_b32 v189, 0xffff0000, v230
  v_lshlrev_b32 v190, 16, v231
  v_and_b32 v191, 0xffff0000, v231
  v_pk_fma_f32 v[152:153], v[184:185], v[56:57], v[152:153]
  v_pk_fma_f32 v[154:155], v[186:187], v[58:59], v[154:155]
  v_pk_fma_f32 v[156:157], v[188:189], v[60:61], v[156:157]
  v_pk_fma_f32 v[158:159], v[190:191], v[62:63], v[158:159]
  s_waitcnt vmcnt(1)
  v_lshlrev_b32 v176, 16, v232
  v_and_b32 v177, 0xffff0000, v232
  v_lshlrev_b32 v178, 16, v233
  v_and_b32 v179, 0xffff0000, v233
  v_lshlrev_b32 v180, 16, v234
  v_and_b32 v181, 0xffff0000, v234
  v_lshlrev_b32 v182, 16, v235
  v_and_b32 v183, 0xffff0000, v235
  v_pk_fma_f32 v[160:161], v[176:177], v[64:65], v[160:161]
  v_pk_fma_f32 v[162:163], v[178:179], v[66:67], v[162:163]
  v_pk_fma_f32 v[164:165], v[180:181], v[68:69], v[164:165]
  v_pk_fma_f32 v[166:167], v[182:183], v[70:71], v[166:167]
  s_waitcnt vmcnt(0)
  v_lshlrev_b32 v184, 16, v236
  v_and_b32 v185, 0xffff0000, v236
  v_lshlrev_b32 v186, 16, v237
  v_and_b32 v187, 0xffff0000, v237
  v_lshlrev_b32 v188, 16, v238
  v_and_b32 v189, 0xffff0000, v238
  v_lshlrev_b32 v190, 16, v239
  v_and_b32 v191, 0xffff0000, v239
  v_pk_fma_f32 v[168:169], v[184:185], v[72:73], v[168:169]
  v_pk_fma_f32 v[170:171], v[186:187], v[74:75], v[170:171]
  v_pk_fma_f32 v[172:173], v[188:189], v[76:77], v[172:173]
  v_pk_fma_f32 v[174:175], v[190:191], v[78:79], v[174:175]
  v_cvt_pk_bf16_f32 v16, v144, v145
  v_cvt_pk_bf16_f32 v17, v146, v147
  v_cvt_pk_bf16_f32 v18, v148, v149
  v_cvt_pk_bf16_f32 v19, v150, v151
  v_cvt_pk_bf16_f32 v20, v152, v153
  v_cvt_pk_bf16_f32 v21, v154, v155
  v_cvt_pk_bf16_f32 v22, v156, v157
  v_cvt_pk_bf16_f32 v23, v158, v159
  v_cvt_pk_bf16_f32 v24, v160, v161
  v_cvt_pk_bf16_f32 v25, v162, v163
  v_cvt_pk_bf16_f32 v26, v164, v165
  v_cvt_pk_bf16_f32 v27, v166, v167
  v_cvt_pk_bf16_f32 v28, v168, v169
  v_cvt_pk_bf16_f32 v29, v170, v171
  v_cvt_pk_bf16_f32 v30, v172, v173
  v_cvt_pk_bf16_f32 v31, v174, v175
  ds_write_b64 v11, v[16:17] offset:0
  ds_write_b64 v11, v[18:19] offset:128
  ds_write_b64 v11, v[20:21] offset:64
  ds_write_b64 v11, v[22:23] offset:192
  ds_write_b64 v11, v[24:25] offset:256
  ds_write_b64 v11, v[26:27] offset:384
  ds_write_b64 v11, v[28:29] offset:320
  ds_write_b64 v11, v[30:31] offset:448
  s_waitcnt lgkmcnt(0)
  ds_read_b128 v[192:195], v12 offset:0
  ds_read_b128 v[196:199], v12 offset:1056
  ds_read_b128 v[200:203], v12 offset:2112
  ds_read_b128 v[204:207], v12 offset:3168
  s_add_u32 s40, s26, 0
  s_waitcnt lgkmcnt(3)
  buffer_store_dwordx4 v[192:195], v10, s[16:19], s40 offen
  s_add_u32 s40, s26, 4096
  s_waitcnt lgkmcnt(2)
  buffer_store_dwordx4 v[196:199], v10, s[16:19], s40 offen
  s_add_u32 s40, s26, 8192
  s_waitcnt lgkmcnt(1)
  buffer_store_dwordx4 v[200:203], v10, s[16:19], s40 offen
  s_add_u32 s40, s26, 12288
  s_waitcnt lgkmcnt(0)
  buffer_store_dwordx4 v[204:207], v10, s[16:19], s40 offen
  s_add_u32 s25, s25, 2
  s_add_u32 s29, s29, 2
  s_add_u32 s26, s26, 131072
  s_add_u32 s27, s27, 393216
  s_cmp_lt_u32 s25, 64
  s_cbranch_scc1 L_FIN_top
  s_branch L_END
L_QKV:
  s_and_b32 s43, s21, 1
  s_lshr_b32 s44, s21, 1
  s_lshl_b32 s44, s44, 8
  s_add_u32 s45, s44, 128
  s_lshl_b32 s46, s43, 7
  s_add_u32 s46, s46, s44
  s_load_dwordx4 s[48:51], s[0:1], 16
  s_waitcnt lgkmcnt(0)
  s_cmp_eq_u32 s43, 0
  s_cselect_b32 s8, s48, s50
  s_cselect_b32 s9, s49, s51
  s_mov_b32 s10, 8388608
  s_mov_b32 s11, 0x20000
  v_bfe_u32 v40, v0, 5, 1
  v_mul_u32_u24 v40, 32768, v40
  v_bfe_u32 v41, v0, 4, 1
  v_mul_u32_u24 v41, 16384, v41
  v_add_u32 v40, v40, v41
  v_bfe_u32 v41, v0, 3, 1
  v_mul_u32_u24 v41, 8192, v41
  v_add_u32 v40, v40, v41
  v_lshrrev_b32 v41, 3, v0
  v_and_b32 v41, 6, v41
  v_xor_b32 v41, v41, v0
  v_and_b32 v41, 7, v41
  v_lshl_add_u32 v40, v41, 4, v40
  s_lshr_b32 s40, s20, 1
  s_mul_i32 s40, s40, 2097152
  s_and_b32 s41, s20, 1
  s_mul_i32 s41, s41, 65536
  s_add_u32 s40, s40, s41
  v_add_u32 v40, s40, v40
  v_bfe_u32 v41, v0, 3, 2
  v_xor_b32 v41, s20, v41
  v_lshlrev_b32 v41, 5, v41
  v_lshrrev_b32 v42, 2, v0
  v_lshl_add_u32 v42, v42, 7, v41
  v_and_b32 v41, 3, v0
  v_lshl_add_u32 v42, v41, 3, v42
  v_add_u32 v43, 0x10000, v42
  v_add_u32 v44, s44, v40
  v_add_u32 v45, s45, v40
  v_add_u32 v46, s46, v40
  s_lshl_b32 s41, s20, 10
  s_add_u32 m0, s41, 0
  s_mov_b32 s42, 0
  buffer_load_dwordx4 v44, s[8:11], s42 offen lds
  s_add_u32 m0, s41, 4096
  s_mov_b32 s42, 0
  buffer_load_dwordx4 v45, s[8:11], s42 offen lds
  s_add_u32 m0, s41, 8192
  s_mov_b32 s42, 131072
  buffer_load_dwordx4 v44, s[8:11], s42 offen lds
  s_add_u32 m0, s41, 12288
  s_mov_b32 s42, 131072
  buffer_load_dwordx4 v45, s[8:11], s42 offen lds
  s_add_u32 m0, s41, 16384
  s_mov_b32 s42, 262144
  buffer_load_dwordx4 v44, s[8:11], s42 offen lds
  s_add_u32 m0, s41, 20480
  s_mov_b32 s42, 262144
  buffer_load_dwordx4 v45, s[8:11], s42 offen lds
  s_add_u32 m0, s41, 24576
  s_mov_b32 s42, 393216
  buffer_load_dwordx4 v44, s[8:11], s42 offen lds
  s_add_u32 m0, s41, 28672
  s_mov_b32 s42, 393216
  buffer_load_dwordx4 v45, s[8:11], s42 offen lds
  s_add_u32 m0, s41, 32768
  s_mov_b32 s42, 524288
  buffer_load_dwordx4 v44, s[8:11], s42 offen lds
  s_add_u32 m0, s41, 36864
  s_mov_b32 s42, 524288
  buffer_load_dwordx4 v45, s[8:11], s42 offen lds
  s_add_u32 m0, s41, 40960
  s_mov_b32 s42, 655360
  buffer_load_dwordx4 v44, s[8:11], s42 offen lds
  s_add_u32 m0, s41, 45056
  s_mov_b32 s42, 655360
  buffer_load_dwordx4 v45, s[8:11], s42 offen lds
  s_add_u32 m0, s41, 49152
  s_mov_b32 s42, 786432
  buffer_load_dwordx4 v44, s[8:11], s42 offen lds
  s_add_u32 m0, s41, 53248
  s_mov_b32 s42, 786432
  buffer_load_dwordx4 v45, s[8:11], s42 offen lds
  s_add_u32 m0, s41, 57344
  s_mov_b32 s42, 917504
  buffer_load_dwordx4 v44, s[8:11], s42 offen lds
  s_add_u32 m0, s41, 61440
  s_mov_b32 s42, 917504
  buffer_load_dwordx4 v45, s[8:11], s42 offen lds
  s_add_u32 m0, s41, 65536
  s_mov_b32 s42, 1048576
  buffer_load_dwordx4 v44, s[8:11], s42 offen lds
  s_add_u32 m0, s41, 69632
  s_mov_b32 s42, 1048576
  buffer_load_dwordx4 v45, s[8:11], s42 offen lds
  s_add_u32 m0, s41, 73728
  s_mov_b32 s42, 1179648
  buffer_load_dwordx4 v44, s[8:11], s42 offen lds
  s_add_u32 m0, s41, 77824
  s_mov_b32 s42, 1179648
  buffer_load_dwordx4 v45, s[8:11], s42 offen lds
  s_add_u32 m0, s41, 81920
  s_mov_b32 s42, 1310720
  buffer_load_dwordx4 v44, s[8:11], s42 offen lds
  s_add_u32 m0, s41, 86016
  s_mov_b32 s42, 1310720
  buffer_load_dwordx4 v45, s[8:11], s42 offen lds
  s_add_u32 m0, s41, 90112
  s_mov_b32 s42, 1441792
  buffer_load_dwordx4 v44, s[8:11], s42 offen lds
  s_add_u32 m0, s41, 94208
  s_mov_b32 s42, 1441792
  buffer_load_dwordx4 v45, s[8:11], s42 offen lds
  s_add_u32 m0, s41, 98304
  s_mov_b32 s42, 1572864
  buffer_load_dwordx4 v44, s[8:11], s42 offen lds
  s_add_u32 m0, s41, 102400
  s_mov_b32 s42, 1572864
  buffer_load_dwordx4 v45, s[8:11], s42 offen lds
  s_add_u32 m0, s41, 106496
  s_mov_b32 s42, 1703936
  buffer_load_dwordx4 v44, s[8:11], s42 offen lds
  s_add_u32 m0, s41, 110592
  s_mov_b32 s42, 1703936
  buffer_load_dwordx4 v45, s[8:11], s42 offen lds
  s_waitcnt vmcnt(24) lgkmcnt(0)
  s_barrier
  s_add_u32 m0, s41, 114688
  s_mov_b32 s42, 1835008
  buffer_load_dwordx4 v44, s[8:11], s42 offen lds
  s_add_u32 m0, s41, 118784
  s_mov_b32 s42, 1835008
  buffer_load_dwordx4 v45, s[8:11], s42 offen lds
  s_add_u32 m0, s41, 122880
  s_mov_b32 s42, 1966080
  buffer_load_dwordx4 v44, s[8:11], s42 offen lds
  s_add_u32 m0, s41, 126976
  s_mov_b32 s42, 1966080
  buffer_load_dwordx4 v45, s[8:11], s42 offen lds
  ds_read_b64_tr_b16 a[0:1], v42 offset:0
  ds_read_b64_tr_b16 a[2:3], v42 offset:2048
  ds_read_b64_tr_b16 a[128:129], v42 offset:4096
  ds_read_b64_tr_b16 a[130:131], v42 offset:6144
  ds_read_b64_tr_b16 a[4:5], v42 offset:8192
  ds_read_b64_tr_b16 a[6:7], v42 offset:10240
  ds_read_b64_tr_b16 a[132:133], v42 offset:12288
  ds_read_b64_tr_b16 a[134:135], v42 offset:14336
  s_waitcnt vmcnt(24) lgkmcnt(0)
  s_barrier
  s_add_u32 m0, s41, 0
  s_mov_b32 s42, 4194304
  buffer_load_dwordx4 v44, s[8:11], s42 offen lds
  s_add_u32 m0, s41, 4096
  s_mov_b32 s42, 4194304
  buffer_load_dwordx4 v45, s[8:11], s42 offen lds
  s_add_u32 m0, s41, 8192
  s_mov_b32 s42, 4325376
  buffer_load_dwordx4 v44, s[8:11], s42 offen lds
  s_add_u32 m0, s41, 12288
  s_mov_b32 s42, 4325376
  buffer_load_dwordx4 v45, s[8:11], s42 offen lds
  ds_read_b64_tr_b16 a[8:9], v42 offset:16384
  ds_read_b64_tr_b16 a[10:11], v42 offset:18432
  ds_read_b64_tr_b16 a[136:137], v42 offset:20480
  ds_read_b64_tr_b16 a[138:139], v42 offset:22528
  ds_read_b64_tr_b16 a[12:13], v42 offset:24576
  ds_read_b64_tr_b16 a[14:15], v42 offset:26624
  ds_read_b64_tr_b16 a[140:141], v42 offset:28672
  ds_read_b64_tr_b16 a[142:143], v42 offset:30720
  s_waitcnt vmcnt(24) lgkmcnt(0)
  s_barrier
  s_add_u32 m0, s41, 16384
  s_mov_b32 s42, 4456448
  buffer_load_dwordx4 v44, s[8:11], s42 offen lds
  s_add_u32 m0, s41, 20480
  s_mov_b32 s42, 4456448
  buffer_load_dwordx4 v45, s[8:11], s42 offen lds
  s_add_u32 m0, s41, 24576
  s_mov_b32 s42, 4587520
  buffer_load_dwordx4 v44, s[8:11], s42 offen lds
  s_add_u32 m0, s41, 28672
  s_mov_b32 s42, 4587520
  buffer_load_dwordx4 v45, s[8:11], s42 offen lds
  ds_read_b64_tr_b16 a[16:17], v42 offset:32768
  ds_read_b64_tr_b16 a[18:19], v42 offset:34816
  ds_read_b64_tr_b16 a[144:145], v42 offset:36864
  ds_read_b64_tr_b16 a[146:147], v42 offset:38912
  ds_read_b64_tr_b16 a[20:21], v42 offset:40960
  ds_read_b64_tr_b16 a[22:23], v42 offset:43008
  ds_read_b64_tr_b16 a[148:149], v42 offset:45056
  ds_read_b64_tr_b16 a[150:151], v42 offset:47104
  s_waitcnt vmcnt(24) lgkmcnt(0)
  s_barrier
  s_add_u32 m0, s41, 32768
  s_mov_b32 s42, 4718592
  buffer_load_dwordx4 v44, s[8:11], s42 offen lds
  s_add_u32 m0, s41, 36864
  s_mov_b32 s42, 4718592
  buffer_load_dwordx4 v45, s[8:11], s42 offen lds
  s_add_u32 m0, s41, 40960
  s_mov_b32 s42, 4849664
  buffer_load_dwordx4 v44, s[8:11], s42 offen lds
  s_add_u32 m0, s41, 45056
  s_mov_b32 s42, 4849664
  buffer_load_dwordx4 v45, s[8:11], s42 offen lds
  ds_read_b64_tr_b16 a[24:25], v42 offset:49152
  ds_read_b64_tr_b16 a[26:27], v42 offset:51200
  ds_read_b64_tr_b16 a[152:153], v42 offset:53248
  ds_read_b64_tr_b16 a[154:155], v42 offset:55296
  ds_read_b64_tr_b16 a[28:29], v42 offset:57344
  ds_read_b64_tr_b16 a[30:31], v42 offset:59392
  ds_read_b64_tr_b16 a[156:157], v42 offset:61440
  ds_read_b64_tr_b16 a[158:159], v42 offset:63488
  s_waitcnt vmcnt(24) lgkmcnt(0)
  s_barrier
  s_add_u32 m0, s41, 49152
  s_mov_b32 s42, 4980736
  buffer_load_dwordx4 v44, s[8:11], s42 offen lds
  s_add_u32 m0, s41, 53248
  s_mov_b32 s42, 4980736
  buffer_load_dwordx4 v45, s[8:11], s42 offen lds
  s_add_u32 m0, s41, 57344
  s_mov_b32 s42, 5111808
  buffer_load_dwordx4 v44, s[8:11], s42 offen lds
  s_add_u32 m0, s41, 61440
  s_mov_b32 s42, 5111808
  buffer_load_dwordx4 v45, s[8:11], s42 offen lds
  ds_read_b64_tr_b16 a[32:33], v43 offset:0
  ds_read_b64_tr_b16 a[34:35], v43 offset:2048
  ds_read_b64_tr_b16 a[160:161], v43 offset:4096
  ds_read_b64_tr_b16 a[162:163], v43 offset:6144
  ds_read_b64_tr_b16 a[36:37], v43 offset:8192
  ds_read_b64_tr_b16 a[38:39], v43 offset:10240
  ds_read_b64_tr_b16 a[164:165], v43 offset:12288
  ds_read_b64_tr_b16 a[166:167], v43 offset:14336
  s_waitcnt vmcnt(24) lgkmcnt(0)
  s_barrier
  s_add_u32 m0, s41, 65536
  s_mov_b32 s42, 5242880
  buffer_load_dwordx4 v44, s[8:11], s42 offen lds
  s_add_u32 m0, s41, 69632
  s_mov_b32 s42, 5242880
  buffer_load_dwordx4 v45, s[8:11], s42 offen lds
  s_add_u32 m0, s41, 73728
  s_mov_b32 s42, 5373952
  buffer_load_dwordx4 v44, s[8:11], s42 offen lds
  s_add_u32 m0, s41, 77824
  s_mov_b32 s42, 5373952
  buffer_load_dwordx4 v45, s[8:11], s42 offen lds
  ds_read_b64_tr_b16 a[40:41], v43 offset:16384
  ds_read_b64_tr_b16 a[42:43], v43 offset:18432
  ds_read_b64_tr_b16 a[168:169], v43 offset:20480
  ds_read_b64_tr_b16 a[170:171], v43 offset:22528
  ds_read_b64_tr_b16 a[44:45], v43 offset:24576
  ds_read_b64_tr_b16 a[46:47], v43 offset:26624
  ds_read_b64_tr_b16 a[172:173], v43 offset:28672
  ds_read_b64_tr_b16 a[174:175], v43 offset:30720
  s_waitcnt vmcnt(24) lgkmcnt(0)
  s_barrier
  s_add_u32 m0, s41, 81920
  s_mov_b32 s42, 5505024
  buffer_load_dwordx4 v44, s[8:11], s42 offen lds
  s_add_u32 m0, s41, 86016
  s_mov_b32 s42, 5505024
  buffer_load_dwordx4 v45, s[8:11], s42 offen lds
  s_add_u32 m0, s41, 90112
  s_mov_b32 s42, 5636096
  buffer_load_dwordx4 v44, s[8:11], s42 offen lds
  s_add_u32 m0, s41, 94208
  s_mov_b32 s42, 5636096
  buffer_load_dwordx4 v45, s[8:11], s42 offen lds
  ds_read_b64_tr_b16 a[48:49], v43 offset:32768
  ds_read_b64_tr_b16 a[50:51], v43 offset:34816
  ds_read_b64_tr_b16 a[176:177], v43 offset:36864
  ds_read_b64_tr_b16 a[178:179], v43 offset:38912
  ds_read_b64_tr_b16 a[52:53], v43 offset:40960
  ds_read_b64_tr_b16 a[54:55], v43 offset:43008
  ds_read_b64_tr_b16 a[180:181], v43 offset:45056
  ds_read_b64_tr_b16 a[182:183], v43 offset:47104
  s_waitcnt vmcnt(24) lgkmcnt(0)
  s_barrier
  s_add_u32 m0, s41, 98304
  s_mov_b32 s42, 5767168
  buffer_load_dwordx4 v44, s[8:11], s42 offen lds
  s_add_u32 m0, s41, 102400
  s_mov_b32 s42, 5767168
  buffer_load_dwordx4 v45, s[8:11], s42 offen lds
  s_add_u32 m0, s41, 106496
  s_mov_b32 s42, 5898240
  buffer_load_dwordx4 v44, s[8:11], s42 offen lds
  s_add_u32 m0, s41, 110592
  s_mov_b32 s42, 5898240
  buffer_load_dwordx4 v45, s[8:11], s42 offen lds
  ds_read_b64_tr_b16 a[56:57], v43 offset:49152
  ds_read_b64_tr_b16 a[58:59], v43 offset:51200
  ds_read_b64_tr_b16 a[184:185], v43 offset:53248
  ds_read_b64_tr_b16 a[186:187], v43 offset:55296
  ds_read_b64_tr_b16 a[60:61], v43 offset:57344
  ds_read_b64_tr_b16 a[62:63], v43 offset:59392
  ds_read_b64_tr_b16 a[188:189], v43 offset:61440
  ds_read_b64_tr_b16 a[190:191], v43 offset:63488
  s_waitcnt vmcnt(24) lgkmcnt(0)
  s_barrier
  s_add_u32 m0, s41, 114688
  s_mov_b32 s42, 6029312
  buffer_load_dwordx4 v44, s[8:11], s42 offen lds
  s_add_u32 m0, s41, 118784
  s_mov_b32 s42, 6029312
  buffer_load_dwordx4 v45, s[8:11], s42 offen lds
  s_add_u32 m0, s41, 122880
  s_mov_b32 s42, 6160384
  buffer_load_dwordx4 v44, s[8:11], s42 offen lds
  s_add_u32 m0, s41, 126976
  s_mov_b32 s42, 6160384
  buffer_load_dwordx4 v45, s[8:11], s42 offen lds
  ds_read_b64_tr_b16 a[64:65], v42 offset:0
  ds_read_b64_tr_b16 a[66:67], v42 offset:2048
  ds_read_b64_tr_b16 a[192:193], v42 offset:4096
  ds_read_b64_tr_b16 a[194:195], v42 offset:6144
  ds_read_b64_tr_b16 a[68:69], v42 offset:8192
  ds_read_b64_tr_b16 a[70:71], v42 offset:10240
  ds_read_b64_tr_b16 a[196:197], v42 offset:12288
  ds_read_b64_tr_b16 a[198:199], v42 offset:14336
  s_waitcnt vmcnt(24) lgkmcnt(0)
  s_barrier
  s_load_dwordx2 s[8:9], s[0:1], 32
  s_mov_b32 s10, 8388608
  s_mov_b32 s11, 0x20000
  s_waitcnt lgkmcnt(0)
  s_add_u32 m0, s41, 0
  s_mov_b32 s42, 0
  buffer_load_dwordx4 v46, s[8:11], s42 offen lds
  s_add_u32 m0, s41, 4096
  s_mov_b32 s42, 131072
  buffer_load_dwordx4 v46, s[8:11], s42 offen lds
  s_add_u32 m0, s41, 8192
  s_mov_b32 s42, 262144
  buffer_load_dwordx4 v46, s[8:11], s42 offen lds
  s_add_u32 m0, s41, 12288
  s_mov_b32 s42, 393216
  buffer_load_dwordx4 v46, s[8:11], s42 offen lds
  ds_read_b64_tr_b16 a[72:73], v42 offset:16384
  ds_read_b64_tr_b16 a[74:75], v42 offset:18432
  ds_read_b64_tr_b16 a[200:201], v42 offset:20480
  ds_read_b64_tr_b16 a[202:203], v42 offset:22528
  ds_read_b64_tr_b16 a[76:77], v42 offset:24576
  ds_read_b64_tr_b16 a[78:79], v42 offset:26624
  ds_read_b64_tr_b16 a[204:205], v42 offset:28672
  ds_read_b64_tr_b16 a[206:207], v42 offset:30720
  s_waitcnt vmcnt(24) lgkmcnt(0)
  s_barrier
  s_add_u32 m0, s41, 16384
  s_mov_b32 s42, 524288
  buffer_load_dwordx4 v46, s[8:11], s42 offen lds
  s_add_u32 m0, s41, 20480
  s_mov_b32 s42, 655360
  buffer_load_dwordx4 v46, s[8:11], s42 offen lds
  s_add_u32 m0, s41, 24576
  s_mov_b32 s42, 786432
  buffer_load_dwordx4 v46, s[8:11], s42 offen lds
  s_add_u32 m0, s41, 28672
  s_mov_b32 s42, 917504
  buffer_load_dwordx4 v46, s[8:11], s42 offen lds
  ds_read_b64_tr_b16 a[80:81], v42 offset:32768
  ds_read_b64_tr_b16 a[82:83], v42 offset:34816
  ds_read_b64_tr_b16 a[208:209], v42 offset:36864
  ds_read_b64_tr_b16 a[210:211], v42 offset:38912
  ds_read_b64_tr_b16 a[84:85], v42 offset:40960
  ds_read_b64_tr_b16 a[86:87], v42 offset:43008
  ds_read_b64_tr_b16 a[212:213], v42 offset:45056
  ds_read_b64_tr_b16 a[214:215], v42 offset:47104
  s_waitcnt vmcnt(24) lgkmcnt(0)
  s_barrier
  s_add_u32 m0, s41, 32768
  s_mov_b32 s42, 1048576
  buffer_load_dwordx4 v46, s[8:11], s42 offen lds
  s_add_u32 m0, s41, 36864
  s_mov_b32 s42, 1179648
  buffer_load_dwordx4 v46, s[8:11], s42 offen lds
  s_add_u32 m0, s41, 40960
  s_mov_b32 s42, 1310720
  buffer_load_dwordx4 v46, s[8:11], s42 offen lds
  s_add_u32 m0, s41, 45056
  s_mov_b32 s42, 1441792
  buffer_load_dwordx4 v46, s[8:11], s42 offen lds
  ds_read_b64_tr_b16 a[88:89], v42 offset:49152
  ds_read_b64_tr_b16 a[90:91], v42 offset:51200
  ds_read_b64_tr_b16 a[216:217], v42 offset:53248
  ds_read_b64_tr_b16 a[218:219], v42 offset:55296
  ds_read_b64_tr_b16 a[92:93], v42 offset:57344
  ds_read_b64_tr_b16 a[94:95], v42 offset:59392
  ds_read_b64_tr_b16 a[220:221], v42 offset:61440
  ds_read_b64_tr_b16 a[222:223], v42 offset:63488
  s_waitcnt vmcnt(24) lgkmcnt(0)
  s_barrier
  s_add_u32 m0, s41, 49152
  s_mov_b32 s42, 1572864
  buffer_load_dwordx4 v46, s[8:11], s42 offen lds
  s_add_u32 m0, s41, 53248
  s_mov_b32 s42, 1703936
  buffer_load_dwordx4 v46, s[8:11], s42 offen lds
  s_add_u32 m0, s41, 57344
  s_mov_b32 s42, 1835008
  buffer_load_dwordx4 v46, s[8:11], s42 offen lds
  s_add_u32 m0, s41, 61440
  s_mov_b32 s42, 1966080
  buffer_load_dwordx4 v46, s[8:11], s42 offen lds
  ds_read_b64_tr_b16 a[96:97], v43 offset:0
  ds_read_b64_tr_b16 a[98:99], v43 offset:2048
  ds_read_b64_tr_b16 a[224:225], v43 offset:4096
  ds_read_b64_tr_b16 a[226:227], v43 offset:6144
  ds_read_b64_tr_b16 a[100:101], v43 offset:8192
  ds_read_b64_tr_b16 a[102:103], v43 offset:10240
  ds_read_b64_tr_b16 a[228:229], v43 offset:12288
  ds_read_b64_tr_b16 a[230:231], v43 offset:14336
  s_waitcnt vmcnt(24) lgkmcnt(0)
  s_barrier
  s_add_u32 m0, s41, 65536
  s_mov_b32 s42, 4194304
  buffer_load_dwordx4 v46, s[8:11], s42 offen lds
  s_add_u32 m0, s41, 69632
  s_mov_b32 s42, 4325376
  buffer_load_dwordx4 v46, s[8:11], s42 offen lds
  s_add_u32 m0, s41, 73728
  s_mov_b32 s42, 4456448
  buffer_load_dwordx4 v46, s[8:11], s42 offen lds
  s_add_u32 m0, s41, 77824
  s_mov_b32 s42, 4587520
  buffer_load_dwordx4 v46, s[8:11], s42 offen lds
  ds_read_b64_tr_b16 a[104:105], v43 offset:16384
  ds_read_b64_tr_b16 a[106:107], v43 offset:18432
  ds_read_b64_tr_b16 a[232:233], v43 offset:20480
  ds_read_b64_tr_b16 a[234:235], v43 offset:22528
  ds_read_b64_tr_b16 a[108:109], v43 offset:24576
  ds_read_b64_tr_b16 a[110:111], v43 offset:26624
  ds_read_b64_tr_b16 a[236:237], v43 offset:28672
  ds_read_b64_tr_b16 a[238:239], v43 offset:30720
  s_waitcnt vmcnt(24) lgkmcnt(0)
  s_barrier
  s_add_u32 m0, s41, 81920
  s_mov_b32 s42, 4718592
  buffer_load_dwordx4 v46, s[8:11], s42 offen lds
  s_add_u32 m0, s41, 86016
  s_mov_b32 s42, 4849664
  buffer_load_dwordx4 v46, s[8:11], s42 offen lds
  s_add_u32 m0, s41, 90112
  s_mov_b32 s42, 4980736
  buffer_load_dwordx4 v46, s[8:11], s42 offen lds
  s_add_u32 m0, s41, 94208
  s_mov_b32 s42, 5111808
  buffer_load_dwordx4 v46, s[8:11], s42 offen lds
  ds_read_b64_tr_b16 a[112:113], v43 offset:32768
  ds_read_b64_tr_b16 a[114:115], v43 offset:34816
  ds_read_b64_tr_b16 a[240:241], v43 offset:36864
  ds_read_b64_tr_b16 a[242:243], v43 offset:38912
  ds_read_b64_tr_b16 a[116:117], v43 offset:40960
  ds_read_b64_tr_b16 a[118:119], v43 offset:43008
  ds_read_b64_tr_b16 a[244:245], v43 offset:45056
  ds_read_b64_tr_b16 a[246:247], v43 offset:47104
  s_waitcnt vmcnt(24) lgkmcnt(0)
  s_barrier
  s_add_u32 m0, s41, 98304
  s_mov_b32 s42, 5242880
  buffer_load_dwordx4 v46, s[8:11], s42 offen lds
  s_add_u32 m0, s41, 102400
  s_mov_b32 s42, 5373952
  buffer_load_dwordx4 v46, s[8:11], s42 offen lds
  s_add_u32 m0, s41, 106496
  s_mov_b32 s42, 5505024
  buffer_load_dwordx4 v46, s[8:11], s42 offen lds
  s_add_u32 m0, s41, 110592
  s_mov_b32 s42, 5636096
  buffer_load_dwordx4 v46, s[8:11], s42 offen lds
  ds_read_b64_tr_b16 a[120:121], v43 offset:49152
  ds_read_b64_tr_b16 a[122:123], v43 offset:51200
  ds_read_b64_tr_b16 a[248:249], v43 offset:53248
  ds_read_b64_tr_b16 a[250:251], v43 offset:55296
  ds_read_b64_tr_b16 a[124:125], v43 offset:57344
  ds_read_b64_tr_b16 a[126:127], v43 offset:59392
  ds_read_b64_tr_b16 a[252:253], v43 offset:61440
  ds_read_b64_tr_b16 a[254:255], v43 offset:63488
  s_waitcnt vmcnt(24) lgkmcnt(0)
  s_barrier
  s_add_u32 m0, s41, 114688
  s_mov_b32 s42, 5767168
  buffer_load_dwordx4 v46, s[8:11], s42 offen lds
  s_add_u32 m0, s41, 118784
  s_mov_b32 s42, 5898240
  buffer_load_dwordx4 v46, s[8:11], s42 offen lds
  s_add_u32 m0, s41, 122880
  s_mov_b32 s42, 6029312
  buffer_load_dwordx4 v46, s[8:11], s42 offen lds
  s_add_u32 m0, s41, 126976
  s_mov_b32 s42, 6160384
  buffer_load_dwordx4 v46, s[8:11], s42 offen lds
  ds_read_b64_tr_b16 v[128:129], v42 offset:0
  ds_read_b64_tr_b16 v[130:131], v42 offset:2048
  ds_read_b64_tr_b16 v[132:133], v42 offset:4096
  ds_read_b64_tr_b16 v[134:135], v42 offset:6144
  ds_read_b64_tr_b16 v[136:137], v42 offset:8192
  ds_read_b64_tr_b16 v[138:139], v42 offset:10240
  ds_read_b64_tr_b16 v[140:141], v42 offset:12288
  ds_read_b64_tr_b16 v[142:143], v42 offset:14336
  s_waitcnt vmcnt(24) lgkmcnt(0)
  s_barrier
  ds_read_b64_tr_b16 v[144:145], v42 offset:16384
  ds_read_b64_tr_b16 v[146:147], v42 offset:18432
  ds_read_b64_tr_b16 v[148:149], v42 offset:20480
  ds_read_b64_tr_b16 v[150:151], v42 offset:22528
  ds_read_b64_tr_b16 v[152:153], v42 offset:24576
  ds_read_b64_tr_b16 v[154:155], v42 offset:26624
  ds_read_b64_tr_b16 v[156:157], v42 offset:28672
  ds_read_b64_tr_b16 v[158:159], v42 offset:30720
  s_waitcnt vmcnt(20) lgkmcnt(0)
  s_barrier
  ds_read_b64_tr_b16 v[160:161], v42 offset:32768
  ds_read_b64_tr_b16 v[162:163], v42 offset:34816
  ds_read_b64_tr_b16 v[164:165], v42 offset:36864
  ds_read_b64_tr_b16 v[166:167], v42 offset:38912
  ds_read_b64_tr_b16 v[168:169], v42 offset:40960
  ds_read_b64_tr_b16 v[170:171], v42 offset:43008
  ds_read_b64_tr_b16 v[172:173], v42 offset:45056
  ds_read_b64_tr_b16 v[174:175], v42 offset:47104
  s_waitcnt vmcnt(16) lgkmcnt(0)
  s_barrier
  ds_read_b64_tr_b16 v[176:177], v42 offset:49152
  ds_read_b64_tr_b16 v[178:179], v42 offset:51200
  ds_read_b64_tr_b16 v[180:181], v42 offset:53248
  ds_read_b64_tr_b16 v[182:183], v42 offset:55296
  ds_read_b64_tr_b16 v[184:185], v42 offset:57344
  ds_read_b64_tr_b16 v[186:187], v42 offset:59392
  ds_read_b64_tr_b16 v[188:189], v42 offset:61440
  ds_read_b64_tr_b16 v[190:191], v42 offset:63488
  s_waitcnt vmcnt(12) lgkmcnt(0)
  s_barrier
  ds_read_b64_tr_b16 v[192:193], v43 offset:0
  ds_read_b64_tr_b16 v[194:195], v43 offset:2048
  ds_read_b64_tr_b16 v[196:197], v43 offset:4096
  ds_read_b64_tr_b16 v[198:199], v43 offset:6144
  ds_read_b64_tr_b16 v[200:201], v43 offset:8192
  ds_read_b64_tr_b16 v[202:203], v43 offset:10240
  ds_read_b64_tr_b16 v[204:205], v43 offset:12288
  ds_read_b64_tr_b16 v[206:207], v43 offset:14336
  s_waitcnt vmcnt(8) lgkmcnt(0)
  s_barrier
  ds_read_b64_tr_b16 v[208:209], v43 offset:16384
  ds_read_b64_tr_b16 v[210:211], v43 offset:18432
  ds_read_b64_tr_b16 v[212:213], v43 offset:20480
  ds_read_b64_tr_b16 v[214:215], v43 offset:22528
  ds_read_b64_tr_b16 v[216:217], v43 offset:24576
  ds_read_b64_tr_b16 v[218:219], v43 offset:26624
  ds_read_b64_tr_b16 v[220:221], v43 offset:28672
  ds_read_b64_tr_b16 v[222:223], v43 offset:30720
  s_waitcnt vmcnt(4) lgkmcnt(0)
  s_barrier
  ds_read_b64_tr_b16 v[224:225], v43 offset:32768
  ds_read_b64_tr_b16 v[226:227], v43 offset:34816
  ds_read_b64_tr_b16 v[228:229], v43 offset:36864
  ds_read_b64_tr_b16 v[230:231], v43 offset:38912
  ds_read_b64_tr_b16 v[232:233], v43 offset:40960
  ds_read_b64_tr_b16 v[234:235], v43 offset:43008
  ds_read_b64_tr_b16 v[236:237], v43 offset:45056
  ds_read_b64_tr_b16 v[238:239], v43 offset:47104
  s_waitcnt vmcnt(0) lgkmcnt(0)
  s_barrier
  ds_read_b64_tr_b16 v[240:241], v43 offset:49152
  ds_read_b64_tr_b16 v[242:243], v43 offset:51200
  ds_read_b64_tr_b16 v[244:245], v43 offset:53248
  ds_read_b64_tr_b16 v[246:247], v43 offset:55296
  ds_read_b64_tr_b16 v[248:249], v43 offset:57344
  ds_read_b64_tr_b16 v[250:251], v43 offset:59392
  ds_read_b64_tr_b16 v[252:253], v43 offset:61440
  ds_read_b64_tr_b16 v[254:255], v43 offset:63488
  s_waitcnt lgkmcnt(0)
  s_barrier
  v_min_u32 v2, 31, v0
  v_lshlrev_b32 v2, 2, v2
  v_add_u32 v2, 128, v2
  s_nop 1
Lpoll_18:
  buffer_load_dword v3, v2, s[12:15], 0 offen sc1
  s_sub_u32 s24, s24, 1
  s_cbranch_scc1 L_FAIL
  s_waitcnt vmcnt(0)
  v_cmp_gt_i32 vcc, 1, v3
  s_cbranch_vccz Lpolld_19
  s_sleep 2
  s_branch Lpoll_18
Lpolld_19:
  v_min_u32 v2, 7, v0
  v_lshlrev_b32 v2, 2, v2
  v_add_u32 v2, 1388544, v2
  s_lshr_b32 s62, s21, 1
  s_lshl_b32 s62, s62, 7
  s_and_b32 s40, s21, 1
  s_lshl_b32 s40, s40, 2
  s_add_u32 s62, s62, s40
  s_add_u32 s62, s62, 1396736
  s_mov_b32 s27, 2097152
  s_lshr_b32 s40, s21, 1
  s_mul_i32 s40, s40, 24576
  s_add_u32 s31, s40, 58720256
  s_and_b32 s41, s21, 1
  s_lshl_b32 s42, s20, 11
  s_lshl_b32 s40, s41, 13
  s_add_u32 s40, s40, s42
  v_lshl_add_u32 v76, v0, 4, s40
  s_lshl_b32 s40, s41, 10
  s_add_u32 s40, s40, s42
  s_add_u32 s40, s40, 16384
  v_lshl_add_u32 v83, v0, 4, s40
  v_lshrrev_b32 v60, 3, v0
  v_and_b32 v61, 6, v60
  v_xor_b32 v61, v61, v0
  v_and_b32 v61, 7, v61
  v_lshlrev_b32 v61, 4, v61
  v_lshl_add_u32 v1, v60, 11, v61
  s_lshl_b32 s40, s20, 14
  v_add_u32 v1, s40, v1
  s_lshl_b32 s32, s20, 10
  v_and_b32 v60, 6, v0
  v_lshrrev_b32 v61, 4, v0
  v_xor_b32 v60, v60, v61
  v_lshlrev_b32 v60, 4, v60
  v_and_b32 v61, 15, v0
  v_lshl_add_u32 v77, v61, 7, v60
  v_xor_b32 v78, 64, v77
  s_lshl_b32 s40, s20, 2
  s_add_u32 s40, s40, 131072
  v_mov_b32 v79, s40
  v_mov_b32 v60, 0
  ds_write_b32 v79, v60
  s_mov_b32 s25, 0
  s_mov_b32 s26, 0
  s_mov_b32 s29, 1
  s_mov_b32 s30, 0
  s_mov_b32 s28, 1
  s_waitcnt lgkmcnt(0)
  s_barrier
  s_branch L_QKV_poll
L_QKV_top:
  s_cmp_lg_u32 s28, 0
  s_cbranch_scc1 L_QKV_go
  buffer_load_dword v3, v2, s[4:7], s30 offen sc1
  v_mov_b32 v60, s25
  v_and_b32 v61, 3, v0
  v_lshlrev_b32 v61, 2, v61
  v_add_u32 v61, 131072, v61
  s_waitcnt vmcnt(1)
  ds_write_b32 v79, v60
  ds_read_b32 v61, v61
  s_waitcnt lgkmcnt(0)
  v_cmp_gt_i32 vcc, s25, v61
  s_cbranch_vccnz L_QKV_nosig
  s_mov_b32 s63, s25
  s_atomic_smax s63, s[4:5], s62 glc
Lnosig_20:
L_QKV_nosig:
  s_cmp_ge_u32 s25, 64
  s_cbranch_scc1 L_END
  s_waitcnt vmcnt(0)
  v_cmp_gt_i32 vcc, s29, v3
  s_cbranch_vccz L_QKV_issue
L_QKV_poll:
  s_nop 3
Lpoll_21:
  buffer_load_dword v3, v2, s[4:7], s30 offen sc1
  s_sub_u32 s24, s24, 1
  s_cbranch_scc1 L_FAIL
  s_waitcnt vmcnt(0)
  v_cmp_gt_i32 vcc, s29, v3
  s_cbranch_vccz Lpolld_22
  s_sleep 2
  s_branch Lpoll_21
Lpolld_22:
L_QKV_issue:
  s_add_u32 s34, s26, s32
  s_mov_b32 s35, s27
  s_add_u32 m0, s34, 0
  s_nop 0
  buffer_load_dwordx4 v1, s[4:7], s35 offen offset:0 sc1 lds
  s_add_u32 m0, s34, 3968
  s_nop 0
  buffer_load_dwordx4 v1, s[4:7], s35 offen offset:128 sc1 lds
  s_add_u32 m0, s34, 7936
  s_nop 0
  buffer_load_dwordx4 v1, s[4:7], s35 offen offset:256 sc1 lds
  s_add_u32 m0, s34, 11904
  s_nop 0
  buffer_load_dwordx4 v1, s[4:7], s35 offen offset:384 sc1 lds
  s_add_u32 m0, s34, 15872
  s_nop 0
  buffer_load_dwordx4 v1, s[4:7], s35 offen offset:512 sc1 lds
  s_add_u32 m0, s34, 19840
  s_nop 0
  buffer_load_dwordx4 v1, s[4:7], s35 offen offset:640 sc1 lds
  s_add_u32 m0, s34, 23808
  s_nop 0
  buffer_load_dwordx4 v1, s[4:7], s35 offen offset:768 sc1 lds
  s_add_u32 m0, s34, 27776
  s_nop 0
  buffer_load_dwordx4 v1, s[4:7], s35 offen offset:896 sc1 lds
  s_add_u32 m0, s34, 31744
  s_nop 0
  buffer_load_dwordx4 v1, s[4:7], s35 offen offset:1024 sc1 lds
  s_add_u32 m0, s34, 35712
  s_nop 0
  buffer_load_dwordx4 v1, s[4:7], s35 offen offset:1152 sc1 lds
  s_add_u32 m0, s34, 39680
  s_nop 0
  buffer_load_dwordx4 v1, s[4:7], s35 offen offset:1280 sc1 lds
  s_add_u32 m0, s34, 43648
  s_nop 0
  buffer_load_dwordx4 v1, s[4:7], s35 offen offset:1408 sc1 lds
  s_add_u32 m0, s34, 47616
  s_nop 0
  buffer_load_dwordx4 v1, s[4:7], s35 offen offset:1536 sc1 lds
  s_add_u32 m0, s34, 51584
  s_nop 0
  buffer_load_dwordx4 v1, s[4:7], s35 offen offset:1664 sc1 lds
  s_add_u32 m0, s34, 55552
  s_nop 0
  buffer_load_dwordx4 v1, s[4:7], s35 offen offset:1792 sc1 lds
  s_add_u32 m0, s34, 59520
  s_nop 0
  buffer_load_dwordx4 v1, s[4:7], s35 offen offset:1920 sc1 lds
L_QKV_go:
  v_add_u32 v81, s26, v77
  v_add_u32 v82, s26, v78
  s_sub_u32 s26, 65536, s26
  s_add_u32 s27, s27, 65536
  s_add_u32 s34, s26, s32
  s_mov_b32 s35, s27
  s_add_u32 s30, s30, 128
  s_waitcnt vmcnt(12)
  s_barrier
  ds_read_b128 v[4:7], v81 offset:0
  ds_read_b128 v[8:11], v81 offset:2048
  ds_read_b128 v[12:15], v82 offset:0
  ds_read_b128 v[16:19], v82 offset:2048
  ds_read_b128 v[20:23], v81 offset:4096
  ds_read_b128 v[24:27], v81 offset:6144
  buffer_load_dword v3, v2, s[4:7], s30 offen sc1
  s_waitcnt lgkmcnt(4)
  v_mfma_f32_16x16x32_bf16 v[36:39], a[0:3], v[4:7], 0
  ds_read_b128 v[28:31], v82 offset:4096
  v_mfma_f32_16x16x32_bf16 v[40:43], a[0:3], v[8:11], 0
  ds_read_b128 v[32:35], v82 offset:6144
  v_mfma_f32_16x16x32_bf16 v[44:47], a[128:131], v[4:7], 0
  v_mfma_f32_16x16x32_bf16 v[48:51], a[128:131], v[8:11], 0
  v_mfma_f32_16x16x32_bf16 v[52:55], v[4:7], v[128:131], 0
  v_mfma_f32_16x16x32_bf16 v[56:59], v[8:11], v[128:131], 0
  s_waitcnt lgkmcnt(4)
  v_mfma_f32_16x16x32_bf16 v[36:39], a[4:7], v[12:15], v[36:39]
  ds_read_b128 v[4:7], v81 offset:8192
  v_mfma_f32_16x16x32_bf16 v[40:43], a[4:7], v[16:19], v[40:43]
  ds_read_b128 v[8:11], v81 offset:10240
  v_mfma_f32_16x16x32_bf16 v[44:47], a[132:135], v[12:15], v[44:47]
  v_mfma_f32_16x16x32_bf16 v[48:51], a[132:135], v[16:19], v[48:51]
  v_mfma_f32_16x16x32_bf16 v[52:55], v[12:15], v[132:135], v[52:55]
  v_mfma_f32_16x16x32_bf16 v[56:59], v[16:19], v[132:135], v[56:59]
  s_waitcnt lgkmcnt(4)
  v_mfma_f32_16x16x32_bf16 v[36:39], a[8:11], v[20:23], v[36:39]
  ds_read_b128 v[12:15], v82 offset:8192
  v_mfma_f32_16x16x32_bf16 v[40:43], a[8:11], v[24:27], v[40:43]
  ds_read_b128 v[16:19], v82 offset:10240
  v_mfma_f32_16x16x32_bf16 v[44:47], a[136:139], v[20:23], v[44:47]
  v_mfma_f32_16x16x32_bf16 v[48:51], a[136:139], v[24:27], v[48:51]
  v_mfma_f32_16x16x32_bf16 v[52:55], v[20:23], v[136:139], v[52:55]
  v_mfma_f32_16x16x32_bf16 v[56:59], v[24:27], v[136:139], v[56:59]
  s_waitcnt lgkmcnt(4)
  v_mfma_f32_16x16x32_bf16 v[36:39], a[12:15], v[28:31], v[36:39]
  ds_read_b128 v[20:23], v81 offset:12288
  v_mfma_f32_16x16x32_bf16 v[40:43], a[12:15], v[32:35], v[40:43]
  ds_read_b128 v[24:27], v81 offset:14336
  v_mfma_f32_16x16x32_bf16 v[44:47], a[140:143], v[28:31], v[44:47]
  v_mfma_f32_16x16x32_bf16 v[48:51], a[140:143], v[32:35], v[48:51]
  v_mfma_f32_16x16x32_bf16 v[52:55], v[28:31], v[140:143], v[52:55]
  v_mfma_f32_16x16x32_bf16 v[56:59], v[32:35], v[140:143], v[56:59]
  s_waitcnt lgkmcnt(4)
  v_mfma_f32_16x16x32_bf16 v[36:39], a[16:19], v[4:7], v[36:39]
  ds_read_b128 v[28:31], v82 offset:12288
  v_mfma_f32_16x16x32_bf16 v[40:43], a[16:19], v[8:11], v[40:43]
  ds_read_b128 v[32:35], v82 offset:14336
  v_mfma_f32_16x16x32_bf16 v[44:47], a[144:147], v[4:7], v[44:47]
  v_mfma_f32_16x16x32_bf16 v[48:51], a[144:147], v[8:11], v[48:51]
  v_mfma_f32_16x16x32_bf16 v[52:55], v[4:7], v[144:147], v[52:55]
  v_mfma_f32_16x16x32_bf16 v[56:59], v[8:11], v[144:147], v[56:59]
  s_waitcnt vmcnt(9)
  s_barrier
  s_waitcnt lgkmcnt(4)
  v_mfma_f32_16x16x32_bf16 v[36:39], a[20:23], v[12:15], v[36:39]
  ds_read_b128 v[4:7], v81 offset:16384
  v_mfma_f32_16x16x32_bf16 v[40:43], a[20:23], v[16:19], v[40:43]
  ds_read_b128 v[8:11], v81 offset:18432
  v_mfma_f32_16x16x32_bf16 v[44:47], a[148:151], v[12:15], v[44:47]
  v_mfma_f32_16x16x32_bf16 v[48:51], a[148:151], v[16:19], v[48:51]
  v_mfma_f32_16x16x32_bf16 v[52:55], v[12:15], v[148:151], v[52:55]
  v_mfma_f32_16x16x32_bf16 v[56:59], v[16:19], v[148:151], v[56:59]
  s_waitcnt lgkmcnt(4)
  v_mfma_f32_16x16x32_bf16 v[36:39], a[24:27], v[20:23], v[36:39]
  ds_read_b128 v[12:15], v82 offset:16384
  v_mfma_f32_16x16x32_bf16 v[40:43], a[24:27], v[24:27], v[40:43]
  ds_read_b128 v[16:19], v82 offset:18432
  v_mfma_f32_16x16x32_bf16 v[44:47], a[152:155], v[20:23], v[44:47]
  v_mfma_f32_16x16x32_bf16 v[48:51], a[152:155], v[24:27], v[48:51]
  v_mfma_f32_16x16x32_bf16 v[52:55], v[20:23], v[152:155], v[52:55]
  v_mfma_f32_16x16x32_bf16 v[56:59], v[24:27], v[152:155], v[56:59]
  s_waitcnt lgkmcnt(4)
  v_mfma_f32_16x16x32_bf16 v[36:39], a[28:31], v[28:31], v[36:39]
  ds_read_b128 v[20:23], v81 offset:20480
  v_mfma_f32_16x16x32_bf16 v[40:43], a[28:31], v[32:35], v[40:43]
  ds_read_b128 v[24:27], v81 offset:22528
  v_mfma_f32_16x16x32_bf16 v[44:47], a[156:159], v[28:31], v[44:47]
  v_mfma_f32_16x16x32_bf16 v[48:51], a[156:159], v[32:35], v[48:51]
  v_mfma_f32_16x16x32_bf16 v[52:55], v[28:31], v[156:159], v[52:55]
  v_mfma_f32_16x16x32_bf16 v[56:59], v[32:35], v[156:159], v[56:59]
  s_waitcnt lgkmcnt(4)
  v_mfma_f32_16x16x32_bf16 v[36:39], a[32:35], v[4:7], v[36:39]
  ds_read_b128 v[28:31], v82 offset:20480
  v_mfma_f32_16x16x32_bf16 v[40:43], a[32:35], v[8:11], v[40:43]
  ds_read_b128 v[32:35], v82 offset:22528
  v_mfma_f32_16x16x32_bf16 v[44:47], a[160:163], v[4:7], v[44:47]
  v_mfma_f32_16x16x32_bf16 v[48:51], a[160:163], v[8:11], v[48:51]
  v_mfma_f32_16x16x32_bf16 v[52:55], v[4:7], v[160:163], v[52:55]
  v_mfma_f32_16x16x32_bf16 v[56:59], v[8:11], v[160:163], v[56:59]
  s_waitcnt lgkmcnt(4)
  v_mfma_f32_16x16x32_bf16 v[36:39], a[36:39], v[12:15], v[36:39]
  ds_read_b128 v[4:7], v81 offset:24576
  v_mfma_f32_16x16x32_bf16 v[40:43], a[36:39], v[16:19], v[40:43]
  ds_read_b128 v[8:11], v81 offset:26624
  v_mfma_f32_16x16x32_bf16 v[44:47], a[164:167], v[12:15], v[44:47]
  v_mfma_f32_16x16x32_bf16 v[48:51], a[164:167], v[16:19], v[48:51]
  v_mfma_f32_16x16x32_bf16 v[52:55], v[12:15], v[164:167], v[52:55]
  v_mfma_f32_16x16x32_bf16 v[56:59], v[16:19], v[164:167], v[56:59]
  s_waitcnt lgkmcnt(4)
  v_mfma_f32_16x16x32_bf16 v[36:39], a[40:43], v[20:23], v[36:39]
  ds_read_b128 v[12:15], v82 offset:24576
  v_mfma_f32_16x16x32_bf16 v[40:43], a[40:43], v[24:27], v[40:43]
  ds_read_b128 v[16:19], v82 offset:26624
  v_mfma_f32_16x16x32_bf16 v[44:47], a[168:171], v[20:23], v[44:47]
  v_mfma_f32_16x16x32_bf16 v[48:51], a[168:171], v[24:27], v[48:51]
  v_mfma_f32_16x16x32_bf16 v[52:55], v[20:23], v[168:171], v[52:55]
  v_mfma_f32_16x16x32_bf16 v[56:59], v[24:27], v[168:171], v[56:59]
  s_waitcnt lgkmcnt(4)
  v_mfma_f32_16x16x32_bf16 v[36:39], a[44:47], v[28:31], v[36:39]
  ds_read_b128 v[20:23], v81 offset:28672
  v_mfma_f32_16x16x32_bf16 v[40:43], a[44:47], v[32:35], v[40:43]
  ds_read_b128 v[24:27], v81 offset:30720
  v_mfma_f32_16x16x32_bf16 v[44:47], a[172:175], v[28:31], v[44:47]
  v_mfma_f32_16x16x32_bf16 v[48:51], a[172:175], v[32:35], v[48:51]
  v_mfma_f32_16x16x32_bf16 v[52:55], v[28:31], v[172:175], v[52:55]
  v_mfma_f32_16x16x32_bf16 v[56:59], v[32:35], v[172:175], v[56:59]
  s_waitcnt lgkmcnt(4)
  v_mfma_f32_16x16x32_bf16 v[36:39], a[48:51], v[4:7], v[36:39]
  ds_read_b128 v[28:31], v82 offset:28672
  v_mfma_f32_16x16x32_bf16 v[40:43], a[48:51], v[8:11], v[40:43]
  ds_read_b128 v[32:35], v82 offset:30720
  v_mfma_f32_16x16x32_bf16 v[44:47], a[176:179], v[4:7], v[44:47]
  v_mfma_f32_16x16x32_bf16 v[48:51], a[176:179], v[8:11], v[48:51]
  v_mfma_f32_16x16x32_bf16 v[52:55], v[4:7], v[176:179], v[52:55]
  v_mfma_f32_16x16x32_bf16 v[56:59], v[8:11], v[176:179], v[56:59]
  s_waitcnt vmcnt(0)
  s_barrier
  v_cmp_gt_i32 vcc, s29, v3
  s_cmp_lg_u32 s20, 0
  s_cbranch_scc1 Lnosig_23
  s_mov_b32 s63, s25
  s_atomic_smax s63, s[4:5], s62 glc
Lnosig_23:
L_QKV_s2:
  s_mov_b32 s28, 0
  s_cbranch_vccnz L_QKV_nopf
  s_cmp_ge_u32 s25, 63
  s_cbranch_scc1 L_QKV_nopf
  s_mov_b32 s28, 1
  s_waitcnt lgkmcnt(4)
  v_mfma_f32_16x16x32_bf16 v[36:39], a[52:55], v[12:15], v[36:39]
  ds_read_b128 v[4:7], v81 offset:32768
  v_mfma_f32_16x16x32_bf16 v[40:43], a[52:55], v[16:19], v[40:43]
  ds_read_b128 v[8:11], v81 offset:34816
  v_mfma_f32_16x16x32_bf16 v[44:47], a[180:183], v[12:15], v[44:47]
  s_add_u32 m0, s34, 0
  s_nop 0
  buffer_load_dwordx4 v1, s[4:7], s35 offen offset:0 sc1 lds
  v_mfma_f32_16x16x32_bf16 v[48:51], a[180:183], v[16:19], v[48:51]
  v_mfma_f32_16x16x32_bf16 v[52:55], v[12:15], v[180:183], v[52:55]
  v_mfma_f32_16x16x32_bf16 v[56:59], v[16:19], v[180:183], v[56:59]
  s_waitcnt lgkmcnt(4)
  v_mfma_f32_16x16x32_bf16 v[36:39], a[56:59], v[20:23], v[36:39]
  ds_read_b128 v[12:15], v82 offset:32768
  v_mfma_f32_16x16x32_bf16 v[40:43], a[56:59], v[24:27], v[40:43]
  ds_read_b128 v[16:19], v82 offset:34816
  v_mfma_f32_16x16x32_bf16 v[44:47], a[184:187], v[20:23], v[44:47]
  s_add_u32 m0, s34, 3968
  s_nop 0
  buffer_load_dwordx4 v1, s[4:7], s35 offen offset:128 sc1 lds
  v_mfma_f32_16x16x32_bf16 v[48:51], a[184:187], v[24:27], v[48:51]
  v_mfma_f32_16x16x32_bf16 v[52:55], v[20:23], v[184:187], v[52:55]
  v_mfma_f32_16x16x32_bf16 v[56:59], v[24:27], v[184:187], v[56:59]
  s_waitcnt lgkmcnt(4)
  v_mfma_f32_16x16x32_bf16 v[36:39], a[60:63], v[28:31], v[36:39]
  ds_read_b128 v[20:23], v81 offset:36864
  v_mfma_f32_16x16x32_bf16 v[40:43], a[60:63], v[32:35], v[40:43]
  ds_read_b128 v[24:27], v81 offset:38912
  v_mfma_f32_16x16x32_bf16 v[44:47], a[188:191], v[28:31], v[44:47]
  s_add_u32 m0, s34, 7936
  s_nop 0
  buffer_load_dwordx4 v1, s[4:7], s35 offen offset:256 sc1 lds
  v_mfma_f32_16x16x32_bf16 v[48:51], a[188:191], v[32:35], v[48:51]
  v_mfma_f32_16x16x32_bf16 v[52:55], v[28:31], v[188:191], v[52:55]
  v_mfma_f32_16x16x32_bf16 v[56:59], v[32:35], v[188:191], v[56:59]
  s_waitcnt lgkmcnt(4)
  v_mfma_f32_16x16x32_bf16 v[36:39], a[64:67], v[4:7], v[36:39]
  ds_read_b128 v[28:31], v82 offset:36864
  v_mfma_f32_16x16x32_bf16 v[40:43], a[64:67], v[8:11], v[40:43]
  ds_read_b128 v[32:35], v82 offset:38912
  v_mfma_f32_16x16x32_bf16 v[44:47], a[192:195], v[4:7], v[44:47]
  s_add_u32 m0, s34, 11904
  s_nop 0
  buffer_load_dwordx4 v1, s[4:7], s35 offen offset:384 sc1 lds
  v_mfma_f32_16x16x32_bf16 v[48:51], a[192:195], v[8:11], v[48:51]
  v_mfma_f32_16x16x32_bf16 v[52:55], v[4:7], v[192:195], v[52:55]
  v_mfma_f32_16x16x32_bf16 v[56:59], v[8:11], v[192:195], v[56:59]
  s_waitcnt lgkmcnt(4)
  v_mfma_f32_16x16x32_bf16 v[36:39], a[68:71], v[12:15], v[36:39]
  ds_read_b128 v[4:7], v81 offset:40960
  v_mfma_f32_16x16x32_bf16 v[40:43], a[68:71], v[16:19], v[40:43]
  ds_read_b128 v[8:11], v81 offset:43008
  v_mfma_f32_16x16x32_bf16 v[44:47], a[196:199], v[12:15], v[44:47]
  s_add_u32 m0, s34, 15872
  s_nop 0
  buffer_load_dwordx4 v1, s[4:7], s35 offen offset:512 sc1 lds
  v_mfma_f32_16x16x32_bf16 v[48:51], a[196:199], v[16:19], v[48:51]
  v_mfma_f32_16x16x32_bf16 v[52:55], v[12:15], v[196:199], v[52:55]
  v_mfma_f32_16x16x32_bf16 v[56:59], v[16:19], v[196:199], v[56:59]
  s_waitcnt lgkmcnt(4)
  v_mfma_f32_16x16x32_bf16 v[36:39], a[72:75], v[20:23], v[36:39]
  ds_read_b128 v[12:15], v82 offset:40960
  v_mfma_f32_16x16x32_bf16 v[40:43], a[72:75], v[24:27], v[40:43]
  ds_read_b128 v[16:19], v82 offset:43008
  v_mfma_f32_16x16x32_bf16 v[44:47], a[200:203], v[20:23], v[44:47]
  s_add_u32 m0, s34, 19840
  s_nop 0
  buffer_load_dwordx4 v1, s[4:7], s35 offen offset:640 sc1 lds
  v_mfma_f32_16x16x32_bf16 v[48:51], a[200:203], v[24:27], v[48:51]
  v_mfma_f32_16x16x32_bf16 v[52:55], v[20:23], v[200:203], v[52:55]
  v_mfma_f32_16x16x32_bf16 v[56:59], v[24:27], v[200:203], v[56:59]
  s_waitcnt lgkmcnt(4)
  v_mfma_f32_16x16x32_bf16 v[36:39], a[76:79], v[28:31], v[36:39]
  ds_read_b128 v[20:23], v81 offset:45056
  v_mfma_f32_16x16x32_bf16 v[40:43], a[76:79], v[32:35], v[40:43]
  ds_read_b128 v[24:27], v81 offset:47104
  v_mfma_f32_16x16x32_bf16 v[44:47], a[204:207], v[28:31], v[44:47]
  s_add_u32 m0, s34, 23808
  s_nop 0
  buffer_load_dwordx4 v1, s[4:7], s35 offen offset:768 sc1 lds
  v_mfma_f32_16x16x32_bf16 v[48:51], a[204:207], v[32:35], v[48:51]
  v_mfma_f32_16x16x32_bf16 v[52:55], v[28:31], v[204:207], v[52:55]
  v_mfma_f32_16x16x32_bf16 v[56:59], v[32:35], v[204:207], v[56:59]
  s_waitcnt lgkmcnt(4)
  v_mfma_f32_16x16x32_bf16 v[36:39], a[80:83], v[4:7], v[36:39]
  ds_read_b128 v[28:31], v82 offset:45056
  v_mfma_f32_16x16x32_bf16 v[40:43], a[80:83], v[8:11], v[40:43]
  ds_read_b128 v[32:35], v82 offset:47104
  v_mfma_f32_16x16x32_bf16 v[44:47], a[208:211], v[4:7], v[44:47]
  s_add_u32 m0, s34, 27776
  s_nop 0
  buffer_load_dwordx4 v1, s[4:7], s35 offen offset:896 sc1 lds
  v_mfma_f32_16x16x32_bf16 v[48:51], a[208:211], v[8:11], v[48:51]
  v_mfma_f32_16x16x32_bf16 v[52:55], v[4:7], v[208:211], v[52:55]
  v_mfma_f32_16x16x32_bf16 v[56:59], v[8:11], v[208:211], v[56:59]
  s_waitcnt lgkmcnt(4)
  v_mfma_f32_16x16x32_bf16 v[36:39], a[84:87], v[12:15], v[36:39]
  ds_read_b128 v[4:7], v81 offset:49152
  v_mfma_f32_16x16x32_bf16 v[40:43], a[84:87], v[16:19], v[40:43]
  ds_read_b128 v[8:11], v81 offset:51200
  v_mfma_f32_16x16x32_bf16 v[44:47], a[212:215], v[12:15], v[44:47]
  s_add_u32 m0, s34, 31744
  s_nop 0
  buffer_load_dwordx4 v1, s[4:7], s35 offen offset:1024 sc1 lds
  v_mfma_f32_16x16x32_bf16 v[48:51], a[212:215], v[16:19], v[48:51]
  v_mfma_f32_16x16x32_bf16 v[52:55], v[12:15], v[212:215], v[52:55]
  v_mfma_f32_16x16x32_bf16 v[56:59], v[16:19], v[212:215], v[56:59]
  s_waitcnt lgkmcnt(4)
  v_mfma_f32_16x16x32_bf16 v[36:39], a[88:91], v[20:23], v[36:39]
  ds_read_b128 v[12:15], v82 offset:49152
  v_mfma_f32_16x16x32_bf16 v[40:43], a[88:91], v[24:27], v[40:43]
  ds_read_b128 v[16:19], v82 offset:51200
  v_mfma_f32_16x16x32_bf16 v[44:47], a[216:219], v[20:23], v[44:47]
  s_add_u32 m0, s34, 35712
  s_nop 0
  buffer_load_dwordx4 v1, s[4:7], s35 offen offset:1152 sc1 lds
  v_mfma_f32_16x16x32_bf16 v[48:51], a[216:219], v[24:27], v[48:51]
  v_mfma_f32_16x16x32_bf16 v[52:55], v[20:23], v[216:219], v[52:55]
  v_mfma_f32_16x16x32_bf16 v[56:59], v[24:27], v[216:219], v[56:59]
  s_waitcnt lgkmcnt(4)
  v_mfma_f32_16x16x32_bf16 v[36:39], a[92:95], v[28:31], v[36:39]
  ds_read_b128 v[20:23], v81 offset:53248
  v_mfma_f32_16x16x32_bf16 v[40:43], a[92:95], v[32:35], v[40:43]
  ds_read_b128 v[24:27], v81 offset:55296
  v_mfma_f32_16x16x32_bf16 v[44:47], a[220:223], v[28:31], v[44:47]
  s_add_u32 m0, s34, 39680
  s_nop 0
  buffer_load_dwordx4 v1, s[4:7], s35 offen offset:1280 sc1 lds
  v_mfma_f32_16x16x32_bf16 v[48:51], a[220:223], v[32:35], v[48:51]
  v_mfma_f32_16x16x32_bf16 v[52:55], v[28:31], v[220:223], v[52:55]
  v_mfma_f32_16x16x32_bf16 v[56:59], v[32:35], v[220:223], v[56:59]
  s_waitcnt lgkmcnt(4)
  v_mfma_f32_16x16x32_bf16 v[36:39], a[96:99], v[4:7], v[36:39]
  ds_read_b128 v[28:31], v82 offset:53248
  v_mfma_f32_16x16x32_bf16 v[40:43], a[96:99], v[8:11], v[40:43]
  ds_read_b128 v[32:35], v82 offset:55296
  v_mfma_f32_16x16x32_bf16 v[44:47], a[224:227], v[4:7], v[44:47]
  s_add_u32 m0, s34, 43648
  s_nop 0
  buffer_load_dwordx4 v1, s[4:7], s35 offen offset:1408 sc1 lds
  v_mfma_f32_16x16x32_bf16 v[48:51], a[224:227], v[8:11], v[48:51]
  v_mfma_f32_16x16x32_bf16 v[52:55], v[4:7], v[224:227], v[52:55]
  v_mfma_f32_16x16x32_bf16 v[56:59], v[8:11], v[224:227], v[56:59]
  s_waitcnt lgkmcnt(4)
  v_mfma_f32_16x16x32_bf16 v[36:39], a[100:103], v[12:15], v[36:39]
  ds_read_b128 v[4:7], v81 offset:57344
  v_mfma_f32_16x16x32_bf16 v[40:43], a[100:103], v[16:19], v[40:43]
  ds_read_b128 v[8:11], v81 offset:59392
  v_mfma_f32_16x16x32_bf16 v[44:47], a[228:231], v[12:15], v[44:47]
  s_add_u32 m0, s34, 47616
  s_nop 0
  buffer_load_dwordx4 v1, s[4:7], s35 offen offset:1536 sc1 lds
  v_mfma_f32_16x16x32_bf16 v[48:51], a[228:231], v[16:19], v[48:51]
  v_mfma_f32_16x16x32_bf16 v[52:55], v[12:15], v[228:231], v[52:55]
  v_mfma_f32_16x16x32_bf16 v[56:59], v[16:19], v[228:231], v[56:59]
  s_waitcnt lgkmcnt(4)
  v_mfma_f32_16x16x32_bf16 v[36:39], a[104:107], v[20:23], v[36:39]
  ds_read_b128 v[12:15], v82 offset:57344
  v_mfma_f32_16x16x32_bf16 v[40:43], a[104:107], v[24:27], v[40:43]
  ds_read_b128 v[16:19], v82 offset:59392
  v_mfma_f32_16x16x32_bf16 v[44:47], a[232:235], v[20:23], v[44:47]
  s_add_u32 m0, s34, 51584
  s_nop 0
  buffer_load_dwordx4 v1, s[4:7], s35 offen offset:1664 sc1 lds
  v_mfma_f32_16x16x32_bf16 v[48:51], a[232:235], v[24:27], v[48:51]
  v_mfma_f32_16x16x32_bf16 v[52:55], v[20:23], v[232:235], v[52:55]
  v_mfma_f32_16x16x32_bf16 v[56:59], v[24:27], v[232:235], v[56:59]
  s_waitcnt lgkmcnt(4)
  v_mfma_f32_16x16x32_bf16 v[36:39], a[108:111], v[28:31], v[36:39]
  ds_read_b128 v[20:23], v81 offset:61440
  v_mfma_f32_16x16x32_bf16 v[40:43], a[108:111], v[32:35], v[40:43]
  ds_read_b128 v[24:27], v81 offset:63488
  v_mfma_f32_16x16x32_bf16 v[44:47], a[236:239], v[28:31], v[44:47]
  s_add_u32 m0, s34, 55552
  s_nop 0
  buffer_load_dwordx4 v1, s[4:7], s35 offen offset:1792 sc1 lds
  v_mfma_f32_16x16x32_bf16 v[48:51], a[236:239], v[32:35], v[48:51]
  v_mfma_f32_16x16x32_bf16 v[52:55], v[28:31], v[236:239], v[52:55]
  v_mfma_f32_16x16x32_bf16 v[56:59], v[32:35], v[236:239], v[56:59]
  s_waitcnt lgkmcnt(4)
  v_mfma_f32_16x16x32_bf16 v[36:39], a[112:115], v[4:7], v[36:39]
  ds_read_b128 v[28:31], v82 offset:61440
  v_mfma_f32_16x16x32_bf16 v[40:43], a[112:115], v[8:11], v[40:43]
  ds_read_b128 v[32:35], v82 offset:63488
  v_mfma_f32_16x16x32_bf16 v[44:47], a[240:243], v[4:7], v[44:47]
  s_add_u32 m0, s34, 59520
  s_nop 0
  buffer_load_dwordx4 v1, s[4:7], s35 offen offset:1920 sc1 lds
  v_mfma_f32_16x16x32_bf16 v[48:51], a[240:243], v[8:11], v[48:51]
  v_mfma_f32_16x16x32_bf16 v[52:55], v[4:7], v[240:243], v[52:55]
  v_mfma_f32_16x16x32_bf16 v[56:59], v[8:11], v[240:243], v[56:59]
  s_waitcnt lgkmcnt(4)
  v_mfma_f32_16x16x32_bf16 v[36:39], a[116:119], v[12:15], v[36:39]
  v_mfma_f32_16x16x32_bf16 v[40:43], a[116:119], v[16:19], v[40:43]
  v_mfma_f32_16x16x32_bf16 v[44:47], a[244:247], v[12:15], v[44:47]
  v_mfma_f32_16x16x32_bf16 v[48:51], a[244:247], v[16:19], v[48:51]
  v_mfma_f32_16x16x32_bf16 v[52:55], v[12:15], v[244:247], v[52:55]
  v_mfma_f32_16x16x32_bf16 v[56:59], v[16:19], v[244:247], v[56:59]
  s_waitcnt lgkmcnt(2)
  v_mfma_f32_16x16x32_bf16 v[36:39], a[120:123], v[20:23], v[36:39]
  v_mfma_f32_16x16x32_bf16 v[40:43], a[120:123], v[24:27], v[40:43]
  v_mfma_f32_16x16x32_bf16 v[44:47], a[248:251], v[20:23], v[44:47]
  v_mfma_f32_16x16x32_bf16 v[48:51], a[248:251], v[24:27], v[48:51]
  v_mfma_f32_16x16x32_bf16 v[52:55], v[20:23], v[248:251], v[52:55]
  v_mfma_f32_16x16x32_bf16 v[56:59], v[24:27], v[248:251], v[56:59]
  s_waitcnt lgkmcnt(0)
  v_mfma_f32_16x16x32_bf16 v[36:39], a[124:127], v[28:31], v[36:39]
  v_mfma_f32_16x16x32_bf16 v[40:43], a[124:127], v[32:35], v[40:43]
  v_mfma_f32_16x16x32_bf16 v[44:47], a[252:255], v[28:31], v[44:47]
  v_mfma_f32_16x16x32_bf16 v[48:51], a[252:255], v[32:35], v[48:51]
  v_mfma_f32_16x16x32_bf16 v[52:55], v[28:31], v[252:255], v[52:55]
  v_mfma_f32_16x16x32_bf16 v[56:59], v[32:35], v[252:255], v[56:59]
  s_nop 7
  s_branch L_QKV_epi
L_QKV_nopf:
  s_waitcnt lgkmcnt(4)
  v_mfma_f32_16x16x32_bf16 v[36:39], a[52:55], v[12:15], v[36:39]
  ds_read_b128 v[4:7], v81 offset:32768
  v_mfma_f32_16x16x32_bf16 v[40:43], a[52:55], v[16:19], v[40:43]
  ds_read_b128 v[8:11], v81 offset:34816
  v_mfma_f32_16x16x32_bf16 v[44:47], a[180:183], v[12:15], v[44:47]
  v_mfma_f32_16x16x32_bf16 v[48:51], a[180:183], v[16:19], v[48:51]
  v_mfma_f32_16x16x32_bf16 v[52:55], v[12:15], v[180:183], v[52:55]
  v_mfma_f32_16x16x32_bf16 v[56:59], v[16:19], v[180:183], v[56:59]
  s_waitcnt lgkmcnt(4)
  v_mfma_f32_16x16x32_bf16 v[36:39], a[56:59], v[20:23], v[36:39]
  ds_read_b128 v[12:15], v82 offset:32768
  v_mfma_f32_16x16x32_bf16 v[40:43], a[56:59], v[24:27], v[40:43]
  ds_read_b128 v[16:19], v82 offset:34816
  v_mfma_f32_16x16x32_bf16 v[44:47], a[184:187], v[20:23], v[44:47]
  v_mfma_f32_16x16x32_bf16 v[48:51], a[184:187], v[24:27], v[48:51]
  v_mfma_f32_16x16x32_bf16 v[52:55], v[20:23], v[184:187], v[52:55]
  v_mfma_f32_16x16x32_bf16 v[56:59], v[24:27], v[184:187], v[56:59]
  s_waitcnt lgkmcnt(4)
  v_mfma_f32_16x16x32_bf16 v[36:39], a[60:63], v[28:31], v[36:39]
  ds_read_b128 v[20:23], v81 offset:36864
  v_mfma_f32_16x16x32_bf16 v[40:43], a[60:63], v[32:35], v[40:43]
  ds_read_b128 v[24:27], v81 offset:38912
  v_mfma_f32_16x16x32_bf16 v[44:47], a[188:191], v[28:31], v[44:47]
  v_mfma_f32_16x16x32_bf16 v[48:51], a[188:191], v[32:35], v[48:51]
  v_mfma_f32_16x16x32_bf16 v[52:55], v[28:31], v[188:191], v[52:55]
  v_mfma_f32_16x16x32_bf16 v[56:59], v[32:35], v[188:191], v[56:59]
  s_waitcnt lgkmcnt(4)
  v_mfma_f32_16x16x32_bf16 v[36:39], a[64:67], v[4:7], v[36:39]
  ds_read_b128 v[28:31], v82 offset:36864
  v_mfma_f32_16x16x32_bf16 v[40:43], a[64:67], v[8:11], v[40:43]
  ds_read_b128 v[32:35], v82 offset:38912
  v_mfma_f32_16x16x32_bf16 v[44:47], a[192:195], v[4:7], v[44:47]
  v_mfma_f32_16x16x32_bf16 v[48:51], a[192:195], v[8:11], v[48:51]
  v_mfma_f32_16x16x32_bf16 v[52:55], v[4:7], v[192:195], v[52:55]
  v_mfma_f32_16x16x32_bf16 v[56:59], v[8:11], v[192:195], v[56:59]
  s_waitcnt lgkmcnt(4)
  v_mfma_f32_16x16x32_bf16 v[36:39], a[68:71], v[12:15], v[36:39]
  ds_read_b128 v[4:7], v81 offset:40960
  v_mfma_f32_16x16x32_bf16 v[40:43], a[68:71], v[16:19], v[40:43]
  ds_read_b128 v[8:11], v81 offset:43008
  v_mfma_f32_16x16x32_bf16 v[44:47], a[196:199], v[12:15], v[44:47]
  v_mfma_f32_16x16x32_bf16 v[48:51], a[196:199], v[16:19], v[48:51]
  v_mfma_f32_16x16x32_bf16 v[52:55], v[12:15], v[196:199], v[52:55]
  v_mfma_f32_16x16x32_bf16 v[56:59], v[16:19], v[196:199], v[56:59]
  s_waitcnt lgkmcnt(4)
  v_mfma_f32_16x16x32_bf16 v[36:39], a[72:75], v[20:23], v[36:39]
  ds_read_b128 v[12:15], v82 offset:40960
  v_mfma_f32_16x16x32_bf16 v[40:43], a[72:75], v[24:27], v[40:43]
  ds_read_b128 v[16:19], v82 offset:43008
  v_mfma_f32_16x16x32_bf16 v[44:47], a[200:203], v[20:23], v[44:47]
  v_mfma_f32_16x16x32_bf16 v[48:51], a[200:203], v[24:27], v[48:51]
  v_mfma_f32_16x16x32_bf16 v[52:55], v[20:23], v[200:203], v[52:55]
  v_mfma_f32_16x16x32_bf16 v[56:59], v[24:27], v[200:203], v[56:59]
  s_waitcnt lgkmcnt(4)
  v_mfma_f32_16x16x32_bf16 v[36:39], a[76:79], v[28:31], v[36:39]
  ds_read_b128 v[20:23], v81 offset:45056
  v_mfma_f32_16x16x32_bf16 v[40:43], a[76:79], v[32:35], v[40:43]
  ds_read_b128 v[24:27], v81 offset:47104
  v_mfma_f32_16x16x32_bf16 v[44:47], a[204:207], v[28:31], v[44:47]
  v_mfma_f32_16x16x32_bf16 v[48:51], a[204:207], v[32:35], v[48:51]
  v_mfma_f32_16x16x32_bf16 v[52:55], v[28:31], v[204:207], v[52:55]
  v_mfma_f32_16x16x32_bf16 v[56:59], v[32:35], v[204:207], v[56:59]
  s_waitcnt lgkmcnt(4)
  v_mfma_f32_16x16x32_bf16 v[36:39], a[80:83], v[4:7], v[36:39]
  ds_read_b128 v[28:31], v82 offset:45056
  v_mfma_f32_16x16x32_bf16 v[40:43], a[80:83], v[8:11], v[40:43]
  ds_read_b128 v[32:35], v82 offset:47104
  v_mfma_f32_16x16x32_bf16 v[44:47], a[208:211], v[4:7], v[44:47]
  v_mfma_f32_16x16x32_bf16 v[48:51], a[208:211], v[8:11], v[48:51]
  v_mfma_f32_16x16x32_bf16 v[52:55], v[4:7], v[208:211], v[52:55]
  v_mfma_f32_16x16x32_bf16 v[56:59], v[8:11], v[208:211], v[56:59]
  s_waitcnt lgkmcnt(4)
  v_mfma_f32_16x16x32_bf16 v[36:39], a[84:87], v[12:15], v[36:39]
  ds_read_b128 v[4:7], v81 offset:49152
  v_mfma_f32_16x16x32_bf16 v[40:43], a[84:87], v[16:19], v[40:43]
  ds_read_b128 v[8:11], v81 offset:51200
  v_mfma_f32_16x16x32_bf16 v[44:47], a[212:215], v[12:15], v[44:47]
  v_mfma_f32_16x16x32_bf16 v[48:51], a[212:215], v[16:19], v[48:51]
  v_mfma_f32_16x16x32_bf16 v[52:55], v[12:15], v[212:215], v[52:55]
  v_mfma_f32_16x16x32_bf16 v[56:59], v[16:19], v[212:215], v[56:59]
  s_waitcnt lgkmcnt(4)
  v_mfma_f32_16x16x32_bf16 v[36:39], a[88:91], v[20:23], v[36:39]
  ds_read_b128 v[12:15], v82 offset:49152
  v_mfma_f32_16x16x32_bf16 v[40:43], a[88:91], v[24:27], v[40:43]
  ds_read_b128 v[16:19], v82 offset:51200
  v_mfma_f32_16x16x32_bf16 v[44:47], a[216:219], v[20:23], v[44:47]
  v_mfma_f32_16x16x32_bf16 v[48:51], a[216:219], v[24:27], v[48:51]
  v_mfma_f32_16x16x32_bf16 v[52:55], v[20:23], v[216:219], v[52:55]
  v_mfma_f32_16x16x32_bf16 v[56:59], v[24:27], v[216:219], v[56:59]
  s_waitcnt lgkmcnt(4)
  v_mfma_f32_16x16x32_bf16 v[36:39], a[92:95], v[28:31], v[36:39]
  ds_read_b128 v[20:23], v81 offset:53248
  v_mfma_f32_16x16x32_bf16 v[40:43], a[92:95], v[32:35], v[40:43]
  ds_read_b128 v[24:27], v81 offset:55296
  v_mfma_f32_16x16x32_bf16 v[44:47], a[220:223], v[28:31], v[44:47]
  v_mfma_f32_16x16x32_bf16 v[48:51], a[220:223], v[32:35], v[48:51]
  v_mfma_f32_16x16x32_bf16 v[52:55], v[28:31], v[220:223], v[52:55]
  v_mfma_f32_16x16x32_bf16 v[56:59], v[32:35], v[220:223], v[56:59]
  s_waitcnt lgkmcnt(4)
  v_mfma_f32_16x16x32_bf16 v[36:39], a[96:99], v[4:7], v[36:39]
  ds_read_b128 v[28:31], v82 offset:53248
  v_mfma_f32_16x16x32_bf16 v[40:43], a[96:99], v[8:11], v[40:43]
  ds_read_b128 v[32:35], v82 offset:55296
  v_mfma_f32_16x16x32_bf16 v[44:47], a[224:227], v[4:7], v[44:47]
  v_mfma_f32_16x16x32_bf16 v[48:51], a[224:227], v[8:11], v[48:51]
  v_mfma_f32_16x16x32_bf16 v[52:55], v[4:7], v[224:227], v[52:55]
  v_mfma_f32_16x16x32_bf16 v[56:59], v[8:11], v[224:227], v[56:59]
  s_waitcnt lgkmcnt(4)
  v_mfma_f32_16x16x32_bf16 v[36:39], a[100:103], v[12:15], v[36:39]
  ds_read_b128 v[4:7], v81 offset:57344
  v_mfma_f32_16x16x32_bf16 v[40:43], a[100:103], v[16:19], v[40:43]
  ds_read_b128 v[8:11], v81 offset:59392
  v_mfma_f32_16x16x32_bf16 v[44:47], a[228:231], v[12:15], v[44:47]
  v_mfma_f32_16x16x32_bf16 v[48:51], a[228:231], v[16:19], v[48:51]
  v_mfma_f32_16x16x32_bf16 v[52:55], v[12:15], v[228:231], v[52:55]
  v_mfma_f32_16x16x32_bf16 v[56:59], v[16:19], v[228:231], v[56:59]
  s_waitcnt lgkmcnt(4)
  v_mfma_f32_16x16x32_bf16 v[36:39], a[104:107], v[20:23], v[36:39]
  ds_read_b128 v[12:15], v82 offset:57344
  v_mfma_f32_16x16x32_bf16 v[40:43], a[104:107], v[24:27], v[40:43]
  ds_read_b128 v[16:19], v82 offset:59392
  v_mfma_f32_16x16x32_bf16 v[44:47], a[232:235], v[20:23], v[44:47]
  v_mfma_f32_16x16x32_bf16 v[48:51], a[232:235], v[24:27], v[48:51]
  v_mfma_f32_16x16x32_bf16 v[52:55], v[20:23], v[232:235], v[52:55]
  v_mfma_f32_16x16x32_bf16 v[56:59], v[24:27], v[232:235], v[56:59]
  s_waitcnt lgkmcnt(4)
  v_mfma_f32_16x16x32_bf16 v[36:39], a[108:111], v[28:31], v[36:39]
  ds_read_b128 v[20:23], v81 offset:61440
  v_mfma_f32_16x16x32_bf16 v[40:43], a[108:111], v[32:35], v[40:43]
  ds_read_b128 v[24:27], v81 offset:63488
  v_mfma_f32_16x16x32_bf16 v[44:47], a[236:239], v[28:31], v[44:47]
  v_mfma_f32_16x16x32_bf16 v[48:51], a[236:239], v[32:35], v[48:51]
  v_mfma_f32_16x16x32_bf16 v[52:55], v[28:31], v[236:239], v[52:55]
  v_mfma_f32_16x16x32_bf16 v[56:59], v[32:35], v[236:239], v[56:59]
  s_waitcnt lgkmcnt(4)
  v_mfma_f32_16x16x32_bf16 v[36:39], a[112:115], v[4:7], v[36:39]
  ds_read_b128 v[28:31], v82 offset:61440
  v_mfma_f32_16x16x32_bf16 v[40:43], a[112:115], v[8:11], v[40:43]
  ds_read_b128 v[32:35], v82 offset:63488
  v_mfma_f32_16x16x32_bf16 v[44:47], a[240:243], v[4:7], v[44:47]
  v_mfma_f32_16x16x32_bf16 v[48:51], a[240:243], v[8:11], v[48:51]
  v_mfma_f32_16x16x32_bf16 v[52:55], v[4:7], v[240:243], v[52:55]
  v_mfma_f32_16x16x32_bf16 v[56:59], v[8:11], v[240:243], v[56:59]
  s_waitcnt lgkmcnt(4)
  v_mfma_f32_16x16x32_bf16 v[36:39], a[116:119], v[12:15], v[36:39]
  v_mfma_f32_16x16x32_bf16 v[40:43], a[116:119], v[16:19], v[40:43]
  v_mfma_f32_16x16x32_bf16 v[44:47], a[244:247], v[12:15], v[44:47]
  v_mfma_f32_16x16x32_bf16 v[48:51], a[244:247], v[16:19], v[48:51]
  v_mfma_f32_16x16x32_bf16 v[52:55], v[12:15], v[244:247], v[52:55]
  v_mfma_f32_16x16x32_bf16 v[56:59], v[16:19], v[244:247], v[56:59]
  s_waitcnt lgkmcnt(2)
  v_mfma_f32_16x16x32_bf16 v[36:39], a[120:123], v[20:23], v[36:39]
  v_mfma_f32_16x16x32_bf16 v[40:43], a[120:123], v[24:27], v[40:43]
  v_mfma_f32_16x16x32_bf16 v[44:47], a[248:251], v[20:23], v[44:47]
  v_mfma_f32_16x16x32_bf16 v[48:51], a[248:251], v[24:27], v[48:51]
  v_mfma_f32_16x16x32_bf16 v[52:55], v[20:23], v[248:251], v[52:55]
  v_mfma_f32_16x16x32_bf16 v[56:59], v[24:27], v[248:251], v[56:59]
  s_waitcnt lgkmcnt(0)
  v_mfma_f32_16x16x32_bf16 v[36:39], a[124:127], v[28:31], v[36:39]
  v_mfma_f32_16x16x32_bf16 v[40:43], a[124:127], v[32:35], v[40:43]
  v_mfma_f32_16x16x32_bf16 v[44:47], a[252:255], v[28:31], v[44:47]
  v_mfma_f32_16x16x32_bf16 v[48:51], a[252:255], v[32:35], v[48:51]
  v_mfma_f32_16x16x32_bf16 v[52:55], v[28:31], v[252:255], v[52:55]
  v_mfma_f32_16x16x32_bf16 v[56:59], v[32:35], v[252:255], v[56:59]
L_QKV_epi:
  s_nop 2
  v_cvt_pk_bf16_f32 v60, v36, v37
  v_cvt_pk_bf16_f32 v61, v38, v39
  v_cvt_pk_bf16_f32 v62, v44, v45
  v_cvt_pk_bf16_f32 v63, v46, v47
  buffer_store_dwordx4 v[60:63], v76, s[4:7], s31 offen offset:0 sc1
  v_cvt_pk_bf16_f32 v64, v40, v41
  v_cvt_pk_bf16_f32 v65, v42, v43
  v_cvt_pk_bf16_f32 v66, v48, v49
  v_cvt_pk_bf16_f32 v67, v50, v51
  buffer_store_dwordx4 v[64:67], v76, s[4:7], s31 offen offset:1024 sc1
  v_cvt_pk_bf16_f32 v68, v52, v53
  v_cvt_pk_bf16_f32 v69, v54, v55
  v_cvt_pk_bf16_f32 v70, v56, v57
  v_cvt_pk_bf16_f32 v71, v58, v59
  buffer_store_dwordx4 v[68:71], v83, s[4:7], s31 offen sc1
  s_add_u32 s25, s25, 1
  s_add_u32 s31, s31, 786432
  s_branch L_QKV_top
L_WO:
  s_load_dwordx2 s[8:9], s[0:1], 40
  s_mov_b32 s10, 8388608
  s_mov_b32 s11, 0x20000
  s_waitcnt lgkmcnt(0)
  s_lshr_b32 s44, s21, 3
  s_mul_i32 s44, s44, 2097152
  s_and_b32 s45, s21, 7
  s_lshl_b32 s45, s45, 8
  s_add_u32 s44, s44, s45
  s_add_u32 s45, s44, 128
  v_bfe_u32 v40, v0, 5, 1
  v_mul_u32_u24 v40, 8192, v40
  v_bfe_u32 v41, v0, 4, 1
  v_mul_u32_u24 v41, 4096, v41
  v_add_u32 v40, v40, v41
  v_bfe_u32 v41, v0, 3, 1
  v_mul_u32_u24 v41, 2048, v41
  v_add_u32 v40, v40, v41
  v_lshrrev_b32 v41, 3, v0
  v_and_b32 v41, 6, v41
  v_xor_b32 v41, v41, v0
  v_and_b32 v41, 7, v41
  v_lshl_add_u32 v40, v41, 4, v40
  s_lshr_b32 s40, s20, 1
  s_mul_i32 s40, s40, 131072
  s_and_b32 s41, s20, 1
  s_mul_i32 s41, s41, 16384
  s_add_u32 s40, s40, s41
  v_add_u32 v40, s40, v40
  v_bfe_u32 v41, v0, 3, 2
  v_xor_b32 v41, s20, v41
  v_lshlrev_b32 v41, 5, v41
  v_lshrrev_b32 v42, 2, v0
  v_lshl_add_u32 v42, v42, 7, v41
  v_and_b32 v41, 3, v0
  v_lshl_add_u32 v42, v41, 3, v42
  v_add_u32 v43, 0x10000, v42
  v_add_u32 v44, s44, v40
  v_add_u32 v45, s45, v40
  s_lshl_b32 s41, s20, 10
  s_add_u32 m0, s41, 0
  s_mov_b32 s42, 0
  buffer_load_dwordx4 v44, s[8:11], s42 offen nt lds
  s_add_u32 m0, s41, 4096
  s_mov_b32 s42, 0
  buffer_load_dwordx4 v45, s[8:11], s42 offen nt lds
  s_add_u32 m0, s41, 8192
  s_mov_b32 s42, 32768
  buffer_load_dwordx4 v44, s[8:11], s42 offen nt lds
  s_add_u32 m0, s41, 12288
  s_mov_b32 s42, 32768
  buffer_load_dwordx4 v45, s[8:11], s42 offen nt lds
  s_add_u32 m0, s41, 16384
  s_mov_b32 s42, 65536
  buffer_load_dwordx4 v44, s[8:11], s42 offen nt lds
  s_add_u32 m0, s41, 20480
  s_mov_b32 s42, 65536
  buffer_load_dwordx4 v45, s[8:11], s42 offen nt lds
  s_add_u32 m0, s41, 24576
  s_mov_b32 s42, 98304
  buffer_load_dwordx4 v44, s[8:11], s42 offen nt lds
  s_add_u32 m0, s41, 28672
  s_mov_b32 s42, 98304
  buffer_load_dwordx4 v45, s[8:11], s42 offen nt lds
  s_add_u32 m0, s41, 32768
  s_mov_b32 s42, 262144
  buffer_load_dwordx4 v44, s[8:11], s42 offen nt lds
  s_add_u32 m0, s41, 36864
  s_mov_b32 s42, 262144
  buffer_load_dwordx4 v45, s[8:11], s42 offen nt lds
  s_add_u32 m0, s41, 40960
  s_mov_b32 s42, 294912
  buffer_load_dwordx4 v44, s[8:11], s42 offen nt lds
  s_add_u32 m0, s41, 45056
  s_mov_b32 s42, 294912
  buffer_load_dwordx4 v45, s[8:11], s42 offen nt lds
  s_add_u32 m0, s41, 49152
  s_mov_b32 s42, 327680
  buffer_load_dwordx4 v44, s[8:11], s42 offen nt lds
  s_add_u32 m0, s41, 53248
  s_mov_b32 s42, 327680
  buffer_load_dwordx4 v45, s[8:11], s42 offen nt lds
  s_add_u32 m0, s41, 57344
  s_mov_b32 s42, 360448
  buffer_load_dwordx4 v44, s[8:11], s42 offen nt lds
  s_add_u32 m0, s41, 61440
  s_mov_b32 s42, 360448
  buffer_load_dwordx4 v45, s[8:11], s42 offen nt lds
  s_add_u32 m0, s41, 65536
  s_mov_b32 s42, 524288
  buffer_load_dwordx4 v44, s[8:11], s42 offen nt lds
  s_add_u32 m0, s41, 69632
  s_mov_b32 s42, 524288
  buffer_load_dwordx4 v45, s[8:11], s42 offen nt lds
  s_add_u32 m0, s41, 73728
  s_mov_b32 s42, 557056
  buffer_load_dwordx4 v44, s[8:11], s42 offen nt lds
  s_add_u32 m0, s41, 77824
  s_mov_b32 s42, 557056
  buffer_load_dwordx4 v45, s[8:11], s42 offen nt lds
  s_add_u32 m0, s41, 81920
  s_mov_b32 s42, 589824
  buffer_load_dwordx4 v44, s[8:11], s42 offen nt lds
  s_add_u32 m0, s41, 86016
  s_mov_b32 s42, 589824
  buffer_load_dwordx4 v45, s[8:11], s42 offen nt lds
  s_add_u32 m0, s41, 90112
  s_mov_b32 s42, 622592
  buffer_load_dwordx4 v44, s[8:11], s42 offen nt lds
  s_add_u32 m0, s41, 94208
  s_mov_b32 s42, 622592
  buffer_load_dwordx4 v45, s[8:11], s42 offen nt lds
  s_add_u32 m0, s41, 98304
  s_mov_b32 s42, 786432
  buffer_load_dwordx4 v44, s[8:11], s42 offen nt lds
  s_add_u32 m0, s41, 102400
  s_mov_b32 s42, 786432
  buffer_load_dwordx4 v45, s[8:11], s42 offen nt lds
  s_add_u32 m0, s41, 106496
  s_mov_b32 s42, 819200
  buffer_load_dwordx4 v44, s[8:11], s42 offen nt lds
  s_add_u32 m0, s41, 110592
  s_mov_b32 s42, 819200
  buffer_load_dwordx4 v45, s[8:11], s42 offen nt lds
  s_waitcnt vmcnt(24) lgkmcnt(0)
  s_barrier
  s_add_u32 m0, s41, 114688
  s_mov_b32 s42, 851968
  buffer_load_dwordx4 v44, s[8:11], s42 offen nt lds
  s_add_u32 m0, s41, 118784
  s_mov_b32 s42, 851968
  buffer_load_dwordx4 v45, s[8:11], s42 offen nt lds
  s_add_u32 m0, s41, 122880
  s_mov_b32 s42, 884736
  buffer_load_dwordx4 v44, s[8:11], s42 offen nt lds
  s_add_u32 m0, s41, 126976
  s_mov_b32 s42, 884736
  buffer_load_dwordx4 v45, s[8:11], s42 offen nt lds
  ds_read_b64_tr_b16 a[0:1], v42 offset:0
  ds_read_b64_tr_b16 a[2:3], v42 offset:2048
  ds_read_b64_tr_b16 a[128:129], v42 offset:4096
  ds_read_b64_tr_b16 a[130:131], v42 offset:6144
  ds_read_b64_tr_b16 a[4:5], v42 offset:8192
  ds_read_b64_tr_b16 a[6:7], v42 offset:10240
  ds_read_b64_tr_b16 a[132:133], v42 offset:12288
  ds_read_b64_tr_b16 a[134:135], v42 offset:14336
  s_waitcnt vmcnt(24) lgkmcnt(0)
  s_barrier
  s_add_u32 m0, s41, 0
  s_mov_b32 s42, 1048576
  buffer_load_dwordx4 v44, s[8:11], s42 offen nt lds
  s_add_u32 m0, s41, 4096
  s_mov_b32 s42, 1048576
  buffer_load_dwordx4 v45, s[8:11], s42 offen nt lds
  s_add_u32 m0, s41, 8192
  s_mov_b32 s42, 1081344
  buffer_load_dwordx4 v44, s[8:11], s42 offen nt lds
  s_add_u32 m0, s41, 12288
  s_mov_b32 s42, 1081344
  buffer_load_dwordx4 v45, s[8:11], s42 offen nt lds
  ds_read_b64_tr_b16 a[8:9], v42 offset:16384
  ds_read_b64_tr_b16 a[10:11], v42 offset:18432
  ds_read_b64_tr_b16 a[136:137], v42 offset:20480
  ds_read_b64_tr_b16 a[138:139], v42 offset:22528
  ds_read_b64_tr_b16 a[12:13], v42 offset:24576
  ds_read_b64_tr_b16 a[14:15], v42 offset:26624
  ds_read_b64_tr_b16 a[140:141], v42 offset:28672
  ds_read_b64_tr_b16 a[142:143], v42 offset:30720
  s_waitcnt vmcnt(24) lgkmcnt(0)
  s_barrier
  s_add_u32 m0, s41, 16384
  s_mov_b32 s42, 1114112
  buffer_load_dwordx4 v44, s[8:11], s42 offen nt lds
  s_add_u32 m0, s41, 20480
  s_mov_b32 s42, 1114112
  buffer_load_dwordx4 v45, s[8:11], s42 offen nt lds
  s_add_u32 m0, s41, 24576
  s_mov_b32 s42, 1146880
  buffer_load_dwordx4 v44, s[8:11], s42 offen nt lds
  s_add_u32 m0, s41, 28672
  s_mov_b32 s42, 1146880
  buffer_load_dwordx4 v45, s[8:11], s42 offen nt lds
  ds_read_b64_tr_b16 a[16:17], v42 offset:32768
  ds_read_b64_tr_b16 a[18:19], v42 offset:34816
  ds_read_b64_tr_b16 a[144:145], v42 offset:36864
  ds_read_b64_tr_b16 a[146:147], v42 offset:38912
  ds_read_b64_tr_b16 a[20:21], v42 offset:40960
  ds_read_b64_tr_b16 a[22:23], v42 offset:43008
  ds_read_b64_tr_b16 a[148:149], v42 offset:45056
  ds_read_b64_tr_b16 a[150:151], v42 offset:47104
  s_waitcnt vmcnt(24) lgkmcnt(0)
  s_barrier
  s_add_u32 m0, s41, 32768
  s_mov_b32 s42, 1310720
  buffer_load_dwordx4 v44, s[8:11], s42 offen nt lds
  s_add_u32 m0, s41, 36864
  s_mov_b32 s42, 1310720
  buffer_load_dwordx4 v45, s[8:11], s42 offen nt lds
  s_add_u32 m0, s41, 40960
  s_mov_b32 s42, 1343488
  buffer_load_dwordx4 v44, s[8:11], s42 offen nt lds
  s_add_u32 m0, s41, 45056
  s_mov_b32 s42, 1343488
  buffer_load_dwordx4 v45, s[8:11], s42 offen nt lds
  ds_read_b64_tr_b16 a[24:25], v42 offset:49152
  ds_read_b64_tr_b16 a[26:27], v42 offset:51200
  ds_read_b64_tr_b16 a[152:153], v42 offset:53248
  ds_read_b64_tr_b16 a[154:155], v42 offset:55296
  ds_read_b64_tr_b16 a[28:29], v42 offset:57344
  ds_read_b64_tr_b16 a[30:31], v42 offset:59392
  ds_read_b64_tr_b16 a[156:157], v42 offset:61440
  ds_read_b64_tr_b16 a[158:159], v42 offset:63488
  s_waitcnt vmcnt(24) lgkmcnt(0)
  s_barrier
  s_add_u32 m0, s41, 49152
  s_mov_b32 s42, 1376256
  buffer_load_dwordx4 v44, s[8:11], s42 offen nt lds
  s_add_u32 m0, s41, 53248
  s_mov_b32 s42, 1376256
  buffer_load_dwordx4 v45, s[8:11], s42 offen nt lds
  s_add_u32 m0, s41, 57344
  s_mov_b32 s42, 1409024
  buffer_load_dwordx4 v44, s[8:11], s42 offen nt lds
  s_add_u32 m0, s41, 61440
  s_mov_b32 s42, 1409024
  buffer_load_dwordx4 v45, s[8:11], s42 offen nt lds
  ds_read_b64_tr_b16 a[32:33], v43 offset:0
  ds_read_b64_tr_b16 a[34:35], v43 offset:2048
  ds_read_b64_tr_b16 a[160:161], v43 offset:4096
  ds_read_b64_tr_b16 a[162:163], v43 offset:6144
  ds_read_b64_tr_b16 a[36:37], v43 offset:8192
  ds_read_b64_tr_b16 a[38:39], v43 offset:10240
  ds_read_b64_tr_b16 a[164:165], v43 offset:12288
  ds_read_b64_tr_b16 a[166:167], v43 offset:14336
  s_waitcnt vmcnt(24) lgkmcnt(0)
  s_barrier
  s_add_u32 m0, s41, 65536
  s_mov_b32 s42, 1572864
  buffer_load_dwordx4 v44, s[8:11], s42 offen nt lds
  s_add_u32 m0, s41, 69632
  s_mov_b32 s42, 1572864
  buffer_load_dwordx4 v45, s[8:11], s42 offen nt lds
  s_add_u32 m0, s41, 73728
  s_mov_b32 s42, 1605632
  buffer_load_dwordx4 v44, s[8:11], s42 offen nt lds
  s_add_u32 m0, s41, 77824
  s_mov_b32 s42, 1605632
  buffer_load_dwordx4 v45, s[8:11], s42 offen nt lds
  ds_read_b64_tr_b16 a[40:41], v43 offset:16384
  ds_read_b64_tr_b16 a[42:43], v43 offset:18432
  ds_read_b64_tr_b16 a[168:169], v43 offset:20480
  ds_read_b64_tr_b16 a[170:171], v43 offset:22528
  ds_read_b64_tr_b16 a[44:45], v43 offset:24576
  ds_read_b64_tr_b16 a[46:47], v43 offset:26624
  ds_read_b64_tr_b16 a[172:173], v43 offset:28672
  ds_read_b64_tr_b16 a[174:175], v43 offset:30720
  s_waitcnt vmcnt(24) lgkmcnt(0)
  s_barrier
  s_add_u32 m0, s41, 81920
  s_mov_b32 s42, 1638400
  buffer_load_dwordx4 v44, s[8:11], s42 offen nt lds
  s_add_u32 m0, s41, 86016
  s_mov_b32 s42, 1638400
  buffer_load_dwordx4 v45, s[8:11], s42 offen nt lds
  s_add_u32 m0, s41, 90112
  s_mov_b32 s42, 1671168
  buffer_load_dwordx4 v44, s[8:11], s42 offen nt lds
  s_add_u32 m0, s41, 94208
  s_mov_b32 s42, 1671168
  buffer_load_dwordx4 v45, s[8:11], s42 offen nt lds
  ds_read_b64_tr_b16 a[48:49], v43 offset:32768
  ds_read_b64_tr_b16 a[50:51], v43 offset:34816
  ds_read_b64_tr_b16 a[176:177], v43 offset:36864
  ds_read_b64_tr_b16 a[178:179], v43 offset:38912
  ds_read_b64_tr_b16 a[52:53], v43 offset:40960
  ds_read_b64_tr_b16 a[54:55], v43 offset:43008
  ds_read_b64_tr_b16 a[180:181], v43 offset:45056
  ds_read_b64_tr_b16 a[182:183], v43 offset:47104
  s_waitcnt vmcnt(24) lgkmcnt(0)
  s_barrier
  s_add_u32 m0, s41, 98304
  s_mov_b32 s42, 1835008
  buffer_load_dwordx4 v44, s[8:11], s42 offen nt lds
  s_add_u32 m0, s41, 102400
  s_mov_b32 s42, 1835008
  buffer_load_dwordx4 v45, s[8:11], s42 offen nt lds
  s_add_u32 m0, s41, 106496
  s_mov_b32 s42, 1867776
  buffer_load_dwordx4 v44, s[8:11], s42 offen nt lds
  s_add_u32 m0, s41, 110592
  s_mov_b32 s42, 1867776
  buffer_load_dwordx4 v45, s[8:11], s42 offen nt lds
  ds_read_b64_tr_b16 a[56:57], v43 offset:49152
  ds_read_b64_tr_b16 a[58:59], v43 offset:51200
  ds_read_b64_tr_b16 a[184:185], v43 offset:53248
  ds_read_b64_tr_b16 a[186:187], v43 offset:55296
  ds_read_b64_tr_b16 a[60:61], v43 offset:57344
  ds_read_b64_tr_b16 a[62:63], v43 offset:59392
  ds_read_b64_tr_b16 a[188:189], v43 offset:61440
  ds_read_b64_tr_b16 a[190:191], v43 offset:63488
  s_waitcnt vmcnt(24) lgkmcnt(0)
  s_barrier
  s_add_u32 m0, s41, 114688
  s_mov_b32 s42, 1900544
  buffer_load_dwordx4 v44, s[8:11], s42 offen nt lds
  s_add_u32 m0, s41, 118784
  s_mov_b32 s42, 1900544
  buffer_load_dwordx4 v45, s[8:11], s42 offen nt lds
  s_add_u32 m0, s41, 122880
  s_mov_b32 s42, 1933312
  buffer_load_dwordx4 v44, s[8:11], s42 offen nt lds
  s_add_u32 m0, s41, 126976
  s_mov_b32 s42, 1933312
  buffer_load_dwordx4 v45, s[8:11], s42 offen nt lds
  ds_read_b64_tr_b16 a[64:65], v42 offset:0
  ds_read_b64_tr_b16 a[66:67], v42 offset:2048
  ds_read_b64_tr_b16 a[192:193], v42 offset:4096
  ds_read_b64_tr_b16 a[194:195], v42 offset:6144
  ds_read_b64_tr_b16 a[68:69], v42 offset:8192
  ds_read_b64_tr_b16 a[70:71], v42 offset:10240
  ds_read_b64_tr_b16 a[196:197], v42 offset:12288
  ds_read_b64_tr_b16 a[198:199], v42 offset:14336
  s_waitcnt vmcnt(24) lgkmcnt(0)
  s_barrier
  ds_read_b64_tr_b16 a[72:73], v42 offset:16384
  ds_read_b64_tr_b16 a[74:75], v42 offset:18432
  ds_read_b64_tr_b16 a[200:201], v42 offset:20480
  ds_read_b64_tr_b16 a[202:203], v42 offset:22528
  ds_read_b64_tr_b16 a[76:77], v42 offset:24576
  ds_read_b64_tr_b16 a[78:79], v42 offset:26624
  ds_read_b64_tr_b16 a[204:205], v42 offset:28672
  ds_read_b64_tr_b16 a[206:207], v42 offset:30720
  s_waitcnt vmcnt(20) lgkmcnt(0)
  s_barrier
  ds_read_b64_tr_b16 a[80:81], v42 offset:32768
  ds_read_b64_tr_b16 a[82:83], v42 offset:34816
  ds_read_b64_tr_b16 a[208:209], v42 offset:36864
  ds_read_b64_tr_b16 a[210:211], v42 offset:38912
  ds_read_b64_tr_b16 a[84:85], v42 offset:40960
  ds_read_b64_tr_b16 a[86:87], v42 offset:43008
  ds_read_b64_tr_b16 a[212:213], v42 offset:45056
  ds_read_b64_tr_b16 a[214:215], v42 offset:47104
  s_waitcnt vmcnt(16) lgkmcnt(0)
  s_barrier
  ds_read_b64_tr_b16 a[88:89], v42 offset:49152
  ds_read_b64_tr_b16 a[90:91], v42 offset:51200
  ds_read_b64_tr_b16 a[216:217], v42 offset:53248
  ds_read_b64_tr_b16 a[218:219], v42 offset:55296
  ds_read_b64_tr_b16 a[92:93], v42 offset:57344
  ds_read_b64_tr_b16 a[94:95], v42 offset:59392
  ds_read_b64_tr_b16 a[220:221], v42 offset:61440
  ds_read_b64_tr_b16 a[222:223], v42 offset:63488
  s_waitcnt vmcnt(12) lgkmcnt(0)
  s_barrier
  ds_read_b64_tr_b16 a[96:97], v43 offset:0
  ds_read_b64_tr_b16 a[98:99], v43 offset:2048
  ds_read_b64_tr_b16 a[224:225], v43 offset:4096
  ds_read_b64_tr_b16 a[226:227], v43 offset:6144
  ds_read_b64_tr_b16 a[100:101], v43 offset:8192
  ds_read_b64_tr_b16 a[102:103], v43 offset:10240
  ds_read_b64_tr_b16 a[228:229], v43 offset:12288
  ds_read_b64_tr_b16 a[230:231], v43 offset:14336
  s_waitcnt vmcnt(8) lgkmcnt(0)
  s_barrier
  ds_read_b64_tr_b16 a[104:105], v43 offset:16384
  ds_read_b64_tr_b16 a[106:107], v43 offset:18432
  ds_read_b64_tr_b16 a[232:233], v43 offset:20480
  ds_read_b64_tr_b16 a[234:235], v43 offset:22528
  ds_read_b64_tr_b16 a[108:109], v43 offset:24576
  ds_read_b64_tr_b16 a[110:111], v43 offset:26624
  ds_read_b64_tr_b16 a[236:237], v43 offset:28672
  ds_read_b64_tr_b16 a[238:239], v43 offset:30720
  s_waitcnt vmcnt(4) lgkmcnt(0)
  s_barrier
  ds_read_b64_tr_b16 a[112:113], v43 offset:32768
  ds_read_b64_tr_b16 a[114:115], v43 offset:34816
  ds_read_b64_tr_b16 a[240:241], v43 offset:36864
  ds_read_b64_tr_b16 a[242:243], v43 offset:38912
  ds_read_b64_tr_b16 a[116:117], v43 offset:40960
  ds_read_b64_tr_b16 a[118:119], v43 offset:43008
  ds_read_b64_tr_b16 a[244:245], v43 offset:45056
  ds_read_b64_tr_b16 a[246:247], v43 offset:47104
  s_waitcnt vmcnt(0) lgkmcnt(0)
  s_barrier
  ds_read_b64_tr_b16 a[120:121], v43 offset:49152
  ds_read_b64_tr_b16 a[122:123], v43 offset:51200
  ds_read_b64_tr_b16 a[248:249], v43 offset:53248
  ds_read_b64_tr_b16 a[250:251], v43 offset:55296
  ds_read_b64_tr_b16 a[124:125], v43 offset:57344
  ds_read_b64_tr_b16 a[126:127], v43 offset:59392
  ds_read_b64_tr_b16 a[252:253], v43 offset:61440
  ds_read_b64_tr_b16 a[254:255], v43 offset:63488
  s_waitcnt lgkmcnt(0)
  s_barrier
  s_and_b32 s43, s21, 24
  v_min_u32 v2, 7, v0
  v_add_u32 v2, s43, v2
  v_lshlrev_b32 v2, 7, v2
  v_add_u32 v2, 1404928, v2
  s_lshl_b32 s62, s21, 7
  s_add_u32 s62, s62, 1409024
  s_lshl_b32 s40, s43, 13
  s_add_u32 s27, s40, 27262976
  s_lshl_b32 s40, s21, 13
  s_add_u32 s31, s40, 109051904
  s_lshl_b32 s40, s20, 11
  v_lshl_add_u32 v68, v0, 4, s40
  v_lshlrev_b32 v1, 4, v0
  s_lshl_b32 s32, s20, 12
  s_mul_i32 s33, s20, 3072
  v_mov_b32 v69, v1
  v_add_u32 v70, 0x10000, v69
  s_lshl_b32 s40, s20, 2
  s_add_u32 s40, s40, 131072
  v_mov_b32 v71, s40
  v_mov_b32 v52, 0
  ds_write_b32 v71, v52
  s_mov_b32 s25, 0
  s_mov_b32 s26, 0
  s_mov_b32 s29, 1
  s_mov_b32 s30, 0
  s_mov_b32 s28, 1
  s_waitcnt lgkmcnt(0)
  s_barrier
  s_branch L_WO_poll
L_WO_top:
  s_cmp_lg_u32 s28, 0
  s_cbranch_scc1 L_WO_go
  buffer_load_dword v3, v2, s[4:7], s30 offen sc1
  v_mov_b32 v52, s25
  v_and_b32 v53, 3, v0
  v_lshlrev_b32 v53, 2, v53
  v_add_u32 v53, 131072, v53
  s_waitcnt vmcnt(1)
  ds_write_b32 v71, v52
  ds_read_b32 v53, v53
  s_waitcnt lgkmcnt(0)
  v_cmp_gt_i32 vcc, s25, v53
  s_cbranch_vccnz L_WO_nosig
  s_mov_b32 s63, s25
  s_atomic_smax s63, s[4:5], s62 glc
Lnosig_24:
L_WO_nosig:
  s_cmp_ge_u32 s25, 64
  s_cbranch_scc1 L_END
  s_waitcnt vmcnt(0)
  v_cmp_gt_i32 vcc, s29, v3
  s_cbranch_vccz L_WO_issue
L_WO_poll:
  s_nop 3
Lpoll_25:
  buffer_load_dword v3, v2, s[4:7], s30 offen sc1
  s_sub_u32 s24, s24, 1
  s_cbranch_scc1 L_FAIL
  s_waitcnt vmcnt(0)
  v_cmp_gt_i32 vcc, s29, v3
  s_cbranch_vccz Lpolld_26
  s_sleep 2
  s_branch Lpoll_25
Lpolld_26:
L_WO_issue:
  s_mov_b32 s34, s26
  s_mov_b32 s35, s27
  s_add_u32 s36, s32, 0
  s_add_u32 m0, s34, s36
  s_add_u32 s36, s35, s36
  buffer_load_dwordx4 v1, s[4:7], s36 offen offset:0 sc1 lds
  buffer_load_dwordx4 v1, s[4:7], s36 offen offset:1024 sc1 lds
  buffer_load_dwordx4 v1, s[4:7], s36 offen offset:2048 sc1 lds
  buffer_load_dwordx4 v1, s[4:7], s36 offen offset:3072 sc1 lds
  s_add_u32 s36, s32, 16384
  s_add_u32 m0, s34, s36
  s_add_u32 s36, s35, s36
  buffer_load_dwordx4 v1, s[4:7], s36 offen offset:0 sc1 lds
  buffer_load_dwordx4 v1, s[4:7], s36 offen offset:1024 sc1 lds
  buffer_load_dwordx4 v1, s[4:7], s36 offen offset:2048 sc1 lds
  buffer_load_dwordx4 v1, s[4:7], s36 offen offset:3072 sc1 lds
  s_add_u32 s36, s32, 32768
  s_add_u32 m0, s34, s36
  s_add_u32 s36, s35, s36
  buffer_load_dwordx4 v1, s[4:7], s36 offen offset:0 sc1 lds
  buffer_load_dwordx4 v1, s[4:7], s36 offen offset:1024 sc1 lds
  buffer_load_dwordx4 v1, s[4:7], s36 offen offset:2048 sc1 lds
  buffer_load_dwordx4 v1, s[4:7], s36 offen offset:3072 sc1 lds
  s_add_u32 s36, s32, 49152
  s_add_u32 m0, s34, s36
  s_add_u32 s36, s35, s36
  buffer_load_dwordx4 v1, s[4:7], s36 offen offset:0 sc1 lds
  buffer_load_dwordx4 v1, s[4:7], s36 offen offset:1024 sc1 lds
  buffer_load_dwordx4 v1, s[4:7], s36 offen offset:2048 sc1 lds
  buffer_load_dwordx4 v1, s[4:7], s36 offen offset:3072 sc1 lds
L_WO_go:
  v_add_u32 v73, s26, v69
  v_add_u32 v74, s26, v70
  s_sub_u32 s26, 65536, s26
  s_add_u32 s27, s27, 262144
  s_mov_b32 s34, s26
  s_mov_b32 s35, s27
  s_add_u32 s29, s29, 1
  s_waitcnt vmcnt(12)
  s_barrier
  ds_read_b128 v[4:7], v73 offset:0
  ds_read_b128 v[8:11], v73 offset:1024
  ds_read_b128 v[12:15], v73 offset:2048
  ds_read_b128 v[16:19], v73 offset:3072
  ds_read_b128 v[20:23], v73 offset:4096
  ds_read_b128 v[24:27], v73 offset:5120
  buffer_load_dword v3, v2, s[4:7], s30 offen sc1
  s_waitcnt lgkmcnt(4)
  v_mfma_f32_16x16x32_bf16 v[36:39], a[0:3], v[4:7], 0
  ds_read_b128 v[28:31], v73 offset:6144
  v_mfma_f32_16x16x32_bf16 v[40:43], a[0:3], v[8:11], 0
  ds_read_b128 v[32:35], v73 offset:7168
  v_mfma_f32_16x16x32_bf16 v[44:47], a[128:131], v[4:7], 0
  v_mfma_f32_16x16x32_bf16 v[48:51], a[128:131], v[8:11], 0
  s_waitcnt lgkmcnt(4)
  v_mfma_f32_16x16x32_bf16 v[36:39], a[4:7], v[12:15], v[36:39]
  ds_read_b128 v[4:7], v73 offset:8192
  v_mfma_f32_16x16x32_bf16 v[40:43], a[4:7], v[16:19], v[40:43]
  ds_read_b128 v[8:11], v73 offset:9216
  v_mfma_f32_16x16x32_bf16 v[44:47], a[132:135], v[12:15], v[44:47]
  v_mfma_f32_16x16x32_bf16 v[48:51], a[132:135], v[16:19], v[48:51]
  s_waitcnt lgkmcnt(4)
  v_mfma_f32_16x16x32_bf16 v[36:39], a[8:11], v[20:23], v[36:39]
  ds_read_b128 v[12:15], v73 offset:10240
  v_mfma_f32_16x16x32_bf16 v[40:43], a[8:11], v[24:27], v[40:43]
  ds_read_b128 v[16:19], v73 offset:11264
  v_mfma_f32_16x16x32_bf16 v[44:47], a[136:139], v[20:23], v[44:47]
  v_mfma_f32_16x16x32_bf16 v[48:51], a[136:139], v[24:27], v[48:51]
  s_waitcnt lgkmcnt(4)
  v_mfma_f32_16x16x32_bf16 v[36:39], a[12:15], v[28:31], v[36:39]
  ds_read_b128 v[20:23], v73 offset:12288
  v_mfma_f32_16x16x32_bf16 v[40:43], a[12:15], v[32:35], v[40:43]
  ds_read_b128 v[24:27], v73 offset:13312
  v_mfma_f32_16x16x32_bf16 v[44:47], a[140:143], v[28:31], v[44:47]
  v_mfma_f32_16x16x32_bf16 v[48:51], a[140:143], v[32:35], v[48:51]
  s_waitcnt lgkmcnt(4)
  v_mfma_f32_16x16x32_bf16 v[36:39], a[16:19], v[4:7], v[36:39]
  ds_read_b128 v[28:31], v73 offset:14336
  v_mfma_f32_16x16x32_bf16 v[40:43], a[16:19], v[8:11], v[40:43]
  ds_read_b128 v[32:35], v73 offset:15360
  v_mfma_f32_16x16x32_bf16 v[44:47], a[144:147], v[4:7], v[44:47]
  v_mfma_f32_16x16x32_bf16 v[48:51], a[144:147], v[8:11], v[48:51]
  s_waitcnt vmcnt(9)
  s_barrier
  s_waitcnt lgkmcnt(4)
  v_mfma_f32_16x16x32_bf16 v[36:39], a[20:23], v[12:15], v[36:39]
  ds_read_b128 v[4:7], v73 offset:16384
  v_mfma_f32_16x16x32_bf16 v[40:43], a[20:23], v[16:19], v[40:43]
  ds_read_b128 v[8:11], v73 offset:17408
  v_mfma_f32_16x16x32_bf16 v[44:47], a[148:151], v[12:15], v[44:47]
  v_mfma_f32_16x16x32_bf16 v[48:51], a[148:151], v[16:19], v[48:51]
  s_waitcnt lgkmcnt(4)
  v_mfma_f32_16x16x32_bf16 v[36:39], a[24:27], v[20:23], v[36:39]
  ds_read_b128 v[12:15], v73 offset:18432
  v_mfma_f32_16x16x32_bf16 v[40:43], a[24:27], v[24:27], v[40:43]
  ds_read_b128 v[16:19], v73 offset:19456
  v_mfma_f32_16x16x32_bf16 v[44:47], a[152:155], v[20:23], v[44:47]
  v_mfma_f32_16x16x32_bf16 v[48:51], a[152:155], v[24:27], v[48:51]
  s_waitcnt lgkmcnt(4)
  v_mfma_f32_16x16x32_bf16 v[36:39], a[28:31], v[28:31], v[36:39]
  ds_read_b128 v[20:23], v73 offset:20480
  v_mfma_f32_16x16x32_bf16 v[40:43], a[28:31], v[32:35], v[40:43]
  ds_read_b128 v[24:27], v73 offset:21504
  v_mfma_f32_16x16x32_bf16 v[44:47], a[156:159], v[28:31], v[44:47]
  v_mfma_f32_16x16x32_bf16 v[48:51], a[156:159], v[32:35], v[48:51]
  s_waitcnt lgkmcnt(4)
  v_mfma_f32_16x16x32_bf16 v[36:39], a[32:35], v[4:7], v[36:39]
  ds_read_b128 v[28:31], v73 offset:22528
  v_mfma_f32_16x16x32_bf16 v[40:43], a[32:35], v[8:11], v[40:43]
  ds_read_b128 v[32:35], v73 offset:23552
  v_mfma_f32_16x16x32_bf16 v[44:47], a[160:163], v[4:7], v[44:47]
  v_mfma_f32_16x16x32_bf16 v[48:51], a[160:163], v[8:11], v[48:51]
  s_waitcnt lgkmcnt(4)
  v_mfma_f32_16x16x32_bf16 v[36:39], a[36:39], v[12:15], v[36:39]
  ds_read_b128 v[4:7], v73 offset:24576
  v_mfma_f32_16x16x32_bf16 v[40:43], a[36:39], v[16:19], v[40:43]
  ds_read_b128 v[8:11], v73 offset:25600
  v_mfma_f32_16x16x32_bf16 v[44:47], a[164:167], v[12:15], v[44:47]
  v_mfma_f32_16x16x32_bf16 v[48:51], a[164:167], v[16:19], v[48:51]
  s_waitcnt lgkmcnt(4)
  v_mfma_f32_16x16x32_bf16 v[36:39], a[40:43], v[20:23], v[36:39]
  ds_read_b128 v[12:15], v73 offset:26624
  v_mfma_f32_16x16x32_bf16 v[40:43], a[40:43], v[24:27], v[40:43]
  ds_read_b128 v[16:19], v73 offset:27648
  v_mfma_f32_16x16x32_bf16 v[44:47], a[168:171], v[20:23], v[44:47]
  v_mfma_f32_16x16x32_bf16 v[48:51], a[168:171], v[24:27], v[48:51]
  s_waitcnt lgkmcnt(4)
  v_mfma_f32_16x16x32_bf16 v[36:39], a[44:47], v[28:31], v[36:39]
  ds_read_b128 v[20:23], v73 offset:28672
  v_mfma_f32_16x16x32_bf16 v[40:43], a[44:47], v[32:35], v[40:43]
  ds_read_b128 v[24:27], v73 offset:29696
  v_mfma_f32_16x16x32_bf16 v[44:47], a[172:175], v[28:31], v[44:47]
  v_mfma_f32_16x16x32_bf16 v[48:51], a[172:175], v[32:35], v[48:51]
  s_waitcnt lgkmcnt(4)
  v_mfma_f32_16x16x32_bf16 v[36:39], a[48:51], v[4:7], v[36:39]
  ds_read_b128 v[28:31], v73 offset:30720
  v_mfma_f32_16x16x32_bf16 v[40:43], a[48:51], v[8:11], v[40:43]
  ds_read_b128 v[32:35], v73 offset:31744
  v_mfma_f32_16x16x32_bf16 v[44:47], a[176:179], v[4:7], v[44:47]
  v_mfma_f32_16x16x32_bf16 v[48:51], a[176:179], v[8:11], v[48:51]
  s_waitcnt vmcnt(0)
  s_barrier
  v_cmp_gt_i32 vcc, s29, v3
  s_cmp_lg_u32 s20, 0
  s_cbranch_scc1 Lnosig_27
  s_mov_b32 s63, s25
  s_atomic_smax s63, s[4:5], s62 glc
Lnosig_27:
L_WO_s2:
  s_mov_b32 s28, 0
  s_cbranch_vccnz L_WO_nopf
  s_cmp_ge_u32 s25, 63
  s_cbranch_scc1 L_WO_nopf
  s_mov_b32 s28, 1
  s_waitcnt lgkmcnt(4)
  v_mfma_f32_16x16x32_bf16 v[36:39], a[52:55], v[12:15], v[36:39]
  ds_read_b128 v[4:7], v73 offset:32768
  v_mfma_f32_16x16x32_bf16 v[40:43], a[52:55], v[16:19], v[40:43]
  ds_read_b128 v[8:11], v73 offset:33792
  v_mfma_f32_16x16x32_bf16 v[44:47], a[180:183], v[12:15], v[44:47]
  s_add_u32 s36, s32, 0
  s_add_u32 m0, s34, s36
  s_add_u32 s36, s35, s36
  buffer_load_dwordx4 v1, s[4:7], s36 offen offset:0 sc1 lds
  v_mfma_f32_16x16x32_bf16 v[48:51], a[180:183], v[16:19], v[48:51]
  s_waitcnt lgkmcnt(4)
  v_mfma_f32_16x16x32_bf16 v[36:39], a[56:59], v[20:23], v[36:39]
  ds_read_b128 v[12:15], v73 offset:34816
  v_mfma_f32_16x16x32_bf16 v[40:43], a[56:59], v[24:27], v[40:43]
  ds_read_b128 v[16:19], v73 offset:35840
  v_mfma_f32_16x16x32_bf16 v[44:47], a[184:187], v[20:23], v[44:47]
  buffer_load_dwordx4 v1, s[4:7], s36 offen offset:1024 sc1 lds
  v_mfma_f32_16x16x32_bf16 v[48:51], a[184:187], v[24:27], v[48:51]
  s_waitcnt lgkmcnt(4)
  v_mfma_f32_16x16x32_bf16 v[36:39], a[60:63], v[28:31], v[36:39]
  ds_read_b128 v[20:23], v73 offset:36864
  v_mfma_f32_16x16x32_bf16 v[40:43], a[60:63], v[32:35], v[40:43]
  ds_read_b128 v[24:27], v73 offset:37888
  v_mfma_f32_16x16x32_bf16 v[44:47], a[188:191], v[28:31], v[44:47]
  buffer_load_dwordx4 v1, s[4:7], s36 offen offset:2048 sc1 lds
  v_mfma_f32_16x16x32_bf16 v[48:51], a[188:191], v[32:35], v[48:51]
  s_waitcnt lgkmcnt(4)
  v_mfma_f32_16x16x32_bf16 v[36:39], a[64:67], v[4:7], v[36:39]
  ds_read_b128 v[28:31], v73 offset:38912
  v_mfma_f32_16x16x32_bf16 v[40:43], a[64:67], v[8:11], v[40:43]
  ds_read_b128 v[32:35], v73 offset:39936
  v_mfma_f32_16x16x32_bf16 v[44:47], a[192:195], v[4:7], v[44:47]
  buffer_load_dwordx4 v1, s[4:7], s36 offen offset:3072 sc1 lds
  v_mfma_f32_16x16x32_bf16 v[48:51], a[192:195], v[8:11], v[48:51]
  s_waitcnt lgkmcnt(4)
  v_mfma_f32_16x16x32_bf16 v[36:39], a[68:71], v[12:15], v[36:39]
  ds_read_b128 v[4:7], v73 offset:40960
  v_mfma_f32_16x16x32_bf16 v[40:43], a[68:71], v[16:19], v[40:43]
  ds_read_b128 v[8:11], v73 offset:41984
  v_mfma_f32_16x16x32_bf16 v[44:47], a[196:199], v[12:15], v[44:47]
  s_add_u32 s36, s32, 16384
  s_add_u32 m0, s34, s36
  s_add_u32 s36, s35, s36
  buffer_load_dwordx4 v1, s[4:7], s36 offen offset:0 sc1 lds
  v_mfma_f32_16x16x32_bf16 v[48:51], a[196:199], v[16:19], v[48:51]
  s_waitcnt lgkmcnt(4)
  v_mfma_f32_16x16x32_bf16 v[36:39], a[72:75], v[20:23], v[36:39]
  ds_read_b128 v[12:15], v73 offset:43008
  v_mfma_f32_16x16x32_bf16 v[40:43], a[72:75], v[24:27], v[40:43]
  ds_read_b128 v[16:19], v73 offset:44032
  v_mfma_f32_16x16x32_bf16 v[44:47], a[200:203], v[20:23], v[44:47]
  buffer_load_dwordx4 v1, s[4:7], s36 offen offset:1024 sc1 lds
  v_mfma_f32_16x16x32_bf16 v[48:51], a[200:203], v[24:27], v[48:51]
  s_waitcnt lgkmcnt(4)
  v_mfma_f32_16x16x32_bf16 v[36:39], a[76:79], v[28:31], v[36:39]
  ds_read_b128 v[20:23], v73 offset:45056
  v_mfma_f32_16x16x32_bf16 v[40:43], a[76:79], v[32:35], v[40:43]
  ds_read_b128 v[24:27], v73 offset:46080
  v_mfma_f32_16x16x32_bf16 v[44:47], a[204:207], v[28:31], v[44:47]
  buffer_load_dwordx4 v1, s[4:7], s36 offen offset:2048 sc1 lds
  v_mfma_f32_16x16x32_bf16 v[48:51], a[204:207], v[32:35], v[48:51]
  s_waitcnt lgkmcnt(4)
  v_mfma_f32_16x16x32_bf16 v[36:39], a[80:83], v[4:7], v[36:39]
  ds_read_b128 v[28:31], v73 offset:47104
  v_mfma_f32_16x16x32_bf16 v[40:43], a[80:83], v[8:11], v[40:43]
  ds_read_b128 v[32:35], v73 offset:48128
  v_mfma_f32_16x16x32_bf16 v[44:47], a[208:211], v[4:7], v[44:47]
  buffer_load_dwordx4 v1, s[4:7], s36 offen offset:3072 sc1 lds
  v_mfma_f32_16x16x32_bf16 v[48:51], a[208:211], v[8:11], v[48:51]
  s_waitcnt lgkmcnt(4)
  v_mfma_f32_16x16x32_bf16 v[36:39], a[84:87], v[12:15], v[36:39]
  ds_read_b128 v[4:7], v73 offset:49152
  v_mfma_f32_16x16x32_bf16 v[40:43], a[84:87], v[16:19], v[40:43]
  ds_read_b128 v[8:11], v73 offset:50176
  v_mfma_f32_16x16x32_bf16 v[44:47], a[212:215], v[12:15], v[44:47]
  s_add_u32 s36, s32, 32768
  s_add_u32 m0, s34, s36
  s_add_u32 s36, s35, s36
  buffer_load_dwordx4 v1, s[4:7], s36 offen offset:0 sc1 lds
  v_mfma_f32_16x16x32_bf16 v[48:51], a[212:215], v[16:19], v[48:51]
  s_waitcnt lgkmcnt(4)
  v_mfma_f32_16x16x32_bf16 v[36:39], a[88:91], v[20:23], v[36:39]
  ds_read_b128 v[12:15], v73 offset:51200
  v_mfma_f32_16x16x32_bf16 v[40:43], a[88:91], v[24:27], v[40:43]
  ds_read_b128 v[16:19], v73 offset:52224
  v_mfma_f32_16x16x32_bf16 v[44:47], a[216:219], v[20:23], v[44:47]
  buffer_load_dwordx4 v1, s[4:7], s36 offen offset:1024 sc1 lds
  v_mfma_f32_16x16x32_bf16 v[48:51], a[216:219], v[24:27], v[48:51]
  s_waitcnt lgkmcnt(4)
  v_mfma_f32_16x16x32_bf16 v[36:39], a[92:95], v[28:31], v[36:39]
  ds_read_b128 v[20:23], v73 offset:53248
  v_mfma_f32_16x16x32_bf16 v[40:43], a[92:95], v[32:35], v[40:43]
  ds_read_b128 v[24:27], v73 offset:54272
  v_mfma_f32_16x16x32_bf16 v[44:47], a[220:223], v[28:31], v[44:47]
  buffer_load_dwordx4 v1, s[4:7], s36 offen offset:2048 sc1 lds
  v_mfma_f32_16x16x32_bf16 v[48:51], a[220:223], v[32:35], v[48:51]
  s_waitcnt lgkmcnt(4)
  v_mfma_f32_16x16x32_bf16 v[36:39], a[96:99], v[4:7], v[36:39]
  ds_read_b128 v[28:31], v73 offset:55296
  v_mfma_f32_16x16x32_bf16 v[40:43], a[96:99], v[8:11], v[40:43]
  ds_read_b128 v[32:35], v73 offset:56320
  v_mfma_f32_16x16x32_bf16 v[44:47], a[224:227], v[4:7], v[44:47]
  buffer_load_dwordx4 v1, s[4:7], s36 offen offset:3072 sc1 lds
  v_mfma_f32_16x16x32_bf16 v[48:51], a[224:227], v[8:11], v[48:51]
  s_waitcnt lgkmcnt(4)
  v_mfma_f32_16x16x32_bf16 v[36:39], a[100:103], v[12:15], v[36:39]
  ds_read_b128 v[4:7], v73 offset:57344
  v_mfma_f32_16x16x32_bf16 v[40:43], a[100:103], v[16:19], v[40:43]
  ds_read_b128 v[8:11], v73 offset:58368
  v_mfma_f32_16x16x32_bf16 v[44:47], a[228:231], v[12:15], v[44:47]
  s_add_u32 s36, s32, 49152
  s_add_u32 m0, s34, s36
  s_add_u32 s36, s35, s36
  buffer_load_dwordx4 v1, s[4:7], s36 offen offset:0 sc1 lds
  v_mfma_f32_16x16x32_bf16 v[48:51], a[228:231], v[16:19], v[48:51]
  s_waitcnt lgkmcnt(4)
  v_mfma_f32_16x16x32_bf16 v[36:39], a[104:107], v[20:23], v[36:39]
  ds_read_b128 v[12:15], v73 offset:59392
  v_mfma_f32_16x16x32_bf16 v[40:43], a[104:107], v[24:27], v[40:43]
  ds_read_b128 v[16:19], v73 offset:60416
  v_mfma_f32_16x16x32_bf16 v[44:47], a[232:235], v[20:23], v[44:47]
  buffer_load_dwordx4 v1, s[4:7], s36 offen offset:1024 sc1 lds
  v_mfma_f32_16x16x32_bf16 v[48:51], a[232:235], v[24:27], v[48:51]
  s_waitcnt lgkmcnt(4)
  v_mfma_f32_16x16x32_bf16 v[36:39], a[108:111], v[28:31], v[36:39]
  ds_read_b128 v[20:23], v73 offset:61440
  v_mfma_f32_16x16x32_bf16 v[40:43], a[108:111], v[32:35], v[40:43]
  ds_read_b128 v[24:27], v73 offset:62464
  v_mfma_f32_16x16x32_bf16 v[44:47], a[236:239], v[28:31], v[44:47]
  buffer_load_dwordx4 v1, s[4:7], s36 offen offset:2048 sc1 lds
  v_mfma_f32_16x16x32_bf16 v[48:51], a[236:239], v[32:35], v[48:51]
  s_waitcnt lgkmcnt(4)
  v_mfma_f32_16x16x32_bf16 v[36:39], a[112:115], v[4:7], v[36:39]
  ds_read_b128 v[28:31], v73 offset:63488
  v_mfma_f32_16x16x32_bf16 v[40:43], a[112:115], v[8:11], v[40:43]
  ds_read_b128 v[32:35], v73 offset:64512
  v_mfma_f32_16x16x32_bf16 v[44:47], a[240:243], v[4:7], v[44:47]
  buffer_load_dwordx4 v1, s[4:7], s36 offen offset:3072 sc1 lds
  v_mfma_f32_16x16x32_bf16 v[48:51], a[240:243], v[8:11], v[48:51]
  s_waitcnt lgkmcnt(4)
  v_mfma_f32_16x16x32_bf16 v[36:39], a[116:119], v[12:15], v[36:39]
  v_mfma_f32_16x16x32_bf16 v[40:43], a[116:119], v[16:19], v[40:43]
  v_mfma_f32_16x16x32_bf16 v[44:47], a[244:247], v[12:15], v[44:47]
  v_mfma_f32_16x16x32_bf16 v[48:51], a[244:247], v[16:19], v[48:51]
  s_waitcnt lgkmcnt(2)
  v_mfma_f32_16x16x32_bf16 v[36:39], a[120:123], v[20:23], v[36:39]
  v_mfma_f32_16x16x32_bf16 v[40:43], a[120:123], v[24:27], v[40:43]
  v_mfma_f32_16x16x32_bf16 v[44:47], a[248:251], v[20:23], v[44:47]
  v_mfma_f32_16x16x32_bf16 v[48:51], a[248:251], v[24:27], v[48:51]
  s_waitcnt lgkmcnt(0)
  v_mfma_f32_16x16x32_bf16 v[36:39], a[124:127], v[28:31], v[36:39]
  v_mfma_f32_16x16x32_bf16 v[40:43], a[124:127], v[32:35], v[40:43]
  v_mfma_f32_16x16x32_bf16 v[44:47], a[252:255], v[28:31], v[44:47]
  v_mfma_f32_16x16x32_bf16 v[48:51], a[252:255], v[32:35], v[48:51]
  s_nop 7
  s_branch L_WO_epi
L_WO_nopf:
  s_waitcnt lgkmcnt(4)
  v_mfma_f32_16x16x32_bf16 v[36:39], a[52:55], v[12:15], v[36:39]
  ds_read_b128 v[4:7], v73 offset:32768
  v_mfma_f32_16x16x32_bf16 v[40:43], a[52:55], v[16:19], v[40:43]
  ds_read_b128 v[8:11], v73 offset:33792
  v_mfma_f32_16x16x32_bf16 v[44:47], a[180:183], v[12:15], v[44:47]
  v_mfma_f32_16x16x32_bf16 v[48:51], a[180:183], v[16:19], v[48:51]
  s_waitcnt lgkmcnt(4)
  v_mfma_f32_16x16x32_bf16 v[36:39], a[56:59], v[20:23], v[36:39]
  ds_read_b128 v[12:15], v73 offset:34816
  v_mfma_f32_16x16x32_bf16 v[40:43], a[56:59], v[24:27], v[40:43]
  ds_read_b128 v[16:19], v73 offset:35840
  v_mfma_f32_16x16x32_bf16 v[44:47], a[184:187], v[20:23], v[44:47]
  v_mfma_f32_16x16x32_bf16 v[48:51], a[184:187], v[24:27], v[48:51]
  s_waitcnt lgkmcnt(4)
  v_mfma_f32_16x16x32_bf16 v[36:39], a[60:63], v[28:31], v[36:39]
  ds_read_b128 v[20:23], v73 offset:36864
  v_mfma_f32_16x16x32_bf16 v[40:43], a[60:63], v[32:35], v[40:43]
  ds_read_b128 v[24:27], v73 offset:37888
  v_mfma_f32_16x16x32_bf16 v[44:47], a[188:191], v[28:31], v[44:47]
  v_mfma_f32_16x16x32_bf16 v[48:51], a[188:191], v[32:35], v[48:51]
  s_waitcnt lgkmcnt(4)
  v_mfma_f32_16x16x32_bf16 v[36:39], a[64:67], v[4:7], v[36:39]
  ds_read_b128 v[28:31], v73 offset:38912
  v_mfma_f32_16x16x32_bf16 v[40:43], a[64:67], v[8:11], v[40:43]
  ds_read_b128 v[32:35], v73 offset:39936
  v_mfma_f32_16x16x32_bf16 v[44:47], a[192:195], v[4:7], v[44:47]
  v_mfma_f32_16x16x32_bf16 v[48:51], a[192:195], v[8:11], v[48:51]
  s_waitcnt lgkmcnt(4)
  v_mfma_f32_16x16x32_bf16 v[36:39], a[68:71], v[12:15], v[36:39]
  ds_read_b128 v[4:7], v73 offset:40960
  v_mfma_f32_16x16x32_bf16 v[40:43], a[68:71], v[16:19], v[40:43]
  ds_read_b128 v[8:11], v73 offset:41984
  v_mfma_f32_16x16x32_bf16 v[44:47], a[196:199], v[12:15], v[44:47]
  v_mfma_f32_16x16x32_bf16 v[48:51], a[196:199], v[16:19], v[48:51]
  s_waitcnt lgkmcnt(4)
  v_mfma_f32_16x16x32_bf16 v[36:39], a[72:75], v[20:23], v[36:39]
  ds_read_b128 v[12:15], v73 offset:43008
  v_mfma_f32_16x16x32_bf16 v[40:43], a[72:75], v[24:27], v[40:43]
  ds_read_b128 v[16:19], v73 offset:44032
  v_mfma_f32_16x16x32_bf16 v[44:47], a[200:203], v[20:23], v[44:47]
  v_mfma_f32_16x16x32_bf16 v[48:51], a[200:203], v[24:27], v[48:51]
  s_waitcnt lgkmcnt(4)
  v_mfma_f32_16x16x32_bf16 v[36:39], a[76:79], v[28:31], v[36:39]
  ds_read_b128 v[20:23], v73 offset:45056
  v_mfma_f32_16x16x32_bf16 v[40:43], a[76:79], v[32:35], v[40:43]
  ds_read_b128 v[24:27], v73 offset:46080
  v_mfma_f32_16x16x32_bf16 v[44:47], a[204:207], v[28:31], v[44:47]
  v_mfma_f32_16x16x32_bf16 v[48:51], a[204:207], v[32:35], v[48:51]
  s_waitcnt lgkmcnt(4)
  v_mfma_f32_16x16x32_bf16 v[36:39], a[80:83], v[4:7], v[36:39]
  ds_read_b128 v[28:31], v73 offset:47104
  v_mfma_f32_16x16x32_bf16 v[40:43], a[80:83], v[8:11], v[40:43]
  ds_read_b128 v[32:35], v73 offset:48128
  v_mfma_f32_16x16x32_bf16 v[44:47], a[208:211], v[4:7], v[44:47]
  v_mfma_f32_16x16x32_bf16 v[48:51], a[208:211], v[8:11], v[48:51]
  s_waitcnt lgkmcnt(4)
  v_mfma_f32_16x16x32_bf16 v[36:39], a[84:87], v[12:15], v[36:39]
  ds_read_b128 v[4:7], v73 offset:49152
  v_mfma_f32_16x16x32_bf16 v[40:43], a[84:87], v[16:19], v[40:43]
  ds_read_b128 v[8:11], v73 offset:50176
  v_mfma_f32_16x16x32_bf16 v[44:47], a[212:215], v[12:15], v[44:47]
  v_mfma_f32_16x16x32_bf16 v[48:51], a[212:215], v[16:19], v[48:51]
  s_waitcnt lgkmcnt(4)
  v_mfma_f32_16x16x32_bf16 v[36:39], a[88:91], v[20:23], v[36:39]
  ds_read_b128 v[12:15], v73 offset:51200
  v_mfma_f32_16x16x32_bf16 v[40:43], a[88:91], v[24:27], v[40:43]
  ds_read_b128 v[16:19], v73 offset:52224
  v_mfma_f32_16x16x32_bf16 v[44:47], a[216:219], v[20:23], v[44:47]
  v_mfma_f32_16x16x32_bf16 v[48:51], a[216:219], v[24:27], v[48:51]
  s_waitcnt lgkmcnt(4)
  v_mfma_f32_16x16x32_bf16 v[36:39], a[92:95], v[28:31], v[36:39]
  ds_read_b128 v[20:23], v73 offset:53248
  v_mfma_f32_16x16x32_bf16 v[40:43], a[92:95], v[32:35], v[40:43]
  ds_read_b128 v[24:27], v73 offset:54272
  v_mfma_f32_16x16x32_bf16 v[44:47], a[220:223], v[28:31], v[44:47]
  v_mfma_f32_16x16x32_bf16 v[48:51], a[220:223], v[32:35], v[48:51]
  s_waitcnt lgkmcnt(4)
  v_mfma_f32_16x16x32_bf16 v[36:39], a[96:99], v[4:7], v[36:39]
  ds_read_b128 v[28:31], v73 offset:55296
  v_mfma_f32_16x16x32_bf16 v[40:43], a[96:99], v[8:11], v[40:43]
  ds_read_b128 v[32:35], v73 offset:56320
  v_mfma_f32_16x16x32_bf16 v[44:47], a[224:227], v[4:7], v[44:47]
  v_mfma_f32_16x16x32_bf16 v[48:51], a[224:227], v[8:11], v[48:51]
  s_waitcnt lgkmcnt(4)
  v_mfma_f32_16x16x32_bf16 v[36:39], a[100:103], v[12:15], v[36:39]
  ds_read_b128 v[4:7], v73 offset:57344
  v_mfma_f32_16x16x32_bf16 v[40:43], a[100:103], v[16:19], v[40:43]
  ds_read_b128 v[8:11], v73 offset:58368
  v_mfma_f32_16x16x32_bf16 v[44:47], a[228:231], v[12:15], v[44:47]
  v_mfma_f32_16x16x32_bf16 v[48:51], a[228:231], v[16:19], v[48:51]
  s_waitcnt lgkmcnt(4)
  v_mfma_f32_16x16x32_bf16 v[36:39], a[104:107], v[20:23], v[36:39]
  ds_read_b128 v[12:15], v73 offset:59392
  v_mfma_f32_16x16x32_bf16 v[40:43], a[104:107], v[24:27], v[40:43]
  ds_read_b128 v[16:19], v73 offset:60416
  v_mfma_f32_16x16x32_bf16 v[44:47], a[232:235], v[20:23], v[44:47]
  v_mfma_f32_16x16x32_bf16 v[48:51], a[232:235], v[24:27], v[48:51]
  s_waitcnt lgkmcnt(4)
  v_mfma_f32_16x16x32_bf16 v[36:39], a[108:111], v[28:31], v[36:39]
  ds_read_b128 v[20:23], v73 offset:61440
  v_mfma_f32_16x16x32_bf16 v[40:43], a[108:111], v[32:35], v[40:43]
  ds_read_b128 v[24:27], v73 offset:62464
  v_mfma_f32_16x16x32_bf16 v[44:47], a[236:239], v[28:31], v[44:47]
  v_mfma_f32_16x16x32_bf16 v[48:51], a[236:239], v[32:35], v[48:51]
  s_waitcnt lgkmcnt(4)
  v_mfma_f32_16x16x32_bf16 v[36:39], a[112:115], v[4:7], v[36:39]
  ds_read_b128 v[28:31], v73 offset:63488
  v_mfma_f32_16x16x32_bf16 v[40:43], a[112:115], v[8:11], v[40:43]
  ds_read_b128 v[32:35], v73 offset:64512
  v_mfma_f32_16x16x32_bf16 v[44:47], a[240:243], v[4:7], v[44:47]
  v_mfma_f32_16x16x32_bf16 v[48:51], a[240:243], v[8:11], v[48:51]
  s_waitcnt lgkmcnt(4)
  v_mfma_f32_16x16x32_bf16 v[36:39], a[116:119], v[12:15], v[36:39]
  v_mfma_f32_16x16x32_bf16 v[40:43], a[116:119], v[16:19], v[40:43]
  v_mfma_f32_16x16x32_bf16 v[44:47], a[244:247], v[12:15], v[44:47]
  v_mfma_f32_16x16x32_bf16 v[48:51], a[244:247], v[16:19], v[48:51]
  s_waitcnt lgkmcnt(2)
  v_mfma_f32_16x16x32_bf16 v[36:39], a[120:123], v[20:23], v[36:39]
  v_mfma_f32_16x16x32_bf16 v[40:43], a[120:123], v[24:27], v[40:43]
  v_mfma_f32_16x16x32_bf16 v[44:47], a[248:251], v[20:23], v[44:47]
  v_mfma_f32_16x16x32_bf16 v[48:51], a[248:251], v[24:27], v[48:51]
  s_waitcnt lgkmcnt(0)
  v_mfma_f32_16x16x32_bf16 v[36:39], a[124:127], v[28:31], v[36:39]
  v_mfma_f32_16x16x32_bf16 v[40:43], a[124:127], v[32:35], v[40:43]
  v_mfma_f32_16x16x32_bf16 v[44:47], a[252:255], v[28:31], v[44:47]
  v_mfma_f32_16x16x32_bf16 v[48:51], a[252:255], v[32:35], v[48:51]
L_WO_epi:
  s_nop 4
  v_cvt_pk_bf16_f32 v52, v36, v37
  v_cvt_pk_bf16_f32 v53, v38, v39
  v_cvt_pk_bf16_f32 v54, v44, v45
  v_cvt_pk_bf16_f32 v55, v46, v47
  buffer_store_dwordx4 v[52:55], v68, s[4:7], s31 offen offset:0 sc1
  v_cvt_pk_bf16_f32 v56, v40, v41
  v_cvt_pk_bf16_f32 v57, v42, v43
  v_cvt_pk_bf16_f32 v58, v48, v49
  v_cvt_pk_bf16_f32 v59, v50, v51
  buffer_store_dwordx4 v[56:59], v68, s[4:7], s31 offen offset:1024 sc1
  s_add_u32 s25, s25, 1
  s_add_u32 s31, s31, 262144
  s_branch L_WO_top
L_F1:
  s_load_dwordx2 s[8:9], s[0:1], 64
  s_mov_b32 s10, 7340032
  s_mov_b32 s11, 0x20000
  s_waitcnt lgkmcnt(0)
  s_lshl_b32 s44, s21, 7
  v_bfe_u32 v40, v0, 5, 1
  v_mul_u32_u24 v40, 28672, v40
  v_bfe_u32 v41, v0, 4, 1
  v_mul_u32_u24 v41, 14336, v41
  v_add_u32 v40, v40, v41
  v_bfe_u32 v41, v0, 3, 1
  v_mul_u32_u24 v41, 7168, v41
  v_add_u32 v40, v40, v41
  v_lshrrev_b32 v41, 3, v0
  v_and_b32 v41, 6, v41
  v_xor_b32 v41, v41, v0
  v_and_b32 v41, 7, v41
  v_lshl_add_u32 v40, v41, 4, v40
  s_lshr_b32 s40, s20, 1
  s_mul_i32 s40, s40, 458752
  s_and_b32 s41, s20, 1
  s_mul_i32 s41, s41, 57344
  s_add_u32 s40, s40, s41
  v_add_u32 v40, s40, v40
  v_bfe_u32 v41, v0, 3, 2
  v_xor_b32 v41, s20, v41
  v_lshlrev_b32 v41, 5, v41
  v_lshrrev_b32 v42, 2, v0
  v_lshl_add_u32 v42, v42, 7, v41
  v_and_b32 v41, 3, v0
  v_lshl_add_u32 v42, v41, 3, v42
  v_add_u32 v43, 0x10000, v42
  v_add_u32 v44, s44, v40
  v_add_u32 v45, s44, v40
  s_lshl_b32 s41, s20, 10
  s_add_u32 m0, s41, 0
  s_mov_b32 s42, 0
  buffer_load_dwordx4 v44, s[8:11], s42 offen nt lds
  s_add_u32 m0, s41, 4096
  s_mov_b32 s42, 114688
  buffer_load_dwordx4 v44, s[8:11], s42 offen nt lds
  s_add_u32 m0, s41, 8192
  s_mov_b32 s42, 229376
  buffer_load_dwordx4 v44, s[8:11], s42 offen nt lds
  s_add_u32 m0, s41, 12288
  s_mov_b32 s42, 344064
  buffer_load_dwordx4 v44, s[8:11], s42 offen nt lds
  s_add_u32 m0, s41, 16384
  s_mov_b32 s42, 917504
  buffer_load_dwordx4 v44, s[8:11], s42 offen nt lds
  s_add_u32 m0, s41, 20480
  s_mov_b32 s42, 1032192
  buffer_load_dwordx4 v44, s[8:11], s42 offen nt lds
  s_add_u32 m0, s41, 24576
  s_mov_b32 s42, 1146880
  buffer_load_dwordx4 v44, s[8:11], s42 offen nt lds
  s_add_u32 m0, s41, 28672
  s_mov_b32 s42, 1261568
  buffer_load_dwordx4 v44, s[8:11], s42 offen nt lds
  s_add_u32 m0, s41, 32768
  s_mov_b32 s42, 1835008
  buffer_load_dwordx4 v44, s[8:11], s42 offen nt lds
  s_add_u32 m0, s41, 36864
  s_mov_b32 s42, 1949696
  buffer_load_dwordx4 v44, s[8:11], s42 offen nt lds
  s_add_u32 m0, s41, 40960
  s_mov_b32 s42, 2064384
  buffer_load_dwordx4 v44, s[8:11], s42 offen nt lds
  s_add_u32 m0, s41, 45056
  s_mov_b32 s42, 2179072
  buffer_load_dwordx4 v44, s[8:11], s42 offen nt lds
  s_add_u32 m0, s41, 49152
  s_mov_b32 s42, 2752512
  buffer_load_dwordx4 v44, s[8:11], s42 offen nt lds
  s_add_u32 m0, s41, 53248
  s_mov_b32 s42, 2867200
  buffer_load_dwordx4 v44, s[8:11], s42 offen nt lds
  s_add_u32 m0, s41, 57344
  s_mov_b32 s42, 2981888
  buffer_load_dwordx4 v44, s[8:11], s42 offen nt lds
  s_add_u32 m0, s41, 61440
  s_mov_b32 s42, 3096576
  buffer_load_dwordx4 v44, s[8:11], s42 offen nt lds
  s_add_u32 m0, s41, 65536
  s_mov_b32 s42, 3670016
  buffer_load_dwordx4 v44, s[8:11], s42 offen nt lds
  s_add_u32 m0, s41, 69632
  s_mov_b32 s42, 3784704
  buffer_load_dwordx4 v44, s[8:11], s42 offen nt lds
  s_add_u32 m0, s41, 73728
  s_mov_b32 s42, 3899392
  buffer_load_dwordx4 v44, s[8:11], s42 offen nt lds
  s_add_u32 m0, s41, 77824
  s_mov_b32 s42, 4014080
  buffer_load_dwordx4 v44, s[8:11], s42 offen nt lds
  s_add_u32 m0, s41, 81920
  s_mov_b32 s42, 4587520
  buffer_load_dwordx4 v44, s[8:11], s42 offen nt lds
  s_add_u32 m0, s41, 86016
  s_mov_b32 s42, 4702208
  buffer_load_dwordx4 v44, s[8:11], s42 offen nt lds
  s_add_u32 m0, s41, 90112
  s_mov_b32 s42, 4816896
  buffer_load_dwordx4 v44, s[8:11], s42 offen nt lds
  s_add_u32 m0, s41, 94208
  s_mov_b32 s42, 4931584
  buffer_load_dwordx4 v44, s[8:11], s42 offen nt lds
  s_add_u32 m0, s41, 98304
  s_mov_b32 s42, 5505024
  buffer_load_dwordx4 v44, s[8:11], s42 offen nt lds
  s_add_u32 m0, s41, 102400
  s_mov_b32 s42, 5619712
  buffer_load_dwordx4 v44, s[8:11], s42 offen nt lds
  s_add_u32 m0, s41, 106496
  s_mov_b32 s42, 5734400
  buffer_load_dwordx4 v44, s[8:11], s42 offen nt lds
  s_add_u32 m0, s41, 110592
  s_mov_b32 s42, 5849088
  buffer_load_dwordx4 v44, s[8:11], s42 offen nt lds
  s_waitcnt vmcnt(24) lgkmcnt(0)
  s_barrier
  s_add_u32 m0, s41, 114688
  s_mov_b32 s42, 6422528
  buffer_load_dwordx4 v44, s[8:11], s42 offen nt lds
  s_add_u32 m0, s41, 118784
  s_mov_b32 s42, 6537216
  buffer_load_dwordx4 v44, s[8:11], s42 offen nt lds
  s_add_u32 m0, s41, 122880
  s_mov_b32 s42, 6651904
  buffer_load_dwordx4 v44, s[8:11], s42 offen nt lds
  s_add_u32 m0, s41, 126976
  s_mov_b32 s42, 6766592
  buffer_load_dwordx4 v44, s[8:11], s42 offen nt lds
  ds_read_b64_tr_b16 a[0:1], v42 offset:0
  ds_read_b64_tr_b16 a[2:3], v42 offset:2048
  ds_read_b64_tr_b16 a[4:5], v42 offset:4096
  ds_read_b64_tr_b16 a[6:7], v42 offset:6144
  ds_read_b64_tr_b16 a[8:9], v42 offset:8192
  ds_read_b64_tr_b16 a[10:11], v42 offset:10240
  ds_read_b64_tr_b16 a[12:13], v42 offset:12288
  ds_read_b64_tr_b16 a[14:15], v42 offset:14336
  s_waitcnt vmcnt(24) lgkmcnt(0)
  s_barrier
  s_load_dwordx2 s[8:9], s[0:1], 72
  s_mov_b32 s10, 7340032
  s_mov_b32 s11, 0x20000
  s_waitcnt lgkmcnt(0)
  s_add_u32 m0, s41, 0
  s_mov_b32 s42, 0
  buffer_load_dwordx4 v45, s[8:11], s42 offen nt lds
  s_add_u32 m0, s41, 4096
  s_mov_b32 s42, 114688
  buffer_load_dwordx4 v45, s[8:11], s42 offen nt lds
  s_add_u32 m0, s41, 8192
  s_mov_b32 s42, 229376
  buffer_load_dwordx4 v45, s[8:11], s42 offen nt lds
  s_add_u32 m0, s41, 12288
  s_mov_b32 s42, 344064
  buffer_load_dwordx4 v45, s[8:11], s42 offen nt lds
  ds_read_b64_tr_b16 a[16:17], v42 offset:16384
  ds_read_b64_tr_b16 a[18:19], v42 offset:18432
  ds_read_b64_tr_b16 a[20:21], v42 offset:20480
  ds_read_b64_tr_b16 a[22:23], v42 offset:22528
  ds_read_b64_tr_b16 a[24:25], v42 offset:24576
  ds_read_b64_tr_b16 a[26:27], v42 offset:26624
  ds_read_b64_tr_b16 a[28:29], v42 offset:28672
  ds_read_b64_tr_b16 a[30:31], v42 offset:30720
  s_waitcnt vmcnt(24) lgkmcnt(0)
  s_barrier
  s_add_u32 m0, s41, 16384
  s_mov_b32 s42, 917504
  buffer_load_dwordx4 v45, s[8:11], s42 offen nt lds
  s_add_u32 m0, s41, 20480
  s_mov_b32 s42, 1032192
  buffer_load_dwordx4 v45, s[8:11], s42 offen nt lds
  s_add_u32 m0, s41, 24576
  s_mov_b32 s42, 1146880
  buffer_load_dwordx4 v45, s[8:11], s42 offen nt lds
  s_add_u32 m0, s41, 28672
  s_mov_b32 s42, 1261568
  buffer_load_dwordx4 v45, s[8:11], s42 offen nt lds
  ds_read_b64_tr_b16 a[32:33], v42 offset:32768
  ds_read_b64_tr_b16 a[34:35], v42 offset:34816
  ds_read_b64_tr_b16 a[36:37], v42 offset:36864
  ds_read_b64_tr_b16 a[38:39], v42 offset:38912
  ds_read_b64_tr_b16 a[40:41], v42 offset:40960
  ds_read_b64_tr_b16 a[42:43], v42 offset:43008
  ds_read_b64_tr_b16 a[44:45], v42 offset:45056
  ds_read_b64_tr_b16 a[46:47], v42 offset:47104
  s_waitcnt vmcnt(24) lgkmcnt(0)
  s_barrier
  s_add_u32 m0, s41, 32768
  s_mov_b32 s42, 1835008
  buffer_load_dwordx4 v45, s[8:11], s42 offen nt lds
  s_add_u32 m0, s41, 36864
  s_mov_b32 s42, 1949696
  buffer_load_dwordx4 v45, s[8:11], s42 offen nt lds
  s_add_u32 m0, s41, 40960
  s_mov_b32 s42, 2064384
  buffer_load_dwordx4 v45, s[8:11], s42 offen nt lds
  s_add_u32 m0, s41, 45056
  s_mov_b32 s42, 2179072
  buffer_load_dwordx4 v45, s[8:11], s42 offen nt lds
  ds_read_b64_tr_b16 a[48:49], v42 offset:49152
  ds_read_b64_tr_b16 a[50:51], v42 offset:51200
  ds_read_b64_tr_b16 a[52:53], v42 offset:53248
  ds_read_b64_tr_b16 a[54:55], v42 offset:55296
  ds_read_b64_tr_b16 a[56:57], v42 offset:57344
  ds_read_b64_tr_b16 a[58:59], v42 offset:59392
  ds_read_b64_tr_b16 a[60:61], v42 offset:61440
  ds_read_b64_tr_b16 a[62:63], v42 offset:63488
  s_waitcnt vmcnt(24) lgkmcnt(0)
  s_barrier
  s_add_u32 m0, s41, 49152
  s_mov_b32 s42, 2752512
  buffer_load_dwordx4 v45, s[8:11], s42 offen nt lds
  s_add_u32 m0, s41, 53248
  s_mov_b32 s42, 2867200
  buffer_load_dwordx4 v45, s[8:11], s42 offen nt lds
  s_add_u32 m0, s41, 57344
  s_mov_b32 s42, 2981888
  buffer_load_dwordx4 v45, s[8:11], s42 offen nt lds
  s_add_u32 m0, s41, 61440
  s_mov_b32 s42, 3096576
  buffer_load_dwordx4 v45, s[8:11], s42 offen nt lds
  ds_read_b64_tr_b16 a[64:65], v43 offset:0
  ds_read_b64_tr_b16 a[66:67], v43 offset:2048
  ds_read_b64_tr_b16 a[68:69], v43 offset:4096
  ds_read_b64_tr_b16 a[70:71], v43 offset:6144
  ds_read_b64_tr_b16 a[72:73], v43 offset:8192
  ds_read_b64_tr_b16 a[74:75], v43 offset:10240
  ds_read_b64_tr_b16 a[76:77], v43 offset:12288
  ds_read_b64_tr_b16 a[78:79], v43 offset:14336
  s_waitcnt vmcnt(24) lgkmcnt(0)
  s_barrier
  s_add_u32 m0, s41, 65536
  s_mov_b32 s42, 3670016
  buffer_load_dwordx4 v45, s[8:11], s42 offen nt lds
  s_add_u32 m0, s41, 69632
  s_mov_b32 s42, 3784704
  buffer_load_dwordx4 v45, s[8:11], s42 offen nt lds
  s_add_u32 m0, s41, 73728
  s_mov_b32 s42, 3899392
  buffer_load_dwordx4 v45, s[8:11], s42 offen nt lds
  s_add_u32 m0, s41, 77824
  s_mov_b32 s42, 4014080
  buffer_load_dwordx4 v45, s[8:11], s42 offen nt lds
  ds_read_b64_tr_b16 a[80:81], v43 offset:16384
  ds_read_b64_tr_b16 a[82:83], v43 offset:18432
  ds_read_b64_tr_b16 a[84:85], v43 offset:20480
  ds_read_b64_tr_b16 a[86:87], v43 offset:22528
  ds_read_b64_tr_b16 a[88:89], v43 offset:24576
  ds_read_b64_tr_b16 a[90:91], v43 offset:26624
  ds_read_b64_tr_b16 a[92:93], v43 offset:28672
  ds_read_b64_tr_b16 a[94:95], v43 offset:30720
  s_waitcnt vmcnt(24) lgkmcnt(0)
  s_barrier
  s_add_u32 m0, s41, 81920
  s_mov_b32 s42, 4587520
  buffer_load_dwordx4 v45, s[8:11], s42 offen nt lds
  s_add_u32 m0, s41, 86016
  s_mov_b32 s42, 4702208
  buffer_load_dwordx4 v45, s[8:11], s42 offen nt lds
  s_add_u32 m0, s41, 90112
  s_mov_b32 s42, 4816896
  buffer_load_dwordx4 v45, s[8:11], s42 offen nt lds
  s_add_u32 m0, s41, 94208
  s_mov_b32 s42, 4931584
  buffer_load_dwordx4 v45, s[8:11], s42 offen nt lds
  ds_read_b64_tr_b16 a[96:97], v43 offset:32768
  ds_read_b64_tr_b16 a[98:99], v43 offset:34816
  ds_read_b64_tr_b16 a[100:101], v43 offset:36864
  ds_read_b64_tr_b16 a[102:103], v43 offset:38912
  ds_read_b64_tr_b16 a[104:105], v43 offset:40960
  ds_read_b64_tr_b16 a[106:107], v43 offset:43008
  ds_read_b64_tr_b16 a[108:109], v43 offset:45056
  ds_read_b64_tr_b16 a[110:111], v43 offset:47104
  s_waitcnt vmcnt(24) lgkmcnt(0)
  s_barrier
  s_add_u32 m0, s41, 98304
  s_mov_b32 s42, 5505024
  buffer_load_dwordx4 v45, s[8:11], s42 offen nt lds
  s_add_u32 m0, s41, 102400
  s_mov_b32 s42, 5619712
  buffer_load_dwordx4 v45, s[8:11], s42 offen nt lds
  s_add_u32 m0, s41, 106496
  s_mov_b32 s42, 5734400
  buffer_load_dwordx4 v45, s[8:11], s42 offen nt lds
  s_add_u32 m0, s41, 110592
  s_mov_b32 s42, 5849088
  buffer_load_dwordx4 v45, s[8:11], s42 offen nt lds
  ds_read_b64_tr_b16 a[112:113], v43 offset:49152
  ds_read_b64_tr_b16 a[114:115], v43 offset:51200
  ds_read_b64_tr_b16 a[116:117], v43 offset:53248
  ds_read_b64_tr_b16 a[118:119], v43 offset:55296
  ds_read_b64_tr_b16 a[120:121], v43 offset:57344
  ds_read_b64_tr_b16 a[122:123], v43 offset:59392
  ds_read_b64_tr_b16 a[124:125], v43 offset:61440
  ds_read_b64_tr_b16 a[126:127], v43 offset:63488
  s_waitcnt vmcnt(24) lgkmcnt(0)
  s_barrier
  s_add_u32 m0, s41, 114688
  s_mov_b32 s42, 6422528
  buffer_load_dwordx4 v45, s[8:11], s42 offen nt lds
  s_add_u32 m0, s41, 118784
  s_mov_b32 s42, 6537216
  buffer_load_dwordx4 v45, s[8:11], s42 offen nt lds
  s_add_u32 m0, s41, 122880
  s_mov_b32 s42, 6651904
  buffer_load_dwordx4 v45, s[8:11], s42 offen nt lds
  s_add_u32 m0, s41, 126976
  s_mov_b32 s42, 6766592
  buffer_load_dwordx4 v45, s[8:11], s42 offen nt lds
  ds_read_b64_tr_b16 a[128:129], v42 offset:0
  ds_read_b64_tr_b16 a[130:131], v42 offset:2048
  ds_read_b64_tr_b16 a[132:133], v42 offset:4096
  ds_read_b64_tr_b16 a[134:135], v42 offset:6144
  ds_read_b64_tr_b16 a[136:137], v42 offset:8192
  ds_read_b64_tr_b16 a[138:139], v42 offset:10240
  ds_read_b64_tr_b16 a[140:141], v42 offset:12288
  ds_read_b64_tr_b16 a[142:143], v42 offset:14336
  s_waitcnt vmcnt(24) lgkmcnt(0)
  s_barrier
  ds_read_b64_tr_b16 a[144:145], v42 offset:16384
  ds_read_b64_tr_b16 a[146:147], v42 offset:18432
  ds_read_b64_tr_b16 a[148:149], v42 offset:20480
  ds_read_b64_tr_b16 a[150:151], v42 offset:22528
  ds_read_b64_tr_b16 a[152:153], v42 offset:24576
  ds_read_b64_tr_b16 a[154:155], v42 offset:26624
  ds_read_b64_tr_b16 a[156:157], v42 offset:28672
  ds_read_b64_tr_b16 a[158:159], v42 offset:30720
  s_waitcnt vmcnt(20) lgkmcnt(0)
  s_barrier
  ds_read_b64_tr_b16 a[160:161], v42 offset:32768
  ds_read_b64_tr_b16 a[162:163], v42 offset:34816
  ds_read_b64_tr_b16 a[164:165], v42 offset:36864
  ds_read_b64_tr_b16 a[166:167], v42 offset:38912
  ds_read_b64_tr_b16 a[168:169], v42 offset:40960
  ds_read_b64_tr_b16 a[170:171], v42 offset:43008
  ds_read_b64_tr_b16 a[172:173], v42 offset:45056
  ds_read_b64_tr_b16 a[174:175], v42 offset:47104
  s_waitcnt vmcnt(16) lgkmcnt(0)
  s_barrier
  ds_read_b64_tr_b16 a[176:177], v42 offset:49152
  ds_read_b64_tr_b16 a[178:179], v42 offset:51200
  ds_read_b64_tr_b16 a[180:181], v42 offset:53248
  ds_read_b64_tr_b16 a[182:183], v42 offset:55296
  ds_read_b64_tr_b16 a[184:185], v42 offset:57344
  ds_read_b64_tr_b16 a[186:187], v42 offset:59392
  ds_read_b64_tr_b16 a[188:189], v42 offset:61440
  ds_read_b64_tr_b16 a[190:191], v42 offset:63488
  s_waitcnt vmcnt(12) lgkmcnt(0)
  s_barrier
  ds_read_b64_tr_b16 a[192:193], v43 offset:0
  ds_read_b64_tr_b16 a[194:195], v43 offset:2048
  ds_read_b64_tr_b16 a[196:197], v43 offset:4096
  ds_read_b64_tr_b16 a[198:199], v43 offset:6144
  ds_read_b64_tr_b16 a[200:201], v43 offset:8192
  ds_read_b64_tr_b16 a[202:203], v43 offset:10240
  ds_read_b64_tr_b16 a[204:205], v43 offset:12288
  ds_read_b64_tr_b16 a[206:207], v43 offset:14336
  s_waitcnt vmcnt(8) lgkmcnt(0)
  s_barrier
  ds_read_b64_tr_b16 a[208:209], v43 offset:16384
  ds_read_b64_tr_b16 a[210:211], v43 offset:18432
  ds_read_b64_tr_b16 a[212:213], v43 offset:20480
  ds_read_b64_tr_b16 a[214:215], v43 offset:22528
  ds_read_b64_tr_b16 a[216:217], v43 offset:24576
  ds_read_b64_tr_b16 a[218:219], v43 offset:26624
  ds_read_b64_tr_b16 a[220:221], v43 offset:28672
  ds_read_b64_tr_b16 a[222:223], v43 offset:30720
  s_waitcnt vmcnt(4) lgkmcnt(0)
  s_barrier
  ds_read_b64_tr_b16 a[224:225], v43 offset:32768
  ds_read_b64_tr_b16 a[226:227], v43 offset:34816
  ds_read_b64_tr_b16 a[228:229], v43 offset:36864
  ds_read_b64_tr_b16 a[230:231], v43 offset:38912
  ds_read_b64_tr_b16 a[232:233], v43 offset:40960
  ds_read_b64_tr_b16 a[234:235], v43 offset:43008
  ds_read_b64_tr_b16 a[236:237], v43 offset:45056
  ds_read_b64_tr_b16 a[238:239], v43 offset:47104
  s_waitcnt vmcnt(0) lgkmcnt(0)
  s_barrier
  ds_read_b64_tr_b16 a[240:241], v43 offset:49152
  ds_read_b64_tr_b16 a[242:243], v43 offset:51200
  ds_read_b64_tr_b16 a[244:245], v43 offset:53248
  ds_read_b64_tr_b16 a[246:247], v43 offset:55296
  ds_read_b64_tr_b16 a[248:249], v43 offset:57344
  ds_read_b64_tr_b16 a[250:251], v43 offset:59392
  ds_read_b64_tr_b16 a[252:253], v43 offset:61440
  ds_read_b64_tr_b16 a[254:255], v43 offset:63488
  s_waitcnt lgkmcnt(0)
  s_barrier
  v_min_u32 v2, 3, v0
  v_lshlrev_b32 v2, 7, v2
  v_add_u32 v2, 1413120, v2
  s_lshl_b32 s62, s21, 7
  s_add_u32 s62, s62, 1414144
  s_mov_b32 s27, 6291456
  s_lshl_b32 s40, s21, 12
  s_add_u32 s31, s40, 44040192
  s_lshr_b32 s40, s20, 1
  s_lshl_b32 s40, s40, 11
  s_and_b32 s41, s20, 1
  s_lshl_b32 s41, s41, 9
  s_add_u32 s40, s40, s41
  v_and_b32 v52, 31, v0
  v_lshl_add_u32 v68, v52, 4, s40
  v_lshrrev_b32 v52, 5, v0
  v_lshl_add_u32 v68, v52, 10, v68
  s_mov_b32 s37, 0xbfb8aa3b
  v_lshlrev_b32 v1, 4, v0
  s_lshl_b32 s32, s20, 12
  s_mul_i32 s33, s20, 3072
  v_mov_b32 v69, v1
  v_add_u32 v70, 0x10000, v69
  s_lshl_b32 s40, s20, 2
  s_add_u32 s40, s40, 131072
  v_mov_b32 v71, s40
  v_mov_b32 v52, 0
  ds_write_b32 v71, v52
  s_mov_b32 s25, 0
  s_mov_b32 s26, 0
  s_mov_b32 s29, 1
  s_mov_b32 s30, 0
  s_mov_b32 s28, 1
  s_waitcnt lgkmcnt(0)
  s_barrier
  s_branch L_F1_poll
L_F1_top:
  s_cmp_lg_u32 s28, 0
  s_cbranch_scc1 L_F1_go
  buffer_load_dword v3, v2, s[4:7], s30 offen sc1
  v_mov_b32 v52, s25
  v_and_b32 v53, 3, v0
  v_lshlrev_b32 v53, 2, v53
  v_add_u32 v53, 131072, v53
  s_waitcnt vmcnt(1)
  ds_write_b32 v71, v52
  ds_read_b32 v53, v53
  s_waitcnt lgkmcnt(0)
  v_cmp_gt_i32 vcc, s25, v53
  s_cbranch_vccnz L_F1_nosig
  s_mov_b32 s63, s25
  s_atomic_smax s63, s[4:5], s62 glc
Lnosig_28:
L_F1_nosig:
  s_cmp_ge_u32 s25, 64
  s_cbranch_scc1 L_END
  s_waitcnt vmcnt(0)
  v_cmp_gt_i32 vcc, s29, v3
  s_cbranch_vccz L_F1_issue
L_F1_poll:
  s_nop 3
Lpoll_29:
  buffer_load_dword v3, v2, s[4:7], s30 offen sc1
  s_sub_u32 s24, s24, 1
  s_cbranch_scc1 L_FAIL
  s_waitcnt vmcnt(0)
  v_cmp_gt_i32 vcc, s29, v3
  s_cbranch_vccz Lpolld_30
  s_sleep 2
  s_branch Lpoll_29
Lpolld_30:
L_F1_issue:
  s_mov_b32 s34, s26
  s_mov_b32 s35, s27
  s_add_u32 s36, s32, 0
  s_add_u32 m0, s34, s36
  s_add_u32 s36, s35, s36
  buffer_load_dwordx4 v1, s[4:7], s36 offen offset:0 sc1 lds
  buffer_load_dwordx4 v1, s[4:7], s36 offen offset:1024 sc1 lds
  buffer_load_dwordx4 v1, s[4:7], s36 offen offset:2048 sc1 lds
  buffer_load_dwordx4 v1, s[4:7], s36 offen offset:3072 sc1 lds
  s_add_u32 s36, s32, 16384
  s_add_u32 m0, s34, s36
  s_add_u32 s36, s35, s36
  buffer_load_dwordx4 v1, s[4:7], s36 offen offset:0 sc1 lds
  buffer_load_dwordx4 v1, s[4:7], s36 offen offset:1024 sc1 lds
  buffer_load_dwordx4 v1, s[4:7], s36 offen offset:2048 sc1 lds
  buffer_load_dwordx4 v1, s[4:7], s36 offen offset:3072 sc1 lds
  s_add_u32 s36, s32, 32768
  s_add_u32 m0, s34, s36
  s_add_u32 s36, s35, s36
  buffer_load_dwordx4 v1, s[4:7], s36 offen offset:0 sc1 lds
  buffer_load_dwordx4 v1, s[4:7], s36 offen offset:1024 sc1 lds
  buffer_load_dwordx4 v1, s[4:7], s36 offen offset:2048 sc1 lds
  buffer_load_dwordx4 v1, s[4:7], s36 offen offset:3072 sc1 lds
  s_add_u32 s36, s32, 49152
  s_add_u32 m0, s34, s36
  s_add_u32 s36, s35, s36
  buffer_load_dwordx4 v1, s[4:7], s36 offen offset:0 sc1 lds
  buffer_load_dwordx4 v1, s[4:7], s36 offen offset:1024 sc1 lds
  buffer_load_dwordx4 v1, s[4:7], s36 offen offset:2048 sc1 lds
  buffer_load_dwordx4 v1, s[4:7], s36 offen offset:3072 sc1 lds
L_F1_go:
  v_add_u32 v73, s26, v69
  v_add_u32 v74, s26, v70
  s_sub_u32 s26, 65536, s26
  s_add_u32 s27, s27, 65536
  s_mov_b32 s34, s26
  s_mov_b32 s35, s27
  s_add_u32 s29, s29, 1
  s_xor_b32 s30, s30, 512
  s_waitcnt vmcnt(12)
  s_barrier
  ds_read_b128 v[4:7], v73 offset:0
  ds_read_b128 v[8:11], v73 offset:1024
  ds_read_b128 v[12:15], v73 offset:2048
  ds_read_b128 v[16:19], v73 offset:3072
  ds_read_b128 v[20:23], v73 offset:4096
  ds_read_b128 v[24:27], v73 offset:5120
  buffer_load_dword v3, v2, s[4:7], s30 offen sc1
  s_waitcnt lgkmcnt(4)
  v_mfma_f32_16x16x32_bf16 v[36:39], a[0:3], v[4:7], 0
  ds_read_b128 v[28:31], v73 offset:6144
  v_mfma_f32_16x16x32_bf16 v[40:43], a[0:3], v[8:11], 0
  ds_read_b128 v[32:35], v73 offset:7168
  v_mfma_f32_16x16x32_bf16 v[44:47], a[128:131], v[4:7], 0
  v_mfma_f32_16x16x32_bf16 v[48:51], a[128:131], v[8:11], 0
  s_waitcnt lgkmcnt(4)
  v_mfma_f32_16x16x32_bf16 v[36:39], a[4:7], v[12:15], v[36:39]
  ds_read_b128 v[4:7], v73 offset:8192
  v_mfma_f32_16x16x32_bf16 v[40:43], a[4:7], v[16:19], v[40:43]
  ds_read_b128 v[8:11], v73 offset:9216
  v_mfma_f32_16x16x32_bf16 v[44:47], a[132:135], v[12:15], v[44:47]
  v_mfma_f32_16x16x32_bf16 v[48:51], a[132:135], v[16:19], v[48:51]
  s_waitcnt lgkmcnt(4)
  v_mfma_f32_16x16x32_bf16 v[36:39], a[8:11], v[20:23], v[36:39]
  ds_read_b128 v[12:15], v73 offset:10240
  v_mfma_f32_16x16x32_bf16 v[40:43], a[8:11], v[24:27], v[40:43]
  ds_read_b128 v[16:19], v73 offset:11264
  v_mfma_f32_16x16x32_bf16 v[44:47], a[136:139], v[20:23], v[44:47]
  v_mfma_f32_16x16x32_bf16 v[48:51], a[136:139], v[24:27], v[48:51]
  s_waitcnt lgkmcnt(4)
  v_mfma_f32_16x16x32_bf16 v[36:39], a[12:15], v[28:31], v[36:39]
  ds_read_b128 v[20:23], v73 offset:12288
  v_mfma_f32_16x16x32_bf16 v[40:43], a[12:15], v[32:35], v[40:43]
  ds_read_b128 v[24:27], v73 offset:13312
  v_mfma_f32_16x16x32_bf16 v[44:47], a[140:143], v[28:31], v[44:47]
  v_mfma_f32_16x16x32_bf16 v[48:51], a[140:143], v[32:35], v[48:51]
  s_waitcnt lgkmcnt(4)
  v_mfma_f32_16x16x32_bf16 v[36:39], a[16:19], v[4:7], v[36:39]
  ds_read_b128 v[28:31], v73 offset:14336
  v_mfma_f32_16x16x32_bf16 v[40:43], a[16:19], v[8:11], v[40:43]
  ds_read_b128 v[32:35], v73 offset:15360
  v_mfma_f32_16x16x32_bf16 v[44:47], a[144:147], v[4:7], v[44:47]
  v_mfma_f32_16x16x32_bf16 v[48:51], a[144:147], v[8:11], v[48:51]
  s_waitcnt vmcnt(9)
  s_barrier
  s_waitcnt lgkmcnt(4)
  v_mfma_f32_16x16x32_bf16 v[36:39], a[20:23], v[12:15], v[36:39]
  ds_read_b128 v[4:7], v73 offset:16384
  v_mfma_f32_16x16x32_bf16 v[40:43], a[20:23], v[16:19], v[40:43]
  ds_read_b128 v[8:11], v73 offset:17408
  v_mfma_f32_16x16x32_bf16 v[44:47], a[148:151], v[12:15], v[44:47]
  v_mfma_f32_16x16x32_bf16 v[48:51], a[148:151], v[16:19], v[48:51]
  s_waitcnt lgkmcnt(4)
  v_mfma_f32_16x16x32_bf16 v[36:39], a[24:27], v[20:23], v[36:39]
  ds_read_b128 v[12:15], v73 offset:18432
  v_mfma_f32_16x16x32_bf16 v[40:43], a[24:27], v[24:27], v[40:43]
  ds_read_b128 v[16:19], v73 offset:19456
  v_mfma_f32_16x16x32_bf16 v[44:47], a[152:155], v[20:23], v[44:47]
  v_mfma_f32_16x16x32_bf16 v[48:51], a[152:155], v[24:27], v[48:51]
  s_waitcnt lgkmcnt(4)
  v_mfma_f32_16x16x32_bf16 v[36:39], a[28:31], v[28:31], v[36:39]
  ds_read_b128 v[20:23], v73 offset:20480
  v_mfma_f32_16x16x32_bf16 v[40:43], a[28:31], v[32:35], v[40:43]
  ds_read_b128 v[24:27], v73 offset:21504
  v_mfma_f32_16x16x32_bf16 v[44:47], a[156:159], v[28:31], v[44:47]
  v_mfma_f32_16x16x32_bf16 v[48:51], a[156:159], v[32:35], v[48:51]
  s_waitcnt lgkmcnt(4)
  v_mfma_f32_16x16x32_bf16 v[36:39], a[32:35], v[4:7], v[36:39]
  ds_read_b128 v[28:31], v73 offset:22528
  v_mfma_f32_16x16x32_bf16 v[40:43], a[32:35], v[8:11], v[40:43]
  ds_read_b128 v[32:35], v73 offset:23552
  v_mfma_f32_16x16x32_bf16 v[44:47], a[160:163], v[4:7], v[44:47]
  v_mfma_f32_16x16x32_bf16 v[48:51], a[160:163], v[8:11], v[48:51]
  s_waitcnt lgkmcnt(4)
  v_mfma_f32_16x16x32_bf16 v[36:39], a[36:39], v[12:15], v[36:39]
  ds_read_b128 v[4:7], v73 offset:24576
  v_mfma_f32_16x16x32_bf16 v[40:43], a[36:39], v[16:19], v[40:43]
  ds_read_b128 v[8:11], v73 offset:25600
  v_mfma_f32_16x16x32_bf16 v[44:47], a[164:167], v[12:15], v[44:47]
  v_mfma_f32_16x16x32_bf16 v[48:51], a[164:167], v[16:19], v[48:51]
  s_waitcnt lgkmcnt(4)
  v_mfma_f32_16x16x32_bf16 v[36:39], a[40:43], v[20:23], v[36:39]
  ds_read_b128 v[12:15], v73 offset:26624
  v_mfma_f32_16x16x32_bf16 v[40:43], a[40:43], v[24:27], v[40:43]
  ds_read_b128 v[16:19], v73 offset:27648
  v_mfma_f32_16x16x32_bf16 v[44:47], a[168:171], v[20:23], v[44:47]
  v_mfma_f32_16x16x32_bf16 v[48:51], a[168:171], v[24:27], v[48:51]
  s_waitcnt lgkmcnt(4)
  v_mfma_f32_16x16x32_bf16 v[36:39], a[44:47], v[28:31], v[36:39]
  ds_read_b128 v[20:23], v73 offset:28672
  v_mfma_f32_16x16x32_bf16 v[40:43], a[44:47], v[32:35], v[40:43]
  ds_read_b128 v[24:27], v73 offset:29696
  v_mfma_f32_16x16x32_bf16 v[44:47], a[172:175], v[28:31], v[44:47]
  v_mfma_f32_16x16x32_bf16 v[48:51], a[172:175], v[32:35], v[48:51]
  s_waitcnt lgkmcnt(4)
  v_mfma_f32_16x16x32_bf16 v[36:39], a[48:51], v[4:7], v[36:39]
  ds_read_b128 v[28:31], v73 offset:30720
  v_mfma_f32_16x16x32_bf16 v[40:43], a[48:51], v[8:11], v[40:43]
  ds_read_b128 v[32:35], v73 offset:31744
  v_mfma_f32_16x16x32_bf16 v[44:47], a[176:179], v[4:7], v[44:47]
  v_mfma_f32_16x16x32_bf16 v[48:51], a[176:179], v[8:11], v[48:51]
  s_waitcnt vmcnt(0)
  s_barrier
  v_cmp_gt_i32 vcc, s29, v3
  s_cmp_lg_u32 s20, 0
  s_cbranch_scc1 Lnosig_31
  s_mov_b32 s63, s25
  s_atomic_smax s63, s[4:5], s62 glc
Lnosig_31:
L_F1_s2:
  s_mov_b32 s28, 0
  s_cbranch_vccnz L_F1_nopf
  s_cmp_ge_u32 s25, 63
  s_cbranch_scc1 L_F1_nopf
  s_mov_b32 s28, 1
  s_waitcnt lgkmcnt(4)
  v_mfma_f32_16x16x32_bf16 v[36:39], a[52:55], v[12:15], v[36:39]
  ds_read_b128 v[4:7], v73 offset:32768
  v_mfma_f32_16x16x32_bf16 v[40:43], a[52:55], v[16:19], v[40:43]
  ds_read_b128 v[8:11], v73 offset:33792
  v_mfma_f32_16x16x32_bf16 v[44:47], a[180:183], v[12:15], v[44:47]
  s_add_u32 s36, s32, 0
  s_add_u32 m0, s34, s36
  s_add_u32 s36, s35, s36
  buffer_load_dwordx4 v1, s[4:7], s36 offen offset:0 sc1 lds
  v_mfma_f32_16x16x32_bf16 v[48:51], a[180:183], v[16:19], v[48:51]
  s_waitcnt lgkmcnt(4)
  v_mfma_f32_16x16x32_bf16 v[36:39], a[56:59], v[20:23], v[36:39]
  ds_read_b128 v[12:15], v73 offset:34816
  v_mfma_f32_16x16x32_bf16 v[40:43], a[56:59], v[24:27], v[40:43]
  ds_read_b128 v[16:19], v73 offset:35840
  v_mfma_f32_16x16x32_bf16 v[44:47], a[184:187], v[20:23], v[44:47]
  buffer_load_dwordx4 v1, s[4:7], s36 offen offset:1024 sc1 lds
  v_mfma_f32_16x16x32_bf16 v[48:51], a[184:187], v[24:27], v[48:51]
  s_waitcnt lgkmcnt(4)
  v_mfma_f32_16x16x32_bf16 v[36:39], a[60:63], v[28:31], v[36:39]
  ds_read_b128 v[20:23], v73 offset:36864
  v_mfma_f32_16x16x32_bf16 v[40:43], a[60:63], v[32:35], v[40:43]
  ds_read_b128 v[24:27], v73 offset:37888
  v_mfma_f32_16x16x32_bf16 v[44:47], a[188:191], v[28:31], v[44:47]
  buffer_load_dwordx4 v1, s[4:7], s36 offen offset:2048 sc1 lds
  v_mfma_f32_16x16x32_bf16 v[48:51], a[188:191], v[32:35], v[48:51]
  s_waitcnt lgkmcnt(4)
  v_mfma_f32_16x16x32_bf16 v[36:39], a[64:67], v[4:7], v[36:39]
  ds_read_b128 v[28:31], v73 offset:38912
  v_mfma_f32_16x16x32_bf16 v[40:43], a[64:67], v[8:11], v[40:43]
  ds_read_b128 v[32:35], v73 offset:39936
  v_mfma_f32_16x16x32_bf16 v[44:47], a[192:195], v[4:7], v[44:47]
  buffer_load_dwordx4 v1, s[4:7], s36 offen offset:3072 sc1 lds
  v_mfma_f32_16x16x32_bf16 v[48:51], a[192:195], v[8:11], v[48:51]
  s_waitcnt lgkmcnt(4)
  v_mfma_f32_16x16x32_bf16 v[36:39], a[68:71], v[12:15], v[36:39]
  ds_read_b128 v[4:7], v73 offset:40960
  v_mfma_f32_16x16x32_bf16 v[40:43], a[68:71], v[16:19], v[40:43]
  ds_read_b128 v[8:11], v73 offset:41984
  v_mfma_f32_16x16x32_bf16 v[44:47], a[196:199], v[12:15], v[44:47]
  s_add_u32 s36, s32, 16384
  s_add_u32 m0, s34, s36
  s_add_u32 s36, s35, s36
  buffer_load_dwordx4 v1, s[4:7], s36 offen offset:0 sc1 lds
  v_mfma_f32_16x16x32_bf16 v[48:51], a[196:199], v[16:19], v[48:51]
  s_waitcnt lgkmcnt(4)
  v_mfma_f32_16x16x32_bf16 v[36:39], a[72:75], v[20:23], v[36:39]
  ds_read_b128 v[12:15], v73 offset:43008
  v_mfma_f32_16x16x32_bf16 v[40:43], a[72:75], v[24:27], v[40:43]
  ds_read_b128 v[16:19], v73 offset:44032
  v_mfma_f32_16x16x32_bf16 v[44:47], a[200:203], v[20:23], v[44:47]
  buffer_load_dwordx4 v1, s[4:7], s36 offen offset:1024 sc1 lds
  v_mfma_f32_16x16x32_bf16 v[48:51], a[200:203], v[24:27], v[48:51]
  s_waitcnt lgkmcnt(4)
  v_mfma_f32_16x16x32_bf16 v[36:39], a[76:79], v[28:31], v[36:39]
  ds_read_b128 v[20:23], v73 offset:45056
  v_mfma_f32_16x16x32_bf16 v[40:43], a[76:79], v[32:35], v[40:43]
  ds_read_b128 v[24:27], v73 offset:46080
  v_mfma_f32_16x16x32_bf16 v[44:47], a[204:207], v[28:31], v[44:47]
  buffer_load_dwordx4 v1, s[4:7], s36 offen offset:2048 sc1 lds
  v_mfma_f32_16x16x32_bf16 v[48:51], a[204:207], v[32:35], v[48:51]
  s_waitcnt lgkmcnt(4)
  v_mfma_f32_16x16x32_bf16 v[36:39], a[80:83], v[4:7], v[36:39]
  ds_read_b128 v[28:31], v73 offset:47104
  v_mfma_f32_16x16x32_bf16 v[40:43], a[80:83], v[8:11], v[40:43]
  ds_read_b128 v[32:35], v73 offset:48128
  v_mfma_f32_16x16x32_bf16 v[44:47], a[208:211], v[4:7], v[44:47]
  buffer_load_dwordx4 v1, s[4:7], s36 offen offset:3072 sc1 lds
  v_mfma_f32_16x16x32_bf16 v[48:51], a[208:211], v[8:11], v[48:51]
  s_waitcnt lgkmcnt(4)
  v_mfma_f32_16x16x32_bf16 v[36:39], a[84:87], v[12:15], v[36:39]
  ds_read_b128 v[4:7], v73 offset:49152
  v_mfma_f32_16x16x32_bf16 v[40:43], a[84:87], v[16:19], v[40:43]
  ds_read_b128 v[8:11], v73 offset:50176
  v_mfma_f32_16x16x32_bf16 v[44:47], a[212:215], v[12:15], v[44:47]
  s_add_u32 s36, s32, 32768
  s_add_u32 m0, s34, s36
  s_add_u32 s36, s35, s36
  buffer_load_dwordx4 v1, s[4:7], s36 offen offset:0 sc1 lds
  v_mfma_f32_16x16x32_bf16 v[48:51], a[212:215], v[16:19], v[48:51]
  s_waitcnt lgkmcnt(4)
  v_mfma_f32_16x16x32_bf16 v[36:39], a[88:91], v[20:23], v[36:39]
  ds_read_b128 v[12:15], v73 offset:51200
  v_mfma_f32_16x16x32_bf16 v[40:43], a[88:91], v[24:27], v[40:43]
  ds_read_b128 v[16:19], v73 offset:52224
  v_mfma_f32_16x16x32_bf16 v[44:47], a[216:219], v[20:23], v[44:47]
  buffer_load_dwordx4 v1, s[4:7], s36 offen offset:1024 sc1 lds
  v_mfma_f32_16x16x32_bf16 v[48:51], a[216:219], v[24:27], v[48:51]
  s_waitcnt lgkmcnt(4)
  v_mfma_f32_16x16x32_bf16 v[36:39], a[92:95], v[28:31], v[36:39]
  ds_read_b128 v[20:23], v73 offset:53248
  v_mfma_f32_16x16x32_bf16 v[40:43], a[92:95], v[32:35], v[40:43]
  ds_read_b128 v[24:27], v73 offset:54272
  v_mfma_f32_16x16x32_bf16 v[44:47], a[220:223], v[28:31], v[44:47]
  buffer_load_dwordx4 v1, s[4:7], s36 offen offset:2048 sc1 lds
  v_mfma_f32_16x16x32_bf16 v[48:51], a[220:223], v[32:35], v[48:51]
  s_waitcnt lgkmcnt(4)
  v_mfma_f32_16x16x32_bf16 v[36:39], a[96:99], v[4:7], v[36:39]
  ds_read_b128 v[28:31], v73 offset:55296
  v_mfma_f32_16x16x32_bf16 v[40:43], a[96:99], v[8:11], v[40:43]
  ds_read_b128 v[32:35], v73 offset:56320
  v_mfma_f32_16x16x32_bf16 v[44:47], a[224:227], v[4:7], v[44:47]
  buffer_load_dwordx4 v1, s[4:7], s36 offen offset:3072 sc1 lds
  v_mfma_f32_16x16x32_bf16 v[48:51], a[224:227], v[8:11], v[48:51]
  s_waitcnt lgkmcnt(4)
  v_mfma_f32_16x16x32_bf16 v[36:39], a[100:103], v[12:15], v[36:39]
  ds_read_b128 v[4:7], v73 offset:57344
  v_mfma_f32_16x16x32_bf16 v[40:43], a[100:103], v[16:19], v[40:43]
  ds_read_b128 v[8:11], v73 offset:58368
  v_mfma_f32_16x16x32_bf16 v[44:47], a[228:231], v[12:15], v[44:47]
  s_add_u32 s36, s32, 49152
  s_add_u32 m0, s34, s36
  s_add_u32 s36, s35, s36
  buffer_load_dwordx4 v1, s[4:7], s36 offen offset:0 sc1 lds
  v_mfma_f32_16x16x32_bf16 v[48:51], a[228:231], v[16:19], v[48:51]
  s_waitcnt lgkmcnt(4)
  v_mfma_f32_16x16x32_bf16 v[36:39], a[104:107], v[20:23], v[36:39]
  ds_read_b128 v[12:15], v73 offset:59392
  v_mfma_f32_16x16x32_bf16 v[40:43], a[104:107], v[24:27], v[40:43]
  ds_read_b128 v[16:19], v73 offset:60416
  v_mfma_f32_16x16x32_bf16 v[44:47], a[232:235], v[20:23], v[44:47]
  buffer_load_dwordx4 v1, s[4:7], s36 offen offset:1024 sc1 lds
  v_mfma_f32_16x16x32_bf16 v[48:51], a[232:235], v[24:27], v[48:51]
  s_waitcnt lgkmcnt(4)
  v_mfma_f32_16x16x32_bf16 v[36:39], a[108:111], v[28:31], v[36:39]
  ds_read_b128 v[20:23], v73 offset:61440
  v_mfma_f32_16x16x32_bf16 v[40:43], a[108:111], v[32:35], v[40:43]
  ds_read_b128 v[24:27], v73 offset:62464
  v_mfma_f32_16x16x32_bf16 v[44:47], a[236:239], v[28:31], v[44:47]
  buffer_load_dwordx4 v1, s[4:7], s36 offen offset:2048 sc1 lds
  v_mfma_f32_16x16x32_bf16 v[48:51], a[236:239], v[32:35], v[48:51]
  s_waitcnt lgkmcnt(4)
  v_mfma_f32_16x16x32_bf16 v[36:39], a[112:115], v[4:7], v[36:39]
  ds_read_b128 v[28:31], v73 offset:63488
  v_mfma_f32_16x16x32_bf16 v[40:43], a[112:115], v[8:11], v[40:43]
  ds_read_b128 v[32:35], v73 offset:64512
  v_mfma_f32_16x16x32_bf16 v[44:47], a[240:243], v[4:7], v[44:47]
  buffer_load_dwordx4 v1, s[4:7], s36 offen offset:3072 sc1 lds
  v_mfma_f32_16x16x32_bf16 v[48:51], a[240:243], v[8:11], v[48:51]
  s_waitcnt lgkmcnt(4)
  v_mfma_f32_16x16x32_bf16 v[36:39], a[116:119], v[12:15], v[36:39]
  v_mfma_f32_16x16x32_bf16 v[40:43], a[116:119], v[16:19], v[40:43]
  v_mfma_f32_16x16x32_bf16 v[44:47], a[244:247], v[12:15], v[44:47]
  v_mfma_f32_16x16x32_bf16 v[48:51], a[244:247], v[16:19], v[48:51]
  s_waitcnt lgkmcnt(2)
  v_mfma_f32_16x16x32_bf16 v[36:39], a[120:123], v[20:23], v[36:39]
  v_mfma_f32_16x16x32_bf16 v[40:43], a[120:123], v[24:27], v[40:43]
  v_mfma_f32_16x16x32_bf16 v[44:47], a[248:251], v[20:23], v[44:47]
  v_mfma_f32_16x16x32_bf16 v[48:51], a[248:251], v[24:27], v[48:51]
  s_waitcnt lgkmcnt(0)
  v_mfma_f32_16x16x32_bf16 v[36:39], a[124:127], v[28:31], v[36:39]
  v_mfma_f32_16x16x32_bf16 v[40:43], a[124:127], v[32:35], v[40:43]
  v_mfma_f32_16x16x32_bf16 v[44:47], a[252:255], v[28:31], v[44:47]
  v_mfma_f32_16x16x32_bf16 v[48:51], a[252:255], v[32:35], v[48:51]
  s_nop 7
  s_branch L_F1_epi
L_F1_nopf:
  s_waitcnt lgkmcnt(4)
  v_mfma_f32_16x16x32_bf16 v[36:39], a[52:55], v[12:15], v[36:39]
  ds_read_b128 v[4:7], v73 offset:32768
  v_mfma_f32_16x16x32_bf16 v[40:43], a[52:55], v[16:19], v[40:43]
  ds_read_b128 v[8:11], v73 offset:33792
  v_mfma_f32_16x16x32_bf16 v[44:47], a[180:183], v[12:15], v[44:47]
  v_mfma_f32_16x16x32_bf16 v[48:51], a[180:183], v[16:19], v[48:51]
  s_waitcnt lgkmcnt(4)
  v_mfma_f32_16x16x32_bf16 v[36:39], a[56:59], v[20:23], v[36:39]
  ds_read_b128 v[12:15], v73 offset:34816
  v_mfma_f32_16x16x32_bf16 v[40:43], a[56:59], v[24:27], v[40:43]
  ds_read_b128 v[16:19], v73 offset:35840
  v_mfma_f32_16x16x32_bf16 v[44:47], a[184:187], v[20:23], v[44:47]
  v_mfma_f32_16x16x32_bf16 v[48:51], a[184:187], v[24:27], v[48:51]
  s_waitcnt lgkmcnt(4)
  v_mfma_f32_16x16x32_bf16 v[36:39], a[60:63], v[28:31], v[36:39]
  ds_read_b128 v[20:23], v73 offset:36864
  v_mfma_f32_16x16x32_bf16 v[40:43], a[60:63], v[32:35], v[40:43]
  ds_read_b128 v[24:27], v73 offset:37888
  v_mfma_f32_16x16x32_bf16 v[44:47], a[188:191], v[28:31], v[44:47]
  v_mfma_f32_16x16x32_bf16 v[48:51], a[188:191], v[32:35], v[48:51]
  s_waitcnt lgkmcnt(4)
  v_mfma_f32_16x16x32_bf16 v[36:39], a[64:67], v[4:7], v[36:39]
  ds_read_b128 v[28:31], v73 offset:38912
  v_mfma_f32_16x16x32_bf16 v[40:43], a[64:67], v[8:11], v[40:43]
  ds_read_b128 v[32:35], v73 offset:39936
  v_mfma_f32_16x16x32_bf16 v[44:47], a[192:195], v[4:7], v[44:47]
  v_mfma_f32_16x16x32_bf16 v[48:51], a[192:195], v[8:11], v[48:51]
  s_waitcnt lgkmcnt(4)
  v_mfma_f32_16x16x32_bf16 v[36:39], a[68:71], v[12:15], v[36:39]
  ds_read_b128 v[4:7], v73 offset:40960
  v_mfma_f32_16x16x32_bf16 v[40:43], a[68:71], v[16:19], v[40:43]
  ds_read_b128 v[8:11], v73 offset:41984
  v_mfma_f32_16x16x32_bf16 v[44:47], a[196:199], v[12:15], v[44:47]
  v_mfma_f32_16x16x32_bf16 v[48:51], a[196:199], v[16:19], v[48:51]
  s_waitcnt lgkmcnt(4)
  v_mfma_f32_16x16x32_bf16 v[36:39], a[72:75], v[20:23], v[36:39]
  ds_read_b128 v[12:15], v73 offset:43008
  v_mfma_f32_16x16x32_bf16 v[40:43], a[72:75], v[24:27], v[40:43]
  ds_read_b128 v[16:19], v73 offset:44032
  v_mfma_f32_16x16x32_bf16 v[44:47], a[200:203], v[20:23], v[44:47]
  v_mfma_f32_16x16x32_bf16 v[48:51], a[200:203], v[24:27], v[48:51]
  s_waitcnt lgkmcnt(4)
  v_mfma_f32_16x16x32_bf16 v[36:39], a[76:79], v[28:31], v[36:39]
  ds_read_b128 v[20:23], v73 offset:45056
  v_mfma_f32_16x16x32_bf16 v[40:43], a[76:79], v[32:35], v[40:43]
  ds_read_b128 v[24:27], v73 offset:46080
  v_mfma_f32_16x16x32_bf16 v[44:47], a[204:207], v[28:31], v[44:47]
  v_mfma_f32_16x16x32_bf16 v[48:51], a[204:207], v[32:35], v[48:51]
  s_waitcnt lgkmcnt(4)
  v_mfma_f32_16x16x32_bf16 v[36:39], a[80:83], v[4:7], v[36:39]
  ds_read_b128 v[28:31], v73 offset:47104
  v_mfma_f32_16x16x32_bf16 v[40:43], a[80:83], v[8:11], v[40:43]
  ds_read_b128 v[32:35], v73 offset:48128
  v_mfma_f32_16x16x32_bf16 v[44:47], a[208:211], v[4:7], v[44:47]
  v_mfma_f32_16x16x32_bf16 v[48:51], a[208:211], v[8:11], v[48:51]
  s_waitcnt lgkmcnt(4)
  v_mfma_f32_16x16x32_bf16 v[36:39], a[84:87], v[12:15], v[36:39]
  ds_read_b128 v[4:7], v73 offset:49152
  v_mfma_f32_16x16x32_bf16 v[40:43], a[84:87], v[16:19], v[40:43]
  ds_read_b128 v[8:11], v73 offset:50176
  v_mfma_f32_16x16x32_bf16 v[44:47], a[212:215], v[12:15], v[44:47]
  v_mfma_f32_16x16x32_bf16 v[48:51], a[212:215], v[16:19], v[48:51]
  s_waitcnt lgkmcnt(4)
  v_mfma_f32_16x16x32_bf16 v[36:39], a[88:91], v[20:23], v[36:39]
  ds_read_b128 v[12:15], v73 offset:51200
  v_mfma_f32_16x16x32_bf16 v[40:43], a[88:91], v[24:27], v[40:43]
  ds_read_b128 v[16:19], v73 offset:52224
  v_mfma_f32_16x16x32_bf16 v[44:47], a[216:219], v[20:23], v[44:47]
  v_mfma_f32_16x16x32_bf16 v[48:51], a[216:219], v[24:27], v[48:51]
  s_waitcnt lgkmcnt(4)
  v_mfma_f32_16x16x32_bf16 v[36:39], a[92:95], v[28:31], v[36:39]
  ds_read_b128 v[20:23], v73 offset:53248
  v_mfma_f32_16x16x32_bf16 v[40:43], a[92:95], v[32:35], v[40:43]
  ds_read_b128 v[24:27], v73 offset:54272
  v_mfma_f32_16x16x32_bf16 v[44:47], a[220:223], v[28:31], v[44:47]
  v_mfma_f32_16x16x32_bf16 v[48:51], a[220:223], v[32:35], v[48:51]
  s_waitcnt lgkmcnt(4)
  v_mfma_f32_16x16x32_bf16 v[36:39], a[96:99], v[4:7], v[36:39]
  ds_read_b128 v[28:31], v73 offset:55296
  v_mfma_f32_16x16x32_bf16 v[40:43], a[96:99], v[8:11], v[40:43]
  ds_read_b128 v[32:35], v73 offset:56320
  v_mfma_f32_16x16x32_bf16 v[44:47], a[224:227], v[4:7], v[44:47]
  v_mfma_f32_16x16x32_bf16 v[48:51], a[224:227], v[8:11], v[48:51]
  s_waitcnt lgkmcnt(4)
  v_mfma_f32_16x16x32_bf16 v[36:39], a[100:103], v[12:15], v[36:39]
  ds_read_b128 v[4:7], v73 offset:57344
  v_mfma_f32_16x16x32_bf16 v[40:43], a[100:103], v[16:19], v[40:43]
  ds_read_b128 v[8:11], v73 offset:58368
  v_mfma_f32_16x16x32_bf16 v[44:47], a[228:231], v[12:15], v[44:47]
  v_mfma_f32_16x16x32_bf16 v[48:51], a[228:231], v[16:19], v[48:51]
  s_waitcnt lgkmcnt(4)
  v_mfma_f32_16x16x32_bf16 v[36:39], a[104:107], v[20:23], v[36:39]
  ds_read_b128 v[12:15], v73 offset:59392
  v_mfma_f32_16x16x32_bf16 v[40:43], a[104:107], v[24:27], v[40:43]
  ds_read_b128 v[16:19], v73 offset:60416
  v_mfma_f32_16x16x32_bf16 v[44:47], a[232:235], v[20:23], v[44:47]
  v_mfma_f32_16x16x32_bf16 v[48:51], a[232:235], v[24:27], v[48:51]
  s_waitcnt lgkmcnt(4)
  v_mfma_f32_16x16x32_bf16 v[36:39], a[108:111], v[28:31], v[36:39]
  ds_read_b128 v[20:23], v73 offset:61440
  v_mfma_f32_16x16x32_bf16 v[40:43], a[108:111], v[32:35], v[40:43]
  ds_read_b128 v[24:27], v73 offset:62464
  v_mfma_f32_16x16x32_bf16 v[44:47], a[236:239], v[28:31], v[44:47]
  v_mfma_f32_16x16x32_bf16 v[48:51], a[236:239], v[32:35], v[48:51]
  s_waitcnt lgkmcnt(4)
  v_mfma_f32_16x16x32_bf16 v[36:39], a[112:115], v[4:7], v[36:39]
  ds_read_b128 v[28:31], v73 offset:63488
  v_mfma_f32_16x16x32_bf16 v[40:43], a[112:115], v[8:11], v[40:43]
  ds_read_b128 v[32:35], v73 offset:64512
  v_mfma_f32_16x16x32_bf16 v[44:47], a[240:243], v[4:7], v[44:47]
  v_mfma_f32_16x16x32_bf16 v[48:51], a[240:243], v[8:11], v[48:51]
  s_waitcnt lgkmcnt(4)
  v_mfma_f32_16x16x32_bf16 v[36:39], a[116:119], v[12:15], v[36:39]
  v_mfma_f32_16x16x32_bf16 v[40:43], a[116:119], v[16:19], v[40:43]
  v_mfma_f32_16x16x32_bf16 v[44:47], a[244:247], v[12:15], v[44:47]
  v_mfma_f32_16x16x32_bf16 v[48:51], a[244:247], v[16:19], v[48:51]
  s_waitcnt lgkmcnt(2)
  v_mfma_f32_16x16x32_bf16 v[36:39], a[120:123], v[20:23], v[36:39]
  v_mfma_f32_16x16x32_bf16 v[40:43], a[120:123], v[24:27], v[40:43]
  v_mfma_f32_16x16x32_bf16 v[44:47], a[248:251], v[20:23], v[44:47]
  v_mfma_f32_16x16x32_bf16 v[48:51], a[248:251], v[24:27], v[48:51]
  s_waitcnt lgkmcnt(0)
  v_mfma_f32_16x16x32_bf16 v[36:39], a[124:127], v[28:31], v[36:39]
  v_mfma_f32_16x16x32_bf16 v[40:43], a[124:127], v[32:35], v[40:43]
  v_mfma_f32_16x16x32_bf16 v[44:47], a[252:255], v[28:31], v[44:47]
  v_mfma_f32_16x16x32_bf16 v[48:51], a[252:255], v[32:35], v[48:51]
L_F1_epi:
  s_nop 4
  v_mul_f32 v52, s37, v36
  v_mul_f32 v53, s37, v37
  v_mul_f32 v54, s37, v38
  v_mul_f32 v55, s37, v39
  v_mul_f32 v56, s37, v40
  v_mul_f32 v57, s37, v41
  v_mul_f32 v58, s37, v42
  v_mul_f32 v59, s37, v43
  v_exp_f32 v52, v52
  v_exp_f32 v53, v53
  v_exp_f32 v54, v54
  v_exp_f32 v55, v55
  v_exp_f32 v56, v56
  v_exp_f32 v57, v57
  v_exp_f32 v58, v58
  v_exp_f32 v59, v59
  v_pk_mul_f32 v[36:37], v[36:37], v[44:45]
  v_pk_mul_f32 v[38:39], v[38:39], v[46:47]
  v_pk_mul_f32 v[40:41], v[40:41], v[48:49]
  v_pk_mul_f32 v[42:43], v[42:43], v[50:51]
  v_add_f32 v52, 1.0, v52
  v_add_f32 v53, 1.0, v53
  v_add_f32 v54, 1.0, v54
  v_add_f32 v55, 1.0, v55
  v_add_f32 v56, 1.0, v56
  v_add_f32 v57, 1.0, v57
  v_add_f32 v58, 1.0, v58
  v_add_f32 v59, 1.0, v59
  v_rcp_f32 v52, v52
  v_rcp_f32 v53, v53
  v_rcp_f32 v54, v54
  v_rcp_f32 v55, v55
  v_rcp_f32 v56, v56
  v_rcp_f32 v57, v57
  v_rcp_f32 v58, v58
  v_rcp_f32 v59, v59
  v_pk_mul_f32 v[36:37], v[36:37], v[52:53]
  v_pk_mul_f32 v[38:39], v[38:39], v[54:55]
  v_pk_mul_f32 v[40:41], v[40:41], v[56:57]
  v_pk_mul_f32 v[42:43], v[42:43], v[58:59]
  v_cvt_pk_bf16_f32 v60, v36, v37
  v_cvt_pk_bf16_f32 v61, v38, v39
  v_cvt_pk_bf16_f32 v62, v40, v41
  v_cvt_pk_bf16_f32 v63, v42, v43
  s_nop 0
  v_permlane32_swap_b32 v60, v62
  v_permlane32_swap_b32 v61, v63
  buffer_store_dwordx4 v[60:63], v68, s[4:7], s31 offen sc1
  s_add_u32 s25, s25, 1
  s_add_u32 s31, s31, 229376
  s_branch L_F1_top
L_F2:
  s_load_dwordx2 s[8:9], s[0:1], 80
  s_mov_b32 s10, 7340032
  s_mov_b32 s11, 0x20000
  s_waitcnt lgkmcnt(0)
  s_lshr_b32 s44, s21, 3
  s_mul_i32 s44, s44, 2424832
  s_and_b32 s45, s21, 7
  s_lshl_b32 s45, s45, 8
  s_add_u32 s44, s44, s45
  s_add_u32 s45, s44, 128
  v_bfe_u32 v40, v0, 5, 1
  v_mul_u32_u24 v40, 8192, v40
  v_bfe_u32 v41, v0, 4, 1
  v_mul_u32_u24 v41, 4096, v41
  v_add_u32 v40, v40, v41
  v_bfe_u32 v41, v0, 3, 1
  v_mul_u32_u24 v41, 2048, v41
  v_add_u32 v40, v40, v41
  v_lshrrev_b32 v41, 3, v0
  v_and_b32 v41, 6, v41
  v_xor_b32 v41, v41, v0
  v_and_b32 v41, 7, v41
  v_lshl_add_u32 v40, v41, 4, v40
  s_lshr_b32 s40, s20, 1
  s_mul_i32 s40, s40, 16384
  s_and_b32 s41, s20, 1
  s_mul_i32 s41, s41, 32768
  s_add_u32 s40, s40, s41
  v_add_u32 v40, s40, v40
  v_bfe_u32 v41, v0, 3, 2
  v_xor_b32 v41, s20, v41
  v_lshlrev_b32 v41, 5, v41
  v_lshrrev_b32 v42, 2, v0
  v_lshl_add_u32 v42, v42, 7, v41
  v_and_b32 v41, 3, v0
  v_lshl_add_u32 v42, v41, 3, v42
  v_add_u32 v43, 0x10000, v42
  v_add_u32 v44, s44, v40
  v_add_u32 v45, s45, v40
  s_lshl_b32 s41, s20, 10
  s_add_u32 m0, s41, 0
  s_mov_b32 s42, 0
  buffer_load_dwordx4 v44, s[8:11], s42 offen nt lds
  s_add_u32 m0, s41, 4096
  s_mov_b32 s42, 0
  buffer_load_dwordx4 v45, s[8:11], s42 offen nt lds
  s_add_u32 m0, s41, 8192
  s_mov_b32 s42, 65536
  buffer_load_dwordx4 v44, s[8:11], s42 offen nt lds
  s_add_u32 m0, s41, 12288
  s_mov_b32 s42, 65536
  buffer_load_dwordx4 v45, s[8:11], s42 offen nt lds
  s_add_u32 m0, s41, 16384
  s_mov_b32 s42, 131072
  buffer_load_dwordx4 v44, s[8:11], s42 offen nt lds
  s_add_u32 m0, s41, 20480
  s_mov_b32 s42, 131072
  buffer_load_dwordx4 v45, s[8:11], s42 offen nt lds
  s_add_u32 m0, s41, 24576
  s_mov_b32 s42, 196608
  buffer_load_dwordx4 v44, s[8:11], s42 offen nt lds
  s_add_u32 m0, s41, 28672
  s_mov_b32 s42, 196608
  buffer_load_dwordx4 v45, s[8:11], s42 offen nt lds
  s_add_u32 m0, s41, 32768
  s_mov_b32 s42, 262144
  buffer_load_dwordx4 v44, s[8:11], s42 offen nt lds
  s_add_u32 m0, s41, 36864
  s_mov_b32 s42, 262144
  buffer_load_dwordx4 v45, s[8:11], s42 offen nt lds
  s_add_u32 m0, s41, 40960
  s_mov_b32 s42, 327680
  buffer_load_dwordx4 v44, s[8:11], s42 offen nt lds
  s_add_u32 m0, s41, 45056
  s_mov_b32 s42, 327680
  buffer_load_dwordx4 v45, s[8:11], s42 offen nt lds
  s_add_u32 m0, s41, 49152
  s_mov_b32 s42, 393216
  buffer_load_dwordx4 v44, s[8:11], s42 offen nt lds
  s_add_u32 m0, s41, 53248
  s_mov_b32 s42, 393216
  buffer_load_dwordx4 v45, s[8:11], s42 offen nt lds
  s_add_u32 m0, s41, 57344
  s_mov_b32 s42, 458752
  buffer_load_dwordx4 v44, s[8:11], s42 offen nt lds
  s_add_u32 m0, s41, 61440
  s_mov_b32 s42, 458752
  buffer_load_dwordx4 v45, s[8:11], s42 offen nt lds
  s_add_u32 m0, s41, 65536
  s_mov_b32 s42, 524288
  buffer_load_dwordx4 v44, s[8:11], s42 offen nt lds
  s_add_u32 m0, s41, 69632
  s_mov_b32 s42, 524288
  buffer_load_dwordx4 v45, s[8:11], s42 offen nt lds
  s_add_u32 m0, s41, 73728
  s_mov_b32 s42, 589824
  buffer_load_dwordx4 v44, s[8:11], s42 offen nt lds
  s_add_u32 m0, s41, 77824
  s_mov_b32 s42, 589824
  buffer_load_dwordx4 v45, s[8:11], s42 offen nt lds
  s_add_u32 m0, s41, 81920
  s_mov_b32 s42, 655360
  buffer_load_dwordx4 v44, s[8:11], s42 offen nt lds
  s_add_u32 m0, s41, 86016
  s_mov_b32 s42, 655360
  buffer_load_dwordx4 v45, s[8:11], s42 offen nt lds
  s_add_u32 m0, s41, 90112
  s_mov_b32 s42, 720896
  buffer_load_dwordx4 v44, s[8:11], s42 offen nt lds
  s_add_u32 m0, s41, 94208
  s_mov_b32 s42, 720896
  buffer_load_dwordx4 v45, s[8:11], s42 offen nt lds
  s_add_u32 m0, s41, 98304
  s_mov_b32 s42, 786432
  buffer_load_dwordx4 v44, s[8:11], s42 offen nt lds
  s_add_u32 m0, s41, 102400
  s_mov_b32 s42, 786432
  buffer_load_dwordx4 v45, s[8:11], s42 offen nt lds
  s_add_u32 m0, s41, 106496
  s_mov_b32 s42, 851968
  buffer_load_dwordx4 v44, s[8:11], s42 offen nt lds
  s_add_u32 m0, s41, 110592
  s_mov_b32 s42, 851968
  buffer_load_dwordx4 v45, s[8:11], s42 offen nt lds
  s_waitcnt vmcnt(24) lgkmcnt(0)
  s_barrier
  s_add_u32 m0, s41, 114688
  s_mov_b32 s42, 917504
  buffer_load_dwordx4 v44, s[8:11], s42 offen nt lds
  s_add_u32 m0, s41, 118784
  s_mov_b32 s42, 917504
  buffer_load_dwordx4 v45, s[8:11], s42 offen nt lds
  s_add_u32 m0, s41, 122880
  s_mov_b32 s42, 983040
  buffer_load_dwordx4 v44, s[8:11], s42 offen nt lds
  s_add_u32 m0, s41, 126976
  s_mov_b32 s42, 983040
  buffer_load_dwordx4 v45, s[8:11], s42 offen nt lds
  ds_read_b64_tr_b16 a[0:1], v42 offset:0
  ds_read_b64_tr_b16 a[2:3], v42 offset:2048
  ds_read_b64_tr_b16 a[152:153], v42 offset:4096
  ds_read_b64_tr_b16 a[154:155], v42 offset:6144
  ds_read_b64_tr_b16 a[4:5], v42 offset:8192
  ds_read_b64_tr_b16 a[6:7], v42 offset:10240
  ds_read_b64_tr_b16 a[156:157], v42 offset:12288
  ds_read_b64_tr_b16 a[158:159], v42 offset:14336
  s_waitcnt vmcnt(24) lgkmcnt(0)
  s_barrier
  s_add_u32 m0, s41, 0
  s_mov_b32 s42, 1048576
  buffer_load_dwordx4 v44, s[8:11], s42 offen nt lds
  s_add_u32 m0, s41, 4096
  s_mov_b32 s42, 1048576
  buffer_load_dwordx4 v45, s[8:11], s42 offen nt lds
  s_add_u32 m0, s41, 8192
  s_mov_b32 s42, 1114112
  buffer_load_dwordx4 v44, s[8:11], s42 offen nt lds
  s_add_u32 m0, s41, 12288
  s_mov_b32 s42, 1114112
  buffer_load_dwordx4 v45, s[8:11], s42 offen nt lds
  ds_read_b64_tr_b16 a[8:9], v42 offset:16384
  ds_read_b64_tr_b16 a[10:11], v42 offset:18432
  ds_read_b64_tr_b16 a[160:161], v42 offset:20480
  ds_read_b64_tr_b16 a[162:163], v42 offset:22528
  ds_read_b64_tr_b16 a[12:13], v42 offset:24576
  ds_read_b64_tr_b16 a[14:15], v42 offset:26624
  ds_read_b64_tr_b16 a[164:165], v42 offset:28672
  ds_read_b64_tr_b16 a[166:167], v42 offset:30720
  s_waitcnt vmcnt(24) lgkmcnt(0)
  s_barrier
  s_add_u32 m0, s41, 16384
  s_mov_b32 s42, 1179648
  buffer_load_dwordx4 v44, s[8:11], s42 offen nt lds
  s_add_u32 m0, s41, 20480
  s_mov_b32 s42, 1179648
  buffer_load_dwordx4 v45, s[8:11], s42 offen nt lds
  s_add_u32 m0, s41, 24576
  s_mov_b32 s42, 1245184
  buffer_load_dwordx4 v44, s[8:11], s42 offen nt lds
  s_add_u32 m0, s41, 28672
  s_mov_b32 s42, 1245184
  buffer_load_dwordx4 v45, s[8:11], s42 offen nt lds
  ds_read_b64_tr_b16 a[16:17], v42 offset:32768
  ds_read_b64_tr_b16 a[18:19], v42 offset:34816
  ds_read_b64_tr_b16 a[168:169], v42 offset:36864
  ds_read_b64_tr_b16 a[170:171], v42 offset:38912
  ds_read_b64_tr_b16 a[20:21], v42 offset:40960
  ds_read_b64_tr_b16 a[22:23], v42 offset:43008
  ds_read_b64_tr_b16 a[172:173], v42 offset:45056
  ds_read_b64_tr_b16 a[174:175], v42 offset:47104
  s_waitcnt vmcnt(24) lgkmcnt(0)
  s_barrier
  s_add_u32 m0, s41, 32768
  s_mov_b32 s42, 1310720
  buffer_load_dwordx4 v44, s[8:11], s42 offen nt lds
  s_add_u32 m0, s41, 36864
  s_mov_b32 s42, 1310720
  buffer_load_dwordx4 v45, s[8:11], s42 offen nt lds
  s_add_u32 m0, s41, 40960
  s_mov_b32 s42, 1376256
  buffer_load_dwordx4 v44, s[8:11], s42 offen nt lds
  s_add_u32 m0, s41, 45056
  s_mov_b32 s42, 1376256
  buffer_load_dwordx4 v45, s[8:11], s42 offen nt lds
  ds_read_b64_tr_b16 a[24:25], v42 offset:49152
  ds_read_b64_tr_b16 a[26:27], v42 offset:51200
  ds_read_b64_tr_b16 a[176:177], v42 offset:53248
  ds_read_b64_tr_b16 a[178:179], v42 offset:55296
  ds_read_b64_tr_b16 a[28:29], v42 offset:57344
  ds_read_b64_tr_b16 a[30:31], v42 offset:59392
  ds_read_b64_tr_b16 a[180:181], v42 offset:61440
  ds_read_b64_tr_b16 a[182:183], v42 offset:63488
  s_waitcnt vmcnt(24) lgkmcnt(0)
  s_barrier
  s_add_u32 m0, s41, 49152
  s_mov_b32 s42, 1441792
  buffer_load_dwordx4 v44, s[8:11], s42 offen nt lds
  s_add_u32 m0, s41, 53248
  s_mov_b32 s42, 1441792
  buffer_load_dwordx4 v45, s[8:11], s42 offen nt lds
  s_add_u32 m0, s41, 57344
  s_mov_b32 s42, 1507328
  buffer_load_dwordx4 v44, s[8:11], s42 offen nt lds
  s_add_u32 m0, s41, 61440
  s_mov_b32 s42, 1507328
  buffer_load_dwordx4 v45, s[8:11], s42 offen nt lds
  ds_read_b64_tr_b16 a[32:33], v43 offset:0
  ds_read_b64_tr_b16 a[34:35], v43 offset:2048
  ds_read_b64_tr_b16 a[184:185], v43 offset:4096
  ds_read_b64_tr_b16 a[186:187], v43 offset:6144
  ds_read_b64_tr_b16 a[36:37], v43 offset:8192
  ds_read_b64_tr_b16 a[38:39], v43 offset:10240
  ds_read_b64_tr_b16 a[188:189], v43 offset:12288
  ds_read_b64_tr_b16 a[190:191], v43 offset:14336
  s_waitcnt vmcnt(24) lgkmcnt(0)
  s_barrier
  s_add_u32 m0, s41, 65536
  s_mov_b32 s42, 1572864
  buffer_load_dwordx4 v44, s[8:11], s42 offen nt lds
  s_add_u32 m0, s41, 69632
  s_mov_b32 s42, 1572864
  buffer_load_dwordx4 v45, s[8:11], s42 offen nt lds
  s_add_u32 m0, s41, 73728
  s_mov_b32 s42, 1638400
  buffer_load_dwordx4 v44, s[8:11], s42 offen nt lds
  s_add_u32 m0, s41, 77824
  s_mov_b32 s42, 1638400
  buffer_load_dwordx4 v45, s[8:11], s42 offen nt lds
  ds_read_b64_tr_b16 a[40:41], v43 offset:16384
  ds_read_b64_tr_b16 a[42:43], v43 offset:18432
  ds_read_b64_tr_b16 a[192:193], v43 offset:20480
  ds_read_b64_tr_b16 a[194:195], v43 offset:22528
  ds_read_b64_tr_b16 a[44:45], v43 offset:24576
  ds_read_b64_tr_b16 a[46:47], v43 offset:26624
  ds_read_b64_tr_b16 a[196:197], v43 offset:28672
  ds_read_b64_tr_b16 a[198:199], v43 offset:30720
  s_waitcnt vmcnt(24) lgkmcnt(0)
  s_barrier
  s_add_u32 m0, s41, 81920
  s_mov_b32 s42, 1703936
  buffer_load_dwordx4 v44, s[8:11], s42 offen nt lds
  s_add_u32 m0, s41, 86016
  s_mov_b32 s42, 1703936
  buffer_load_dwordx4 v45, s[8:11], s42 offen nt lds
  s_add_u32 m0, s41, 90112
  s_mov_b32 s42, 1769472
  buffer_load_dwordx4 v44, s[8:11], s42 offen nt lds
  s_add_u32 m0, s41, 94208
  s_mov_b32 s42, 1769472
  buffer_load_dwordx4 v45, s[8:11], s42 offen nt lds
  ds_read_b64_tr_b16 a[48:49], v43 offset:32768
  ds_read_b64_tr_b16 a[50:51], v43 offset:34816
  ds_read_b64_tr_b16 a[200:201], v43 offset:36864
  ds_read_b64_tr_b16 a[202:203], v43 offset:38912
  ds_read_b64_tr_b16 a[52:53], v43 offset:40960
  ds_read_b64_tr_b16 a[54:55], v43 offset:43008
  ds_read_b64_tr_b16 a[204:205], v43 offset:45056
  ds_read_b64_tr_b16 a[206:207], v43 offset:47104
  s_waitcnt vmcnt(24) lgkmcnt(0)
  s_barrier
  s_add_u32 m0, s41, 98304
  s_mov_b32 s42, 1835008
  buffer_load_dwordx4 v44, s[8:11], s42 offen nt lds
  s_add_u32 m0, s41, 102400
  s_mov_b32 s42, 1835008
  buffer_load_dwordx4 v45, s[8:11], s42 offen nt lds
  s_add_u32 m0, s41, 106496
  s_mov_b32 s42, 1900544
  buffer_load_dwordx4 v44, s[8:11], s42 offen nt lds
  s_add_u32 m0, s41, 110592
  s_mov_b32 s42, 1900544
  buffer_load_dwordx4 v45, s[8:11], s42 offen nt lds
  ds_read_b64_tr_b16 a[56:57], v43 offset:49152
  ds_read_b64_tr_b16 a[58:59], v43 offset:51200
  ds_read_b64_tr_b16 a[208:209], v43 offset:53248
  ds_read_b64_tr_b16 a[210:211], v43 offset:55296
  ds_read_b64_tr_b16 a[60:61], v43 offset:57344
  ds_read_b64_tr_b16 a[62:63], v43 offset:59392
  ds_read_b64_tr_b16 a[212:213], v43 offset:61440
  ds_read_b64_tr_b16 a[214:215], v43 offset:63488
  s_waitcnt vmcnt(24) lgkmcnt(0)
  s_barrier
  s_add_u32 m0, s41, 114688
  s_mov_b32 s42, 1966080
  buffer_load_dwordx4 v44, s[8:11], s42 offen nt lds
  s_add_u32 m0, s41, 118784
  s_mov_b32 s42, 1966080
  buffer_load_dwordx4 v45, s[8:11], s42 offen nt lds
  s_add_u32 m0, s41, 122880
  s_mov_b32 s42, 2031616
  buffer_load_dwordx4 v44, s[8:11], s42 offen nt lds
  s_add_u32 m0, s41, 126976
  s_mov_b32 s42, 2031616
  buffer_load_dwordx4 v45, s[8:11], s42 offen nt lds
  ds_read_b64_tr_b16 a[64:65], v42 offset:0
  ds_read_b64_tr_b16 a[66:67], v42 offset:2048
  ds_read_b64_tr_b16 a[216:217], v42 offset:4096
  ds_read_b64_tr_b16 a[218:219], v42 offset:6144
  ds_read_b64_tr_b16 a[68:69], v42 offset:8192
  ds_read_b64_tr_b16 a[70:71], v42 offset:10240
  ds_read_b64_tr_b16 a[220:221], v42 offset:12288
  ds_read_b64_tr_b16 a[222:223], v42 offset:14336
  s_waitcnt vmcnt(24) lgkmcnt(0)
  s_barrier
  s_add_u32 m0, s41, 0
  s_mov_b32 s42, 2097152
  buffer_load_dwordx4 v44, s[8:11], s42 offen nt lds
  s_add_u32 m0, s41, 4096
  s_mov_b32 s42, 2097152
  buffer_load_dwordx4 v45, s[8:11], s42 offen nt lds
  s_add_u32 m0, s41, 8192
  s_mov_b32 s42, 2162688
  buffer_load_dwordx4 v44, s[8:11], s42 offen nt lds
  s_add_u32 m0, s41, 12288
  s_mov_b32 s42, 2162688
  buffer_load_dwordx4 v45, s[8:11], s42 offen nt lds
  ds_read_b64_tr_b16 a[72:73], v42 offset:16384
  ds_read_b64_tr_b16 a[74:75], v42 offset:18432
  ds_read_b64_tr_b16 a[224:225], v42 offset:20480
  ds_read_b64_tr_b16 a[226:227], v42 offset:22528
  ds_read_b64_tr_b16 a[76:77], v42 offset:24576
  ds_read_b64_tr_b16 a[78:79], v42 offset:26624
  ds_read_b64_tr_b16 a[228:229], v42 offset:28672
  ds_read_b64_tr_b16 a[230:231], v42 offset:30720
  s_waitcnt vmcnt(24) lgkmcnt(0)
  s_barrier
  s_add_u32 m0, s41, 16384
  s_mov_b32 s42, 2228224
  buffer_load_dwordx4 v44, s[8:11], s42 offen nt lds
  s_add_u32 m0, s41, 20480
  s_mov_b32 s42, 2228224
  buffer_load_dwordx4 v45, s[8:11], s42 offen nt lds
  s_add_u32 m0, s41, 24576
  s_mov_b32 s42, 2293760
  buffer_load_dwordx4 v44, s[8:11], s42 offen nt lds
  s_add_u32 m0, s41, 28672
  s_mov_b32 s42, 2293760
  buffer_load_dwordx4 v45, s[8:11], s42 offen nt lds
  ds_read_b64_tr_b16 a[80:81], v42 offset:32768
  ds_read_b64_tr_b16 a[82:83], v42 offset:34816
  ds_read_b64_tr_b16 a[232:233], v42 offset:36864
  ds_read_b64_tr_b16 a[234:235], v42 offset:38912
  ds_read_b64_tr_b16 a[84:85], v42 offset:40960
  ds_read_b64_tr_b16 a[86:87], v42 offset:43008
  ds_read_b64_tr_b16 a[236:237], v42 offset:45056
  ds_read_b64_tr_b16 a[238:239], v42 offset:47104
  s_waitcnt vmcnt(24) lgkmcnt(0)
  s_barrier
  s_add_u32 m0, s41, 32768
  s_mov_b32 s42, 2359296
  buffer_load_dwordx4 v44, s[8:11], s42 offen nt lds
  s_add_u32 m0, s41, 36864
  s_mov_b32 s42, 2359296
  buffer_load_dwordx4 v45, s[8:11], s42 offen nt lds
  s_add_u32 m0, s41, 40960
  s_mov_b32 s42, 2424832
  buffer_load_dwordx4 v44, s[8:11], s42 offen nt lds
  s_add_u32 m0, s41, 45056
  s_mov_b32 s42, 2424832
  buffer_load_dwordx4 v45, s[8:11], s42 offen nt lds
  ds_read_b64_tr_b16 a[88:89], v42 offset:49152
  ds_read_b64_tr_b16 a[90:91], v42 offset:51200
  ds_read_b64_tr_b16 a[240:241], v42 offset:53248
  ds_read_b64_tr_b16 a[242:243], v42 offset:55296
  ds_read_b64_tr_b16 a[92:93], v42 offset:57344
  ds_read_b64_tr_b16 a[94:95], v42 offset:59392
  ds_read_b64_tr_b16 a[244:245], v42 offset:61440
  ds_read_b64_tr_b16 a[246:247], v42 offset:63488
  s_waitcnt vmcnt(24) lgkmcnt(0)
  s_barrier
  ds_read_b64_tr_b16 a[96:97], v43 offset:0
  ds_read_b64_tr_b16 a[98:99], v43 offset:2048
  ds_read_b64_tr_b16 a[248:249], v43 offset:4096
  ds_read_b64_tr_b16 a[250:251], v43 offset:6144
  ds_read_b64_tr_b16 a[100:101], v43 offset:8192
  ds_read_b64_tr_b16 a[102:103], v43 offset:10240
  ds_read_b64_tr_b16 a[252:253], v43 offset:12288
  ds_read_b64_tr_b16 a[254:255], v43 offset:14336
  s_waitcnt vmcnt(20) lgkmcnt(0)
  s_barrier
  ds_read_b64_tr_b16 a[104:105], v43 offset:16384
  ds_read_b64_tr_b16 a[106:107], v43 offset:18432
  ds_read_b64_tr_b16 v[128:129], v43 offset:20480
  ds_read_b64_tr_b16 v[130:131], v43 offset:22528
  ds_read_b64_tr_b16 a[108:109], v43 offset:24576
  ds_read_b64_tr_b16 a[110:111], v43 offset:26624
  ds_read_b64_tr_b16 v[132:133], v43 offset:28672
  ds_read_b64_tr_b16 v[134:135], v43 offset:30720
  s_waitcnt vmcnt(16) lgkmcnt(0)
  s_barrier
  ds_read_b64_tr_b16 a[112:113], v43 offset:32768
  ds_read_b64_tr_b16 a[114:115], v43 offset:34816
  ds_read_b64_tr_b16 v[136:137], v43 offset:36864
  ds_read_b64_tr_b16 v[138:139], v43 offset:38912
  ds_read_b64_tr_b16 a[116:117], v43 offset:40960
  ds_read_b64_tr_b16 a[118:119], v43 offset:43008
  ds_read_b64_tr_b16 v[140:141], v43 offset:45056
  ds_read_b64_tr_b16 v[142:143], v43 offset:47104
  s_waitcnt vmcnt(12) lgkmcnt(0)
  s_barrier
  ds_read_b64_tr_b16 a[120:121], v43 offset:49152
  ds_read_b64_tr_b16 a[122:123], v43 offset:51200
  ds_read_b64_tr_b16 v[144:145], v43 offset:53248
  ds_read_b64_tr_b16 v[146:147], v43 offset:55296
  ds_read_b64_tr_b16 a[124:125], v43 offset:57344
  ds_read_b64_tr_b16 a[126:127], v43 offset:59392
  ds_read_b64_tr_b16 v[148:149], v43 offset:61440
  ds_read_b64_tr_b16 v[150:151], v43 offset:63488
  s_waitcnt vmcnt(8) lgkmcnt(0)
  s_barrier
  ds_read_b64_tr_b16 a[128:129], v42 offset:0
  ds_read_b64_tr_b16 a[130:131], v42 offset:2048
  ds_read_b64_tr_b16 v[152:153], v42 offset:4096
  ds_read_b64_tr_b16 v[154:155], v42 offset:6144
  ds_read_b64_tr_b16 a[132:133], v42 offset:8192
  ds_read_b64_tr_b16 a[134:135], v42 offset:10240
  ds_read_b64_tr_b16 v[156:157], v42 offset:12288
  ds_read_b64_tr_b16 v[158:159], v42 offset:14336
  s_waitcnt vmcnt(4) lgkmcnt(0)
  s_barrier
  ds_read_b64_tr_b16 a[136:137], v42 offset:16384
  ds_read_b64_tr_b16 a[138:139], v42 offset:18432
  ds_read_b64_tr_b16 v[160:161], v42 offset:20480
  ds_read_b64_tr_b16 v[162:163], v42 offset:22528
  ds_read_b64_tr_b16 a[140:141], v42 offset:24576
  ds_read_b64_tr_b16 a[142:143], v42 offset:26624
  ds_read_b64_tr_b16 v[164:165], v42 offset:28672
  ds_read_b64_tr_b16 v[166:167], v42 offset:30720
  s_waitcnt vmcnt(0) lgkmcnt(0)
  s_barrier
  ds_read_b64_tr_b16 a[144:145], v42 offset:32768
  ds_read_b64_tr_b16 a[146:147], v42 offset:34816
  ds_read_b64_tr_b16 v[168:169], v42 offset:36864
  ds_read_b64_tr_b16 v[170:171], v42 offset:38912
  ds_read_b64_tr_b16 a[148:149], v42 offset:40960
  ds_read_b64_tr_b16 a[150:151], v42 offset:43008
  ds_read_b64_tr_b16 v[172:173], v42 offset:45056
  ds_read_b64_tr_b16 v[174:175], v42 offset:47104
  s_waitcnt lgkmcnt(0)
  s_barrier
  s_cmp_lt_u32 s21, 8
  s_cbranch_scc1 L_F2_keep
  v_accvgpr_write_b32 a0, 0
  v_accvgpr_write_b32 a1, 0
  v_accvgpr_write_b32 a2, 0
  v_accvgpr_write_b32 a3, 0
  v_accvgpr_write_b32 a152, 0
  v_accvgpr_write_b32 a153, 0
  v_accvgpr_write_b32 a154, 0
  v_accvgpr_write_b32 a155, 0
  s_nop 1
L_F2_keep:
  s_lshr_b32 s43, s21, 3
  s_mul_i32 s43, s43, 37
  s_lshr_b32 s44, s43, 1
  v_min_u32 v52, 19, v0
  v_add_u32 v52, s44, v52
  v_min_u32 v52, 55, v52
  v_lshlrev_b32 v52, 7, v52
  v_add_u32 v2, 1414144, v52
  s_lshl_b32 s40, s43, 11
  s_add_u32 s27, s40, 44040192
  s_lshl_b32 s62, s21, 7
  s_add_u32 s62, s62, 1421312
  s_lshl_b32 s40, s21, 13
  s_add_u32 s31, s40, 142606336
  s_lshl_b32 s40, s20, 11
  v_lshl_add_u32 v68, v0, 4, s40
  v_lshlrev_b32 v1, 4, v0
  s_lshl_b32 s32, s20, 12
  s_mul_i32 s33, s20, 3072
  v_mov_b32 v69, v1
  v_add_u32 v70, 0x10000, v69
  s_lshl_b32 s40, s20, 2
  s_add_u32 s40, s40, 155648
  v_mov_b32 v71, s40
  v_mov_b32 v52, 0
  ds_write_b32 v71, v52
  s_mov_b32 s25, 0
  s_mov_b32 s26, 0
  s_mov_b32 s29, 1
  s_mov_b32 s30, 0
  s_mov_b32 s28, 1
  s_waitcnt lgkmcnt(0)
  s_barrier
  s_branch L_F2_poll
L_F2_top:
  s_cmp_lg_u32 s28, 0
  s_cbranch_scc1 L_F2_go
  buffer_load_dword v3, v2, s[4:7], s30 offen sc1
  v_mov_b32 v52, s25
  v_and_b32 v53, 3, v0
  v_lshlrev_b32 v53, 2, v53
  v_add_u32 v53, 155648, v53
  s_waitcnt vmcnt(1)
  ds_write_b32 v71, v52
  ds_read_b32 v53, v53
  s_waitcnt lgkmcnt(0)
  v_cmp_gt_i32 vcc, s25, v53
  s_cbranch_vccnz L_F2_nosig
  s_mov_b32 s63, s25
  s_atomic_smax s63, s[4:5], s62 glc
Lnosig_32:
L_F2_nosig:
  s_cmp_ge_u32 s25, 64
  s_cbranch_scc1 L_END
  s_waitcnt vmcnt(0)
  v_cmp_gt_i32 vcc, s29, v3
  s_cbranch_vccz L_F2_issue
L_F2_poll:
  s_nop 3
Lpoll_33:
  buffer_load_dword v3, v2, s[4:7], s30 offen sc1
  s_sub_u32 s24, s24, 1
  s_cbranch_scc1 L_FAIL
  s_waitcnt vmcnt(0)
  v_cmp_gt_i32 vcc, s29, v3
  s_cbranch_vccz Lpolld_34
  s_sleep 2
  s_branch Lpoll_33
Lpolld_34:
L_F2_issue:
  s_mov_b32 s34, s26
  s_mov_b32 s35, s27
  s_add_u32 s36, s32, 0
  s_add_u32 m0, s34, s36
  s_add_u32 s36, s35, s36
  buffer_load_dwordx4 v1, s[4:7], s36 offen offset:0 sc1 lds
  buffer_load_dwordx4 v1, s[4:7], s36 offen offset:1024 sc1 lds
  buffer_load_dwordx4 v1, s[4:7], s36 offen offset:2048 sc1 lds
  buffer_load_dwordx4 v1, s[4:7], s36 offen offset:3072 sc1 lds
  s_add_u32 s36, s32, 16384
  s_add_u32 m0, s34, s36
  s_add_u32 s36, s35, s36
  buffer_load_dwordx4 v1, s[4:7], s36 offen offset:0 sc1 lds
  buffer_load_dwordx4 v1, s[4:7], s36 offen offset:1024 sc1 lds
  buffer_load_dwordx4 v1, s[4:7], s36 offen offset:2048 sc1 lds
  buffer_load_dwordx4 v1, s[4:7], s36 offen offset:3072 sc1 lds
  s_add_u32 s36, s32, 32768
  s_add_u32 m0, s34, s36
  s_add_u32 s36, s35, s36
  buffer_load_dwordx4 v1, s[4:7], s36 offen offset:0 sc1 lds
  buffer_load_dwordx4 v1, s[4:7], s36 offen offset:1024 sc1 lds
  buffer_load_dwordx4 v1, s[4:7], s36 offen offset:2048 sc1 lds
  buffer_load_dwordx4 v1, s[4:7], s36 offen offset:3072 sc1 lds
  s_add_u32 s36, s32, 49152
  s_add_u32 m0, s34, s36
  s_add_u32 s36, s35, s36
  buffer_load_dwordx4 v1, s[4:7], s36 offen offset:0 sc1 lds
  buffer_load_dwordx4 v1, s[4:7], s36 offen offset:1024 sc1 lds
  buffer_load_dwordx4 v1, s[4:7], s36 offen offset:2048 sc1 lds
  buffer_load_dwordx4 v1, s[4:7], s36 offen offset:3072 sc1 lds
  s_add_u32 s36, s33, 65536
  s_add_u32 m0, s34, s36
  s_add_u32 s36, s35, s36
  buffer_load_dwordx4 v1, s[4:7], s36 offen offset:0 sc1 lds
  buffer_load_dwordx4 v1, s[4:7], s36 offen offset:1024 sc1 lds
  buffer_load_dwordx4 v1, s[4:7], s36 offen offset:2048 sc1 lds
L_F2_go:
  v_add_u32 v73, s26, v69
  v_add_u32 v74, s26, v70
  s_sub_u32 s26, 77824, s26
  s_add_u32 s27, s27, 229376
  s_mov_b32 s34, s26
  s_mov_b32 s35, s27
  s_add_u32 s29, s29, 1
  s_waitcnt vmcnt(15)
  s_barrier
  ds_read_b128 v[4:7], v73 offset:0
  ds_read_b128 v[8:11], v73 offset:1024
  ds_read_b128 v[12:15], v73 offset:2048
  ds_read_b128 v[16:19], v73 offset:3072
  ds_read_b128 v[20:23], v73 offset:4096
  ds_read_b128 v[24:27], v73 offset:5120
  buffer_load_dword v3, v2, s[4:7], s30 offen sc1
  s_waitcnt lgkmcnt(4)
  v_mfma_f32_16x16x32_bf16 v[36:39], a[0:3], v[4:7], 0
  ds_read_b128 v[28:31], v73 offset:6144
  v_mfma_f32_16x16x32_bf16 v[40:43], a[0:3], v[8:11], 0
  ds_read_b128 v[32:35], v73 offset:7168
  v_mfma_f32_16x16x32_bf16 v[44:47], a[152:155], v[4:7], 0
  v_mfma_f32_16x16x32_bf16 v[48:51], a[152:155], v[8:11], 0
  s_waitcnt lgkmcnt(4)
  v_mfma_f32_16x16x32_bf16 v[36:39], a[4:7], v[12:15], v[36:39]
  ds_read_b128 v[4:7], v73 offset:8192
  v_mfma_f32_16x16x32_bf16 v[40:43], a[4:7], v[16:19], v[40:43]
  ds_read_b128 v[8:11], v73 offset:9216
  v_mfma_f32_16x16x32_bf16 v[44:47], a[156:159], v[12:15], v[44:47]
  v_mfma_f32_16x16x32_bf16 v[48:51], a[156:159], v[16:19], v[48:51]
  s_waitcnt lgkmcnt(4)
  v_mfma_f32_16x16x32_bf16 v[36:39], a[8:11], v[20:23], v[36:39]
  ds_read_b128 v[12:15], v73 offset:10240
  v_mfma_f32_16x16x32_bf16 v[40:43], a[8:11], v[24:27], v[40:43]
  ds_read_b128 v[16:19], v73 offset:11264
  v_mfma_f32_16x16x32_bf16 v[44:47], a[160:163], v[20:23], v[44:47]
  v_mfma_f32_16x16x32_bf16 v[48:51], a[160:163], v[24:27], v[48:51]
  s_waitcnt lgkmcnt(4)
  v_mfma_f32_16x16x32_bf16 v[36:39], a[12:15], v[28:31], v[36:39]
  ds_read_b128 v[20:23], v73 offset:12288
  v_mfma_f32_16x16x32_bf16 v[40:43], a[12:15], v[32:35], v[40:43]
  ds_read_b128 v[24:27], v73 offset:13312
  v_mfma_f32_16x16x32_bf16 v[44:47], a[164:167], v[28:31], v[44:47]
  v_mfma_f32_16x16x32_bf16 v[48:51], a[164:167], v[32:35], v[48:51]
  s_waitcnt lgkmcnt(4)
  v_mfma_f32_16x16x32_bf16 v[36:39], a[16:19], v[4:7], v[36:39]
  ds_read_b128 v[28:31], v73 offset:14336
  v_mfma_f32_16x16x32_bf16 v[40:43], a[16:19], v[8:11], v[40:43]
  ds_read_b128 v[32:35], v73 offset:15360
  v_mfma_f32_16x16x32_bf16 v[44:47], a[168:171], v[4:7], v[44:47]
  v_mfma_f32_16x16x32_bf16 v[48:51], a[168:171], v[8:11], v[48:51]
  s_waitcnt vmcnt(12)
  s_barrier
  s_waitcnt lgkmcnt(4)
  v_mfma_f32_16x16x32_bf16 v[36:39], a[20:23], v[12:15], v[36:39]
  ds_read_b128 v[4:7], v73 offset:16384
  v_mfma_f32_16x16x32_bf16 v[40:43], a[20:23], v[16:19], v[40:43]
  ds_read_b128 v[8:11], v73 offset:17408
  v_mfma_f32_16x16x32_bf16 v[44:47], a[172:175], v[12:15], v[44:47]
  v_mfma_f32_16x16x32_bf16 v[48:51], a[172:175], v[16:19], v[48:51]
  s_waitcnt lgkmcnt(4)
  v_mfma_f32_16x16x32_bf16 v[36:39], a[24:27], v[20:23], v[36:39]
  ds_read_b128 v[12:15], v73 offset:18432
  v_mfma_f32_16x16x32_bf16 v[40:43], a[24:27], v[24:27], v[40:43]
  ds_read_b128 v[16:19], v73 offset:19456
  v_mfma_f32_16x16x32_bf16 v[44:47], a[176:179], v[20:23], v[44:47]
  v_mfma_f32_16x16x32_bf16 v[48:51], a[176:179], v[24:27], v[48:51]
  s_waitcnt lgkmcnt(4)
  v_mfma_f32_16x16x32_bf16 v[36:39], a[28:31], v[28:31], v[36:39]
  ds_read_b128 v[20:23], v73 offset:20480
  v_mfma_f32_16x16x32_bf16 v[40:43], a[28:31], v[32:35], v[40:43]
  ds_read_b128 v[24:27], v73 offset:21504
  v_mfma_f32_16x16x32_bf16 v[44:47], a[180:183], v[28:31], v[44:47]
  v_mfma_f32_16x16x32_bf16 v[48:51], a[180:183], v[32:35], v[48:51]
  s_waitcnt lgkmcnt(4)
  v_mfma_f32_16x16x32_bf16 v[36:39], a[32:35], v[4:7], v[36:39]
  ds_read_b128 v[28:31], v73 offset:22528
  v_mfma_f32_16x16x32_bf16 v[40:43], a[32:35], v[8:11], v[40:43]
  ds_read_b128 v[32:35], v73 offset:23552
  v_mfma_f32_16x16x32_bf16 v[44:47], a[184:187], v[4:7], v[44:47]
  v_mfma_f32_16x16x32_bf16 v[48:51], a[184:187], v[8:11], v[48:51]
  s_waitcnt lgkmcnt(4)
  v_mfma_f32_16x16x32_bf16 v[36:39], a[36:39], v[12:15], v[36:39]
  ds_read_b128 v[4:7], v73 offset:24576
  v_mfma_f32_16x16x32_bf16 v[40:43], a[36:39], v[16:19], v[40:43]
  ds_read_b128 v[8:11], v73 offset:25600
  v_mfma_f32_16x16x32_bf16 v[44:47], a[188:191], v[12:15], v[44:47]
  v_mfma_f32_16x16x32_bf16 v[48:51], a[188:191], v[16:19], v[48:51]
  s_waitcnt lgkmcnt(4)
  v_mfma_f32_16x16x32_bf16 v[36:39], a[40:43], v[20:23], v[36:39]
  ds_read_b128 v[12:15], v73 offset:26624
  v_mfma_f32_16x16x32_bf16 v[40:43], a[40:43], v[24:27], v[40:43]
  ds_read_b128 v[16:19], v73 offset:27648
  v_mfma_f32_16x16x32_bf16 v[44:47], a[192:195], v[20:23], v[44:47]
  v_mfma_f32_16x16x32_bf16 v[48:51], a[192:195], v[24:27], v[48:51]
  s_waitcnt lgkmcnt(4)
  v_mfma_f32_16x16x32_bf16 v[36:39], a[44:47], v[28:31], v[36:39]
  ds_read_b128 v[20:23], v73 offset:28672
  v_mfma_f32_16x16x32_bf16 v[40:43], a[44:47], v[32:35], v[40:43]
  ds_read_b128 v[24:27], v73 offset:29696
  v_mfma_f32_16x16x32_bf16 v[44:47], a[196:199], v[28:31], v[44:47]
  v_mfma_f32_16x16x32_bf16 v[48:51], a[196:199], v[32:35], v[48:51]
  s_waitcnt lgkmcnt(4)
  v_mfma_f32_16x16x32_bf16 v[36:39], a[48:51], v[4:7], v[36:39]
  ds_read_b128 v[28:31], v73 offset:30720
  v_mfma_f32_16x16x32_bf16 v[40:43], a[48:51], v[8:11], v[40:43]
  ds_read_b128 v[32:35], v73 offset:31744
  v_mfma_f32_16x16x32_bf16 v[44:47], a[200:203], v[4:7], v[44:47]
  v_mfma_f32_16x16x32_bf16 v[48:51], a[200:203], v[8:11], v[48:51]
  s_waitcnt vmcnt(0)
  s_barrier
  v_cmp_gt_i32 vcc, s29, v3
  s_cmp_lg_u32 s20, 0
  s_cbranch_scc1 Lnosig_35
  s_mov_b32 s63, s25
  s_atomic_smax s63, s[4:5], s62 glc
Lnosig_35:
L_F2_s2:
  s_mov_b32 s28, 0
  s_cbranch_vccnz L_F2_nopf
  s_cmp_ge_u32 s25, 63
  s_cbranch_scc1 L_F2_nopf
  s_mov_b32 s28, 1
  s_waitcnt lgkmcnt(4)
  v_mfma_f32_16x16x32_bf16 v[36:39], a[52:55], v[12:15], v[36:39]
  ds_read_b128 v[4:7], v73 offset:32768
  v_mfma_f32_16x16x32_bf16 v[40:43], a[52:55], v[16:19], v[40:43]
  ds_read_b128 v[8:11], v73 offset:33792
  v_mfma_f32_16x16x32_bf16 v[44:47], a[204:207], v[12:15], v[44:47]
  s_add_u32 s36, s32, 0
  s_add_u32 m0, s34, s36
  s_add_u32 s36, s35, s36
  buffer_load_dwordx4 v1, s[4:7], s36 offen offset:0 sc1 lds
  v_mfma_f32_16x16x32_bf16 v[48:51], a[204:207], v[16:19], v[48:51]
  s_waitcnt lgkmcnt(4)
  v_mfma_f32_16x16x32_bf16 v[36:39], a[56:59], v[20:23], v[36:39]
  ds_read_b128 v[12:15], v73 offset:34816
  v_mfma_f32_16x16x32_bf16 v[40:43], a[56:59], v[24:27], v[40:43]
  ds_read_b128 v[16:19], v73 offset:35840
  v_mfma_f32_16x16x32_bf16 v[44:47], a[208:211], v[20:23], v[44:47]
  buffer_load_dwordx4 v1, s[4:7], s36 offen offset:1024 sc1 lds
  v_mfma_f32_16x16x32_bf16 v[48:51], a[208:211], v[24:27], v[48:51]
  s_waitcnt lgkmcnt(4)
  v_mfma_f32_16x16x32_bf16 v[36:39], a[60:63], v[28:31], v[36:39]
  ds_read_b128 v[20:23], v73 offset:36864
  v_mfma_f32_16x16x32_bf16 v[40:43], a[60:63], v[32:35], v[40:43]
  ds_read_b128 v[24:27], v73 offset:37888
  v_mfma_f32_16x16x32_bf16 v[44:47], a[212:215], v[28:31], v[44:47]
  buffer_load_dwordx4 v1, s[4:7], s36 offen offset:2048 sc1 lds
  v_mfma_f32_16x16x32_bf16 v[48:51], a[212:215], v[32:35], v[48:51]
  s_waitcnt lgkmcnt(4)
  v_mfma_f32_16x16x32_bf16 v[36:39], a[64:67], v[4:7], v[36:39]
  ds_read_b128 v[28:31], v73 offset:38912
  v_mfma_f32_16x16x32_bf16 v[40:43], a[64:67], v[8:11], v[40:43]
  ds_read_b128 v[32:35], v73 offset:39936
  v_mfma_f32_16x16x32_bf16 v[44:47], a[216:219], v[4:7], v[44:47]
  buffer_load_dwordx4 v1, s[4:7], s36 offen offset:3072 sc1 lds
  v_mfma_f32_16x16x32_bf16 v[48:51], a[216:219], v[8:11], v[48:51]
  s_waitcnt lgkmcnt(4)
  v_mfma_f32_16x16x32_bf16 v[36:39], a[68:71], v[12:15], v[36:39]
  ds_read_b128 v[4:7], v73 offset:40960
  v_mfma_f32_16x16x32_bf16 v[40:43], a[68:71], v[16:19], v[40:43]
  ds_read_b128 v[8:11], v73 offset:41984
  v_mfma_f32_16x16x32_bf16 v[44:47], a[220:223], v[12:15], v[44:47]
  s_add_u32 s36, s32, 16384
  s_add_u32 m0, s34, s36
  s_add_u32 s36, s35, s36
  buffer_load_dwordx4 v1, s[4:7], s36 offen offset:0 sc1 lds
  v_mfma_f32_16x16x32_bf16 v[48:51], a[220:223], v[16:19], v[48:51]
  s_waitcnt lgkmcnt(4)
  v_mfma_f32_16x16x32_bf16 v[36:39], a[72:75], v[20:23], v[36:39]
  ds_read_b128 v[12:15], v73 offset:43008
  v_mfma_f32_16x16x32_bf16 v[40:43], a[72:75], v[24:27], v[40:43]
  ds_read_b128 v[16:19], v73 offset:44032
  v_mfma_f32_16x16x32_bf16 v[44:47], a[224:227], v[20:23], v[44:47]
  buffer_load_dwordx4 v1, s[4:7], s36 offen offset:1024 sc1 lds
  v_mfma_f32_16x16x32_bf16 v[48:51], a[224:227], v[24:27], v[48:51]
  s_waitcnt lgkmcnt(4)
  v_mfma_f32_16x16x32_bf16 v[36:39], a[76:79], v[28:31], v[36:39]
  ds_read_b128 v[20:23], v73 offset:45056
  v_mfma_f32_16x16x32_bf16 v[40:43], a[76:79], v[32:35], v[40:43]
  ds_read_b128 v[24:27], v73 offset:46080
  v_mfma_f32_16x16x32_bf16 v[44:47], a[228:231], v[28:31], v[44:47]
  buffer_load_dwordx4 v1, s[4:7], s36 offen offset:2048 sc1 lds
  v_mfma_f32_16x16x32_bf16 v[48:51], a[228:231], v[32:35], v[48:51]
  s_waitcnt lgkmcnt(4)
  v_mfma_f32_16x16x32_bf16 v[36:39], a[80:83], v[4:7], v[36:39]
  ds_read_b128 v[28:31], v73 offset:47104
  v_mfma_f32_16x16x32_bf16 v[40:43], a[80:83], v[8:11], v[40:43]
  ds_read_b128 v[32:35], v73 offset:48128
  v_mfma_f32_16x16x32_bf16 v[44:47], a[232:235], v[4:7], v[44:47]
  buffer_load_dwordx4 v1, s[4:7], s36 offen offset:3072 sc1 lds
  v_mfma_f32_16x16x32_bf16 v[48:51], a[232:235], v[8:11], v[48:51]
  s_waitcnt lgkmcnt(4)
  v_mfma_f32_16x16x32_bf16 v[36:39], a[84:87], v[12:15], v[36:39]
  ds_read_b128 v[4:7], v73 offset:49152
  v_mfma_f32_16x16x32_bf16 v[40:43], a[84:87], v[16:19], v[40:43]
  ds_read_b128 v[8:11], v73 offset:50176
  v_mfma_f32_16x16x32_bf16 v[44:47], a[236:239], v[12:15], v[44:47]
  s_add_u32 s36, s32, 32768
  s_add_u32 m0, s34, s36
  s_add_u32 s36, s35, s36
  buffer_load_dwordx4 v1, s[4:7], s36 offen offset:0 sc1 lds
  v_mfma_f32_16x16x32_bf16 v[48:51], a[236:239], v[16:19], v[48:51]
  s_waitcnt lgkmcnt(4)
  v_mfma_f32_16x16x32_bf16 v[36:39], a[88:91], v[20:23], v[36:39]
  ds_read_b128 v[12:15], v73 offset:51200
  v_mfma_f32_16x16x32_bf16 v[40:43], a[88:91], v[24:27], v[40:43]
  ds_read_b128 v[16:19], v73 offset:52224
  v_mfma_f32_16x16x32_bf16 v[44:47], a[240:243], v[20:23], v[44:47]
  buffer_load_dwordx4 v1, s[4:7], s36 offen offset:1024 sc1 lds
  v_mfma_f32_16x16x32_bf16 v[48:51], a[240:243], v[24:27], v[48:51]
  s_waitcnt lgkmcnt(4)
  v_mfma_f32_16x16x32_bf16 v[36:39], a[92:95], v[28:31], v[36:39]
  ds_read_b128 v[20:23], v73 offset:53248
  v_mfma_f32_16x16x32_bf16 v[40:43], a[92:95], v[32:35], v[40:43]
  ds_read_b128 v[24:27], v73 offset:54272
  v_mfma_f32_16x16x32_bf16 v[44:47], a[244:247], v[28:31], v[44:47]
  buffer_load_dwordx4 v1, s[4:7], s36 offen offset:2048 sc1 lds
  v_mfma_f32_16x16x32_bf16 v[48:51], a[244:247], v[32:35], v[48:51]
  s_waitcnt lgkmcnt(4)
  v_mfma_f32_16x16x32_bf16 v[36:39], a[96:99], v[4:7], v[36:39]
  ds_read_b128 v[28:31], v73 offset:55296
  v_mfma_f32_16x16x32_bf16 v[40:43], a[96:99], v[8:11], v[40:43]
  ds_read_b128 v[32:35], v73 offset:56320
  v_mfma_f32_16x16x32_bf16 v[44:47], a[248:251], v[4:7], v[44:47]
  buffer_load_dwordx4 v1, s[4:7], s36 offen offset:3072 sc1 lds
  v_mfma_f32_16x16x32_bf16 v[48:51], a[248:251], v[8:11], v[48:51]
  s_waitcnt lgkmcnt(4)
  v_mfma_f32_16x16x32_bf16 v[36:39], a[100:103], v[12:15], v[36:39]
  ds_read_b128 v[4:7], v73 offset:57344
  v_mfma_f32_16x16x32_bf16 v[40:43], a[100:103], v[16:19], v[40:43]
  ds_read_b128 v[8:11], v73 offset:58368
  v_mfma_f32_16x16x32_bf16 v[44:47], a[252:255], v[12:15], v[44:47]
  s_add_u32 s36, s32, 49152
  s_add_u32 m0, s34, s36
  s_add_u32 s36, s35, s36
  buffer_load_dwordx4 v1, s[4:7], s36 offen offset:0 sc1 lds
  v_mfma_f32_16x16x32_bf16 v[48:51], a[252:255], v[16:19], v[48:51]
  s_waitcnt lgkmcnt(4)
  v_mfma_f32_16x16x32_bf16 v[36:39], a[104:107], v[20:23], v[36:39]
  ds_read_b128 v[12:15], v73 offset:59392
  v_mfma_f32_16x16x32_bf16 v[40:43], a[104:107], v[24:27], v[40:43]
  ds_read_b128 v[16:19], v73 offset:60416
  v_mfma_f32_16x16x32_bf16 v[44:47], v[128:131], v[20:23], v[44:47]
  buffer_load_dwordx4 v1, s[4:7], s36 offen offset:1024 sc1 lds
  v_mfma_f32_16x16x32_bf16 v[48:51], v[128:131], v[24:27], v[48:51]
  s_waitcnt lgkmcnt(4)
  v_mfma_f32_16x16x32_bf16 v[36:39], a[108:111], v[28:31], v[36:39]
  ds_read_b128 v[20:23], v73 offset:61440
  v_mfma_f32_16x16x32_bf16 v[40:43], a[108:111], v[32:35], v[40:43]
  ds_read_b128 v[24:27], v73 offset:62464
  v_mfma_f32_16x16x32_bf16 v[44:47], v[132:135], v[28:31], v[44:47]
  buffer_load_dwordx4 v1, s[4:7], s36 offen offset:2048 sc1 lds
  v_mfma_f32_16x16x32_bf16 v[48:51], v[132:135], v[32:35], v[48:51]
  s_waitcnt lgkmcnt(4)
  v_mfma_f32_16x16x32_bf16 v[36:39], a[112:115], v[4:7], v[36:39]
  ds_read_b128 v[28:31], v73 offset:63488
  v_mfma_f32_16x16x32_bf16 v[40:43], a[112:115], v[8:11], v[40:43]
  ds_read_b128 v[32:35], v73 offset:64512
  v_mfma_f32_16x16x32_bf16 v[44:47], v[136:139], v[4:7], v[44:47]
  buffer_load_dwordx4 v1, s[4:7], s36 offen offset:3072 sc1 lds
  v_mfma_f32_16x16x32_bf16 v[48:51], v[136:139], v[8:11], v[48:51]
  s_waitcnt lgkmcnt(4)
  v_mfma_f32_16x16x32_bf16 v[36:39], a[116:119], v[12:15], v[36:39]
  ds_read_b128 v[4:7], v74 offset:0
  v_mfma_f32_16x16x32_bf16 v[40:43], a[116:119], v[16:19], v[40:43]
  ds_read_b128 v[8:11], v74 offset:1024
  v_mfma_f32_16x16x32_bf16 v[44:47], v[140:143], v[12:15], v[44:47]
  s_add_u32 s36, s33, 65536
  s_add_u32 m0, s34, s36
  s_add_u32 s36, s35, s36
  buffer_load_dwordx4 v1, s[4:7], s36 offen offset:0 sc1 lds
  v_mfma_f32_16x16x32_bf16 v[48:51], v[140:143], v[16:19], v[48:51]
  s_waitcnt lgkmcnt(4)
  v_mfma_f32_16x16x32_bf16 v[36:39], a[120:123], v[20:23], v[36:39]
  ds_read_b128 v[12:15], v74 offset:2048
  v_mfma_f32_16x16x32_bf16 v[40:43], a[120:123], v[24:27], v[40:43]
  ds_read_b128 v[16:19], v74 offset:3072
  v_mfma_f32_16x16x32_bf16 v[44:47], v[144:147], v[20:23], v[44:47]
  buffer_load_dwordx4 v1, s[4:7], s36 offen offset:1024 sc1 lds
  v_mfma_f32_16x16x32_bf16 v[48:51], v[144:147], v[24:27], v[48:51]
  s_waitcnt lgkmcnt(4)
  v_mfma_f32_16x16x32_bf16 v[36:39], a[124:127], v[28:31], v[36:39]
  ds_read_b128 v[20:23], v74 offset:4096
  v_mfma_f32_16x16x32_bf16 v[40:43], a[124:127], v[32:35], v[40:43]
  ds_read_b128 v[24:27], v74 offset:5120
  v_mfma_f32_16x16x32_bf16 v[44:47], v[148:151], v[28:31], v[44:47]
  buffer_load_dwordx4 v1, s[4:7], s36 offen offset:2048 sc1 lds
  v_mfma_f32_16x16x32_bf16 v[48:51], v[148:151], v[32:35], v[48:51]
  s_waitcnt lgkmcnt(4)
  v_mfma_f32_16x16x32_bf16 v[36:39], a[128:131], v[4:7], v[36:39]
  ds_read_b128 v[28:31], v74 offset:6144
  v_mfma_f32_16x16x32_bf16 v[40:43], a[128:131], v[8:11], v[40:43]
  ds_read_b128 v[32:35], v74 offset:7168
  v_mfma_f32_16x16x32_bf16 v[44:47], v[152:155], v[4:7], v[44:47]
  v_mfma_f32_16x16x32_bf16 v[48:51], v[152:155], v[8:11], v[48:51]
  s_waitcnt lgkmcnt(4)
  v_mfma_f32_16x16x32_bf16 v[36:39], a[132:135], v[12:15], v[36:39]
  ds_read_b128 v[4:7], v74 offset:8192
  v_mfma_f32_16x16x32_bf16 v[40:43], a[132:135], v[16:19], v[40:43]
  ds_read_b128 v[8:11], v74 offset:9216
  v_mfma_f32_16x16x32_bf16 v[44:47], v[156:159], v[12:15], v[44:47]
  v_mfma_f32_16x16x32_bf16 v[48:51], v[156:159], v[16:19], v[48:51]
  s_waitcnt lgkmcnt(4)
  v_mfma_f32_16x16x32_bf16 v[36:39], a[136:139], v[20:23], v[36:39]
  ds_read_b128 v[12:15], v74 offset:10240
  v_mfma_f32_16x16x32_bf16 v[40:43], a[136:139], v[24:27], v[40:43]
  ds_read_b128 v[16:19], v74 offset:11264
  v_mfma_f32_16x16x32_bf16 v[44:47], v[160:163], v[20:23], v[44:47]
  v_mfma_f32_16x16x32_bf16 v[48:51], v[160:163], v[24:27], v[48:51]
  s_waitcnt lgkmcnt(4)
  v_mfma_f32_16x16x32_bf16 v[36:39], a[140:143], v[28:31], v[36:39]
  v_mfma_f32_16x16x32_bf16 v[40:43], a[140:143], v[32:35], v[40:43]
  v_mfma_f32_16x16x32_bf16 v[44:47], v[164:167], v[28:31], v[44:47]
  v_mfma_f32_16x16x32_bf16 v[48:51], v[164:167], v[32:35], v[48:51]
  s_waitcnt lgkmcnt(2)
  v_mfma_f32_16x16x32_bf16 v[36:39], a[144:147], v[4:7], v[36:39]
  v_mfma_f32_16x16x32_bf16 v[40:43], a[144:147], v[8:11], v[40:43]
  v_mfma_f32_16x16x32_bf16 v[44:47], v[168:171], v[4:7], v[44:47]
  v_mfma_f32_16x16x32_bf16 v[48:51], v[168:171], v[8:11], v[48:51]
  s_waitcnt lgkmcnt(0)
  v_mfma_f32_16x16x32_bf16 v[36:39], a[148:151], v[12:15], v[36:39]
  v_mfma_f32_16x16x32_bf16 v[40:43], a[148:151], v[16:19], v[40:43]
  v_mfma_f32_16x16x32_bf16 v[44:47], v[172:175], v[12:15], v[44:47]
  v_mfma_f32_16x16x32_bf16 v[48:51], v[172:175], v[16:19], v[48:51]
  s_nop 7
  s_branch L_F2_epi
L_F2_nopf:
  s_waitcnt lgkmcnt(4)
  v_mfma_f32_16x16x32_bf16 v[36:39], a[52:55], v[12:15], v[36:39]
  ds_read_b128 v[4:7], v73 offset:32768
  v_mfma_f32_16x16x32_bf16 v[40:43], a[52:55], v[16:19], v[40:43]
  ds_read_b128 v[8:11], v73 offset:33792
  v_mfma_f32_16x16x32_bf16 v[44:47], a[204:207], v[12:15], v[44:47]
  v_mfma_f32_16x16x32_bf16 v[48:51], a[204:207], v[16:19], v[48:51]
  s_waitcnt lgkmcnt(4)
  v_mfma_f32_16x16x32_bf16 v[36:39], a[56:59], v[20:23], v[36:39]
  ds_read_b128 v[12:15], v73 offset:34816
  v_mfma_f32_16x16x32_bf16 v[40:43], a[56:59], v[24:27], v[40:43]
  ds_read_b128 v[16:19], v73 offset:35840
  v_mfma_f32_16x16x32_bf16 v[44:47], a[208:211], v[20:23], v[44:47]
  v_mfma_f32_16x16x32_bf16 v[48:51], a[208:211], v[24:27], v[48:51]
  s_waitcnt lgkmcnt(4)
  v_mfma_f32_16x16x32_bf16 v[36:39], a[60:63], v[28:31], v[36:39]
  ds_read_b128 v[20:23], v73 offset:36864
  v_mfma_f32_16x16x32_bf16 v[40:43], a[60:63], v[32:35], v[40:43]
  ds_read_b128 v[24:27], v73 offset:37888
  v_mfma_f32_16x16x32_bf16 v[44:47], a[212:215], v[28:31], v[44:47]
  v_mfma_f32_16x16x32_bf16 v[48:51], a[212:215], v[32:35], v[48:51]
  s_waitcnt lgkmcnt(4)
  v_mfma_f32_16x16x32_bf16 v[36:39], a[64:67], v[4:7], v[36:39]
  ds_read_b128 v[28:31], v73 offset:38912
  v_mfma_f32_16x16x32_bf16 v[40:43], a[64:67], v[8:11], v[40:43]
  ds_read_b128 v[32:35], v73 offset:39936
  v_mfma_f32_16x16x32_bf16 v[44:47], a[216:219], v[4:7], v[44:47]
  v_mfma_f32_16x16x32_bf16 v[48:51], a[216:219], v[8:11], v[48:51]
  s_waitcnt lgkmcnt(4)
  v_mfma_f32_16x16x32_bf16 v[36:39], a[68:71], v[12:15], v[36:39]
  ds_read_b128 v[4:7], v73 offset:40960
  v_mfma_f32_16x16x32_bf16 v[40:43], a[68:71], v[16:19], v[40:43]
  ds_read_b128 v[8:11], v73 offset:41984
  v_mfma_f32_16x16x32_bf16 v[44:47], a[220:223], v[12:15], v[44:47]
  v_mfma_f32_16x16x32_bf16 v[48:51], a[220:223], v[16:19], v[48:51]
  s_waitcnt lgkmcnt(4)
  v_mfma_f32_16x16x32_bf16 v[36:39], a[72:75], v[20:23], v[36:39]
  ds_read_b128 v[12:15], v73 offset:43008
  v_mfma_f32_16x16x32_bf16 v[40:43], a[72:75], v[24:27], v[40:43]
  ds_read_b128 v[16:19], v73 offset:44032
  v_mfma_f32_16x16x32_bf16 v[44:47], a[224:227], v[20:23], v[44:47]
  v_mfma_f32_16x16x32_bf16 v[48:51], a[224:227], v[24:27], v[48:51]
  s_waitcnt lgkmcnt(4)
  v_mfma_f32_16x16x32_bf16 v[36:39], a[76:79], v[28:31], v[36:39]
  ds_read_b128 v[20:23], v73 offset:45056
  v_mfma_f32_16x16x32_bf16 v[40:43], a[76:79], v[32:35], v[40:43]
  ds_read_b128 v[24:27], v73 offset:46080
  v_mfma_f32_16x16x32_bf16 v[44:47], a[228:231], v[28:31], v[44:47]
  v_mfma_f32_16x16x32_bf16 v[48:51], a[228:231], v[32:35], v[48:51]
  s_waitcnt lgkmcnt(4)
  v_mfma_f32_16x16x32_bf16 v[36:39], a[80:83], v[4:7], v[36:39]
  ds_read_b128 v[28:31], v73 offset:47104
  v_mfma_f32_16x16x32_bf16 v[40:43], a[80:83], v[8:11], v[40:43]
  ds_read_b128 v[32:35], v73 offset:48128
  v_mfma_f32_16x16x32_bf16 v[44:47], a[232:235], v[4:7], v[44:47]
  v_mfma_f32_16x16x32_bf16 v[48:51], a[232:235], v[8:11], v[48:51]
  s_waitcnt lgkmcnt(4)
  v_mfma_f32_16x16x32_bf16 v[36:39], a[84:87], v[12:15], v[36:39]
  ds_read_b128 v[4:7], v73 offset:49152
  v_mfma_f32_16x16x32_bf16 v[40:43], a[84:87], v[16:19], v[40:43]
  ds_read_b128 v[8:11], v73 offset:50176
  v_mfma_f32_16x16x32_bf16 v[44:47], a[236:239], v[12:15], v[44:47]
  v_mfma_f32_16x16x32_bf16 v[48:51], a[236:239], v[16:19], v[48:51]
  s_waitcnt lgkmcnt(4)
  v_mfma_f32_16x16x32_bf16 v[36:39], a[88:91], v[20:23], v[36:39]
  ds_read_b128 v[12:15], v73 offset:51200
  v_mfma_f32_16x16x32_bf16 v[40:43], a[88:91], v[24:27], v[40:43]
  ds_read_b128 v[16:19], v73 offset:52224
  v_mfma_f32_16x16x32_bf16 v[44:47], a[240:243], v[20:23], v[44:47]
  v_mfma_f32_16x16x32_bf16 v[48:51], a[240:243], v[24:27], v[48:51]
  s_waitcnt lgkmcnt(4)
  v_mfma_f32_16x16x32_bf16 v[36:39], a[92:95], v[28:31], v[36:39]
  ds_read_b128 v[20:23], v73 offset:53248
  v_mfma_f32_16x16x32_bf16 v[40:43], a[92:95], v[32:35], v[40:43]
  ds_read_b128 v[24:27], v73 offset:54272
  v_mfma_f32_16x16x32_bf16 v[44:47], a[244:247], v[28:31], v[44:47]
  v_mfma_f32_16x16x32_bf16 v[48:51], a[244:247], v[32:35], v[48:51]
  s_waitcnt lgkmcnt(4)
  v_mfma_f32_16x16x32_bf16 v[36:39], a[96:99], v[4:7], v[36:39]
  ds_read_b128 v[28:31], v73 offset:55296
  v_mfma_f32_16x16x32_bf16 v[40:43], a[96:99], v[8:11], v[40:43]
  ds_read_b128 v[32:35], v73 offset:56320
  v_mfma_f32_16x16x32_bf16 v[44:47], a[248:251], v[4:7], v[44:47]
  v_mfma_f32_16x16x32_bf16 v[48:51], a[248:251], v[8:11], v[48:51]
  s_waitcnt lgkmcnt(4)
  v_mfma_f32_16x16x32_bf16 v[36:39], a[100:103], v[12:15], v[36:39]
  ds_read_b128 v[4:7], v73 offset:57344
  v_mfma_f32_16x16x32_bf16 v[40:43], a[100:103], v[16:19], v[40:43]
  ds_read_b128 v[8:11], v73 offset:58368
  v_mfma_f32_16x16x32_bf16 v[44:47], a[252:255], v[12:15], v[44:47]
  v_mfma_f32_16x16x32_bf16 v[48:51], a[252:255], v[16:19], v[48:51]
  s_waitcnt lgkmcnt(4)
  v_mfma_f32_16x16x32_bf16 v[36:39], a[104:107], v[20:23], v[36:39]
  ds_read_b128 v[12:15], v73 offset:59392
  v_mfma_f32_16x16x32_bf16 v[40:43], a[104:107], v[24:27], v[40:43]
  ds_read_b128 v[16:19], v73 offset:60416
  v_mfma_f32_16x16x32_bf16 v[44:47], v[128:131], v[20:23], v[44:47]
  v_mfma_f32_16x16x32_bf16 v[48:51], v[128:131], v[24:27], v[48:51]
  s_waitcnt lgkmcnt(4)
  v_mfma_f32_16x16x32_bf16 v[36:39], a[108:111], v[28:31], v[36:39]
  ds_read_b128 v[20:23], v73 offset:61440
  v_mfma_f32_16x16x32_bf16 v[40:43], a[108:111], v[32:35], v[40:43]
  ds_read_b128 v[24:27], v73 offset:62464
  v_mfma_f32_16x16x32_bf16 v[44:47], v[132:135], v[28:31], v[44:47]
  v_mfma_f32_16x16x32_bf16 v[48:51], v[132:135], v[32:35], v[48:51]
  s_waitcnt lgkmcnt(4)
  v_mfma_f32_16x16x32_bf16 v[36:39], a[112:115], v[4:7], v[36:39]
  ds_read_b128 v[28:31], v73 offset:63488
  v_mfma_f32_16x16x32_bf16 v[40:43], a[112:115], v[8:11], v[40:43]
  ds_read_b128 v[32:35], v73 offset:64512
  v_mfma_f32_16x16x32_bf16 v[44:47], v[136:139], v[4:7], v[44:47]
  v_mfma_f32_16x16x32_bf16 v[48:51], v[136:139], v[8:11], v[48:51]
  s_waitcnt lgkmcnt(4)
  v_mfma_f32_16x16x32_bf16 v[36:39], a[116:119], v[12:15], v[36:39]
  ds_read_b128 v[4:7], v74 offset:0
  v_mfma_f32_16x16x32_bf16 v[40:43], a[116:119], v[16:19], v[40:43]
  ds_read_b128 v[8:11], v74 offset:1024
  v_mfma_f32_16x16x32_bf16 v[44:47], v[140:143], v[12:15], v[44:47]
  v_mfma_f32_16x16x32_bf16 v[48:51], v[140:143], v[16:19], v[48:51]
  s_waitcnt lgkmcnt(4)
  v_mfma_f32_16x16x32_bf16 v[36:39], a[120:123], v[20:23], v[36:39]
  ds_read_b128 v[12:15], v74 offset:2048
  v_mfma_f32_16x16x32_bf16 v[40:43], a[120:123], v[24:27], v[40:43]
  ds_read_b128 v[16:19], v74 offset:3072
  v_mfma_f32_16x16x32_bf16 v[44:47], v[144:147], v[20:23], v[44:47]
  v_mfma_f32_16x16x32_bf16 v[48:51], v[144:147], v[24:27], v[48:51]
  s_waitcnt lgkmcnt(4)
  v_mfma_f32_16x16x32_bf16 v[36:39], a[124:127], v[28:31], v[36:39]
  ds_read_b128 v[20:23], v74 offset:4096
  v_mfma_f32_16x16x32_bf16 v[40:43], a[124:127], v[32:35], v[40:43]
  ds_read_b128 v[24:27], v74 offset:5120
  v_mfma_f32_16x16x32_bf16 v[44:47], v[148:151], v[28:31], v[44:47]
  v_mfma_f32_16x16x32_bf16 v[48:51], v[148:151], v[32:35], v[48:51]
  s_waitcnt lgkmcnt(4)
  v_mfma_f32_16x16x32_bf16 v[36:39], a[128:131], v[4:7], v[36:39]
  ds_read_b128 v[28:31], v74 offset:6144
  v_mfma_f32_16x16x32_bf16 v[40:43], a[128:131], v[8:11], v[40:43]
  ds_read_b128 v[32:35], v74 offset:7168
  v_mfma_f32_16x16x32_bf16 v[44:47], v[152:155], v[4:7], v[44:47]
  v_mfma_f32_16x16x32_bf16 v[48:51], v[152:155], v[8:11], v[48:51]
  s_waitcnt lgkmcnt(4)
  v_mfma_f32_16x16x32_bf16 v[36:39], a[132:135], v[12:15], v[36:39]
  ds_read_b128 v[4:7], v74 offset:8192
  v_mfma_f32_16x16x32_bf16 v[40:43], a[132:135], v[16:19], v[40:43]
  ds_read_b128 v[8:11], v74 offset:9216
  v_mfma_f32_16x16x32_bf16 v[44:47], v[156:159], v[12:15], v[44:47]
  v_mfma_f32_16x16x32_bf16 v[48:51], v[156:159], v[16:19], v[48:51]
  s_waitcnt lgkmcnt(4)
  v_mfma_f32_16x16x32_bf16 v[36:39], a[136:139], v[20:23], v[36:39]
  ds_read_b128 v[12:15], v74 offset:10240
  v_mfma_f32_16x16x32_bf16 v[40:43], a[136:139], v[24:27], v[40:43]
  ds_read_b128 v[16:19], v74 offset:11264
  v_mfma_f32_16x16x32_bf16 v[44:47], v[160:163], v[20:23], v[44:47]
  v_mfma_f32_16x16x32_bf16 v[48:51], v[160:163], v[24:27], v[48:51]
  s_waitcnt lgkmcnt(4)
  v_mfma_f32_16x16x32_bf16 v[36:39], a[140:143], v[28:31], v[36:39]
  v_mfma_f32_16x16x32_bf16 v[40:43], a[140:143], v[32:35], v[40:43]
  v_mfma_f32_16x16x32_bf16 v[44:47], v[164:167], v[28:31], v[44:47]
  v_mfma_f32_16x16x32_bf16 v[48:51], v[164:167], v[32:35], v[48:51]
  s_waitcnt lgkmcnt(2)
  v_mfma_f32_16x16x32_bf16 v[36:39], a[144:147], v[4:7], v[36:39]
  v_mfma_f32_16x16x32_bf16 v[40:43], a[144:147], v[8:11], v[40:43]
  v_mfma_f32_16x16x32_bf16 v[44:47], v[168:171], v[4:7], v[44:47]
  v_mfma_f32_16x16x32_bf16 v[48:51], v[168:171], v[8:11], v[48:51]
  s_waitcnt lgkmcnt(0)
  v_mfma_f32_16x16x32_bf16 v[36:39], a[148:151], v[12:15], v[36:39]
  v_mfma_f32_16x16x32_bf16 v[40:43], a[148:151], v[16:19], v[40:43]
  v_mfma_f32_16x16x32_bf16 v[44:47], v[172:175], v[12:15], v[44:47]
  v_mfma_f32_16x16x32_bf16 v[48:51], v[172:175], v[16:19], v[48:51]
L_F2_epi:
  s_nop 4
  v_cvt_pk_bf16_f32 v52, v36, v37
  v_cvt_pk_bf16_f32 v53, v38, v39
  v_cvt_pk_bf16_f32 v54, v44, v45
  v_cvt_pk_bf16_f32 v55, v46, v47
  buffer_store_dwordx4 v[52:55], v68, s[4:7], s31 offen offset:0 sc1
  v_cvt_pk_bf16_f32 v56, v40, v41
  v_cvt_pk_bf16_f32 v57, v42, v43
  v_cvt_pk_bf16_f32 v58, v48, v49
  v_cvt_pk_bf16_f32 v59, v50, v51
  buffer_store_dwordx4 v[56:59], v68, s[4:7], s31 offen offset:1024 sc1
  s_add_u32 s25, s25, 1
  s_add_u32 s31, s31, 196608
  s_branch L_F2_top
L_WOF:
  s_load_dwordx2 s[8:9], s[0:1], 40
  s_mov_b32 s10, 8388608
  s_mov_b32 s11, 0x20000
  s_waitcnt lgkmcnt(0)
  v_bfe_u32 v1, v0, 5, 1
  v_mul_u32_u24 v1, 131072, v1
  v_bfe_u32 v2, v0, 4, 1
  v_mul_u32_u24 v2, 8192, v2
  v_add_u32 v1, v1, v2
  v_bfe_u32 v2, v0, 3, 1
  v_mul_u32_u24 v2, 2048, v2
  v_add_u32 v1, v1, v2
  v_lshrrev_b32 v2, 3, v0
  v_and_b32 v2, 6, v2
  v_xor_b32 v2, v2, v0
  v_and_b32 v2, 7, v2
  v_lshl_add_u32 v1, v2, 4, v1
  v_bfe_u32 v2, v0, 3, 2
  v_xor_b32 v2, 0, v2
  v_lshlrev_b32 v2, 5, v2
  v_lshrrev_b32 v4, 2, v0
  v_lshl_add_u32 v4, v4, 7, v2
  v_and_b32 v2, 3, v0
  v_lshl_add_u32 v4, v2, 3, v4
  s_and_b32 s43, s21, 3
  s_lshl_b32 s43, s43, 2
  s_add_u32 s43, s43, s20
  s_lshr_b32 s44, s21, 2
  s_lshl_b32 s40, s43, 19
  s_lshl_b32 s41, s44, 7
  s_add_u32 s40, s40, s41
  v_add_u32 v1, s40, v1
  s_lshl_b32 s41, s20, 15
  v_add_u32 v4, s41, v4
  s_lshl_b32 s40, s44, 19
  s_lshl_b32 s45, s43, 14
  s_add_u32 s40, s40, s45
  v_lshl_add_u32 v3, v0, 4, s40
  v_xor_b32 v5, 32, v4
  v_xor_b32 v6, 64, v4
  v_xor_b32 v7, 96, v4
  s_add_u32 m0, s41, 0
  s_mov_b32 s42, 0
  buffer_load_dwordx4 v1, s[8:11], s42 offen nt lds
  s_add_u32 m0, s41, 1024
  s_mov_b32 s42, 16384
  buffer_load_dwordx4 v1, s[8:11], s42 offen nt lds
  s_add_u32 m0, s41, 2048
  s_mov_b32 s42, 4096
  buffer_load_dwordx4 v1, s[8:11], s42 offen nt lds
  s_add_u32 m0, s41, 3072
  s_mov_b32 s42, 20480
  buffer_load_dwordx4 v1, s[8:11], s42 offen nt lds
  s_add_u32 m0, s41, 4096
  s_mov_b32 s42, 32768
  buffer_load_dwordx4 v1, s[8:11], s42 offen nt lds
  s_add_u32 m0, s41, 5120
  s_mov_b32 s42, 49152
  buffer_load_dwordx4 v1, s[8:11], s42 offen nt lds
  s_add_u32 m0, s41, 6144
  s_mov_b32 s42, 36864
  buffer_load_dwordx4 v1, s[8:11], s42 offen nt lds
  s_add_u32 m0, s41, 7168
  s_mov_b32 s42, 53248
  buffer_load_dwordx4 v1, s[8:11], s42 offen nt lds
  s_add_u32 m0, s41, 8192
  s_mov_b32 s42, 65536
  buffer_load_dwordx4 v1, s[8:11], s42 offen nt lds
  s_add_u32 m0, s41, 9216
  s_mov_b32 s42, 81920
  buffer_load_dwordx4 v1, s[8:11], s42 offen nt lds
  s_add_u32 m0, s41, 10240
  s_mov_b32 s42, 69632
  buffer_load_dwordx4 v1, s[8:11], s42 offen nt lds
  s_add_u32 m0, s41, 11264
  s_mov_b32 s42, 86016
  buffer_load_dwordx4 v1, s[8:11], s42 offen nt lds
  s_add_u32 m0, s41, 12288
  s_mov_b32 s42, 98304
  buffer_load_dwordx4 v1, s[8:11], s42 offen nt lds
  s_add_u32 m0, s41, 13312
  s_mov_b32 s42, 114688
  buffer_load_dwordx4 v1, s[8:11], s42 offen nt lds
  s_add_u32 m0, s41, 14336
  s_mov_b32 s42, 102400
  buffer_load_dwordx4 v1, s[8:11], s42 offen nt lds
  s_add_u32 m0, s41, 15360
  s_mov_b32 s42, 118784
  buffer_load_dwordx4 v1, s[8:11], s42 offen nt lds
  s_add_u32 m0, s41, 16384
  s_mov_b32 s42, 262144
  buffer_load_dwordx4 v1, s[8:11], s42 offen nt lds
  s_add_u32 m0, s41, 17408
  s_mov_b32 s42, 278528
  buffer_load_dwordx4 v1, s[8:11], s42 offen nt lds
  s_add_u32 m0, s41, 18432
  s_mov_b32 s42, 266240
  buffer_load_dwordx4 v1, s[8:11], s42 offen nt lds
  s_add_u32 m0, s41, 19456
  s_mov_b32 s42, 282624
  buffer_load_dwordx4 v1, s[8:11], s42 offen nt lds
  s_add_u32 m0, s41, 20480
  s_mov_b32 s42, 294912
  buffer_load_dwordx4 v1, s[8:11], s42 offen nt lds
  s_add_u32 m0, s41, 21504
  s_mov_b32 s42, 311296
  buffer_load_dwordx4 v1, s[8:11], s42 offen nt lds
  s_add_u32 m0, s41, 22528
  s_mov_b32 s42, 299008
  buffer_load_dwordx4 v1, s[8:11], s42 offen nt lds
  s_add_u32 m0, s41, 23552
  s_mov_b32 s42, 315392
  buffer_load_dwordx4 v1, s[8:11], s42 offen nt lds
  s_add_u32 m0, s41, 24576
  s_mov_b32 s42, 327680
  buffer_load_dwordx4 v1, s[8:11], s42 offen nt lds
  s_add_u32 m0, s41, 25600
  s_mov_b32 s42, 344064
  buffer_load_dwordx4 v1, s[8:11], s42 offen nt lds
  s_add_u32 m0, s41, 26624
  s_mov_b32 s42, 331776
  buffer_load_dwordx4 v1, s[8:11], s42 offen nt lds
  s_add_u32 m0, s41, 27648
  s_mov_b32 s42, 348160
  buffer_load_dwordx4 v1, s[8:11], s42 offen nt lds
  s_add_u32 m0, s41, 28672
  s_mov_b32 s42, 360448
  buffer_load_dwordx4 v1, s[8:11], s42 offen nt lds
  s_add_u32 m0, s41, 29696
  s_mov_b32 s42, 376832
  buffer_load_dwordx4 v1, s[8:11], s42 offen nt lds
  s_add_u32 m0, s41, 30720
  s_mov_b32 s42, 364544
  buffer_load_dwordx4 v1, s[8:11], s42 offen nt lds
  s_add_u32 m0, s41, 31744
  s_mov_b32 s42, 380928
  buffer_load_dwordx4 v1, s[8:11], s42 offen nt lds
  s_waitcnt vmcnt(24)
  ds_read_b64_tr_b16 v[8:9], v4 offset:0
  ds_read_b64_tr_b16 v[10:11], v4 offset:2048
  ds_read_b64_tr_b16 v[12:13], v4 offset:4096
  ds_read_b64_tr_b16 v[14:15], v4 offset:6144
  ds_read_b64_tr_b16 v[16:17], v5 offset:0
  ds_read_b64_tr_b16 v[18:19], v5 offset:2048
  ds_read_b64_tr_b16 v[20:21], v5 offset:4096
  ds_read_b64_tr_b16 v[22:23], v5 offset:6144
  ds_read_b64_tr_b16 v[24:25], v6 offset:0
  ds_read_b64_tr_b16 v[26:27], v6 offset:2048
  ds_read_b64_tr_b16 v[28:29], v6 offset:4096
  ds_read_b64_tr_b16 v[30:31], v6 offset:6144
  ds_read_b64_tr_b16 v[32:33], v7 offset:0
  ds_read_b64_tr_b16 v[34:35], v7 offset:2048
  ds_read_b64_tr_b16 v[36:37], v7 offset:4096
  ds_read_b64_tr_b16 v[38:39], v7 offset:6144
  s_mov_b32 s42, 14680064
  s_waitcnt lgkmcnt(12)
  buffer_store_dwordx4 v[8:11], v3, s[4:7], s42 offen offset:0 sc1
  buffer_store_dwordx4 v[12:15], v3, s[4:7], s42 offen offset:1024 sc1
  s_mov_b32 s42, 14680064
  s_waitcnt lgkmcnt(8)
  buffer_store_dwordx4 v[16:19], v3, s[4:7], s42 offen offset:2048 sc1
  buffer_store_dwordx4 v[20:23], v3, s[4:7], s42 offen offset:3072 sc1
  s_mov_b32 s42, 14942208
  s_waitcnt lgkmcnt(4)
  buffer_store_dwordx4 v[24:27], v3, s[4:7], s42 offen offset:0 sc1
  buffer_store_dwordx4 v[28:31], v3, s[4:7], s42 offen offset:1024 sc1
  s_mov_b32 s42, 14942208
  s_waitcnt lgkmcnt(0)
  buffer_store_dwordx4 v[32:35], v3, s[4:7], s42 offen offset:2048 sc1
  buffer_store_dwordx4 v[36:39], v3, s[4:7], s42 offen offset:3072 sc1
  s_waitcnt vmcnt(24)
  ds_read_b64_tr_b16 v[40:41], v4 offset:8192
  ds_read_b64_tr_b16 v[42:43], v4 offset:10240
  ds_read_b64_tr_b16 v[44:45], v4 offset:12288
  ds_read_b64_tr_b16 v[46:47], v4 offset:14336
  ds_read_b64_tr_b16 v[48:49], v5 offset:8192
  ds_read_b64_tr_b16 v[50:51], v5 offset:10240
  ds_read_b64_tr_b16 v[52:53], v5 offset:12288
  ds_read_b64_tr_b16 v[54:55], v5 offset:14336
  ds_read_b64_tr_b16 v[56:57], v6 offset:8192
  ds_read_b64_tr_b16 v[58:59], v6 offset:10240
  ds_read_b64_tr_b16 v[60:61], v6 offset:12288
  ds_read_b64_tr_b16 v[62:63], v6 offset:14336
  ds_read_b64_tr_b16 v[64:65], v7 offset:8192
  ds_read_b64_tr_b16 v[66:67], v7 offset:10240
  ds_read_b64_tr_b16 v[68:69], v7 offset:12288
  ds_read_b64_tr_b16 v[70:71], v7 offset:14336
  s_mov_b32 s42, 14684160
  s_waitcnt lgkmcnt(12)
  buffer_store_dwordx4 v[40:43], v3, s[4:7], s42 offen offset:0 sc1
  buffer_store_dwordx4 v[44:47], v3, s[4:7], s42 offen offset:1024 sc1
  s_mov_b32 s42, 14684160
  s_waitcnt lgkmcnt(8)
  buffer_store_dwordx4 v[48:51], v3, s[4:7], s42 offen offset:2048 sc1
  buffer_store_dwordx4 v[52:55], v3, s[4:7], s42 offen offset:3072 sc1
  s_mov_b32 s42, 14946304
  s_waitcnt lgkmcnt(4)
  buffer_store_dwordx4 v[56:59], v3, s[4:7], s42 offen offset:0 sc1
  buffer_store_dwordx4 v[60:63], v3, s[4:7], s42 offen offset:1024 sc1
  s_mov_b32 s42, 14946304
  s_waitcnt lgkmcnt(0)
  buffer_store_dwordx4 v[64:67], v3, s[4:7], s42 offen offset:2048 sc1
  buffer_store_dwordx4 v[68:71], v3, s[4:7], s42 offen offset:3072 sc1
  s_waitcnt vmcnt(24)
  ds_read_b64_tr_b16 v[72:73], v4 offset:16384
  ds_read_b64_tr_b16 v[74:75], v4 offset:18432
  ds_read_b64_tr_b16 v[76:77], v4 offset:20480
  ds_read_b64_tr_b16 v[78:79], v4 offset:22528
  ds_read_b64_tr_b16 v[80:81], v5 offset:16384
  ds_read_b64_tr_b16 v[82:83], v5 offset:18432
  ds_read_b64_tr_b16 v[84:85], v5 offset:20480
  ds_read_b64_tr_b16 v[86:87], v5 offset:22528
  ds_read_b64_tr_b16 v[88:89], v6 offset:16384
  ds_read_b64_tr_b16 v[90:91], v6 offset:18432
  ds_read_b64_tr_b16 v[92:93], v6 offset:20480
  ds_read_b64_tr_b16 v[94:95], v6 offset:22528
  ds_read_b64_tr_b16 v[96:97], v7 offset:16384
  ds_read_b64_tr_b16 v[98:99], v7 offset:18432
  ds_read_b64_tr_b16 v[100:101], v7 offset:20480
  ds_read_b64_tr_b16 v[102:103], v7 offset:22528
  s_mov_b32 s42, 14688256
  s_waitcnt lgkmcnt(12)
  buffer_store_dwordx4 v[72:75], v3, s[4:7], s42 offen offset:0 sc1
  buffer_store_dwordx4 v[76:79], v3, s[4:7], s42 offen offset:1024 sc1
  s_mov_b32 s42, 14688256
  s_waitcnt lgkmcnt(8)
  buffer_store_dwordx4 v[80:83], v3, s[4:7], s42 offen offset:2048 sc1
  buffer_store_dwordx4 v[84:87], v3, s[4:7], s42 offen offset:3072 sc1
  s_mov_b32 s42, 14950400
  s_waitcnt lgkmcnt(4)
  buffer_store_dwordx4 v[88:91], v3, s[4:7], s42 offen offset:0 sc1
  buffer_store_dwordx4 v[92:95], v3, s[4:7], s42 offen offset:1024 sc1
  s_mov_b32 s42, 14950400
  s_waitcnt lgkmcnt(0)
  buffer_store_dwordx4 v[96:99], v3, s[4:7], s42 offen offset:2048 sc1
  buffer_store_dwordx4 v[100:103], v3, s[4:7], s42 offen offset:3072 sc1
  s_waitcnt vmcnt(24)
  ds_read_b64_tr_b16 v[104:105], v4 offset:24576
  ds_read_b64_tr_b16 v[106:107], v4 offset:26624
  ds_read_b64_tr_b16 v[108:109], v4 offset:28672
  ds_read_b64_tr_b16 v[110:111], v4 offset:30720
  ds_read_b64_tr_b16 v[112:113], v5 offset:24576
  ds_read_b64_tr_b16 v[114:115], v5 offset:26624
  ds_read_b64_tr_b16 v[116:117], v5 offset:28672
  ds_read_b64_tr_b16 v[118:119], v5 offset:30720
  ds_read_b64_tr_b16 v[120:121], v6 offset:24576
  ds_read_b64_tr_b16 v[122:123], v6 offset:26624
  ds_read_b64_tr_b16 v[124:125], v6 offset:28672
  ds_read_b64_tr_b16 v[126:127], v6 offset:30720
  ds_read_b64_tr_b16 v[128:129], v7 offset:24576
  ds_read_b64_tr_b16 v[130:131], v7 offset:26624
  ds_read_b64_tr_b16 v[132:133], v7 offset:28672
  ds_read_b64_tr_b16 v[134:135], v7 offset:30720
  s_mov_b32 s42, 14692352
  s_waitcnt lgkmcnt(12)
  buffer_store_dwordx4 v[104:107], v3, s[4:7], s42 offen offset:0 sc1
  buffer_store_dwordx4 v[108:111], v3, s[4:7], s42 offen offset:1024 sc1
  s_mov_b32 s42, 14692352
  s_waitcnt lgkmcnt(8)
  buffer_store_dwordx4 v[112:115], v3, s[4:7], s42 offen offset:2048 sc1
  buffer_store_dwordx4 v[116:119], v3, s[4:7], s42 offen offset:3072 sc1
  s_mov_b32 s42, 14954496
  s_waitcnt lgkmcnt(4)
  buffer_store_dwordx4 v[120:123], v3, s[4:7], s42 offen offset:0 sc1
  buffer_store_dwordx4 v[124:127], v3, s[4:7], s42 offen offset:1024 sc1
  s_mov_b32 s42, 14954496
  s_waitcnt lgkmcnt(0)
  buffer_store_dwordx4 v[128:131], v3, s[4:7], s42 offen offset:2048 sc1
  buffer_store_dwordx4 v[132:135], v3, s[4:7], s42 offen offset:3072 sc1
  v_min_u32 v1, 31, v0
  v_lshlrev_b32 v1, 2, v1
  v_add_u32 v1, 128, v1
  s_nop 1
Lpoll_36:
  buffer_load_dword v2, v1, s[12:15], 0 offen sc1
  s_sub_u32 s24, s24, 1
  s_cbranch_scc1 L_FAIL
  s_waitcnt vmcnt(0)
  v_cmp_gt_i32 vcc, 1, v2
  s_cbranch_vccz Lpolld_37
  s_sleep 2
  s_branch Lpoll_36
Lpolld_37:
  s_barrier
  s_lshl_b32 s40, s21, 7
  s_add_u32 s40, s40, 1432576
  s_cmp_lg_u32 s20, 0
  s_cbranch_scc1 Lnosig_38
  s_mov_b32 s63, 1
  s_atomic_smax s63, s[4:5], s40 glc
Lnosig_38:
  s_branch L_LN1
L_QK:
  v_bfe_u32 v76, v0, 3, 2
  v_xor_b32 v76, s20, v76
  v_lshlrev_b32 v76, 5, v76
  v_lshrrev_b32 v4, 2, v0
  v_lshl_add_u32 v4, v4, 7, v76
  v_and_b32 v76, 3, v0
  v_lshl_add_u32 v4, v76, 3, v4
  s_lshl_b32 s40, s20, 15
  v_add_u32 v4, s40, v4
  v_lshl_add_u32 v85, v0, 4, s40
  s_lshl_b32 s40, s20, 12
  s_add_u32 s40, s40, 131072
  v_lshl_add_u32 v1, v0, 4, s40
  s_lshr_b32 s54, s21, 4
  s_lshl_b32 s52, s54, 22
  s_sub_u32 s53, 0, s52
  v_xor_b32 v5, 32768, v4
  v_xor_b32 v2, 4096, v1
  v_xor_b32 v6, 65536, v4
  v_xor_b32 v3, 8192, v1
  v_xor_b32 v7, 98304, v4
  v_xor_b32 v84, 12288, v1
  v_bfe_u32 v8, v0, 5, 1
  v_mul_u32_u24 v8, 16384, v8
  v_bfe_u32 v76, v0, 4, 1
  v_mul_u32_u24 v76, 32768, v76
  v_add_u32 v8, v8, v76
  v_bfe_u32 v76, v0, 3, 1
  v_mul_u32_u24 v76, 131072, v76
  v_add_u32 v8, v8, v76
  v_lshrrev_b32 v76, 3, v0
  v_and_b32 v76, 6, v76
  v_xor_b32 v76, v76, v0
  v_and_b32 v76, 7, v76
  v_lshl_add_u32 v8, v76, 4, v8
  s_lshl_b32 s40, s20, 19
  v_add_u32 v8, s40, v8
  s_lshl_b32 s44, s21, 8
  s_add_u32 s45, s44, 128
  s_load_dwordx2 s[8:9], s[0:1], 16
  s_mov_b32 s10, 8388608
  s_mov_b32 s11, 0x20000
  s_waitcnt lgkmcnt(0)
  v_add_u32 v9, s44, v8
  v_add_u32 v10, s45, v8
  v_add_u32 v11, s44, v8
  v_add_u32 v12, s45, v8
  s_lshl_b32 s41, s20, 15
  s_add_u32 m0, s41, 0
  s_add_u32 s42, s52, 0
  buffer_load_dwordx4 v9, s[8:11], s42 offen lds
  s_add_u32 m0, s41, 1024
  s_add_u32 s42, s52, 65536
  buffer_load_dwordx4 v9, s[8:11], s42 offen lds
  s_add_u32 m0, s41, 2048
  s_add_u32 s42, s52, 8192
  buffer_load_dwordx4 v9, s[8:11], s42 offen lds
  s_add_u32 m0, s41, 3072
  s_add_u32 s42, s52, 73728
  buffer_load_dwordx4 v9, s[8:11], s42 offen lds
  s_add_u32 m0, s41, 4096
  s_add_u32 s42, s52, 262144
  buffer_load_dwordx4 v9, s[8:11], s42 offen lds
  s_add_u32 m0, s41, 5120
  s_add_u32 s42, s52, 327680
  buffer_load_dwordx4 v9, s[8:11], s42 offen lds
  s_add_u32 m0, s41, 6144
  s_add_u32 s42, s52, 270336
  buffer_load_dwordx4 v9, s[8:11], s42 offen lds
  s_add_u32 m0, s41, 7168
  s_add_u32 s42, s52, 335872
  buffer_load_dwordx4 v9, s[8:11], s42 offen lds
  s_add_u32 m0, s41, 8192
  s_add_u32 s42, s52, 2097152
  buffer_load_dwordx4 v9, s[8:11], s42 offen lds
  s_add_u32 m0, s41, 9216
  s_add_u32 s42, s52, 2162688
  buffer_load_dwordx4 v9, s[8:11], s42 offen lds
  s_add_u32 m0, s41, 10240
  s_add_u32 s42, s52, 2105344
  buffer_load_dwordx4 v9, s[8:11], s42 offen lds
  s_add_u32 m0, s41, 11264
  s_add_u32 s42, s52, 2170880
  buffer_load_dwordx4 v9, s[8:11], s42 offen lds
  s_add_u32 m0, s41, 12288
  s_add_u32 s42, s52, 2359296
  buffer_load_dwordx4 v9, s[8:11], s42 offen lds
  s_add_u32 m0, s41, 13312
  s_add_u32 s42, s52, 2424832
  buffer_load_dwordx4 v9, s[8:11], s42 offen lds
  s_add_u32 m0, s41, 14336
  s_add_u32 s42, s52, 2367488
  buffer_load_dwordx4 v9, s[8:11], s42 offen lds
  s_add_u32 m0, s41, 15360
  s_add_u32 s42, s52, 2433024
  buffer_load_dwordx4 v9, s[8:11], s42 offen lds
  s_add_u32 m0, s41, 16384
  s_add_u32 s42, s53, 4194304
  buffer_load_dwordx4 v9, s[8:11], s42 offen lds
  s_add_u32 m0, s41, 17408
  s_add_u32 s42, s53, 4259840
  buffer_load_dwordx4 v9, s[8:11], s42 offen lds
  s_add_u32 m0, s41, 18432
  s_add_u32 s42, s53, 4202496
  buffer_load_dwordx4 v9, s[8:11], s42 offen lds
  s_add_u32 m0, s41, 19456
  s_add_u32 s42, s53, 4268032
  buffer_load_dwordx4 v9, s[8:11], s42 offen lds
  s_add_u32 m0, s41, 20480
  s_add_u32 s42, s53, 4456448
  buffer_load_dwordx4 v9, s[8:11], s42 offen lds
  s_add_u32 m0, s41, 21504
  s_add_u32 s42, s53, 4521984
  buffer_load_dwordx4 v9, s[8:11], s42 offen lds
  s_add_u32 m0, s41, 22528
  s_add_u32 s42, s53, 4464640
  buffer_load_dwordx4 v9, s[8:11], s42 offen lds
  s_add_u32 m0, s41, 23552
  s_add_u32 s42, s53, 4530176
  buffer_load_dwordx4 v9, s[8:11], s42 offen lds
  s_waitcnt vmcnt(16) lgkmcnt(0)
  s_barrier
  s_add_u32 m0, s41, 24576
  s_add_u32 s42, s53, 6291456
  buffer_load_dwordx4 v9, s[8:11], s42 offen lds
  s_add_u32 m0, s41, 25600
  s_add_u32 s42, s53, 6356992
  buffer_load_dwordx4 v9, s[8:11], s42 offen lds
  s_add_u32 m0, s41, 26624
  s_add_u32 s42, s53, 6299648
  buffer_load_dwordx4 v9, s[8:11], s42 offen lds
  s_add_u32 m0, s41, 27648
  s_add_u32 s42, s53, 6365184
  buffer_load_dwordx4 v9, s[8:11], s42 offen lds
  s_add_u32 m0, s41, 28672
  s_add_u32 s42, s53, 6553600
  buffer_load_dwordx4 v9, s[8:11], s42 offen lds
  s_add_u32 m0, s41, 29696
  s_add_u32 s42, s53, 6619136
  buffer_load_dwordx4 v9, s[8:11], s42 offen lds
  s_add_u32 m0, s41, 30720
  s_add_u32 s42, s53, 6561792
  buffer_load_dwordx4 v9, s[8:11], s42 offen lds
  s_add_u32 m0, s41, 31744
  s_add_u32 s42, s53, 6627328
  buffer_load_dwordx4 v9, s[8:11], s42 offen lds
  ds_read_b64_tr_b16 a[0:1], v4 offset:0
  ds_read_b64_tr_b16 a[2:3], v4 offset:2048
  ds_read_b64_tr_b16 a[4:5], v4 offset:4096
  ds_read_b64_tr_b16 a[6:7], v4 offset:6144
  ds_read_b64_tr_b16 a[16:17], v5 offset:0
  ds_read_b64_tr_b16 a[18:19], v5 offset:2048
  ds_read_b64_tr_b16 a[20:21], v5 offset:4096
  ds_read_b64_tr_b16 a[22:23], v5 offset:6144
  ds_read_b64_tr_b16 a[32:33], v6 offset:0
  ds_read_b64_tr_b16 a[34:35], v6 offset:2048
  ds_read_b64_tr_b16 a[36:37], v6 offset:4096
  ds_read_b64_tr_b16 a[38:39], v6 offset:6144
  ds_read_b64_tr_b16 a[48:49], v7 offset:0
  ds_read_b64_tr_b16 a[50:51], v7 offset:2048
  ds_read_b64_tr_b16 a[52:53], v7 offset:4096
  ds_read_b64_tr_b16 a[54:55], v7 offset:6144
  s_waitcnt vmcnt(16) lgkmcnt(0)
  s_barrier
  s_add_u32 m0, s41, 0
  s_add_u32 s42, s52, 0
  buffer_load_dwordx4 v10, s[8:11], s42 offen lds
  s_add_u32 m0, s41, 1024
  s_add_u32 s42, s52, 65536
  buffer_load_dwordx4 v10, s[8:11], s42 offen lds
  s_add_u32 m0, s41, 2048
  s_add_u32 s42, s52, 8192
  buffer_load_dwordx4 v10, s[8:11], s42 offen lds
  s_add_u32 m0, s41, 3072
  s_add_u32 s42, s52, 73728
  buffer_load_dwordx4 v10, s[8:11], s42 offen lds
  s_add_u32 m0, s41, 4096
  s_add_u32 s42, s52, 262144
  buffer_load_dwordx4 v10, s[8:11], s42 offen lds
  s_add_u32 m0, s41, 5120
  s_add_u32 s42, s52, 327680
  buffer_load_dwordx4 v10, s[8:11], s42 offen lds
  s_add_u32 m0, s41, 6144
  s_add_u32 s42, s52, 270336
  buffer_load_dwordx4 v10, s[8:11], s42 offen lds
  s_add_u32 m0, s41, 7168
  s_add_u32 s42, s52, 335872
  buffer_load_dwordx4 v10, s[8:11], s42 offen lds
  ds_read_b64_tr_b16 a[8:9], v4 offset:8192
  ds_read_b64_tr_b16 a[10:11], v4 offset:10240
  ds_read_b64_tr_b16 a[12:13], v4 offset:12288
  ds_read_b64_tr_b16 a[14:15], v4 offset:14336
  ds_read_b64_tr_b16 a[24:25], v5 offset:8192
  ds_read_b64_tr_b16 a[26:27], v5 offset:10240
  ds_read_b64_tr_b16 a[28:29], v5 offset:12288
  ds_read_b64_tr_b16 a[30:31], v5 offset:14336
  ds_read_b64_tr_b16 a[40:41], v6 offset:8192
  ds_read_b64_tr_b16 a[42:43], v6 offset:10240
  ds_read_b64_tr_b16 a[44:45], v6 offset:12288
  ds_read_b64_tr_b16 a[46:47], v6 offset:14336
  ds_read_b64_tr_b16 a[56:57], v7 offset:8192
  ds_read_b64_tr_b16 a[58:59], v7 offset:10240
  ds_read_b64_tr_b16 a[60:61], v7 offset:12288
  ds_read_b64_tr_b16 a[62:63], v7 offset:14336
  s_waitcnt vmcnt(16) lgkmcnt(0)
  s_barrier
  s_add_u32 m0, s41, 8192
  s_add_u32 s42, s52, 2097152
  buffer_load_dwordx4 v10, s[8:11], s42 offen lds
  s_add_u32 m0, s41, 9216
  s_add_u32 s42, s52, 2162688
  buffer_load_dwordx4 v10, s[8:11], s42 offen lds
  s_add_u32 m0, s41, 10240
  s_add_u32 s42, s52, 2105344
  buffer_load_dwordx4 v10, s[8:11], s42 offen lds
  s_add_u32 m0, s41, 11264
  s_add_u32 s42, s52, 2170880
  buffer_load_dwordx4 v10, s[8:11], s42 offen lds
  s_add_u32 m0, s41, 12288
  s_add_u32 s42, s52, 2359296
  buffer_load_dwordx4 v10, s[8:11], s42 offen lds
  s_add_u32 m0, s41, 13312
  s_add_u32 s42, s52, 2424832
  buffer_load_dwordx4 v10, s[8:11], s42 offen lds
  s_add_u32 m0, s41, 14336
  s_add_u32 s42, s52, 2367488
  buffer_load_dwordx4 v10, s[8:11], s42 offen lds
  s_add_u32 m0, s41, 15360
  s_add_u32 s42, s52, 2433024
  buffer_load_dwordx4 v10, s[8:11], s42 offen lds
  ds_read_b64_tr_b16 a[64:65], v4 offset:16384
  ds_read_b64_tr_b16 a[66:67], v4 offset:18432
  ds_read_b64_tr_b16 a[68:69], v4 offset:20480
  ds_read_b64_tr_b16 a[70:71], v4 offset:22528
  ds_read_b64_tr_b16 a[80:81], v5 offset:16384
  ds_read_b64_tr_b16 a[82:83], v5 offset:18432
  ds_read_b64_tr_b16 a[84:85], v5 offset:20480
  ds_read_b64_tr_b16 a[86:87], v5 offset:22528
  ds_read_b64_tr_b16 a[96:97], v6 offset:16384
  ds_read_b64_tr_b16 a[98:99], v6 offset:18432
  ds_read_b64_tr_b16 a[100:101], v6 offset:20480
  ds_read_b64_tr_b16 a[102:103], v6 offset:22528
  ds_read_b64_tr_b16 a[112:113], v7 offset:16384
  ds_read_b64_tr_b16 a[114:115], v7 offset:18432
  ds_read_b64_tr_b16 a[116:117], v7 offset:20480
  ds_read_b64_tr_b16 a[118:119], v7 offset:22528
  s_waitcnt vmcnt(16) lgkmcnt(0)
  s_barrier
  s_add_u32 m0, s41, 16384
  s_add_u32 s42, s53, 4194304
  buffer_load_dwordx4 v10, s[8:11], s42 offen lds
  s_add_u32 m0, s41, 17408
  s_add_u32 s42, s53, 4259840
  buffer_load_dwordx4 v10, s[8:11], s42 offen lds
  s_add_u32 m0, s41, 18432
  s_add_u32 s42, s53, 4202496
  buffer_load_dwordx4 v10, s[8:11], s42 offen lds
  s_add_u32 m0, s41, 19456
  s_add_u32 s42, s53, 4268032
  buffer_load_dwordx4 v10, s[8:11], s42 offen lds
  s_add_u32 m0, s41, 20480
  s_add_u32 s42, s53, 4456448
  buffer_load_dwordx4 v10, s[8:11], s42 offen lds
  s_add_u32 m0, s41, 21504
  s_add_u32 s42, s53, 4521984
  buffer_load_dwordx4 v10, s[8:11], s42 offen lds
  s_add_u32 m0, s41, 22528
  s_add_u32 s42, s53, 4464640
  buffer_load_dwordx4 v10, s[8:11], s42 offen lds
  s_add_u32 m0, s41, 23552
  s_add_u32 s42, s53, 4530176
  buffer_load_dwordx4 v10, s[8:11], s42 offen lds
  ds_read_b64_tr_b16 a[72:73], v4 offset:24576
  ds_read_b64_tr_b16 a[74:75], v4 offset:26624
  ds_read_b64_tr_b16 a[76:77], v4 offset:28672
  ds_read_b64_tr_b16 a[78:79], v4 offset:30720
  ds_read_b64_tr_b16 a[88:89], v5 offset:24576
  ds_read_b64_tr_b16 a[90:91], v5 offset:26624
  ds_read_b64_tr_b16 a[92:93], v5 offset:28672
  ds_read_b64_tr_b16 a[94:95], v5 offset:30720
  ds_read_b64_tr_b16 a[104:105], v6 offset:24576
  ds_read_b64_tr_b16 a[106:107], v6 offset:26624
  ds_read_b64_tr_b16 a[108:109], v6 offset:28672
  ds_read_b64_tr_b16 a[110:111], v6 offset:30720
  ds_read_b64_tr_b16 a[120:121], v7 offset:24576
  ds_read_b64_tr_b16 a[122:123], v7 offset:26624
  ds_read_b64_tr_b16 a[124:125], v7 offset:28672
  ds_read_b64_tr_b16 a[126:127], v7 offset:30720
  s_waitcnt vmcnt(16) lgkmcnt(0)
  s_barrier
  s_add_u32 m0, s41, 24576
  s_add_u32 s42, s53, 6291456
  buffer_load_dwordx4 v10, s[8:11], s42 offen lds
  s_add_u32 m0, s41, 25600
  s_add_u32 s42, s53, 6356992
  buffer_load_dwordx4 v10, s[8:11], s42 offen lds
  s_add_u32 m0, s41, 26624
  s_add_u32 s42, s53, 6299648
  buffer_load_dwordx4 v10, s[8:11], s42 offen lds
  s_add_u32 m0, s41, 27648
  s_add_u32 s42, s53, 6365184
  buffer_load_dwordx4 v10, s[8:11], s42 offen lds
  s_add_u32 m0, s41, 28672
  s_add_u32 s42, s53, 6553600
  buffer_load_dwordx4 v10, s[8:11], s42 offen lds
  s_add_u32 m0, s41, 29696
  s_add_u32 s42, s53, 6619136
  buffer_load_dwordx4 v10, s[8:11], s42 offen lds
  s_add_u32 m0, s41, 30720
  s_add_u32 s42, s53, 6561792
  buffer_load_dwordx4 v10, s[8:11], s42 offen lds
  s_add_u32 m0, s41, 31744
  s_add_u32 s42, s53, 6627328
  buffer_load_dwordx4 v10, s[8:11], s42 offen lds
  ds_read_b64_tr_b16 a[128:129], v4 offset:0
  ds_read_b64_tr_b16 a[130:131], v4 offset:2048
  ds_read_b64_tr_b16 a[132:133], v4 offset:4096
  ds_read_b64_tr_b16 a[134:135], v4 offset:6144
  ds_read_b64_tr_b16 a[144:145], v5 offset:0
  ds_read_b64_tr_b16 a[146:147], v5 offset:2048
  ds_read_b64_tr_b16 a[148:149], v5 offset:4096
  ds_read_b64_tr_b16 a[150:151], v5 offset:6144
  ds_read_b64_tr_b16 a[160:161], v6 offset:0
  ds_read_b64_tr_b16 a[162:163], v6 offset:2048
  ds_read_b64_tr_b16 a[164:165], v6 offset:4096
  ds_read_b64_tr_b16 a[166:167], v6 offset:6144
  ds_read_b64_tr_b16 a[176:177], v7 offset:0
  ds_read_b64_tr_b16 a[178:179], v7 offset:2048
  ds_read_b64_tr_b16 a[180:181], v7 offset:4096
  ds_read_b64_tr_b16 a[182:183], v7 offset:6144
  s_waitcnt vmcnt(16) lgkmcnt(0)
  s_barrier
  s_load_dwordx2 s[8:9], s[0:1], 24
  s_mov_b32 s10, 8388608
  s_mov_b32 s11, 0x20000
  s_waitcnt lgkmcnt(0)
  s_add_u32 m0, s41, 0
  s_add_u32 s42, s52, 0
  buffer_load_dwordx4 v11, s[8:11], s42 offen lds
  s_add_u32 m0, s41, 1024
  s_add_u32 s42, s52, 65536
  buffer_load_dwordx4 v11, s[8:11], s42 offen lds
  s_add_u32 m0, s41, 2048
  s_add_u32 s42, s52, 8192
  buffer_load_dwordx4 v11, s[8:11], s42 offen lds
  s_add_u32 m0, s41, 3072
  s_add_u32 s42, s52, 73728
  buffer_load_dwordx4 v11, s[8:11], s42 offen lds
  s_add_u32 m0, s41, 4096
  s_add_u32 s42, s52, 262144
  buffer_load_dwordx4 v11, s[8:11], s42 offen lds
  s_add_u32 m0, s41, 5120
  s_add_u32 s42, s52, 327680
  buffer_load_dwordx4 v11, s[8:11], s42 offen lds
  s_add_u32 m0, s41, 6144
  s_add_u32 s42, s52, 270336
  buffer_load_dwordx4 v11, s[8:11], s42 offen lds
  s_add_u32 m0, s41, 7168
  s_add_u32 s42, s52, 335872
  buffer_load_dwordx4 v11, s[8:11], s42 offen lds
  ds_read_b64_tr_b16 a[136:137], v4 offset:8192
  ds_read_b64_tr_b16 a[138:139], v4 offset:10240
  ds_read_b64_tr_b16 a[140:141], v4 offset:12288
  ds_read_b64_tr_b16 a[142:143], v4 offset:14336
  ds_read_b64_tr_b16 a[152:153], v5 offset:8192
  ds_read_b64_tr_b16 a[154:155], v5 offset:10240
  ds_read_b64_tr_b16 a[156:157], v5 offset:12288
  ds_read_b64_tr_b16 a[158:159], v5 offset:14336
  ds_read_b64_tr_b16 a[168:169], v6 offset:8192
  ds_read_b64_tr_b16 a[170:171], v6 offset:10240
  ds_read_b64_tr_b16 a[172:173], v6 offset:12288
  ds_read_b64_tr_b16 a[174:175], v6 offset:14336
  ds_read_b64_tr_b16 a[184:185], v7 offset:8192
  ds_read_b64_tr_b16 a[186:187], v7 offset:10240
  ds_read_b64_tr_b16 a[188:189], v7 offset:12288
  ds_read_b64_tr_b16 a[190:191], v7 offset:14336
  s_waitcnt vmcnt(16) lgkmcnt(0)
  s_barrier
  s_add_u32 m0, s41, 8192
  s_add_u32 s42, s52, 2097152
  buffer_load_dwordx4 v11, s[8:11], s42 offen lds
  s_add_u32 m0, s41, 9216
  s_add_u32 s42, s52, 2162688
  buffer_load_dwordx4 v11, s[8:11], s42 offen lds
  s_add_u32 m0, s41, 10240
  s_add_u32 s42, s52, 2105344
  buffer_load_dwordx4 v11, s[8:11], s42 offen lds
  s_add_u32 m0, s41, 11264
  s_add_u32 s42, s52, 2170880
  buffer_load_dwordx4 v11, s[8:11], s42 offen lds
  s_add_u32 m0, s41, 12288
  s_add_u32 s42, s52, 2359296
  buffer_load_dwordx4 v11, s[8:11], s42 offen lds
  s_add_u32 m0, s41, 13312
  s_add_u32 s42, s52, 2424832
  buffer_load_dwordx4 v11, s[8:11], s42 offen lds
  s_add_u32 m0, s41, 14336
  s_add_u32 s42, s52, 2367488
  buffer_load_dwordx4 v11, s[8:11], s42 offen lds
  s_add_u32 m0, s41, 15360
  s_add_u32 s42, s52, 2433024
  buffer_load_dwordx4 v11, s[8:11], s42 offen lds
  ds_read_b64_tr_b16 a[192:193], v4 offset:16384
  ds_read_b64_tr_b16 a[194:195], v4 offset:18432
  ds_read_b64_tr_b16 a[196:197], v4 offset:20480
  ds_read_b64_tr_b16 a[198:199], v4 offset:22528
  ds_read_b64_tr_b16 a[208:209], v5 offset:16384
  ds_read_b64_tr_b16 a[210:211], v5 offset:18432
  ds_read_b64_tr_b16 a[212:213], v5 offset:20480
  ds_read_b64_tr_b16 a[214:215], v5 offset:22528
  ds_read_b64_tr_b16 a[224:225], v6 offset:16384
  ds_read_b64_tr_b16 a[226:227], v6 offset:18432
  ds_read_b64_tr_b16 a[228:229], v6 offset:20480
  ds_read_b64_tr_b16 a[230:231], v6 offset:22528
  ds_read_b64_tr_b16 a[240:241], v7 offset:16384
  ds_read_b64_tr_b16 a[242:243], v7 offset:18432
  ds_read_b64_tr_b16 a[244:245], v7 offset:20480
  ds_read_b64_tr_b16 a[246:247], v7 offset:22528
  s_cmp_lg_u32 s20, 0
  s_cbranch_scc1 Lchore_39
Lini_40:
  s_load_dwordx16 s[64:79], s[12:13], 128 glc
  s_load_dwordx16 s[80:95], s[12:13], 192 glc
  s_sub_u32 s24, s24, 1
  s_cbranch_scc1 L_FAIL
  s_waitcnt lgkmcnt(0)
  s_and_b64 s[64:65], s[64:65], s[66:67]
  s_and_b64 s[64:65], s[64:65], s[68:69]
  s_and_b64 s[64:65], s[64:65], s[70:71]
  s_and_b64 s[64:65], s[64:65], s[72:73]
  s_and_b64 s[64:65], s[64:65], s[74:75]
  s_and_b64 s[64:65], s[64:65], s[76:77]
  s_and_b64 s[64:65], s[64:65], s[78:79]
  s_and_b64 s[64:65], s[64:65], s[80:81]
  s_and_b64 s[64:65], s[64:65], s[82:83]
  s_and_b64 s[64:65], s[64:65], s[84:85]
  s_and_b64 s[64:65], s[64:65], s[86:87]
  s_and_b64 s[64:65], s[64:65], s[88:89]
  s_and_b64 s[64:65], s[64:65], s[90:91]
  s_and_b64 s[64:65], s[64:65], s[92:93]
  s_and_b64 s[64:65], s[64:65], s[94:95]
  s_and_b32 s64, s64, s65
  s_cbranch_scc0 Lini_40
  s_mov_b32 s46, 0xffff
  s_and_b32 s40, s21, 3
  s_lshl_b32 s40, s40, 13
  s_lshr_b32 s43, s21, 2
  s_lshl_b32 s43, s43, 10
  s_add_u32 s43, s43, s40
  s_add_u32 s43, s43, 1343488
  s_waitcnt lgkmcnt(0)
  s_memtime s[64:65]
  s_waitcnt lgkmcnt(0)
  s_load_dword s68, s[4:5], s43 glc
  s_waitcnt lgkmcnt(0)
  s_memtime s[66:67]
  s_waitcnt lgkmcnt(0)
  s_sub_u32 s64, s66, s64
  s_min_u32 s46, s46, s64
Lchore_39:
  s_waitcnt vmcnt(16) lgkmcnt(0)
  s_barrier
  s_add_u32 m0, s41, 16384
  s_add_u32 s42, s53, 4194304
  buffer_load_dwordx4 v11, s[8:11], s42 offen lds
  s_add_u32 m0, s41, 17408
  s_add_u32 s42, s53, 4259840
  buffer_load_dwordx4 v11, s[8:11], s42 offen lds
  s_add_u32 m0, s41, 18432
  s_add_u32 s42, s53, 4202496
  buffer_load_dwordx4 v11, s[8:11], s42 offen lds
  s_add_u32 m0, s41, 19456
  s_add_u32 s42, s53, 4268032
  buffer_load_dwordx4 v11, s[8:11], s42 offen lds
  s_add_u32 m0, s41, 20480
  s_add_u32 s42, s53, 4456448
  buffer_load_dwordx4 v11, s[8:11], s42 offen lds
  s_add_u32 m0, s41, 21504
  s_add_u32 s42, s53, 4521984
  buffer_load_dwordx4 v11, s[8:11], s42 offen lds
  s_add_u32 m0, s41, 22528
  s_add_u32 s42, s53, 4464640
  buffer_load_dwordx4 v11, s[8:11], s42 offen lds
  s_add_u32 m0, s41, 23552
  s_add_u32 s42, s53, 4530176
  buffer_load_dwordx4 v11, s[8:11], s42 offen lds
  ds_read_b64_tr_b16 a[200:201], v4 offset:24576
  ds_read_b64_tr_b16 a[202:203], v4 offset:26624
  ds_read_b64_tr_b16 a[204:205], v4 offset:28672
  ds_read_b64_tr_b16 a[206:207], v4 offset:30720
  ds_read_b64_tr_b16 a[216:217], v5 offset:24576
  ds_read_b64_tr_b16 a[218:219], v5 offset:26624
  ds_read_b64_tr_b16 a[220:221], v5 offset:28672
  ds_read_b64_tr_b16 a[222:223], v5 offset:30720
  ds_read_b64_tr_b16 a[232:233], v6 offset:24576
  ds_read_b64_tr_b16 a[234:235], v6 offset:26624
  ds_read_b64_tr_b16 a[236:237], v6 offset:28672
  ds_read_b64_tr_b16 a[238:239], v6 offset:30720
  ds_read_b64_tr_b16 a[248:249], v7 offset:24576
  ds_read_b64_tr_b16 a[250:251], v7 offset:26624
  ds_read_b64_tr_b16 a[252:253], v7 offset:28672
  ds_read_b64_tr_b16 a[254:255], v7 offset:30720
  s_cmp_lg_u32 s20, 0
  s_cbranch_scc1 Lchore_41
  s_waitcnt lgkmcnt(0)
  s_memtime s[64:65]
  s_waitcnt lgkmcnt(0)
  s_load_dword s68, s[4:5], s43 glc
  s_waitcnt lgkmcnt(0)
  s_memtime s[66:67]
  s_waitcnt lgkmcnt(0)
  s_sub_u32 s64, s66, s64
  s_min_u32 s46, s46, s64
Lchore_41:
  s_waitcnt vmcnt(16) lgkmcnt(0)
  s_barrier
  s_add_u32 m0, s41, 24576
  s_add_u32 s42, s53, 6291456
  buffer_load_dwordx4 v11, s[8:11], s42 offen lds
  s_add_u32 m0, s41, 25600
  s_add_u32 s42, s53, 6356992
  buffer_load_dwordx4 v11, s[8:11], s42 offen lds
  s_add_u32 m0, s41, 26624
  s_add_u32 s42, s53, 6299648
  buffer_load_dwordx4 v11, s[8:11], s42 offen lds
  s_add_u32 m0, s41, 27648
  s_add_u32 s42, s53, 6365184
  buffer_load_dwordx4 v11, s[8:11], s42 offen lds
  s_add_u32 m0, s41, 28672
  s_add_u32 s42, s53, 6553600
  buffer_load_dwordx4 v11, s[8:11], s42 offen lds
  s_add_u32 m0, s41, 29696
  s_add_u32 s42, s53, 6619136
  buffer_load_dwordx4 v11, s[8:11], s42 offen lds
  s_add_u32 m0, s41, 30720
  s_add_u32 s42, s53, 6561792
  buffer_load_dwordx4 v11, s[8:11], s42 offen lds
  s_add_u32 m0, s41, 31744
  s_add_u32 s42, s53, 6627328
  buffer_load_dwordx4 v11, s[8:11], s42 offen lds
  ds_read_b64_tr_b16 v[128:129], v4 offset:0
  ds_read_b64_tr_b16 v[130:131], v4 offset:2048
  ds_read_b64_tr_b16 v[132:133], v4 offset:4096
  ds_read_b64_tr_b16 v[134:135], v4 offset:6144
  ds_read_b64_tr_b16 v[144:145], v5 offset:0
  ds_read_b64_tr_b16 v[146:147], v5 offset:2048
  ds_read_b64_tr_b16 v[148:149], v5 offset:4096
  ds_read_b64_tr_b16 v[150:151], v5 offset:6144
  ds_read_b64_tr_b16 v[160:161], v6 offset:0
  ds_read_b64_tr_b16 v[162:163], v6 offset:2048
  ds_read_b64_tr_b16 v[164:165], v6 offset:4096
  ds_read_b64_tr_b16 v[166:167], v6 offset:6144
  ds_read_b64_tr_b16 v[176:177], v7 offset:0
  ds_read_b64_tr_b16 v[178:179], v7 offset:2048
  ds_read_b64_tr_b16 v[180:181], v7 offset:4096
  ds_read_b64_tr_b16 v[182:183], v7 offset:6144
  s_cmp_lg_u32 s20, 0
  s_cbranch_scc1 Lchore_42
  s_waitcnt lgkmcnt(0)
  s_memtime s[64:65]
  s_waitcnt lgkmcnt(0)
  s_load_dword s68, s[4:5], s43 glc
  s_waitcnt lgkmcnt(0)
  s_memtime s[66:67]
  s_waitcnt lgkmcnt(0)
  s_sub_u32 s64, s66, s64
  s_min_u32 s46, s46, s64
Lchore_42:
  s_waitcnt vmcnt(16) lgkmcnt(0)
  s_barrier
  s_add_u32 m0, s41, 0
  s_add_u32 s42, s52, 0
  buffer_load_dwordx4 v12, s[8:11], s42 offen lds
  s_add_u32 m0, s41, 1024
  s_add_u32 s42, s52, 65536
  buffer_load_dwordx4 v12, s[8:11], s42 offen lds
  s_add_u32 m0, s41, 2048
  s_add_u32 s42, s52, 8192
  buffer_load_dwordx4 v12, s[8:11], s42 offen lds
  s_add_u32 m0, s41, 3072
  s_add_u32 s42, s52, 73728
  buffer_load_dwordx4 v12, s[8:11], s42 offen lds
  s_add_u32 m0, s41, 4096
  s_add_u32 s42, s52, 262144
  buffer_load_dwordx4 v12, s[8:11], s42 offen lds
  s_add_u32 m0, s41, 5120
  s_add_u32 s42, s52, 327680
  buffer_load_dwordx4 v12, s[8:11], s42 offen lds
  s_add_u32 m0, s41, 6144
  s_add_u32 s42, s52, 270336
  buffer_load_dwordx4 v12, s[8:11], s42 offen lds
  s_add_u32 m0, s41, 7168
  s_add_u32 s42, s52, 335872
  buffer_load_dwordx4 v12, s[8:11], s42 offen lds
  ds_read_b64_tr_b16 v[136:137], v4 offset:8192
  ds_read_b64_tr_b16 v[138:139], v4 offset:10240
  ds_read_b64_tr_b16 v[140:141], v4 offset:12288
  ds_read_b64_tr_b16 v[142:143], v4 offset:14336
  ds_read_b64_tr_b16 v[152:153], v5 offset:8192
  ds_read_b64_tr_b16 v[154:155], v5 offset:10240
  ds_read_b64_tr_b16 v[156:157], v5 offset:12288
  ds_read_b64_tr_b16 v[158:159], v5 offset:14336
  ds_read_b64_tr_b16 v[168:169], v6 offset:8192
  ds_read_b64_tr_b16 v[170:171], v6 offset:10240
  ds_read_b64_tr_b16 v[172:173], v6 offset:12288
  ds_read_b64_tr_b16 v[174:175], v6 offset:14336
  ds_read_b64_tr_b16 v[184:185], v7 offset:8192
  ds_read_b64_tr_b16 v[186:187], v7 offset:10240
  ds_read_b64_tr_b16 v[188:189], v7 offset:12288
  ds_read_b64_tr_b16 v[190:191], v7 offset:14336
  s_cmp_lg_u32 s20, 0
  s_cbranch_scc1 Lchore_43
  s_waitcnt lgkmcnt(0)
  s_memtime s[64:65]
  s_waitcnt lgkmcnt(0)
  s_load_dword s68, s[4:5], s43 glc
  s_waitcnt lgkmcnt(0)
  s_memtime s[66:67]
  s_waitcnt lgkmcnt(0)
  s_sub_u32 s64, s66, s64
  s_min_u32 s46, s46, s64
Lchore_43:
  s_waitcnt vmcnt(16) lgkmcnt(0)
  s_barrier
  s_add_u32 m0, s41, 8192
  s_add_u32 s42, s52, 2097152
  buffer_load_dwordx4 v12, s[8:11], s42 offen lds
  s_add_u32 m0, s41, 9216
  s_add_u32 s42, s52, 2162688
  buffer_load_dwordx4 v12, s[8:11], s42 offen lds
  s_add_u32 m0, s41, 10240
  s_add_u32 s42, s52, 2105344
  buffer_load_dwordx4 v12, s[8:11], s42 offen lds
  s_add_u32 m0, s41, 11264
  s_add_u32 s42, s52, 2170880
  buffer_load_dwordx4 v12, s[8:11], s42 offen lds
  s_add_u32 m0, s41, 12288
  s_add_u32 s42, s52, 2359296
  buffer_load_dwordx4 v12, s[8:11], s42 offen lds
  s_add_u32 m0, s41, 13312
  s_add_u32 s42, s52, 2424832
  buffer_load_dwordx4 v12, s[8:11], s42 offen lds
  s_add_u32 m0, s41, 14336
  s_add_u32 s42, s52, 2367488
  buffer_load_dwordx4 v12, s[8:11], s42 offen lds
  s_add_u32 m0, s41, 15360
  s_add_u32 s42, s52, 2433024
  buffer_load_dwordx4 v12, s[8:11], s42 offen lds
  ds_read_b64_tr_b16 v[192:193], v4 offset:16384
  ds_read_b64_tr_b16 v[194:195], v4 offset:18432
  ds_read_b64_tr_b16 v[196:197], v4 offset:20480
  ds_read_b64_tr_b16 v[198:199], v4 offset:22528
  ds_read_b64_tr_b16 v[208:209], v5 offset:16384
  ds_read_b64_tr_b16 v[210:211], v5 offset:18432
  ds_read_b64_tr_b16 v[212:213], v5 offset:20480
  ds_read_b64_tr_b16 v[214:215], v5 offset:22528
  ds_read_b64_tr_b16 v[224:225], v6 offset:16384
  ds_read_b64_tr_b16 v[226:227], v6 offset:18432
  ds_read_b64_tr_b16 v[228:229], v6 offset:20480
  ds_read_b64_tr_b16 v[230:231], v6 offset:22528
  ds_read_b64_tr_b16 v[240:241], v7 offset:16384
  ds_read_b64_tr_b16 v[242:243], v7 offset:18432
  ds_read_b64_tr_b16 v[244:245], v7 offset:20480
  ds_read_b64_tr_b16 v[246:247], v7 offset:22528
  s_cmp_lg_u32 s20, 0
  s_cbranch_scc1 Lchore_44
  s_waitcnt lgkmcnt(0)
  s_memtime s[64:65]
  s_waitcnt lgkmcnt(0)
  s_load_dword s68, s[4:5], s43 glc
  s_waitcnt lgkmcnt(0)
  s_memtime s[66:67]
  s_waitcnt lgkmcnt(0)
  s_sub_u32 s64, s66, s64
  s_min_u32 s46, s46, s64
Lchore_44:
  s_waitcnt vmcnt(16) lgkmcnt(0)
  s_barrier
  s_add_u32 m0, s41, 16384
  s_add_u32 s42, s53, 4194304
  buffer_load_dwordx4 v12, s[8:11], s42 offen lds
  s_add_u32 m0, s41, 17408
  s_add_u32 s42, s53, 4259840
  buffer_load_dwordx4 v12, s[8:11], s42 offen lds
  s_add_u32 m0, s41, 18432
  s_add_u32 s42, s53, 4202496
  buffer_load_dwordx4 v12, s[8:11], s42 offen lds
  s_add_u32 m0, s41, 19456
  s_add_u32 s42, s53, 4268032
  buffer_load_dwordx4 v12, s[8:11], s42 offen lds
  s_add_u32 m0, s41, 20480
  s_add_u32 s42, s53, 4456448
  buffer_load_dwordx4 v12, s[8:11], s42 offen lds
  s_add_u32 m0, s41, 21504
  s_add_u32 s42, s53, 4521984
  buffer_load_dwordx4 v12, s[8:11], s42 offen lds
  s_add_u32 m0, s41, 22528
  s_add_u32 s42, s53, 4464640
  buffer_load_dwordx4 v12, s[8:11], s42 offen lds
  s_add_u32 m0, s41, 23552
  s_add_u32 s42, s53, 4530176
  buffer_load_dwordx4 v12, s[8:11], s42 offen lds
  ds_read_b64_tr_b16 v[200:201], v4 offset:24576
  ds_read_b64_tr_b16 v[202:203], v4 offset:26624
  ds_read_b64_tr_b16 v[204:205], v4 offset:28672
  ds_read_b64_tr_b16 v[206:207], v4 offset:30720
  ds_read_b64_tr_b16 v[216:217], v5 offset:24576
  ds_read_b64_tr_b16 v[218:219], v5 offset:26624
  ds_read_b64_tr_b16 v[220:221], v5 offset:28672
  ds_read_b64_tr_b16 v[222:223], v5 offset:30720
  ds_read_b64_tr_b16 v[232:233], v6 offset:24576
  ds_read_b64_tr_b16 v[234:235], v6 offset:26624
  ds_read_b64_tr_b16 v[236:237], v6 offset:28672
  ds_read_b64_tr_b16 v[238:239], v6 offset:30720
  ds_read_b64_tr_b16 v[248:249], v7 offset:24576
  ds_read_b64_tr_b16 v[250:251], v7 offset:26624
  ds_read_b64_tr_b16 v[252:253], v7 offset:28672
  ds_read_b64_tr_b16 v[254:255], v7 offset:30720
  s_cmp_lg_u32 s20, 0
  s_cbranch_scc1 Lchore_45
  s_waitcnt lgkmcnt(0)
  s_memtime s[64:65]
  s_waitcnt lgkmcnt(0)
  s_load_dword s68, s[4:5], s43 glc
  s_waitcnt lgkmcnt(0)
  s_memtime s[66:67]
  s_waitcnt lgkmcnt(0)
  s_sub_u32 s64, s66, s64
  s_min_u32 s46, s46, s64
  s_getreg_b32 s55, hwreg(HW_REG_XCC_ID)
  s_and_b32 s55, s55, 15
  s_lshl_b32 s46, s46, 8
  s_or_b32 s46, s46, s55
  s_add_u32 s40, s21, 0
  s_lshl_b32 s40, s40, 7
  s_add_u32 s40, s40, 1424384
  s_mov_b32 s63, s46
  s_atomic_smax s63, s[4:5], s40 glc
Lnosig_46:
Lchore_45:
  s_waitcnt vmcnt(16) lgkmcnt(0)
  s_barrier
  s_add_u32 m0, s41, 24576
  s_add_u32 s42, s53, 6291456
  buffer_load_dwordx4 v12, s[8:11], s42 offen lds
  s_add_u32 m0, s41, 25600
  s_add_u32 s42, s53, 6356992
  buffer_load_dwordx4 v12, s[8:11], s42 offen lds
  s_add_u32 m0, s41, 26624
  s_add_u32 s42, s53, 6299648
  buffer_load_dwordx4 v12, s[8:11], s42 offen lds
  s_add_u32 m0, s41, 27648
  s_add_u32 s42, s53, 6365184
  buffer_load_dwordx4 v12, s[8:11], s42 offen lds
  s_add_u32 m0, s41, 28672
  s_add_u32 s42, s53, 6553600
  buffer_load_dwordx4 v12, s[8:11], s42 offen lds
  s_add_u32 m0, s41, 29696
  s_add_u32 s42, s53, 6619136
  buffer_load_dwordx4 v12, s[8:11], s42 offen lds
  s_add_u32 m0, s41, 30720
  s_add_u32 s42, s53, 6561792
  buffer_load_dwordx4 v12, s[8:11], s42 offen lds
  s_add_u32 m0, s41, 31744
  s_add_u32 s42, s53, 6627328
  buffer_load_dwordx4 v12, s[8:11], s42 offen lds
  ds_read_b64_tr_b16 v[20:21], v4 offset:0
  ds_read_b64_tr_b16 v[22:23], v4 offset:2048
  ds_read_b64_tr_b16 v[24:25], v4 offset:4096
  ds_read_b64_tr_b16 v[26:27], v4 offset:6144
  ds_read_b64_tr_b16 v[28:29], v5 offset:0
  ds_read_b64_tr_b16 v[30:31], v5 offset:2048
  ds_read_b64_tr_b16 v[32:33], v5 offset:4096
  ds_read_b64_tr_b16 v[34:35], v5 offset:6144
  ds_read_b64_tr_b16 v[36:37], v6 offset:0
  ds_read_b64_tr_b16 v[38:39], v6 offset:2048
  ds_read_b64_tr_b16 v[40:41], v6 offset:4096
  ds_read_b64_tr_b16 v[42:43], v6 offset:6144
  ds_read_b64_tr_b16 v[44:45], v7 offset:0
  ds_read_b64_tr_b16 v[46:47], v7 offset:2048
  ds_read_b64_tr_b16 v[48:49], v7 offset:4096
  ds_read_b64_tr_b16 v[50:51], v7 offset:6144
  s_waitcnt lgkmcnt(0)
  s_barrier
  ds_write_b128 v85, v[20:23] offset:0
  ds_write_b128 v85, v[24:27] offset:1024
  ds_write_b128 v85, v[28:31] offset:2048
  ds_write_b128 v85, v[32:35] offset:3072
  ds_write_b128 v85, v[36:39] offset:4096
  ds_write_b128 v85, v[40:43] offset:5120
  ds_write_b128 v85, v[44:47] offset:6144
  ds_write_b128 v85, v[48:51] offset:7168
  s_waitcnt vmcnt(16) lgkmcnt(0)
  s_barrier
  ds_read_b64_tr_b16 v[20:21], v4 offset:8192
  ds_read_b64_tr_b16 v[22:23], v4 offset:10240
  ds_read_b64_tr_b16 v[24:25], v4 offset:12288
  ds_read_b64_tr_b16 v[26:27], v4 offset:14336
  ds_read_b64_tr_b16 v[28:29], v5 offset:8192
  ds_read_b64_tr_b16 v[30:31], v5 offset:10240
  ds_read_b64_tr_b16 v[32:33], v5 offset:12288
  ds_read_b64_tr_b16 v[34:35], v5 offset:14336
  ds_read_b64_tr_b16 v[36:37], v6 offset:8192
  ds_read_b64_tr_b16 v[38:39], v6 offset:10240
  ds_read_b64_tr_b16 v[40:41], v6 offset:12288
  ds_read_b64_tr_b16 v[42:43], v6 offset:14336
  ds_read_b64_tr_b16 v[44:45], v7 offset:8192
  ds_read_b64_tr_b16 v[46:47], v7 offset:10240
  ds_read_b64_tr_b16 v[48:49], v7 offset:12288
  ds_read_b64_tr_b16 v[50:51], v7 offset:14336
  s_waitcnt lgkmcnt(0)
  s_barrier
  ds_write_b128 v85, v[20:23] offset:8192
  ds_write_b128 v85, v[24:27] offset:9216
  ds_write_b128 v85, v[28:31] offset:10240
  ds_write_b128 v85, v[32:35] offset:11264
  ds_write_b128 v85, v[36:39] offset:12288
  ds_write_b128 v85, v[40:43] offset:13312
  ds_write_b128 v85, v[44:47] offset:14336
  ds_write_b128 v85, v[48:51] offset:15360
  s_waitcnt vmcnt(8) lgkmcnt(0)
  s_barrier
  ds_read_b64_tr_b16 v[20:21], v4 offset:16384
  ds_read_b64_tr_b16 v[22:23], v4 offset:18432
  ds_read_b64_tr_b16 v[24:25], v4 offset:20480
  ds_read_b64_tr_b16 v[26:27], v4 offset:22528
  ds_read_b64_tr_b16 v[28:29], v5 offset:16384
  ds_read_b64_tr_b16 v[30:31], v5 offset:18432
  ds_read_b64_tr_b16 v[32:33], v5 offset:20480
  ds_read_b64_tr_b16 v[34:35], v5 offset:22528
  ds_read_b64_tr_b16 v[36:37], v6 offset:16384
  ds_read_b64_tr_b16 v[38:39], v6 offset:18432
  ds_read_b64_tr_b16 v[40:41], v6 offset:20480
  ds_read_b64_tr_b16 v[42:43], v6 offset:22528
  ds_read_b64_tr_b16 v[44:45], v7 offset:16384
  ds_read_b64_tr_b16 v[46:47], v7 offset:18432
  ds_read_b64_tr_b16 v[48:49], v7 offset:20480
  ds_read_b64_tr_b16 v[50:51], v7 offset:22528
  s_waitcnt lgkmcnt(0)
  s_barrier
  ds_write_b128 v85, v[20:23] offset:16384
  ds_write_b128 v85, v[24:27] offset:17408
  ds_write_b128 v85, v[28:31] offset:18432
  ds_write_b128 v85, v[32:35] offset:19456
  ds_write_b128 v85, v[36:39] offset:20480
  ds_write_b128 v85, v[40:43] offset:21504
  ds_write_b128 v85, v[44:47] offset:22528
  ds_write_b128 v85, v[48:51] offset:23552
  s_waitcnt vmcnt(0) lgkmcnt(0)
  s_barrier
  ds_read_b64_tr_b16 v[20:21], v4 offset:24576
  ds_read_b64_tr_b16 v[22:23], v4 offset:26624
  ds_read_b64_tr_b16 v[24:25], v4 offset:28672
  ds_read_b64_tr_b16 v[26:27], v4 offset:30720
  ds_read_b64_tr_b16 v[28:29], v5 offset:24576
  ds_read_b64_tr_b16 v[30:31], v5 offset:26624
  ds_read_b64_tr_b16 v[32:33], v5 offset:28672
  ds_read_b64_tr_b16 v[34:35], v5 offset:30720
  ds_read_b64_tr_b16 v[36:37], v6 offset:24576
  ds_read_b64_tr_b16 v[38:39], v6 offset:26624
  ds_read_b64_tr_b16 v[40:41], v6 offset:28672
  ds_read_b64_tr_b16 v[42:43], v6 offset:30720
  ds_read_b64_tr_b16 v[44:45], v7 offset:24576
  ds_read_b64_tr_b16 v[46:47], v7 offset:26624
  ds_read_b64_tr_b16 v[48:49], v7 offset:28672
  ds_read_b64_tr_b16 v[50:51], v7 offset:30720
  s_waitcnt lgkmcnt(0)
  s_barrier
  ds_write_b128 v85, v[20:23] offset:24576
  ds_write_b128 v85, v[24:27] offset:25600
  ds_write_b128 v85, v[28:31] offset:26624
  ds_write_b128 v85, v[32:35] offset:27648
  ds_write_b128 v85, v[36:39] offset:28672
  ds_write_b128 v85, v[40:43] offset:29696
  ds_write_b128 v85, v[44:47] offset:30720
  ds_write_b128 v85, v[48:51] offset:31744
  s_waitcnt lgkmcnt(0)
  s_getreg_b32 s55, hwreg(HW_REG_XCC_ID)
  s_and_b32 s55, s55, 15
  v_min_u32 v76, 63, v0
  v_lshlrev_b32 v76, 7, v76
  v_add_u32 v76, 1424384, v76
  s_nop 1
Lpoll_47:
  buffer_load_dword v77, v76, s[4:7], 0 offen sc1
  s_sub_u32 s24, s24, 1
  s_cbranch_scc1 L_FAIL
  s_waitcnt vmcnt(0)
  v_cmp_gt_i32 vcc, 0, v77
  s_cbranch_vccz Lpolld_48
  s_sleep 1
  s_branch Lpoll_47
Lpolld_48:
  v_and_b32 v78, 15, v77
  v_cmp_ne_u32 vcc, s55, v78
  s_lshl_b32 s40, s54, 4
  s_lshl_b32 s40, 0xffff, s40
  s_or_b32 s41, vcc_lo, vcc_hi
  s_and_b32 s40, s40, s41
  s_cselect_b32 s36, 0, 8192
  v_lshrrev_b32 v77, 8, v77
  v_and_b32 v78, 3, v0
  v_lshl_or_b32 v77, v77, 2, v78
  s_nop 1
  v_min_u32_dpp v77, v77, v77 row_ror:8 row_mask:0xf bank_mask:0xf
  s_nop 1
  v_min_u32_dpp v77, v77, v77 row_ror:4 row_mask:0xf bank_mask:0xf
  v_mov_b32 v78, v77
  s_nop 1
  v_permlane16_swap_b32 v78, v77
  v_min_u32 v77, v77, v78
  v_mov_b32 v78, v77
  s_nop 1
  v_permlane32_swap_b32 v78, v77
  v_min_u32 v77, v77, v78
  s_nop 1
  v_min_u32_dpp v77, v77, v77 row_ror:2 row_mask:0xf bank_mask:0xf
  s_nop 1
  v_min_u32_dpp v77, v77, v77 row_ror:1 row_mask:0xf bank_mask:0xf
  s_nop 0
  v_readfirstlane_b32 s26, v77
  s_and_b32 s26, s26, 3
  s_lshl_b32 s26, s26, 13
  s_lshr_b32 s40, s20, 1
  s_mul_i32 s40, s40, 32768
  s_and_b32 s41, s20, 1
  s_lshl_b32 s41, s41, 10
  s_add_u32 s40, s40, s41
  s_lshl_b32 s41, s54, 12
  s_add_u32 s40, s40, s41
  v_lshl_add_u32 v86, v0, 4, s40
  v_xor_b32 v87, 0x1000, v86
  v_and_b32 v76, 2, v0
  v_cmp_eq_u32 vcc, 0, v76
  v_mov_b32 v76, 0xeeee
  v_mov_b32 v77, 0x4444
  v_cndmask_b32 v88, v76, v77, vcc
  s_lshr_b32 s40, s21, 2
  s_mul_i32 s40, s40, 32768
  s_and_b32 s41, s21, 3
  s_lshl_b32 s41, s41, 11
  s_add_u32 s47, s40, s41
  s_lshl_b32 s41, s20, 9
  s_add_u32 s47, s47, s41
  v_lshl_add_u32 v92, v0, 3, s47
  s_lshl_b32 s41, s54, 12
  s_add_u32 s40, s41, 1310720
  s_add_u32 s40, s40, s26
  v_lshrrev_b32 v76, 2, v0
  v_lshl_add_u32 v76, v76, 7, s40
  v_and_b32 v77, 3, v0
  v_lshl_add_u32 v90, v77, 2, v76
  s_mov_b32 s57, s40
  s_cmp_eq_u32 s36, 0
  s_cselect_b32 s56, 1, s20
  s_and_b32 s41, s21, 15
  s_lshl_b32 s41, s41, 7
  s_lshl_b32 s40, s20, 2
  s_add_u32 s40, s40, s41
  s_add_u32 s40, s40, 2048
  s_mov_b32 s25, 0
  s_mov_b32 s60, 0
  s_mov_b32 s61, 0
  s_mov_b32 s51, -1
  v_mov_b32 v91, 2147483392
  s_mov_b64 exec, 1
  v_mov_b32 v91, s40
  s_mov_b64 exec, -1
  v_mov_b32 v80, -1
  v_mov_b32 v81, -1
  v_mov_b32 v82, -1
  v_mov_b32 v83, -1
  v_mov_b32 v112, 0
  v_mov_b32 v113, 0
  v_mov_b32 v114, 0
  v_mov_b32 v115, 0
  v_mov_b32 v116, 0
  v_mov_b32 v117, 0
  v_mov_b32 v118, 0
  v_mov_b32 v119, 0
  v_mov_b32 v120, 0
  v_mov_b32 v121, 0
  v_mov_b32 v108, 0x3f803f80
  v_mov_b32 v109, 0x3f803f80
  v_mov_b32 v110, 0x3f803f80
  v_mov_b32 v111, 0x3f803f80
  v_lshlrev_b32 v95, 4, v0
  s_lshl_b32 s58, s20, 12
  s_add_u32 s40, s58, 149504
  s_add_u32 s58, s58, 131072
  v_lshrrev_b32 v76, 4, v0
  v_bfe_u32 v77, v0, 1, 2
  v_xor_b32 v76, v76, v77
  v_lshl_add_u32 v76, v76, 4, s40
  v_and_b32 v77, 15, v0
  v_lshl_add_u32 v123, v77, 6, v76
  v_bfe_u32 v76, v0, 3, 2
  v_xor_b32 v76, v76, v0
  v_lshl_add_u32 v124, v76, 4, s40
  v_bfe_u32 v76, v0, 4, 1
  v_lshlrev_b32 v76, 1, v76
  v_and_b32 v77, 13, v0
  v_or_b32 v76, v76, v77
  v_lshl_add_u32 v122, v76, 4, s47
  v_lshrrev_b32 v76, 5, v0
  v_lshl_add_u32 v122, v76, 8, v122
  v_and_b32 v76, 2, v0
  v_cmp_eq_u32 vcc, 0, v76
  v_mov_b32 v77, 2147483392
  s_nop 0
  v_cndmask_b32 v122, v122, v77, vcc
  s_lshl_b32 s43, s21, 2
  s_add_u32 s43, s43, s20
  s_lshl_b32 s30, s43, 11
  s_add_u32 s30, s30, 27262976
  s_and_b32 s46, s20, 1
  s_lshl_b32 s46, s46, 10
  s_add_u32 s30, s30, s46
  s_mul_i32 s32, s21, 24576
  s_lshl_b32 s40, s20, 11
  s_add_u32 s32, s32, s40
  s_add_u32 s32, s32, 58720256
  s_lshl_b32 s59, s21, 7
  s_add_u32 s59, s59, 1396736
  s_lshl_b32 s62, s21, 7
  s_add_u32 s62, s62, 1404928
  s_mov_b32 s38, 0x3e0293ee
  s_mov_b32 s39, s38
  s_mov_b32 s50, 0
  s_mov_b32 s49, 2147483392
  v_xor_b32 v125, 4096, v124
  v_xor_b32 v126, 8192, v124
  v_xor_b32 v127, 12288, v124
  v_readfirstlane_b32 s88, v86
  s_xor_b32 s41, s47, 131072
  v_min_u32 v76, 3, v0
  v_lshl_add_u32 v87, v76, 7, s41
  v_lshrrev_b32 v76, 4, v0
  v_lshlrev_b32 v76, 2, v76
  v_and_b32 v77, 15, v0
  v_sub_u32 v76, v77, v76
  s_lshr_b32 s41, s46, 6
  v_add_u32 v76, s41, v76
  v_and_b32 v92, 0xfffffdff, v92
  v_mov_b32 v86, 0xd028965f
  v_cmp_le_i32 s[8:9], 0, v76
  v_cmp_le_i32 s[10:11], 1, v76
  v_cmp_le_i32 s[16:17], 2, v76
  v_cmp_le_i32 s[18:19], 3, v76
  v_cmp_le_i32 s[42:43], 16, v76
  v_cmp_le_i32 s[44:45], 17, v76
  v_cmp_le_i32 s[52:53], 18, v76
  v_cmp_le_i32 s[54:55], 19, v76
  s_xor_b32 s89, s88, 1024
  s_xor_b32 s90, s88, 32768
  s_xor_b32 s91, s88, 33792
  s_mov_b32 s33, 1
  s_mov_b64 s[100:101], 0
  s_cmp_lg_u32 s20, 1
  s_cbranch_scc1 Lskip_51
Lask_49:
  s_min_i32 s47, s100, s101
  s_cmp_ge_i32 s47, s33
  s_cbranch_scc1 Lhave_50
  s_load_dwordx2 s[100:101], s[4:5], s59 glc
  s_sub_u32 s24, s24, 1
  s_cbranch_scc1 L_FAIL
  s_waitcnt lgkmcnt(0)
  s_branch Lask_49
Lhave_50:
  s_add_u32 s33, s33, 2
  s_min_u32 s33, s33, 64
  s_cmp_ge_i32 s47, s33
  s_cbranch_scc1 Lskip_51
  s_load_dwordx2 s[100:101], s[4:5], s59 glc
Lskip_51:
  s_barrier
  s_add_u32 m0, s58, 16384
  s_add_u32 s31, s32, 8192
  buffer_load_dwordx4 v95, s[4:7], s31 offen offset:0 sc1 lds
  buffer_load_dwordx4 v95, s[4:7], s31 offen offset:1024 sc1 lds
  s_add_u32 m0, s58, 2048
  s_add_u32 s31, s32, 16384
  buffer_load_dwordx4 v95, s[4:7], s31 offen offset:0 sc1 lds
  buffer_load_dwordx4 v95, s[4:7], s31 offen offset:1024 sc1 lds
  s_mov_b32 m0, s58
  s_add_u32 s31, s32, s46
  buffer_load_dwordx4 v95, s[4:7], s31 offen offset:0 sc1 lds
  s_sub_u32 s31, s32, s46
  buffer_load_dwordx4 v95, s[4:7], s31 offen offset:1024 sc1 lds
  s_and_b32 s40, s25, 3
  s_lshl_b32 s40, s40, 16
  s_add_u32 s27, s40, s26
  s_add_u32 s27, s27, 1048576
  s_xor_b32 s37, s27, s36
  s_lshl_b32 s40, s40, 2
  s_add_u32 s28, s40, s26
  s_lshr_b32 s40, s40, 5
  s_and_b32 s40, s40, 0x4000
  s_xor_b32 s28, s28, s40
  s_xor_b32 s29, s28, 0x4000
  s_xor_b32 s34, s28, 0x84000
  s_xor_b32 s48, s28, 8192
  s_lshr_b32 s40, s46, 1
  s_add_u32 s29, s29, s40
  s_xor_b32 s35, s29, 512
  s_add_u32 s92, s37, s88
  s_add_u32 s96, s27, s88
  s_xor_b32 s96, s96, 0x1000
  s_add_u32 s93, s37, s89
  s_add_u32 s97, s27, s89
  s_xor_b32 s97, s97, 0x1000
  s_add_u32 s94, s37, s90
  s_add_u32 s98, s27, s90
  s_xor_b32 s98, s98, 0x1000
  s_add_u32 s95, s37, s91
  s_add_u32 s99, s27, s91
  s_xor_b32 s99, s99, 0x1000
L_QK_top:
  v_mov_b32 v94, s25
  v_mov_b64 v[52:53], 0
  v_mov_b64 v[54:55], 0
  v_mov_b64 v[56:57], 0
  v_mov_b64 v[58:59], 0
  v_mov_b64 v[60:61], 0
  v_mov_b64 v[62:63], 0
  v_mov_b64 v[64:65], 0
  v_mov_b64 v[66:67], 0
  ds_read_b128 v[20:23], v85 offset:0
  ds_read_b128 v[24:27], v85 offset:1024
  ds_read_b128 v[28:31], v85 offset:8192
  ds_read_b128 v[32:35], v85 offset:9216
  ds_read_b128 v[36:39], v85 offset:2048
  ds_read_b128 v[40:43], v85 offset:3072
  ds_read_b128 v[44:47], v85 offset:10240
  ds_read_b128 v[48:51], v85 offset:11264
  s_waitcnt vmcnt(0)
  s_waitcnt lgkmcnt(0)
  s_barrier
  s_cmp_lg_u32 s20, 3
  s_cbranch_scc1 Lnosig_52
  s_mov_b32 s63, s50
  s_atomic_smax s63, s[4:5], s62 glc
Lnosig_52:
  s_cmp_ge_u32 s25, 64
  s_cbranch_scc1 L_QK_end
  s_cmp_eq_u32 s25, 0
  s_cbranch_scc1 L_QK_go
  s_cmp_lg_u32 s56, 0
  s_cbranch_scc1 Ltrigd_54
  buffer_load_dword v76, v90, s[4:7], 0 offen offset:0 sc1
  s_sleep 1
  buffer_load_dword v77, v90, s[4:7], 0 offen offset:0 sc1
  s_sleep 1
  buffer_load_dword v78, v90, s[4:7], 0 offen offset:0 sc1
  s_sleep 1
Ltrig_53:
  s_sub_u32 s24, s24, 1
  s_cbranch_scc1 L_FAIL
  buffer_load_dword v79, v90, s[4:7], 0 offen offset:0 sc1
  s_waitcnt vmcnt(3)
  v_cmp_gt_i32 vcc, s25, v76
  s_cbranch_vccz Ltrigd_54
  buffer_load_dword v76, v90, s[4:7], 0 offen offset:0 sc1
  s_waitcnt vmcnt(3)
  v_cmp_gt_i32 vcc, s25, v77
  s_cbranch_vccz Ltrigd_54
  buffer_load_dword v77, v90, s[4:7], 0 offen offset:0 sc1
  s_waitcnt vmcnt(3)
  v_cmp_gt_i32 vcc, s25, v78
  s_cbranch_vccz Ltrigd_54
  buffer_load_dword v78, v90, s[4:7], 0 offen offset:0 sc1
  s_waitcnt vmcnt(3)
  v_cmp_gt_i32 vcc, s25, v79
  s_cbranch_vccnz Ltrig_53
Ltrigd_54:
  s_barrier
L_QK_go:
L_QKM_again:
  buffer_load_dwordx4 v[96:99], v95, s[4:7], s92 offen offset:0 sc1
  s_nop 0
  buffer_load_dwordx4 v[100:103], v95, s[4:7], s92 offen offset:2048 sc1
  s_nop 0
  buffer_load_dwordx4 v[68:71], v95, s[4:7], s93 offen offset:0 sc1
  s_nop 0
  buffer_load_dwordx4 v[72:75], v95, s[4:7], s93 offen offset:2048 sc1
  s_nop 0
  buffer_load_dwordx4 v[4:7], v95, s[4:7], s94 offen offset:0 sc1
  s_nop 0
  s_waitcnt vmcnt(4)
  buffer_load_dwordx4 v[8:11], v95, s[4:7], s94 offen offset:2048 sc1
  buffer_load_dwordx4 v[12:15], v95, s[4:7], s95 offen offset:0 sc1
  v_smfmac_f32_16x16x64_bf16 v[52:55], v[96:99], a[0:7], v88
  v_smfmac_f32_16x16x64_bf16 v[60:63], v[96:99], v[128:135], v88
  s_waitcnt vmcnt(5)
  v_smfmac_f32_16x16x64_bf16 v[56:59], v[96:99], a[128:135], v88
  v_smfmac_f32_16x16x64_bf16 v[64:67], v[96:99], v[20:27], v88
  buffer_load_dwordx4 v[16:19], v95, s[4:7], s95 offen offset:2048 sc1
  buffer_load_dwordx4 v[96:99], v95, s[4:7], s96 offen offset:0 sc1
  v_smfmac_f32_16x16x64_bf16 v[52:55], v[100:103], a[8:15], v88
  ds_read_b128 v[20:23], v85 offset:4096
  v_smfmac_f32_16x16x64_bf16 v[60:63], v[100:103], v[136:143], v88
  ds_read_b128 v[24:27], v85 offset:5120
  s_waitcnt vmcnt(6)
  v_smfmac_f32_16x16x64_bf16 v[56:59], v[100:103], a[136:143], v88
  v_smfmac_f32_16x16x64_bf16 v[64:67], v[100:103], v[28:35], v88
  buffer_load_dwordx4 v[100:103], v95, s[4:7], s96 offen offset:2048 sc1
  v_smfmac_f32_16x16x64_bf16 v[52:55], v[68:71], a[16:23], v88
  ds_read_b128 v[28:31], v85 offset:12288
  v_smfmac_f32_16x16x64_bf16 v[60:63], v[68:71], v[144:151], v88
  ds_read_b128 v[32:35], v85 offset:13312
  s_waitcnt vmcnt(6)
  v_smfmac_f32_16x16x64_bf16 v[56:59], v[68:71], a[144:151], v88
  v_smfmac_f32_16x16x64_bf16 v[64:67], v[68:71], v[36:43], v88
  buffer_load_dwordx4 v[68:71], v95, s[4:7], s97 offen offset:0 sc1
  v_smfmac_f32_16x16x64_bf16 v[52:55], v[72:75], a[24:31], v88
  ds_read_b128 v[36:39], v85 offset:6144
  v_smfmac_f32_16x16x64_bf16 v[60:63], v[72:75], v[152:159], v88
  ds_read_b128 v[40:43], v85 offset:7168
  s_waitcnt vmcnt(6)
  v_smfmac_f32_16x16x64_bf16 v[56:59], v[72:75], a[152:159], v88
  v_smfmac_f32_16x16x64_bf16 v[64:67], v[72:75], v[44:51], v88
  buffer_load_dwordx4 v[72:75], v95, s[4:7], s97 offen offset:2048 sc1
  v_smfmac_f32_16x16x64_bf16 v[52:55], v[4:7], a[32:39], v88
  ds_read_b128 v[44:47], v85 offset:14336
  v_smfmac_f32_16x16x64_bf16 v[60:63], v[4:7], v[160:167], v88
  ds_read_b128 v[48:51], v85 offset:15360
  s_waitcnt vmcnt(6)
  v_smfmac_f32_16x16x64_bf16 v[56:59], v[4:7], a[160:167], v88
  s_waitcnt lgkmcnt(6)
  v_smfmac_f32_16x16x64_bf16 v[64:67], v[4:7], v[20:27], v88
  buffer_load_dwordx4 v[4:7], v95, s[4:7], s98 offen offset:0 sc1
  v_smfmac_f32_16x16x64_bf16 v[52:55], v[8:11], a[40:47], v88
  ds_read_b128 v[20:23], v85 offset:16384
  v_smfmac_f32_16x16x64_bf16 v[60:63], v[8:11], v[168:175], v88
  ds_read_b128 v[24:27], v85 offset:17408
  s_waitcnt vmcnt(6)
  v_smfmac_f32_16x16x64_bf16 v[56:59], v[8:11], a[168:175], v88
  s_waitcnt lgkmcnt(6)
  v_smfmac_f32_16x16x64_bf16 v[64:67], v[8:11], v[28:35], v88
  buffer_load_dwordx4 v[8:11], v95, s[4:7], s98 offen offset:2048 sc1
  v_smfmac_f32_16x16x64_bf16 v[52:55], v[12:15], a[48:55], v88
  ds_read_b128 v[28:31], v85 offset:24576
  v_smfmac_f32_16x16x64_bf16 v[60:63], v[12:15], v[176:183], v88
  ds_read_b128 v[32:35], v85 offset:25600
  s_waitcnt vmcnt(6)
  v_smfmac_f32_16x16x64_bf16 v[56:59], v[12:15], a[176:183], v88
  s_waitcnt lgkmcnt(6)
  v_smfmac_f32_16x16x64_bf16 v[64:67], v[12:15], v[36:43], v88
  buffer_load_dwordx4 v[12:15], v95, s[4:7], s99 offen offset:0 sc1
  v_smfmac_f32_16x16x64_bf16 v[52:55], v[16:19], a[56:63], v88
  ds_read_b128 v[36:39], v85 offset:18432
  v_smfmac_f32_16x16x64_bf16 v[60:63], v[16:19], v[184:191], v88
  s_waitcnt vmcnt(6)
  v_cmp_eq_u32 vcc, -1, v96
  v_smfmac_f32_16x16x64_bf16 v[56:59], v[16:19], a[184:191], v88
  ds_read_b128 v[40:43], v85 offset:19456
  s_waitcnt lgkmcnt(6)
  v_smfmac_f32_16x16x64_bf16 v[64:67], v[16:19], v[44:51], v88
  s_cbranch_vccnz L_QKM_g8
L_QKM_ok8:
  buffer_load_dwordx4 v[16:19], v95, s[4:7], s99 offen offset:2048 sc1
  v_smfmac_f32_16x16x64_bf16 v[52:55], v[96:99], a[64:71], v88
  ds_read_b128 v[44:47], v85 offset:26624
  v_smfmac_f32_16x16x64_bf16 v[60:63], v[96:99], v[192:199], v88
  s_waitcnt vmcnt(6)
  v_cmp_eq_u32 vcc, -1, v100
  v_smfmac_f32_16x16x64_bf16 v[56:59], v[96:99], a[192:199], v88
  ds_read_b128 v[48:51], v85 offset:27648
  s_waitcnt lgkmcnt(6)
  v_smfmac_f32_16x16x64_bf16 v[64:67], v[96:99], v[20:27], v88
  s_cbranch_vccnz L_QKM_g9
L_QKM_ok9:
  ds_read_b128 v[20:23], v85 offset:20480
  v_smfmac_f32_16x16x64_bf16 v[52:55], v[100:103], a[72:79], v88
  ds_read_b128 v[24:27], v85 offset:21504
  v_smfmac_f32_16x16x64_bf16 v[60:63], v[100:103], v[200:207], v88
  s_waitcnt vmcnt(5)
  v_cmp_eq_u32 vcc, -1, v68
  v_smfmac_f32_16x16x64_bf16 v[56:59], v[100:103], a[200:207], v88
  s_waitcnt lgkmcnt(6)
  v_smfmac_f32_16x16x64_bf16 v[64:67], v[100:103], v[28:35], v88
  s_cbranch_vccnz L_QKM_g10
L_QKM_ok10:
  ds_read_b128 v[28:31], v85 offset:28672
  v_smfmac_f32_16x16x64_bf16 v[52:55], v[68:71], a[80:87], v88
  ds_read_b128 v[32:35], v85 offset:29696
  v_smfmac_f32_16x16x64_bf16 v[60:63], v[68:71], v[208:215], v88
  s_waitcnt vmcnt(4)
  v_cmp_eq_u32 vcc, -1, v72
  v_smfmac_f32_16x16x64_bf16 v[56:59], v[68:71], a[208:215], v88
  s_waitcnt lgkmcnt(6)
  v_smfmac_f32_16x16x64_bf16 v[64:67], v[68:71], v[36:43], v88
  s_cbranch_vccnz L_QKM_g11
L_QKM_ok11:
  ds_read_b128 v[36:39], v85 offset:22528
  v_smfmac_f32_16x16x64_bf16 v[52:55], v[72:75], a[88:95], v88
  ds_read_b128 v[40:43], v85 offset:23552
  v_smfmac_f32_16x16x64_bf16 v[60:63], v[72:75], v[216:223], v88
  s_waitcnt vmcnt(3)
  v_cmp_eq_u32 vcc, -1, v4
  v_smfmac_f32_16x16x64_bf16 v[56:59], v[72:75], a[216:223], v88
  ds_read_b128 v[96:99], v1 offset:2048
  s_waitcnt lgkmcnt(7)
  v_smfmac_f32_16x16x64_bf16 v[64:67], v[72:75], v[44:51], v88
  s_cbranch_vccnz L_QKM_g12
L_QKM_ok12:
  ds_read_b128 v[44:47], v85 offset:30720
  v_smfmac_f32_16x16x64_bf16 v[52:55], v[4:7], a[96:103], v88
  ds_read_b128 v[48:51], v85 offset:31744
  v_smfmac_f32_16x16x64_bf16 v[60:63], v[4:7], v[224:231], v88
  s_waitcnt vmcnt(2)
  v_cmp_eq_u32 vcc, -1, v8
  v_smfmac_f32_16x16x64_bf16 v[56:59], v[4:7], a[224:231], v88
  ds_read_b128 v[100:103], v1 offset:3072
  s_waitcnt lgkmcnt(8)
  v_smfmac_f32_16x16x64_bf16 v[64:67], v[4:7], v[20:27], v88
  s_cbranch_vccnz L_QKM_g13
L_QKM_ok13:
  ds_read_b128 v[68:71], v84 offset:16384
  v_smfmac_f32_16x16x64_bf16 v[52:55], v[8:11], a[104:111], v88
  ds_read_b128 v[72:75], v84 offset:17408
  v_smfmac_f32_16x16x64_bf16 v[60:63], v[8:11], v[232:239], v88
  s_waitcnt vmcnt(1)
  v_cmp_eq_u32 vcc, -1, v12
  v_smfmac_f32_16x16x64_bf16 v[56:59], v[8:11], a[232:239], v88
  ds_read_b128 v[20:23], v1 offset:16384
  s_waitcnt lgkmcnt(9)
  v_smfmac_f32_16x16x64_bf16 v[64:67], v[8:11], v[28:35], v88
  s_cbranch_vccnz L_QKM_g14
L_QKM_ok14:
  ds_read_b128 v[24:27], v1 offset:17408
  v_smfmac_f32_16x16x64_bf16 v[52:55], v[12:15], a[112:119], v88
  ds_read_b128 v[28:31], v2 offset:16384
  v_smfmac_f32_16x16x64_bf16 v[60:63], v[12:15], v[240:247], v88
  s_waitcnt vmcnt(0)
  v_cmp_eq_u32 vcc, -1, v16
  v_smfmac_f32_16x16x64_bf16 v[56:59], v[12:15], a[240:247], v88
  ds_read_b128 v[32:35], v2 offset:17408
  s_waitcnt lgkmcnt(10)
  v_smfmac_f32_16x16x64_bf16 v[64:67], v[12:15], v[36:43], v88
  s_cbranch_vccnz L_QKM_g15
L_QKM_ok15:
  ds_read_b128 v[36:39], v3 offset:16384
  v_smfmac_f32_16x16x64_bf16 v[52:55], v[16:19], a[120:127], v88
  ds_read_b128 v[40:43], v3 offset:17408
  v_smfmac_f32_16x16x64_bf16 v[60:63], v[16:19], v[248:255], v88
  v_smfmac_f32_16x16x64_bf16 v[56:59], v[16:19], a[248:255], v88
  s_waitcnt lgkmcnt(9)
  v_smfmac_f32_16x16x64_bf16 v[64:67], v[16:19], v[44:51], v88
  s_nop 2
  v_pk_add_f32 v[52:53], v[52:53], v[54:55]
  s_nop 0
  v_pk_add_f32 v[60:61], v[60:61], v[62:63]
  v_cmp_u_f32 vcc, v52, v53
  v_cvt_pk_bf16_f32 v77, v52, v53
  v_cvt_pk_bf16_f32 v76, v60, v61
  v_pk_add_f32 v[56:57], v[56:57], v[58:59]
  v_pk_add_f32 v[64:65], v[64:65], v[66:67]
  v_cvt_pk_bf16_f32 v79, v56, v57
  v_cvt_pk_bf16_f32 v78, v64, v65
  ds_write_b128 v123, v[76:79]
  ds_read_b64_tr_b16 v[4:5], v124 offset:0
  ds_read_b64_tr_b16 v[6:7], v124 offset:8
  s_cbranch_vccnz L_QKM_nan
L_QKM_done:
  s_waitcnt lgkmcnt(2)
  s_barrier
  ds_read_b64_tr_b16 v[8:9], v125 offset:0
  ds_read_b64_tr_b16 v[10:11], v125 offset:8
  ds_read_b64_tr_b16 v[12:13], v126 offset:0
  ds_read_b64_tr_b16 v[14:15], v126 offset:8
  ds_read_b64_tr_b16 v[16:17], v127 offset:0
  ds_read_b64_tr_b16 v[18:19], v127 offset:8
  s_waitcnt lgkmcnt(6)
  v_mfma_f32_16x16x32_bf16 v[52:55], v[20:23], v[4:7], 0
  v_mfma_f32_16x16x32_bf16 v[56:59], v[24:27], v[4:7], 0
  v_mfma_f32_16x16x32_bf16 v[60:63], v[4:7], v[4:7], 0
  s_waitcnt lgkmcnt(4)
  v_mfma_f32_16x16x32_bf16 v[52:55], v[28:31], v[8:11], v[52:55]
  v_mfma_f32_16x16x32_bf16 v[56:59], v[32:35], v[8:11], v[56:59]
  v_mfma_f32_16x16x32_bf16 v[60:63], v[8:11], v[8:11], v[60:63]
  buffer_load_dwordx2 v[104:105], v92, s[4:7], s29 offen sc1
  buffer_load_dwordx2 v[106:107], v92, s[4:7], s35 offen sc1
  s_waitcnt lgkmcnt(2)
  v_mfma_f32_16x16x32_bf16 v[52:55], v[36:39], v[12:15], v[52:55]
  v_mfma_f32_16x16x32_bf16 v[56:59], v[40:43], v[12:15], v[56:59]
  v_mfma_f32_16x16x32_bf16 v[60:63], v[12:15], v[12:15], v[60:63]
  s_waitcnt lgkmcnt(0)
  v_mfma_f32_16x16x32_bf16 v[52:55], v[68:71], v[16:19], v[52:55]
  v_mfma_f32_16x16x32_bf16 v[56:59], v[72:75], v[16:19], v[56:59]
  v_mfma_f32_16x16x32_bf16 v[60:63], v[16:19], v[16:19], v[60:63]
  s_nop 5
  v_max3_f32 v64, v52, v53, v54
  v_max3_f32 v65, v55, v56, v57
  v_max3_f32 v64, v64, v58, v59
  v_max3_f32 v65, v65, v60, v61
  v_max_f32 v66, v64, v65
  v_max_f32 v67, v64, v65
  s_nop 1
  v_permlane16_swap_b32 v66, v67
  v_max_f32 v64, v66, v67
  v_max_f32 v65, v66, v67
  s_nop 1
  v_permlane32_swap_b32 v64, v65
  v_max_f32 v64, v64, v65
  v_mul_f32 v64, s38, v64
  v_pk_fma_f32 v[60:61], v[60:61], s[38:39], v[64:65] op_sel_hi:[1,1,0] neg_lo:[0,0,1] neg_hi:[0,0,1]
  v_pk_fma_f32 v[52:53], v[52:53], s[38:39], v[64:65] op_sel_hi:[1,1,0] neg_lo:[0,0,1] neg_hi:[0,0,1]
  v_exp_f32 v60, v60
  v_exp_f32 v61, v61
  v_pk_fma_f32 v[54:55], v[54:55], s[38:39], v[64:65] op_sel_hi:[1,1,0] neg_lo:[0,0,1] neg_hi:[0,0,1]
  v_pk_fma_f32 v[56:57], v[56:57], s[38:39], v[64:65] op_sel_hi:[1,1,0] neg_lo:[0,0,1] neg_hi:[0,0,1]
  v_pk_fma_f32 v[58:59], v[58:59], s[38:39], v[64:65] op_sel_hi:[1,1,0] neg_lo:[0,0,1] neg_hi:[0,0,1]
  v_cvt_pk_bf16_f32 v114, v60, v61
  v_cvt_pk_bf16_f32 v119, v60, v61
  s_waitcnt vmcnt(0)
  v_max3_u32 v89, v104, v105, v106
  v_max_u32 v89, v89, v107
  v_cmp_eq_u32 vcc, -1, v89
  v_mfma_f32_16x16x32_bf16 v[64:67], v[108:111], v[114:117], 0
  v_exp_f32 v52, v52
  v_exp_f32 v53, v53
  s_cbranch_vccnz L_QK_vbad
L_QK_vok:
  v_mfma_f32_16x16x32_bf16 v[44:47], v[104:107], v[114:117], 0
  v_exp_f32 v54, v54
  v_exp_f32 v55, v55
  v_mfma_f32_16x16x32_bf16 v[48:51], v[104:107], v[118:121], 0
  v_exp_f32 v56, v56
  v_exp_f32 v57, v57
  v_cvt_pk_bf16_f32 v76, v52, v53
  v_exp_f32 v58, v58
  v_exp_f32 v59, v59
  v_cvt_pk_bf16_f32 v77, v54, v55
  v_cvt_pk_bf16_f32 v78, v56, v57
  v_cvt_pk_bf16_f32 v79, v58, v59
  s_nop 1
  v_mfma_f32_16x16x32_bf16 v[64:67], v[108:111], v[76:79], v[64:67]
  v_mfma_f32_16x16x32_bf16 v[44:47], v[96:99], v[76:79], v[44:47]
  v_mfma_f32_16x16x32_bf16 v[48:51], v[100:103], v[76:79], v[48:51]
  buffer_store_dword v94, v91, s[4:7], s57 offen
  s_nop 4
  v_rcp_f32 v64, v64
  s_nop 0
  v_pk_mul_f32 v[44:45], v[44:45], v[64:65] op_sel_hi:[1,0]
  v_pk_mul_f32 v[46:47], v[46:47], v[64:65] op_sel_hi:[1,0]
  v_pk_mul_f32 v[48:49], v[48:49], v[64:65] op_sel_hi:[1,0]
  v_pk_mul_f32 v[50:51], v[50:51], v[64:65] op_sel_hi:[1,0]
  v_cvt_pk_bf16_f32 v52, v44, v45
  v_cvt_pk_bf16_f32 v53, v46, v47
  v_cvt_pk_bf16_f32 v54, v48, v49
  v_cvt_pk_bf16_f32 v55, v50, v51
  v_min_u32 v52, -2, v52
  v_min_u32 v53, -2, v53
  v_min_u32 v54, -2, v54
  v_min_u32 v55, -2, v55
  buffer_store_dwordx4 v[52:55], v122, s[4:7], s48 offen
  ds_read_b128 v[44:47], v1 offset:0
  ds_read_b128 v[48:51], v2 offset:1024
  ds_read_b128 v[76:79], v1 offset:19456
  s_add_u32 s32, s32, 786432
  s_add_u32 s33, s25, 2
  s_min_u32 s33, s33, 64
  s_xor_b32 s41, s49, 2048
  s_waitcnt lgkmcnt(0)
  buffer_store_dwordx4 v[52:55], v122, s[4:7], s28 offen sc1
  v_mfma_f32_16x16x32_bf16 v[56:59], v[20:23], v[44:47], 0
  v_mfma_f32_16x16x32_bf16 v[60:63], v[24:27], v[44:47], 0
  v_mfma_f32_16x16x32_bf16 v[64:67], v[4:7], v[44:47], 0
  ds_read_b128 v[20:23], v3 offset:0
  ds_read_b128 v[24:27], v2 offset:2048
  v_mfma_f32_16x16x32_bf16 v[56:59], v[28:31], v[48:51], v[56:59]
  v_mfma_f32_16x16x32_bf16 v[60:63], v[32:35], v[48:51], v[60:63]
  v_mfma_f32_16x16x32_bf16 v[64:67], v[8:11], v[48:51], v[64:67]
  ds_read_b128 v[28:31], v84 offset:1024
  ds_read_b128 v[32:35], v2 offset:3072
  s_waitcnt lgkmcnt(3)
  v_mfma_f32_16x16x32_bf16 v[56:59], v[36:39], v[20:23], v[56:59]
  v_mfma_f32_16x16x32_bf16 v[60:63], v[40:43], v[20:23], v[60:63]
  v_mfma_f32_16x16x32_bf16 v[64:67], v[12:15], v[20:23], v[64:67]
  s_waitcnt lgkmcnt(0)
  v_mfma_f32_16x16x32_bf16 v[56:59], v[68:71], v[28:31], v[56:59]
  v_mfma_f32_16x16x32_bf16 v[60:63], v[72:75], v[28:31], v[60:63]
  v_mfma_f32_16x16x32_bf16 v[64:67], v[16:19], v[28:31], v[64:67]
  buffer_load_dword v89, v87, s[4:7], s28 offen sc1
  s_cmp_lg_u32 s20, 1
  s_cbranch_scc1 Lskip_57
Lask_55:
  s_min_i32 s47, s100, s101
  s_cmp_ge_i32 s47, s33
  s_cbranch_scc1 Lhave_56
  s_load_dwordx2 s[100:101], s[4:5], s59 glc
  s_sub_u32 s24, s24, 1
  s_cbranch_scc1 L_FAIL
  s_waitcnt lgkmcnt(0)
  s_branch Lask_55
Lhave_56:
  s_add_u32 s33, s33, 2
  s_min_u32 s33, s33, 64
  s_cmp_ge_i32 s47, s33
  s_cbranch_scc1 Lskip_57
  s_load_dwordx2 s[100:101], s[4:5], s59 glc
Lskip_57:
  s_barrier
  s_add_u32 m0, s58, 16384
  s_add_u32 s31, s32, 8192
  buffer_load_dwordx4 v95, s[4:7], s31 offen offset:0 sc1 lds
  v_cndmask_b32 v56, v86, v56, s[8:9]
  v_cndmask_b32 v57, v86, v57, s[10:11]
  v_cndmask_b32 v58, v86, v58, s[16:17]
  v_cndmask_b32 v59, v86, v59, s[18:19]
  buffer_load_dwordx4 v95, s[4:7], s31 offen offset:1024 sc1 lds
  v_cndmask_b32 v60, v86, v60, s[42:43]
  v_cndmask_b32 v61, v86, v61, s[44:45]
  v_cndmask_b32 v62, v86, v62, s[52:53]
  v_cndmask_b32 v63, v86, v63, s[54:55]
  s_add_u32 m0, s58, 2048
  s_add_u32 s31, s32, 16384
  buffer_load_dwordx4 v95, s[4:7], s31 offen offset:0 sc1 lds
  v_max3_f32 v72, v56, v57, v58
  v_max3_f32 v73, v59, v60, v61
  v_max3_f32 v72, v72, v62, v63
  v_max3_f32 v73, v73, v64, v65
  buffer_load_dwordx4 v95, s[4:7], s31 offen offset:1024 sc1 lds
  v_max_f32 v74, v72, v73
  v_max_f32 v75, v72, v73
  v_mov_b64 v[68:69], -1
  v_mov_b64 v[70:71], -1
  s_mov_b32 m0, s58
  s_add_u32 s31, s32, s46
  buffer_load_dwordx4 v95, s[4:7], s31 offen offset:0 sc1 lds
  v_permlane16_swap_b32 v74, v75
  v_max_f32 v72, v74, v75
  v_max_f32 v73, v74, v75
  s_nop 1
  v_permlane32_swap_b32 v72, v73
  s_sub_u32 s31, s32, s46
  buffer_load_dwordx4 v95, s[4:7], s31 offen offset:1024 sc1 lds
  v_max_f32 v72, v72, v73
  v_mul_f32 v72, s38, v72
  v_pk_fma_f32 v[56:57], v[56:57], s[38:39], v[72:73] op_sel_hi:[1,1,0] neg_lo:[0,0,1] neg_hi:[0,0,1]
  v_pk_fma_f32 v[58:59], v[58:59], s[38:39], v[72:73] op_sel_hi:[1,1,0] neg_lo:[0,0,1] neg_hi:[0,0,1]
  buffer_store_dwordx4 v[68:71], v122, s[4:7], s34 offen sc1
  v_pk_fma_f32 v[60:61], v[60:61], s[38:39], v[72:73] op_sel_hi:[1,1,0] neg_lo:[0,0,1] neg_hi:[0,0,1]
  v_pk_fma_f32 v[62:63], v[62:63], s[38:39], v[72:73] op_sel_hi:[1,1,0] neg_lo:[0,0,1] neg_hi:[0,0,1]
  v_pk_fma_f32 v[64:65], v[64:65], s[38:39], v[72:73] op_sel_hi:[1,1,0] neg_lo:[0,0,1] neg_hi:[0,0,1]
  v_exp_f32 v56, v56
  s_xor_b32 s40, s34, 8192
  buffer_store_dwordx4 v[68:71], v122, s[4:7], s40 offen
  v_exp_f32 v57, v57
  v_exp_f32 v58, v58
  v_exp_f32 v59, v59
  v_exp_f32 v60, v60
  v_exp_f32 v61, v61
  v_exp_f32 v62, v62
  v_exp_f32 v63, v63
  v_exp_f32 v64, v64
  v_exp_f32 v65, v65
  v_cvt_pk_bf16_f32 v36, v56, v57
  v_cvt_pk_bf16_f32 v37, v58, v59
  v_cvt_pk_bf16_f32 v38, v60, v61
  v_cvt_pk_bf16_f32 v39, v62, v63
  v_cvt_pk_bf16_f32 v114, v64, v65
  v_cvt_pk_bf16_f32 v119, v64, v65
  s_cmp_ge_u32 s25, 0
  s_addc_u32 s50, s25, 0
  s_add_u32 s25, s25, 1
  v_mfma_f32_16x16x32_bf16 v[40:43], v[108:111], v[36:39], 0
  s_and_b32 s40, s25, 3
  s_lshl_b32 s40, s40, 16
  s_add_u32 s27, s40, s26
  v_mfma_f32_16x16x32_bf16 v[52:55], v[96:99], v[36:39], 0
  s_add_u32 s27, s27, 1048576
  s_xor_b32 s37, s27, s36
  s_lshl_b32 s40, s40, 2
  v_mfma_f32_16x16x32_bf16 v[56:59], v[100:103], v[36:39], 0
  s_add_u32 s28, s40, s26
  s_lshr_b32 s40, s40, 5
  s_and_b32 s40, s40, 0x4000
  v_mfma_f32_16x16x32_bf16 v[60:63], v[24:27], v[36:39], 0
  s_xor_b32 s28, s28, s40
  s_xor_b32 s29, s28, 0x4000
  s_xor_b32 s34, s28, 0x84000
  v_mfma_f32_16x16x32_bf16 v[64:67], v[32:35], v[36:39], 0
  s_xor_b32 s48, s28, 8192
  s_lshr_b32 s40, s46, 1
  s_add_u32 s29, s29, s40
  v_mfma_f32_16x16x32_bf16 v[40:43], v[108:111], v[114:117], v[40:43]
  s_xor_b32 s35, s29, 512
  s_add_u32 s92, s37, s88
  s_add_u32 s96, s27, s88
  v_mfma_f32_16x16x32_bf16 v[52:55], v[104:107], v[114:117], v[52:55]
  s_xor_b32 s96, s96, 0x1000
  s_add_u32 s93, s37, s89
  s_add_u32 s97, s27, s89
  v_mfma_f32_16x16x32_bf16 v[56:59], v[104:107], v[118:121], v[56:59]
  s_xor_b32 s97, s97, 0x1000
  s_add_u32 s94, s37, s90
  s_add_u32 s98, s27, s90
  v_mfma_f32_16x16x32_bf16 v[60:63], v[104:107], v[112:115], v[60:63]
  s_xor_b32 s98, s98, 0x1000
  s_add_u32 s95, s37, s91
  s_add_u32 s99, s27, s91
  v_mfma_f32_16x16x32_bf16 v[64:67], v[104:107], v[116:119], v[64:67]
  s_xor_b32 s99, s99, 0x1000
  v_rcp_f32 v40, v40
  s_nop 0
  v_pk_mul_f32 v[52:53], v[52:53], v[40:41] op_sel_hi:[1,0]
  v_pk_mul_f32 v[54:55], v[54:55], v[40:41] op_sel_hi:[1,0]
  v_pk_mul_f32 v[56:57], v[56:57], v[40:41] op_sel_hi:[1,0]
  v_pk_mul_f32 v[58:59], v[58:59], v[40:41] op_sel_hi:[1,0]
  v_pk_mul_f32 v[60:61], v[60:61], v[40:41] op_sel_hi:[1,0]
  v_pk_mul_f32 v[62:63], v[62:63], v[40:41] op_sel_hi:[1,0]
  v_pk_mul_f32 v[64:65], v[64:65], v[40:41] op_sel_hi:[1,0]
  v_pk_mul_f32 v[66:67], v[66:67], v[40:41] op_sel_hi:[1,0]
  v_cvt_pk_bf16_f32 v4, v52, v53
  v_cvt_pk_bf16_f32 v5, v54, v55
  v_cvt_pk_bf16_f32 v6, v56, v57
  v_cvt_pk_bf16_f32 v7, v58, v59
  v_cvt_pk_bf16_f32 v80, v60, v61
  v_cvt_pk_bf16_f32 v81, v62, v63
  v_cvt_pk_bf16_f32 v82, v64, v65
  v_cvt_pk_bf16_f32 v83, v66, v67
  ds_write_b128 v1, v[4:7] offset:19456
  s_mov_b32 s49, s30
  s_add_u32 s30, s30, 262144
  s_cmp_lt_u32 s50, s25
  s_cbranch_scc1 L_QK_keep
  s_xor_b32 s41, s49, 2048
  buffer_store_dwordx4 v[4:7], v95, s[4:7], s49 offen sc1
  buffer_store_dwordx4 v[80:83], v95, s[4:7], s41 offen sc1
L_QK_keep:
  s_nop 1
  s_branch L_QK_top
L_QK_end:
  s_branch L_END
L_QKM_nan:
  s_cmp_eq_u32 s51, s25
  s_cbranch_scc1 L_QKM_done
  s_mov_b32 s51, s25
  s_add_u32 s60, s60, 0x10000
  s_waitcnt vmcnt(0) lgkmcnt(0)
L_QKM_v0:
  s_sub_u32 s24, s24, 1
  s_cbranch_scc1 L_FAIL
  buffer_load_dwordx4 v[96:99], v95, s[4:7], s92 offen offset:0 sc1
  buffer_load_dwordx4 v[100:103], v95, s[4:7], s92 offen offset:2048 sc1
  buffer_load_dwordx4 v[68:71], v95, s[4:7], s93 offen offset:0 sc1
  buffer_load_dwordx4 v[72:75], v95, s[4:7], s93 offen offset:2048 sc1
  v_mov_b32 v89, 0
  s_waitcnt vmcnt(0)
  v_max3_u32 v89, v96, v97, v89
  v_max3_u32 v89, v98, v99, v89
  v_max3_u32 v89, v100, v101, v89
  v_max3_u32 v89, v102, v103, v89
  v_max3_u32 v89, v68, v69, v89
  v_max3_u32 v89, v70, v71, v89
  v_max3_u32 v89, v72, v73, v89
  v_max3_u32 v89, v74, v75, v89
  v_cmp_eq_u32 vcc, -1, v89
  s_cbranch_vccnz L_QKM_v0
L_QKM_v4:
  s_sub_u32 s24, s24, 1
  s_cbranch_scc1 L_FAIL
  buffer_load_dwordx4 v[4:7], v95, s[4:7], s94 offen offset:0 sc1
  buffer_load_dwordx4 v[8:11], v95, s[4:7], s94 offen offset:2048 sc1
  buffer_load_dwordx4 v[12:15], v95, s[4:7], s95 offen offset:0 sc1
  buffer_load_dwordx4 v[16:19], v95, s[4:7], s95 offen offset:2048 sc1
  v_mov_b32 v89, 0
  s_waitcnt vmcnt(0)
  v_max3_u32 v89, v4, v5, v89
  v_max3_u32 v89, v6, v7, v89
  v_max3_u32 v89, v8, v9, v89
  v_max3_u32 v89, v10, v11, v89
  v_max3_u32 v89, v12, v13, v89
  v_max3_u32 v89, v14, v15, v89
  v_max3_u32 v89, v16, v17, v89
  v_max3_u32 v89, v18, v19, v89
  v_cmp_eq_u32 vcc, -1, v89
  s_cbranch_vccnz L_QKM_v4
L_QKM_v8:
  s_sub_u32 s24, s24, 1
  s_cbranch_scc1 L_FAIL
  buffer_load_dwordx4 v[96:99], v95, s[4:7], s96 offen offset:0 sc1
  buffer_load_dwordx4 v[100:103], v95, s[4:7], s96 offen offset:2048 sc1
  buffer_load_dwordx4 v[68:71], v95, s[4:7], s97 offen offset:0 sc1
  buffer_load_dwordx4 v[72:75], v95, s[4:7], s97 offen offset:2048 sc1
  v_mov_b32 v89, 0
  s_waitcnt vmcnt(0)
  v_max3_u32 v89, v96, v97, v89
  v_max3_u32 v89, v98, v99, v89
  v_max3_u32 v89, v100, v101, v89
  v_max3_u32 v89, v102, v103, v89
  v_max3_u32 v89, v68, v69, v89
  v_max3_u32 v89, v70, v71, v89
  v_max3_u32 v89, v72, v73, v89
  v_max3_u32 v89, v74, v75, v89
  v_cmp_eq_u32 vcc, -1, v89
  s_cbranch_vccnz L_QKM_v8
L_QKM_v12:
  s_sub_u32 s24, s24, 1
  s_cbranch_scc1 L_FAIL
  buffer_load_dwordx4 v[4:7], v95, s[4:7], s98 offen offset:0 sc1
  buffer_load_dwordx4 v[8:11], v95, s[4:7], s98 offen offset:2048 sc1
  buffer_load_dwordx4 v[12:15], v95, s[4:7], s99 offen offset:0 sc1
  buffer_load_dwordx4 v[16:19], v95, s[4:7], s99 offen offset:2048 sc1
  v_mov_b32 v89, 0
  s_waitcnt vmcnt(0)
  v_max3_u32 v89, v4, v5, v89
  v_max3_u32 v89, v6, v7, v89
  v_max3_u32 v89, v8, v9, v89
  v_max3_u32 v89, v10, v11, v89
  v_max3_u32 v89, v12, v13, v89
  v_max3_u32 v89, v14, v15, v89
  v_max3_u32 v89, v16, v17, v89
  v_max3_u32 v89, v18, v19, v89
  v_cmp_eq_u32 vcc, -1, v89
  s_cbranch_vccnz L_QKM_v12
  v_mov_b64 v[52:53], 0
  v_mov_b64 v[54:55], 0
  v_mov_b64 v[56:57], 0
  v_mov_b64 v[58:59], 0
  v_mov_b64 v[60:61], 0
  v_mov_b64 v[62:63], 0
  v_mov_b64 v[64:65], 0
  v_mov_b64 v[66:67], 0
  ds_read_b128 v[20:23], v85 offset:0
  ds_read_b128 v[24:27], v85 offset:1024
  ds_read_b128 v[28:31], v85 offset:8192
  ds_read_b128 v[32:35], v85 offset:9216
  ds_read_b128 v[36:39], v85 offset:2048
  ds_read_b128 v[40:43], v85 offset:3072
  ds_read_b128 v[44:47], v85 offset:10240
  ds_read_b128 v[48:51], v85 offset:11264
  s_waitcnt lgkmcnt(0)
  s_branch L_QKM_again
L_QKM_g8:
  s_sub_u32 s24, s24, 1
  s_cbranch_scc1 L_FAIL
  s_add_u32 s60, s60, 256
  buffer_load_dwordx4 v[96:99], v95, s[4:7], s96 offen offset:0 sc1
  s_waitcnt vmcnt(0)
  v_cmp_eq_u32 vcc, -1, v96
  s_cbranch_vccnz L_QKM_g8
  buffer_load_dwordx4 v[100:103], v95, s[4:7], s96 offen offset:2048 sc1
  s_nop 0
  buffer_load_dwordx4 v[68:71], v95, s[4:7], s97 offen offset:0 sc1
  s_nop 0
  buffer_load_dwordx4 v[72:75], v95, s[4:7], s97 offen offset:2048 sc1
  s_nop 0
  buffer_load_dwordx4 v[4:7], v95, s[4:7], s98 offen offset:0 sc1
  s_nop 0
  buffer_load_dwordx4 v[8:11], v95, s[4:7], s98 offen offset:2048 sc1
  s_nop 0
  buffer_load_dwordx4 v[12:15], v95, s[4:7], s99 offen offset:0 sc1
  s_nop 0
  s_branch L_QKM_ok8
L_QKM_g9:
  s_sub_u32 s24, s24, 1
  s_cbranch_scc1 L_FAIL
  s_add_u32 s60, s60, 256
  buffer_load_dwordx4 v[100:103], v95, s[4:7], s96 offen offset:2048 sc1
  s_waitcnt vmcnt(0)
  v_cmp_eq_u32 vcc, -1, v100
  s_cbranch_vccnz L_QKM_g9
  buffer_load_dwordx4 v[68:71], v95, s[4:7], s97 offen offset:0 sc1
  s_nop 0
  buffer_load_dwordx4 v[72:75], v95, s[4:7], s97 offen offset:2048 sc1
  s_nop 0
  buffer_load_dwordx4 v[4:7], v95, s[4:7], s98 offen offset:0 sc1
  s_nop 0
  buffer_load_dwordx4 v[8:11], v95, s[4:7], s98 offen offset:2048 sc1
  s_nop 0
  buffer_load_dwordx4 v[12:15], v95, s[4:7], s99 offen offset:0 sc1
  s_nop 0
  buffer_load_dwordx4 v[16:19], v95, s[4:7], s99 offen offset:2048 sc1
  s_nop 0
  s_branch L_QKM_ok9
L_QKM_g10:
  s_sub_u32 s24, s24, 1
  s_cbranch_scc1 L_FAIL
  s_add_u32 s60, s60, 256
  buffer_load_dwordx4 v[68:71], v95, s[4:7], s97 offen offset:0 sc1
  s_waitcnt vmcnt(0)
  v_cmp_eq_u32 vcc, -1, v68
  s_cbranch_vccnz L_QKM_g10
  buffer_load_dwordx4 v[72:75], v95, s[4:7], s97 offen offset:2048 sc1
  s_nop 0
  buffer_load_dwordx4 v[4:7], v95, s[4:7], s98 offen offset:0 sc1
  s_nop 0
  buffer_load_dwordx4 v[8:11], v95, s[4:7], s98 offen offset:2048 sc1
  s_nop 0
  buffer_load_dwordx4 v[12:15], v95, s[4:7], s99 offen offset:0 sc1
  s_nop 0
  buffer_load_dwordx4 v[16:19], v95, s[4:7], s99 offen offset:2048 sc1
  s_nop 0
  s_branch L_QKM_ok10
L_QKM_g11:
  s_sub_u32 s24, s24, 1
  s_cbranch_scc1 L_FAIL
  s_add_u32 s60, s60, 256
  buffer_load_dwordx4 v[72:75], v95, s[4:7], s97 offen offset:2048 sc1
  s_waitcnt vmcnt(0)
  v_cmp_eq_u32 vcc, -1, v72
  s_cbranch_vccnz L_QKM_g11
  buffer_load_dwordx4 v[4:7], v95, s[4:7], s98 offen offset:0 sc1
  s_nop 0
  buffer_load_dwordx4 v[8:11], v95, s[4:7], s98 offen offset:2048 sc1
  s_nop 0
  buffer_load_dwordx4 v[12:15], v95, s[4:7], s99 offen offset:0 sc1
  s_nop 0
  buffer_load_dwordx4 v[16:19], v95, s[4:7], s99 offen offset:2048 sc1
  s_nop 0
  s_branch L_QKM_ok11
L_QKM_g12:
  s_sub_u32 s24, s24, 1
  s_cbranch_scc1 L_FAIL
  s_add_u32 s60, s60, 256
  buffer_load_dwordx4 v[4:7], v95, s[4:7], s98 offen offset:0 sc1
  s_waitcnt vmcnt(0)
  v_cmp_eq_u32 vcc, -1, v4
  s_cbranch_vccnz L_QKM_g12
  buffer_load_dwordx4 v[8:11], v95, s[4:7], s98 offen offset:2048 sc1
  s_nop 0
  buffer_load_dwordx4 v[12:15], v95, s[4:7], s99 offen offset:0 sc1
  s_nop 0
  buffer_load_dwordx4 v[16:19], v95, s[4:7], s99 offen offset:2048 sc1
  s_nop 0
  s_branch L_QKM_ok12
L_QKM_g13:
  s_sub_u32 s24, s24, 1
  s_cbranch_scc1 L_FAIL
  s_add_u32 s60, s60, 256
  buffer_load_dwordx4 v[8:11], v95, s[4:7], s98 offen offset:2048 sc1
  s_waitcnt vmcnt(0)
  v_cmp_eq_u32 vcc, -1, v8
  s_cbranch_vccnz L_QKM_g13
  buffer_load_dwordx4 v[12:15], v95, s[4:7], s99 offen offset:0 sc1
  s_nop 0
  buffer_load_dwordx4 v[16:19], v95, s[4:7], s99 offen offset:2048 sc1
  s_nop 0
  s_branch L_QKM_ok13
L_QKM_g14:
  s_sub_u32 s24, s24, 1
  s_cbranch_scc1 L_FAIL
  s_add_u32 s60, s60, 256
  buffer_load_dwordx4 v[12:15], v95, s[4:7], s99 offen offset:0 sc1
  s_waitcnt vmcnt(0)
  v_cmp_eq_u32 vcc, -1, v12
  s_cbranch_vccnz L_QKM_g14
  buffer_load_dwordx4 v[16:19], v95, s[4:7], s99 offen offset:2048 sc1
  s_nop 0
  s_branch L_QKM_ok14
L_QKM_g15:
  s_sub_u32 s24, s24, 1
  s_cbranch_scc1 L_FAIL
  s_add_u32 s60, s60, 256
  buffer_load_dwordx4 v[16:19], v95, s[4:7], s99 offen offset:2048 sc1
  s_waitcnt vmcnt(0)
  v_cmp_eq_u32 vcc, -1, v16
  s_cbranch_vccnz L_QKM_g15
  s_branch L_QKM_ok15
L_QK_vbad:
  s_sub_u32 s24, s24, 1
  s_cbranch_scc1 L_FAIL
  s_add_u32 s61, s61, 1
  buffer_load_dwordx2 v[104:105], v92, s[4:7], s29 offen sc1
  buffer_load_dwordx2 v[106:107], v92, s[4:7], s35 offen sc1
  s_waitcnt vmcnt(0)
  v_max3_u32 v89, v104, v105, v106
  v_max_u32 v89, v89, v107
  v_cmp_eq_u32 vcc, -1, v89
  s_cbranch_vccnz L_QK_vbad
  s_branch L_QK_vok
L_VO:
  v_bfe_u32 v76, v0, 3, 2
  v_xor_b32 v76, s20, v76
  v_lshlrev_b32 v76, 5, v76
  v_lshrrev_b32 v4, 2, v0
  v_lshl_add_u32 v4, v4, 7, v76
  v_and_b32 v76, 3, v0
  v_lshl_add_u32 v4, v76, 3, v4
  s_lshl_b32 s40, s20, 15
  v_add_u32 v4, s40, v4
  v_lshl_add_u32 v85, v0, 4, s40
  s_lshl_b32 s40, s20, 12
  s_add_u32 s40, s40, 131072
  v_lshl_add_u32 v1, v0, 4, s40
  s_lshr_b32 s54, s21, 4
  s_lshl_b32 s52, s54, 22
  s_sub_u32 s53, 0, s52
  v_xor_b32 v5, 32768, v4
  v_xor_b32 v2, 4096, v1
  v_xor_b32 v6, 65536, v4
  v_xor_b32 v3, 8192, v1
  v_xor_b32 v7, 98304, v4
  v_xor_b32 v84, 12288, v1
  v_bfe_u32 v8, v0, 5, 1
  v_mul_u32_u24 v8, 16384, v8
  v_bfe_u32 v76, v0, 4, 1
  v_mul_u32_u24 v76, 32768, v76
  v_add_u32 v8, v8, v76
  v_bfe_u32 v76, v0, 3, 1
  v_mul_u32_u24 v76, 131072, v76
  v_add_u32 v8, v8, v76
  v_lshrrev_b32 v76, 3, v0
  v_and_b32 v76, 6, v76
  v_xor_b32 v76, v76, v0
  v_and_b32 v76, 7, v76
  v_lshl_add_u32 v8, v76, 4, v8
  s_lshl_b32 s40, s20, 19
  v_add_u32 v8, s40, v8
  s_lshl_b32 s44, s21, 8
  s_add_u32 s45, s44, 128
  s_load_dwordx2 s[8:9], s[0:1], 32
  s_mov_b32 s10, 8388608
  s_mov_b32 s11, 0x20000
  s_waitcnt lgkmcnt(0)
  v_add_u32 v9, s44, v8
  v_add_u32 v10, s45, v8
  s_lshl_b32 s41, s20, 15
  s_add_u32 m0, s41, 0
  s_add_u32 s42, s52, 0
  buffer_load_dwordx4 v9, s[8:11], s42 offen lds
  s_add_u32 m0, s41, 1024
  s_add_u32 s42, s52, 65536
  buffer_load_dwordx4 v9, s[8:11], s42 offen lds
  s_add_u32 m0, s41, 2048
  s_add_u32 s42, s52, 8192
  buffer_load_dwordx4 v9, s[8:11], s42 offen lds
  s_add_u32 m0, s41, 3072
  s_add_u32 s42, s52, 73728
  buffer_load_dwordx4 v9, s[8:11], s42 offen lds
  s_add_u32 m0, s41, 4096
  s_add_u32 s42, s52, 262144
  buffer_load_dwordx4 v9, s[8:11], s42 offen lds
  s_add_u32 m0, s41, 5120
  s_add_u32 s42, s52, 327680
  buffer_load_dwordx4 v9, s[8:11], s42 offen lds
  s_add_u32 m0, s41, 6144
  s_add_u32 s42, s52, 270336
  buffer_load_dwordx4 v9, s[8:11], s42 offen lds
  s_add_u32 m0, s41, 7168
  s_add_u32 s42, s52, 335872
  buffer_load_dwordx4 v9, s[8:11], s42 offen lds
  s_add_u32 m0, s41, 8192
  s_add_u32 s42, s52, 2097152
  buffer_load_dwordx4 v9, s[8:11], s42 offen lds
  s_add_u32 m0, s41, 9216
  s_add_u32 s42, s52, 2162688
  buffer_load_dwordx4 v9, s[8:11], s42 offen lds
  s_add_u32 m0, s41, 10240
  s_add_u32 s42, s52, 2105344
  buffer_load_dwordx4 v9, s[8:11], s42 offen lds
  s_add_u32 m0, s41, 11264
  s_add_u32 s42, s52, 2170880
  buffer_load_dwordx4 v9, s[8:11], s42 offen lds
  s_add_u32 m0, s41, 12288
  s_add_u32 s42, s52, 2359296
  buffer_load_dwordx4 v9, s[8:11], s42 offen lds
  s_add_u32 m0, s41, 13312
  s_add_u32 s42, s52, 2424832
  buffer_load_dwordx4 v9, s[8:11], s42 offen lds
  s_add_u32 m0, s41, 14336
  s_add_u32 s42, s52, 2367488
  buffer_load_dwordx4 v9, s[8:11], s42 offen lds
  s_add_u32 m0, s41, 15360
  s_add_u32 s42, s52, 2433024
  buffer_load_dwordx4 v9, s[8:11], s42 offen lds
  s_add_u32 m0, s41, 16384
  s_add_u32 s42, s53, 4194304
  buffer_load_dwordx4 v9, s[8:11], s42 offen lds
  s_add_u32 m0, s41, 17408
  s_add_u32 s42, s53, 4259840
  buffer_load_dwordx4 v9, s[8:11], s42 offen lds
  s_add_u32 m0, s41, 18432
  s_add_u32 s42, s53, 4202496
  buffer_load_dwordx4 v9, s[8:11], s42 offen lds
  s_add_u32 m0, s41, 19456
  s_add_u32 s42, s53, 4268032
  buffer_load_dwordx4 v9, s[8:11], s42 offen lds
  s_add_u32 m0, s41, 20480
  s_add_u32 s42, s53, 4456448
  buffer_load_dwordx4 v9, s[8:11], s42 offen lds
  s_add_u32 m0, s41, 21504
  s_add_u32 s42, s53, 4521984
  buffer_load_dwordx4 v9, s[8:11], s42 offen lds
  s_add_u32 m0, s41, 22528
  s_add_u32 s42, s53, 4464640
  buffer_load_dwordx4 v9, s[8:11], s42 offen lds
  s_add_u32 m0, s41, 23552
  s_add_u32 s42, s53, 4530176
  buffer_load_dwordx4 v9, s[8:11], s42 offen lds
  s_waitcnt vmcnt(16) lgkmcnt(0)
  s_barrier
  s_add_u32 m0, s41, 24576
  s_add_u32 s42, s53, 6291456
  buffer_load_dwordx4 v9, s[8:11], s42 offen lds
  s_add_u32 m0, s41, 25600
  s_add_u32 s42, s53, 6356992
  buffer_load_dwordx4 v9, s[8:11], s42 offen lds
  s_add_u32 m0, s41, 26624
  s_add_u32 s42, s53, 6299648
  buffer_load_dwordx4 v9, s[8:11], s42 offen lds
  s_add_u32 m0, s41, 27648
  s_add_u32 s42, s53, 6365184
  buffer_load_dwordx4 v9, s[8:11], s42 offen lds
  s_add_u32 m0, s41, 28672
  s_add_u32 s42, s53, 6553600
  buffer_load_dwordx4 v9, s[8:11], s42 offen lds
  s_add_u32 m0, s41, 29696
  s_add_u32 s42, s53, 6619136
  buffer_load_dwordx4 v9, s[8:11], s42 offen lds
  s_add_u32 m0, s41, 30720
  s_add_u32 s42, s53, 6561792
  buffer_load_dwordx4 v9, s[8:11], s42 offen lds
  s_add_u32 m0, s41, 31744
  s_add_u32 s42, s53, 6627328
  buffer_load_dwordx4 v9, s[8:11], s42 offen lds
  ds_read_b64_tr_b16 v[128:129], v4 offset:0
  ds_read_b64_tr_b16 v[130:131], v4 offset:2048
  ds_read_b64_tr_b16 v[132:133], v4 offset:4096
  ds_read_b64_tr_b16 v[134:135], v4 offset:6144
  ds_read_b64_tr_b16 v[144:145], v5 offset:0
  ds_read_b64_tr_b16 v[146:147], v5 offset:2048
  ds_read_b64_tr_b16 v[148:149], v5 offset:4096
  ds_read_b64_tr_b16 v[150:151], v5 offset:6144
  ds_read_b64_tr_b16 v[160:161], v6 offset:0
  ds_read_b64_tr_b16 v[162:163], v6 offset:2048
  ds_read_b64_tr_b16 v[164:165], v6 offset:4096
  ds_read_b64_tr_b16 v[166:167], v6 offset:6144
  ds_read_b64_tr_b16 v[176:177], v7 offset:0
  ds_read_b64_tr_b16 v[178:179], v7 offset:2048
  ds_read_b64_tr_b16 v[180:181], v7 offset:4096
  ds_read_b64_tr_b16 v[182:183], v7 offset:6144
  s_waitcnt vmcnt(16) lgkmcnt(0)
  s_barrier
  s_add_u32 m0, s41, 0
  s_add_u32 s42, s52, 0
  buffer_load_dwordx4 v10, s[8:11], s42 offen lds
  s_add_u32 m0, s41, 1024
  s_add_u32 s42, s52, 65536
  buffer_load_dwordx4 v10, s[8:11], s42 offen lds
  s_add_u32 m0, s41, 2048
  s_add_u32 s42, s52, 8192
  buffer_load_dwordx4 v10, s[8:11], s42 offen lds
  s_add_u32 m0, s41, 3072
  s_add_u32 s42, s52, 73728
  buffer_load_dwordx4 v10, s[8:11], s42 offen lds
  s_add_u32 m0, s41, 4096
  s_add_u32 s42, s52, 262144
  buffer_load_dwordx4 v10, s[8:11], s42 offen lds
  s_add_u32 m0, s41, 5120
  s_add_u32 s42, s52, 327680
  buffer_load_dwordx4 v10, s[8:11], s42 offen lds
  s_add_u32 m0, s41, 6144
  s_add_u32 s42, s52, 270336
  buffer_load_dwordx4 v10, s[8:11], s42 offen lds
  s_add_u32 m0, s41, 7168
  s_add_u32 s42, s52, 335872
  buffer_load_dwordx4 v10, s[8:11], s42 offen lds
  ds_read_b64_tr_b16 v[136:137], v4 offset:8192
  ds_read_b64_tr_b16 v[138:139], v4 offset:10240
  ds_read_b64_tr_b16 v[140:141], v4 offset:12288
  ds_read_b64_tr_b16 v[142:143], v4 offset:14336
  ds_read_b64_tr_b16 v[152:153], v5 offset:8192
  ds_read_b64_tr_b16 v[154:155], v5 offset:10240
  ds_read_b64_tr_b16 v[156:157], v5 offset:12288
  ds_read_b64_tr_b16 v[158:159], v5 offset:14336
  ds_read_b64_tr_b16 v[168:169], v6 offset:8192
  ds_read_b64_tr_b16 v[170:171], v6 offset:10240
  ds_read_b64_tr_b16 v[172:173], v6 offset:12288
  ds_read_b64_tr_b16 v[174:175], v6 offset:14336
  ds_read_b64_tr_b16 v[184:185], v7 offset:8192
  ds_read_b64_tr_b16 v[186:187], v7 offset:10240
  ds_read_b64_tr_b16 v[188:189], v7 offset:12288
  ds_read_b64_tr_b16 v[190:191], v7 offset:14336
  s_waitcnt vmcnt(16) lgkmcnt(0)
  s_barrier
  s_add_u32 m0, s41, 8192
  s_add_u32 s42, s52, 2097152
  buffer_load_dwordx4 v10, s[8:11], s42 offen lds
  s_add_u32 m0, s41, 9216
  s_add_u32 s42, s52, 2162688
  buffer_load_dwordx4 v10, s[8:11], s42 offen lds
  s_add_u32 m0, s41, 10240
  s_add_u32 s42, s52, 2105344
  buffer_load_dwordx4 v10, s[8:11], s42 offen lds
  s_add_u32 m0, s41, 11264
  s_add_u32 s42, s52, 2170880
  buffer_load_dwordx4 v10, s[8:11], s42 offen lds
  s_add_u32 m0, s41, 12288
  s_add_u32 s42, s52, 2359296
  buffer_load_dwordx4 v10, s[8:11], s42 offen lds
  s_add_u32 m0, s41, 13312
  s_add_u32 s42, s52, 2424832
  buffer_load_dwordx4 v10, s[8:11], s42 offen lds
  s_add_u32 m0, s41, 14336
  s_add_u32 s42, s52, 2367488
  buffer_load_dwordx4 v10, s[8:11], s42 offen lds
  s_add_u32 m0, s41, 15360
  s_add_u32 s42, s52, 2433024
  buffer_load_dwordx4 v10, s[8:11], s42 offen lds
  ds_read_b64_tr_b16 v[192:193], v4 offset:16384
  ds_read_b64_tr_b16 v[194:195], v4 offset:18432
  ds_read_b64_tr_b16 v[196:197], v4 offset:20480
  ds_read_b64_tr_b16 v[198:199], v4 offset:22528
  ds_read_b64_tr_b16 v[208:209], v5 offset:16384
  ds_read_b64_tr_b16 v[210:211], v5 offset:18432
  ds_read_b64_tr_b16 v[212:213], v5 offset:20480
  ds_read_b64_tr_b16 v[214:215], v5 offset:22528
  ds_read_b64_tr_b16 v[224:225], v6 offset:16384
  ds_read_b64_tr_b16 v[226:227], v6 offset:18432
  ds_read_b64_tr_b16 v[228:229], v6 offset:20480
  ds_read_b64_tr_b16 v[230:231], v6 offset:22528
  ds_read_b64_tr_b16 v[240:241], v7 offset:16384
  ds_read_b64_tr_b16 v[242:243], v7 offset:18432
  ds_read_b64_tr_b16 v[244:245], v7 offset:20480
  ds_read_b64_tr_b16 v[246:247], v7 offset:22528
  s_waitcnt vmcnt(16) lgkmcnt(0)
  s_barrier
  s_add_u32 m0, s41, 16384
  s_add_u32 s42, s53, 4194304
  buffer_load_dwordx4 v10, s[8:11], s42 offen lds
  s_add_u32 m0, s41, 17408
  s_add_u32 s42, s53, 4259840
  buffer_load_dwordx4 v10, s[8:11], s42 offen lds
  s_add_u32 m0, s41, 18432
  s_add_u32 s42, s53, 4202496
  buffer_load_dwordx4 v10, s[8:11], s42 offen lds
  s_add_u32 m0, s41, 19456
  s_add_u32 s42, s53, 4268032
  buffer_load_dwordx4 v10, s[8:11], s42 offen lds
  s_add_u32 m0, s41, 20480
  s_add_u32 s42, s53, 4456448
  buffer_load_dwordx4 v10, s[8:11], s42 offen lds
  s_add_u32 m0, s41, 21504
  s_add_u32 s42, s53, 4521984
  buffer_load_dwordx4 v10, s[8:11], s42 offen lds
  s_add_u32 m0, s41, 22528
  s_add_u32 s42, s53, 4464640
  buffer_load_dwordx4 v10, s[8:11], s42 offen lds
  s_add_u32 m0, s41, 23552
  s_add_u32 s42, s53, 4530176
  buffer_load_dwordx4 v10, s[8:11], s42 offen lds
  ds_read_b64_tr_b16 v[200:201], v4 offset:24576
  ds_read_b64_tr_b16 v[202:203], v4 offset:26624
  ds_read_b64_tr_b16 v[204:205], v4 offset:28672
  ds_read_b64_tr_b16 v[206:207], v4 offset:30720
  ds_read_b64_tr_b16 v[216:217], v5 offset:24576
  ds_read_b64_tr_b16 v[218:219], v5 offset:26624
  ds_read_b64_tr_b16 v[220:221], v5 offset:28672
  ds_read_b64_tr_b16 v[222:223], v5 offset:30720
  ds_read_b64_tr_b16 v[232:233], v6 offset:24576
  ds_read_b64_tr_b16 v[234:235], v6 offset:26624
  ds_read_b64_tr_b16 v[236:237], v6 offset:28672
  ds_read_b64_tr_b16 v[238:239], v6 offset:30720
  ds_read_b64_tr_b16 v[248:249], v7 offset:24576
  ds_read_b64_tr_b16 v[250:251], v7 offset:26624
  ds_read_b64_tr_b16 v[252:253], v7 offset:28672
  ds_read_b64_tr_b16 v[254:255], v7 offset:30720
  s_cmp_lg_u32 s20, 0
  s_cbranch_scc1 Lchore_58
Lini_59:
  s_load_dwordx16 s[64:79], s[12:13], 128 glc
  s_load_dwordx16 s[80:95], s[12:13], 192 glc
  s_sub_u32 s24, s24, 1
  s_cbranch_scc1 L_FAIL
  s_waitcnt lgkmcnt(0)
  s_and_b64 s[64:65], s[64:65], s[66:67]
  s_and_b64 s[64:65], s[64:65], s[68:69]
  s_and_b64 s[64:65], s[64:65], s[70:71]
  s_and_b64 s[64:65], s[64:65], s[72:73]
  s_and_b64 s[64:65], s[64:65], s[74:75]
  s_and_b64 s[64:65], s[64:65], s[76:77]
  s_and_b64 s[64:65], s[64:65], s[78:79]
  s_and_b64 s[64:65], s[64:65], s[80:81]
  s_and_b64 s[64:65], s[64:65], s[82:83]
  s_and_b64 s[64:65], s[64:65], s[84:85]
  s_and_b64 s[64:65], s[64:65], s[86:87]
  s_and_b64 s[64:65], s[64:65], s[88:89]
  s_and_b64 s[64:65], s[64:65], s[90:91]
  s_and_b64 s[64:65], s[64:65], s[92:93]
  s_and_b64 s[64:65], s[64:65], s[94:95]
  s_and_b32 s64, s64, s65
  s_cbranch_scc0 Lini_59
  s_mov_b32 s46, 0xffff
  s_and_b32 s40, s21, 3
  s_lshl_b32 s40, s40, 13
  s_lshr_b32 s43, s21, 2
  s_lshl_b32 s43, s43, 10
  s_add_u32 s43, s43, s40
  s_add_u32 s43, s43, 1344000
  s_waitcnt lgkmcnt(0)
  s_memtime s[64:65]
  s_waitcnt lgkmcnt(0)
  s_load_dword s68, s[4:5], s43 glc
  s_waitcnt lgkmcnt(0)
  s_memtime s[66:67]
  s_waitcnt lgkmcnt(0)
  s_sub_u32 s64, s66, s64
  s_min_u32 s46, s46, s64
  s_getreg_b32 s55, hwreg(HW_REG_XCC_ID)
  s_and_b32 s55, s55, 15
  s_lshl_b32 s46, s46, 8
  s_or_b32 s46, s46, s55
  s_add_u32 s40, s21, 32
  s_lshl_b32 s40, s40, 7
  s_add_u32 s40, s40, 1424384
  s_mov_b32 s63, s46
  s_atomic_smax s63, s[4:5], s40 glc
Lnosig_60:
Lchore_58:
  s_waitcnt vmcnt(16) lgkmcnt(0)
  s_barrier
  s_add_u32 m0, s41, 24576
  s_add_u32 s42, s53, 6291456
  buffer_load_dwordx4 v10, s[8:11], s42 offen lds
  s_add_u32 m0, s41, 25600
  s_add_u32 s42, s53, 6356992
  buffer_load_dwordx4 v10, s[8:11], s42 offen lds
  s_add_u32 m0, s41, 26624
  s_add_u32 s42, s53, 6299648
  buffer_load_dwordx4 v10, s[8:11], s42 offen lds
  s_add_u32 m0, s41, 27648
  s_add_u32 s42, s53, 6365184
  buffer_load_dwordx4 v10, s[8:11], s42 offen lds
  s_add_u32 m0, s41, 28672
  s_add_u32 s42, s53, 6553600
  buffer_load_dwordx4 v10, s[8:11], s42 offen lds
  s_add_u32 m0, s41, 29696
  s_add_u32 s42, s53, 6619136
  buffer_load_dwordx4 v10, s[8:11], s42 offen lds
  s_add_u32 m0, s41, 30720
  s_add_u32 s42, s53, 6561792
  buffer_load_dwordx4 v10, s[8:11], s42 offen lds
  s_add_u32 m0, s41, 31744
  s_add_u32 s42, s53, 6627328
  buffer_load_dwordx4 v10, s[8:11], s42 offen lds
  ds_read_b64_tr_b16 v[20:21], v4 offset:0
  ds_read_b64_tr_b16 v[22:23], v4 offset:2048
  ds_read_b64_tr_b16 v[24:25], v4 offset:4096
  ds_read_b64_tr_b16 v[26:27], v4 offset:6144
  ds_read_b64_tr_b16 v[28:29], v5 offset:0
  ds_read_b64_tr_b16 v[30:31], v5 offset:2048
  ds_read_b64_tr_b16 v[32:33], v5 offset:4096
  ds_read_b64_tr_b16 v[34:35], v5 offset:6144
  ds_read_b64_tr_b16 v[36:37], v6 offset:0
  ds_read_b64_tr_b16 v[38:39], v6 offset:2048
  ds_read_b64_tr_b16 v[40:41], v6 offset:4096
  ds_read_b64_tr_b16 v[42:43], v6 offset:6144
  ds_read_b64_tr_b16 v[44:45], v7 offset:0
  ds_read_b64_tr_b16 v[46:47], v7 offset:2048
  ds_read_b64_tr_b16 v[48:49], v7 offset:4096
  ds_read_b64_tr_b16 v[50:51], v7 offset:6144
  s_waitcnt lgkmcnt(0)
  s_barrier
  ds_write_b128 v85, v[20:23] offset:0
  ds_write_b128 v85, v[24:27] offset:1024
  ds_write_b128 v85, v[28:31] offset:2048
  ds_write_b128 v85, v[32:35] offset:3072
  ds_write_b128 v85, v[36:39] offset:4096
  ds_write_b128 v85, v[40:43] offset:5120
  ds_write_b128 v85, v[44:47] offset:6144
  ds_write_b128 v85, v[48:51] offset:7168
  s_waitcnt vmcnt(16) lgkmcnt(0)
  s_barrier
  ds_read_b64_tr_b16 v[20:21], v4 offset:8192
  ds_read_b64_tr_b16 v[22:23], v4 offset:10240
  ds_read_b64_tr_b16 v[24:25], v4 offset:12288
  ds_read_b64_tr_b16 v[26:27], v4 offset:14336
  ds_read_b64_tr_b16 v[28:29], v5 offset:8192
  ds_read_b64_tr_b16 v[30:31], v5 offset:10240
  ds_read_b64_tr_b16 v[32:33], v5 offset:12288
  ds_read_b64_tr_b16 v[34:35], v5 offset:14336
  ds_read_b64_tr_b16 v[36:37], v6 offset:8192
  ds_read_b64_tr_b16 v[38:39], v6 offset:10240
  ds_read_b64_tr_b16 v[40:41], v6 offset:12288
  ds_read_b64_tr_b16 v[42:43], v6 offset:14336
  ds_read_b64_tr_b16 v[44:45], v7 offset:8192
  ds_read_b64_tr_b16 v[46:47], v7 offset:10240
  ds_read_b64_tr_b16 v[48:49], v7 offset:12288
  ds_read_b64_tr_b16 v[50:51], v7 offset:14336
  s_waitcnt lgkmcnt(0)
  s_barrier
  ds_write_b128 v85, v[20:23] offset:8192
  ds_write_b128 v85, v[24:27] offset:9216
  ds_write_b128 v85, v[28:31] offset:10240
  ds_write_b128 v85, v[32:35] offset:11264
  ds_write_b128 v85, v[36:39] offset:12288
  ds_write_b128 v85, v[40:43] offset:13312
  ds_write_b128 v85, v[44:47] offset:14336
  ds_write_b128 v85, v[48:51] offset:15360
  s_waitcnt vmcnt(8) lgkmcnt(0)
  s_barrier
  ds_read_b64_tr_b16 v[20:21], v4 offset:16384
  ds_read_b64_tr_b16 v[22:23], v4 offset:18432
  ds_read_b64_tr_b16 v[24:25], v4 offset:20480
  ds_read_b64_tr_b16 v[26:27], v4 offset:22528
  ds_read_b64_tr_b16 v[28:29], v5 offset:16384
  ds_read_b64_tr_b16 v[30:31], v5 offset:18432
  ds_read_b64_tr_b16 v[32:33], v5 offset:20480
  ds_read_b64_tr_b16 v[34:35], v5 offset:22528
  ds_read_b64_tr_b16 v[36:37], v6 offset:16384
  ds_read_b64_tr_b16 v[38:39], v6 offset:18432
  ds_read_b64_tr_b16 v[40:41], v6 offset:20480
  ds_read_b64_tr_b16 v[42:43], v6 offset:22528
  ds_read_b64_tr_b16 v[44:45], v7 offset:16384
  ds_read_b64_tr_b16 v[46:47], v7 offset:18432
  ds_read_b64_tr_b16 v[48:49], v7 offset:20480
  ds_read_b64_tr_b16 v[50:51], v7 offset:22528
  s_waitcnt lgkmcnt(0)
  s_barrier
  ds_write_b128 v85, v[20:23] offset:16384
  ds_write_b128 v85, v[24:27] offset:17408
  ds_write_b128 v85, v[28:31] offset:18432
  ds_write_b128 v85, v[32:35] offset:19456
  ds_write_b128 v85, v[36:39] offset:20480
  ds_write_b128 v85, v[40:43] offset:21504
  ds_write_b128 v85, v[44:47] offset:22528
  ds_write_b128 v85, v[48:51] offset:23552
  s_waitcnt vmcnt(0) lgkmcnt(0)
  s_barrier
  ds_read_b64_tr_b16 v[20:21], v4 offset:24576
  ds_read_b64_tr_b16 v[22:23], v4 offset:26624
  ds_read_b64_tr_b16 v[24:25], v4 offset:28672
  ds_read_b64_tr_b16 v[26:27], v4 offset:30720
  ds_read_b64_tr_b16 v[28:29], v5 offset:24576
  ds_read_b64_tr_b16 v[30:31], v5 offset:26624
  ds_read_b64_tr_b16 v[32:33], v5 offset:28672
  ds_read_b64_tr_b16 v[34:35], v5 offset:30720
  ds_read_b64_tr_b16 v[36:37], v6 offset:24576
  ds_read_b64_tr_b16 v[38:39], v6 offset:26624
  ds_read_b64_tr_b16 v[40:41], v6 offset:28672
  ds_read_b64_tr_b16 v[42:43], v6 offset:30720
  ds_read_b64_tr_b16 v[44:45], v7 offset:24576
  ds_read_b64_tr_b16 v[46:47], v7 offset:26624
  ds_read_b64_tr_b16 v[48:49], v7 offset:28672
  ds_read_b64_tr_b16 v[50:51], v7 offset:30720
  s_waitcnt lgkmcnt(0)
  s_barrier
  ds_write_b128 v85, v[20:23] offset:24576
  ds_write_b128 v85, v[24:27] offset:25600
  ds_write_b128 v85, v[28:31] offset:26624
  ds_write_b128 v85, v[32:35] offset:27648
  ds_write_b128 v85, v[36:39] offset:28672
  ds_write_b128 v85, v[40:43] offset:29696
  ds_write_b128 v85, v[44:47] offset:30720
  ds_write_b128 v85, v[48:51] offset:31744
  s_waitcnt lgkmcnt(0)
  s_lshr_b32 s40, s21, 1
  s_lshl_b32 s40, s40, 2
  v_min_u32 v76, 3, v0
  v_add_u32 v76, s40, v76
  v_lshlrev_b32 v76, 7, v76
  v_add_u32 v76, 1432576, v76
  s_nop 1
Lpoll_61:
  buffer_load_dword v77, v76, s[4:7], 0 offen sc1
  s_sub_u32 s24, s24, 1
  s_cbranch_scc1 L_FAIL
  s_waitcnt vmcnt(0)
  v_cmp_gt_i32 vcc, 1, v77
  s_cbranch_vccz Lpolld_62
  s_sleep 1
  s_branch Lpoll_61
Lpolld_62:
  s_lshl_b32 s40, s21, 18
  s_lshl_b32 s41, s20, 15
  s_add_u32 s40, s40, s41
  v_lshl_add_u32 v76, v0, 4, s40
  s_add_u32 s50, s21, s20
  s_and_b32 s50, s50, 3
  s_lshl_b32 s41, s54, 5
  s_add_u32 s41, s41, s50
  s_lshl_b32 s41, s41, 12
  s_xor_b32 s40, s41, 0
  s_add_u32 s40, s40, 14680064
  buffer_load_dwordx4 a[0:3], v76, s[4:7], s40 offen offset:0 sc1
  buffer_load_dwordx4 a[4:7], v76, s[4:7], s40 offen offset:1024 sc1
  buffer_load_dwordx4 a[8:11], v76, s[4:7], s40 offen offset:2048 sc1
  buffer_load_dwordx4 a[12:15], v76, s[4:7], s40 offen offset:3072 sc1
  s_xor_b32 s40, s41, 4096
  s_add_u32 s40, s40, 14680064
  buffer_load_dwordx4 a[16:19], v76, s[4:7], s40 offen offset:0 sc1
  buffer_load_dwordx4 a[20:23], v76, s[4:7], s40 offen offset:1024 sc1
  buffer_load_dwordx4 a[24:27], v76, s[4:7], s40 offen offset:2048 sc1
  buffer_load_dwordx4 a[28:31], v76, s[4:7], s40 offen offset:3072 sc1
  s_xor_b32 s40, s41, 8192
  s_add_u32 s40, s40, 14680064
  buffer_load_dwordx4 a[32:35], v76, s[4:7], s40 offen offset:0 sc1
  buffer_load_dwordx4 a[36:39], v76, s[4:7], s40 offen offset:1024 sc1
  buffer_load_dwordx4 a[40:43], v76, s[4:7], s40 offen offset:2048 sc1
  buffer_load_dwordx4 a[44:47], v76, s[4:7], s40 offen offset:3072 sc1
  s_xor_b32 s40, s41, 12288
  s_add_u32 s40, s40, 14680064
  buffer_load_dwordx4 a[48:51], v76, s[4:7], s40 offen offset:0 sc1
  buffer_load_dwordx4 a[52:55], v76, s[4:7], s40 offen offset:1024 sc1
  buffer_load_dwordx4 a[56:59], v76, s[4:7], s40 offen offset:2048 sc1
  buffer_load_dwordx4 a[60:63], v76, s[4:7], s40 offen offset:3072 sc1
  s_xor_b32 s40, s41, 16384
  s_add_u32 s40, s40, 14680064
  buffer_load_dwordx4 a[64:67], v76, s[4:7], s40 offen offset:0 sc1
  buffer_load_dwordx4 a[68:71], v76, s[4:7], s40 offen offset:1024 sc1
  buffer_load_dwordx4 a[72:75], v76, s[4:7], s40 offen offset:2048 sc1
  buffer_load_dwordx4 a[76:79], v76, s[4:7], s40 offen offset:3072 sc1
  s_xor_b32 s40, s41, 20480
  s_add_u32 s40, s40, 14680064
  buffer_load_dwordx4 a[80:83], v76, s[4:7], s40 offen offset:0 sc1
  buffer_load_dwordx4 a[84:87], v76, s[4:7], s40 offen offset:1024 sc1
  buffer_load_dwordx4 a[88:91], v76, s[4:7], s40 offen offset:2048 sc1
  buffer_load_dwordx4 a[92:95], v76, s[4:7], s40 offen offset:3072 sc1
  s_xor_b32 s40, s41, 24576
  s_add_u32 s40, s40, 14680064
  buffer_load_dwordx4 a[96:99], v76, s[4:7], s40 offen offset:0 sc1
  buffer_load_dwordx4 a[100:103], v76, s[4:7], s40 offen offset:1024 sc1
  buffer_load_dwordx4 a[104:107], v76, s[4:7], s40 offen offset:2048 sc1
  buffer_load_dwordx4 a[108:111], v76, s[4:7], s40 offen offset:3072 sc1
  s_xor_b32 s40, s41, 28672
  s_add_u32 s40, s40, 14680064
  buffer_load_dwordx4 a[112:115], v76, s[4:7], s40 offen offset:0 sc1
  buffer_load_dwordx4 a[116:119], v76, s[4:7], s40 offen offset:1024 sc1
  buffer_load_dwordx4 a[120:123], v76, s[4:7], s40 offen offset:2048 sc1
  buffer_load_dwordx4 a[124:127], v76, s[4:7], s40 offen offset:3072 sc1
  s_xor_b32 s40, s41, 131072
  s_add_u32 s40, s40, 14680064
  buffer_load_dwordx4 a[128:131], v76, s[4:7], s40 offen offset:0 sc1
  buffer_load_dwordx4 a[132:135], v76, s[4:7], s40 offen offset:1024 sc1
  buffer_load_dwordx4 a[136:139], v76, s[4:7], s40 offen offset:2048 sc1
  buffer_load_dwordx4 a[140:143], v76, s[4:7], s40 offen offset:3072 sc1
  s_waitcnt vmcnt(32)
  s_xor_b32 s40, s41, 135168
  s_add_u32 s40, s40, 14680064
  buffer_load_dwordx4 a[144:147], v76, s[4:7], s40 offen offset:0 sc1
  buffer_load_dwordx4 a[148:151], v76, s[4:7], s40 offen offset:1024 sc1
  buffer_load_dwordx4 a[152:155], v76, s[4:7], s40 offen offset:2048 sc1
  buffer_load_dwordx4 a[156:159], v76, s[4:7], s40 offen offset:3072 sc1
  s_waitcnt vmcnt(32)
  s_xor_b32 s40, s41, 139264
  s_add_u32 s40, s40, 14680064
  buffer_load_dwordx4 a[160:163], v76, s[4:7], s40 offen offset:0 sc1
  buffer_load_dwordx4 a[164:167], v76, s[4:7], s40 offen offset:1024 sc1
  buffer_load_dwordx4 a[168:171], v76, s[4:7], s40 offen offset:2048 sc1
  buffer_load_dwordx4 a[172:175], v76, s[4:7], s40 offen offset:3072 sc1
  s_waitcnt vmcnt(32)
  s_xor_b32 s40, s41, 143360
  s_add_u32 s40, s40, 14680064
  buffer_load_dwordx4 a[176:179], v76, s[4:7], s40 offen offset:0 sc1
  buffer_load_dwordx4 a[180:183], v76, s[4:7], s40 offen offset:1024 sc1
  buffer_load_dwordx4 a[184:187], v76, s[4:7], s40 offen offset:2048 sc1
  buffer_load_dwordx4 a[188:191], v76, s[4:7], s40 offen offset:3072 sc1
  s_waitcnt vmcnt(32)
  s_xor_b32 s40, s41, 147456
  s_add_u32 s40, s40, 14680064
  buffer_load_dwordx4 a[192:195], v76, s[4:7], s40 offen offset:0 sc1
  buffer_load_dwordx4 a[196:199], v76, s[4:7], s40 offen offset:1024 sc1
  buffer_load_dwordx4 a[200:203], v76, s[4:7], s40 offen offset:2048 sc1
  buffer_load_dwordx4 a[204:207], v76, s[4:7], s40 offen offset:3072 sc1
  s_waitcnt vmcnt(32)
  s_xor_b32 s40, s41, 151552
  s_add_u32 s40, s40, 14680064
  buffer_load_dwordx4 a[208:211], v76, s[4:7], s40 offen offset:0 sc1
  buffer_load_dwordx4 a[212:215], v76, s[4:7], s40 offen offset:1024 sc1
  buffer_load_dwordx4 a[216:219], v76, s[4:7], s40 offen offset:2048 sc1
  buffer_load_dwordx4 a[220:223], v76, s[4:7], s40 offen offset:3072 sc1
  s_waitcnt vmcnt(32)
  s_xor_b32 s40, s41, 155648
  s_add_u32 s40, s40, 14680064
  buffer_load_dwordx4 a[224:227], v76, s[4:7], s40 offen offset:0 sc1
  buffer_load_dwordx4 a[228:231], v76, s[4:7], s40 offen offset:1024 sc1
  buffer_load_dwordx4 a[232:235], v76, s[4:7], s40 offen offset:2048 sc1
  buffer_load_dwordx4 a[236:239], v76, s[4:7], s40 offen offset:3072 sc1
  s_waitcnt vmcnt(32)
  s_xor_b32 s40, s41, 159744
  s_add_u32 s40, s40, 14680064
  buffer_load_dwordx4 a[240:243], v76, s[4:7], s40 offen offset:0 sc1
  buffer_load_dwordx4 a[244:247], v76, s[4:7], s40 offen offset:1024 sc1
  buffer_load_dwordx4 a[248:251], v76, s[4:7], s40 offen offset:2048 sc1
  buffer_load_dwordx4 a[252:255], v76, s[4:7], s40 offen offset:3072 sc1
  s_waitcnt vmcnt(32)
  s_getreg_b32 s55, hwreg(HW_REG_XCC_ID)
  s_and_b32 s55, s55, 15
  v_min_u32 v76, 63, v0
  v_lshlrev_b32 v76, 7, v76
  v_add_u32 v76, 1424384, v76
  s_nop 1
Lpoll_63:
  buffer_load_dword v77, v76, s[4:7], 0 offen sc1
  s_sub_u32 s24, s24, 1
  s_cbranch_scc1 L_FAIL
  s_waitcnt vmcnt(0)
  v_cmp_gt_i32 vcc, 0, v77
  s_cbranch_vccz Lpolld_64
  s_sleep 1
  s_branch Lpoll_63
Lpolld_64:
  v_and_b32 v78, 15, v77
  v_cmp_ne_u32 vcc, s55, v78
  s_lshl_b32 s40, s54, 4
  s_lshl_b32 s40, 0xffff, s40
  s_or_b32 s41, vcc_lo, vcc_hi
  s_and_b32 s40, s40, s41
  s_cselect_b32 s36, 0, 8192
  v_lshrrev_b32 v77, 8, v77
  v_and_b32 v78, 3, v0
  v_lshl_or_b32 v77, v77, 2, v78
  s_nop 1
  v_min_u32_dpp v77, v77, v77 row_ror:8 row_mask:0xf bank_mask:0xf
  s_nop 1
  v_min_u32_dpp v77, v77, v77 row_ror:4 row_mask:0xf bank_mask:0xf
  v_mov_b32 v78, v77
  s_nop 1
  v_permlane16_swap_b32 v78, v77
  v_min_u32 v77, v77, v78
  v_mov_b32 v78, v77
  s_nop 1
  v_permlane32_swap_b32 v78, v77
  v_min_u32 v77, v77, v78
  s_nop 1
  v_min_u32_dpp v77, v77, v77 row_ror:2 row_mask:0xf bank_mask:0xf
  s_nop 1
  v_min_u32_dpp v77, v77, v77 row_ror:1 row_mask:0xf bank_mask:0xf
  s_nop 0
  v_readfirstlane_b32 s26, v77
  s_and_b32 s26, s26, 3
  s_lshl_b32 s26, s26, 13
  s_lshr_b32 s40, s20, 1
  s_mul_i32 s40, s40, 32768
  s_and_b32 s41, s20, 1
  s_lshl_b32 s41, s41, 10
  s_add_u32 s40, s40, s41
  s_lshl_b32 s41, s54, 12
  s_add_u32 s40, s40, s41
  v_lshl_add_u32 v86, v0, 4, s40
  v_xor_b32 v87, 0x1000, v86
  v_and_b32 v76, 2, v0
  v_cmp_eq_u32 vcc, 0, v76
  v_mov_b32 v76, 0xeeee
  v_mov_b32 v77, 0x4444
  v_cndmask_b32 v88, v76, v77, vcc
  s_lshr_b32 s40, s21, 2
  s_mul_i32 s40, s40, 32768
  s_and_b32 s41, s21, 3
  s_lshl_b32 s41, s41, 11
  s_add_u32 s47, s40, s41
  s_lshl_b32 s41, s20, 9
  s_add_u32 s47, s47, s41
  v_lshl_add_u32 v92, v0, 3, s47
  s_lshl_b32 s41, s54, 12
  s_add_u32 s40, s41, 1310720
  s_add_u32 s40, s40, s26
  v_lshrrev_b32 v76, 2, v0
  v_lshl_add_u32 v76, v76, 7, s40
  v_and_b32 v77, 3, v0
  v_lshl_add_u32 v90, v77, 2, v76
  s_mov_b32 s57, s40
  s_cmp_eq_u32 s36, 0
  s_cselect_b32 s56, 1, s20
  s_and_b32 s41, s21, 15
  s_lshl_b32 s41, s41, 7
  s_lshl_b32 s40, s20, 2
  s_add_u32 s40, s40, s41
  s_add_u32 s40, s40, 0
  s_mov_b32 s25, 0
  s_mov_b32 s60, 0
  s_mov_b32 s61, 0
  s_mov_b32 s51, -1
  v_mov_b32 v91, 2147483392
  s_mov_b64 exec, 1
  v_mov_b32 v91, s40
  s_mov_b64 exec, -1
  v_mov_b32 v80, -1
  v_mov_b32 v81, -1
  v_mov_b32 v82, -1
  v_mov_b32 v83, -1
  s_mul_i32 s40, s20, 32768
  s_and_b32 s41, s50, 3
  s_lshl_b32 s41, s41, 10
  s_add_u32 s40, s40, s41
  v_lshl_add_u32 v111, v0, 4, s40
  v_xor_b32 v112, 0x400, v111
  v_xor_b32 v113, 0x800, v111
  v_xor_b32 v114, 0xc00, v111
  s_mul_i32 s58, s54, 131072
  s_and_b32 s41, s50, 4
  s_lshl_b32 s41, s41, 10
  s_add_u32 s58, s58, s41
  s_mul_i32 s59, s21, 24576
  s_add_u32 s59, s59, 58720256
  s_mul_i32 s40, s20, 6144
  v_min_u32 v110, 47, v0
  v_lshl_add_u32 v110, v110, 7, s40
  s_lshl_b32 s40, s20, 10
  s_add_u32 s40, s40, 147456
  v_lshl_add_u32 v95, v0, 4, s40
  s_and_b32 s40, s20, 1
  s_lshl_b32 s40, s40, 3
  v_bfe_u32 v4, v0, 2, 3
  v_add_u32 v4, s40, v4
  s_lshr_b32 s40, s20, 1
  s_lshl_b32 s40, s40, 3
  v_and_b32 v5, 3, v0
  v_add_u32 v5, s40, v5
  v_bfe_u32 v76, v4, 1, 1
  v_lshl_add_u32 v5, v76, 2, v5
  v_lshrrev_b32 v76, 2, v4
  v_and_b32 v77, 1, v4
  v_lshl_add_u32 v78, v76, 4, v5
  v_lshlrev_b32 v78, 4, v78
  v_lshl_add_u32 v78, v77, 3, v78
  v_add_u32 v108, 147456, v78
  s_bfe_u32 s41, s21, 0x10002
  s_mul_i32 s41, s41, 32768
  s_lshr_b32 s40, s21, 3
  s_lshl_b32 s40, s40, 11
  s_add_u32 s40, s40, s41
  s_and_b32 s41, s21, 3
  s_lshl_b32 s41, s41, 9
  s_add_u32 s40, s40, s41
  s_lshl_b32 s41, s20, 7
  s_add_u32 s40, s40, s41
  v_lshl_add_u32 v109, v0, 2, s40
  s_mov_b32 exec_lo, 0
  v_mov_b32 v109, 2147483392
  s_mov_b64 exec, -1
  v_mov_b64 v[52:53], 0
  v_mov_b64 v[54:55], 0
  v_mov_b64 v[56:57], 0
  v_mov_b64 v[58:59], 0
  ds_read_b128 v[20:23], v85 offset:0
  ds_read_b128 v[24:27], v85 offset:1024
  ds_read_b128 v[28:31], v85 offset:8192
  ds_read_b128 v[32:35], v85 offset:9216
  ds_read_b128 v[36:39], v85 offset:2048
  ds_read_b128 v[40:43], v85 offset:3072
  ds_read_b128 v[44:47], v85 offset:10240
  ds_read_b128 v[48:51], v85 offset:11264
L_VO_top:
  s_and_b32 s40, s25, 3
  s_lshl_b32 s40, s40, 16
  s_add_u32 s27, s40, s26
  s_add_u32 s27, s27, 1048576
  s_xor_b32 s37, s27, s36
  s_lshl_b32 s40, s40, 2
  s_add_u32 s28, s40, s26
  s_lshr_b32 s40, s40, 5
  s_and_b32 s40, s40, 0x4000
  s_xor_b32 s28, s28, s40
  s_xor_b32 s29, s28, 0x4000
  s_sleep 2
L_VO_retry:
  buffer_load_dwordx4 v[4:7], v86, s[4:7], s37 offen offset:0 sc1
  s_nop 0
  buffer_load_dwordx4 v[8:11], v86, s[4:7], s37 offen offset:2048 sc1
  s_nop 0
  s_waitcnt vmcnt(1) lgkmcnt(0)
  v_smfmac_f32_16x16x64_bf16 v[52:55], v[4:7], v[128:135], v88
  ds_write_b128 v1, v[4:7] offset:0
  v_max3_u32 v89, v4, v5, v6
  v_smfmac_f32_16x16x64_bf16 v[56:59], v[4:7], v[20:27], v88
  v_max3_u32 v89, v6, v7, v89
  s_waitcnt vmcnt(0)
  ds_write_b128 v1, v[8:11] offset:1024
  v_max3_u32 v89, v8, v9, v89
  v_max3_u32 v89, v10, v11, v89
  v_cmp_eq_u32 vcc, -1, v89
  s_cbranch_vccnz L_VO_bad
  s_waitcnt lgkmcnt(0)
  s_barrier
  ds_read_b128 v[12:15], v2 offset:0
  ds_read_b128 v[16:19], v2 offset:1024
  v_smfmac_f32_16x16x64_bf16 v[52:55], v[8:11], v[136:143], v88
  buffer_load_dwordx4 v[68:71], v87, s[4:7], s27 offen offset:0 sc1
  buffer_load_dwordx4 v[72:75], v87, s[4:7], s27 offen offset:2048 sc1
  ds_read_b128 v[4:7], v3 offset:0
  v_smfmac_f32_16x16x64_bf16 v[56:59], v[8:11], v[28:35], v88
  ds_read_b128 v[20:23], v85 offset:4096
  ds_read_b128 v[24:27], v85 offset:5120
  s_waitcnt lgkmcnt(4)
  v_smfmac_f32_16x16x64_bf16 v[52:55], v[12:15], v[144:151], v88
  ds_read_b128 v[8:11], v3 offset:1024
  ds_read_b128 v[28:31], v85 offset:12288
  v_smfmac_f32_16x16x64_bf16 v[56:59], v[12:15], v[36:43], v88
  ds_read_b128 v[32:35], v85 offset:13312
  s_waitcnt lgkmcnt(6)
  v_smfmac_f32_16x16x64_bf16 v[52:55], v[16:19], v[152:159], v88
  ds_read_b128 v[12:15], v84 offset:0
  ds_read_b128 v[36:39], v85 offset:6144
  v_smfmac_f32_16x16x64_bf16 v[56:59], v[16:19], v[44:51], v88
  ds_read_b128 v[40:43], v85 offset:7168
  s_waitcnt lgkmcnt(6)
  v_smfmac_f32_16x16x64_bf16 v[52:55], v[4:7], v[160:167], v88
  ds_read_b128 v[16:19], v84 offset:1024
  ds_read_b128 v[44:47], v85 offset:14336
  v_smfmac_f32_16x16x64_bf16 v[56:59], v[4:7], v[20:27], v88
  ds_read_b128 v[48:51], v85 offset:15360
  s_waitcnt lgkmcnt(6)
  v_smfmac_f32_16x16x64_bf16 v[52:55], v[8:11], v[168:175], v88
  ds_read_b128 v[20:23], v85 offset:16384
  v_smfmac_f32_16x16x64_bf16 v[56:59], v[8:11], v[28:35], v88
  ds_read_b128 v[24:27], v85 offset:17408
  s_waitcnt lgkmcnt(5)
  v_smfmac_f32_16x16x64_bf16 v[52:55], v[12:15], v[176:183], v88
  ds_read_b128 v[28:31], v85 offset:24576
  v_smfmac_f32_16x16x64_bf16 v[56:59], v[12:15], v[36:43], v88
  ds_read_b128 v[32:35], v85 offset:25600
  s_waitcnt lgkmcnt(4)
L_VO_rchk:
  s_waitcnt vmcnt(0)
  ds_write_b128 v1, v[68:71] offset:2048
  ds_write_b128 v1, v[72:75] offset:3072
  v_max3_u32 v89, v68, v69, v70
  v_max3_u32 v89, v70, v71, v89
  v_max3_u32 v89, v72, v73, v89
  v_max3_u32 v89, v74, v75, v89
  v_cmp_eq_u32 vcc, -1, v89
  s_cbranch_vccnz L_VO_rbad
  v_smfmac_f32_16x16x64_bf16 v[52:55], v[16:19], v[184:191], v88
  ds_read_b128 v[36:39], v85 offset:18432
  v_smfmac_f32_16x16x64_bf16 v[56:59], v[16:19], v[44:51], v88
  ds_read_b128 v[40:43], v85 offset:19456
  s_waitcnt lgkmcnt(6)
  s_waitcnt lgkmcnt(2)
  s_barrier
  v_smfmac_f32_16x16x64_bf16 v[52:55], v[68:71], v[192:199], v88
  ds_read_b128 v[12:15], v2 offset:2048
  ds_read_b128 v[16:19], v2 offset:3072
  v_smfmac_f32_16x16x64_bf16 v[56:59], v[68:71], v[20:27], v88
  ds_read_b128 v[44:47], v85 offset:26624
  ds_read_b128 v[48:51], v85 offset:27648
  v_smfmac_f32_16x16x64_bf16 v[52:55], v[72:75], v[200:207], v88
  ds_read_b128 v[4:7], v3 offset:2048
  ds_read_b128 v[20:23], v85 offset:20480
  v_smfmac_f32_16x16x64_bf16 v[56:59], v[72:75], v[28:35], v88
  ds_read_b128 v[24:27], v85 offset:21504
  s_waitcnt lgkmcnt(6)
  v_smfmac_f32_16x16x64_bf16 v[52:55], v[12:15], v[208:215], v88
  ds_read_b128 v[8:11], v3 offset:3072
  ds_read_b128 v[28:31], v85 offset:28672
  v_smfmac_f32_16x16x64_bf16 v[56:59], v[12:15], v[36:43], v88
  ds_read_b128 v[32:35], v85 offset:29696
  s_waitcnt lgkmcnt(6)
  v_smfmac_f32_16x16x64_bf16 v[52:55], v[16:19], v[216:223], v88
  ds_read_b128 v[12:15], v84 offset:2048
  ds_read_b128 v[36:39], v85 offset:22528
  v_smfmac_f32_16x16x64_bf16 v[56:59], v[16:19], v[44:51], v88
  ds_read_b128 v[40:43], v85 offset:23552
  s_waitcnt lgkmcnt(6)
  v_smfmac_f32_16x16x64_bf16 v[52:55], v[4:7], v[224:231], v88
  ds_read_b128 v[16:19], v84 offset:3072
  ds_read_b128 v[44:47], v85 offset:30720
  v_smfmac_f32_16x16x64_bf16 v[56:59], v[4:7], v[20:27], v88
  ds_read_b128 v[48:51], v85 offset:31744
  s_waitcnt lgkmcnt(6)
  v_smfmac_f32_16x16x64_bf16 v[52:55], v[8:11], v[232:239], v88
  v_smfmac_f32_16x16x64_bf16 v[56:59], v[8:11], v[28:35], v88
  s_waitcnt lgkmcnt(3)
  v_smfmac_f32_16x16x64_bf16 v[52:55], v[12:15], v[240:247], v88
  v_smfmac_f32_16x16x64_bf16 v[56:59], v[12:15], v[36:43], v88
  s_waitcnt lgkmcnt(0)
  v_smfmac_f32_16x16x64_bf16 v[52:55], v[16:19], v[248:255], v88
  v_smfmac_f32_16x16x64_bf16 v[56:59], v[16:19], v[44:51], v88
  s_nop 6
  v_pk_add_f32 v[52:53], v[52:53], v[54:55]
  v_pk_add_f32 v[56:57], v[56:57], v[58:59]
  v_cvt_pk_bf16_f32 v100, v52, v53
  v_cvt_pk_bf16_f32 v101, v56, v57
  v_min_u32 v100, -2, v100
  v_min_u32 v101, -2, v101
  s_cmp_eq_u32 s36, 0
  s_cbranch_scc1 Lwt_65
  buffer_store_dwordx2 v[100:101], v92, s[4:7], s29 offen
  s_branch Lwtd_66
Lwt_65:
  buffer_store_dwordx2 v[100:101], v92, s[4:7], s29 offen sc1
Lwtd_66:
  s_cmp_ge_u32 s25, 63
  s_cbranch_scc1 L_VO_end
  s_add_u32 s42, s28, s58
  s_xor_b32 s30, s42, s36
  s_xor_b32 s31, s30, 4096
  s_xor_b32 s32, s42, 131072
  s_xor_b32 s48, s32, 4096
  s_add_u32 s41, s25, 1
  v_mov_b32 v94, s41
  s_and_b32 s41, s41, 3
  s_lshl_b32 s41, s41, 16
  s_add_u32 s33, s41, s26
  s_add_u32 s33, s33, 1048576
  s_xor_b32 s49, s33, 8192
  s_xor_b32 s34, s33, 0x20000
  s_xor_b32 s35, s29, 0x84000
  buffer_store_dword v80, v109, s[4:7], s34 offen sc1
  s_xor_b32 s40, s34, 8192
  buffer_store_dword v80, v109, s[4:7], s40 offen
  s_cmp_eq_u32 s36, 0
  s_cbranch_scc1 Lwt_67
  buffer_store_dwordx2 v[80:81], v92, s[4:7], s35 offen
  s_branch Lwtd_68
Lwt_67:
  buffer_store_dwordx2 v[80:81], v92, s[4:7], s35 offen sc1
Lwtd_68:
  v_mov_b64 v[60:61], 0
  v_mov_b64 v[62:63], 0
  v_mov_b64 v[64:65], 0
  v_mov_b64 v[66:67], 0
  v_mov_b64 v[52:53], 0
  v_mov_b64 v[54:55], 0
  v_mov_b64 v[56:57], 0
  v_mov_b64 v[58:59], 0
  ds_read_b128 v[20:23], v85 offset:0
  ds_read_b128 v[24:27], v85 offset:1024
  ds_read_b128 v[28:31], v85 offset:8192
  ds_read_b128 v[32:35], v85 offset:9216
  ds_read_b128 v[36:39], v85 offset:2048
  ds_read_b128 v[40:43], v85 offset:3072
  ds_read_b128 v[44:47], v85 offset:10240
  ds_read_b128 v[48:51], v85 offset:11264
  s_cmp_lg_u32 s56, 0
  s_cbranch_scc1 Ltrigd_70
  buffer_load_dword v76, v90, s[4:7], 0 offen offset:2048 sc1
  s_sleep 1
  buffer_load_dword v77, v90, s[4:7], 0 offen offset:2048 sc1
  s_sleep 1
  buffer_load_dword v78, v90, s[4:7], 0 offen offset:2048 sc1
  s_sleep 1
Ltrig_69:
  s_sub_u32 s24, s24, 1
  s_cbranch_scc1 L_FAIL
  buffer_load_dword v79, v90, s[4:7], 0 offen offset:2048 sc1
  s_waitcnt vmcnt(3)
  v_cmp_gt_i32 vcc, s25, v76
  s_cbranch_vccz Ltrigd_70
  buffer_load_dword v76, v90, s[4:7], 0 offen offset:2048 sc1
  s_waitcnt vmcnt(3)
  v_cmp_gt_i32 vcc, s25, v77
  s_cbranch_vccz Ltrigd_70
  buffer_load_dword v77, v90, s[4:7], 0 offen offset:2048 sc1
  s_waitcnt vmcnt(3)
  v_cmp_gt_i32 vcc, s25, v78
  s_cbranch_vccz Ltrigd_70
  buffer_load_dword v78, v90, s[4:7], 0 offen offset:2048 sc1
  s_waitcnt vmcnt(3)
  v_cmp_gt_i32 vcc, s25, v79
  s_cbranch_vccnz Ltrig_69
Ltrigd_70:
  s_barrier
L_VOO_again:
  buffer_load_dwordx4 v[4:7], v111, s[4:7], s30 offen sc1
  s_nop 0
  buffer_load_dwordx4 v[8:11], v112, s[4:7], s30 offen sc1
  s_nop 0
  buffer_load_dwordx4 v[12:15], v113, s[4:7], s30 offen sc1
  s_nop 0
  buffer_load_dwordx4 v[16:19], v114, s[4:7], s30 offen sc1
  s_nop 0
  buffer_load_dwordx4 v[68:71], v111, s[4:7], s31 offen sc1
  s_nop 0
  s_waitcnt vmcnt(4)
  v_cmp_eq_u32 vcc, -1, v4
  s_cbranch_vccnz L_VOO_g0
L_VOO_ok0:
  buffer_load_dwordx4 v[72:75], v112, s[4:7], s31 offen sc1
  buffer_load_dwordx4 v[96:99], v113, s[4:7], s31 offen sc1
  v_smfmac_f32_16x16x64_bf16 v[60:63], v[4:7], a[0:7], v88
  s_waitcnt vmcnt(5)
  v_cmp_eq_u32 vcc, -1, v8
  v_smfmac_f32_16x16x64_bf16 v[64:67], v[4:7], a[8:15], v88
  s_cbranch_vccnz L_VOO_g1
L_VOO_ok1:
  buffer_load_dwordx4 v[4:7], v114, s[4:7], s31 offen sc1
  v_smfmac_f32_16x16x64_bf16 v[60:63], v[8:11], a[16:23], v88
  s_waitcnt vmcnt(5)
  v_cmp_eq_u32 vcc, -1, v12
  v_smfmac_f32_16x16x64_bf16 v[64:67], v[8:11], a[24:31], v88
  s_cbranch_vccnz L_VOO_g2
L_VOO_ok2:
  buffer_load_dwordx4 v[8:11], v111, s[4:7], s32 offen sc1
  v_smfmac_f32_16x16x64_bf16 v[60:63], v[12:15], a[32:39], v88
  s_waitcnt vmcnt(5)
  v_cmp_eq_u32 vcc, -1, v16
  v_smfmac_f32_16x16x64_bf16 v[64:67], v[12:15], a[40:47], v88
  s_cbranch_vccnz L_VOO_g3
L_VOO_ok3:
  buffer_load_dwordx4 v[12:15], v112, s[4:7], s32 offen sc1
  v_smfmac_f32_16x16x64_bf16 v[60:63], v[16:19], a[48:55], v88
  s_waitcnt vmcnt(5)
  v_cmp_eq_u32 vcc, -1, v68
  v_smfmac_f32_16x16x64_bf16 v[64:67], v[16:19], a[56:63], v88
  s_cbranch_vccnz L_VOO_g4
L_VOO_ok4:
  buffer_load_dwordx4 v[16:19], v113, s[4:7], s32 offen sc1
  v_smfmac_f32_16x16x64_bf16 v[60:63], v[68:71], a[64:71], v88
  s_waitcnt vmcnt(5)
  v_cmp_eq_u32 vcc, -1, v72
  v_smfmac_f32_16x16x64_bf16 v[64:67], v[68:71], a[72:79], v88
  s_cbranch_vccnz L_VOO_g5
L_VOO_ok5:
  buffer_load_dwordx4 v[68:71], v114, s[4:7], s32 offen sc1
  v_smfmac_f32_16x16x64_bf16 v[60:63], v[72:75], a[80:87], v88
  s_waitcnt vmcnt(5)
  v_cmp_eq_u32 vcc, -1, v96
  v_smfmac_f32_16x16x64_bf16 v[64:67], v[72:75], a[88:95], v88
  s_cbranch_vccnz L_VOO_g6
L_VOO_ok6:
  buffer_load_dwordx4 v[72:75], v111, s[4:7], s48 offen sc1
  v_smfmac_f32_16x16x64_bf16 v[60:63], v[96:99], a[96:103], v88
  s_waitcnt vmcnt(5)
  v_cmp_eq_u32 vcc, -1, v4
  v_smfmac_f32_16x16x64_bf16 v[64:67], v[96:99], a[104:111], v88
  s_cbranch_vccnz L_VOO_g7
L_VOO_ok7:
  buffer_load_dwordx4 v[96:99], v112, s[4:7], s48 offen sc1
  v_smfmac_f32_16x16x64_bf16 v[60:63], v[4:7], a[112:119], v88
  s_waitcnt vmcnt(5)
  v_cmp_eq_u32 vcc, -1, v8
  v_smfmac_f32_16x16x64_bf16 v[64:67], v[4:7], a[120:127], v88
  s_cbranch_vccnz L_VOO_g8
L_VOO_ok8:
  buffer_load_dwordx4 v[4:7], v113, s[4:7], s48 offen sc1
  v_smfmac_f32_16x16x64_bf16 v[60:63], v[8:11], a[128:135], v88
  s_waitcnt vmcnt(5)
  v_cmp_eq_u32 vcc, -1, v12
  v_smfmac_f32_16x16x64_bf16 v[64:67], v[8:11], a[136:143], v88
  s_cbranch_vccnz L_VOO_g9
L_VOO_ok9:
  buffer_load_dwordx4 v[8:11], v114, s[4:7], s48 offen sc1
  v_smfmac_f32_16x16x64_bf16 v[60:63], v[12:15], a[144:151], v88
  s_waitcnt vmcnt(5)
  v_cmp_eq_u32 vcc, -1, v16
  v_smfmac_f32_16x16x64_bf16 v[64:67], v[12:15], a[152:159], v88
  s_cbranch_vccnz L_VOO_g10
L_VOO_ok10:
  v_smfmac_f32_16x16x64_bf16 v[60:63], v[16:19], a[160:167], v88
  s_waitcnt vmcnt(4)
  v_cmp_eq_u32 vcc, -1, v68
  v_smfmac_f32_16x16x64_bf16 v[64:67], v[16:19], a[168:175], v88
  s_cbranch_vccnz L_VOO_g11
L_VOO_ok11:
  v_smfmac_f32_16x16x64_bf16 v[60:63], v[68:71], a[176:183], v88
  s_waitcnt vmcnt(3)
  v_cmp_eq_u32 vcc, -1, v72
  v_smfmac_f32_16x16x64_bf16 v[64:67], v[68:71], a[184:191], v88
  s_cbranch_vccnz L_VOO_g12
L_VOO_ok12:
  v_smfmac_f32_16x16x64_bf16 v[60:63], v[72:75], a[192:199], v88
  s_waitcnt vmcnt(2)
  v_cmp_eq_u32 vcc, -1, v96
  v_smfmac_f32_16x16x64_bf16 v[64:67], v[72:75], a[200:207], v88
  s_cbranch_vccnz L_VOO_g13
L_VOO_ok13:
  v_smfmac_f32_16x16x64_bf16 v[60:63], v[96:99], a[208:215], v88
  s_waitcnt vmcnt(1)
  v_cmp_eq_u32 vcc, -1, v4
  v_smfmac_f32_16x16x64_bf16 v[64:67], v[96:99], a[216:223], v88
  s_cbranch_vccnz L_VOO_g14
L_VOO_ok14:
  v_smfmac_f32_16x16x64_bf16 v[60:63], v[4:7], a[224:231], v88
  s_waitcnt vmcnt(0)
  v_cmp_eq_u32 vcc, -1, v8
  v_smfmac_f32_16x16x64_bf16 v[64:67], v[4:7], a[232:239], v88
  s_cbranch_vccnz L_VOO_g15
L_VOO_ok15:
  v_smfmac_f32_16x16x64_bf16 v[60:63], v[8:11], a[240:247], v88
  v_smfmac_f32_16x16x64_bf16 v[64:67], v[8:11], a[248:255], v88
  s_nop 6
  v_add_f32 v100, v60, v62
  v_add_f32 v102, v61, v63
  v_add_f32 v101, v64, v66
  v_add_f32 v103, v65, v67
  ds_write_b128 v95, v[100:103]
  v_cmp_u_f32 vcc, v100, v102
  s_cbranch_vccnz L_VOO_nan
L_VOO_done:
  s_waitcnt lgkmcnt(0)
  s_barrier
  ds_read2st64_b64 v[100:103], v108 offset0:0 offset1:2
  ds_read2st64_b64 v[104:107], v108 offset0:4 offset1:6
  buffer_store_dword v94, v91, s[4:7], s57 offen
  s_waitcnt lgkmcnt(1)
  v_pk_add_f32 v[100:101], v[100:101], v[102:103]
  s_waitcnt lgkmcnt(0)
  v_pk_add_f32 v[104:105], v[104:105], v[106:107]
  v_pk_add_f32 v[100:101], v[100:101], v[104:105]
  v_cvt_pk_bf16_f32 v100, v100, v101
  v_min_u32 v100, -2, v100
  buffer_store_dword v100, v109, s[4:7], s49 offen
  buffer_store_dword v100, v109, s[4:7], s33 offen sc1
  s_add_u32 s25, s25, 1
  s_branch L_VO_top
L_VO_end:
  s_branch L_END
L_VO_bad:
  s_nop 7
  s_sub_u32 s24, s24, 1
  s_cbranch_scc1 L_FAIL
  s_add_u32 s60, s60, 1
  v_mov_b64 v[52:53], 0
  v_mov_b64 v[54:55], 0
  v_mov_b64 v[56:57], 0
  v_mov_b64 v[58:59], 0
  s_nop 1
  s_branch L_VO_retry
L_VO_rbad:
  s_sub_u32 s24, s24, 1
  s_cbranch_scc1 L_FAIL
  s_add_u32 s60, s60, 0x10000
  s_waitcnt lgkmcnt(0)
  buffer_load_dwordx4 v[68:71], v87, s[4:7], s27 offen offset:0 sc1
  buffer_load_dwordx4 v[72:75], v87, s[4:7], s27 offen offset:2048 sc1
  s_branch L_VO_rchk
L_VOO_nan:
  s_cmp_eq_u32 s51, s25
  s_cbranch_scc1 L_VOO_done
  s_mov_b32 s51, s25
  s_add_u32 s61, s61, 0x10000
  s_waitcnt vmcnt(0) lgkmcnt(0)
L_VOO_v0:
  s_sub_u32 s24, s24, 1
  s_cbranch_scc1 L_FAIL
  buffer_load_dwordx4 v[4:7], v111, s[4:7], s30 offen sc1
  buffer_load_dwordx4 v[8:11], v112, s[4:7], s30 offen sc1
  buffer_load_dwordx4 v[12:15], v113, s[4:7], s30 offen sc1
  buffer_load_dwordx4 v[16:19], v114, s[4:7], s30 offen sc1
  v_mov_b32 v89, 0
  s_waitcnt vmcnt(0)
  v_max3_u32 v89, v4, v5, v89
  v_max3_u32 v89, v6, v7, v89
  v_max3_u32 v89, v8, v9, v89
  v_max3_u32 v89, v10, v11, v89
  v_max3_u32 v89, v12, v13, v89
  v_max3_u32 v89, v14, v15, v89
  v_max3_u32 v89, v16, v17, v89
  v_max3_u32 v89, v18, v19, v89
  v_cmp_eq_u32 vcc, -1, v89
  s_cbranch_vccnz L_VOO_v0
L_VOO_v4:
  s_sub_u32 s24, s24, 1
  s_cbranch_scc1 L_FAIL
  buffer_load_dwordx4 v[68:71], v111, s[4:7], s31 offen sc1
  buffer_load_dwordx4 v[72:75], v112, s[4:7], s31 offen sc1
  buffer_load_dwordx4 v[96:99], v113, s[4:7], s31 offen sc1
  buffer_load_dwordx4 v[4:7], v114, s[4:7], s31 offen sc1
  v_mov_b32 v89, 0
  s_waitcnt vmcnt(0)
  v_max3_u32 v89, v68, v69, v89
  v_max3_u32 v89, v70, v71, v89
  v_max3_u32 v89, v72, v73, v89
  v_max3_u32 v89, v74, v75, v89
  v_max3_u32 v89, v96, v97, v89
  v_max3_u32 v89, v98, v99, v89
  v_max3_u32 v89, v4, v5, v89
  v_max3_u32 v89, v6, v7, v89
  v_cmp_eq_u32 vcc, -1, v89
  s_cbranch_vccnz L_VOO_v4
L_VOO_v8:
  s_sub_u32 s24, s24, 1
  s_cbranch_scc1 L_FAIL
  buffer_load_dwordx4 v[8:11], v111, s[4:7], s32 offen sc1
  buffer_load_dwordx4 v[12:15], v112, s[4:7], s32 offen sc1
  buffer_load_dwordx4 v[16:19], v113, s[4:7], s32 offen sc1
  buffer_load_dwordx4 v[68:71], v114, s[4:7], s32 offen sc1
  v_mov_b32 v89, 0
  s_waitcnt vmcnt(0)
  v_max3_u32 v89, v8, v9, v89
  v_max3_u32 v89, v10, v11, v89
  v_max3_u32 v89, v12, v13, v89
  v_max3_u32 v89, v14, v15, v89
  v_max3_u32 v89, v16, v17, v89
  v_max3_u32 v89, v18, v19, v89
  v_max3_u32 v89, v68, v69, v89
  v_max3_u32 v89, v70, v71, v89
  v_cmp_eq_u32 vcc, -1, v89
  s_cbranch_vccnz L_VOO_v8
L_VOO_v12:
  s_sub_u32 s24, s24, 1
  s_cbranch_scc1 L_FAIL
  buffer_load_dwordx4 v[72:75], v111, s[4:7], s48 offen sc1
  buffer_load_dwordx4 v[96:99], v112, s[4:7], s48 offen sc1
  buffer_load_dwordx4 v[4:7], v113, s[4:7], s48 offen sc1
  buffer_load_dwordx4 v[8:11], v114, s[4:7], s48 offen sc1
  v_mov_b32 v89, 0
  s_waitcnt vmcnt(0)
  v_max3_u32 v89, v72, v73, v89
  v_max3_u32 v89, v74, v75, v89
  v_max3_u32 v89, v96, v97, v89
  v_max3_u32 v89, v98, v99, v89
  v_max3_u32 v89, v4, v5, v89
  v_max3_u32 v89, v6, v7, v89
  v_max3_u32 v89, v8, v9, v89
  v_max3_u32 v89, v10, v11, v89
  v_cmp_eq_u32 vcc, -1, v89
  s_cbranch_vccnz L_VOO_v12
  v_mov_b64 v[60:61], 0
  v_mov_b64 v[62:63], 0
  v_mov_b64 v[64:65], 0
  v_mov_b64 v[66:67], 0
  s_nop 1
  s_branch L_VOO_again
L_VOO_g0:
  s_sub_u32 s24, s24, 1
  s_cbranch_scc1 L_FAIL
  s_add_u32 s61, s61, 1
  buffer_load_dwordx4 v[4:7], v111, s[4:7], s30 offen sc1
  s_waitcnt vmcnt(0)
  v_cmp_eq_u32 vcc, -1, v4
  s_cbranch_vccnz L_VOO_g0
  buffer_load_dwordx4 v[8:11], v112, s[4:7], s30 offen sc1
  s_nop 0
  buffer_load_dwordx4 v[12:15], v113, s[4:7], s30 offen sc1
  s_nop 0
  buffer_load_dwordx4 v[16:19], v114, s[4:7], s30 offen sc1
  s_nop 0
  buffer_load_dwordx4 v[68:71], v111, s[4:7], s31 offen sc1
  s_nop 0
  s_branch L_VOO_ok0
L_VOO_g1:
  s_sub_u32 s24, s24, 1
  s_cbranch_scc1 L_FAIL
  s_add_u32 s61, s61, 1
  buffer_load_dwordx4 v[8:11], v112, s[4:7], s30 offen sc1
  s_waitcnt vmcnt(0)
  v_cmp_eq_u32 vcc, -1, v8
  s_cbranch_vccnz L_VOO_g1
  buffer_load_dwordx4 v[12:15], v113, s[4:7], s30 offen sc1
  s_nop 0
  buffer_load_dwordx4 v[16:19], v114, s[4:7], s30 offen sc1
  s_nop 0
  buffer_load_dwordx4 v[68:71], v111, s[4:7], s31 offen sc1
  s_nop 0
  buffer_load_dwordx4 v[72:75], v112, s[4:7], s31 offen sc1
  s_nop 0
  buffer_load_dwordx4 v[96:99], v113, s[4:7], s31 offen sc1
  s_nop 0
  s_branch L_VOO_ok1
L_VOO_g2:
  s_sub_u32 s24, s24, 1
  s_cbranch_scc1 L_FAIL
  s_add_u32 s61, s61, 1
  buffer_load_dwordx4 v[12:15], v113, s[4:7], s30 offen sc1
  s_waitcnt vmcnt(0)
  v_cmp_eq_u32 vcc, -1, v12
  s_cbranch_vccnz L_VOO_g2
  buffer_load_dwordx4 v[16:19], v114, s[4:7], s30 offen sc1
  s_nop 0
  buffer_load_dwordx4 v[68:71], v111, s[4:7], s31 offen sc1
  s_nop 0
  buffer_load_dwordx4 v[72:75], v112, s[4:7], s31 offen sc1
  s_nop 0
  buffer_load_dwordx4 v[96:99], v113, s[4:7], s31 offen sc1
  s_nop 0
  buffer_load_dwordx4 v[4:7], v114, s[4:7], s31 offen sc1
  s_nop 0
  s_branch L_VOO_ok2
L_VOO_g3:
  s_sub_u32 s24, s24, 1
  s_cbranch_scc1 L_FAIL
  s_add_u32 s61, s61, 1
  buffer_load_dwordx4 v[16:19], v114, s[4:7], s30 offen sc1
  s_waitcnt vmcnt(0)
  v_cmp_eq_u32 vcc, -1, v16
  s_cbranch_vccnz L_VOO_g3
  buffer_load_dwordx4 v[68:71], v111, s[4:7], s31 offen sc1
  s_nop 0
  buffer_load_dwordx4 v[72:75], v112, s[4:7], s31 offen sc1
  s_nop 0
  buffer_load_dwordx4 v[96:99], v113, s[4:7], s31 offen sc1
  s_nop 0
  buffer_load_dwordx4 v[4:7], v114, s[4:7], s31 offen sc1
  s_nop 0
  buffer_load_dwordx4 v[8:11], v111, s[4:7], s32 offen sc1
  s_nop 0
  s_branch L_VOO_ok3
L_VOO_g4:
  s_sub_u32 s24, s24, 1
  s_cbranch_scc1 L_FAIL
  s_add_u32 s61, s61, 1
  buffer_load_dwordx4 v[68:71], v111, s[4:7], s31 offen sc1
  s_waitcnt vmcnt(0)
  v_cmp_eq_u32 vcc, -1, v68
  s_cbranch_vccnz L_VOO_g4
  buffer_load_dwordx4 v[72:75], v112, s[4:7], s31 offen sc1
  s_nop 0
  buffer_load_dwordx4 v[96:99], v113, s[4:7], s31 offen sc1
  s_nop 0
  buffer_load_dwordx4 v[4:7], v114, s[4:7], s31 offen sc1
  s_nop 0
  buffer_load_dwordx4 v[8:11], v111, s[4:7], s32 offen sc1
  s_nop 0
  buffer_load_dwordx4 v[12:15], v112, s[4:7], s32 offen sc1
  s_nop 0
  s_branch L_VOO_ok4
L_VOO_g5:
  s_sub_u32 s24, s24, 1
  s_cbranch_scc1 L_FAIL
  s_add_u32 s61, s61, 1
  buffer_load_dwordx4 v[72:75], v112, s[4:7], s31 offen sc1
  s_waitcnt vmcnt(0)
  v_cmp_eq_u32 vcc, -1, v72
  s_cbranch_vccnz L_VOO_g5
  buffer_load_dwordx4 v[96:99], v113, s[4:7], s31 offen sc1
  s_nop 0
  buffer_load_dwordx4 v[4:7], v114, s[4:7], s31 offen sc1
  s_nop 0
  buffer_load_dwordx4 v[8:11], v111, s[4:7], s32 offen sc1
  s_nop 0
  buffer_load_dwordx4 v[12:15], v112, s[4:7], s32 offen sc1
  s_nop 0
  buffer_load_dwordx4 v[16:19], v113, s[4:7], s32 offen sc1
  s_nop 0
  s_branch L_VOO_ok5
L_VOO_g6:
  s_sub_u32 s24, s24, 1
  s_cbranch_scc1 L_FAIL
  s_add_u32 s61, s61, 1
  buffer_load_dwordx4 v[96:99], v113, s[4:7], s31 offen sc1
  s_waitcnt vmcnt(0)
  v_cmp_eq_u32 vcc, -1, v96
  s_cbranch_vccnz L_VOO_g6
  buffer_load_dwordx4 v[4:7], v114, s[4:7], s31 offen sc1
  s_nop 0
  buffer_load_dwordx4 v[8:11], v111, s[4:7], s32 offen sc1
  s_nop 0
  buffer_load_dwordx4 v[12:15], v112, s[4:7], s32 offen sc1
  s_nop 0
  buffer_load_dwordx4 v[16:19], v113, s[4:7], s32 offen sc1
  s_nop 0
  buffer_load_dwordx4 v[68:71], v114, s[4:7], s32 offen sc1
  s_nop 0
  s_branch L_VOO_ok6
L_VOO_g7:
  s_sub_u32 s24, s24, 1
  s_cbranch_scc1 L_FAIL
  s_add_u32 s61, s61, 1
  buffer_load_dwordx4 v[4:7], v114, s[4:7], s31 offen sc1
  s_waitcnt vmcnt(0)
  v_cmp_eq_u32 vcc, -1, v4
  s_cbranch_vccnz L_VOO_g7
  buffer_load_dwordx4 v[8:11], v111, s[4:7], s32 offen sc1
  s_nop 0
  buffer_load_dwordx4 v[12:15], v112, s[4:7], s32 offen sc1
  s_nop 0
  buffer_load_dwordx4 v[16:19], v113, s[4:7], s32 offen sc1
  s_nop 0
  buffer_load_dwordx4 v[68:71], v114, s[4:7], s32 offen sc1
  s_nop 0
  buffer_load_dwordx4 v[72:75], v111, s[4:7], s48 offen sc1
  s_nop 0
  s_branch L_VOO_ok7
L_VOO_g8:
  s_sub_u32 s24, s24, 1
  s_cbranch_scc1 L_FAIL
  s_add_u32 s61, s61, 256
  buffer_load_dwordx4 v[8:11], v111, s[4:7], s32 offen sc1
  s_waitcnt vmcnt(0)
  v_cmp_eq_u32 vcc, -1, v8
  s_cbranch_vccnz L_VOO_g8
  buffer_load_dwordx4 v[12:15], v112, s[4:7], s32 offen sc1
  s_nop 0
  buffer_load_dwordx4 v[16:19], v113, s[4:7], s32 offen sc1
  s_nop 0
  buffer_load_dwordx4 v[68:71], v114, s[4:7], s32 offen sc1
  s_nop 0
  buffer_load_dwordx4 v[72:75], v111, s[4:7], s48 offen sc1
  s_nop 0
  buffer_load_dwordx4 v[96:99], v112, s[4:7], s48 offen sc1
  s_nop 0
  s_branch L_VOO_ok8
L_VOO_g9:
  s_sub_u32 s24, s24, 1
  s_cbranch_scc1 L_FAIL
  s_add_u32 s61, s61, 256
  buffer_load_dwordx4 v[12:15], v112, s[4:7], s32 offen sc1
  s_waitcnt vmcnt(0)
  v_cmp_eq_u32 vcc, -1, v12
  s_cbranch_vccnz L_VOO_g9
  buffer_load_dwordx4 v[16:19], v113, s[4:7], s32 offen sc1
  s_nop 0
  buffer_load_dwordx4 v[68:71], v114, s[4:7], s32 offen sc1
  s_nop 0
  buffer_load_dwordx4 v[72:75], v111, s[4:7], s48 offen sc1
  s_nop 0
  buffer_load_dwordx4 v[96:99], v112, s[4:7], s48 offen sc1
  s_nop 0
  buffer_load_dwordx4 v[4:7], v113, s[4:7], s48 offen sc1
  s_nop 0
  s_branch L_VOO_ok9
L_VOO_g10:
  s_sub_u32 s24, s24, 1
  s_cbranch_scc1 L_FAIL
  s_add_u32 s61, s61, 256
  buffer_load_dwordx4 v[16:19], v113, s[4:7], s32 offen sc1
  s_waitcnt vmcnt(0)
  v_cmp_eq_u32 vcc, -1, v16
  s_cbranch_vccnz L_VOO_g10
  buffer_load_dwordx4 v[68:71], v114, s[4:7], s32 offen sc1
  s_nop 0
  buffer_load_dwordx4 v[72:75], v111, s[4:7], s48 offen sc1
  s_nop 0
  buffer_load_dwordx4 v[96:99], v112, s[4:7], s48 offen sc1
  s_nop 0
  buffer_load_dwordx4 v[4:7], v113, s[4:7], s48 offen sc1
  s_nop 0
  buffer_load_dwordx4 v[8:11], v114, s[4:7], s48 offen sc1
  s_nop 0
  s_branch L_VOO_ok10
L_VOO_g11:
  s_sub_u32 s24, s24, 1
  s_cbranch_scc1 L_FAIL
  s_add_u32 s61, s61, 256
  buffer_load_dwordx4 v[68:71], v114, s[4:7], s32 offen sc1
  s_waitcnt vmcnt(0)
  v_cmp_eq_u32 vcc, -1, v68
  s_cbranch_vccnz L_VOO_g11
  buffer_load_dwordx4 v[72:75], v111, s[4:7], s48 offen sc1
  s_nop 0
  buffer_load_dwordx4 v[96:99], v112, s[4:7], s48 offen sc1
  s_nop 0
  buffer_load_dwordx4 v[4:7], v113, s[4:7], s48 offen sc1
  s_nop 0
  buffer_load_dwordx4 v[8:11], v114, s[4:7], s48 offen sc1
  s_nop 0
  s_branch L_VOO_ok11
L_VOO_g12:
  s_sub_u32 s24, s24, 1
  s_cbranch_scc1 L_FAIL
  s_add_u32 s61, s61, 256
  buffer_load_dwordx4 v[72:75], v111, s[4:7], s48 offen sc1
  s_waitcnt vmcnt(0)
  v_cmp_eq_u32 vcc, -1, v72
  s_cbranch_vccnz L_VOO_g12
  buffer_load_dwordx4 v[96:99], v112, s[4:7], s48 offen sc1
  s_nop 0
  buffer_load_dwordx4 v[4:7], v113, s[4:7], s48 offen sc1
  s_nop 0
  buffer_load_dwordx4 v[8:11], v114, s[4:7], s48 offen sc1
  s_nop 0
  s_branch L_VOO_ok12
L_VOO_g13:
  s_sub_u32 s24, s24, 1
  s_cbranch_scc1 L_FAIL
  s_add_u32 s61, s61, 256
  buffer_load_dwordx4 v[96:99], v112, s[4:7], s48 offen sc1
  s_waitcnt vmcnt(0)
  v_cmp_eq_u32 vcc, -1, v96
  s_cbranch_vccnz L_VOO_g13
  buffer_load_dwordx4 v[4:7], v113, s[4:7], s48 offen sc1
  s_nop 0
  buffer_load_dwordx4 v[8:11], v114, s[4:7], s48 offen sc1
  s_nop 0
  s_branch L_VOO_ok13
L_VOO_g14:
  s_sub_u32 s24, s24, 1
  s_cbranch_scc1 L_FAIL
  s_add_u32 s61, s61, 256
  buffer_load_dwordx4 v[4:7], v113, s[4:7], s48 offen sc1
  s_waitcnt vmcnt(0)
  v_cmp_eq_u32 vcc, -1, v4
  s_cbranch_vccnz L_VOO_g14
  buffer_load_dwordx4 v[8:11], v114, s[4:7], s48 offen sc1
  s_nop 0
  s_branch L_VOO_ok14
L_VOO_g15:
  s_sub_u32 s24, s24, 1
  s_cbranch_scc1 L_FAIL
  s_add_u32 s61, s61, 256
  buffer_load_dwordx4 v[8:11], v114, s[4:7], s48 offen sc1
  s_waitcnt vmcnt(0)
  v_cmp_eq_u32 vcc, -1, v8
  s_cbranch_vccnz L_VOO_g15
  s_branch L_VOO_ok15
.section .rodata,"a"
.p2align 6
.amdhsa_kernel adaLN_cond__memory_aug_recurrent_mem_tr__glu_gated_swiglu__prompt_kernel
  .amdhsa_next_free_vgpr 512
  .amdhsa_next_free_sgpr 102
  .amdhsa_accum_offset 256
  .amdhsa_group_segment_fixed_size 0
  .amdhsa_kernarg_size 128
  .amdhsa_user_sgpr_count 2
  .amdhsa_user_sgpr_kernarg_segment_ptr 1
  .amdhsa_system_sgpr_workgroup_id_x 1
  .amdhsa_float_denorm_mode_32 3
.end_amdhsa_kernel
```

```asm
; @launch grid=(256,1,1) block=(256,1,1) lds=163840
.amdgcn_target "amdgcn-amd-amdhsa--gfx950"
.text
.globl adaLN_cond__memory_aug_recurrent_mem_tr__glu_gated_swiglu__prompt_kernel
.p2align 8
.type adaLN_cond__memory_aug_recurrent_mem_tr__glu_gated_swiglu__prompt_kernel,@function
adaLN_cond__memory_aug_recurrent_mem_tr__glu_gated_swiglu__prompt_kernel:
  s_cmp_ge_u32 s2, 256
  s_cbranch_scc1 L_END
  s_load_dwordx2 s[4:5], s[0:1], 120
  s_load_dwordx2 s[12:13], s[0:1], 112
  v_lshrrev_b32 v1, 6, v0
  v_and_b32 v0, 63, v0
  v_readfirstlane_b32 s20, v1
  s_mov_b32 s6, 205520896
  s_mov_b32 s7, 0x20000
  s_mov_b32 s14, 256
  s_mov_b32 s15, 0x20000
  s_mov_b32 s24, 300000
  s_and_b32 s40, s2, 7
  s_lshl_b32 s40, s40, 2
  s_lshr_b32 s22, 0x53417260, s40
  s_and_b32 s22, s22, 7
  s_lshr_b32 s23, s2, 3
  s_waitcnt lgkmcnt(0)
  s_add_u32 s4, s4, 0x1fffff
  s_addc_u32 s5, s5, 0
  s_and_b32 s4, s4, 0xffe00000
  s_cmp_ge_u32 s22, 4
  s_cbranch_scc1 L_TRAIL
  s_lshr_b32 s40, s22, 1
  s_bitcmp1_b32 s22, 0
  s_cbranch_scc0 L_REC
  s_lshl_b32 s40, s40, 5
  s_add_u32 s21, s40, s23
  s_branch L_QKV
L_REC:
  s_lshl_b32 s40, s40, 4
  s_lshr_b32 s41, s23, 1
  s_add_u32 s21, s40, s41
  s_bitcmp1_b32 s23, 0
  s_cbranch_scc1 L_VO
  s_branch L_QK
L_TRAIL:
  s_mov_b32 s21, s23
  s_cmp_eq_u32 s22, 6
  s_cbranch_scc1 L_MOD
  s_sub_u32 s40, s22, 4
  s_lshl_b32 s40, s40, 5
  s_add_u32 s21, s40, s23
  s_cmp_lg_u32 s22, 7
  s_cbranch_scc1 L_WOF
L_INIT:
  s_lshl_b32 s40, s23, 2
  s_add_u32 s40, s40, s20
  s_lshl_b32 s40, s40, 12
  s_add_u32 s41, s40, 1048576
  s_add_u32 s42, s40, 0x80000
  v_lshlrev_b32 v1, 4, v0
  v_mov_b32 v4, -1
  v_mov_b32 v5, -1
  v_mov_b32 v6, -1
  v_mov_b32 v7, -1
  s_cmp_lt_u32 s23, 4
  s_cselect_b32 s41, 2147483392, s41
  buffer_store_dwordx4 v[4:7], v1, s[4:7], s41 offen offset:0 sc1
  buffer_store_dwordx4 v[4:7], v1, s[4:7], s41 offen offset:1024 sc1
  buffer_store_dwordx4 v[4:7], v1, s[4:7], s41 offen offset:2048 sc1
  buffer_store_dwordx4 v[4:7], v1, s[4:7], s41 offen offset:3072 sc1
  buffer_store_dwordx4 v[4:7], v1, s[4:7], s40 offen offset:0 sc1
  buffer_store_dwordx4 v[4:7], v1, s[4:7], s40 offen offset:1024 sc1
  buffer_store_dwordx4 v[4:7], v1, s[4:7], s40 offen offset:2048 sc1
  buffer_store_dwordx4 v[4:7], v1, s[4:7], s40 offen offset:3072 sc1
  buffer_store_dwordx4 v[4:7], v1, s[4:7], s42 offen offset:0 sc1
  buffer_store_dwordx4 v[4:7], v1, s[4:7], s42 offen offset:1024 sc1
  buffer_store_dwordx4 v[4:7], v1, s[4:7], s42 offen offset:2048 sc1
  buffer_store_dwordx4 v[4:7], v1, s[4:7], s42 offen offset:3072 sc1
  s_load_dwordx2 s[16:17], s[0:1], 8
  s_mov_b32 s18, 16384
  s_mov_b32 s19, 0x20000
  s_waitcnt lgkmcnt(0)
  s_and_b32 s40, s20, 1
  s_lshl_b32 s40, s40, 3
  v_bfe_u32 v8, v0, 2, 3
  v_add_u32 v8, s40, v8
  s_lshr_b32 s40, s20, 1
  s_lshl_b32 s40, s40, 3
  v_and_b32 v9, 3, v0
  v_add_u32 v9, s40, v9
  v_bfe_u32 v10, v8, 1, 1
  v_lshl_add_u32 v9, v10, 2, v9
  v_lshrrev_b32 v10, 2, v8
  v_and_b32 v11, 1, v8
  v_lshl_add_u32 v10, v10, 1, v11
  s_lshl_b32 s40, s23, 6
  v_lshl_add_u32 v10, v10, 11, s40
  v_lshl_add_u32 v10, v9, 1, v10
  buffer_load_ushort v11, v10, s[16:19], 0 offen
  buffer_load_ushort v12, v10, s[16:19], 0 offen offset:32
  s_bfe_u32 s41, s23, 0x10002
  s_mul_i32 s41, s41, 32768
  s_lshr_b32 s40, s23, 3
  s_lshl_b32 s40, s40, 11
  s_add_u32 s40, s40, s41
  s_and_b32 s41, s23, 3
  s_lshl_b32 s41, s41, 9
  s_add_u32 s40, s40, s41
  s_lshl_b32 s41, s20, 7
  s_add_u32 s40, s40, s41
  s_add_u32 s40, s40, 1048576
  s_add_u32 s41, s40, 0x4000
  v_and_b32 v8, 31, v0
  v_lshlrev_b32 v8, 2, v8
  v_lshrrev_b32 v9, 5, v0
  v_lshl_add_u32 v8, v9, 13, v8
  s_waitcnt vmcnt(0)
  v_lshl_or_b32 v11, v12, 16, v11
  v_min_u32 v11, -2, v11
  buffer_store_dword v11, v8, s[4:7], s40 offen sc1
  buffer_store_dword v11, v8, s[4:7], s41 offen sc1
  s_lshl_b32 s40, s23, 2
  s_add_u32 s40, s40, 128
  v_mov_b32 v2, 2147483392
  s_mov_b64 exec, 1
  v_mov_b32 v2, s40
  s_mov_b64 exec, -1
  v_mov_b32 v3, 1
  s_waitcnt vmcnt(0)
  s_barrier
  s_cmp_lg_u32 s20, 0
  s_cbranch_scc1 L_LN1
  buffer_store_dword v3, v2, s[12:15], 0 offen sc1
  s_branch L_LN1
L_MOD:
  s_load_dwordx2 s[16:17], s[0:1], 88
  s_mov_b32 s18, 2048
  s_mov_b32 s19, 0x20000
  s_waitcnt lgkmcnt(0)
  s_load_dwordx2 s[8:9], s[0:1], 96
  s_mov_b32 s10, 12582912
  s_mov_b32 s11, 0x20000
  s_waitcnt lgkmcnt(0)
  s_lshl_b32 s40, s20, 9
  v_lshl_add_u32 v1, v0, 3, s40
  buffer_load_dwordx2 v[8:9], v1, s[16:19], 0 offen
  v_bfe_u32 v2, v0, 5, 1
  v_mul_u32_u24 v2, 98304, v2
  v_bfe_u32 v3, v0, 4, 1
  v_mul_u32_u24 v3, 24576, v3
  v_add_u32 v2, v2, v3
  v_bfe_u32 v3, v0, 3, 1
  v_mul_u32_u24 v3, 12288, v3
  v_add_u32 v2, v2, v3
  v_lshrrev_b32 v3, 3, v0
  v_and_b32 v3, 6, v3
  v_xor_b32 v3, v3, v0
  v_and_b32 v3, 7, v3
  v_lshl_add_u32 v2, v3, 4, v2
  s_lshr_b32 s40, s20, 1
  s_mul_i32 s40, s40, 49152
  s_and_b32 s41, s20, 1
  s_mul_i32 s41, s41, 196608
  s_add_u32 s40, s40, s41
  s_lshl_b32 s41, s21, 7
  s_add_u32 s40, s40, s41
  v_add_u32 v2, s40, v2
  s_lshl_b32 s41, s20, 10
  s_add_u32 m0, s41, 0
  s_mov_b32 s42, 0
  buffer_load_dwordx4 v2, s[8:11], s42 offen nt lds
  s_add_u32 m0, s41, 4096
  s_mov_b32 s42, 393216
  buffer_load_dwordx4 v2, s[8:11], s42 offen nt lds
  s_add_u32 m0, s41, 8192
  s_mov_b32 s42, 786432
  buffer_load_dwordx4 v2, s[8:11], s42 offen nt lds
  s_add_u32 m0, s41, 12288
  s_mov_b32 s42, 1179648
  buffer_load_dwordx4 v2, s[8:11], s42 offen nt lds
  s_add_u32 m0, s41, 16384
  s_mov_b32 s42, 1572864
  buffer_load_dwordx4 v2, s[8:11], s42 offen nt lds
  s_add_u32 m0, s41, 20480
  s_mov_b32 s42, 1966080
  buffer_load_dwordx4 v2, s[8:11], s42 offen nt lds
  s_add_u32 m0, s41, 24576
  s_mov_b32 s42, 2359296
  buffer_load_dwordx4 v2, s[8:11], s42 offen nt lds
  s_add_u32 m0, s41, 28672
  s_mov_b32 s42, 2752512
  buffer_load_dwordx4 v2, s[8:11], s42 offen nt lds
  s_add_u32 m0, s41, 32768
  s_mov_b32 s42, 3145728
  buffer_load_dwordx4 v2, s[8:11], s42 offen nt lds
  s_add_u32 m0, s41, 36864
  s_mov_b32 s42, 3538944
  buffer_load_dwordx4 v2, s[8:11], s42 offen nt lds
  s_add_u32 m0, s41, 40960
  s_mov_b32 s42, 3932160
  buffer_load_dwordx4 v2, s[8:11], s42 offen nt lds
  s_add_u32 m0, s41, 45056
  s_mov_b32 s42, 4325376
  buffer_load_dwordx4 v2, s[8:11], s42 offen nt lds
  s_add_u32 m0, s41, 49152
  s_mov_b32 s42, 4718592
  buffer_load_dwordx4 v2, s[8:11], s42 offen nt lds
  s_add_u32 m0, s41, 53248
  s_mov_b32 s42, 5111808
  buffer_load_dwordx4 v2, s[8:11], s42 offen nt lds
  s_add_u32 m0, s41, 57344
  s_mov_b32 s42, 5505024
  buffer_load_dwordx4 v2, s[8:11], s42 offen nt lds
  s_add_u32 m0, s41, 61440
  s_mov_b32 s42, 5898240
  buffer_load_dwordx4 v2, s[8:11], s42 offen nt lds
  s_add_u32 m0, s41, 65536
  s_mov_b32 s42, 6291456
  buffer_load_dwordx4 v2, s[8:11], s42 offen nt lds
  s_add_u32 m0, s41, 69632
  s_mov_b32 s42, 6684672
  buffer_load_dwordx4 v2, s[8:11], s42 offen nt lds
  s_add_u32 m0, s41, 73728
  s_mov_b32 s42, 7077888
  buffer_load_dwordx4 v2, s[8:11], s42 offen nt lds
  s_add_u32 m0, s41, 77824
  s_mov_b32 s42, 7471104
  buffer_load_dwordx4 v2, s[8:11], s42 offen nt lds
  s_add_u32 m0, s41, 81920
  s_mov_b32 s42, 7864320
  buffer_load_dwordx4 v2, s[8:11], s42 offen nt lds
  s_add_u32 m0, s41, 86016
  s_mov_b32 s42, 8257536
  buffer_load_dwordx4 v2, s[8:11], s42 offen nt lds
  s_add_u32 m0, s41, 90112
  s_mov_b32 s42, 8650752
  buffer_load_dwordx4 v2, s[8:11], s42 offen nt lds
  s_add_u32 m0, s41, 94208
  s_mov_b32 s42, 9043968
  buffer_load_dwordx4 v2, s[8:11], s42 offen nt lds
  s_add_u32 m0, s41, 98304
  s_mov_b32 s42, 9437184
  buffer_load_dwordx4 v2, s[8:11], s42 offen nt lds
  s_add_u32 m0, s41, 102400
  s_mov_b32 s42, 9830400
  buffer_load_dwordx4 v2, s[8:11], s42 offen nt lds
  s_add_u32 m0, s41, 106496
  s_mov_b32 s42, 10223616
  buffer_load_dwordx4 v2, s[8:11], s42 offen nt lds
  s_add_u32 m0, s41, 110592
  s_mov_b32 s42, 10616832
  buffer_load_dwordx4 v2, s[8:11], s42 offen nt lds
  s_add_u32 m0, s41, 114688
  s_mov_b32 s42, 11010048
  buffer_load_dwordx4 v2, s[8:11], s42 offen nt lds
  s_add_u32 m0, s41, 118784
  s_mov_b32 s42, 11403264
  buffer_load_dwordx4 v2, s[8:11], s42 offen nt lds
  s_add_u32 m0, s41, 122880
  s_mov_b32 s42, 11796480
  buffer_load_dwordx4 v2, s[8:11], s42 offen nt lds
  s_add_u32 m0, s41, 126976
  s_mov_b32 s42, 12189696
  buffer_load_dwordx4 v2, s[8:11], s42 offen nt lds
  v_bfe_u32 v3, v0, 3, 2
  v_xor_b32 v3, s20, v3
  v_lshlrev_b32 v3, 5, v3
  v_lshrrev_b32 v4, 2, v0
  v_lshl_add_u32 v4, v4, 7, v3
  v_and_b32 v3, 3, v0
  v_lshl_add_u32 v4, v3, 3, v4
  v_add_u32 v5, 0x10000, v4
  v_lshrrev_b32 v6, 4, v0
  v_lshlrev_b32 v6, 4, v6
  v_add_u32 v6, 0x20000, v6
  v_add_u32 v1, 0x20000, v1
  s_mov_b32 s37, 0xbfb8aa3b
  s_waitcnt vmcnt(32)
  v_lshlrev_b32 v10, 16, v8
  v_and_b32 v11, 0xffff0000, v8
  v_lshlrev_b32 v12, 16, v9
  v_and_b32 v13, 0xffff0000, v9
  v_mul_f32 v14, s37, v10
  v_mul_f32 v15, s37, v11
  v_mul_f32 v16, s37, v12
  v_mul_f32 v17, s37, v13
  v_exp_f32 v14, v14
  v_exp_f32 v15, v15
  v_exp_f32 v16, v16
  v_exp_f32 v17, v17
  v_add_f32 v14, 1.0, v14
  v_add_f32 v15, 1.0, v15
  v_add_f32 v16, 1.0, v16
  v_add_f32 v17, 1.0, v17
  v_rcp_f32 v14, v14
  v_rcp_f32 v15, v15
  v_rcp_f32 v16, v16
  v_rcp_f32 v17, v17
  v_mul_f32 v10, v10, v14
  v_mul_f32 v11, v11, v15
  v_mul_f32 v12, v12, v16
  v_mul_f32 v13, v13, v17
  v_cvt_pk_bf16_f32 v8, v10, v11
  v_cvt_pk_bf16_f32 v9, v12, v13
  ds_write_b64 v1, v[8:9]
  s_waitcnt vmcnt(28) lgkmcnt(0)
  s_barrier
  ds_read_b64_tr_b16 v[24:25], v4 offset:0
  ds_read_b64_tr_b16 v[26:27], v4 offset:2048
  ds_read_b128 v[28:31], v6 offset:0
  ds_read_b64_tr_b16 v[32:33], v4 offset:4096
  ds_read_b64_tr_b16 v[34:35], v4 offset:6144
  ds_read_b128 v[36:39], v6 offset:64
  ds_read_b64_tr_b16 v[40:41], v4 offset:8192
  ds_read_b64_tr_b16 v[42:43], v4 offset:10240
  ds_read_b128 v[44:47], v6 offset:128
  ds_read_b64_tr_b16 v[48:49], v4 offset:12288
  ds_read_b64_tr_b16 v[50:51], v4 offset:14336
  ds_read_b128 v[52:55], v6 offset:192
  s_waitcnt lgkmcnt(9)
  v_mfma_f32_16x16x32_bf16 v[20:23], v[24:27], v[28:31], 0
  s_waitcnt lgkmcnt(6)
  v_mfma_f32_16x16x32_bf16 v[20:23], v[32:35], v[36:39], v[20:23]
  s_waitcnt lgkmcnt(3)
  v_mfma_f32_16x16x32_bf16 v[20:23], v[40:43], v[44:47], v[20:23]
  s_waitcnt lgkmcnt(0)
  v_mfma_f32_16x16x32_bf16 v[20:23], v[48:51], v[52:55], v[20:23]
  s_waitcnt vmcnt(24) lgkmcnt(0)
  s_barrier
  ds_read_b64_tr_b16 v[24:25], v4 offset:16384
  ds_read_b64_tr_b16 v[26:27], v4 offset:18432
  ds_read_b128 v[28:31], v6 offset:256
  ds_read_b64_tr_b16 v[32:33], v4 offset:20480
  ds_read_b64_tr_b16 v[34:35], v4 offset:22528
  ds_read_b128 v[36:39], v6 offset:320
  ds_read_b64_tr_b16 v[40:41], v4 offset:24576
  ds_read_b64_tr_b16 v[42:43], v4 offset:26624
  ds_read_b128 v[44:47], v6 offset:384
  ds_read_b64_tr_b16 v[48:49], v4 offset:28672
  ds_read_b64_tr_b16 v[50:51], v4 offset:30720
  ds_read_b128 v[52:55], v6 offset:448
  s_waitcnt lgkmcnt(9)
  v_mfma_f32_16x16x32_bf16 v[20:23], v[24:27], v[28:31], v[20:23]
  s_waitcnt lgkmcnt(6)
  v_mfma_f32_16x16x32_bf16 v[20:23], v[32:35], v[36:39], v[20:23]
  s_waitcnt lgkmcnt(3)
  v_mfma_f32_16x16x32_bf16 v[20:23], v[40:43], v[44:47], v[20:23]
  s_waitcnt lgkmcnt(0)
  v_mfma_f32_16x16x32_bf16 v[20:23], v[48:51], v[52:55], v[20:23]
  s_waitcnt vmcnt(20) lgkmcnt(0)
  s_barrier
  ds_read_b64_tr_b16 v[24:25], v4 offset:32768
  ds_read_b64_tr_b16 v[26:27], v4 offset:34816
  ds_read_b128 v[28:31], v6 offset:512
  ds_read_b64_tr_b16 v[32:33], v4 offset:36864
  ds_read_b64_tr_b16 v[34:35], v4 offset:38912
  ds_read_b128 v[36:39], v6 offset:576
  ds_read_b64_tr_b16 v[40:41], v4 offset:40960
  ds_read_b64_tr_b16 v[42:43], v4 offset:43008
  ds_read_b128 v[44:47], v6 offset:640
  ds_read_b64_tr_b16 v[48:49], v4 offset:45056
  ds_read_b64_tr_b16 v[50:51], v4 offset:47104
  ds_read_b128 v[52:55], v6 offset:704
  s_waitcnt lgkmcnt(9)
  v_mfma_f32_16x16x32_bf16 v[20:23], v[24:27], v[28:31], v[20:23]
  s_waitcnt lgkmcnt(6)
  v_mfma_f32_16x16x32_bf16 v[20:23], v[32:35], v[36:39], v[20:23]
  s_waitcnt lgkmcnt(3)
  v_mfma_f32_16x16x32_bf16 v[20:23], v[40:43], v[44:47], v[20:23]
  s_waitcnt lgkmcnt(0)
  v_mfma_f32_16x16x32_bf16 v[20:23], v[48:51], v[52:55], v[20:23]
  s_waitcnt vmcnt(16) lgkmcnt(0)
  s_barrier
  ds_read_b64_tr_b16 v[24:25], v4 offset:49152
  ds_read_b64_tr_b16 v[26:27], v4 offset:51200
  ds_read_b128 v[28:31], v6 offset:768
  ds_read_b64_tr_b16 v[32:33], v4 offset:53248
  ds_read_b64_tr_b16 v[34:35], v4 offset:55296
  ds_read_b128 v[36:39], v6 offset:832
  ds_read_b64_tr_b16 v[40:41], v4 offset:57344
  ds_read_b64_tr_b16 v[42:43], v4 offset:59392
  ds_read_b128 v[44:47], v6 offset:896
  ds_read_b64_tr_b16 v[48:49], v4 offset:61440
  ds_read_b64_tr_b16 v[50:51], v4 offset:63488
  ds_read_b128 v[52:55], v6 offset:960
  s_waitcnt lgkmcnt(9)
  v_mfma_f32_16x16x32_bf16 v[20:23], v[24:27], v[28:31], v[20:23]
  s_waitcnt lgkmcnt(6)
  v_mfma_f32_16x16x32_bf16 v[20:23], v[32:35], v[36:39], v[20:23]
  s_waitcnt lgkmcnt(3)
  v_mfma_f32_16x16x32_bf16 v[20:23], v[40:43], v[44:47], v[20:23]
  s_waitcnt lgkmcnt(0)
  v_mfma_f32_16x16x32_bf16 v[20:23], v[48:51], v[52:55], v[20:23]
  s_waitcnt vmcnt(12) lgkmcnt(0)
  s_barrier
  ds_read_b64_tr_b16 v[24:25], v5 offset:0
  ds_read_b64_tr_b16 v[26:27], v5 offset:2048
  ds_read_b128 v[28:31], v6 offset:1024
  ds_read_b64_tr_b16 v[32:33], v5 offset:4096
  ds_read_b64_tr_b16 v[34:35], v5 offset:6144
  ds_read_b128 v[36:39], v6 offset:1088
  ds_read_b64_tr_b16 v[40:41], v5 offset:8192
  ds_read_b64_tr_b16 v[42:43], v5 offset:10240
  ds_read_b128 v[44:47], v6 offset:1152
  ds_read_b64_tr_b16 v[48:49], v5 offset:12288
  ds_read_b64_tr_b16 v[50:51], v5 offset:14336
  ds_read_b128 v[52:55], v6 offset:1216
  s_waitcnt lgkmcnt(9)
  v_mfma_f32_16x16x32_bf16 v[20:23], v[24:27], v[28:31], v[20:23]
  s_waitcnt lgkmcnt(6)
  v_mfma_f32_16x16x32_bf16 v[20:23], v[32:35], v[36:39], v[20:23]
  s_waitcnt lgkmcnt(3)
  v_mfma_f32_16x16x32_bf16 v[20:23], v[40:43], v[44:47], v[20:23]
  s_waitcnt lgkmcnt(0)
  v_mfma_f32_16x16x32_bf16 v[20:23], v[48:51], v[52:55], v[20:23]
  s_waitcnt vmcnt(8) lgkmcnt(0)
  s_barrier
  ds_read_b64_tr_b16 v[24:25], v5 offset:16384
  ds_read_b64_tr_b16 v[26:27], v5 offset:18432
  ds_read_b128 v[28:31], v6 offset:1280
  ds_read_b64_tr_b16 v[32:33], v5 offset:20480
  ds_read_b64_tr_b16 v[34:35], v5 offset:22528
  ds_read_b128 v[36:39], v6 offset:1344
  ds_read_b64_tr_b16 v[40:41], v5 offset:24576
  ds_read_b64_tr_b16 v[42:43], v5 offset:26624
  ds_read_b128 v[44:47], v6 offset:1408
  ds_read_b64_tr_b16 v[48:49], v5 offset:28672
  ds_read_b64_tr_b16 v[50:51], v5 offset:30720
  ds_read_b128 v[52:55], v6 offset:1472
  s_waitcnt lgkmcnt(9)
  v_mfma_f32_16x16x32_bf16 v[20:23], v[24:27], v[28:31], v[20:23]
  s_waitcnt lgkmcnt(6)
  v_mfma_f32_16x16x32_bf16 v[20:23], v[32:35], v[36:39], v[20:23]
  s_waitcnt lgkmcnt(3)
  v_mfma_f32_16x16x32_bf16 v[20:23], v[40:43], v[44:47], v[20:23]
  s_waitcnt lgkmcnt(0)
  v_mfma_f32_16x16x32_bf16 v[20:23], v[48:51], v[52:55], v[20:23]
  s_waitcnt vmcnt(4) lgkmcnt(0)
  s_barrier
  ds_read_b64_tr_b16 v[24:25], v5 offset:32768
  ds_read_b64_tr_b16 v[26:27], v5 offset:34816
  ds_read_b128 v[28:31], v6 offset:1536
  ds_read_b64_tr_b16 v[32:33], v5 offset:36864
  ds_read_b64_tr_b16 v[34:35], v5 offset:38912
  ds_read_b128 v[36:39], v6 offset:1600
  ds_read_b64_tr_b16 v[40:41], v5 offset:40960
  ds_read_b64_tr_b16 v[42:43], v5 offset:43008
  ds_read_b128 v[44:47], v6 offset:1664
  ds_read_b64_tr_b16 v[48:49], v5 offset:45056
  ds_read_b64_tr_b16 v[50:51], v5 offset:47104
  ds_read_b128 v[52:55], v6 offset:1728
  s_waitcnt lgkmcnt(9)
  v_mfma_f32_16x16x32_bf16 v[20:23], v[24:27], v[28:31], v[20:23]
  s_waitcnt lgkmcnt(6)
  v_mfma_f32_16x16x32_bf16 v[20:23], v[32:35], v[36:39], v[20:23]
  s_waitcnt lgkmcnt(3)
  v_mfma_f32_16x16x32_bf16 v[20:23], v[40:43], v[44:47], v[20:23]
  s_waitcnt lgkmcnt(0)
  v_mfma_f32_16x16x32_bf16 v[20:23], v[48:51], v[52:55], v[20:23]
  s_waitcnt vmcnt(0) lgkmcnt(0)
  s_barrier
  ds_read_b64_tr_b16 v[24:25], v5 offset:49152
  ds_read_b64_tr_b16 v[26:27], v5 offset:51200
  ds_read_b128 v[28:31], v6 offset:1792
  ds_read_b64_tr_b16 v[32:33], v5 offset:53248
  ds_read_b64_tr_b16 v[34:35], v5 offset:55296
  ds_read_b128 v[36:39], v6 offset:1856
  ds_read_b64_tr_b16 v[40:41], v5 offset:57344
  ds_read_b64_tr_b16 v[42:43], v5 offset:59392
  ds_read_b128 v[44:47], v6 offset:1920
  ds_read_b64_tr_b16 v[48:49], v5 offset:61440
  ds_read_b64_tr_b16 v[50:51], v5 offset:63488
  ds_read_b128 v[52:55], v6 offset:1984
  s_waitcnt lgkmcnt(9)
  v_mfma_f32_16x16x32_bf16 v[20:23], v[24:27], v[28:31], v[20:23]
  s_waitcnt lgkmcnt(6)
  v_mfma_f32_16x16x32_bf16 v[20:23], v[32:35], v[36:39], v[20:23]
  s_waitcnt lgkmcnt(3)
  v_mfma_f32_16x16x32_bf16 v[20:23], v[40:43], v[44:47], v[20:23]
  s_waitcnt lgkmcnt(0)
  v_mfma_f32_16x16x32_bf16 v[20:23], v[48:51], v[52:55], v[20:23]
  s_lshl_b32 s40, s21, 8
  s_lshl_b32 s41, s20, 6
  s_add_u32 s40, s40, s41
  s_add_u32 s40, s40, 1572864
  v_and_b32 v2, 15, v0
  v_cmp_eq_u32 vcc, 0, v2
  v_mov_b32 v3, 2147483392
  s_nop 0
  v_cndmask_b32 v1, v3, v0, vcc
  v_cvt_pk_bf16_f32 v8, v20, v21
  v_cvt_pk_bf16_f32 v9, v22, v23
  v_lshlrev_b32 v20, 16, v8
  v_and_b32 v21, 0xffff0000, v8
  v_lshlrev_b32 v22, 16, v9
  v_and_b32 v23, 0xffff0000, v9
  buffer_store_dwordx4 v[20:23], v1, s[4:7], s40 offen sc1
  v_min_u32 v2, 31, v0
  v_lshlrev_b32 v2, 2, v2
  v_add_u32 v2, 128, v2
  s_nop 1
Lpoll_1:
  buffer_load_dword v3, v2, s[12:15], 0 offen sc1
  s_sub_u32 s24, s24, 1
  s_cbranch_scc1 L_FAIL
  s_waitcnt vmcnt(0)
  v_cmp_gt_i32 vcc, 1, v3
  s_cbranch_vccz Lpolld_2
  s_sleep 2
  s_branch Lpoll_1
Lpolld_2:
  s_lshl_b32 s40, s21, 7
  s_add_u32 s40, s40, 1376256
  v_mov_b32 v2, 2147483392
  s_mov_b64 exec, 1
  v_mov_b32 v2, s40
  s_mov_b64 exec, -1
  v_mov_b32 v3, 1
  s_barrier
  s_cmp_lg_u32 s20, 0
  s_cbranch_scc1 L_MOD_done
  buffer_store_dword v3, v2, s[4:7], 0 offen sc1
L_MOD_done:
  s_cmp_lg_u32 s22, 6
  s_cbranch_scc1 L_ROLE
L_LN1:
  s_load_dwordx2 s[16:17], s[0:1], 0
  s_mov_b32 s18, 4194304
  s_mov_b32 s19, 0x20000
  s_waitcnt lgkmcnt(0)
  s_sub_u32 s43, 7, s22
  s_lshl_b32 s43, s43, 5
  s_add_u32 s43, s43, s23
  s_lshl_b32 s43, s43, 2
  s_add_u32 s43, s43, s20
  s_lshl_b32 s44, s43, 13
  s_add_u32 s45, s44, 4096
  v_lshlrev_b32 v1, 3, v0
  v_lshlrev_b32 v2, 4, v0
  buffer_load_dwordx2 v[8:9], v1, s[16:19], s44 offen offset:0 nt
  buffer_load_dwordx2 v[10:11], v1, s[16:19], s44 offen offset:512 nt
  buffer_load_dwordx2 v[12:13], v1, s[16:19], s44 offen offset:1024 nt
  buffer_load_dwordx2 v[14:15], v1, s[16:19], s44 offen offset:1536 nt
  buffer_load_dwordx2 v[16:17], v1, s[16:19], s44 offen offset:2048 nt
  buffer_load_dwordx2 v[18:19], v1, s[16:19], s44 offen offset:2560 nt
  buffer_load_dwordx2 v[20:21], v1, s[16:19], s44 offen offset:3072 nt
  buffer_load_dwordx2 v[22:23], v1, s[16:19], s44 offen offset:3584 nt
  buffer_load_dwordx2 v[24:25], v1, s[16:19], s45 offen offset:0 nt
  buffer_load_dwordx2 v[26:27], v1, s[16:19], s45 offen offset:512 nt
  buffer_load_dwordx2 v[28:29], v1, s[16:19], s45 offen offset:1024 nt
  buffer_load_dwordx2 v[30:31], v1, s[16:19], s45 offen offset:1536 nt
  buffer_load_dwordx2 v[32:33], v1, s[16:19], s45 offen offset:2048 nt
  buffer_load_dwordx2 v[34:35], v1, s[16:19], s45 offen offset:2560 nt
  buffer_load_dwordx2 v[36:37], v1, s[16:19], s45 offen offset:3072 nt
  buffer_load_dwordx2 v[38:39], v1, s[16:19], s45 offen offset:3584 nt
  s_waitcnt vmcnt(0)
  v_lshlrev_b32 v40, 16, v8
  v_and_b32 v41, 0xffff0000, v8
  v_lshlrev_b32 v42, 16, v9
  v_and_b32 v43, 0xffff0000, v9
  v_lshlrev_b32 v44, 16, v10
  v_and_b32 v45, 0xffff0000, v10
  v_lshlrev_b32 v46, 16, v11
  v_and_b32 v47, 0xffff0000, v11
  v_lshlrev_b32 v48, 16, v12
  v_and_b32 v49, 0xffff0000, v12
  v_lshlrev_b32 v50, 16, v13
  v_and_b32 v51, 0xffff0000, v13
  v_lshlrev_b32 v52, 16, v14
  v_and_b32 v53, 0xffff0000, v14
  v_lshlrev_b32 v54, 16, v15
  v_and_b32 v55, 0xffff0000, v15
  v_lshlrev_b32 v56, 16, v16
  v_and_b32 v57, 0xffff0000, v16
  v_lshlrev_b32 v58, 16, v17
  v_and_b32 v59, 0xffff0000, v17
  v_lshlrev_b32 v60, 16, v18
  v_and_b32 v61, 0xffff0000, v18
  v_lshlrev_b32 v62, 16, v19
  v_and_b32 v63, 0xffff0000, v19
  v_lshlrev_b32 v64, 16, v20
  v_and_b32 v65, 0xffff0000, v20
  v_lshlrev_b32 v66, 16, v21
  v_and_b32 v67, 0xffff0000, v21
  v_lshlrev_b32 v68, 16, v22
  v_and_b32 v69, 0xffff0000, v22
  v_lshlrev_b32 v70, 16, v23
  v_and_b32 v71, 0xffff0000, v23
  v_lshlrev_b32 v72, 16, v24
  v_and_b32 v73, 0xffff0000, v24
  v_lshlrev_b32 v74, 16, v25
  v_and_b32 v75, 0xffff0000, v25
  v_lshlrev_b32 v76, 16, v26
  v_and_b32 v77, 0xffff0000, v26
  v_lshlrev_b32 v78, 16, v27
  v_and_b32 v79, 0xffff0000, v27
  v_lshlrev_b32 v80, 16, v28
  v_and_b32 v81, 0xffff0000, v28
  v_lshlrev_b32 v82, 16, v29
  v_and_b32 v83, 0xffff0000, v29
  v_lshlrev_b32 v84, 16, v30
  v_and_b32 v85, 0xffff0000, v30
  v_lshlrev_b32 v86, 16, v31
  v_and_b32 v87, 0xffff0000, v31
  v_lshlrev_b32 v88, 16, v32
  v_and_b32 v89, 0xffff0000, v32
  v_lshlrev_b32 v90, 16, v33
  v_and_b32 v91, 0xffff0000, v33
  v_lshlrev_b32 v92, 16, v34
  v_and_b32 v93, 0xffff0000, v34
  v_lshlrev_b32 v94, 16, v35
  v_and_b32 v95, 0xffff0000, v35
  v_lshlrev_b32 v96, 16, v36
  v_and_b32 v97, 0xffff0000, v36
  v_lshlrev_b32 v98, 16, v37
  v_and_b32 v99, 0xffff0000, v37
  v_lshlrev_b32 v100, 16, v38
  v_and_b32 v101, 0xffff0000, v38
  v_lshlrev_b32 v102, 16, v39
  v_and_b32 v103, 0xffff0000, v39
  v_pk_add_f32 v[104:105], v[40:41], v[42:43]
  v_pk_add_f32 v[108:109], v[56:57], v[58:59]
  v_pk_add_f32 v[112:113], v[72:73], v[74:75]
  v_pk_add_f32 v[116:117], v[88:89], v[90:91]
  v_pk_add_f32 v[104:105], v[104:105], v[44:45]
  v_pk_add_f32 v[108:109], v[108:109], v[60:61]
  v_pk_add_f32 v[112:113], v[112:113], v[76:77]
  v_pk_add_f32 v[116:117], v[116:117], v[92:93]
  v_pk_add_f32 v[104:105], v[104:105], v[46:47]
  v_pk_add_f32 v[108:109], v[108:109], v[62:63]
  v_pk_add_f32 v[112:113], v[112:113], v[78:79]
  v_pk_add_f32 v[116:117], v[116:117], v[94:95]
  v_pk_add_f32 v[104:105], v[104:105], v[48:49]
  v_pk_add_f32 v[108:109], v[108:109], v[64:65]
  v_pk_add_f32 v[112:113], v[112:113], v[80:81]
  v_pk_add_f32 v[116:117], v[116:117], v[96:97]
  v_pk_add_f32 v[104:105], v[104:105], v[50:51]
  v_pk_add_f32 v[108:109], v[108:109], v[66:67]
  v_pk_add_f32 v[112:113], v[112:113], v[82:83]
  v_pk_add_f32 v[116:117], v[116:117], v[98:99]
  v_pk_add_f32 v[104:105], v[104:105], v[52:53]
  v_pk_add_f32 v[108:109], v[108:109], v[68:69]
  v_pk_add_f32 v[112:113], v[112:113], v[84:85]
  v_pk_add_f32 v[116:117], v[116:117], v[100:101]
  v_pk_add_f32 v[104:105], v[104:105], v[54:55]
  v_pk_add_f32 v[108:109], v[108:109], v[70:71]
  v_pk_add_f32 v[112:113], v[112:113], v[86:87]
  v_pk_add_f32 v[116:117], v[116:117], v[102:103]
  v_add_f32 v104, v104, v105
  v_add_f32 v108, v108, v109
  v_add_f32 v112, v112, v113
  v_add_f32 v116, v116, v117
  v_add_f32_dpp v104, v104, v104 row_ror:8 row_mask:0xf bank_mask:0xf
  v_add_f32_dpp v108, v108, v108 row_ror:8 row_mask:0xf bank_mask:0xf
  v_add_f32_dpp v112, v112, v112 row_ror:8 row_mask:0xf bank_mask:0xf
  v_add_f32_dpp v116, v116, v116 row_ror:8 row_mask:0xf bank_mask:0xf
  v_add_f32_dpp v104, v104, v104 row_ror:4 row_mask:0xf bank_mask:0xf
  v_add_f32_dpp v108, v108, v108 row_ror:4 row_mask:0xf bank_mask:0xf
  v_add_f32_dpp v112, v112, v112 row_ror:4 row_mask:0xf bank_mask:0xf
  v_add_f32_dpp v116, v116, v116 row_ror:4 row_mask:0xf bank_mask:0xf
  v_add_f32_dpp v104, v104, v104 row_ror:2 row_mask:0xf bank_mask:0xf
  v_add_f32_dpp v108, v108, v108 row_ror:2 row_mask:0xf bank_mask:0xf
  v_add_f32_dpp v112, v112, v112 row_ror:2 row_mask:0xf bank_mask:0xf
  v_add_f32_dpp v116, v116, v116 row_ror:2 row_mask:0xf bank_mask:0xf
  v_add_f32_dpp v104, v104, v104 row_ror:1 row_mask:0xf bank_mask:0xf
  v_add_f32_dpp v108, v108, v108 row_ror:1 row_mask:0xf bank_mask:0xf
  v_add_f32_dpp v112, v112, v112 row_ror:1 row_mask:0xf bank_mask:0xf
  v_add_f32_dpp v116, v116, v116 row_ror:1 row_mask:0xf bank_mask:0xf
  v_mov_b32 v105, v104
  v_mov_b32 v109, v108
  v_mov_b32 v113, v112
  v_mov_b32 v117, v116
  v_permlane16_swap_b32 v105, v104
  v_permlane16_swap_b32 v109, v108
  v_permlane16_swap_b32 v113, v112
  v_permlane16_swap_b32 v117, v116
  v_add_f32 v104, v104, v105
  v_add_f32 v108, v108, v109
  v_add_f32 v112, v112, v113
  v_add_f32 v116, v116, v117
  v_mov_b32 v105, v104
  v_mov_b32 v109, v108
  v_mov_b32 v113, v112
  v_mov_b32 v117, v116
  v_permlane32_swap_b32 v105, v104
  v_permlane32_swap_b32 v109, v108
  v_permlane32_swap_b32 v113, v112
  v_permlane32_swap_b32 v117, v116
  v_add_f32 v104, v104, v105
  v_add_f32 v108, v108, v109
  v_add_f32 v112, v112, v113
  v_add_f32 v116, v116, v117
  v_mul_f32 v104, 0xba800000, v104
  v_mul_f32 v108, 0xba800000, v108
  v_mul_f32 v112, 0xba800000, v112
  v_mul_f32 v116, 0xba800000, v116
  v_pk_add_f32 v[40:41], v[40:41], v[104:105] op_sel_hi:[1,0]
  v_pk_add_f32 v[56:57], v[56:57], v[108:109] op_sel_hi:[1,0]
  v_pk_add_f32 v[72:73], v[72:73], v[112:113] op_sel_hi:[1,0]
  v_pk_add_f32 v[88:89], v[88:89], v[116:117] op_sel_hi:[1,0]
  v_pk_add_f32 v[42:43], v[42:43], v[104:105] op_sel_hi:[1,0]
  v_pk_add_f32 v[58:59], v[58:59], v[108:109] op_sel_hi:[1,0]
  v_pk_add_f32 v[74:75], v[74:75], v[112:113] op_sel_hi:[1,0]
  v_pk_add_f32 v[90:91], v[90:91], v[116:117] op_sel_hi:[1,0]
  v_pk_add_f32 v[44:45], v[44:45], v[104:105] op_sel_hi:[1,0]
  v_pk_add_f32 v[60:61], v[60:61], v[108:109] op_sel_hi:[1,0]
  v_pk_add_f32 v[76:77], v[76:77], v[112:113] op_sel_hi:[1,0]
  v_pk_add_f32 v[92:93], v[92:93], v[116:117] op_sel_hi:[1,0]
  v_pk_add_f32 v[46:47], v[46:47], v[104:105] op_sel_hi:[1,0]
  v_pk_add_f32 v[62:63], v[62:63], v[108:109] op_sel_hi:[1,0]
  v_pk_add_f32 v[78:79], v[78:79], v[112:113] op_sel_hi:[1,0]
  v_pk_add_f32 v[94:95], v[94:95], v[116:117] op_sel_hi:[1,0]
  v_pk_add_f32 v[48:49], v[48:49], v[104:105] op_sel_hi:[1,0]
  v_pk_add_f32 v[64:65], v[64:65], v[108:109] op_sel_hi:[1,0]
  v_pk_add_f32 v[80:81], v[80:81], v[112:113] op_sel_hi:[1,0]
  v_pk_add_f32 v[96:97], v[96:97], v[116:117] op_sel_hi:[1,0]
  v_pk_add_f32 v[50:51], v[50:51], v[104:105] op_sel_hi:[1,0]
  v_pk_add_f32 v[66:67], v[66:67], v[108:109] op_sel_hi:[1,0]
  v_pk_add_f32 v[82:83], v[82:83], v[112:113] op_sel_hi:[1,0]
  v_pk_add_f32 v[98:99], v[98:99], v[116:117] op_sel_hi:[1,0]
  v_pk_add_f32 v[52:53], v[52:53], v[104:105] op_sel_hi:[1,0]
  v_pk_add_f32 v[68:69], v[68:69], v[108:109] op_sel_hi:[1,0]
  v_pk_add_f32 v[84:85], v[84:85], v[112:113] op_sel_hi:[1,0]
  v_pk_add_f32 v[100:101], v[100:101], v[116:117] op_sel_hi:[1,0]
  v_pk_add_f32 v[54:55], v[54:55], v[104:105] op_sel_hi:[1,0]
  v_pk_add_f32 v[70:71], v[70:71], v[108:109] op_sel_hi:[1,0]
  v_pk_add_f32 v[86:87], v[86:87], v[112:113] op_sel_hi:[1,0]
  v_pk_add_f32 v[102:103], v[102:103], v[116:117] op_sel_hi:[1,0]
  v_pk_mul_f32 v[104:105], v[40:41], v[40:41]
  v_pk_mul_f32 v[108:109], v[56:57], v[56:57]
  v_pk_mul_f32 v[112:113], v[72:73], v[72:73]
  v_pk_mul_f32 v[116:117], v[88:89], v[88:89]
  v_pk_fma_f32 v[104:105], v[42:43], v[42:43], v[104:105]
  v_pk_fma_f32 v[108:109], v[58:59], v[58:59], v[108:109]
  v_pk_fma_f32 v[112:113], v[74:75], v[74:75], v[112:113]
  v_pk_fma_f32 v[116:117], v[90:91], v[90:91], v[116:117]
  v_pk_fma_f32 v[104:105], v[44:45], v[44:45], v[104:105]
  v_pk_fma_f32 v[108:109], v[60:61], v[60:61], v[108:109]
  v_pk_fma_f32 v[112:113], v[76:77], v[76:77], v[112:113]
  v_pk_fma_f32 v[116:117], v[92:93], v[92:93], v[116:117]
  v_pk_fma_f32 v[104:105], v[46:47], v[46:47], v[104:105]
  v_pk_fma_f32 v[108:109], v[62:63], v[62:63], v[108:109]
  v_pk_fma_f32 v[112:113], v[78:79], v[78:79], v[112:113]
  v_pk_fma_f32 v[116:117], v[94:95], v[94:95], v[116:117]
  v_pk_fma_f32 v[104:105], v[48:49], v[48:49], v[104:105]
  v_pk_fma_f32 v[108:109], v[64:65], v[64:65], v[108:109]
  v_pk_fma_f32 v[112:113], v[80:81], v[80:81], v[112:113]
  v_pk_fma_f32 v[116:117], v[96:97], v[96:97], v[116:117]
  v_pk_fma_f32 v[104:105], v[50:51], v[50:51], v[104:105]
  v_pk_fma_f32 v[108:109], v[66:67], v[66:67], v[108:109]
  v_pk_fma_f32 v[112:113], v[82:83], v[82:83], v[112:113]
  v_pk_fma_f32 v[116:117], v[98:99], v[98:99], v[116:117]
  v_pk_fma_f32 v[104:105], v[52:53], v[52:53], v[104:105]
  v_pk_fma_f32 v[108:109], v[68:69], v[68:69], v[108:109]
  v_pk_fma_f32 v[112:113], v[84:85], v[84:85], v[112:113]
  v_pk_fma_f32 v[116:117], v[100:101], v[100:101], v[116:117]
  v_pk_fma_f32 v[104:105], v[54:55], v[54:55], v[104:105]
  v_pk_fma_f32 v[108:109], v[70:71], v[70:71], v[108:109]
  v_pk_fma_f32 v[112:113], v[86:87], v[86:87], v[112:113]
  v_pk_fma_f32 v[116:117], v[102:103], v[102:103], v[116:117]
  v_add_f32 v104, v104, v105
  v_add_f32 v108, v108, v109
  v_add_f32 v112, v112, v113
  v_add_f32 v116, v116, v117
  v_add_f32_dpp v104, v104, v104 row_ror:8 row_mask:0xf bank_mask:0xf
  v_add_f32_dpp v108, v108, v108 row_ror:8 row_mask:0xf bank_mask:0xf
  v_add_f32_dpp v112, v112, v112 row_ror:8 row_mask:0xf bank_mask:0xf
  v_add_f32_dpp v116, v116, v116 row_ror:8 row_mask:0xf bank_mask:0xf
  v_add_f32_dpp v104, v104, v104 row_ror:4 row_mask:0xf bank_mask:0xf
  v_add_f32_dpp v108, v108, v108 row_ror:4 row_mask:0xf bank_mask:0xf
  v_add_f32_dpp v112, v112, v112 row_ror:4 row_mask:0xf bank_mask:0xf
  v_add_f32_dpp v116, v116, v116 row_ror:4 row_mask:0xf bank_mask:0xf
  v_add_f32_dpp v104, v104, v104 row_ror:2 row_mask:0xf bank_mask:0xf
  v_add_f32_dpp v108, v108, v108 row_ror:2 row_mask:0xf bank_mask:0xf
  v_add_f32_dpp v112, v112, v112 row_ror:2 row_mask:0xf bank_mask:0xf
  v_add_f32_dpp v116, v116, v116 row_ror:2 row_mask:0xf bank_mask:0xf
  v_add_f32_dpp v104, v104, v104 row_ror:1 row_mask:0xf bank_mask:0xf
  v_add_f32_dpp v108, v108, v108 row_ror:1 row_mask:0xf bank_mask:0xf
  v_add_f32_dpp v112, v112, v112 row_ror:1 row_mask:0xf bank_mask:0xf
  v_add_f32_dpp v116, v116, v116 row_ror:1 row_mask:0xf bank_mask:0xf
  v_mov_b32 v105, v104
  v_mov_b32 v109, v108
  v_mov_b32 v113, v112
  v_mov_b32 v117, v116
  v_permlane16_swap_b32 v105, v104
  v_permlane16_swap_b32 v109, v108
  v_permlane16_swap_b32 v113, v112
  v_permlane16_swap_b32 v117, v116
  v_add_f32 v104, v104, v105
  v_add_f32 v108, v108, v109
  v_add_f32 v112, v112, v113
  v_add_f32 v116, v116, v117
  v_mov_b32 v105, v104
  v_mov_b32 v109, v108
  v_mov_b32 v113, v112
  v_mov_b32 v117, v116
  v_permlane32_swap_b32 v105, v104
  v_permlane32_swap_b32 v109, v108
  v_permlane32_swap_b32 v113, v112
  v_permlane32_swap_b32 v117, v116
  v_add_f32 v104, v104, v105
  v_add_f32 v108, v108, v109
  v_add_f32 v112, v112, v113
  v_add_f32 v116, v116, v117
  v_mul_f32 v104, 0x3a800000, v104
  v_mul_f32 v108, 0x3a800000, v108
  v_mul_f32 v112, 0x3a800000, v112
  v_mul_f32 v116, 0x3a800000, v116
  v_add_f32 v104, 0x3727c5ac, v104
  v_add_f32 v108, 0x3727c5ac, v108
  v_add_f32 v112, 0x3727c5ac, v112
  v_add_f32 v116, 0x3727c5ac, v116
  v_rsq_f32 v104, v104
  v_rsq_f32 v108, v108
  v_rsq_f32 v112, v112
  v_rsq_f32 v116, v116
  v_pk_mul_f32 v[40:41], v[40:41], v[104:105] op_sel_hi:[1,0]
  v_pk_mul_f32 v[56:57], v[56:57], v[108:109] op_sel_hi:[1,0]
  v_pk_mul_f32 v[72:73], v[72:73], v[112:113] op_sel_hi:[1,0]
  v_pk_mul_f32 v[88:89], v[88:89], v[116:117] op_sel_hi:[1,0]
  v_pk_mul_f32 v[42:43], v[42:43], v[104:105] op_sel_hi:[1,0]
  v_pk_mul_f32 v[58:59], v[58:59], v[108:109] op_sel_hi:[1,0]
  v_pk_mul_f32 v[74:75], v[74:75], v[112:113] op_sel_hi:[1,0]
  v_pk_mul_f32 v[90:91], v[90:91], v[116:117] op_sel_hi:[1,0]
  v_pk_mul_f32 v[44:45], v[44:45], v[104:105] op_sel_hi:[1,0]
  v_pk_mul_f32 v[60:61], v[60:61], v[108:109] op_sel_hi:[1,0]
  v_pk_mul_f32 v[76:77], v[76:77], v[112:113] op_sel_hi:[1,0]
  v_pk_mul_f32 v[92:93], v[92:93], v[116:117] op_sel_hi:[1,0]
  v_pk_mul_f32 v[46:47], v[46:47], v[104:105] op_sel_hi:[1,0]
  v_pk_mul_f32 v[62:63], v[62:63], v[108:109] op_sel_hi:[1,0]
  v_pk_mul_f32 v[78:79], v[78:79], v[112:113] op_sel_hi:[1,0]
  v_pk_mul_f32 v[94:95], v[94:95], v[116:117] op_sel_hi:[1,0]
  v_pk_mul_f32 v[48:49], v[48:49], v[104:105] op_sel_hi:[1,0]
  v_pk_mul_f32 v[64:65], v[64:65], v[108:109] op_sel_hi:[1,0]
  v_pk_mul_f32 v[80:81], v[80:81], v[112:113] op_sel_hi:[1,0]
  v_pk_mul_f32 v[96:97], v[96:97], v[116:117] op_sel_hi:[1,0]
  v_pk_mul_f32 v[50:51], v[50:51], v[104:105] op_sel_hi:[1,0]
  v_pk_mul_f32 v[66:67], v[66:67], v[108:109] op_sel_hi:[1,0]
  v_pk_mul_f32 v[82:83], v[82:83], v[112:113] op_sel_hi:[1,0]
  v_pk_mul_f32 v[98:99], v[98:99], v[116:117] op_sel_hi:[1,0]
  v_pk_mul_f32 v[52:53], v[52:53], v[104:105] op_sel_hi:[1,0]
  v_pk_mul_f32 v[68:69], v[68:69], v[108:109] op_sel_hi:[1,0]
  v_pk_mul_f32 v[84:85], v[84:85], v[112:113] op_sel_hi:[1,0]
  v_pk_mul_f32 v[100:101], v[100:101], v[116:117] op_sel_hi:[1,0]
  v_pk_mul_f32 v[54:55], v[54:55], v[104:105] op_sel_hi:[1,0]
  v_pk_mul_f32 v[70:71], v[70:71], v[108:109] op_sel_hi:[1,0]
  v_pk_mul_f32 v[86:87], v[86:87], v[112:113] op_sel_hi:[1,0]
  v_pk_mul_f32 v[102:103], v[102:103], v[116:117] op_sel_hi:[1,0]
  v_min_u32 v3, 31, v0
  v_lshlrev_b32 v3, 2, v3
  v_add_u32 v3, 128, v3
  s_nop 1
Lpoll_3:
  buffer_load_dword v4, v3, s[12:15], 0 offen sc1
  s_sub_u32 s24, s24, 1
  s_cbranch_scc1 L_FAIL
  s_waitcnt vmcnt(0)
  v_cmp_gt_i32 vcc, 1, v4
  s_cbranch_vccz Lpolld_4
  s_sleep 2
  s_branch Lpoll_3
Lpolld_4:
  v_min_u32 v3, 31, v0
  v_lshlrev_b32 v3, 7, v3
  v_add_u32 v3, 1376256, v3
  s_nop 1
Lpoll_5:
  buffer_load_dword v4, v3, s[4:7], 0 offen sc1
  s_sub_u32 s24, s24, 1
  s_cbranch_scc1 L_FAIL
  s_waitcnt vmcnt(0)
  v_cmp_gt_i32 vcc, 1, v4
  s_cbranch_vccz Lpolld_6
  s_sleep 2
  s_branch Lpoll_5
Lpolld_6:
  s_mov_b32 s40, 1572864
  buffer_load_dwordx4 v[136:139], v2, s[4:7], s40 offen offset:0 sc1
  buffer_load_dwordx4 v[140:143], v2, s[4:7], s40 offen offset:1024 sc1
  buffer_load_dwordx4 v[144:147], v2, s[4:7], s40 offen offset:2048 sc1
  buffer_load_dwordx4 v[148:151], v2, s[4:7], s40 offen offset:3072 sc1
  s_mov_b32 s40, 1576960
  buffer_load_dwordx4 v[120:123], v2, s[4:7], s40 offen offset:0 sc1
  buffer_load_dwordx4 v[124:127], v2, s[4:7], s40 offen offset:1024 sc1
  buffer_load_dwordx4 v[128:131], v2, s[4:7], s40 offen offset:2048 sc1
  buffer_load_dwordx4 v[132:135], v2, s[4:7], s40 offen offset:3072 sc1
  s_waitcnt vmcnt(0)
  v_add_f32 v120, 1.0, v120
  v_add_f32 v121, 1.0, v121
  v_add_f32 v122, 1.0, v122
  v_add_f32 v123, 1.0, v123
  v_add_f32 v124, 1.0, v124
  v_add_f32 v125, 1.0, v125
  v_add_f32 v126, 1.0, v126
  v_add_f32 v127, 1.0, v127
  v_add_f32 v128, 1.0, v128
  v_add_f32 v129, 1.0, v129
  v_add_f32 v130, 1.0, v130
  v_add_f32 v131, 1.0, v131
  v_add_f32 v132, 1.0, v132
  v_add_f32 v133, 1.0, v133
  v_add_f32 v134, 1.0, v134
  v_add_f32 v135, 1.0, v135
  s_add_u32 s44, s44, 2097152
  s_add_u32 s45, s45, 2097152
  v_pk_fma_f32 v[40:41], v[40:41], v[120:121], v[136:137]
  v_pk_fma_f32 v[42:43], v[42:43], v[122:123], v[138:139]
  v_pk_fma_f32 v[44:45], v[44:45], v[124:125], v[140:141]
  v_pk_fma_f32 v[46:47], v[46:47], v[126:127], v[142:143]
  v_pk_fma_f32 v[48:49], v[48:49], v[128:129], v[144:145]
  v_pk_fma_f32 v[50:51], v[50:51], v[130:131], v[146:147]
  v_pk_fma_f32 v[52:53], v[52:53], v[132:133], v[148:149]
  v_pk_fma_f32 v[54:55], v[54:55], v[134:135], v[150:151]
  v_cvt_pk_bf16_f32 v8, v40, v41
  v_cvt_pk_bf16_f32 v9, v42, v43
  v_cvt_pk_bf16_f32 v10, v44, v45
  v_cvt_pk_bf16_f32 v11, v46, v47
  v_cvt_pk_bf16_f32 v12, v48, v49
  v_cvt_pk_bf16_f32 v13, v50, v51
  v_cvt_pk_bf16_f32 v14, v52, v53
  v_cvt_pk_bf16_f32 v15, v54, v55
  buffer_store_dwordx4 v[8:11], v2, s[4:7], s44 offen offset:0 sc1
  buffer_store_dwordx4 v[12:15], v2, s[4:7], s44 offen offset:1024 sc1
  v_pk_fma_f32 v[56:57], v[56:57], v[120:121], v[136:137]
  v_pk_fma_f32 v[58:59], v[58:59], v[122:123], v[138:139]
  v_pk_fma_f32 v[60:61], v[60:61], v[124:125], v[140:141]
  v_pk_fma_f32 v[62:63], v[62:63], v[126:127], v[142:143]
  v_pk_fma_f32 v[64:65], v[64:65], v[128:129], v[144:145]
  v_pk_fma_f32 v[66:67], v[66:67], v[130:131], v[146:147]
  v_pk_fma_f32 v[68:69], v[68:69], v[132:133], v[148:149]
  v_pk_fma_f32 v[70:71], v[70:71], v[134:135], v[150:151]
  v_cvt_pk_bf16_f32 v16, v56, v57
  v_cvt_pk_bf16_f32 v17, v58, v59
  v_cvt_pk_bf16_f32 v18, v60, v61
  v_cvt_pk_bf16_f32 v19, v62, v63
  v_cvt_pk_bf16_f32 v20, v64, v65
  v_cvt_pk_bf16_f32 v21, v66, v67
  v_cvt_pk_bf16_f32 v22, v68, v69
  v_cvt_pk_bf16_f32 v23, v70, v71
  buffer_store_dwordx4 v[16:19], v2, s[4:7], s44 offen offset:2048 sc1
  buffer_store_dwordx4 v[20:23], v2, s[4:7], s44 offen offset:3072 sc1
  v_pk_fma_f32 v[72:73], v[72:73], v[120:121], v[136:137]
  v_pk_fma_f32 v[74:75], v[74:75], v[122:123], v[138:139]
  v_pk_fma_f32 v[76:77], v[76:77], v[124:125], v[140:141]
  v_pk_fma_f32 v[78:79], v[78:79], v[126:127], v[142:143]
  v_pk_fma_f32 v[80:81], v[80:81], v[128:129], v[144:145]
  v_pk_fma_f32 v[82:83], v[82:83], v[130:131], v[146:147]
  v_pk_fma_f32 v[84:85], v[84:85], v[132:133], v[148:149]
  v_pk_fma_f32 v[86:87], v[86:87], v[134:135], v[150:151]
  v_cvt_pk_bf16_f32 v24, v72, v73
  v_cvt_pk_bf16_f32 v25, v74, v75
  v_cvt_pk_bf16_f32 v26, v76, v77
  v_cvt_pk_bf16_f32 v27, v78, v79
  v_cvt_pk_bf16_f32 v28, v80, v81
  v_cvt_pk_bf16_f32 v29, v82, v83
  v_cvt_pk_bf16_f32 v30, v84, v85
  v_cvt_pk_bf16_f32 v31, v86, v87
  buffer_store_dwordx4 v[24:27], v2, s[4:7], s45 offen offset:0 sc1
  buffer_store_dwordx4 v[28:31], v2, s[4:7], s45 offen offset:1024 sc1
  v_pk_fma_f32 v[88:89], v[88:89], v[120:121], v[136:137]
  v_pk_fma_f32 v[90:91], v[90:91], v[122:123], v[138:139]
  v_pk_fma_f32 v[92:93], v[92:93], v[124:125], v[140:141]
  v_pk_fma_f32 v[94:95], v[94:95], v[126:127], v[142:143]
  v_pk_fma_f32 v[96:97], v[96:97], v[128:129], v[144:145]
  v_pk_fma_f32 v[98:99], v[98:99], v[130:131], v[146:147]
  v_pk_fma_f32 v[100:101], v[100:101], v[132:133], v[148:149]
  v_pk_fma_f32 v[102:103], v[102:103], v[134:135], v[150:151]
  v_cvt_pk_bf16_f32 v32, v88, v89
  v_cvt_pk_bf16_f32 v33, v90, v91
  v_cvt_pk_bf16_f32 v34, v92, v93
  v_cvt_pk_bf16_f32 v35, v94, v95
  v_cvt_pk_bf16_f32 v36, v96, v97
  v_cvt_pk_bf16_f32 v37, v98, v99
  v_cvt_pk_bf16_f32 v38, v100, v101
  v_cvt_pk_bf16_f32 v39, v102, v103
  buffer_store_dwordx4 v[32:35], v2, s[4:7], s45 offen offset:2048 sc1
  buffer_store_dwordx4 v[36:39], v2, s[4:7], s45 offen offset:3072 sc1
  s_lshr_b32 s40, s43, 3
  s_lshl_b32 s40, s40, 7
  s_and_b32 s41, s43, 7
  s_lshl_b32 s41, s41, 2
  s_add_u32 s40, s40, s41
  s_add_u32 s40, s40, 1388544
  v_mov_b32 v3, 2147483392
  s_mov_b64 exec, 1
  v_mov_b32 v3, s40
  s_mov_b64 exec, -1
  v_mov_b32 v4, 1
  s_waitcnt vmcnt(0)
  buffer_store_dword v4, v3, s[4:7], 0 offen sc1
  s_mov_b32 s40, 1396736
  s_cmp_lt_u32 s22, 6
  s_cselect_b32 s40, 1424384, s40
  v_mov_b32 v1, s40
  s_nop 1
Lpoll_7:
  buffer_load_dword v2, v1, s[4:7], 0 offen sc1
  s_sub_u32 s24, s24, 1
  s_cbranch_scc1 L_FAIL
  s_waitcnt vmcnt(0)
  v_cmp_gt_i32 vcc, 0, v2
  s_cbranch_vccz Lpolld_8
  s_sleep 8
  s_branch Lpoll_7
Lpolld_8:
  s_sub_u32 s40, s22, 3
  s_lshl_b32 s40, s40, 5
  s_add_u32 s21, s40, s23
  s_cmp_lt_u32 s22, 6
  s_cbranch_scc1 L_MOD
L_ROLE:
  s_mov_b32 s43, 32
  s_cmp_eq_u32 s22, 7
  s_cselect_b32 s43, 24, s43
  s_sub_u32 s40, s22, 5
  s_cmp_lt_u32 s40, 2
  s_cselect_b32 s43, 28, s43
  s_cmp_lt_u32 s23, s43
  s_cbranch_scc1 L_HEAVY
  s_sub_u32 s21, s23, s43
  s_cmp_eq_u32 s22, 7
  s_cbranch_scc1 L_FIN
  s_lshl_b32 s40, s40, 2
  s_add_u32 s21, s21, s40
  s_branch L_LN2
L_HEAVY:
  s_mov_b32 s21, s23
  s_cmp_eq_u32 s22, 4
  s_cbranch_scc1 L_WO
  s_cmp_eq_u32 s22, 7
  s_cbranch_scc1 L_F2
  s_sub_u32 s40, s22, 5
  s_mul_i32 s40, s40, 28
  s_add_u32 s21, s21, s40
  s_branch L_F1
L_FAIL:
  s_mov_b64 exec, -1
  s_lshl_b32 s40, s2, 8
  s_add_u32 s40, s40, s25
  s_add_u32 s40, s40, 0x70000000
  v_mov_b32 v1, 60
  v_mov_b32 v2, s40
  buffer_store_dword v2, v1, s[12:15], 0 offen
L_END:
  s_endpgm
L_LN2:
  s_load_dwordx2 s[16:17], s[0:1], 0
  s_mov_b32 s18, 4194304
  s_mov_b32 s19, 0x20000
  s_waitcnt lgkmcnt(0)
  s_mov_b32 s25, 0
  s_mov_b32 s29, 1
  s_mov_b32 s26, 0
  s_mov_b32 s27, 37748736
  s_cmp_eq_u32 s20, 0
  s_cselect_b32 s31, 0, 2147483392
  s_lshl_b32 s40, s21, 8
  s_lshl_b32 s41, s20, 14
  s_add_u32 s40, s40, s41
  v_and_b32 v6, 15, v0
  v_lshl_add_u32 v1, v6, 4, s40
  v_lshrrev_b32 v6, 4, v0
  v_lshl_add_u32 v1, v6, 11, v1
  v_and_b32 v6, 3, v0
  v_lshrrev_b32 v7, 5, v0
  v_lshrrev_b32 v8, 2, v0
  s_lshl_b32 s40, s20, 10
  v_lshl_add_u32 v5, v8, 4, s40
  s_lshl_b32 s40, s21, 13
  s_lshl_b32 s41, s20, 9
  s_add_u32 s40, s40, s41
  v_and_b32 v9, 31, v0
  v_lshl_add_u32 v10, v9, 4, s40
  v_lshl_add_u32 v10, v7, 11, v10
  v_min_u32 v2, 63, v0
  v_lshlrev_b32 v2, 7, v2
  v_add_u32 v2, 1380352, v2
  s_nop 1
Lpoll_9:
  buffer_load_dword v3, v2, s[4:7], 0 offen sc1
  s_sub_u32 s24, s24, 1
  s_cbranch_scc1 L_FAIL
  s_waitcnt vmcnt(0)
  v_cmp_gt_i32 vcc, 1, v3
  s_cbranch_vccz Lpolld_10
  s_sleep 2
  s_branch Lpoll_9
Lpolld_10:
  s_mov_b32 s40, 1585152
  buffer_load_dwordx4 v[64:67], v5, s[4:7], s40 offen offset:0 sc1
  buffer_load_dwordx4 v[68:71], v5, s[4:7], s40 offen offset:256 sc1
  buffer_load_dwordx4 v[72:75], v5, s[4:7], s40 offen offset:512 sc1
  buffer_load_dwordx4 v[76:79], v5, s[4:7], s40 offen offset:768 sc1
  s_mov_b32 s40, 1589248
  buffer_load_dwordx4 v[80:83], v5, s[4:7], s40 offen offset:0 sc1
  buffer_load_dwordx4 v[84:87], v5, s[4:7], s40 offen offset:256 sc1
  buffer_load_dwordx4 v[88:91], v5, s[4:7], s40 offen offset:512 sc1
  buffer_load_dwordx4 v[92:95], v5, s[4:7], s40 offen offset:768 sc1
  s_mov_b32 s40, 1581056
  buffer_load_dwordx4 v[48:51], v5, s[4:7], s40 offen offset:0 sc1
  buffer_load_dwordx4 v[52:55], v5, s[4:7], s40 offen offset:256 sc1
  buffer_load_dwordx4 v[56:59], v5, s[4:7], s40 offen offset:512 sc1
  buffer_load_dwordx4 v[60:63], v5, s[4:7], s40 offen offset:768 sc1
  s_waitcnt vmcnt(0)
  v_lshrrev_b32 v48, 16, v48
  v_lshrrev_b32 v50, 16, v50
  v_lshrrev_b32 v52, 16, v52
  v_lshrrev_b32 v54, 16, v54
  v_lshrrev_b32 v56, 16, v56
  v_lshrrev_b32 v58, 16, v58
  v_lshrrev_b32 v60, 16, v60
  v_lshrrev_b32 v62, 16, v62
  v_add_f32 v80, 1.0, v80
  v_add_f32 v81, 1.0, v81
  v_add_f32 v82, 1.0, v82
  v_add_f32 v83, 1.0, v83
  v_add_f32 v84, 1.0, v84
  v_add_f32 v85, 1.0, v85
  v_add_f32 v86, 1.0, v86
  v_add_f32 v87, 1.0, v87
  v_add_f32 v88, 1.0, v88
  v_add_f32 v89, 1.0, v89
  v_add_f32 v90, 1.0, v90
  v_add_f32 v91, 1.0, v91
  v_add_f32 v92, 1.0, v92
  v_add_f32 v93, 1.0, v93
  v_add_f32 v94, 1.0, v94
  v_add_f32 v95, 1.0, v95
  v_min_u32 v2, 31, v0
  v_lshlrev_b32 v2, 7, v2
  v_add_u32 v2, 1409024, v2
  s_lshl_b32 s62, s21, 7
  s_add_u32 s62, s62, 1413120
  s_lshl_b32 s30, s20, 11
  v_lshl_add_u32 v11, v6, 9, s30
  v_lshl_add_u32 v11, v8, 3, v11
  s_lshl_b32 s40, s20, 5
  s_add_u32 s40, s40, 8192
  v_lshl_add_u32 v12, v6, 3, s40
  v_lshlrev_b32 v13, 3, v6
  v_add_u32 v13, 8192, v13
  s_add_u32 m0, s30, 0
  s_add_u32 s40, s26, 0
  buffer_load_dwordx4 v10, s[16:19], s40 offen nt lds
  s_add_u32 m0, s30, 1024
  s_add_u32 s40, s26, 4096
  buffer_load_dwordx4 v10, s[16:19], s40 offen nt lds
  buffer_load_dword v3, v2, s[4:7], s31 offen sc1
  s_waitcnt vmcnt(1)
  ds_read_b64 v[24:25], v11 offset:0
  ds_read_b64 v[26:27], v11 offset:128
  ds_read_b64 v[28:29], v11 offset:256
  ds_read_b64 v[30:31], v11 offset:384
  s_waitcnt lgkmcnt(0)
L_LN2_top:
  v_lshlrev_b32 v96, 16, v24
  v_and_b32 v97, 0xffff0000, v24
  v_lshlrev_b32 v98, 16, v25
  v_and_b32 v99, 0xffff0000, v25
  v_lshlrev_b32 v100, 16, v26
  v_and_b32 v101, 0xffff0000, v26
  v_lshlrev_b32 v102, 16, v27
  v_and_b32 v103, 0xffff0000, v27
  v_lshlrev_b32 v104, 16, v28
  v_and_b32 v105, 0xffff0000, v28
  v_lshlrev_b32 v106, 16, v29
  v_and_b32 v107, 0xffff0000, v29
  v_lshlrev_b32 v108, 16, v30
  v_and_b32 v109, 0xffff0000, v30
  v_lshlrev_b32 v110, 16, v31
  v_and_b32 v111, 0xffff0000, v31
  s_cmp_lg_u32 s20, 0
  s_cbranch_scc1 Lgo_11
  s_waitcnt vmcnt(0)
  v_cmp_gt_i32 vcc, s29, v3
  s_cbranch_vccz Lgo_11
  s_nop 3
Lpoll_12:
  buffer_load_dword v3, v2, s[4:7], 0 offen sc1
  s_sub_u32 s24, s24, 1
  s_cbranch_scc1 L_FAIL
  s_waitcnt vmcnt(0)
  v_cmp_gt_i32 vcc, s29, v3
  s_cbranch_vccz Lpolld_13
  s_sleep 1
  s_branch Lpoll_12
Lpolld_13:
Lgo_11:
  s_barrier
  s_add_u32 s40, s27, 0
  buffer_load_dwordx4 v[112:115], v1, s[4:7], s40 offen sc1
  s_add_u32 s40, s27, 8192
  buffer_load_dwordx4 v[116:119], v1, s[4:7], s40 offen sc1
  s_add_u32 s40, s27, 65536
  buffer_load_dwordx4 v[120:123], v1, s[4:7], s40 offen sc1
  s_add_u32 s40, s27, 73728
  buffer_load_dwordx4 v[124:127], v1, s[4:7], s40 offen sc1
  s_add_u32 s40, s27, 131072
  buffer_load_dwordx4 v[128:131], v1, s[4:7], s40 offen sc1
  s_add_u32 s40, s27, 139264
  buffer_load_dwordx4 v[132:135], v1, s[4:7], s40 offen sc1
  s_add_u32 s40, s27, 196608
  buffer_load_dwordx4 v[136:139], v1, s[4:7], s40 offen sc1
  s_add_u32 s40, s27, 204800
  buffer_load_dwordx4 v[140:143], v1, s[4:7], s40 offen sc1
  s_add_u32 m0, s30, 0
  s_add_u32 s40, s26, 65536
  buffer_load_dwordx4 v10, s[16:19], s40 offen nt lds
  s_add_u32 m0, s30, 1024
  s_add_u32 s40, s26, 69632
  buffer_load_dwordx4 v10, s[16:19], s40 offen nt lds
  s_waitcnt vmcnt(9)
  v_dot2c_f32_bf16 v96, v112, v48
  v_dot2c_f32_bf16 v97, v112, v49
  v_dot2c_f32_bf16 v98, v113, v50
  v_dot2c_f32_bf16 v99, v113, v51
  v_dot2c_f32_bf16 v100, v114, v52
  v_dot2c_f32_bf16 v101, v114, v53
  v_dot2c_f32_bf16 v102, v115, v54
  v_dot2c_f32_bf16 v103, v115, v55
  s_waitcnt vmcnt(8)
  v_dot2c_f32_bf16 v104, v116, v56
  v_dot2c_f32_bf16 v105, v116, v57
  v_dot2c_f32_bf16 v106, v117, v58
  v_dot2c_f32_bf16 v107, v117, v59
  v_dot2c_f32_bf16 v108, v118, v60
  v_dot2c_f32_bf16 v109, v118, v61
  v_dot2c_f32_bf16 v110, v119, v62
  v_dot2c_f32_bf16 v111, v119, v63
  s_waitcnt vmcnt(7)
  v_dot2c_f32_bf16 v96, v120, v48
  v_dot2c_f32_bf16 v97, v120, v49
  v_dot2c_f32_bf16 v98, v121, v50
  v_dot2c_f32_bf16 v99, v121, v51
  v_dot2c_f32_bf16 v100, v122, v52
  v_dot2c_f32_bf16 v101, v122, v53
  v_dot2c_f32_bf16 v102, v123, v54
  v_dot2c_f32_bf16 v103, v123, v55
  s_waitcnt vmcnt(6)
  v_dot2c_f32_bf16 v104, v124, v56
  v_dot2c_f32_bf16 v105, v124, v57
  v_dot2c_f32_bf16 v106, v125, v58
  v_dot2c_f32_bf16 v107, v125, v59
  v_dot2c_f32_bf16 v108, v126, v60
  v_dot2c_f32_bf16 v109, v126, v61
  v_dot2c_f32_bf16 v110, v127, v62
  v_dot2c_f32_bf16 v111, v127, v63
  s_waitcnt vmcnt(5)
  v_dot2c_f32_bf16 v96, v128, v48
  v_dot2c_f32_bf16 v97, v128, v49
  v_dot2c_f32_bf16 v98, v129, v50
  v_dot2c_f32_bf16 v99, v129, v51
  v_dot2c_f32_bf16 v100, v130, v52
  v_dot2c_f32_bf16 v101, v130, v53
  v_dot2c_f32_bf16 v102, v131, v54
  v_dot2c_f32_bf16 v103, v131, v55
  s_waitcnt vmcnt(4)
  v_dot2c_f32_bf16 v104, v132, v56
  v_dot2c_f32_bf16 v105, v132, v57
  v_dot2c_f32_bf16 v106, v133, v58
  v_dot2c_f32_bf16 v107, v133, v59
  v_dot2c_f32_bf16 v108, v134, v60
  v_dot2c_f32_bf16 v109, v134, v61
  v_dot2c_f32_bf16 v110, v135, v62
  v_dot2c_f32_bf16 v111, v135, v63
  s_waitcnt vmcnt(3)
  v_dot2c_f32_bf16 v96, v136, v48
  v_dot2c_f32_bf16 v97, v136, v49
  v_dot2c_f32_bf16 v98, v137, v50
  v_dot2c_f32_bf16 v99, v137, v51
  v_dot2c_f32_bf16 v100, v138, v52
  v_dot2c_f32_bf16 v101, v138, v53
  v_dot2c_f32_bf16 v102, v139, v54
  v_dot2c_f32_bf16 v103, v139, v55
  s_waitcnt vmcnt(2)
  v_dot2c_f32_bf16 v104, v140, v56
  v_dot2c_f32_bf16 v105, v140, v57
  v_dot2c_f32_bf16 v106, v141, v58
  v_dot2c_f32_bf16 v107, v141, v59
  v_dot2c_f32_bf16 v108, v142, v60
  v_dot2c_f32_bf16 v109, v142, v61
  v_dot2c_f32_bf16 v110, v143, v62
  v_dot2c_f32_bf16 v111, v143, v63
  s_nop 2
  v_pk_add_f32 v[32:33], v[96:97], v[98:99]
  v_pk_add_f32 v[32:33], v[32:33], v[100:101]
  v_pk_add_f32 v[32:33], v[32:33], v[102:103]
  v_pk_add_f32 v[32:33], v[32:33], v[104:105]
  v_pk_add_f32 v[32:33], v[32:33], v[106:107]
  v_pk_add_f32 v[32:33], v[32:33], v[108:109]
  v_pk_add_f32 v[32:33], v[32:33], v[110:111]
  v_add_f32 v32, v32, v33
  s_nop 1
  v_add_f32_dpp v32, v32, v32 row_ror:4 row_mask:0xf bank_mask:0xf
  s_nop 1
  v_add_f32_dpp v32, v32, v32 row_ror:8 row_mask:0xf bank_mask:0xf
  v_mov_b32 v33, v32
  s_nop 1
  v_permlane16_swap_b32 v33, v32
  v_add_f32 v32, v32, v33
  v_mov_b32 v33, v32
  s_nop 1
  v_permlane32_swap_b32 v33, v32
  v_add_f32 v32, v32, v33
  v_mul_f32 v32, 0x3b800000, v32
  v_pk_add_f32 v[112:113], v[96:97], v[32:33] op_sel_hi:[1,0] neg_lo:[0,1] neg_hi:[0,1]
  v_pk_add_f32 v[114:115], v[98:99], v[32:33] op_sel_hi:[1,0] neg_lo:[0,1] neg_hi:[0,1]
  v_pk_add_f32 v[116:117], v[100:101], v[32:33] op_sel_hi:[1,0] neg_lo:[0,1] neg_hi:[0,1]
  v_pk_add_f32 v[118:119], v[102:103], v[32:33] op_sel_hi:[1,0] neg_lo:[0,1] neg_hi:[0,1]
  v_pk_add_f32 v[120:121], v[104:105], v[32:33] op_sel_hi:[1,0] neg_lo:[0,1] neg_hi:[0,1]
  v_pk_add_f32 v[122:123], v[106:107], v[32:33] op_sel_hi:[1,0] neg_lo:[0,1] neg_hi:[0,1]
  v_pk_add_f32 v[124:125], v[108:109], v[32:33] op_sel_hi:[1,0] neg_lo:[0,1] neg_hi:[0,1]
  v_pk_add_f32 v[126:127], v[110:111], v[32:33] op_sel_hi:[1,0] neg_lo:[0,1] neg_hi:[0,1]
  v_pk_mul_f32 v[34:35], v[112:113], v[112:113]
  v_pk_fma_f32 v[34:35], v[114:115], v[114:115], v[34:35]
  v_pk_fma_f32 v[34:35], v[116:117], v[116:117], v[34:35]
  v_pk_fma_f32 v[34:35], v[118:119], v[118:119], v[34:35]
  v_pk_fma_f32 v[34:35], v[120:121], v[120:121], v[34:35]
  v_pk_fma_f32 v[34:35], v[122:123], v[122:123], v[34:35]
  v_pk_fma_f32 v[34:35], v[124:125], v[124:125], v[34:35]
  v_pk_fma_f32 v[34:35], v[126:127], v[126:127], v[34:35]
  v_add_f32 v34, v34, v35
  s_nop 1
  v_add_f32_dpp v34, v34, v34 row_ror:4 row_mask:0xf bank_mask:0xf
  s_nop 1
  v_add_f32_dpp v34, v34, v34 row_ror:8 row_mask:0xf bank_mask:0xf
  v_mov_b32 v35, v34
  s_nop 1
  v_permlane16_swap_b32 v35, v34
  v_add_f32 v34, v34, v35
  v_mov_b32 v35, v34
  s_nop 1
  v_permlane32_swap_b32 v35, v34
  v_add_f32 v34, v34, v35
  v_mov_b32 v33, v34
  ds_write_b64 v12, v[32:33]
  v_cvt_pk_bf16_f32 v16, v96, v97
  v_cvt_pk_bf16_f32 v17, v98, v99
  v_cvt_pk_bf16_f32 v18, v100, v101
  v_cvt_pk_bf16_f32 v19, v102, v103
  v_cvt_pk_bf16_f32 v20, v104, v105
  v_cvt_pk_bf16_f32 v21, v106, v107
  v_cvt_pk_bf16_f32 v22, v108, v109
  v_cvt_pk_bf16_f32 v23, v110, v111
  s_waitcnt lgkmcnt(0)
  s_barrier
  ds_read2_b64 v[36:39], v13 offset0:0 offset1:4
  ds_read2_b64 v[40:43], v13 offset0:8 offset1:12
  s_add_u32 s40, s26, 10485760
  buffer_store_dwordx4 v[16:19], v1, s[4:7], s40 offen sc1
  s_add_u32 s40, s26, 10493952
  buffer_store_dwordx4 v[20:23], v1, s[4:7], s40 offen sc1
  s_waitcnt lgkmcnt(0)
  v_pk_add_f32 v[34:35], v[36:37], v[38:39]
  v_pk_add_f32 v[44:45], v[40:41], v[42:43]
  v_pk_add_f32 v[34:35], v[34:35], v[44:45]
  v_mul_f32 v34, 0x3e800000, v34
  v_mul_f32 v35, 0x3b800000, v35
  v_sub_f32 v36, v36, v34
  v_sub_f32 v38, v38, v34
  v_sub_f32 v40, v40, v34
  v_sub_f32 v42, v42, v34
  v_fmac_f32 v35, v36, v36
  v_fmac_f32 v35, v38, v38
  v_fmac_f32 v35, v40, v40
  v_fmac_f32 v35, v42, v42
  v_mul_f32 v35, 0x3e800000, v35
  v_add_f32 v35, 0x3727c5ac, v35
  v_rsq_f32 v44, v35
  v_sub_f32 v32, v32, v34
  v_mul_f32 v32, v32, v44
  v_pk_fma_f32 v[112:113], v[112:113], v[44:45], v[32:33] op_sel_hi:[1,0,0]
  v_pk_fma_f32 v[114:115], v[114:115], v[44:45], v[32:33] op_sel_hi:[1,0,0]
  v_pk_fma_f32 v[116:117], v[116:117], v[44:45], v[32:33] op_sel_hi:[1,0,0]
  v_pk_fma_f32 v[118:119], v[118:119], v[44:45], v[32:33] op_sel_hi:[1,0,0]
  v_pk_fma_f32 v[112:113], v[112:113], v[80:81], v[64:65]
  v_pk_fma_f32 v[114:115], v[114:115], v[82:83], v[66:67]
  v_pk_fma_f32 v[116:117], v[116:117], v[84:85], v[68:69]
  v_pk_fma_f32 v[118:119], v[118:119], v[86:87], v[70:71]
  v_cvt_pk_bf16_f32 v128, v112, v113
  v_cvt_pk_bf16_f32 v129, v114, v115
  v_cvt_pk_bf16_f32 v130, v116, v117
  v_cvt_pk_bf16_f32 v131, v118, v119
  s_add_u32 s40, s26, 6291456
  buffer_store_dwordx4 v[128:131], v1, s[4:7], s40 offen sc1
  v_pk_fma_f32 v[120:121], v[120:121], v[44:45], v[32:33] op_sel_hi:[1,0,0]
  v_pk_fma_f32 v[122:123], v[122:123], v[44:45], v[32:33] op_sel_hi:[1,0,0]
  v_pk_fma_f32 v[124:125], v[124:125], v[44:45], v[32:33] op_sel_hi:[1,0,0]
  v_pk_fma_f32 v[126:127], v[126:127], v[44:45], v[32:33] op_sel_hi:[1,0,0]
  v_pk_fma_f32 v[120:121], v[120:121], v[88:89], v[72:73]
  v_pk_fma_f32 v[122:123], v[122:123], v[90:91], v[74:75]
  v_pk_fma_f32 v[124:125], v[124:125], v[92:93], v[76:77]
  v_pk_fma_f32 v[126:127], v[126:127], v[94:95], v[78:79]
  v_cvt_pk_bf16_f32 v132, v120, v121
  v_cvt_pk_bf16_f32 v133, v122, v123
  v_cvt_pk_bf16_f32 v134, v124, v125
  v_cvt_pk_bf16_f32 v135, v126, v127
  s_add_u32 s40, s26, 6299648
  buffer_store_dwordx4 v[132:135], v1, s[4:7], s40 offen sc1
  buffer_load_dword v3, v2, s[4:7], s31 offen sc1
  s_waitcnt vmcnt(5)
  ds_read_b64 v[24:25], v11 offset:0
  ds_read_b64 v[26:27], v11 offset:128
  ds_read_b64 v[28:29], v11 offset:256
  ds_read_b64 v[30:31], v11 offset:384
  s_waitcnt vmcnt(1) lgkmcnt(0)
  s_barrier
  s_cmp_lg_u32 s20, 0
  s_cbranch_scc1 Lnosig_14
  s_mov_b32 s63, s29
  s_atomic_smax s63, s[4:5], s62 glc
Lnosig_14:
  s_add_u32 s25, s25, 1
  s_add_u32 s29, s29, 1
  s_add_u32 s26, s26, 65536
  s_add_u32 s27, s27, 262144
  s_cmp_lt_u32 s25, 64
  s_cbranch_scc1 L_LN2_top
  s_branch L_END
L_FIN:
  s_load_dwordx2 s[16:17], s[0:1], 104
  s_mov_b32 s18, 4194304
  s_mov_b32 s19, 0x20000
  s_waitcnt lgkmcnt(0)
  s_mov_b32 s25, 0
  s_mov_b32 s29, 1
  s_mov_b32 s26, 0
  s_mov_b32 s27, 54525952
  s_cmp_eq_u32 s20, 0
  s_cselect_b32 s31, 0, 2147483392
  s_lshl_b32 s40, s21, 8
  s_lshl_b32 s41, s20, 14
  s_add_u32 s40, s40, s41
  v_and_b32 v6, 15, v0
  v_lshl_add_u32 v1, v6, 4, s40
  v_lshrrev_b32 v6, 4, v0
  v_lshl_add_u32 v1, v6, 11, v1
  v_and_b32 v6, 3, v0
  v_lshrrev_b32 v7, 5, v0
  v_lshrrev_b32 v8, 2, v0
  s_lshl_b32 s40, s20, 10
  v_lshl_add_u32 v5, v8, 4, s40
  s_lshl_b32 s40, s21, 13
  s_lshl_b32 s41, s20, 9
  s_add_u32 s40, s40, s41
  v_and_b32 v9, 31, v0
  v_lshl_add_u32 v10, v9, 4, s40
  v_lshl_add_u32 v10, v7, 11, v10
  v_min_u32 v2, 63, v0
  v_lshlrev_b32 v2, 7, v2
  v_add_u32 v2, 1380352, v2
  s_nop 1
Lpoll_15:
  buffer_load_dword v3, v2, s[4:7], 0 offen sc1
  s_sub_u32 s24, s24, 1
  s_cbranch_scc1 L_FAIL
  s_waitcnt vmcnt(0)
  v_cmp_gt_i32 vcc, 1, v3
  s_cbranch_vccz Lpolld_16
  s_sleep 2
  s_branch Lpoll_15
Lpolld_16:
  s_mov_b32 s40, 1593344
  buffer_load_dwordx4 v[48:51], v5, s[4:7], s40 offen offset:0 sc1
  buffer_load_dwordx4 v[52:55], v5, s[4:7], s40 offen offset:256 sc1
  buffer_load_dwordx4 v[56:59], v5, s[4:7], s40 offen offset:512 sc1
  buffer_load_dwordx4 v[60:63], v5, s[4:7], s40 offen offset:768 sc1
  s_waitcnt vmcnt(0)
  v_lshrrev_b32 v48, 16, v48
  v_lshrrev_b32 v50, 16, v50
  v_lshrrev_b32 v52, 16, v52
  v_lshrrev_b32 v54, 16, v54
  v_lshrrev_b32 v56, 16, v56
  v_lshrrev_b32 v58, 16, v58
  v_lshrrev_b32 v60, 16, v60
  v_lshrrev_b32 v62, 16, v62
  v_min_u32 v2, 23, v0
  v_lshlrev_b32 v2, 7, v2
  v_add_u32 v2, 1421312, v2
  s_mul_i32 s30, s20, 2176
  v_mul_u32_u24 v11, 544, v6
  v_lshl_add_u32 v11, v8, 3, v11
  v_add_u32 v11, s30, v11
  v_mul_u32_u24 v12, 544, v7
  v_lshl_add_u32 v12, v9, 4, v12
  v_add_u32 v12, s30, v12
  buffer_load_dword v3, v2, s[4:7], s31 offen sc1
  s_nop 0
L_FIN_top:
  s_cmp_lg_u32 s20, 0
  s_cbranch_scc1 Lgo_17
  s_waitcnt vmcnt(0)
  v_cmp_gt_i32 vcc, s29, v3
  s_cbranch_vccz Lgo_17
  s_nop 3
Lpoll_18:
  buffer_load_dword v3, v2, s[4:7], 0 offen sc1
  s_sub_u32 s24, s24, 1
  s_cbranch_scc1 L_FAIL
  s_waitcnt vmcnt(0)
  v_cmp_gt_i32 vcc, s29, v3
  s_cbranch_vccz Lpolld_19
  s_sleep 1
  s_branch Lpoll_18
Lpolld_19:
Lgo_17:
  s_barrier
  s_add_u32 s40, s26, 10485760
  buffer_load_dwordx4 v[16:19], v1, s[4:7], s40 offen sc1
  s_add_u32 s40, s26, 10493952
  buffer_load_dwordx4 v[20:23], v1, s[4:7], s40 offen sc1
  s_add_u32 s40, s27, 0
  buffer_load_dwordx4 v[112:115], v1, s[4:7], s40 offen sc1
  s_add_u32 s40, s27, 8192
  buffer_load_dwordx4 v[116:119], v1, s[4:7], s40 offen sc1
  s_add_u32 s40, s27, 65536
  buffer_load_dwordx4 v[120:123], v1, s[4:7], s40 offen sc1
  s_add_u32 s40, s27, 73728
  buffer_load_dwordx4 v[124:127], v1, s[4:7], s40 offen sc1
  s_add_u32 s40, s27, 131072
  buffer_load_dwordx4 v[128:131], v1, s[4:7], s40 offen sc1
  s_add_u32 s40, s27, 139264
  buffer_load_dwordx4 v[132:135], v1, s[4:7], s40 offen sc1
  s_waitcnt vmcnt(6)
  v_lshlrev_b32 v96, 16, v16
  v_and_b32 v97, 0xffff0000, v16
  v_lshlrev_b32 v98, 16, v17
  v_and_b32 v99, 0xffff0000, v17
  v_lshlrev_b32 v100, 16, v18
  v_and_b32 v101, 0xffff0000, v18
  v_lshlrev_b32 v102, 16, v19
  v_and_b32 v103, 0xffff0000, v19
  v_lshlrev_b32 v104, 16, v20
  v_and_b32 v105, 0xffff0000, v20
  v_lshlrev_b32 v106, 16, v21
  v_and_b32 v107, 0xffff0000, v21
  v_lshlrev_b32 v108, 16, v22
  v_and_b32 v109, 0xffff0000, v22
  v_lshlrev_b32 v110, 16, v23
  v_and_b32 v111, 0xffff0000, v23
  s_waitcnt vmcnt(5)
  v_dot2c_f32_bf16 v96, v112, v48
  v_dot2c_f32_bf16 v97, v112, v49
  v_dot2c_f32_bf16 v98, v113, v50
  v_dot2c_f32_bf16 v99, v113, v51
  v_dot2c_f32_bf16 v100, v114, v52
  v_dot2c_f32_bf16 v101, v114, v53
  v_dot2c_f32_bf16 v102, v115, v54
  v_dot2c_f32_bf16 v103, v115, v55
  s_waitcnt vmcnt(4)
  v_dot2c_f32_bf16 v104, v116, v56
  v_dot2c_f32_bf16 v105, v116, v57
  v_dot2c_f32_bf16 v106, v117, v58
  v_dot2c_f32_bf16 v107, v117, v59
  v_dot2c_f32_bf16 v108, v118, v60
  v_dot2c_f32_bf16 v109, v118, v61
  v_dot2c_f32_bf16 v110, v119, v62
  v_dot2c_f32_bf16 v111, v119, v63
  s_waitcnt vmcnt(3)
  v_dot2c_f32_bf16 v96, v120, v48
  v_dot2c_f32_bf16 v97, v120, v49
  v_dot2c_f32_bf16 v98, v121, v50
  v_dot2c_f32_bf16 v99, v121, v51
  v_dot2c_f32_bf16 v100, v122, v52
  v_dot2c_f32_bf16 v101, v122, v53
  v_dot2c_f32_bf16 v102, v123, v54
  v_dot2c_f32_bf16 v103, v123, v55
  s_waitcnt vmcnt(2)
  v_dot2c_f32_bf16 v104, v124, v56
  v_dot2c_f32_bf16 v105, v124, v57
  v_dot2c_f32_bf16 v106, v125, v58
  v_dot2c_f32_bf16 v107, v125, v59
  v_dot2c_f32_bf16 v108, v126, v60
  v_dot2c_f32_bf16 v109, v126, v61
  v_dot2c_f32_bf16 v110, v127, v62
  v_dot2c_f32_bf16 v111, v127, v63
  s_waitcnt vmcnt(1)
  v_dot2c_f32_bf16 v96, v128, v48
  v_dot2c_f32_bf16 v97, v128, v49
  v_dot2c_f32_bf16 v98, v129, v50
  v_dot2c_f32_bf16 v99, v129, v51
  v_dot2c_f32_bf16 v100, v130, v52
  v_dot2c_f32_bf16 v101, v130, v53
  v_dot2c_f32_bf16 v102, v131, v54
  v_dot2c_f32_bf16 v103, v131, v55
  s_waitcnt vmcnt(0)
  v_dot2c_f32_bf16 v104, v132, v56
  v_dot2c_f32_bf16 v105, v132, v57
  v_dot2c_f32_bf16 v106, v133, v58
  v_dot2c_f32_bf16 v107, v133, v59
  v_dot2c_f32_bf16 v108, v134, v60
  v_dot2c_f32_bf16 v109, v134, v61
  v_dot2c_f32_bf16 v110, v135, v62
  v_dot2c_f32_bf16 v111, v135, v63
  s_nop 2
  buffer_load_dword v3, v2, s[4:7], s31 offen sc1
  v_cvt_pk_bf16_f32 v16, v96, v97
  v_cvt_pk_bf16_f32 v17, v98, v99
  v_cvt_pk_bf16_f32 v18, v100, v101
  v_cvt_pk_bf16_f32 v19, v102, v103
  v_cvt_pk_bf16_f32 v20, v104, v105
  v_cvt_pk_bf16_f32 v21, v106, v107
  v_cvt_pk_bf16_f32 v22, v108, v109
  v_cvt_pk_bf16_f32 v23, v110, v111
  ds_write_b64 v11, v[16:17] offset:0
  ds_write_b64 v11, v[18:19] offset:128
  ds_write_b64 v11, v[20:21] offset:256
  ds_write_b64 v11, v[22:23] offset:384
  ds_read_b128 v[112:115], v12 offset:0
  ds_read_b128 v[116:119], v12 offset:1088
  s_add_u32 s40, s26, 0
  s_waitcnt lgkmcnt(1)
  buffer_store_dwordx4 v[112:115], v10, s[16:19], s40 offen
  s_add_u32 s40, s26, 4096
  s_waitcnt lgkmcnt(0)
  buffer_store_dwordx4 v[116:119], v10, s[16:19], s40 offen
  s_add_u32 s25, s25, 1
  s_add_u32 s29, s29, 1
  s_add_u32 s26, s26, 65536
  s_add_u32 s27, s27, 196608
  s_cmp_lt_u32 s25, 64
  s_cbranch_scc1 L_FIN_top
  s_branch L_END
L_QKV:
  s_and_b32 s43, s21, 1
  s_lshr_b32 s44, s21, 1
  s_lshl_b32 s44, s44, 8
  s_add_u32 s45, s44, 128
  s_lshl_b32 s46, s43, 7
  s_add_u32 s46, s46, s44
  s_load_dwordx4 s[48:51], s[0:1], 16
  s_waitcnt lgkmcnt(0)
  s_cmp_eq_u32 s43, 0
  s_cselect_b32 s8, s48, s50
  s_cselect_b32 s9, s49, s51
  s_mov_b32 s10, 8388608
  s_mov_b32 s11, 0x20000
  v_bfe_u32 v40, v0, 5, 1
  v_mul_u32_u24 v40, 32768, v40
  v_bfe_u32 v41, v0, 4, 1
  v_mul_u32_u24 v41, 16384, v41
  v_add_u32 v40, v40, v41
  v_bfe_u32 v41, v0, 3, 1
  v_mul_u32_u24 v41, 8192, v41
  v_add_u32 v40, v40, v41
  v_lshrrev_b32 v41, 3, v0
  v_and_b32 v41, 6, v41
  v_xor_b32 v41, v41, v0
  v_and_b32 v41, 7, v41
  v_lshl_add_u32 v40, v41, 4, v40
  s_lshr_b32 s40, s20, 1
  s_mul_i32 s40, s40, 2097152
  s_and_b32 s41, s20, 1
  s_mul_i32 s41, s41, 65536
  s_add_u32 s40, s40, s41
  v_add_u32 v40, s40, v40
  v_bfe_u32 v41, v0, 3, 2
  v_xor_b32 v41, s20, v41
  v_lshlrev_b32 v41, 5, v41
  v_lshrrev_b32 v42, 2, v0
  v_lshl_add_u32 v42, v42, 7, v41
  v_and_b32 v41, 3, v0
  v_lshl_add_u32 v42, v41, 3, v42
  v_add_u32 v43, 0x10000, v42
  v_add_u32 v44, s44, v40
  v_add_u32 v45, s45, v40
  v_add_u32 v46, s46, v40
  s_lshl_b32 s41, s20, 10
  s_add_u32 m0, s41, 0
  s_mov_b32 s42, 0
  buffer_load_dwordx4 v44, s[8:11], s42 offen lds
  s_add_u32 m0, s41, 4096
  s_mov_b32 s42, 0
  buffer_load_dwordx4 v45, s[8:11], s42 offen lds
  s_add_u32 m0, s41, 8192
  s_mov_b32 s42, 131072
  buffer_load_dwordx4 v44, s[8:11], s42 offen lds
  s_add_u32 m0, s41, 12288
  s_mov_b32 s42, 131072
  buffer_load_dwordx4 v45, s[8:11], s42 offen lds
  s_add_u32 m0, s41, 16384
  s_mov_b32 s42, 262144
  buffer_load_dwordx4 v44, s[8:11], s42 offen lds
  s_add_u32 m0, s41, 20480
  s_mov_b32 s42, 262144
  buffer_load_dwordx4 v45, s[8:11], s42 offen lds
  s_add_u32 m0, s41, 24576
  s_mov_b32 s42, 393216
  buffer_load_dwordx4 v44, s[8:11], s42 offen lds
  s_add_u32 m0, s41, 28672
  s_mov_b32 s42, 393216
  buffer_load_dwordx4 v45, s[8:11], s42 offen lds
  s_add_u32 m0, s41, 32768
  s_mov_b32 s42, 524288
  buffer_load_dwordx4 v44, s[8:11], s42 offen lds
  s_add_u32 m0, s41, 36864
  s_mov_b32 s42, 524288
  buffer_load_dwordx4 v45, s[8:11], s42 offen lds
  s_add_u32 m0, s41, 40960
  s_mov_b32 s42, 655360
  buffer_load_dwordx4 v44, s[8:11], s42 offen lds
  s_add_u32 m0, s41, 45056
  s_mov_b32 s42, 655360
  buffer_load_dwordx4 v45, s[8:11], s42 offen lds
  s_add_u32 m0, s41, 49152
  s_mov_b32 s42, 786432
  buffer_load_dwordx4 v44, s[8:11], s42 offen lds
  s_add_u32 m0, s41, 53248
  s_mov_b32 s42, 786432
  buffer_load_dwordx4 v45, s[8:11], s42 offen lds
  s_add_u32 m0, s41, 57344
  s_mov_b32 s42, 917504
  buffer_load_dwordx4 v44, s[8:11], s42 offen lds
  s_add_u32 m0, s41, 61440
  s_mov_b32 s42, 917504
  buffer_load_dwordx4 v45, s[8:11], s42 offen lds
  s_add_u32 m0, s41, 65536
  s_mov_b32 s42, 1048576
  buffer_load_dwordx4 v44, s[8:11], s42 offen lds
  s_add_u32 m0, s41, 69632
  s_mov_b32 s42, 1048576
  buffer_load_dwordx4 v45, s[8:11], s42 offen lds
  s_add_u32 m0, s41, 73728
  s_mov_b32 s42, 1179648
  buffer_load_dwordx4 v44, s[8:11], s42 offen lds
  s_add_u32 m0, s41, 77824
  s_mov_b32 s42, 1179648
  buffer_load_dwordx4 v45, s[8:11], s42 offen lds
  s_add_u32 m0, s41, 81920
  s_mov_b32 s42, 1310720
  buffer_load_dwordx4 v44, s[8:11], s42 offen lds
  s_add_u32 m0, s41, 86016
  s_mov_b32 s42, 1310720
  buffer_load_dwordx4 v45, s[8:11], s42 offen lds
  s_add_u32 m0, s41, 90112
  s_mov_b32 s42, 1441792
  buffer_load_dwordx4 v44, s[8:11], s42 offen lds
  s_add_u32 m0, s41, 94208
  s_mov_b32 s42, 1441792
  buffer_load_dwordx4 v45, s[8:11], s42 offen lds
  s_add_u32 m0, s41, 98304
  s_mov_b32 s42, 1572864
  buffer_load_dwordx4 v44, s[8:11], s42 offen lds
  s_add_u32 m0, s41, 102400
  s_mov_b32 s42, 1572864
  buffer_load_dwordx4 v45, s[8:11], s42 offen lds
  s_add_u32 m0, s41, 106496
  s_mov_b32 s42, 1703936
  buffer_load_dwordx4 v44, s[8:11], s42 offen lds
  s_add_u32 m0, s41, 110592
  s_mov_b32 s42, 1703936
  buffer_load_dwordx4 v45, s[8:11], s42 offen lds
  s_waitcnt vmcnt(24) lgkmcnt(0)
  s_barrier
  s_add_u32 m0, s41, 114688
  s_mov_b32 s42, 1835008
  buffer_load_dwordx4 v44, s[8:11], s42 offen lds
  s_add_u32 m0, s41, 118784
  s_mov_b32 s42, 1835008
  buffer_load_dwordx4 v45, s[8:11], s42 offen lds
  s_add_u32 m0, s41, 122880
  s_mov_b32 s42, 1966080
  buffer_load_dwordx4 v44, s[8:11], s42 offen lds
  s_add_u32 m0, s41, 126976
  s_mov_b32 s42, 1966080
  buffer_load_dwordx4 v45, s[8:11], s42 offen lds
  ds_read_b64_tr_b16 a[0:1], v42 offset:0
  ds_read_b64_tr_b16 a[2:3], v42 offset:2048
  ds_read_b64_tr_b16 a[128:129], v42 offset:4096
  ds_read_b64_tr_b16 a[130:131], v42 offset:6144
  ds_read_b64_tr_b16 a[4:5], v42 offset:8192
  ds_read_b64_tr_b16 a[6:7], v42 offset:10240
  ds_read_b64_tr_b16 a[132:133], v42 offset:12288
  ds_read_b64_tr_b16 a[134:135], v42 offset:14336
  s_waitcnt vmcnt(24) lgkmcnt(0)
  s_barrier
  s_add_u32 m0, s41, 0
  s_mov_b32 s42, 4194304
  buffer_load_dwordx4 v44, s[8:11], s42 offen lds
  s_add_u32 m0, s41, 4096
  s_mov_b32 s42, 4194304
  buffer_load_dwordx4 v45, s[8:11], s42 offen lds
  s_add_u32 m0, s41, 8192
  s_mov_b32 s42, 4325376
  buffer_load_dwordx4 v44, s[8:11], s42 offen lds
  s_add_u32 m0, s41, 12288
  s_mov_b32 s42, 4325376
  buffer_load_dwordx4 v45, s[8:11], s42 offen lds
  ds_read_b64_tr_b16 a[8:9], v42 offset:16384
  ds_read_b64_tr_b16 a[10:11], v42 offset:18432
  ds_read_b64_tr_b16 a[136:137], v42 offset:20480
  ds_read_b64_tr_b16 a[138:139], v42 offset:22528
  ds_read_b64_tr_b16 a[12:13], v42 offset:24576
  ds_read_b64_tr_b16 a[14:15], v42 offset:26624
  ds_read_b64_tr_b16 a[140:141], v42 offset:28672
  ds_read_b64_tr_b16 a[142:143], v42 offset:30720
  s_waitcnt vmcnt(24) lgkmcnt(0)
  s_barrier
  s_add_u32 m0, s41, 16384
  s_mov_b32 s42, 4456448
  buffer_load_dwordx4 v44, s[8:11], s42 offen lds
  s_add_u32 m0, s41, 20480
  s_mov_b32 s42, 4456448
  buffer_load_dwordx4 v45, s[8:11], s42 offen lds
  s_add_u32 m0, s41, 24576
  s_mov_b32 s42, 4587520
  buffer_load_dwordx4 v44, s[8:11], s42 offen lds
  s_add_u32 m0, s41, 28672
  s_mov_b32 s42, 4587520
  buffer_load_dwordx4 v45, s[8:11], s42 offen lds
  ds_read_b64_tr_b16 a[16:17], v42 offset:32768
  ds_read_b64_tr_b16 a[18:19], v42 offset:34816
  ds_read_b64_tr_b16 a[144:145], v42 offset:36864
  ds_read_b64_tr_b16 a[146:147], v42 offset:38912
  ds_read_b64_tr_b16 a[20:21], v42 offset:40960
  ds_read_b64_tr_b16 a[22:23], v42 offset:43008
  ds_read_b64_tr_b16 a[148:149], v42 offset:45056
  ds_read_b64_tr_b16 a[150:151], v42 offset:47104
  s_waitcnt vmcnt(24) lgkmcnt(0)
  s_barrier
  s_add_u32 m0, s41, 32768
  s_mov_b32 s42, 4718592
  buffer_load_dwordx4 v44, s[8:11], s42 offen lds
  s_add_u32 m0, s41, 36864
  s_mov_b32 s42, 4718592
  buffer_load_dwordx4 v45, s[8:11], s42 offen lds
  s_add_u32 m0, s41, 40960
  s_mov_b32 s42, 4849664
  buffer_load_dwordx4 v44, s[8:11], s42 offen lds
  s_add_u32 m0, s41, 45056
  s_mov_b32 s42, 4849664
  buffer_load_dwordx4 v45, s[8:11], s42 offen lds
  ds_read_b64_tr_b16 a[24:25], v42 offset:49152
  ds_read_b64_tr_b16 a[26:27], v42 offset:51200
  ds_read_b64_tr_b16 a[152:153], v42 offset:53248
  ds_read_b64_tr_b16 a[154:155], v42 offset:55296
  ds_read_b64_tr_b16 a[28:29], v42 offset:57344
  ds_read_b64_tr_b16 a[30:31], v42 offset:59392
  ds_read_b64_tr_b16 a[156:157], v42 offset:61440
  ds_read_b64_tr_b16 a[158:159], v42 offset:63488
  s_waitcnt vmcnt(24) lgkmcnt(0)
  s_barrier
  s_add_u32 m0, s41, 49152
  s_mov_b32 s42, 4980736
  buffer_load_dwordx4 v44, s[8:11], s42 offen lds
  s_add_u32 m0, s41, 53248
  s_mov_b32 s42, 4980736
  buffer_load_dwordx4 v45, s[8:11], s42 offen lds
  s_add_u32 m0, s41, 57344
  s_mov_b32 s42, 5111808
  buffer_load_dwordx4 v44, s[8:11], s42 offen lds
  s_add_u32 m0, s41, 61440
  s_mov_b32 s42, 5111808
  buffer_load_dwordx4 v45, s[8:11], s42 offen lds
  ds_read_b64_tr_b16 a[32:33], v43 offset:0
  ds_read_b64_tr_b16 a[34:35], v43 offset:2048
  ds_read_b64_tr_b16 a[160:161], v43 offset:4096
  ds_read_b64_tr_b16 a[162:163], v43 offset:6144
  ds_read_b64_tr_b16 a[36:37], v43 offset:8192
  ds_read_b64_tr_b16 a[38:39], v43 offset:10240
  ds_read_b64_tr_b16 a[164:165], v43 offset:12288
  ds_read_b64_tr_b16 a[166:167], v43 offset:14336
  s_waitcnt vmcnt(24) lgkmcnt(0)
  s_barrier
  s_add_u32 m0, s41, 65536
  s_mov_b32 s42, 5242880
  buffer_load_dwordx4 v44, s[8:11], s42 offen lds
  s_add_u32 m0, s41, 69632
  s_mov_b32 s42, 5242880
  buffer_load_dwordx4 v45, s[8:11], s42 offen lds
  s_add_u32 m0, s41, 73728
  s_mov_b32 s42, 5373952
  buffer_load_dwordx4 v44, s[8:11], s42 offen lds
  s_add_u32 m0, s41, 77824
  s_mov_b32 s42, 5373952
  buffer_load_dwordx4 v45, s[8:11], s42 offen lds
  ds_read_b64_tr_b16 a[40:41], v43 offset:16384
  ds_read_b64_tr_b16 a[42:43], v43 offset:18432
  ds_read_b64_tr_b16 a[168:169], v43 offset:20480
  ds_read_b64_tr_b16 a[170:171], v43 offset:22528
  ds_read_b64_tr_b16 a[44:45], v43 offset:24576
  ds_read_b64_tr_b16 a[46:47], v43 offset:26624
  ds_read_b64_tr_b16 a[172:173], v43 offset:28672
  ds_read_b64_tr_b16 a[174:175], v43 offset:30720
  s_waitcnt vmcnt(24) lgkmcnt(0)
  s_barrier
  s_add_u32 m0, s41, 81920
  s_mov_b32 s42, 5505024
  buffer_load_dwordx4 v44, s[8:11], s42 offen lds
  s_add_u32 m0, s41, 86016
  s_mov_b32 s42, 5505024
  buffer_load_dwordx4 v45, s[8:11], s42 offen lds
  s_add_u32 m0, s41, 90112
  s_mov_b32 s42, 5636096
  buffer_load_dwordx4 v44, s[8:11], s42 offen lds
  s_add_u32 m0, s41, 94208
  s_mov_b32 s42, 5636096
  buffer_load_dwordx4 v45, s[8:11], s42 offen lds
  ds_read_b64_tr_b16 a[48:49], v43 offset:32768
  ds_read_b64_tr_b16 a[50:51], v43 offset:34816
  ds_read_b64_tr_b16 a[176:177], v43 offset:36864
  ds_read_b64_tr_b16 a[178:179], v43 offset:38912
  ds_read_b64_tr_b16 a[52:53], v43 offset:40960
  ds_read_b64_tr_b16 a[54:55], v43 offset:43008
  ds_read_b64_tr_b16 a[180:181], v43 offset:45056
  ds_read_b64_tr_b16 a[182:183], v43 offset:47104
  s_waitcnt vmcnt(24) lgkmcnt(0)
  s_barrier
  s_add_u32 m0, s41, 98304
  s_mov_b32 s42, 5767168
  buffer_load_dwordx4 v44, s[8:11], s42 offen lds
  s_add_u32 m0, s41, 102400
  s_mov_b32 s42, 5767168
  buffer_load_dwordx4 v45, s[8:11], s42 offen lds
  s_add_u32 m0, s41, 106496
  s_mov_b32 s42, 5898240
  buffer_load_dwordx4 v44, s[8:11], s42 offen lds
  s_add_u32 m0, s41, 110592
  s_mov_b32 s42, 5898240
  buffer_load_dwordx4 v45, s[8:11], s42 offen lds
  ds_read_b64_tr_b16 a[56:57], v43 offset:49152
  ds_read_b64_tr_b16 a[58:59], v43 offset:51200
  ds_read_b64_tr_b16 a[184:185], v43 offset:53248
  ds_read_b64_tr_b16 a[186:187], v43 offset:55296
  ds_read_b64_tr_b16 a[60:61], v43 offset:57344
  ds_read_b64_tr_b16 a[62:63], v43 offset:59392
  ds_read_b64_tr_b16 a[188:189], v43 offset:61440
  ds_read_b64_tr_b16 a[190:191], v43 offset:63488
  s_waitcnt vmcnt(24) lgkmcnt(0)
  s_barrier
  s_add_u32 m0, s41, 114688
  s_mov_b32 s42, 6029312
  buffer_load_dwordx4 v44, s[8:11], s42 offen lds
  s_add_u32 m0, s41, 118784
  s_mov_b32 s42, 6029312
  buffer_load_dwordx4 v45, s[8:11], s42 offen lds
  s_add_u32 m0, s41, 122880
  s_mov_b32 s42, 6160384
  buffer_load_dwordx4 v44, s[8:11], s42 offen lds
  s_add_u32 m0, s41, 126976
  s_mov_b32 s42, 6160384
  buffer_load_dwordx4 v45, s[8:11], s42 offen lds
  ds_read_b64_tr_b16 a[64:65], v42 offset:0
  ds_read_b64_tr_b16 a[66:67], v42 offset:2048
  ds_read_b64_tr_b16 a[192:193], v42 offset:4096
  ds_read_b64_tr_b16 a[194:195], v42 offset:6144
  ds_read_b64_tr_b16 a[68:69], v42 offset:8192
  ds_read_b64_tr_b16 a[70:71], v42 offset:10240
  ds_read_b64_tr_b16 a[196:197], v42 offset:12288
  ds_read_b64_tr_b16 a[198:199], v42 offset:14336
  s_waitcnt vmcnt(24) lgkmcnt(0)
  s_barrier
  s_load_dwordx2 s[8:9], s[0:1], 32
  s_mov_b32 s10, 8388608
  s_mov_b32 s11, 0x20000
  s_waitcnt lgkmcnt(0)
  s_add_u32 m0, s41, 0
  s_mov_b32 s42, 0
  buffer_load_dwordx4 v46, s[8:11], s42 offen lds
  s_add_u32 m0, s41, 4096
  s_mov_b32 s42, 131072
  buffer_load_dwordx4 v46, s[8:11], s42 offen lds
  s_add_u32 m0, s41, 8192
  s_mov_b32 s42, 262144
  buffer_load_dwordx4 v46, s[8:11], s42 offen lds
  s_add_u32 m0, s41, 12288
  s_mov_b32 s42, 393216
  buffer_load_dwordx4 v46, s[8:11], s42 offen lds
  ds_read_b64_tr_b16 a[72:73], v42 offset:16384
  ds_read_b64_tr_b16 a[74:75], v42 offset:18432
  ds_read_b64_tr_b16 a[200:201], v42 offset:20480
  ds_read_b64_tr_b16 a[202:203], v42 offset:22528
  ds_read_b64_tr_b16 a[76:77], v42 offset:24576
  ds_read_b64_tr_b16 a[78:79], v42 offset:26624
  ds_read_b64_tr_b16 a[204:205], v42 offset:28672
  ds_read_b64_tr_b16 a[206:207], v42 offset:30720
  s_waitcnt vmcnt(24) lgkmcnt(0)
  s_barrier
  s_add_u32 m0, s41, 16384
  s_mov_b32 s42, 524288
  buffer_load_dwordx4 v46, s[8:11], s42 offen lds
  s_add_u32 m0, s41, 20480
  s_mov_b32 s42, 655360
  buffer_load_dwordx4 v46, s[8:11], s42 offen lds
  s_add_u32 m0, s41, 24576
  s_mov_b32 s42, 786432
  buffer_load_dwordx4 v46, s[8:11], s42 offen lds
  s_add_u32 m0, s41, 28672
  s_mov_b32 s42, 917504
  buffer_load_dwordx4 v46, s[8:11], s42 offen lds
  ds_read_b64_tr_b16 a[80:81], v42 offset:32768
  ds_read_b64_tr_b16 a[82:83], v42 offset:34816
  ds_read_b64_tr_b16 a[208:209], v42 offset:36864
  ds_read_b64_tr_b16 a[210:211], v42 offset:38912
  ds_read_b64_tr_b16 a[84:85], v42 offset:40960
  ds_read_b64_tr_b16 a[86:87], v42 offset:43008
  ds_read_b64_tr_b16 a[212:213], v42 offset:45056
  ds_read_b64_tr_b16 a[214:215], v42 offset:47104
  s_cmp_lg_u32 s20, 0
  s_cbranch_scc1 L_QKV_noinit
Lini_20:
  s_load_dwordx16 s[64:79], s[12:13], 128 glc
  s_load_dwordx16 s[80:95], s[12:13], 192 glc
  s_sub_u32 s24, s24, 1
  s_cbranch_scc1 L_FAIL
  s_waitcnt lgkmcnt(0)
  s_and_b64 s[64:65], s[64:65], s[66:67]
  s_and_b64 s[64:65], s[64:65], s[68:69]
  s_and_b64 s[64:65], s[64:65], s[70:71]
  s_and_b64 s[64:65], s[64:65], s[72:73]
  s_and_b64 s[64:65], s[64:65], s[74:75]
  s_and_b64 s[64:65], s[64:65], s[76:77]
  s_and_b64 s[64:65], s[64:65], s[78:79]
  s_and_b64 s[64:65], s[64:65], s[80:81]
  s_and_b64 s[64:65], s[64:65], s[82:83]
  s_and_b64 s[64:65], s[64:65], s[84:85]
  s_and_b64 s[64:65], s[64:65], s[86:87]
  s_and_b64 s[64:65], s[64:65], s[88:89]
  s_and_b64 s[64:65], s[64:65], s[90:91]
  s_and_b64 s[64:65], s[64:65], s[92:93]
  s_and_b64 s[64:65], s[64:65], s[94:95]
  s_and_b32 s64, s64, s65
  s_cbranch_scc0 Lini_20
L_QKV_noinit:
  s_waitcnt vmcnt(24) lgkmcnt(0)
  s_barrier
  s_add_u32 m0, s41, 32768
  s_mov_b32 s42, 1048576
  buffer_load_dwordx4 v46, s[8:11], s42 offen lds
  s_add_u32 m0, s41, 36864
  s_mov_b32 s42, 1179648
  buffer_load_dwordx4 v46, s[8:11], s42 offen lds
  s_add_u32 m0, s41, 40960
  s_mov_b32 s42, 1310720
  buffer_load_dwordx4 v46, s[8:11], s42 offen lds
  s_add_u32 m0, s41, 45056
  s_mov_b32 s42, 1441792
  buffer_load_dwordx4 v46, s[8:11], s42 offen lds
  ds_read_b64_tr_b16 a[88:89], v42 offset:49152
  ds_read_b64_tr_b16 a[90:91], v42 offset:51200
  ds_read_b64_tr_b16 a[216:217], v42 offset:53248
  ds_read_b64_tr_b16 a[218:219], v42 offset:55296
  ds_read_b64_tr_b16 a[92:93], v42 offset:57344
  ds_read_b64_tr_b16 a[94:95], v42 offset:59392
  ds_read_b64_tr_b16 a[220:221], v42 offset:61440
  ds_read_b64_tr_b16 a[222:223], v42 offset:63488
  s_waitcnt vmcnt(24) lgkmcnt(0)
  s_barrier
  s_add_u32 m0, s41, 49152
  s_mov_b32 s42, 1572864
  buffer_load_dwordx4 v46, s[8:11], s42 offen lds
  s_add_u32 m0, s41, 53248
  s_mov_b32 s42, 1703936
  buffer_load_dwordx4 v46, s[8:11], s42 offen lds
  s_add_u32 m0, s41, 57344
  s_mov_b32 s42, 1835008
  buffer_load_dwordx4 v46, s[8:11], s42 offen lds
  s_add_u32 m0, s41, 61440
  s_mov_b32 s42, 1966080
  buffer_load_dwordx4 v46, s[8:11], s42 offen lds
  ds_read_b64_tr_b16 a[96:97], v43 offset:0
  ds_read_b64_tr_b16 a[98:99], v43 offset:2048
  ds_read_b64_tr_b16 a[224:225], v43 offset:4096
  ds_read_b64_tr_b16 a[226:227], v43 offset:6144
  ds_read_b64_tr_b16 a[100:101], v43 offset:8192
  ds_read_b64_tr_b16 a[102:103], v43 offset:10240
  ds_read_b64_tr_b16 a[228:229], v43 offset:12288
  ds_read_b64_tr_b16 a[230:231], v43 offset:14336
  s_waitcnt vmcnt(24) lgkmcnt(0)
  s_barrier
  s_add_u32 m0, s41, 65536
  s_mov_b32 s42, 4194304
  buffer_load_dwordx4 v46, s[8:11], s42 offen lds
  s_add_u32 m0, s41, 69632
  s_mov_b32 s42, 4325376
  buffer_load_dwordx4 v46, s[8:11], s42 offen lds
  s_add_u32 m0, s41, 73728
  s_mov_b32 s42, 4456448
  buffer_load_dwordx4 v46, s[8:11], s42 offen lds
  s_add_u32 m0, s41, 77824
  s_mov_b32 s42, 4587520
  buffer_load_dwordx4 v46, s[8:11], s42 offen lds
  ds_read_b64_tr_b16 a[104:105], v43 offset:16384
  ds_read_b64_tr_b16 a[106:107], v43 offset:18432
  ds_read_b64_tr_b16 a[232:233], v43 offset:20480
  ds_read_b64_tr_b16 a[234:235], v43 offset:22528
  ds_read_b64_tr_b16 a[108:109], v43 offset:24576
  ds_read_b64_tr_b16 a[110:111], v43 offset:26624
  ds_read_b64_tr_b16 a[236:237], v43 offset:28672
  ds_read_b64_tr_b16 a[238:239], v43 offset:30720
  s_waitcnt vmcnt(24) lgkmcnt(0)
  s_barrier
  s_add_u32 m0, s41, 81920
  s_mov_b32 s42, 4718592
  buffer_load_dwordx4 v46, s[8:11], s42 offen lds
  s_add_u32 m0, s41, 86016
  s_mov_b32 s42, 4849664
  buffer_load_dwordx4 v46, s[8:11], s42 offen lds
  s_add_u32 m0, s41, 90112
  s_mov_b32 s42, 4980736
  buffer_load_dwordx4 v46, s[8:11], s42 offen lds
  s_add_u32 m0, s41, 94208
  s_mov_b32 s42, 5111808
  buffer_load_dwordx4 v46, s[8:11], s42 offen lds
  ds_read_b64_tr_b16 a[112:113], v43 offset:32768
  ds_read_b64_tr_b16 a[114:115], v43 offset:34816
  ds_read_b64_tr_b16 a[240:241], v43 offset:36864
  ds_read_b64_tr_b16 a[242:243], v43 offset:38912
  ds_read_b64_tr_b16 a[116:117], v43 offset:40960
  ds_read_b64_tr_b16 a[118:119], v43 offset:43008
  ds_read_b64_tr_b16 a[244:245], v43 offset:45056
  ds_read_b64_tr_b16 a[246:247], v43 offset:47104
  s_waitcnt vmcnt(24) lgkmcnt(0)
  s_barrier
  s_add_u32 m0, s41, 98304
  s_mov_b32 s42, 5242880
  buffer_load_dwordx4 v46, s[8:11], s42 offen lds
  s_add_u32 m0, s41, 102400
  s_mov_b32 s42, 5373952
  buffer_load_dwordx4 v46, s[8:11], s42 offen lds
  s_add_u32 m0, s41, 106496
  s_mov_b32 s42, 5505024
  buffer_load_dwordx4 v46, s[8:11], s42 offen lds
  s_add_u32 m0, s41, 110592
  s_mov_b32 s42, 5636096
  buffer_load_dwordx4 v46, s[8:11], s42 offen lds
  ds_read_b64_tr_b16 a[120:121], v43 offset:49152
  ds_read_b64_tr_b16 a[122:123], v43 offset:51200
  ds_read_b64_tr_b16 a[248:249], v43 offset:53248
  ds_read_b64_tr_b16 a[250:251], v43 offset:55296
  ds_read_b64_tr_b16 a[124:125], v43 offset:57344
  ds_read_b64_tr_b16 a[126:127], v43 offset:59392
  ds_read_b64_tr_b16 a[252:253], v43 offset:61440
  ds_read_b64_tr_b16 a[254:255], v43 offset:63488
  s_waitcnt vmcnt(24) lgkmcnt(0)
  s_barrier
  s_add_u32 m0, s41, 114688
  s_mov_b32 s42, 5767168
  buffer_load_dwordx4 v46, s[8:11], s42 offen lds
  s_add_u32 m0, s41, 118784
  s_mov_b32 s42, 5898240
  buffer_load_dwordx4 v46, s[8:11], s42 offen lds
  s_add_u32 m0, s41, 122880
  s_mov_b32 s42, 6029312
  buffer_load_dwordx4 v46, s[8:11], s42 offen lds
  s_add_u32 m0, s41, 126976
  s_mov_b32 s42, 6160384
  buffer_load_dwordx4 v46, s[8:11], s42 offen lds
  ds_read_b64_tr_b16 v[128:129], v42 offset:0
  ds_read_b64_tr_b16 v[130:131], v42 offset:2048
  ds_read_b64_tr_b16 v[132:133], v42 offset:4096
  ds_read_b64_tr_b16 v[134:135], v42 offset:6144
  ds_read_b64_tr_b16 v[136:137], v42 offset:8192
  ds_read_b64_tr_b16 v[138:139], v42 offset:10240
  ds_read_b64_tr_b16 v[140:141], v42 offset:12288
  ds_read_b64_tr_b16 v[142:143], v42 offset:14336
  s_waitcnt vmcnt(24) lgkmcnt(0)
  s_barrier
  ds_read_b64_tr_b16 v[144:145], v42 offset:16384
  ds_read_b64_tr_b16 v[146:147], v42 offset:18432
  ds_read_b64_tr_b16 v[148:149], v42 offset:20480
  ds_read_b64_tr_b16 v[150:151], v42 offset:22528
  ds_read_b64_tr_b16 v[152:153], v42 offset:24576
  ds_read_b64_tr_b16 v[154:155], v42 offset:26624
  ds_read_b64_tr_b16 v[156:157], v42 offset:28672
  ds_read_b64_tr_b16 v[158:159], v42 offset:30720
  s_waitcnt vmcnt(20) lgkmcnt(0)
  s_barrier
  ds_read_b64_tr_b16 v[160:161], v42 offset:32768
  ds_read_b64_tr_b16 v[162:163], v42 offset:34816
  ds_read_b64_tr_b16 v[164:165], v42 offset:36864
  ds_read_b64_tr_b16 v[166:167], v42 offset:38912
  ds_read_b64_tr_b16 v[168:169], v42 offset:40960
  ds_read_b64_tr_b16 v[170:171], v42 offset:43008
  ds_read_b64_tr_b16 v[172:173], v42 offset:45056
  ds_read_b64_tr_b16 v[174:175], v42 offset:47104
  s_waitcnt vmcnt(16) lgkmcnt(0)
  s_barrier
  ds_read_b64_tr_b16 v[176:177], v42 offset:49152
  ds_read_b64_tr_b16 v[178:179], v42 offset:51200
  ds_read_b64_tr_b16 v[180:181], v42 offset:53248
  ds_read_b64_tr_b16 v[182:183], v42 offset:55296
  ds_read_b64_tr_b16 v[184:185], v42 offset:57344
  ds_read_b64_tr_b16 v[186:187], v42 offset:59392
  ds_read_b64_tr_b16 v[188:189], v42 offset:61440
  ds_read_b64_tr_b16 v[190:191], v42 offset:63488
  s_waitcnt vmcnt(12) lgkmcnt(0)
  s_barrier
  ds_read_b64_tr_b16 v[192:193], v43 offset:0
  ds_read_b64_tr_b16 v[194:195], v43 offset:2048
  ds_read_b64_tr_b16 v[196:197], v43 offset:4096
  ds_read_b64_tr_b16 v[198:199], v43 offset:6144
  ds_read_b64_tr_b16 v[200:201], v43 offset:8192
  ds_read_b64_tr_b16 v[202:203], v43 offset:10240
  ds_read_b64_tr_b16 v[204:205], v43 offset:12288
  ds_read_b64_tr_b16 v[206:207], v43 offset:14336
  s_waitcnt vmcnt(8) lgkmcnt(0)
  s_barrier
  ds_read_b64_tr_b16 v[208:209], v43 offset:16384
  ds_read_b64_tr_b16 v[210:211], v43 offset:18432
  ds_read_b64_tr_b16 v[212:213], v43 offset:20480
  ds_read_b64_tr_b16 v[214:215], v43 offset:22528
  ds_read_b64_tr_b16 v[216:217], v43 offset:24576
  ds_read_b64_tr_b16 v[218:219], v43 offset:26624
  ds_read_b64_tr_b16 v[220:221], v43 offset:28672
  ds_read_b64_tr_b16 v[222:223], v43 offset:30720
  s_waitcnt vmcnt(4) lgkmcnt(0)
  s_barrier
  ds_read_b64_tr_b16 v[224:225], v43 offset:32768
  ds_read_b64_tr_b16 v[226:227], v43 offset:34816
  ds_read_b64_tr_b16 v[228:229], v43 offset:36864
  ds_read_b64_tr_b16 v[230:231], v43 offset:38912
  ds_read_b64_tr_b16 v[232:233], v43 offset:40960
  ds_read_b64_tr_b16 v[234:235], v43 offset:43008
  ds_read_b64_tr_b16 v[236:237], v43 offset:45056
  ds_read_b64_tr_b16 v[238:239], v43 offset:47104
  s_waitcnt vmcnt(0) lgkmcnt(0)
  s_barrier
  ds_read_b64_tr_b16 v[240:241], v43 offset:49152
  ds_read_b64_tr_b16 v[242:243], v43 offset:51200
  ds_read_b64_tr_b16 v[244:245], v43 offset:53248
  ds_read_b64_tr_b16 v[246:247], v43 offset:55296
  ds_read_b64_tr_b16 v[248:249], v43 offset:57344
  ds_read_b64_tr_b16 v[250:251], v43 offset:59392
  ds_read_b64_tr_b16 v[252:253], v43 offset:61440
  ds_read_b64_tr_b16 v[254:255], v43 offset:63488
  s_waitcnt lgkmcnt(0)
  s_barrier
  s_lshr_b32 s62, s21, 1
  s_lshl_b32 s62, s62, 7
  s_and_b32 s40, s21, 1
  s_lshl_b32 s40, s40, 2
  s_add_u32 s62, s62, s40
  s_add_u32 s62, s62, 1396736
  s_mov_b32 s27, 2097152
  s_lshr_b32 s40, s21, 1
  s_mul_i32 s31, s40, 65536
  s_and_b32 s41, s21, 1
  s_lshl_b32 s42, s20, 11
  s_lshl_b32 s40, s41, 14
  s_add_u32 s40, s40, s42
  v_lshl_add_u32 v76, v0, 4, s40
  s_lshl_b32 s40, s41, 10
  s_add_u32 s40, s40, s42
  s_add_u32 s40, s40, 32768
  v_lshl_add_u32 v83, v0, 4, s40
  v_lshrrev_b32 v60, 3, v0
  v_and_b32 v61, 6, v60
  v_xor_b32 v61, v61, v0
  v_and_b32 v61, 7, v61
  v_lshlrev_b32 v61, 4, v61
  v_lshl_add_u32 v1, v60, 11, v61
  s_lshl_b32 s40, s20, 14
  v_add_u32 v1, s40, v1
  s_lshl_b32 s32, s20, 10
  v_and_b32 v60, 6, v0
  v_lshrrev_b32 v61, 4, v0
  v_xor_b32 v60, v60, v61
  v_lshlrev_b32 v60, 4, v60
  v_and_b32 v61, 15, v0
  v_lshl_add_u32 v77, v61, 7, v60
  v_xor_b32 v78, 64, v77
  v_lshrrev_b32 v2, 3, v0
  v_lshlrev_b32 v2, 7, v2
  v_and_b32 v3, 7, v0
  v_lshl_add_u32 v2, v3, 2, v2
  v_add_u32 v2, 1388544, v2
  s_mov_b32 s25, 0
  s_mov_b32 s37, 2147483392
  s_mov_b32 s30, 0
  s_mov_b32 s34, s32
  s_mov_b32 s35, s27
  v_mov_b32 v81, v77
  v_mov_b32 v82, v78
  s_cmp_lg_u32 s20, 0
  s_cbranch_scc1 Lnosig_21
  s_mov_b32 s63, 0
  s_atomic_smax s63, s[4:5], s62 glc
Lnosig_21:
Lpoll_22:
  buffer_load_dword v3, v2, s[4:7], 0 offen sc1
  s_sub_u32 s24, s24, 1
  s_cbranch_scc1 L_FAIL
  s_waitcnt vmcnt(0)
  v_cmp_gt_i32 vcc, 1, v3
  s_cbranch_vccz Lpolld_23
  s_sleep 1
  s_branch Lpoll_22
Lpolld_23:
  s_add_u32 m0, s34, 0
  s_nop 0
  buffer_load_dwordx4 v1, s[4:7], s35 offen offset:0 sc1 lds
  s_add_u32 m0, s34, 3968
  s_nop 0
  buffer_load_dwordx4 v1, s[4:7], s35 offen offset:128 sc1 lds
  s_add_u32 m0, s34, 7936
  s_nop 0
  buffer_load_dwordx4 v1, s[4:7], s35 offen offset:256 sc1 lds
  s_add_u32 m0, s34, 11904
  s_nop 0
  buffer_load_dwordx4 v1, s[4:7], s35 offen offset:384 sc1 lds
  s_add_u32 m0, s34, 15872
  s_nop 0
  buffer_load_dwordx4 v1, s[4:7], s35 offen offset:512 sc1 lds
  s_add_u32 m0, s34, 19840
  s_nop 0
  buffer_load_dwordx4 v1, s[4:7], s35 offen offset:640 sc1 lds
  s_add_u32 m0, s34, 23808
  s_nop 0
  buffer_load_dwordx4 v1, s[4:7], s35 offen offset:768 sc1 lds
  s_add_u32 m0, s34, 27776
  s_nop 0
  buffer_load_dwordx4 v1, s[4:7], s35 offen offset:896 sc1 lds
  s_add_u32 m0, s34, 31744
  s_nop 0
  buffer_load_dwordx4 v1, s[4:7], s35 offen offset:1024 sc1 lds
  s_add_u32 m0, s34, 35712
  s_nop 0
  buffer_load_dwordx4 v1, s[4:7], s35 offen offset:1152 sc1 lds
  s_add_u32 m0, s34, 39680
  s_nop 0
  buffer_load_dwordx4 v1, s[4:7], s35 offen offset:1280 sc1 lds
  s_add_u32 m0, s34, 43648
  s_nop 0
  buffer_load_dwordx4 v1, s[4:7], s35 offen offset:1408 sc1 lds
  s_add_u32 m0, s34, 47616
  s_nop 0
  buffer_load_dwordx4 v1, s[4:7], s35 offen offset:1536 sc1 lds
  s_add_u32 m0, s34, 51584
  s_nop 0
  buffer_load_dwordx4 v1, s[4:7], s35 offen offset:1664 sc1 lds
  s_add_u32 m0, s34, 55552
  s_nop 0
  buffer_load_dwordx4 v1, s[4:7], s35 offen offset:1792 sc1 lds
  s_add_u32 m0, s34, 59520
  s_nop 0
  buffer_load_dwordx4 v1, s[4:7], s35 offen offset:1920 sc1 lds
  v_min_u32 v60, 63, v0
  v_lshlrev_b32 v60, 7, v60
  v_add_u32 v60, 1424384, v60
  s_nop 1
Lpoll_24:
  buffer_load_dword v61, v60, s[4:7], 0 offen sc1
  s_sub_u32 s24, s24, 1
  s_cbranch_scc1 L_FAIL
  s_waitcnt vmcnt(0)
  v_cmp_gt_i32 vcc, 0, v61
  s_cbranch_vccz Lpolld_25
  s_sleep 1
  s_branch Lpoll_24
Lpolld_25:
  v_lshrrev_b32 v61, 8, v61
  v_and_b32 v62, 3, v0
  v_lshl_or_b32 v61, v61, 2, v62
  s_nop 1
  v_min_u32_dpp v61, v61, v61 row_ror:8 row_mask:0xf bank_mask:0xf
  s_nop 1
  v_min_u32_dpp v61, v61, v61 row_ror:4 row_mask:0xf bank_mask:0xf
  v_mov_b32 v62, v61
  s_nop 1
  v_permlane16_swap_b32 v62, v61
  v_min_u32 v61, v61, v62
  v_mov_b32 v62, v61
  s_nop 1
  v_permlane32_swap_b32 v62, v61
  v_min_u32 v61, v61, v62
  s_nop 1
  v_min_u32_dpp v61, v61, v61 row_ror:2 row_mask:0xf bank_mask:0xf
  s_nop 1
  v_min_u32_dpp v61, v61, v61 row_ror:1 row_mask:0xf bank_mask:0xf
  s_nop 0
  v_readfirstlane_b32 s40, v61
  s_and_b32 s40, s40, 3
  s_lshl_b32 s40, s40, 13
  s_and_b32 s40, s40, 0x2000
  s_xor_b32 s40, s40, 67108864
  s_add_u32 s31, s31, s40
  s_waitcnt lgkmcnt(0)
  s_barrier
  ds_read_b128 v[4:7], v81 offset:0
  ds_read_b128 v[8:11], v81 offset:2048
  ds_read_b128 v[12:15], v82 offset:0
  ds_read_b128 v[16:19], v82 offset:2048
  ds_read_b128 v[20:23], v81 offset:4096
  ds_read_b128 v[24:27], v81 offset:6144
L_QKV_top:
  s_waitcnt lgkmcnt(4)
  v_cvt_pk_bf16_f32 v60, v36, v37
  v_cvt_pk_bf16_f32 v61, v38, v39
  v_mfma_f32_16x16x32_bf16 v[36:39], a[0:3], v[4:7], 0
  v_cvt_pk_bf16_f32 v62, v44, v45
  v_cvt_pk_bf16_f32 v63, v46, v47
  v_mfma_f32_16x16x32_bf16 v[44:47], a[128:131], v[4:7], 0
  v_cvt_pk_bf16_f32 v64, v40, v41
  v_cvt_pk_bf16_f32 v65, v42, v43
  v_mfma_f32_16x16x32_bf16 v[40:43], a[0:3], v[8:11], 0
  v_cvt_pk_bf16_f32 v66, v48, v49
  v_cvt_pk_bf16_f32 v67, v50, v51
  v_mfma_f32_16x16x32_bf16 v[48:51], a[128:131], v[8:11], 0
  v_cvt_pk_bf16_f32 v68, v52, v53
  v_cvt_pk_bf16_f32 v69, v54, v55
  v_mfma_f32_16x16x32_bf16 v[52:55], v[4:7], v[128:131], 0
  ds_read_b128 v[28:31], v82 offset:4096
  v_cvt_pk_bf16_f32 v70, v56, v57
  v_cvt_pk_bf16_f32 v71, v58, v59
  v_mfma_f32_16x16x32_bf16 v[56:59], v[8:11], v[128:131], 0
  ds_read_b128 v[32:35], v82 offset:6144
  s_waitcnt lgkmcnt(4)
  v_mfma_f32_16x16x32_bf16 v[36:39], a[4:7], v[12:15], v[36:39]
  ds_read_b128 v[4:7], v81 offset:8192
  v_mfma_f32_16x16x32_bf16 v[44:47], a[132:135], v[12:15], v[44:47]
  ds_read_b128 v[8:11], v81 offset:10240
  v_mfma_f32_16x16x32_bf16 v[40:43], a[4:7], v[16:19], v[40:43]
  buffer_store_dwordx4 v[60:63], v76, s[4:7], s37 offen offset:0 sc1
  v_mfma_f32_16x16x32_bf16 v[48:51], a[132:135], v[16:19], v[48:51]
  buffer_store_dwordx4 v[64:67], v76, s[4:7], s37 offen offset:1024 sc1
  v_mfma_f32_16x16x32_bf16 v[52:55], v[12:15], v[132:135], v[52:55]
  v_mfma_f32_16x16x32_bf16 v[56:59], v[16:19], v[132:135], v[56:59]
  s_waitcnt lgkmcnt(4)
  v_mfma_f32_16x16x32_bf16 v[36:39], a[8:11], v[20:23], v[36:39]
  ds_read_b128 v[12:15], v82 offset:8192
  v_mfma_f32_16x16x32_bf16 v[44:47], a[136:139], v[20:23], v[44:47]
  ds_read_b128 v[16:19], v82 offset:10240
  v_mfma_f32_16x16x32_bf16 v[40:43], a[8:11], v[24:27], v[40:43]
  buffer_store_dwordx4 v[68:71], v83, s[4:7], s37 offen sc1
  v_mfma_f32_16x16x32_bf16 v[48:51], a[136:139], v[24:27], v[48:51]
  v_cmp_gt_i32 vcc, 1, v3
  v_mfma_f32_16x16x32_bf16 v[52:55], v[20:23], v[136:139], v[52:55]
  v_mfma_f32_16x16x32_bf16 v[56:59], v[24:27], v[136:139], v[56:59]
  s_xor_b32 s34, s34, 0x10000
  s_add_u32 s35, s35, 65536
  s_cbranch_vccz L_QKV_have
  s_nop 4
Lpoll_26:
  buffer_load_dword v3, v2, s[4:7], s30 offen sc1
  s_sub_u32 s24, s24, 1
  s_cbranch_scc1 L_FAIL
  s_waitcnt vmcnt(0)
  v_cmp_gt_i32 vcc, 1, v3
  s_cbranch_vccz Lpolld_27
  s_sleep 1
  s_branch Lpoll_26
Lpolld_27:
L_QKV_have:
  s_barrier
  s_waitcnt lgkmcnt(4)
  v_mfma_f32_16x16x32_bf16 v[36:39], a[12:15], v[28:31], v[36:39]
  ds_read_b128 v[20:23], v81 offset:12288
  v_mfma_f32_16x16x32_bf16 v[44:47], a[140:143], v[28:31], v[44:47]
  ds_read_b128 v[24:27], v81 offset:14336
  v_mfma_f32_16x16x32_bf16 v[40:43], a[12:15], v[32:35], v[40:43]
  s_add_u32 m0, s34, 0
  s_nop 0
  buffer_load_dwordx4 v1, s[4:7], s35 offen offset:0 sc1 lds
  v_mfma_f32_16x16x32_bf16 v[48:51], a[140:143], v[32:35], v[48:51]
  v_mfma_f32_16x16x32_bf16 v[52:55], v[28:31], v[140:143], v[52:55]
  v_mfma_f32_16x16x32_bf16 v[56:59], v[32:35], v[140:143], v[56:59]
  s_waitcnt lgkmcnt(4)
  v_mfma_f32_16x16x32_bf16 v[36:39], a[16:19], v[4:7], v[36:39]
  ds_read_b128 v[28:31], v82 offset:12288
  v_mfma_f32_16x16x32_bf16 v[44:47], a[144:147], v[4:7], v[44:47]
  ds_read_b128 v[32:35], v82 offset:14336
  v_mfma_f32_16x16x32_bf16 v[40:43], a[16:19], v[8:11], v[40:43]
  s_add_u32 m0, s34, 3968
  s_nop 0
  buffer_load_dwordx4 v1, s[4:7], s35 offen offset:128 sc1 lds
  v_mfma_f32_16x16x32_bf16 v[48:51], a[144:147], v[8:11], v[48:51]
  v_mfma_f32_16x16x32_bf16 v[52:55], v[4:7], v[144:147], v[52:55]
  v_mfma_f32_16x16x32_bf16 v[56:59], v[8:11], v[144:147], v[56:59]
  s_waitcnt lgkmcnt(4)
  v_mfma_f32_16x16x32_bf16 v[36:39], a[20:23], v[12:15], v[36:39]
  ds_read_b128 v[4:7], v81 offset:16384
  v_mfma_f32_16x16x32_bf16 v[44:47], a[148:151], v[12:15], v[44:47]
  ds_read_b128 v[8:11], v81 offset:18432
  v_mfma_f32_16x16x32_bf16 v[40:43], a[20:23], v[16:19], v[40:43]
  s_add_u32 m0, s34, 7936
  s_nop 0
  buffer_load_dwordx4 v1, s[4:7], s35 offen offset:256 sc1 lds
  v_mfma_f32_16x16x32_bf16 v[48:51], a[148:151], v[16:19], v[48:51]
  v_mfma_f32_16x16x32_bf16 v[52:55], v[12:15], v[148:151], v[52:55]
  v_mfma_f32_16x16x32_bf16 v[56:59], v[16:19], v[148:151], v[56:59]
  s_waitcnt lgkmcnt(4)
  v_mfma_f32_16x16x32_bf16 v[36:39], a[24:27], v[20:23], v[36:39]
  ds_read_b128 v[12:15], v82 offset:16384
  v_mfma_f32_16x16x32_bf16 v[44:47], a[152:155], v[20:23], v[44:47]
  ds_read_b128 v[16:19], v82 offset:18432
  v_mfma_f32_16x16x32_bf16 v[40:43], a[24:27], v[24:27], v[40:43]
  s_add_u32 m0, s34, 11904
  s_nop 0
  buffer_load_dwordx4 v1, s[4:7], s35 offen offset:384 sc1 lds
  v_mfma_f32_16x16x32_bf16 v[48:51], a[152:155], v[24:27], v[48:51]
  v_mfma_f32_16x16x32_bf16 v[52:55], v[20:23], v[152:155], v[52:55]
  v_mfma_f32_16x16x32_bf16 v[56:59], v[24:27], v[152:155], v[56:59]
  s_waitcnt lgkmcnt(4)
  v_mfma_f32_16x16x32_bf16 v[36:39], a[28:31], v[28:31], v[36:39]
  ds_read_b128 v[20:23], v81 offset:20480
  v_mfma_f32_16x16x32_bf16 v[44:47], a[156:159], v[28:31], v[44:47]
  ds_read_b128 v[24:27], v81 offset:22528
  v_mfma_f32_16x16x32_bf16 v[40:43], a[28:31], v[32:35], v[40:43]
  s_add_u32 m0, s34, 15872
  s_nop 0
  buffer_load_dwordx4 v1, s[4:7], s35 offen offset:512 sc1 lds
  v_mfma_f32_16x16x32_bf16 v[48:51], a[156:159], v[32:35], v[48:51]
  v_mfma_f32_16x16x32_bf16 v[52:55], v[28:31], v[156:159], v[52:55]
  v_mfma_f32_16x16x32_bf16 v[56:59], v[32:35], v[156:159], v[56:59]
  s_waitcnt lgkmcnt(4)
  v_mfma_f32_16x16x32_bf16 v[36:39], a[32:35], v[4:7], v[36:39]
  ds_read_b128 v[28:31], v82 offset:20480
  v_mfma_f32_16x16x32_bf16 v[44:47], a[160:163], v[4:7], v[44:47]
  ds_read_b128 v[32:35], v82 offset:22528
  v_mfma_f32_16x16x32_bf16 v[40:43], a[32:35], v[8:11], v[40:43]
  s_add_u32 m0, s34, 19840
  s_nop 0
  buffer_load_dwordx4 v1, s[4:7], s35 offen offset:640 sc1 lds
  v_mfma_f32_16x16x32_bf16 v[48:51], a[160:163], v[8:11], v[48:51]
  v_mfma_f32_16x16x32_bf16 v[52:55], v[4:7], v[160:163], v[52:55]
  v_mfma_f32_16x16x32_bf16 v[56:59], v[8:11], v[160:163], v[56:59]
  s_waitcnt lgkmcnt(4)
  v_mfma_f32_16x16x32_bf16 v[36:39], a[36:39], v[12:15], v[36:39]
  ds_read_b128 v[4:7], v81 offset:24576
  v_mfma_f32_16x16x32_bf16 v[44:47], a[164:167], v[12:15], v[44:47]
  ds_read_b128 v[8:11], v81 offset:26624
  v_mfma_f32_16x16x32_bf16 v[40:43], a[36:39], v[16:19], v[40:43]
  s_add_u32 m0, s34, 23808
  s_nop 0
  buffer_load_dwordx4 v1, s[4:7], s35 offen offset:768 sc1 lds
  v_mfma_f32_16x16x32_bf16 v[48:51], a[164:167], v[16:19], v[48:51]
  v_mfma_f32_16x16x32_bf16 v[52:55], v[12:15], v[164:167], v[52:55]
  v_mfma_f32_16x16x32_bf16 v[56:59], v[16:19], v[164:167], v[56:59]
  s_waitcnt lgkmcnt(4)
  v_mfma_f32_16x16x32_bf16 v[36:39], a[40:43], v[20:23], v[36:39]
  ds_read_b128 v[12:15], v82 offset:24576
  v_mfma_f32_16x16x32_bf16 v[44:47], a[168:171], v[20:23], v[44:47]
  ds_read_b128 v[16:19], v82 offset:26624
  v_mfma_f32_16x16x32_bf16 v[40:43], a[40:43], v[24:27], v[40:43]
  s_add_u32 m0, s34, 27776
  s_nop 0
  buffer_load_dwordx4 v1, s[4:7], s35 offen offset:896 sc1 lds
  v_mfma_f32_16x16x32_bf16 v[48:51], a[168:171], v[24:27], v[48:51]
  v_mfma_f32_16x16x32_bf16 v[52:55], v[20:23], v[168:171], v[52:55]
  v_mfma_f32_16x16x32_bf16 v[56:59], v[24:27], v[168:171], v[56:59]
  s_waitcnt lgkmcnt(4)
  v_mfma_f32_16x16x32_bf16 v[36:39], a[44:47], v[28:31], v[36:39]
  ds_read_b128 v[20:23], v81 offset:28672
  v_mfma_f32_16x16x32_bf16 v[44:47], a[172:175], v[28:31], v[44:47]
  ds_read_b128 v[24:27], v81 offset:30720
  v_mfma_f32_16x16x32_bf16 v[40:43], a[44:47], v[32:35], v[40:43]
  s_add_u32 m0, s34, 31744
  s_nop 0
  buffer_load_dwordx4 v1, s[4:7], s35 offen offset:1024 sc1 lds
  v_mfma_f32_16x16x32_bf16 v[48:51], a[172:175], v[32:35], v[48:51]
  v_mfma_f32_16x16x32_bf16 v[52:55], v[28:31], v[172:175], v[52:55]
  v_mfma_f32_16x16x32_bf16 v[56:59], v[32:35], v[172:175], v[56:59]
  s_waitcnt vmcnt(9)
  s_barrier
  s_cmp_lg_u32 s20, 0
  s_cbranch_scc1 Lnosig_28
  s_mov_b32 s63, s25
  s_atomic_smax s63, s[4:5], s62 glc
Lnosig_28:
  s_waitcnt lgkmcnt(4)
  v_mfma_f32_16x16x32_bf16 v[36:39], a[48:51], v[4:7], v[36:39]
  ds_read_b128 v[28:31], v82 offset:28672
  v_mfma_f32_16x16x32_bf16 v[44:47], a[176:179], v[4:7], v[44:47]
  ds_read_b128 v[32:35], v82 offset:30720
  v_mfma_f32_16x16x32_bf16 v[40:43], a[48:51], v[8:11], v[40:43]
  s_add_u32 m0, s34, 35712
  s_nop 0
  buffer_load_dwordx4 v1, s[4:7], s35 offen offset:1152 sc1 lds
  v_mfma_f32_16x16x32_bf16 v[48:51], a[176:179], v[8:11], v[48:51]
  v_mfma_f32_16x16x32_bf16 v[52:55], v[4:7], v[176:179], v[52:55]
  v_mfma_f32_16x16x32_bf16 v[56:59], v[8:11], v[176:179], v[56:59]
  s_waitcnt lgkmcnt(4)
  v_mfma_f32_16x16x32_bf16 v[36:39], a[52:55], v[12:15], v[36:39]
  ds_read_b128 v[4:7], v81 offset:32768
  v_mfma_f32_16x16x32_bf16 v[44:47], a[180:183], v[12:15], v[44:47]
  ds_read_b128 v[8:11], v81 offset:34816
  v_mfma_f32_16x16x32_bf16 v[40:43], a[52:55], v[16:19], v[40:43]
  s_add_u32 m0, s34, 39680
  s_nop 0
  buffer_load_dwordx4 v1, s[4:7], s35 offen offset:1280 sc1 lds
  v_mfma_f32_16x16x32_bf16 v[48:51], a[180:183], v[16:19], v[48:51]
  v_mfma_f32_16x16x32_bf16 v[52:55], v[12:15], v[180:183], v[52:55]
  v_mfma_f32_16x16x32_bf16 v[56:59], v[16:19], v[180:183], v[56:59]
  s_waitcnt lgkmcnt(4)
  v_mfma_f32_16x16x32_bf16 v[36:39], a[56:59], v[20:23], v[36:39]
  ds_read_b128 v[12:15], v82 offset:32768
  v_mfma_f32_16x16x32_bf16 v[44:47], a[184:187], v[20:23], v[44:47]
  ds_read_b128 v[16:19], v82 offset:34816
  v_mfma_f32_16x16x32_bf16 v[40:43], a[56:59], v[24:27], v[40:43]
  s_add_u32 m0, s34, 43648
  s_nop 0
  buffer_load_dwordx4 v1, s[4:7], s35 offen offset:1408 sc1 lds
  v_mfma_f32_16x16x32_bf16 v[48:51], a[184:187], v[24:27], v[48:51]
  v_mfma_f32_16x16x32_bf16 v[52:55], v[20:23], v[184:187], v[52:55]
  v_mfma_f32_16x16x32_bf16 v[56:59], v[24:27], v[184:187], v[56:59]
  s_waitcnt lgkmcnt(4)
  v_mfma_f32_16x16x32_bf16 v[36:39], a[60:63], v[28:31], v[36:39]
  ds_read_b128 v[20:23], v81 offset:36864
  v_mfma_f32_16x16x32_bf16 v[44:47], a[188:191], v[28:31], v[44:47]
  ds_read_b128 v[24:27], v81 offset:38912
  v_mfma_f32_16x16x32_bf16 v[40:43], a[60:63], v[32:35], v[40:43]
  s_add_u32 m0, s34, 47616
  s_nop 0
  buffer_load_dwordx4 v1, s[4:7], s35 offen offset:1536 sc1 lds
  v_mfma_f32_16x16x32_bf16 v[48:51], a[188:191], v[32:35], v[48:51]
  v_mfma_f32_16x16x32_bf16 v[52:55], v[28:31], v[188:191], v[52:55]
  v_mfma_f32_16x16x32_bf16 v[56:59], v[32:35], v[188:191], v[56:59]
  s_waitcnt lgkmcnt(4)
  v_mfma_f32_16x16x32_bf16 v[36:39], a[64:67], v[4:7], v[36:39]
  ds_read_b128 v[28:31], v82 offset:36864
  v_mfma_f32_16x16x32_bf16 v[44:47], a[192:195], v[4:7], v[44:47]
  ds_read_b128 v[32:35], v82 offset:38912
  v_mfma_f32_16x16x32_bf16 v[40:43], a[64:67], v[8:11], v[40:43]
  s_add_u32 m0, s34, 51584
  s_nop 0
  buffer_load_dwordx4 v1, s[4:7], s35 offen offset:1664 sc1 lds
  v_mfma_f32_16x16x32_bf16 v[48:51], a[192:195], v[8:11], v[48:51]
  v_mfma_f32_16x16x32_bf16 v[52:55], v[4:7], v[192:195], v[52:55]
  v_mfma_f32_16x16x32_bf16 v[56:59], v[8:11], v[192:195], v[56:59]
  s_waitcnt lgkmcnt(4)
  v_mfma_f32_16x16x32_bf16 v[36:39], a[68:71], v[12:15], v[36:39]
  ds_read_b128 v[4:7], v81 offset:40960
  v_mfma_f32_16x16x32_bf16 v[44:47], a[196:199], v[12:15], v[44:47]
  ds_read_b128 v[8:11], v81 offset:43008
  v_mfma_f32_16x16x32_bf16 v[40:43], a[68:71], v[16:19], v[40:43]
  s_add_u32 m0, s34, 55552
  s_nop 0
  buffer_load_dwordx4 v1, s[4:7], s35 offen offset:1792 sc1 lds
  v_mfma_f32_16x16x32_bf16 v[48:51], a[196:199], v[16:19], v[48:51]
  v_mfma_f32_16x16x32_bf16 v[52:55], v[12:15], v[196:199], v[52:55]
  v_mfma_f32_16x16x32_bf16 v[56:59], v[16:19], v[196:199], v[56:59]
  s_waitcnt lgkmcnt(4)
  v_mfma_f32_16x16x32_bf16 v[36:39], a[72:75], v[20:23], v[36:39]
  ds_read_b128 v[12:15], v82 offset:40960
  v_mfma_f32_16x16x32_bf16 v[44:47], a[200:203], v[20:23], v[44:47]
  ds_read_b128 v[16:19], v82 offset:43008
  v_mfma_f32_16x16x32_bf16 v[40:43], a[72:75], v[24:27], v[40:43]
  s_add_u32 m0, s34, 59520
  s_nop 0
  buffer_load_dwordx4 v1, s[4:7], s35 offen offset:1920 sc1 lds
  v_mfma_f32_16x16x32_bf16 v[48:51], a[200:203], v[24:27], v[48:51]
  v_mfma_f32_16x16x32_bf16 v[52:55], v[20:23], v[200:203], v[52:55]
  v_mfma_f32_16x16x32_bf16 v[56:59], v[24:27], v[200:203], v[56:59]
  s_waitcnt lgkmcnt(4)
  v_mfma_f32_16x16x32_bf16 v[36:39], a[76:79], v[28:31], v[36:39]
  ds_read_b128 v[20:23], v81 offset:45056
  v_mfma_f32_16x16x32_bf16 v[44:47], a[204:207], v[28:31], v[44:47]
  ds_read_b128 v[24:27], v81 offset:47104
  v_mfma_f32_16x16x32_bf16 v[40:43], a[76:79], v[32:35], v[40:43]
  v_mfma_f32_16x16x32_bf16 v[48:51], a[204:207], v[32:35], v[48:51]
  v_mfma_f32_16x16x32_bf16 v[52:55], v[28:31], v[204:207], v[52:55]
  v_mfma_f32_16x16x32_bf16 v[56:59], v[32:35], v[204:207], v[56:59]
  s_waitcnt lgkmcnt(4)
  v_mfma_f32_16x16x32_bf16 v[36:39], a[80:83], v[4:7], v[36:39]
  ds_read_b128 v[28:31], v82 offset:45056
  v_mfma_f32_16x16x32_bf16 v[44:47], a[208:211], v[4:7], v[44:47]
  ds_read_b128 v[32:35], v82 offset:47104
  v_mfma_f32_16x16x32_bf16 v[40:43], a[80:83], v[8:11], v[40:43]
  s_add_u32 s30, s25, 2
  s_and_b32 s30, s30, 56
  s_lshl_b32 s30, s30, 7
  buffer_load_dword v3, v2, s[4:7], s30 offen sc1
  v_mfma_f32_16x16x32_bf16 v[48:51], a[208:211], v[8:11], v[48:51]
  v_mfma_f32_16x16x32_bf16 v[52:55], v[4:7], v[208:211], v[52:55]
  v_mfma_f32_16x16x32_bf16 v[56:59], v[8:11], v[208:211], v[56:59]
  s_waitcnt lgkmcnt(4)
  v_mfma_f32_16x16x32_bf16 v[36:39], a[84:87], v[12:15], v[36:39]
  ds_read_b128 v[4:7], v81 offset:49152
  v_mfma_f32_16x16x32_bf16 v[44:47], a[212:215], v[12:15], v[44:47]
  ds_read_b128 v[8:11], v81 offset:51200
  v_mfma_f32_16x16x32_bf16 v[40:43], a[84:87], v[16:19], v[40:43]
  v_mfma_f32_16x16x32_bf16 v[48:51], a[212:215], v[16:19], v[48:51]
  v_mfma_f32_16x16x32_bf16 v[52:55], v[12:15], v[212:215], v[52:55]
  v_mfma_f32_16x16x32_bf16 v[56:59], v[16:19], v[212:215], v[56:59]
  s_waitcnt lgkmcnt(4)
  v_mfma_f32_16x16x32_bf16 v[36:39], a[88:91], v[20:23], v[36:39]
  ds_read_b128 v[12:15], v82 offset:49152
  v_mfma_f32_16x16x32_bf16 v[44:47], a[216:219], v[20:23], v[44:47]
  ds_read_b128 v[16:19], v82 offset:51200
  v_mfma_f32_16x16x32_bf16 v[40:43], a[88:91], v[24:27], v[40:43]
  v_mfma_f32_16x16x32_bf16 v[48:51], a[216:219], v[24:27], v[48:51]
  v_mfma_f32_16x16x32_bf16 v[52:55], v[20:23], v[216:219], v[52:55]
  v_mfma_f32_16x16x32_bf16 v[56:59], v[24:27], v[216:219], v[56:59]
  s_waitcnt lgkmcnt(4)
  v_mfma_f32_16x16x32_bf16 v[36:39], a[92:95], v[28:31], v[36:39]
  ds_read_b128 v[20:23], v81 offset:53248
  v_mfma_f32_16x16x32_bf16 v[44:47], a[220:223], v[28:31], v[44:47]
  ds_read_b128 v[24:27], v81 offset:55296
  v_mfma_f32_16x16x32_bf16 v[40:43], a[92:95], v[32:35], v[40:43]
  v_mfma_f32_16x16x32_bf16 v[48:51], a[220:223], v[32:35], v[48:51]
  v_mfma_f32_16x16x32_bf16 v[52:55], v[28:31], v[220:223], v[52:55]
  v_mfma_f32_16x16x32_bf16 v[56:59], v[32:35], v[220:223], v[56:59]
  s_waitcnt lgkmcnt(4)
  v_mfma_f32_16x16x32_bf16 v[36:39], a[96:99], v[4:7], v[36:39]
  ds_read_b128 v[28:31], v82 offset:53248
  v_mfma_f32_16x16x32_bf16 v[44:47], a[224:227], v[4:7], v[44:47]
  ds_read_b128 v[32:35], v82 offset:55296
  v_mfma_f32_16x16x32_bf16 v[40:43], a[96:99], v[8:11], v[40:43]
  v_mfma_f32_16x16x32_bf16 v[48:51], a[224:227], v[8:11], v[48:51]
  v_mfma_f32_16x16x32_bf16 v[52:55], v[4:7], v[224:227], v[52:55]
  v_mfma_f32_16x16x32_bf16 v[56:59], v[8:11], v[224:227], v[56:59]
  s_waitcnt lgkmcnt(4)
  v_mfma_f32_16x16x32_bf16 v[36:39], a[100:103], v[12:15], v[36:39]
  ds_read_b128 v[4:7], v81 offset:57344
  v_mfma_f32_16x16x32_bf16 v[44:47], a[228:231], v[12:15], v[44:47]
  ds_read_b128 v[8:11], v81 offset:59392
  v_mfma_f32_16x16x32_bf16 v[40:43], a[100:103], v[16:19], v[40:43]
  v_mfma_f32_16x16x32_bf16 v[48:51], a[228:231], v[16:19], v[48:51]
  v_mfma_f32_16x16x32_bf16 v[52:55], v[12:15], v[228:231], v[52:55]
  v_mfma_f32_16x16x32_bf16 v[56:59], v[16:19], v[228:231], v[56:59]
  s_waitcnt lgkmcnt(4)
  v_mfma_f32_16x16x32_bf16 v[36:39], a[104:107], v[20:23], v[36:39]
  ds_read_b128 v[12:15], v82 offset:57344
  v_mfma_f32_16x16x32_bf16 v[44:47], a[232:235], v[20:23], v[44:47]
  ds_read_b128 v[16:19], v82 offset:59392
  v_mfma_f32_16x16x32_bf16 v[40:43], a[104:107], v[24:27], v[40:43]
  v_mfma_f32_16x16x32_bf16 v[48:51], a[232:235], v[24:27], v[48:51]
  v_mfma_f32_16x16x32_bf16 v[52:55], v[20:23], v[232:235], v[52:55]
  v_mfma_f32_16x16x32_bf16 v[56:59], v[24:27], v[232:235], v[56:59]
  s_waitcnt lgkmcnt(4)
  v_mfma_f32_16x16x32_bf16 v[36:39], a[108:111], v[28:31], v[36:39]
  ds_read_b128 v[20:23], v81 offset:61440
  v_mfma_f32_16x16x32_bf16 v[44:47], a[236:239], v[28:31], v[44:47]
  ds_read_b128 v[24:27], v81 offset:63488
  v_mfma_f32_16x16x32_bf16 v[40:43], a[108:111], v[32:35], v[40:43]
  v_mfma_f32_16x16x32_bf16 v[48:51], a[236:239], v[32:35], v[48:51]
  v_mfma_f32_16x16x32_bf16 v[52:55], v[28:31], v[236:239], v[52:55]
  v_mfma_f32_16x16x32_bf16 v[56:59], v[32:35], v[236:239], v[56:59]
  s_waitcnt lgkmcnt(4)
  v_mfma_f32_16x16x32_bf16 v[36:39], a[112:115], v[4:7], v[36:39]
  ds_read_b128 v[28:31], v82 offset:61440
  v_mfma_f32_16x16x32_bf16 v[44:47], a[240:243], v[4:7], v[44:47]
  ds_read_b128 v[32:35], v82 offset:63488
  v_mfma_f32_16x16x32_bf16 v[40:43], a[112:115], v[8:11], v[40:43]
  v_mfma_f32_16x16x32_bf16 v[48:51], a[240:243], v[8:11], v[48:51]
  v_mfma_f32_16x16x32_bf16 v[52:55], v[4:7], v[240:243], v[52:55]
  v_mfma_f32_16x16x32_bf16 v[56:59], v[8:11], v[240:243], v[56:59]
  s_waitcnt vmcnt(0)
  s_barrier
  v_xor_b32 v81, 0x10000, v81
  v_xor_b32 v82, 0x10000, v82
  s_waitcnt lgkmcnt(4)
  v_mfma_f32_16x16x32_bf16 v[36:39], a[116:119], v[12:15], v[36:39]
  ds_read_b128 v[4:7], v81 offset:0
  v_mfma_f32_16x16x32_bf16 v[44:47], a[244:247], v[12:15], v[44:47]
  ds_read_b128 v[8:11], v81 offset:2048
  v_mfma_f32_16x16x32_bf16 v[40:43], a[116:119], v[16:19], v[40:43]
  v_mfma_f32_16x16x32_bf16 v[48:51], a[244:247], v[16:19], v[48:51]
  v_mfma_f32_16x16x32_bf16 v[52:55], v[12:15], v[244:247], v[52:55]
  v_mfma_f32_16x16x32_bf16 v[56:59], v[16:19], v[244:247], v[56:59]
  s_waitcnt lgkmcnt(4)
  v_mfma_f32_16x16x32_bf16 v[36:39], a[120:123], v[20:23], v[36:39]
  ds_read_b128 v[12:15], v82 offset:0
  v_mfma_f32_16x16x32_bf16 v[44:47], a[248:251], v[20:23], v[44:47]
  ds_read_b128 v[16:19], v82 offset:2048
  v_mfma_f32_16x16x32_bf16 v[40:43], a[120:123], v[24:27], v[40:43]
  v_mfma_f32_16x16x32_bf16 v[48:51], a[248:251], v[24:27], v[48:51]
  v_mfma_f32_16x16x32_bf16 v[52:55], v[20:23], v[248:251], v[52:55]
  v_mfma_f32_16x16x32_bf16 v[56:59], v[24:27], v[248:251], v[56:59]
  s_waitcnt lgkmcnt(4)
  v_mfma_f32_16x16x32_bf16 v[36:39], a[124:127], v[28:31], v[36:39]
  ds_read_b128 v[20:23], v81 offset:4096
  v_mfma_f32_16x16x32_bf16 v[44:47], a[252:255], v[28:31], v[44:47]
  ds_read_b128 v[24:27], v81 offset:6144
  v_mfma_f32_16x16x32_bf16 v[40:43], a[124:127], v[32:35], v[40:43]
  v_mfma_f32_16x16x32_bf16 v[48:51], a[252:255], v[32:35], v[48:51]
  v_mfma_f32_16x16x32_bf16 v[52:55], v[28:31], v[252:255], v[52:55]
  v_mfma_f32_16x16x32_bf16 v[56:59], v[32:35], v[252:255], v[56:59]
  s_mov_b32 s37, s31
  s_add_u32 s31, s31, 2097152
  s_xor_b32 s31, s31, 0x2000
  s_add_u32 s25, s25, 1
  s_cmp_lt_u32 s25, 64
  s_cbranch_scc1 L_QKV_top
  v_cvt_pk_bf16_f32 v60, v36, v37
  v_cvt_pk_bf16_f32 v61, v38, v39
  v_cvt_pk_bf16_f32 v62, v44, v45
  v_cvt_pk_bf16_f32 v63, v46, v47
  v_cvt_pk_bf16_f32 v64, v40, v41
  v_cvt_pk_bf16_f32 v65, v42, v43
  v_cvt_pk_bf16_f32 v66, v48, v49
  v_cvt_pk_bf16_f32 v67, v50, v51
  v_cvt_pk_bf16_f32 v68, v52, v53
  v_cvt_pk_bf16_f32 v69, v54, v55
  v_cvt_pk_bf16_f32 v70, v56, v57
  v_cvt_pk_bf16_f32 v71, v58, v59
  buffer_store_dwordx4 v[60:63], v76, s[4:7], s37 offen offset:0 sc1
  buffer_store_dwordx4 v[64:67], v76, s[4:7], s37 offen offset:1024 sc1
  buffer_store_dwordx4 v[68:71], v83, s[4:7], s37 offen sc1
  s_waitcnt vmcnt(0) lgkmcnt(0)
  s_barrier
  s_cmp_lg_u32 s20, 0
  s_cbranch_scc1 Lnosig_29
  s_mov_b32 s63, s25
  s_atomic_smax s63, s[4:5], s62 glc
Lnosig_29:
  s_branch L_END
L_WO:
  s_load_dwordx2 s[8:9], s[0:1], 40
  s_mov_b32 s10, 8388608
  s_mov_b32 s11, 0x20000
  s_waitcnt lgkmcnt(0)
  s_lshr_b32 s44, s21, 3
  s_mul_i32 s44, s44, 2097152
  s_and_b32 s45, s21, 7
  s_lshl_b32 s45, s45, 8
  s_add_u32 s44, s44, s45
  s_add_u32 s45, s44, 128
  v_bfe_u32 v40, v0, 5, 1
  v_mul_u32_u24 v40, 8192, v40
  v_bfe_u32 v41, v0, 4, 1
  v_mul_u32_u24 v41, 4096, v41
  v_add_u32 v40, v40, v41
  v_bfe_u32 v41, v0, 3, 1
  v_mul_u32_u24 v41, 2048, v41
  v_add_u32 v40, v40, v41
  v_lshrrev_b32 v41, 3, v0
  v_and_b32 v41, 6, v41
  v_xor_b32 v41, v41, v0
  v_and_b32 v41, 7, v41
  v_lshl_add_u32 v40, v41, 4, v40
  s_lshr_b32 s40, s20, 1
  s_mul_i32 s40, s40, 131072
  s_and_b32 s41, s20, 1
  s_mul_i32 s41, s41, 16384
  s_add_u32 s40, s40, s41
  v_add_u32 v40, s40, v40
  v_bfe_u32 v41, v0, 3, 2
  v_xor_b32 v41, s20, v41
  v_lshlrev_b32 v41, 5, v41
  v_lshrrev_b32 v42, 2, v0
  v_lshl_add_u32 v42, v42, 7, v41
  v_and_b32 v41, 3, v0
  v_lshl_add_u32 v42, v41, 3, v42
  v_add_u32 v43, 0x10000, v42
  v_add_u32 v44, s44, v40
  v_add_u32 v45, s45, v40
  s_lshl_b32 s41, s20, 10
  s_add_u32 m0, s41, 0
  s_mov_b32 s42, 0
  buffer_load_dwordx4 v44, s[8:11], s42 offen nt lds
  s_add_u32 m0, s41, 4096
  s_mov_b32 s42, 0
  buffer_load_dwordx4 v45, s[8:11], s42 offen nt lds
  s_add_u32 m0, s41, 8192
  s_mov_b32 s42, 32768
  buffer_load_dwordx4 v44, s[8:11], s42 offen nt lds
  s_add_u32 m0, s41, 12288
  s_mov_b32 s42, 32768
  buffer_load_dwordx4 v45, s[8:11], s42 offen nt lds
  s_add_u32 m0, s41, 16384
  s_mov_b32 s42, 65536
  buffer_load_dwordx4 v44, s[8:11], s42 offen nt lds
  s_add_u32 m0, s41, 20480
  s_mov_b32 s42, 65536
  buffer_load_dwordx4 v45, s[8:11], s42 offen nt lds
  s_add_u32 m0, s41, 24576
  s_mov_b32 s42, 98304
  buffer_load_dwordx4 v44, s[8:11], s42 offen nt lds
  s_add_u32 m0, s41, 28672
  s_mov_b32 s42, 98304
  buffer_load_dwordx4 v45, s[8:11], s42 offen nt lds
  s_add_u32 m0, s41, 32768
  s_mov_b32 s42, 262144
  buffer_load_dwordx4 v44, s[8:11], s42 offen nt lds
  s_add_u32 m0, s41, 36864
  s_mov_b32 s42, 262144
  buffer_load_dwordx4 v45, s[8:11], s42 offen nt lds
  s_add_u32 m0, s41, 40960
  s_mov_b32 s42, 294912
  buffer_load_dwordx4 v44, s[8:11], s42 offen nt lds
  s_add_u32 m0, s41, 45056
  s_mov_b32 s42, 294912
  buffer_load_dwordx4 v45, s[8:11], s42 offen nt lds
  s_add_u32 m0, s41, 49152
  s_mov_b32 s42, 327680
  buffer_load_dwordx4 v44, s[8:11], s42 offen nt lds
  s_add_u32 m0, s41, 53248
  s_mov_b32 s42, 327680
  buffer_load_dwordx4 v45, s[8:11], s42 offen nt lds
  s_add_u32 m0, s41, 57344
  s_mov_b32 s42, 360448
  buffer_load_dwordx4 v44, s[8:11], s42 offen nt lds
  s_add_u32 m0, s41, 61440
  s_mov_b32 s42, 360448
  buffer_load_dwordx4 v45, s[8:11], s42 offen nt lds
  s_add_u32 m0, s41, 65536
  s_mov_b32 s42, 524288
  buffer_load_dwordx4 v44, s[8:11], s42 offen nt lds
  s_add_u32 m0, s41, 69632
  s_mov_b32 s42, 524288
  buffer_load_dwordx4 v45, s[8:11], s42 offen nt lds
  s_add_u32 m0, s41, 73728
  s_mov_b32 s42, 557056
  buffer_load_dwordx4 v44, s[8:11], s42 offen nt lds
  s_add_u32 m0, s41, 77824
  s_mov_b32 s42, 557056
  buffer_load_dwordx4 v45, s[8:11], s42 offen nt lds
  s_add_u32 m0, s41, 81920
  s_mov_b32 s42, 589824
  buffer_load_dwordx4 v44, s[8:11], s42 offen nt lds
  s_add_u32 m0, s41, 86016
  s_mov_b32 s42, 589824
  buffer_load_dwordx4 v45, s[8:11], s42 offen nt lds
  s_add_u32 m0, s41, 90112
  s_mov_b32 s42, 622592
  buffer_load_dwordx4 v44, s[8:11], s42 offen nt lds
  s_add_u32 m0, s41, 94208
  s_mov_b32 s42, 622592
  buffer_load_dwordx4 v45, s[8:11], s42 offen nt lds
  s_add_u32 m0, s41, 98304
  s_mov_b32 s42, 786432
  buffer_load_dwordx4 v44, s[8:11], s42 offen nt lds
  s_add_u32 m0, s41, 102400
  s_mov_b32 s42, 786432
  buffer_load_dwordx4 v45, s[8:11], s42 offen nt lds
  s_add_u32 m0, s41, 106496
  s_mov_b32 s42, 819200
  buffer_load_dwordx4 v44, s[8:11], s42 offen nt lds
  s_add_u32 m0, s41, 110592
  s_mov_b32 s42, 819200
  buffer_load_dwordx4 v45, s[8:11], s42 offen nt lds
  s_waitcnt vmcnt(24) lgkmcnt(0)
  s_barrier
  s_add_u32 m0, s41, 114688
  s_mov_b32 s42, 851968
  buffer_load_dwordx4 v44, s[8:11], s42 offen nt lds
  s_add_u32 m0, s41, 118784
  s_mov_b32 s42, 851968
  buffer_load_dwordx4 v45, s[8:11], s42 offen nt lds
  s_add_u32 m0, s41, 122880
  s_mov_b32 s42, 884736
  buffer_load_dwordx4 v44, s[8:11], s42 offen nt lds
  s_add_u32 m0, s41, 126976
  s_mov_b32 s42, 884736
  buffer_load_dwordx4 v45, s[8:11], s42 offen nt lds
  ds_read_b64_tr_b16 a[0:1], v42 offset:0
  ds_read_b64_tr_b16 a[2:3], v42 offset:2048
  ds_read_b64_tr_b16 a[128:129], v42 offset:4096
  ds_read_b64_tr_b16 a[130:131], v42 offset:6144
  ds_read_b64_tr_b16 a[4:5], v42 offset:8192
  ds_read_b64_tr_b16 a[6:7], v42 offset:10240
  ds_read_b64_tr_b16 a[132:133], v42 offset:12288
  ds_read_b64_tr_b16 a[134:135], v42 offset:14336
  s_waitcnt vmcnt(24) lgkmcnt(0)
  s_barrier
  s_add_u32 m0, s41, 0
  s_mov_b32 s42, 1048576
  buffer_load_dwordx4 v44, s[8:11], s42 offen nt lds
  s_add_u32 m0, s41, 4096
  s_mov_b32 s42, 1048576
  buffer_load_dwordx4 v45, s[8:11], s42 offen nt lds
  s_add_u32 m0, s41, 8192
  s_mov_b32 s42, 1081344
  buffer_load_dwordx4 v44, s[8:11], s42 offen nt lds
  s_add_u32 m0, s41, 12288
  s_mov_b32 s42, 1081344
  buffer_load_dwordx4 v45, s[8:11], s42 offen nt lds
  ds_read_b64_tr_b16 a[8:9], v42 offset:16384
  ds_read_b64_tr_b16 a[10:11], v42 offset:18432
  ds_read_b64_tr_b16 a[136:137], v42 offset:20480
  ds_read_b64_tr_b16 a[138:139], v42 offset:22528
  ds_read_b64_tr_b16 a[12:13], v42 offset:24576
  ds_read_b64_tr_b16 a[14:15], v42 offset:26624
  ds_read_b64_tr_b16 a[140:141], v42 offset:28672
  ds_read_b64_tr_b16 a[142:143], v42 offset:30720
  s_waitcnt vmcnt(24) lgkmcnt(0)
  s_barrier
  s_add_u32 m0, s41, 16384
  s_mov_b32 s42, 1114112
  buffer_load_dwordx4 v44, s[8:11], s42 offen nt lds
  s_add_u32 m0, s41, 20480
  s_mov_b32 s42, 1114112
  buffer_load_dwordx4 v45, s[8:11], s42 offen nt lds
  s_add_u32 m0, s41, 24576
  s_mov_b32 s42, 1146880
  buffer_load_dwordx4 v44, s[8:11], s42 offen nt lds
  s_add_u32 m0, s41, 28672
  s_mov_b32 s42, 1146880
  buffer_load_dwordx4 v45, s[8:11], s42 offen nt lds
  ds_read_b64_tr_b16 a[16:17], v42 offset:32768
  ds_read_b64_tr_b16 a[18:19], v42 offset:34816
  ds_read_b64_tr_b16 a[144:145], v42 offset:36864
  ds_read_b64_tr_b16 a[146:147], v42 offset:38912
  ds_read_b64_tr_b16 a[20:21], v42 offset:40960
  ds_read_b64_tr_b16 a[22:23], v42 offset:43008
  ds_read_b64_tr_b16 a[148:149], v42 offset:45056
  ds_read_b64_tr_b16 a[150:151], v42 offset:47104
  s_waitcnt vmcnt(24) lgkmcnt(0)
  s_barrier
  s_add_u32 m0, s41, 32768
  s_mov_b32 s42, 1310720
  buffer_load_dwordx4 v44, s[8:11], s42 offen nt lds
  s_add_u32 m0, s41, 36864
  s_mov_b32 s42, 1310720
  buffer_load_dwordx4 v45, s[8:11], s42 offen nt lds
  s_add_u32 m0, s41, 40960
  s_mov_b32 s42, 1343488
  buffer_load_dwordx4 v44, s[8:11], s42 offen nt lds
  s_add_u32 m0, s41, 45056
  s_mov_b32 s42, 1343488
  buffer_load_dwordx4 v45, s[8:11], s42 offen nt lds
  ds_read_b64_tr_b16 a[24:25], v42 offset:49152
  ds_read_b64_tr_b16 a[26:27], v42 offset:51200
  ds_read_b64_tr_b16 a[152:153], v42 offset:53248
  ds_read_b64_tr_b16 a[154:155], v42 offset:55296
  ds_read_b64_tr_b16 a[28:29], v42 offset:57344
  ds_read_b64_tr_b16 a[30:31], v42 offset:59392
  ds_read_b64_tr_b16 a[156:157], v42 offset:61440
  ds_read_b64_tr_b16 a[158:159], v42 offset:63488
  s_waitcnt vmcnt(24) lgkmcnt(0)
  s_barrier
  s_add_u32 m0, s41, 49152
  s_mov_b32 s42, 1376256
  buffer_load_dwordx4 v44, s[8:11], s42 offen nt lds
  s_add_u32 m0, s41, 53248
  s_mov_b32 s42, 1376256
  buffer_load_dwordx4 v45, s[8:11], s42 offen nt lds
  s_add_u32 m0, s41, 57344
  s_mov_b32 s42, 1409024
  buffer_load_dwordx4 v44, s[8:11], s42 offen nt lds
  s_add_u32 m0, s41, 61440
  s_mov_b32 s42, 1409024
  buffer_load_dwordx4 v45, s[8:11], s42 offen nt lds
  ds_read_b64_tr_b16 a[32:33], v43 offset:0
  ds_read_b64_tr_b16 a[34:35], v43 offset:2048
  ds_read_b64_tr_b16 a[160:161], v43 offset:4096
  ds_read_b64_tr_b16 a[162:163], v43 offset:6144
  ds_read_b64_tr_b16 a[36:37], v43 offset:8192
  ds_read_b64_tr_b16 a[38:39], v43 offset:10240
  ds_read_b64_tr_b16 a[164:165], v43 offset:12288
  ds_read_b64_tr_b16 a[166:167], v43 offset:14336
  s_waitcnt vmcnt(24) lgkmcnt(0)
  s_barrier
  s_add_u32 m0, s41, 65536
  s_mov_b32 s42, 1572864
  buffer_load_dwordx4 v44, s[8:11], s42 offen nt lds
  s_add_u32 m0, s41, 69632
  s_mov_b32 s42, 1572864
  buffer_load_dwordx4 v45, s[8:11], s42 offen nt lds
  s_add_u32 m0, s41, 73728
  s_mov_b32 s42, 1605632
  buffer_load_dwordx4 v44, s[8:11], s42 offen nt lds
  s_add_u32 m0, s41, 77824
  s_mov_b32 s42, 1605632
  buffer_load_dwordx4 v45, s[8:11], s42 offen nt lds
  ds_read_b64_tr_b16 a[40:41], v43 offset:16384
  ds_read_b64_tr_b16 a[42:43], v43 offset:18432
  ds_read_b64_tr_b16 a[168:169], v43 offset:20480
  ds_read_b64_tr_b16 a[170:171], v43 offset:22528
  ds_read_b64_tr_b16 a[44:45], v43 offset:24576
  ds_read_b64_tr_b16 a[46:47], v43 offset:26624
  ds_read_b64_tr_b16 a[172:173], v43 offset:28672
  ds_read_b64_tr_b16 a[174:175], v43 offset:30720
  s_waitcnt vmcnt(24) lgkmcnt(0)
  s_barrier
  s_add_u32 m0, s41, 81920
  s_mov_b32 s42, 1638400
  buffer_load_dwordx4 v44, s[8:11], s42 offen nt lds
  s_add_u32 m0, s41, 86016
  s_mov_b32 s42, 1638400
  buffer_load_dwordx4 v45, s[8:11], s42 offen nt lds
  s_add_u32 m0, s41, 90112
  s_mov_b32 s42, 1671168
  buffer_load_dwordx4 v44, s[8:11], s42 offen nt lds
  s_add_u32 m0, s41, 94208
  s_mov_b32 s42, 1671168
  buffer_load_dwordx4 v45, s[8:11], s42 offen nt lds
  ds_read_b64_tr_b16 a[48:49], v43 offset:32768
  ds_read_b64_tr_b16 a[50:51], v43 offset:34816
  ds_read_b64_tr_b16 a[176:177], v43 offset:36864
  ds_read_b64_tr_b16 a[178:179], v43 offset:38912
  ds_read_b64_tr_b16 a[52:53], v43 offset:40960
  ds_read_b64_tr_b16 a[54:55], v43 offset:43008
  ds_read_b64_tr_b16 a[180:181], v43 offset:45056
  ds_read_b64_tr_b16 a[182:183], v43 offset:47104
  s_waitcnt vmcnt(24) lgkmcnt(0)
  s_barrier
  s_add_u32 m0, s41, 98304
  s_mov_b32 s42, 1835008
  buffer_load_dwordx4 v44, s[8:11], s42 offen nt lds
  s_add_u32 m0, s41, 102400
  s_mov_b32 s42, 1835008
  buffer_load_dwordx4 v45, s[8:11], s42 offen nt lds
  s_add_u32 m0, s41, 106496
  s_mov_b32 s42, 1867776
  buffer_load_dwordx4 v44, s[8:11], s42 offen nt lds
  s_add_u32 m0, s41, 110592
  s_mov_b32 s42, 1867776
  buffer_load_dwordx4 v45, s[8:11], s42 offen nt lds
  ds_read_b64_tr_b16 a[56:57], v43 offset:49152
  ds_read_b64_tr_b16 a[58:59], v43 offset:51200
  ds_read_b64_tr_b16 a[184:185], v43 offset:53248
  ds_read_b64_tr_b16 a[186:187], v43 offset:55296
  ds_read_b64_tr_b16 a[60:61], v43 offset:57344
  ds_read_b64_tr_b16 a[62:63], v43 offset:59392
  ds_read_b64_tr_b16 a[188:189], v43 offset:61440
  ds_read_b64_tr_b16 a[190:191], v43 offset:63488
  s_waitcnt vmcnt(24) lgkmcnt(0)
  s_barrier
  s_add_u32 m0, s41, 114688
  s_mov_b32 s42, 1900544
  buffer_load_dwordx4 v44, s[8:11], s42 offen nt lds
  s_add_u32 m0, s41, 118784
  s_mov_b32 s42, 1900544
  buffer_load_dwordx4 v45, s[8:11], s42 offen nt lds
  s_add_u32 m0, s41, 122880
  s_mov_b32 s42, 1933312
  buffer_load_dwordx4 v44, s[8:11], s42 offen nt lds
  s_add_u32 m0, s41, 126976
  s_mov_b32 s42, 1933312
  buffer_load_dwordx4 v45, s[8:11], s42 offen nt lds
  ds_read_b64_tr_b16 a[64:65], v42 offset:0
  ds_read_b64_tr_b16 a[66:67], v42 offset:2048
  ds_read_b64_tr_b16 a[192:193], v42 offset:4096
  ds_read_b64_tr_b16 a[194:195], v42 offset:6144
  ds_read_b64_tr_b16 a[68:69], v42 offset:8192
  ds_read_b64_tr_b16 a[70:71], v42 offset:10240
  ds_read_b64_tr_b16 a[196:197], v42 offset:12288
  ds_read_b64_tr_b16 a[198:199], v42 offset:14336
  s_waitcnt vmcnt(24) lgkmcnt(0)
  s_barrier
  ds_read_b64_tr_b16 a[72:73], v42 offset:16384
  ds_read_b64_tr_b16 a[74:75], v42 offset:18432
  ds_read_b64_tr_b16 a[200:201], v42 offset:20480
  ds_read_b64_tr_b16 a[202:203], v42 offset:22528
  ds_read_b64_tr_b16 a[76:77], v42 offset:24576
  ds_read_b64_tr_b16 a[78:79], v42 offset:26624
  ds_read_b64_tr_b16 a[204:205], v42 offset:28672
  ds_read_b64_tr_b16 a[206:207], v42 offset:30720
  s_waitcnt vmcnt(20) lgkmcnt(0)
  s_barrier
  ds_read_b64_tr_b16 a[80:81], v42 offset:32768
  ds_read_b64_tr_b16 a[82:83], v42 offset:34816
  ds_read_b64_tr_b16 a[208:209], v42 offset:36864
  ds_read_b64_tr_b16 a[210:211], v42 offset:38912
  ds_read_b64_tr_b16 a[84:85], v42 offset:40960
  ds_read_b64_tr_b16 a[86:87], v42 offset:43008
  ds_read_b64_tr_b16 a[212:213], v42 offset:45056
  ds_read_b64_tr_b16 a[214:215], v42 offset:47104
  s_waitcnt vmcnt(16) lgkmcnt(0)
  s_barrier
  ds_read_b64_tr_b16 a[88:89], v42 offset:49152
  ds_read_b64_tr_b16 a[90:91], v42 offset:51200
  ds_read_b64_tr_b16 a[216:217], v42 offset:53248
  ds_read_b64_tr_b16 a[218:219], v42 offset:55296
  ds_read_b64_tr_b16 a[92:93], v42 offset:57344
  ds_read_b64_tr_b16 a[94:95], v42 offset:59392
  ds_read_b64_tr_b16 a[220:221], v42 offset:61440
  ds_read_b64_tr_b16 a[222:223], v42 offset:63488
  s_waitcnt vmcnt(12) lgkmcnt(0)
  s_barrier
  ds_read_b64_tr_b16 a[96:97], v43 offset:0
  ds_read_b64_tr_b16 a[98:99], v43 offset:2048
  ds_read_b64_tr_b16 a[224:225], v43 offset:4096
  ds_read_b64_tr_b16 a[226:227], v43 offset:6144
  ds_read_b64_tr_b16 a[100:101], v43 offset:8192
  ds_read_b64_tr_b16 a[102:103], v43 offset:10240
  ds_read_b64_tr_b16 a[228:229], v43 offset:12288
  ds_read_b64_tr_b16 a[230:231], v43 offset:14336
  s_waitcnt vmcnt(8) lgkmcnt(0)
  s_barrier
  ds_read_b64_tr_b16 a[104:105], v43 offset:16384
  ds_read_b64_tr_b16 a[106:107], v43 offset:18432
  ds_read_b64_tr_b16 a[232:233], v43 offset:20480
  ds_read_b64_tr_b16 a[234:235], v43 offset:22528
  ds_read_b64_tr_b16 a[108:109], v43 offset:24576
  ds_read_b64_tr_b16 a[110:111], v43 offset:26624
  ds_read_b64_tr_b16 a[236:237], v43 offset:28672
  ds_read_b64_tr_b16 a[238:239], v43 offset:30720
  s_waitcnt vmcnt(4) lgkmcnt(0)
  s_barrier
  ds_read_b64_tr_b16 a[112:113], v43 offset:32768
  ds_read_b64_tr_b16 a[114:115], v43 offset:34816
  ds_read_b64_tr_b16 a[240:241], v43 offset:36864
  ds_read_b64_tr_b16 a[242:243], v43 offset:38912
  ds_read_b64_tr_b16 a[116:117], v43 offset:40960
  ds_read_b64_tr_b16 a[118:119], v43 offset:43008
  ds_read_b64_tr_b16 a[244:245], v43 offset:45056
  ds_read_b64_tr_b16 a[246:247], v43 offset:47104
  s_waitcnt vmcnt(0) lgkmcnt(0)
  s_barrier
  ds_read_b64_tr_b16 a[120:121], v43 offset:49152
  ds_read_b64_tr_b16 a[122:123], v43 offset:51200
  ds_read_b64_tr_b16 a[248:249], v43 offset:53248
  ds_read_b64_tr_b16 a[250:251], v43 offset:55296
  ds_read_b64_tr_b16 a[124:125], v43 offset:57344
  ds_read_b64_tr_b16 a[126:127], v43 offset:59392
  ds_read_b64_tr_b16 a[252:253], v43 offset:61440
  ds_read_b64_tr_b16 a[254:255], v43 offset:63488
  s_waitcnt lgkmcnt(0)
  s_barrier
  s_and_b32 s43, s21, 24
  v_min_u32 v2, 7, v0
  v_add_u32 v2, s43, v2
  v_lshlrev_b32 v2, 7, v2
  v_add_u32 v2, 1404928, v2
  s_lshl_b32 s62, s21, 7
  s_add_u32 s62, s62, 1409024
  v_min_u32 v52, 63, v0
  v_lshlrev_b32 v52, 7, v52
  v_add_u32 v52, 1424384, v52
  s_nop 1
Lpoll_30:
  buffer_load_dword v53, v52, s[4:7], 0 offen sc1
  s_sub_u32 s24, s24, 1
  s_cbranch_scc1 L_FAIL
  s_waitcnt vmcnt(0)
  v_cmp_gt_i32 vcc, 0, v53
  s_cbranch_vccz Lpolld_31
  s_sleep 1
  s_branch Lpoll_30
Lpolld_31:
  v_lshrrev_b32 v53, 8, v53
  v_and_b32 v54, 3, v0
  v_lshl_or_b32 v53, v53, 2, v54
  s_nop 1
  v_min_u32_dpp v53, v53, v53 row_ror:8 row_mask:0xf bank_mask:0xf
  s_nop 1
  v_min_u32_dpp v53, v53, v53 row_ror:4 row_mask:0xf bank_mask:0xf
  v_mov_b32 v54, v53
  s_nop 1
  v_permlane16_swap_b32 v54, v53
  v_min_u32 v53, v53, v54
  v_mov_b32 v54, v53
  s_nop 1
  v_permlane32_swap_b32 v54, v53
  v_min_u32 v53, v53, v54
  s_nop 1
  v_min_u32_dpp v53, v53, v53 row_ror:2 row_mask:0xf bank_mask:0xf
  s_nop 1
  v_min_u32_dpp v53, v53, v53 row_ror:1 row_mask:0xf bank_mask:0xf
  s_nop 0
  v_readfirstlane_b32 s27, v53
  s_and_b32 s27, s27, 3
  s_lshl_b32 s27, s27, 13
  s_and_b32 s27, s27, 0x2000
  s_xor_b32 s27, s27, 67108864
  s_lshr_b32 s40, s20, 1
  s_add_u32 s40, s40, s43
  s_mul_i32 s40, s40, 65536
  s_and_b32 s41, s20, 1
  s_lshl_b32 s41, s41, 12
  s_add_u32 s40, s40, s41
  s_add_u32 s40, s40, 49152
  s_add_u32 s27, s27, s40
  s_lshl_b32 s40, s21, 13
  s_add_u32 s31, s40, 37748736
  s_lshl_b32 s40, s20, 11
  v_and_b32 v68, 3, v0
  v_lshlrev_b32 v68, 4, v68
  v_lshrrev_b32 v52, 4, v0
  v_lshl_add_u32 v68, v52, 6, v68
  v_bfe_u32 v52, v0, 2, 2
  v_lshl_add_u32 v68, v52, 8, v68
  v_add_u32 v68, s40, v68
  v_lshlrev_b32 v1, 4, v0
  s_lshl_b32 s32, s20, 12
  s_mul_i32 s33, s20, 3072
  v_mov_b32 v69, v1
  v_add_u32 v70, 0x10000, v69
  v_lshlrev_b32 v71, 2, v0
  v_add_u32 v71, 131072, v71
  s_mov_b32 s25, 0
  s_mov_b32 s26, 0
  s_mov_b32 s29, 1
  s_mov_b32 s30, 0
  s_mov_b32 s28, 0
L_WO_top:
  s_cmp_lg_u32 s28, 0
  s_cbranch_scc1 L_WO_go
  s_cmp_lg_u32 s20, 0
  s_cbranch_scc1 L_WO_park
  buffer_load_dword v3, v2, s[4:7], s30 offen sc1
  s_waitcnt vmcnt(1)
  s_barrier
  s_mov_b32 s63, s25
  s_atomic_smax s63, s[4:5], s62 glc
Lnosig_32:
  s_cmp_ge_u32 s25, 64
  s_cbranch_scc1 L_END
  s_waitcnt vmcnt(0)
  v_cmp_gt_i32 vcc, s29, v3
  s_cbranch_vccz L_WO_issue
  s_nop 3
Lpoll_33:
  buffer_load_dword v3, v2, s[4:7], s30 offen sc1
  s_sub_u32 s24, s24, 1
  s_cbranch_scc1 L_FAIL
  s_waitcnt vmcnt(0)
  v_cmp_gt_i32 vcc, s29, v3
  s_cbranch_vccz Lpolld_34
  s_sleep 1
  s_branch Lpoll_33
Lpolld_34:
  s_branch L_WO_issue
L_WO_park:
  s_waitcnt vmcnt(0)
  s_barrier
  s_cmp_ge_u32 s25, 64
  s_cbranch_scc1 L_END
L_WO_issue:
  s_barrier
  s_mov_b32 s34, s26
  s_mov_b32 s35, s27
  s_add_u32 s36, s32, 0
  s_add_u32 m0, s34, s36
  s_add_u32 s36, s35, 0
  buffer_load_dwordx4 v1, s[4:7], s36 offen offset:0 sc1 lds
  buffer_load_dwordx4 v1, s[4:7], s36 offen offset:1024 sc1 lds
  buffer_load_dwordx4 v1, s[4:7], s36 offen offset:2048 sc1 lds
  buffer_load_dwordx4 v1, s[4:7], s36 offen offset:3072 sc1 lds
  s_add_u32 s36, s32, 16384
  s_add_u32 m0, s34, s36
  s_add_u32 s36, s35, 131072
  buffer_load_dwordx4 v1, s[4:7], s36 offen offset:0 sc1 lds
  buffer_load_dwordx4 v1, s[4:7], s36 offen offset:1024 sc1 lds
  buffer_load_dwordx4 v1, s[4:7], s36 offen offset:2048 sc1 lds
  buffer_load_dwordx4 v1, s[4:7], s36 offen offset:3072 sc1 lds
  s_add_u32 s36, s32, 32768
  s_add_u32 m0, s34, s36
  s_add_u32 s36, s35, 262144
  buffer_load_dwordx4 v1, s[4:7], s36 offen offset:0 sc1 lds
  buffer_load_dwordx4 v1, s[4:7], s36 offen offset:1024 sc1 lds
  buffer_load_dwordx4 v1, s[4:7], s36 offen offset:2048 sc1 lds
  buffer_load_dwordx4 v1, s[4:7], s36 offen offset:3072 sc1 lds
L_WO_go:
  v_add_u32 v73, s26, v69
  v_add_u32 v74, s26, v70
  s_sub_u32 s26, 65536, s26
  s_add_u32 s27, s27, 2097152
  s_xor_b32 s27, s27, 0x2000
  s_add_u32 s29, s29, 1
  s_waitcnt vmcnt(8)
  s_barrier
  ds_read_b128 v[4:7], v73 offset:0
  ds_read_b128 v[8:11], v73 offset:1024
  ds_read_b128 v[12:15], v73 offset:2048
  ds_read_b128 v[16:19], v73 offset:3072
  ds_read_b128 v[20:23], v73 offset:4096
  ds_read_b128 v[24:27], v73 offset:5120
  s_waitcnt lgkmcnt(4)
  v_mfma_f32_16x16x32_bf16 v[36:39], a[0:3], v[4:7], 0
  ds_read_b128 v[28:31], v73 offset:6144
  v_mfma_f32_16x16x32_bf16 v[40:43], a[0:3], v[8:11], 0
  ds_read_b128 v[32:35], v73 offset:7168
  v_mfma_f32_16x16x32_bf16 v[44:47], a[128:131], v[4:7], 0
  s_add_u32 s36, s32, 49152
  s_add_u32 m0, s34, s36
  s_add_u32 s36, s35, 393216
  buffer_load_dwordx4 v1, s[4:7], s36 offen offset:0 sc1 lds
  v_mfma_f32_16x16x32_bf16 v[48:51], a[128:131], v[8:11], 0
  s_waitcnt lgkmcnt(4)
  v_mfma_f32_16x16x32_bf16 v[36:39], a[4:7], v[12:15], v[36:39]
  ds_read_b128 v[4:7], v73 offset:8192
  v_mfma_f32_16x16x32_bf16 v[40:43], a[4:7], v[16:19], v[40:43]
  ds_read_b128 v[8:11], v73 offset:9216
  v_mfma_f32_16x16x32_bf16 v[44:47], a[132:135], v[12:15], v[44:47]
  buffer_load_dwordx4 v1, s[4:7], s36 offen offset:1024 sc1 lds
  v_mfma_f32_16x16x32_bf16 v[48:51], a[132:135], v[16:19], v[48:51]
  s_waitcnt lgkmcnt(4)
  v_mfma_f32_16x16x32_bf16 v[36:39], a[8:11], v[20:23], v[36:39]
  ds_read_b128 v[12:15], v73 offset:10240
  v_mfma_f32_16x16x32_bf16 v[40:43], a[8:11], v[24:27], v[40:43]
  ds_read_b128 v[16:19], v73 offset:11264
  v_mfma_f32_16x16x32_bf16 v[44:47], a[136:139], v[20:23], v[44:47]
  buffer_load_dwordx4 v1, s[4:7], s36 offen offset:2048 sc1 lds
  v_mfma_f32_16x16x32_bf16 v[48:51], a[136:139], v[24:27], v[48:51]
  s_waitcnt lgkmcnt(4)
  v_mfma_f32_16x16x32_bf16 v[36:39], a[12:15], v[28:31], v[36:39]
  ds_read_b128 v[20:23], v73 offset:12288
  v_mfma_f32_16x16x32_bf16 v[40:43], a[12:15], v[32:35], v[40:43]
  ds_read_b128 v[24:27], v73 offset:13312
  v_mfma_f32_16x16x32_bf16 v[44:47], a[140:143], v[28:31], v[44:47]
  buffer_load_dwordx4 v1, s[4:7], s36 offen offset:3072 sc1 lds
  v_mfma_f32_16x16x32_bf16 v[48:51], a[140:143], v[32:35], v[48:51]
  s_waitcnt lgkmcnt(4)
  v_mfma_f32_16x16x32_bf16 v[36:39], a[16:19], v[4:7], v[36:39]
  ds_read_b128 v[28:31], v73 offset:14336
  v_mfma_f32_16x16x32_bf16 v[40:43], a[16:19], v[8:11], v[40:43]
  ds_read_b128 v[32:35], v73 offset:15360
  v_mfma_f32_16x16x32_bf16 v[44:47], a[144:147], v[4:7], v[44:47]
  v_mfma_f32_16x16x32_bf16 v[48:51], a[144:147], v[8:11], v[48:51]
  s_waitcnt vmcnt(8)
  s_barrier
  s_lshl_b32 s40, s20, 8
  s_add_u32 m0, s40, 131072
  s_cmp_eq_u32 s20, 0
  s_cselect_b32 s40, s30, 2147483392
  buffer_load_dword v2, s[4:7], s40 offen sc1 lds
  s_mov_b32 s34, s26
  s_mov_b32 s35, s27
  s_waitcnt lgkmcnt(4)
  v_mfma_f32_16x16x32_bf16 v[36:39], a[20:23], v[12:15], v[36:39]
  ds_read_b128 v[4:7], v73 offset:16384
  v_mfma_f32_16x16x32_bf16 v[40:43], a[20:23], v[16:19], v[40:43]
  ds_read_b128 v[8:11], v73 offset:17408
  v_mfma_f32_16x16x32_bf16 v[44:47], a[148:151], v[12:15], v[44:47]
  v_mfma_f32_16x16x32_bf16 v[48:51], a[148:151], v[16:19], v[48:51]
  s_waitcnt lgkmcnt(4)
  v_mfma_f32_16x16x32_bf16 v[36:39], a[24:27], v[20:23], v[36:39]
  ds_read_b128 v[12:15], v73 offset:18432
  v_mfma_f32_16x16x32_bf16 v[40:43], a[24:27], v[24:27], v[40:43]
  ds_read_b128 v[16:19], v73 offset:19456
  v_mfma_f32_16x16x32_bf16 v[44:47], a[152:155], v[20:23], v[44:47]
  v_mfma_f32_16x16x32_bf16 v[48:51], a[152:155], v[24:27], v[48:51]
  s_waitcnt lgkmcnt(4)
  v_mfma_f32_16x16x32_bf16 v[36:39], a[28:31], v[28:31], v[36:39]
  ds_read_b128 v[20:23], v73 offset:20480
  v_mfma_f32_16x16x32_bf16 v[40:43], a[28:31], v[32:35], v[40:43]
  ds_read_b128 v[24:27], v73 offset:21504
  v_mfma_f32_16x16x32_bf16 v[44:47], a[156:159], v[28:31], v[44:47]
  v_mfma_f32_16x16x32_bf16 v[48:51], a[156:159], v[32:35], v[48:51]
  s_waitcnt lgkmcnt(4)
  v_mfma_f32_16x16x32_bf16 v[36:39], a[32:35], v[4:7], v[36:39]
  ds_read_b128 v[28:31], v73 offset:22528
  v_mfma_f32_16x16x32_bf16 v[40:43], a[32:35], v[8:11], v[40:43]
  ds_read_b128 v[32:35], v73 offset:23552
  v_mfma_f32_16x16x32_bf16 v[44:47], a[160:163], v[4:7], v[44:47]
  v_mfma_f32_16x16x32_bf16 v[48:51], a[160:163], v[8:11], v[48:51]
  s_waitcnt lgkmcnt(4)
  v_mfma_f32_16x16x32_bf16 v[36:39], a[36:39], v[12:15], v[36:39]
  ds_read_b128 v[4:7], v73 offset:24576
  v_mfma_f32_16x16x32_bf16 v[40:43], a[36:39], v[16:19], v[40:43]
  ds_read_b128 v[8:11], v73 offset:25600
  v_mfma_f32_16x16x32_bf16 v[44:47], a[164:167], v[12:15], v[44:47]
  v_mfma_f32_16x16x32_bf16 v[48:51], a[164:167], v[16:19], v[48:51]
  s_waitcnt lgkmcnt(4)
  v_mfma_f32_16x16x32_bf16 v[36:39], a[40:43], v[20:23], v[36:39]
  ds_read_b128 v[12:15], v73 offset:26624
  v_mfma_f32_16x16x32_bf16 v[40:43], a[40:43], v[24:27], v[40:43]
  ds_read_b128 v[16:19], v73 offset:27648
  v_mfma_f32_16x16x32_bf16 v[44:47], a[168:171], v[20:23], v[44:47]
  v_mfma_f32_16x16x32_bf16 v[48:51], a[168:171], v[24:27], v[48:51]
  s_waitcnt lgkmcnt(4)
  v_mfma_f32_16x16x32_bf16 v[36:39], a[44:47], v[28:31], v[36:39]
  ds_read_b128 v[20:23], v73 offset:28672
  v_mfma_f32_16x16x32_bf16 v[40:43], a[44:47], v[32:35], v[40:43]
  ds_read_b128 v[24:27], v73 offset:29696
  v_mfma_f32_16x16x32_bf16 v[44:47], a[172:175], v[28:31], v[44:47]
  v_mfma_f32_16x16x32_bf16 v[48:51], a[172:175], v[32:35], v[48:51]
  s_waitcnt lgkmcnt(4)
  v_mfma_f32_16x16x32_bf16 v[36:39], a[48:51], v[4:7], v[36:39]
  ds_read_b128 v[28:31], v73 offset:30720
  v_mfma_f32_16x16x32_bf16 v[40:43], a[48:51], v[8:11], v[40:43]
  ds_read_b128 v[32:35], v73 offset:31744
  v_mfma_f32_16x16x32_bf16 v[44:47], a[176:179], v[4:7], v[44:47]
  v_mfma_f32_16x16x32_bf16 v[48:51], a[176:179], v[8:11], v[48:51]
  s_waitcnt vmcnt(7)
  s_cmp_lg_u32 s28, 0
  s_cbranch_scc1 L_WO_b2
  s_waitcnt vmcnt(5)
L_WO_b2:
  s_barrier
  s_waitcnt lgkmcnt(4)
  v_mfma_f32_16x16x32_bf16 v[36:39], a[52:55], v[12:15], v[36:39]
  ds_read_b128 v[4:7], v73 offset:32768
  v_mfma_f32_16x16x32_bf16 v[40:43], a[52:55], v[16:19], v[40:43]
  ds_read_b128 v[8:11], v73 offset:33792
  v_mfma_f32_16x16x32_bf16 v[44:47], a[180:183], v[12:15], v[44:47]
  v_mfma_f32_16x16x32_bf16 v[48:51], a[180:183], v[16:19], v[48:51]
  s_waitcnt lgkmcnt(4)
  v_mfma_f32_16x16x32_bf16 v[36:39], a[56:59], v[20:23], v[36:39]
  ds_read_b128 v[12:15], v73 offset:34816
  v_mfma_f32_16x16x32_bf16 v[40:43], a[56:59], v[24:27], v[40:43]
  ds_read_b128 v[16:19], v73 offset:35840
  v_mfma_f32_16x16x32_bf16 v[44:47], a[184:187], v[20:23], v[44:47]
  v_mfma_f32_16x16x32_bf16 v[48:51], a[184:187], v[24:27], v[48:51]
  s_waitcnt lgkmcnt(4)
  v_mfma_f32_16x16x32_bf16 v[36:39], a[60:63], v[28:31], v[36:39]
  ds_read_b128 v[20:23], v73 offset:36864
  v_mfma_f32_16x16x32_bf16 v[40:43], a[60:63], v[32:35], v[40:43]
  ds_read_b128 v[24:27], v73 offset:37888
  v_mfma_f32_16x16x32_bf16 v[44:47], a[188:191], v[28:31], v[44:47]
  v_mfma_f32_16x16x32_bf16 v[48:51], a[188:191], v[32:35], v[48:51]
  s_waitcnt lgkmcnt(4)
  v_mfma_f32_16x16x32_bf16 v[36:39], a[64:67], v[4:7], v[36:39]
  ds_read_b128 v[28:31], v73 offset:38912
  v_mfma_f32_16x16x32_bf16 v[40:43], a[64:67], v[8:11], v[40:43]
  ds_read_b128 v[32:35], v73 offset:39936
  v_mfma_f32_16x16x32_bf16 v[44:47], a[192:195], v[4:7], v[44:47]
  v_mfma_f32_16x16x32_bf16 v[48:51], a[192:195], v[8:11], v[48:51]
  s_waitcnt lgkmcnt(4)
  v_mfma_f32_16x16x32_bf16 v[36:39], a[68:71], v[12:15], v[36:39]
  ds_read_b128 v[4:7], v73 offset:40960
  v_mfma_f32_16x16x32_bf16 v[40:43], a[68:71], v[16:19], v[40:43]
  ds_read_b128 v[8:11], v73 offset:41984
  v_mfma_f32_16x16x32_bf16 v[44:47], a[196:199], v[12:15], v[44:47]
  v_mfma_f32_16x16x32_bf16 v[48:51], a[196:199], v[16:19], v[48:51]
  s_waitcnt lgkmcnt(4)
  v_mfma_f32_16x16x32_bf16 v[36:39], a[72:75], v[20:23], v[36:39]
  ds_read_b128 v[12:15], v73 offset:43008
  v_mfma_f32_16x16x32_bf16 v[40:43], a[72:75], v[24:27], v[40:43]
  ds_read_b128 v[16:19], v73 offset:44032
  v_mfma_f32_16x16x32_bf16 v[44:47], a[200:203], v[20:23], v[44:47]
  v_mfma_f32_16x16x32_bf16 v[48:51], a[200:203], v[24:27], v[48:51]
  s_waitcnt vmcnt(0)
  s_barrier
  ds_read_b32 v3, v71
  s_lshl_b32 s40, s20, 1
  s_add_u32 s40, s40, 1
  s_cmp_lg_u32 s40, s28
  s_cbranch_scc1 L_WO_s2
  s_mov_b32 s63, s25
  s_atomic_smax s63, s[4:5], s62 glc
Lnosig_35:
L_WO_s2:
  s_waitcnt lgkmcnt(4)
  v_mfma_f32_16x16x32_bf16 v[36:39], a[76:79], v[28:31], v[36:39]
  ds_read_b128 v[20:23], v73 offset:45056
  v_mfma_f32_16x16x32_bf16 v[40:43], a[76:79], v[32:35], v[40:43]
  ds_read_b128 v[24:27], v73 offset:46080
  v_mfma_f32_16x16x32_bf16 v[44:47], a[204:207], v[28:31], v[44:47]
  v_mfma_f32_16x16x32_bf16 v[48:51], a[204:207], v[32:35], v[48:51]
  s_waitcnt lgkmcnt(4)
  v_mfma_f32_16x16x32_bf16 v[36:39], a[80:83], v[4:7], v[36:39]
  ds_read_b128 v[28:31], v73 offset:47104
  v_mfma_f32_16x16x32_bf16 v[40:43], a[80:83], v[8:11], v[40:43]
  ds_read_b128 v[32:35], v73 offset:48128
  v_mfma_f32_16x16x32_bf16 v[44:47], a[208:211], v[4:7], v[44:47]
  v_mfma_f32_16x16x32_bf16 v[48:51], a[208:211], v[8:11], v[48:51]
  s_waitcnt lgkmcnt(4)
  v_cmp_gt_i32 vcc, s29, v3
  s_mov_b32 s28, 0
  s_cbranch_vccnz L_WO_nopf
  s_cmp_ge_u32 s25, 63
  s_cbranch_scc1 L_WO_nopf
  s_mov_b32 s28, 1
  s_waitcnt lgkmcnt(4)
  v_mfma_f32_16x16x32_bf16 v[36:39], a[84:87], v[12:15], v[36:39]
  ds_read_b128 v[4:7], v73 offset:49152
  v_mfma_f32_16x16x32_bf16 v[40:43], a[84:87], v[16:19], v[40:43]
  ds_read_b128 v[8:11], v73 offset:50176
  v_mfma_f32_16x16x32_bf16 v[44:47], a[212:215], v[12:15], v[44:47]
  s_add_u32 s36, s32, 0
  s_add_u32 m0, s34, s36
  s_add_u32 s36, s35, 0
  buffer_load_dwordx4 v1, s[4:7], s36 offen offset:0 sc1 lds
  v_mfma_f32_16x16x32_bf16 v[48:51], a[212:215], v[16:19], v[48:51]
  buffer_load_dwordx4 v1, s[4:7], s36 offen offset:1024 sc1 lds
  s_waitcnt lgkmcnt(4)
  v_mfma_f32_16x16x32_bf16 v[36:39], a[88:91], v[20:23], v[36:39]
  ds_read_b128 v[12:15], v73 offset:51200
  v_mfma_f32_16x16x32_bf16 v[40:43], a[88:91], v[24:27], v[40:43]
  ds_read_b128 v[16:19], v73 offset:52224
  v_mfma_f32_16x16x32_bf16 v[44:47], a[216:219], v[20:23], v[44:47]
  buffer_load_dwordx4 v1, s[4:7], s36 offen offset:2048 sc1 lds
  v_mfma_f32_16x16x32_bf16 v[48:51], a[216:219], v[24:27], v[48:51]
  buffer_load_dwordx4 v1, s[4:7], s36 offen offset:3072 sc1 lds
  s_waitcnt lgkmcnt(4)
  v_mfma_f32_16x16x32_bf16 v[36:39], a[92:95], v[28:31], v[36:39]
  ds_read_b128 v[20:23], v73 offset:53248
  v_mfma_f32_16x16x32_bf16 v[40:43], a[92:95], v[32:35], v[40:43]
  ds_read_b128 v[24:27], v73 offset:54272
  v_mfma_f32_16x16x32_bf16 v[44:47], a[220:223], v[28:31], v[44:47]
  s_add_u32 s36, s32, 16384
  s_add_u32 m0, s34, s36
  s_add_u32 s36, s35, 131072
  buffer_load_dwordx4 v1, s[4:7], s36 offen offset:0 sc1 lds
  v_mfma_f32_16x16x32_bf16 v[48:51], a[220:223], v[32:35], v[48:51]
  buffer_load_dwordx4 v1, s[4:7], s36 offen offset:1024 sc1 lds
  s_waitcnt lgkmcnt(4)
  v_mfma_f32_16x16x32_bf16 v[36:39], a[96:99], v[4:7], v[36:39]
  ds_read_b128 v[28:31], v73 offset:55296
  v_mfma_f32_16x16x32_bf16 v[40:43], a[96:99], v[8:11], v[40:43]
  ds_read_b128 v[32:35], v73 offset:56320
  v_mfma_f32_16x16x32_bf16 v[44:47], a[224:227], v[4:7], v[44:47]
  buffer_load_dwordx4 v1, s[4:7], s36 offen offset:2048 sc1 lds
  v_mfma_f32_16x16x32_bf16 v[48:51], a[224:227], v[8:11], v[48:51]
  buffer_load_dwordx4 v1, s[4:7], s36 offen offset:3072 sc1 lds
  s_waitcnt lgkmcnt(4)
  v_mfma_f32_16x16x32_bf16 v[36:39], a[100:103], v[12:15], v[36:39]
  ds_read_b128 v[4:7], v73 offset:57344
  v_mfma_f32_16x16x32_bf16 v[40:43], a[100:103], v[16:19], v[40:43]
  ds_read_b128 v[8:11], v73 offset:58368
  v_mfma_f32_16x16x32_bf16 v[44:47], a[228:231], v[12:15], v[44:47]
  s_add_u32 s36, s32, 32768
  s_add_u32 m0, s34, s36
  s_add_u32 s36, s35, 262144
  buffer_load_dwordx4 v1, s[4:7], s36 offen offset:0 sc1 lds
  v_mfma_f32_16x16x32_bf16 v[48:51], a[228:231], v[16:19], v[48:51]
  buffer_load_dwordx4 v1, s[4:7], s36 offen offset:1024 sc1 lds
  s_waitcnt lgkmcnt(4)
  v_mfma_f32_16x16x32_bf16 v[36:39], a[104:107], v[20:23], v[36:39]
  ds_read_b128 v[12:15], v73 offset:59392
  v_mfma_f32_16x16x32_bf16 v[40:43], a[104:107], v[24:27], v[40:43]
  ds_read_b128 v[16:19], v73 offset:60416
  v_mfma_f32_16x16x32_bf16 v[44:47], a[232:235], v[20:23], v[44:47]
  buffer_load_dwordx4 v1, s[4:7], s36 offen offset:2048 sc1 lds
  v_mfma_f32_16x16x32_bf16 v[48:51], a[232:235], v[24:27], v[48:51]
  buffer_load_dwordx4 v1, s[4:7], s36 offen offset:3072 sc1 lds
  s_waitcnt lgkmcnt(4)
  v_mfma_f32_16x16x32_bf16 v[36:39], a[108:111], v[28:31], v[36:39]
  ds_read_b128 v[20:23], v73 offset:61440
  v_mfma_f32_16x16x32_bf16 v[40:43], a[108:111], v[32:35], v[40:43]
  ds_read_b128 v[24:27], v73 offset:62464
  v_mfma_f32_16x16x32_bf16 v[44:47], a[236:239], v[28:31], v[44:47]
  v_mfma_f32_16x16x32_bf16 v[48:51], a[236:239], v[32:35], v[48:51]
  s_waitcnt lgkmcnt(4)
  v_mfma_f32_16x16x32_bf16 v[36:39], a[112:115], v[4:7], v[36:39]
  ds_read_b128 v[28:31], v73 offset:63488
  v_mfma_f32_16x16x32_bf16 v[40:43], a[112:115], v[8:11], v[40:43]
  ds_read_b128 v[32:35], v73 offset:64512
  v_mfma_f32_16x16x32_bf16 v[44:47], a[240:243], v[4:7], v[44:47]
  v_mfma_f32_16x16x32_bf16 v[48:51], a[240:243], v[8:11], v[48:51]
  s_waitcnt lgkmcnt(4)
  v_mfma_f32_16x16x32_bf16 v[36:39], a[116:119], v[12:15], v[36:39]
  v_mfma_f32_16x16x32_bf16 v[40:43], a[116:119], v[16:19], v[40:43]
  v_mfma_f32_16x16x32_bf16 v[44:47], a[244:247], v[12:15], v[44:47]
  v_mfma_f32_16x16x32_bf16 v[48:51], a[244:247], v[16:19], v[48:51]
  s_waitcnt lgkmcnt(2)
  v_mfma_f32_16x16x32_bf16 v[36:39], a[120:123], v[20:23], v[36:39]
  v_mfma_f32_16x16x32_bf16 v[40:43], a[120:123], v[24:27], v[40:43]
  v_mfma_f32_16x16x32_bf16 v[44:47], a[248:251], v[20:23], v[44:47]
  v_mfma_f32_16x16x32_bf16 v[48:51], a[248:251], v[24:27], v[48:51]
  s_waitcnt lgkmcnt(0)
  v_mfma_f32_16x16x32_bf16 v[36:39], a[124:127], v[28:31], v[36:39]
  v_mfma_f32_16x16x32_bf16 v[40:43], a[124:127], v[32:35], v[40:43]
  v_mfma_f32_16x16x32_bf16 v[44:47], a[252:255], v[28:31], v[44:47]
  v_mfma_f32_16x16x32_bf16 v[48:51], a[252:255], v[32:35], v[48:51]
  s_nop 7
  s_branch L_WO_epi
L_WO_nopf:
  s_waitcnt lgkmcnt(4)
  v_mfma_f32_16x16x32_bf16 v[36:39], a[84:87], v[12:15], v[36:39]
  ds_read_b128 v[4:7], v73 offset:49152
  v_mfma_f32_16x16x32_bf16 v[40:43], a[84:87], v[16:19], v[40:43]
  ds_read_b128 v[8:11], v73 offset:50176
  v_mfma_f32_16x16x32_bf16 v[44:47], a[212:215], v[12:15], v[44:47]
  v_mfma_f32_16x16x32_bf16 v[48:51], a[212:215], v[16:19], v[48:51]
  s_waitcnt lgkmcnt(4)
  v_mfma_f32_16x16x32_bf16 v[36:39], a[88:91], v[20:23], v[36:39]
  ds_read_b128 v[12:15], v73 offset:51200
  v_mfma_f32_16x16x32_bf16 v[40:43], a[88:91], v[24:27], v[40:43]
  ds_read_b128 v[16:19], v73 offset:52224
  v_mfma_f32_16x16x32_bf16 v[44:47], a[216:219], v[20:23], v[44:47]
  v_mfma_f32_16x16x32_bf16 v[48:51], a[216:219], v[24:27], v[48:51]
  s_waitcnt lgkmcnt(4)
  v_mfma_f32_16x16x32_bf16 v[36:39], a[92:95], v[28:31], v[36:39]
  ds_read_b128 v[20:23], v73 offset:53248
  v_mfma_f32_16x16x32_bf16 v[40:43], a[92:95], v[32:35], v[40:43]
  ds_read_b128 v[24:27], v73 offset:54272
  v_mfma_f32_16x16x32_bf16 v[44:47], a[220:223], v[28:31], v[44:47]
  v_mfma_f32_16x16x32_bf16 v[48:51], a[220:223], v[32:35], v[48:51]
  s_waitcnt lgkmcnt(4)
  v_mfma_f32_16x16x32_bf16 v[36:39], a[96:99], v[4:7], v[36:39]
  ds_read_b128 v[28:31], v73 offset:55296
  v_mfma_f32_16x16x32_bf16 v[40:43], a[96:99], v[8:11], v[40:43]
  ds_read_b128 v[32:35], v73 offset:56320
  v_mfma_f32_16x16x32_bf16 v[44:47], a[224:227], v[4:7], v[44:47]
  v_mfma_f32_16x16x32_bf16 v[48:51], a[224:227], v[8:11], v[48:51]
  s_waitcnt lgkmcnt(4)
  v_mfma_f32_16x16x32_bf16 v[36:39], a[100:103], v[12:15], v[36:39]
  ds_read_b128 v[4:7], v73 offset:57344
  v_mfma_f32_16x16x32_bf16 v[40:43], a[100:103], v[16:19], v[40:43]
  ds_read_b128 v[8:11], v73 offset:58368
  v_mfma_f32_16x16x32_bf16 v[44:47], a[228:231], v[12:15], v[44:47]
  v_mfma_f32_16x16x32_bf16 v[48:51], a[228:231], v[16:19], v[48:51]
  s_waitcnt lgkmcnt(4)
  v_mfma_f32_16x16x32_bf16 v[36:39], a[104:107], v[20:23], v[36:39]
  ds_read_b128 v[12:15], v73 offset:59392
  v_mfma_f32_16x16x32_bf16 v[40:43], a[104:107], v[24:27], v[40:43]
  ds_read_b128 v[16:19], v73 offset:60416
  v_mfma_f32_16x16x32_bf16 v[44:47], a[232:235], v[20:23], v[44:47]
  v_mfma_f32_16x16x32_bf16 v[48:51], a[232:235], v[24:27], v[48:51]
  s_waitcnt lgkmcnt(4)
  v_mfma_f32_16x16x32_bf16 v[36:39], a[108:111], v[28:31], v[36:39]
  ds_read_b128 v[20:23], v73 offset:61440
  v_mfma_f32_16x16x32_bf16 v[40:43], a[108:111], v[32:35], v[40:43]
  ds_read_b128 v[24:27], v73 offset:62464
  v_mfma_f32_16x16x32_bf16 v[44:47], a[236:239], v[28:31], v[44:47]
  v_mfma_f32_16x16x32_bf16 v[48:51], a[236:239], v[32:35], v[48:51]
  s_waitcnt lgkmcnt(4)
  v_mfma_f32_16x16x32_bf16 v[36:39], a[112:115], v[4:7], v[36:39]
  ds_read_b128 v[28:31], v73 offset:63488
  v_mfma_f32_16x16x32_bf16 v[40:43], a[112:115], v[8:11], v[40:43]
  ds_read_b128 v[32:35], v73 offset:64512
  v_mfma_f32_16x16x32_bf16 v[44:47], a[240:243], v[4:7], v[44:47]
  v_mfma_f32_16x16x32_bf16 v[48:51], a[240:243], v[8:11], v[48:51]
  s_waitcnt lgkmcnt(4)
  v_mfma_f32_16x16x32_bf16 v[36:39], a[116:119], v[12:15], v[36:39]
  v_mfma_f32_16x16x32_bf16 v[40:43], a[116:119], v[16:19], v[40:43]
  v_mfma_f32_16x16x32_bf16 v[44:47], a[244:247], v[12:15], v[44:47]
  v_mfma_f32_16x16x32_bf16 v[48:51], a[244:247], v[16:19], v[48:51]
  s_waitcnt lgkmcnt(2)
  v_mfma_f32_16x16x32_bf16 v[36:39], a[120:123], v[20:23], v[36:39]
  v_mfma_f32_16x16x32_bf16 v[40:43], a[120:123], v[24:27], v[40:43]
  v_mfma_f32_16x16x32_bf16 v[44:47], a[248:251], v[20:23], v[44:47]
  v_mfma_f32_16x16x32_bf16 v[48:51], a[248:251], v[24:27], v[48:51]
  s_waitcnt lgkmcnt(0)
  v_mfma_f32_16x16x32_bf16 v[36:39], a[124:127], v[28:31], v[36:39]
  v_mfma_f32_16x16x32_bf16 v[40:43], a[124:127], v[32:35], v[40:43]
  v_mfma_f32_16x16x32_bf16 v[44:47], a[252:255], v[28:31], v[44:47]
  v_mfma_f32_16x16x32_bf16 v[48:51], a[252:255], v[32:35], v[48:51]
L_WO_epi:
  s_nop 4
  v_cvt_pk_bf16_f32 v52, v36, v37
  v_cvt_pk_bf16_f32 v53, v38, v39
  v_cvt_pk_bf16_f32 v54, v44, v45
  v_cvt_pk_bf16_f32 v55, v46, v47
  buffer_store_dwordx4 v[52:55], v68, s[4:7], s31 offen offset:0 sc1
  v_cvt_pk_bf16_f32 v56, v40, v41
  v_cvt_pk_bf16_f32 v57, v42, v43
  v_cvt_pk_bf16_f32 v58, v48, v49
  v_cvt_pk_bf16_f32 v59, v50, v51
  buffer_store_dwordx4 v[56:59], v68, s[4:7], s31 offen offset:1024 sc1
  s_add_u32 s25, s25, 1
  s_add_u32 s31, s31, 262144
  s_branch L_WO_top
L_F1:
  s_load_dwordx2 s[8:9], s[0:1], 64
  s_mov_b32 s10, 7340032
  s_mov_b32 s11, 0x20000
  s_waitcnt lgkmcnt(0)
  s_lshl_b32 s44, s21, 7
  v_bfe_u32 v40, v0, 5, 1
  v_mul_u32_u24 v40, 28672, v40
  v_bfe_u32 v41, v0, 4, 1
  v_mul_u32_u24 v41, 14336, v41
  v_add_u32 v40, v40, v41
  v_bfe_u32 v41, v0, 3, 1
  v_mul_u32_u24 v41, 7168, v41
  v_add_u32 v40, v40, v41
  v_lshrrev_b32 v41, 3, v0
  v_and_b32 v41, 6, v41
  v_xor_b32 v41, v41, v0
  v_and_b32 v41, 7, v41
  v_lshl_add_u32 v40, v41, 4, v40
  s_lshr_b32 s40, s20, 1
  s_mul_i32 s40, s40, 458752
  s_and_b32 s41, s20, 1
  s_mul_i32 s41, s41, 57344
  s_add_u32 s40, s40, s41
  v_add_u32 v40, s40, v40
  v_bfe_u32 v41, v0, 3, 2
  v_xor_b32 v41, s20, v41
  v_lshlrev_b32 v41, 5, v41
  v_lshrrev_b32 v42, 2, v0
  v_lshl_add_u32 v42, v42, 7, v41
  v_and_b32 v41, 3, v0
  v_lshl_add_u32 v42, v41, 3, v42
  v_add_u32 v43, 0x10000, v42
  v_add_u32 v44, s44, v40
  v_add_u32 v45, s44, v40
  s_lshl_b32 s41, s20, 10
  s_add_u32 m0, s41, 0
  s_mov_b32 s42, 0
  buffer_load_dwordx4 v44, s[8:11], s42 offen nt lds
  s_add_u32 m0, s41, 4096
  s_mov_b32 s42, 114688
  buffer_load_dwordx4 v44, s[8:11], s42 offen nt lds
  s_add_u32 m0, s41, 8192
  s_mov_b32 s42, 229376
  buffer_load_dwordx4 v44, s[8:11], s42 offen nt lds
  s_add_u32 m0, s41, 12288
  s_mov_b32 s42, 344064
  buffer_load_dwordx4 v44, s[8:11], s42 offen nt lds
  s_add_u32 m0, s41, 16384
  s_mov_b32 s42, 917504
  buffer_load_dwordx4 v44, s[8:11], s42 offen nt lds
  s_add_u32 m0, s41, 20480
  s_mov_b32 s42, 1032192
  buffer_load_dwordx4 v44, s[8:11], s42 offen nt lds
  s_add_u32 m0, s41, 24576
  s_mov_b32 s42, 1146880
  buffer_load_dwordx4 v44, s[8:11], s42 offen nt lds
  s_add_u32 m0, s41, 28672
  s_mov_b32 s42, 1261568
  buffer_load_dwordx4 v44, s[8:11], s42 offen nt lds
  s_add_u32 m0, s41, 32768
  s_mov_b32 s42, 1835008
  buffer_load_dwordx4 v44, s[8:11], s42 offen nt lds
  s_add_u32 m0, s41, 36864
  s_mov_b32 s42, 1949696
  buffer_load_dwordx4 v44, s[8:11], s42 offen nt lds
  s_add_u32 m0, s41, 40960
  s_mov_b32 s42, 2064384
  buffer_load_dwordx4 v44, s[8:11], s42 offen nt lds
  s_add_u32 m0, s41, 45056
  s_mov_b32 s42, 2179072
  buffer_load_dwordx4 v44, s[8:11], s42 offen nt lds
  s_add_u32 m0, s41, 49152
  s_mov_b32 s42, 2752512
  buffer_load_dwordx4 v44, s[8:11], s42 offen nt lds
  s_add_u32 m0, s41, 53248
  s_mov_b32 s42, 2867200
  buffer_load_dwordx4 v44, s[8:11], s42 offen nt lds
  s_add_u32 m0, s41, 57344
  s_mov_b32 s42, 2981888
  buffer_load_dwordx4 v44, s[8:11], s42 offen nt lds
  s_add_u32 m0, s41, 61440
  s_mov_b32 s42, 3096576
  buffer_load_dwordx4 v44, s[8:11], s42 offen nt lds
  s_add_u32 m0, s41, 65536
  s_mov_b32 s42, 3670016
  buffer_load_dwordx4 v44, s[8:11], s42 offen nt lds
  s_add_u32 m0, s41, 69632
  s_mov_b32 s42, 3784704
  buffer_load_dwordx4 v44, s[8:11], s42 offen nt lds
  s_add_u32 m0, s41, 73728
  s_mov_b32 s42, 3899392
  buffer_load_dwordx4 v44, s[8:11], s42 offen nt lds
  s_add_u32 m0, s41, 77824
  s_mov_b32 s42, 4014080
  buffer_load_dwordx4 v44, s[8:11], s42 offen nt lds
  s_add_u32 m0, s41, 81920
  s_mov_b32 s42, 4587520
  buffer_load_dwordx4 v44, s[8:11], s42 offen nt lds
  s_add_u32 m0, s41, 86016
  s_mov_b32 s42, 4702208
  buffer_load_dwordx4 v44, s[8:11], s42 offen nt lds
  s_add_u32 m0, s41, 90112
  s_mov_b32 s42, 4816896
  buffer_load_dwordx4 v44, s[8:11], s42 offen nt lds
  s_add_u32 m0, s41, 94208
  s_mov_b32 s42, 4931584
  buffer_load_dwordx4 v44, s[8:11], s42 offen nt lds
  s_add_u32 m0, s41, 98304
  s_mov_b32 s42, 5505024
  buffer_load_dwordx4 v44, s[8:11], s42 offen nt lds
  s_add_u32 m0, s41, 102400
  s_mov_b32 s42, 5619712
  buffer_load_dwordx4 v44, s[8:11], s42 offen nt lds
  s_add_u32 m0, s41, 106496
  s_mov_b32 s42, 5734400
  buffer_load_dwordx4 v44, s[8:11], s42 offen nt lds
  s_add_u32 m0, s41, 110592
  s_mov_b32 s42, 5849088
  buffer_load_dwordx4 v44, s[8:11], s42 offen nt lds
  s_waitcnt vmcnt(24) lgkmcnt(0)
  s_barrier
  s_add_u32 m0, s41, 114688
  s_mov_b32 s42, 6422528
  buffer_load_dwordx4 v44, s[8:11], s42 offen nt lds
  s_add_u32 m0, s41, 118784
  s_mov_b32 s42, 6537216
  buffer_load_dwordx4 v44, s[8:11], s42 offen nt lds
  s_add_u32 m0, s41, 122880
  s_mov_b32 s42, 6651904
  buffer_load_dwordx4 v44, s[8:11], s42 offen nt lds
  s_add_u32 m0, s41, 126976
  s_mov_b32 s42, 6766592
  buffer_load_dwordx4 v44, s[8:11], s42 offen nt lds
  ds_read_b64_tr_b16 a[0:1], v42 offset:0
  ds_read_b64_tr_b16 a[2:3], v42 offset:2048
  ds_read_b64_tr_b16 a[4:5], v42 offset:4096
  ds_read_b64_tr_b16 a[6:7], v42 offset:6144
  ds_read_b64_tr_b16 a[8:9], v42 offset:8192
  ds_read_b64_tr_b16 a[10:11], v42 offset:10240
  ds_read_b64_tr_b16 a[12:13], v42 offset:12288
  ds_read_b64_tr_b16 a[14:15], v42 offset:14336
  s_waitcnt vmcnt(24) lgkmcnt(0)
  s_barrier
  s_load_dwordx2 s[8:9], s[0:1], 72
  s_mov_b32 s10, 7340032
  s_mov_b32 s11, 0x20000
  s_waitcnt lgkmcnt(0)
  s_add_u32 m0, s41, 0
  s_mov_b32 s42, 0
  buffer_load_dwordx4 v45, s[8:11], s42 offen nt lds
  s_add_u32 m0, s41, 4096
  s_mov_b32 s42, 114688
  buffer_load_dwordx4 v45, s[8:11], s42 offen nt lds
  s_add_u32 m0, s41, 8192
  s_mov_b32 s42, 229376
  buffer_load_dwordx4 v45, s[8:11], s42 offen nt lds
  s_add_u32 m0, s41, 12288
  s_mov_b32 s42, 344064
  buffer_load_dwordx4 v45, s[8:11], s42 offen nt lds
  ds_read_b64_tr_b16 a[16:17], v42 offset:16384
  ds_read_b64_tr_b16 a[18:19], v42 offset:18432
  ds_read_b64_tr_b16 a[20:21], v42 offset:20480
  ds_read_b64_tr_b16 a[22:23], v42 offset:22528
  ds_read_b64_tr_b16 a[24:25], v42 offset:24576
  ds_read_b64_tr_b16 a[26:27], v42 offset:26624
  ds_read_b64_tr_b16 a[28:29], v42 offset:28672
  ds_read_b64_tr_b16 a[30:31], v42 offset:30720
  s_waitcnt vmcnt(24) lgkmcnt(0)
  s_barrier
  s_add_u32 m0, s41, 16384
  s_mov_b32 s42, 917504
  buffer_load_dwordx4 v45, s[8:11], s42 offen nt lds
  s_add_u32 m0, s41, 20480
  s_mov_b32 s42, 1032192
  buffer_load_dwordx4 v45, s[8:11], s42 offen nt lds
  s_add_u32 m0, s41, 24576
  s_mov_b32 s42, 1146880
  buffer_load_dwordx4 v45, s[8:11], s42 offen nt lds
  s_add_u32 m0, s41, 28672
  s_mov_b32 s42, 1261568
  buffer_load_dwordx4 v45, s[8:11], s42 offen nt lds
  ds_read_b64_tr_b16 a[32:33], v42 offset:32768
  ds_read_b64_tr_b16 a[34:35], v42 offset:34816
  ds_read_b64_tr_b16 a[36:37], v42 offset:36864
  ds_read_b64_tr_b16 a[38:39], v42 offset:38912
  ds_read_b64_tr_b16 a[40:41], v42 offset:40960
  ds_read_b64_tr_b16 a[42:43], v42 offset:43008
  ds_read_b64_tr_b16 a[44:45], v42 offset:45056
  ds_read_b64_tr_b16 a[46:47], v42 offset:47104
  s_waitcnt vmcnt(24) lgkmcnt(0)
  s_barrier
  s_add_u32 m0, s41, 32768
  s_mov_b32 s42, 1835008
  buffer_load_dwordx4 v45, s[8:11], s42 offen nt lds
  s_add_u32 m0, s41, 36864
  s_mov_b32 s42, 1949696
  buffer_load_dwordx4 v45, s[8:11], s42 offen nt lds
  s_add_u32 m0, s41, 40960
  s_mov_b32 s42, 2064384
  buffer_load_dwordx4 v45, s[8:11], s42 offen nt lds
  s_add_u32 m0, s41, 45056
  s_mov_b32 s42, 2179072
  buffer_load_dwordx4 v45, s[8:11], s42 offen nt lds
  ds_read_b64_tr_b16 a[48:49], v42 offset:49152
  ds_read_b64_tr_b16 a[50:51], v42 offset:51200
  ds_read_b64_tr_b16 a[52:53], v42 offset:53248
  ds_read_b64_tr_b16 a[54:55], v42 offset:55296
  ds_read_b64_tr_b16 a[56:57], v42 offset:57344
  ds_read_b64_tr_b16 a[58:59], v42 offset:59392
  ds_read_b64_tr_b16 a[60:61], v42 offset:61440
  ds_read_b64_tr_b16 a[62:63], v42 offset:63488
  s_waitcnt vmcnt(24) lgkmcnt(0)
  s_barrier
  s_add_u32 m0, s41, 49152
  s_mov_b32 s42, 2752512
  buffer_load_dwordx4 v45, s[8:11], s42 offen nt lds
  s_add_u32 m0, s41, 53248
  s_mov_b32 s42, 2867200
  buffer_load_dwordx4 v45, s[8:11], s42 offen nt lds
  s_add_u32 m0, s41, 57344
  s_mov_b32 s42, 2981888
  buffer_load_dwordx4 v45, s[8:11], s42 offen nt lds
  s_add_u32 m0, s41, 61440
  s_mov_b32 s42, 3096576
  buffer_load_dwordx4 v45, s[8:11], s42 offen nt lds
  ds_read_b64_tr_b16 a[64:65], v43 offset:0
  ds_read_b64_tr_b16 a[66:67], v43 offset:2048
  ds_read_b64_tr_b16 a[68:69], v43 offset:4096
  ds_read_b64_tr_b16 a[70:71], v43 offset:6144
  ds_read_b64_tr_b16 a[72:73], v43 offset:8192
  ds_read_b64_tr_b16 a[74:75], v43 offset:10240
  ds_read_b64_tr_b16 a[76:77], v43 offset:12288
  ds_read_b64_tr_b16 a[78:79], v43 offset:14336
  s_waitcnt vmcnt(24) lgkmcnt(0)
  s_barrier
  s_add_u32 m0, s41, 65536
  s_mov_b32 s42, 3670016
  buffer_load_dwordx4 v45, s[8:11], s42 offen nt lds
  s_add_u32 m0, s41, 69632
  s_mov_b32 s42, 3784704
  buffer_load_dwordx4 v45, s[8:11], s42 offen nt lds
  s_add_u32 m0, s41, 73728
  s_mov_b32 s42, 3899392
  buffer_load_dwordx4 v45, s[8:11], s42 offen nt lds
  s_add_u32 m0, s41, 77824
  s_mov_b32 s42, 4014080
  buffer_load_dwordx4 v45, s[8:11], s42 offen nt lds
  ds_read_b64_tr_b16 a[80:81], v43 offset:16384
  ds_read_b64_tr_b16 a[82:83], v43 offset:18432
  ds_read_b64_tr_b16 a[84:85], v43 offset:20480
  ds_read_b64_tr_b16 a[86:87], v43 offset:22528
  ds_read_b64_tr_b16 a[88:89], v43 offset:24576
  ds_read_b64_tr_b16 a[90:91], v43 offset:26624
  ds_read_b64_tr_b16 a[92:93], v43 offset:28672
  ds_read_b64_tr_b16 a[94:95], v43 offset:30720
  s_waitcnt vmcnt(24) lgkmcnt(0)
  s_barrier
  s_add_u32 m0, s41, 81920
  s_mov_b32 s42, 4587520
  buffer_load_dwordx4 v45, s[8:11], s42 offen nt lds
  s_add_u32 m0, s41, 86016
  s_mov_b32 s42, 4702208
  buffer_load_dwordx4 v45, s[8:11], s42 offen nt lds
  s_add_u32 m0, s41, 90112
  s_mov_b32 s42, 4816896
  buffer_load_dwordx4 v45, s[8:11], s42 offen nt lds
  s_add_u32 m0, s41, 94208
  s_mov_b32 s42, 4931584
  buffer_load_dwordx4 v45, s[8:11], s42 offen nt lds
  ds_read_b64_tr_b16 a[96:97], v43 offset:32768
  ds_read_b64_tr_b16 a[98:99], v43 offset:34816
  ds_read_b64_tr_b16 a[100:101], v43 offset:36864
  ds_read_b64_tr_b16 a[102:103], v43 offset:38912
  ds_read_b64_tr_b16 a[104:105], v43 offset:40960
  ds_read_b64_tr_b16 a[106:107], v43 offset:43008
  ds_read_b64_tr_b16 a[108:109], v43 offset:45056
  ds_read_b64_tr_b16 a[110:111], v43 offset:47104
  s_waitcnt vmcnt(24) lgkmcnt(0)
  s_barrier
  s_add_u32 m0, s41, 98304
  s_mov_b32 s42, 5505024
  buffer_load_dwordx4 v45, s[8:11], s42 offen nt lds
  s_add_u32 m0, s41, 102400
  s_mov_b32 s42, 5619712
  buffer_load_dwordx4 v45, s[8:11], s42 offen nt lds
  s_add_u32 m0, s41, 106496
  s_mov_b32 s42, 5734400
  buffer_load_dwordx4 v45, s[8:11], s42 offen nt lds
  s_add_u32 m0, s41, 110592
  s_mov_b32 s42, 5849088
  buffer_load_dwordx4 v45, s[8:11], s42 offen nt lds
  ds_read_b64_tr_b16 a[112:113], v43 offset:49152
  ds_read_b64_tr_b16 a[114:115], v43 offset:51200
  ds_read_b64_tr_b16 a[116:117], v43 offset:53248
  ds_read_b64_tr_b16 a[118:119], v43 offset:55296
  ds_read_b64_tr_b16 a[120:121], v43 offset:57344
  ds_read_b64_tr_b16 a[122:123], v43 offset:59392
  ds_read_b64_tr_b16 a[124:125], v43 offset:61440
  ds_read_b64_tr_b16 a[126:127], v43 offset:63488
  s_waitcnt vmcnt(24) lgkmcnt(0)
  s_barrier
  s_add_u32 m0, s41, 114688
  s_mov_b32 s42, 6422528
  buffer_load_dwordx4 v45, s[8:11], s42 offen nt lds
  s_add_u32 m0, s41, 118784
  s_mov_b32 s42, 6537216
  buffer_load_dwordx4 v45, s[8:11], s42 offen nt lds
  s_add_u32 m0, s41, 122880
  s_mov_b32 s42, 6651904
  buffer_load_dwordx4 v45, s[8:11], s42 offen nt lds
  s_add_u32 m0, s41, 126976
  s_mov_b32 s42, 6766592
  buffer_load_dwordx4 v45, s[8:11], s42 offen nt lds
  ds_read_b64_tr_b16 a[128:129], v42 offset:0
  ds_read_b64_tr_b16 a[130:131], v42 offset:2048
  ds_read_b64_tr_b16 a[132:133], v42 offset:4096
  ds_read_b64_tr_b16 a[134:135], v42 offset:6144
  ds_read_b64_tr_b16 a[136:137], v42 offset:8192
  ds_read_b64_tr_b16 a[138:139], v42 offset:10240
  ds_read_b64_tr_b16 a[140:141], v42 offset:12288
  ds_read_b64_tr_b16 a[142:143], v42 offset:14336
  s_waitcnt vmcnt(24) lgkmcnt(0)
  s_barrier
  ds_read_b64_tr_b16 a[144:145], v42 offset:16384
  ds_read_b64_tr_b16 a[146:147], v42 offset:18432
  ds_read_b64_tr_b16 a[148:149], v42 offset:20480
  ds_read_b64_tr_b16 a[150:151], v42 offset:22528
  ds_read_b64_tr_b16 a[152:153], v42 offset:24576
  ds_read_b64_tr_b16 a[154:155], v42 offset:26624
  ds_read_b64_tr_b16 a[156:157], v42 offset:28672
  ds_read_b64_tr_b16 a[158:159], v42 offset:30720
  s_waitcnt vmcnt(20) lgkmcnt(0)
  s_barrier
  ds_read_b64_tr_b16 a[160:161], v42 offset:32768
  ds_read_b64_tr_b16 a[162:163], v42 offset:34816
  ds_read_b64_tr_b16 a[164:165], v42 offset:36864
  ds_read_b64_tr_b16 a[166:167], v42 offset:38912
  ds_read_b64_tr_b16 a[168:169], v42 offset:40960
  ds_read_b64_tr_b16 a[170:171], v42 offset:43008
  ds_read_b64_tr_b16 a[172:173], v42 offset:45056
  ds_read_b64_tr_b16 a[174:175], v42 offset:47104
  s_waitcnt vmcnt(16) lgkmcnt(0)
  s_barrier
  ds_read_b64_tr_b16 a[176:177], v42 offset:49152
  ds_read_b64_tr_b16 a[178:179], v42 offset:51200
  ds_read_b64_tr_b16 a[180:181], v42 offset:53248
  ds_read_b64_tr_b16 a[182:183], v42 offset:55296
  ds_read_b64_tr_b16 a[184:185], v42 offset:57344
  ds_read_b64_tr_b16 a[186:187], v42 offset:59392
  ds_read_b64_tr_b16 a[188:189], v42 offset:61440
  ds_read_b64_tr_b16 a[190:191], v42 offset:63488
  s_waitcnt vmcnt(12) lgkmcnt(0)
  s_barrier
  ds_read_b64_tr_b16 a[192:193], v43 offset:0
  ds_read_b64_tr_b16 a[194:195], v43 offset:2048
  ds_read_b64_tr_b16 a[196:197], v43 offset:4096
  ds_read_b64_tr_b16 a[198:199], v43 offset:6144
  ds_read_b64_tr_b16 a[200:201], v43 offset:8192
  ds_read_b64_tr_b16 a[202:203], v43 offset:10240
  ds_read_b64_tr_b16 a[204:205], v43 offset:12288
  ds_read_b64_tr_b16 a[206:207], v43 offset:14336
  s_waitcnt vmcnt(8) lgkmcnt(0)
  s_barrier
  ds_read_b64_tr_b16 a[208:209], v43 offset:16384
  ds_read_b64_tr_b16 a[210:211], v43 offset:18432
  ds_read_b64_tr_b16 a[212:213], v43 offset:20480
  ds_read_b64_tr_b16 a[214:215], v43 offset:22528
  ds_read_b64_tr_b16 a[216:217], v43 offset:24576
  ds_read_b64_tr_b16 a[218:219], v43 offset:26624
  ds_read_b64_tr_b16 a[220:221], v43 offset:28672
  ds_read_b64_tr_b16 a[222:223], v43 offset:30720
  s_waitcnt vmcnt(4) lgkmcnt(0)
  s_barrier
  ds_read_b64_tr_b16 a[224:225], v43 offset:32768
  ds_read_b64_tr_b16 a[226:227], v43 offset:34816
  ds_read_b64_tr_b16 a[228:229], v43 offset:36864
  ds_read_b64_tr_b16 a[230:231], v43 offset:38912
  ds_read_b64_tr_b16 a[232:233], v43 offset:40960
  ds_read_b64_tr_b16 a[234:235], v43 offset:43008
  ds_read_b64_tr_b16 a[236:237], v43 offset:45056
  ds_read_b64_tr_b16 a[238:239], v43 offset:47104
  s_waitcnt vmcnt(0) lgkmcnt(0)
  s_barrier
  ds_read_b64_tr_b16 a[240:241], v43 offset:49152
  ds_read_b64_tr_b16 a[242:243], v43 offset:51200
  ds_read_b64_tr_b16 a[244:245], v43 offset:53248
  ds_read_b64_tr_b16 a[246:247], v43 offset:55296
  ds_read_b64_tr_b16 a[248:249], v43 offset:57344
  ds_read_b64_tr_b16 a[250:251], v43 offset:59392
  ds_read_b64_tr_b16 a[252:253], v43 offset:61440
  ds_read_b64_tr_b16 a[254:255], v43 offset:63488
  s_waitcnt lgkmcnt(0)
  s_barrier
  v_min_u32 v2, 7, v0
  v_lshlrev_b32 v2, 7, v2
  v_add_u32 v2, 1413120, v2
  s_lshl_b32 s62, s21, 7
  s_add_u32 s62, s62, 1414144
  s_mov_b32 s27, 6291456
  s_lshl_b32 s40, s21, 12
  s_add_u32 s31, s40, 23068672
  s_lshr_b32 s40, s20, 1
  s_lshl_b32 s40, s40, 11
  s_and_b32 s41, s20, 1
  s_lshl_b32 s41, s41, 9
  s_add_u32 s40, s40, s41
  v_and_b32 v52, 31, v0
  v_lshl_add_u32 v68, v52, 4, s40
  v_lshrrev_b32 v52, 5, v0
  v_lshl_add_u32 v68, v52, 10, v68
  s_mov_b32 s37, 0xbfb8aa3b
  v_lshlrev_b32 v1, 4, v0
  s_lshl_b32 s32, s20, 12
  s_mul_i32 s33, s20, 3072
  v_mov_b32 v69, v1
  v_add_u32 v70, 0x10000, v69
  v_and_b32 v1, 3, v0
  v_lshlrev_b32 v1, 4, v1
  v_lshrrev_b32 v52, 4, v0
  v_lshl_add_u32 v1, v52, 6, v1
  v_bfe_u32 v52, v0, 2, 2
  v_lshl_add_u32 v1, v52, 8, v1
  v_lshlrev_b32 v71, 2, v0
  v_add_u32 v71, 131072, v71
  s_mov_b32 s25, 0
  s_mov_b32 s26, 0
  s_mov_b32 s29, 1
  s_mov_b32 s30, 0
  s_mov_b32 s28, 0
L_F1_top:
  s_cmp_lg_u32 s28, 0
  s_cbranch_scc1 L_F1_go
  s_cmp_lg_u32 s20, 0
  s_cbranch_scc1 L_F1_park
  buffer_load_dword v3, v2, s[4:7], s30 offen sc1
  s_waitcnt vmcnt(1)
  s_barrier
  s_mov_b32 s63, s25
  s_atomic_smax s63, s[4:5], s62 glc
Lnosig_36:
  s_cmp_ge_u32 s25, 64
  s_cbranch_scc1 L_END
  s_waitcnt vmcnt(0)
  v_cmp_gt_i32 vcc, s29, v3
  s_cbranch_vccz L_F1_issue
  s_nop 3
Lpoll_37:
  buffer_load_dword v3, v2, s[4:7], s30 offen sc1
  s_sub_u32 s24, s24, 1
  s_cbranch_scc1 L_FAIL
  s_waitcnt vmcnt(0)
  v_cmp_gt_i32 vcc, s29, v3
  s_cbranch_vccz Lpolld_38
  s_sleep 1
  s_branch Lpoll_37
Lpolld_38:
  s_branch L_F1_issue
L_F1_park:
  s_waitcnt vmcnt(0)
  s_barrier
  s_cmp_ge_u32 s25, 64
  s_cbranch_scc1 L_END
L_F1_issue:
  s_barrier
  s_mov_b32 s34, s26
  s_mov_b32 s35, s27
  s_add_u32 s36, s32, 0
  s_add_u32 m0, s34, s36
  s_add_u32 s36, s35, s36
  buffer_load_dwordx4 v1, s[4:7], s36 offen offset:0 sc1 lds
  buffer_load_dwordx4 v1, s[4:7], s36 offen offset:1024 sc1 lds
  buffer_load_dwordx4 v1, s[4:7], s36 offen offset:2048 sc1 lds
  buffer_load_dwordx4 v1, s[4:7], s36 offen offset:3072 sc1 lds
  s_add_u32 s36, s32, 16384
  s_add_u32 m0, s34, s36
  s_add_u32 s36, s35, s36
  buffer_load_dwordx4 v1, s[4:7], s36 offen offset:0 sc1 lds
  buffer_load_dwordx4 v1, s[4:7], s36 offen offset:1024 sc1 lds
  buffer_load_dwordx4 v1, s[4:7], s36 offen offset:2048 sc1 lds
  buffer_load_dwordx4 v1, s[4:7], s36 offen offset:3072 sc1 lds
  s_add_u32 s36, s32, 32768
  s_add_u32 m0, s34, s36
  s_add_u32 s36, s35, s36
  buffer_load_dwordx4 v1, s[4:7], s36 offen offset:0 sc1 lds
  buffer_load_dwordx4 v1, s[4:7], s36 offen offset:1024 sc1 lds
  buffer_load_dwordx4 v1, s[4:7], s36 offen offset:2048 sc1 lds
  buffer_load_dwordx4 v1, s[4:7], s36 offen offset:3072 sc1 lds
L_F1_go:
  v_add_u32 v73, s26, v69
  v_add_u32 v74, s26, v70
  s_sub_u32 s26, 65536, s26
  s_add_u32 s27, s27, 65536
  s_add_u32 s29, s29, 1
  s_waitcnt vmcnt(8)
  s_barrier
  ds_read_b128 v[4:7], v73 offset:0
  ds_read_b128 v[8:11], v73 offset:1024
  ds_read_b128 v[12:15], v73 offset:2048
  ds_read_b128 v[16:19], v73 offset:3072
  ds_read_b128 v[20:23], v73 offset:4096
  ds_read_b128 v[24:27], v73 offset:5120
  s_waitcnt lgkmcnt(4)
  v_mfma_f32_16x16x32_bf16 v[36:39], a[0:3], v[4:7], 0
  ds_read_b128 v[28:31], v73 offset:6144
  v_mfma_f32_16x16x32_bf16 v[40:43], a[0:3], v[8:11], 0
  ds_read_b128 v[32:35], v73 offset:7168
  v_mfma_f32_16x16x32_bf16 v[44:47], a[128:131], v[4:7], 0
  s_add_u32 s36, s32, 49152
  s_add_u32 m0, s34, s36
  s_add_u32 s36, s35, s36
  buffer_load_dwordx4 v1, s[4:7], s36 offen offset:0 sc1 lds
  v_mfma_f32_16x16x32_bf16 v[48:51], a[128:131], v[8:11], 0
  s_waitcnt lgkmcnt(4)
  v_mfma_f32_16x16x32_bf16 v[36:39], a[4:7], v[12:15], v[36:39]
  ds_read_b128 v[4:7], v73 offset:8192
  v_mfma_f32_16x16x32_bf16 v[40:43], a[4:7], v[16:19], v[40:43]
  ds_read_b128 v[8:11], v73 offset:9216
  v_mfma_f32_16x16x32_bf16 v[44:47], a[132:135], v[12:15], v[44:47]
  buffer_load_dwordx4 v1, s[4:7], s36 offen offset:1024 sc1 lds
  v_mfma_f32_16x16x32_bf16 v[48:51], a[132:135], v[16:19], v[48:51]
  s_waitcnt lgkmcnt(4)
  v_mfma_f32_16x16x32_bf16 v[36:39], a[8:11], v[20:23], v[36:39]
  ds_read_b128 v[12:15], v73 offset:10240
  v_mfma_f32_16x16x32_bf16 v[40:43], a[8:11], v[24:27], v[40:43]
  ds_read_b128 v[16:19], v73 offset:11264
  v_mfma_f32_16x16x32_bf16 v[44:47], a[136:139], v[20:23], v[44:47]
  buffer_load_dwordx4 v1, s[4:7], s36 offen offset:2048 sc1 lds
  v_mfma_f32_16x16x32_bf16 v[48:51], a[136:139], v[24:27], v[48:51]
  s_waitcnt lgkmcnt(4)
  v_mfma_f32_16x16x32_bf16 v[36:39], a[12:15], v[28:31], v[36:39]
  ds_read_b128 v[20:23], v73 offset:12288
  v_mfma_f32_16x16x32_bf16 v[40:43], a[12:15], v[32:35], v[40:43]
  ds_read_b128 v[24:27], v73 offset:13312
  v_mfma_f32_16x16x32_bf16 v[44:47], a[140:143], v[28:31], v[44:47]
  buffer_load_dwordx4 v1, s[4:7], s36 offen offset:3072 sc1 lds
  v_mfma_f32_16x16x32_bf16 v[48:51], a[140:143], v[32:35], v[48:51]
  s_waitcnt lgkmcnt(4)
  v_mfma_f32_16x16x32_bf16 v[36:39], a[16:19], v[4:7], v[36:39]
  ds_read_b128 v[28:31], v73 offset:14336
  v_mfma_f32_16x16x32_bf16 v[40:43], a[16:19], v[8:11], v[40:43]
  ds_read_b128 v[32:35], v73 offset:15360
  v_mfma_f32_16x16x32_bf16 v[44:47], a[144:147], v[4:7], v[44:47]
  v_mfma_f32_16x16x32_bf16 v[48:51], a[144:147], v[8:11], v[48:51]
  s_waitcnt vmcnt(8)
  s_barrier
  s_lshl_b32 s40, s20, 8
  s_add_u32 m0, s40, 131072
  s_cmp_eq_u32 s20, 0
  s_cselect_b32 s40, s30, 2147483392
  buffer_load_dword v2, s[4:7], s40 offen sc1 lds
  s_mov_b32 s34, s26
  s_mov_b32 s35, s27
  s_waitcnt lgkmcnt(4)
  v_mfma_f32_16x16x32_bf16 v[36:39], a[20:23], v[12:15], v[36:39]
  ds_read_b128 v[4:7], v73 offset:16384
  v_mfma_f32_16x16x32_bf16 v[40:43], a[20:23], v[16:19], v[40:43]
  ds_read_b128 v[8:11], v73 offset:17408
  v_mfma_f32_16x16x32_bf16 v[44:47], a[148:151], v[12:15], v[44:47]
  v_mfma_f32_16x16x32_bf16 v[48:51], a[148:151], v[16:19], v[48:51]
  s_waitcnt lgkmcnt(4)
  v_mfma_f32_16x16x32_bf16 v[36:39], a[24:27], v[20:23], v[36:39]
  ds_read_b128 v[12:15], v73 offset:18432
  v_mfma_f32_16x16x32_bf16 v[40:43], a[24:27], v[24:27], v[40:43]
  ds_read_b128 v[16:19], v73 offset:19456
  v_mfma_f32_16x16x32_bf16 v[44:47], a[152:155], v[20:23], v[44:47]
  v_mfma_f32_16x16x32_bf16 v[48:51], a[152:155], v[24:27], v[48:51]
  s_waitcnt lgkmcnt(4)
  v_mfma_f32_16x16x32_bf16 v[36:39], a[28:31], v[28:31], v[36:39]
  ds_read_b128 v[20:23], v73 offset:20480
  v_mfma_f32_16x16x32_bf16 v[40:43], a[28:31], v[32:35], v[40:43]
  ds_read_b128 v[24:27], v73 offset:21504
  v_mfma_f32_16x16x32_bf16 v[44:47], a[156:159], v[28:31], v[44:47]
  v_mfma_f32_16x16x32_bf16 v[48:51], a[156:159], v[32:35], v[48:51]
  s_waitcnt lgkmcnt(4)
  v_mfma_f32_16x16x32_bf16 v[36:39], a[32:35], v[4:7], v[36:39]
  ds_read_b128 v[28:31], v73 offset:22528
  v_mfma_f32_16x16x32_bf16 v[40:43], a[32:35], v[8:11], v[40:43]
  ds_read_b128 v[32:35], v73 offset:23552
  v_mfma_f32_16x16x32_bf16 v[44:47], a[160:163], v[4:7], v[44:47]
  v_mfma_f32_16x16x32_bf16 v[48:51], a[160:163], v[8:11], v[48:51]
  s_waitcnt lgkmcnt(4)
  v_mfma_f32_16x16x32_bf16 v[36:39], a[36:39], v[12:15], v[36:39]
  ds_read_b128 v[4:7], v73 offset:24576
  v_mfma_f32_16x16x32_bf16 v[40:43], a[36:39], v[16:19], v[40:43]
  ds_read_b128 v[8:11], v73 offset:25600
  v_mfma_f32_16x16x32_bf16 v[44:47], a[164:167], v[12:15], v[44:47]
  v_mfma_f32_16x16x32_bf16 v[48:51], a[164:167], v[16:19], v[48:51]
  s_waitcnt lgkmcnt(4)
  v_mfma_f32_16x16x32_bf16 v[36:39], a[40:43], v[20:23], v[36:39]
  ds_read_b128 v[12:15], v73 offset:26624
  v_mfma_f32_16x16x32_bf16 v[40:43], a[40:43], v[24:27], v[40:43]
  ds_read_b128 v[16:19], v73 offset:27648
  v_mfma_f32_16x16x32_bf16 v[44:47], a[168:171], v[20:23], v[44:47]
  v_mfma_f32_16x16x32_bf16 v[48:51], a[168:171], v[24:27], v[48:51]
  s_waitcnt lgkmcnt(4)
  v_mfma_f32_16x16x32_bf16 v[36:39], a[44:47], v[28:31], v[36:39]
  ds_read_b128 v[20:23], v73 offset:28672
  v_mfma_f32_16x16x32_bf16 v[40:43], a[44:47], v[32:35], v[40:43]
  ds_read_b128 v[24:27], v73 offset:29696
  v_mfma_f32_16x16x32_bf16 v[44:47], a[172:175], v[28:31], v[44:47]
  v_mfma_f32_16x16x32_bf16 v[48:51], a[172:175], v[32:35], v[48:51]
  s_waitcnt lgkmcnt(4)
  v_mfma_f32_16x16x32_bf16 v[36:39], a[48:51], v[4:7], v[36:39]
  ds_read_b128 v[28:31], v73 offset:30720
  v_mfma_f32_16x16x32_bf16 v[40:43], a[48:51], v[8:11], v[40:43]
  ds_read_b128 v[32:35], v73 offset:31744
  v_mfma_f32_16x16x32_bf16 v[44:47], a[176:179], v[4:7], v[44:47]
  v_mfma_f32_16x16x32_bf16 v[48:51], a[176:179], v[8:11], v[48:51]
  s_waitcnt vmcnt(6)
  s_cmp_lg_u32 s28, 0
  s_cbranch_scc1 L_F1_b2
  s_waitcnt vmcnt(5)
L_F1_b2:
  s_barrier
  s_waitcnt lgkmcnt(4)
  v_mfma_f32_16x16x32_bf16 v[36:39], a[52:55], v[12:15], v[36:39]
  ds_read_b128 v[4:7], v73 offset:32768
  v_mfma_f32_16x16x32_bf16 v[40:43], a[52:55], v[16:19], v[40:43]
  ds_read_b128 v[8:11], v73 offset:33792
  v_mfma_f32_16x16x32_bf16 v[44:47], a[180:183], v[12:15], v[44:47]
  v_mfma_f32_16x16x32_bf16 v[48:51], a[180:183], v[16:19], v[48:51]
  s_waitcnt lgkmcnt(4)
  v_mfma_f32_16x16x32_bf16 v[36:39], a[56:59], v[20:23], v[36:39]
  ds_read_b128 v[12:15], v73 offset:34816
  v_mfma_f32_16x16x32_bf16 v[40:43], a[56:59], v[24:27], v[40:43]
  ds_read_b128 v[16:19], v73 offset:35840
  v_mfma_f32_16x16x32_bf16 v[44:47], a[184:187], v[20:23], v[44:47]
  v_mfma_f32_16x16x32_bf16 v[48:51], a[184:187], v[24:27], v[48:51]
  s_waitcnt lgkmcnt(4)
  v_mfma_f32_16x16x32_bf16 v[36:39], a[60:63], v[28:31], v[36:39]
  ds_read_b128 v[20:23], v73 offset:36864
  v_mfma_f32_16x16x32_bf16 v[40:43], a[60:63], v[32:35], v[40:43]
  ds_read_b128 v[24:27], v73 offset:37888
  v_mfma_f32_16x16x32_bf16 v[44:47], a[188:191], v[28:31], v[44:47]
  v_mfma_f32_16x16x32_bf16 v[48:51], a[188:191], v[32:35], v[48:51]
  s_waitcnt lgkmcnt(4)
  v_mfma_f32_16x16x32_bf16 v[36:39], a[64:67], v[4:7], v[36:39]
  ds_read_b128 v[28:31], v73 offset:38912
  v_mfma_f32_16x16x32_bf16 v[40:43], a[64:67], v[8:11], v[40:43]
  ds_read_b128 v[32:35], v73 offset:39936
  v_mfma_f32_16x16x32_bf16 v[44:47], a[192:195], v[4:7], v[44:47]
  v_mfma_f32_16x16x32_bf16 v[48:51], a[192:195], v[8:11], v[48:51]
  s_waitcnt lgkmcnt(4)
  v_mfma_f32_16x16x32_bf16 v[36:39], a[68:71], v[12:15], v[36:39]
  ds_read_b128 v[4:7], v73 offset:40960
  v_mfma_f32_16x16x32_bf16 v[40:43], a[68:71], v[16:19], v[40:43]
  ds_read_b128 v[8:11], v73 offset:41984
  v_mfma_f32_16x16x32_bf16 v[44:47], a[196:199], v[12:15], v[44:47]
  v_mfma_f32_16x16x32_bf16 v[48:51], a[196:199], v[16:19], v[48:51]
  s_waitcnt lgkmcnt(4)
  v_mfma_f32_16x16x32_bf16 v[36:39], a[72:75], v[20:23], v[36:39]
  ds_read_b128 v[12:15], v73 offset:43008
  v_mfma_f32_16x16x32_bf16 v[40:43], a[72:75], v[24:27], v[40:43]
  ds_read_b128 v[16:19], v73 offset:44032
  v_mfma_f32_16x16x32_bf16 v[44:47], a[200:203], v[20:23], v[44:47]
  v_mfma_f32_16x16x32_bf16 v[48:51], a[200:203], v[24:27], v[48:51]
  s_waitcnt vmcnt(0)
  s_barrier
  ds_read_b32 v3, v71
  s_lshl_b32 s40, s20, 1
  s_add_u32 s40, s40, 1
  s_cmp_lg_u32 s40, s28
  s_cbranch_scc1 L_F1_s2
  s_mov_b32 s63, s25
  s_atomic_smax s63, s[4:5], s62 glc
Lnosig_39:
L_F1_s2:
  s_waitcnt lgkmcnt(4)
  v_mfma_f32_16x16x32_bf16 v[36:39], a[76:79], v[28:31], v[36:39]
  ds_read_b128 v[20:23], v73 offset:45056
  v_mfma_f32_16x16x32_bf16 v[40:43], a[76:79], v[32:35], v[40:43]
  ds_read_b128 v[24:27], v73 offset:46080
  v_mfma_f32_16x16x32_bf16 v[44:47], a[204:207], v[28:31], v[44:47]
  v_mfma_f32_16x16x32_bf16 v[48:51], a[204:207], v[32:35], v[48:51]
  s_waitcnt lgkmcnt(4)
  v_mfma_f32_16x16x32_bf16 v[36:39], a[80:83], v[4:7], v[36:39]
  ds_read_b128 v[28:31], v73 offset:47104
  v_mfma_f32_16x16x32_bf16 v[40:43], a[80:83], v[8:11], v[40:43]
  ds_read_b128 v[32:35], v73 offset:48128
  v_mfma_f32_16x16x32_bf16 v[44:47], a[208:211], v[4:7], v[44:47]
  v_mfma_f32_16x16x32_bf16 v[48:51], a[208:211], v[8:11], v[48:51]
  s_waitcnt lgkmcnt(4)
  v_cmp_gt_i32 vcc, s29, v3
  s_mov_b32 s28, 0
  s_cbranch_vccnz L_F1_nopf
  s_cmp_ge_u32 s25, 63
  s_cbranch_scc1 L_F1_nopf
  s_mov_b32 s28, 1
  s_waitcnt lgkmcnt(4)
  v_mfma_f32_16x16x32_bf16 v[36:39], a[84:87], v[12:15], v[36:39]
  ds_read_b128 v[4:7], v73 offset:49152
  v_mfma_f32_16x16x32_bf16 v[40:43], a[84:87], v[16:19], v[40:43]
  ds_read_b128 v[8:11], v73 offset:50176
  v_mfma_f32_16x16x32_bf16 v[44:47], a[212:215], v[12:15], v[44:47]
  s_add_u32 s36, s32, 0
  s_add_u32 m0, s34, s36
  s_add_u32 s36, s35, s36
  buffer_load_dwordx4 v1, s[4:7], s36 offen offset:0 sc1 lds
  v_mfma_f32_16x16x32_bf16 v[48:51], a[212:215], v[16:19], v[48:51]
  buffer_load_dwordx4 v1, s[4:7], s36 offen offset:1024 sc1 lds
  s_waitcnt lgkmcnt(4)
  v_mfma_f32_16x16x32_bf16 v[36:39], a[88:91], v[20:23], v[36:39]
  ds_read_b128 v[12:15], v73 offset:51200
  v_mfma_f32_16x16x32_bf16 v[40:43], a[88:91], v[24:27], v[40:43]
  ds_read_b128 v[16:19], v73 offset:52224
  v_mfma_f32_16x16x32_bf16 v[44:47], a[216:219], v[20:23], v[44:47]
  buffer_load_dwordx4 v1, s[4:7], s36 offen offset:2048 sc1 lds
  v_mfma_f32_16x16x32_bf16 v[48:51], a[216:219], v[24:27], v[48:51]
  buffer_load_dwordx4 v1, s[4:7], s36 offen offset:3072 sc1 lds
  s_waitcnt lgkmcnt(4)
  v_mfma_f32_16x16x32_bf16 v[36:39], a[92:95], v[28:31], v[36:39]
  ds_read_b128 v[20:23], v73 offset:53248
  v_mfma_f32_16x16x32_bf16 v[40:43], a[92:95], v[32:35], v[40:43]
  ds_read_b128 v[24:27], v73 offset:54272
  v_mfma_f32_16x16x32_bf16 v[44:47], a[220:223], v[28:31], v[44:47]
  s_add_u32 s36, s32, 16384
  s_add_u32 m0, s34, s36
  s_add_u32 s36, s35, s36
  buffer_load_dwordx4 v1, s[4:7], s36 offen offset:0 sc1 lds
  v_mfma_f32_16x16x32_bf16 v[48:51], a[220:223], v[32:35], v[48:51]
  buffer_load_dwordx4 v1, s[4:7], s36 offen offset:1024 sc1 lds
  s_waitcnt lgkmcnt(4)
  v_mfma_f32_16x16x32_bf16 v[36:39], a[96:99], v[4:7], v[36:39]
  ds_read_b128 v[28:31], v73 offset:55296
  v_mfma_f32_16x16x32_bf16 v[40:43], a[96:99], v[8:11], v[40:43]
  ds_read_b128 v[32:35], v73 offset:56320
  v_mfma_f32_16x16x32_bf16 v[44:47], a[224:227], v[4:7], v[44:47]
  buffer_load_dwordx4 v1, s[4:7], s36 offen offset:2048 sc1 lds
  v_mfma_f32_16x16x32_bf16 v[48:51], a[224:227], v[8:11], v[48:51]
  buffer_load_dwordx4 v1, s[4:7], s36 offen offset:3072 sc1 lds
  s_waitcnt lgkmcnt(4)
  v_mfma_f32_16x16x32_bf16 v[36:39], a[100:103], v[12:15], v[36:39]
  ds_read_b128 v[4:7], v73 offset:57344
  v_mfma_f32_16x16x32_bf16 v[40:43], a[100:103], v[16:19], v[40:43]
  ds_read_b128 v[8:11], v73 offset:58368
  v_mfma_f32_16x16x32_bf16 v[44:47], a[228:231], v[12:15], v[44:47]
  s_add_u32 s36, s32, 32768
  s_add_u32 m0, s34, s36
  s_add_u32 s36, s35, s36
  buffer_load_dwordx4 v1, s[4:7], s36 offen offset:0 sc1 lds
  v_mfma_f32_16x16x32_bf16 v[48:51], a[228:231], v[16:19], v[48:51]
  buffer_load_dwordx4 v1, s[4:7], s36 offen offset:1024 sc1 lds
  s_waitcnt lgkmcnt(4)
  v_mfma_f32_16x16x32_bf16 v[36:39], a[104:107], v[20:23], v[36:39]
  ds_read_b128 v[12:15], v73 offset:59392
  v_mfma_f32_16x16x32_bf16 v[40:43], a[104:107], v[24:27], v[40:43]
  ds_read_b128 v[16:19], v73 offset:60416
  v_mfma_f32_16x16x32_bf16 v[44:47], a[232:235], v[20:23], v[44:47]
  buffer_load_dwordx4 v1, s[4:7], s36 offen offset:2048 sc1 lds
  v_mfma_f32_16x16x32_bf16 v[48:51], a[232:235], v[24:27], v[48:51]
  buffer_load_dwordx4 v1, s[4:7], s36 offen offset:3072 sc1 lds
  s_waitcnt lgkmcnt(4)
  v_mfma_f32_16x16x32_bf16 v[36:39], a[108:111], v[28:31], v[36:39]
  ds_read_b128 v[20:23], v73 offset:61440
  v_mfma_f32_16x16x32_bf16 v[40:43], a[108:111], v[32:35], v[40:43]
  ds_read_b128 v[24:27], v73 offset:62464
  v_mfma_f32_16x16x32_bf16 v[44:47], a[236:239], v[28:31], v[44:47]
  v_mfma_f32_16x16x32_bf16 v[48:51], a[236:239], v[32:35], v[48:51]
  s_waitcnt lgkmcnt(4)
  v_mfma_f32_16x16x32_bf16 v[36:39], a[112:115], v[4:7], v[36:39]
  ds_read_b128 v[28:31], v73 offset:63488
  v_mfma_f32_16x16x32_bf16 v[40:43], a[112:115], v[8:11], v[40:43]
  ds_read_b128 v[32:35], v73 offset:64512
  v_mfma_f32_16x16x32_bf16 v[44:47], a[240:243], v[4:7], v[44:47]
  v_mfma_f32_16x16x32_bf16 v[48:51], a[240:243], v[8:11], v[48:51]
  s_waitcnt lgkmcnt(4)
  v_mfma_f32_16x16x32_bf16 v[36:39], a[116:119], v[12:15], v[36:39]
  v_mfma_f32_16x16x32_bf16 v[40:43], a[116:119], v[16:19], v[40:43]
  v_mfma_f32_16x16x32_bf16 v[44:47], a[244:247], v[12:15], v[44:47]
  v_mfma_f32_16x16x32_bf16 v[48:51], a[244:247], v[16:19], v[48:51]
  s_waitcnt lgkmcnt(2)
  v_mfma_f32_16x16x32_bf16 v[36:39], a[120:123], v[20:23], v[36:39]
  v_mfma_f32_16x16x32_bf16 v[40:43], a[120:123], v[24:27], v[40:43]
  v_mfma_f32_16x16x32_bf16 v[44:47], a[248:251], v[20:23], v[44:47]
  v_mfma_f32_16x16x32_bf16 v[48:51], a[248:251], v[24:27], v[48:51]
  s_waitcnt lgkmcnt(0)
  v_mfma_f32_16x16x32_bf16 v[36:39], a[124:127], v[28:31], v[36:39]
  v_mfma_f32_16x16x32_bf16 v[40:43], a[124:127], v[32:35], v[40:43]
  v_mfma_f32_16x16x32_bf16 v[44:47], a[252:255], v[28:31], v[44:47]
  v_mfma_f32_16x16x32_bf16 v[48:51], a[252:255], v[32:35], v[48:51]
  s_nop 7
  s_branch L_F1_epi
L_F1_nopf:
  s_waitcnt lgkmcnt(4)
  v_mfma_f32_16x16x32_bf16 v[36:39], a[84:87], v[12:15], v[36:39]
  ds_read_b128 v[4:7], v73 offset:49152
  v_mfma_f32_16x16x32_bf16 v[40:43], a[84:87], v[16:19], v[40:43]
  ds_read_b128 v[8:11], v73 offset:50176
  v_mfma_f32_16x16x32_bf16 v[44:47], a[212:215], v[12:15], v[44:47]
  v_mfma_f32_16x16x32_bf16 v[48:51], a[212:215], v[16:19], v[48:51]
  s_waitcnt lgkmcnt(4)
  v_mfma_f32_16x16x32_bf16 v[36:39], a[88:91], v[20:23], v[36:39]
  ds_read_b128 v[12:15], v73 offset:51200
  v_mfma_f32_16x16x32_bf16 v[40:43], a[88:91], v[24:27], v[40:43]
  ds_read_b128 v[16:19], v73 offset:52224
  v_mfma_f32_16x16x32_bf16 v[44:47], a[216:219], v[20:23], v[44:47]
  v_mfma_f32_16x16x32_bf16 v[48:51], a[216:219], v[24:27], v[48:51]
  s_waitcnt lgkmcnt(4)
  v_mfma_f32_16x16x32_bf16 v[36:39], a[92:95], v[28:31], v[36:39]
  ds_read_b128 v[20:23], v73 offset:53248
  v_mfma_f32_16x16x32_bf16 v[40:43], a[92:95], v[32:35], v[40:43]
  ds_read_b128 v[24:27], v73 offset:54272
  v_mfma_f32_16x16x32_bf16 v[44:47], a[220:223], v[28:31], v[44:47]
  v_mfma_f32_16x16x32_bf16 v[48:51], a[220:223], v[32:35], v[48:51]
  s_waitcnt lgkmcnt(4)
  v_mfma_f32_16x16x32_bf16 v[36:39], a[96:99], v[4:7], v[36:39]
  ds_read_b128 v[28:31], v73 offset:55296
  v_mfma_f32_16x16x32_bf16 v[40:43], a[96:99], v[8:11], v[40:43]
  ds_read_b128 v[32:35], v73 offset:56320
  v_mfma_f32_16x16x32_bf16 v[44:47], a[224:227], v[4:7], v[44:47]
  v_mfma_f32_16x16x32_bf16 v[48:51], a[224:227], v[8:11], v[48:51]
  s_waitcnt lgkmcnt(4)
  v_mfma_f32_16x16x32_bf16 v[36:39], a[100:103], v[12:15], v[36:39]
  ds_read_b128 v[4:7], v73 offset:57344
  v_mfma_f32_16x16x32_bf16 v[40:43], a[100:103], v[16:19], v[40:43]
  ds_read_b128 v[8:11], v73 offset:58368
  v_mfma_f32_16x16x32_bf16 v[44:47], a[228:231], v[12:15], v[44:47]
  v_mfma_f32_16x16x32_bf16 v[48:51], a[228:231], v[16:19], v[48:51]
  s_waitcnt lgkmcnt(4)
  v_mfma_f32_16x16x32_bf16 v[36:39], a[104:107], v[20:23], v[36:39]
  ds_read_b128 v[12:15], v73 offset:59392
  v_mfma_f32_16x16x32_bf16 v[40:43], a[104:107], v[24:27], v[40:43]
  ds_read_b128 v[16:19], v73 offset:60416
  v_mfma_f32_16x16x32_bf16 v[44:47], a[232:235], v[20:23], v[44:47]
  v_mfma_f32_16x16x32_bf16 v[48:51], a[232:235], v[24:27], v[48:51]
  s_waitcnt lgkmcnt(4)
  v_mfma_f32_16x16x32_bf16 v[36:39], a[108:111], v[28:31], v[36:39]
  ds_read_b128 v[20:23], v73 offset:61440
  v_mfma_f32_16x16x32_bf16 v[40:43], a[108:111], v[32:35], v[40:43]
  ds_read_b128 v[24:27], v73 offset:62464
  v_mfma_f32_16x16x32_bf16 v[44:47], a[236:239], v[28:31], v[44:47]
  v_mfma_f32_16x16x32_bf16 v[48:51], a[236:239], v[32:35], v[48:51]
  s_waitcnt lgkmcnt(4)
  v_mfma_f32_16x16x32_bf16 v[36:39], a[112:115], v[4:7], v[36:39]
  ds_read_b128 v[28:31], v73 offset:63488
  v_mfma_f32_16x16x32_bf16 v[40:43], a[112:115], v[8:11], v[40:43]
  ds_read_b128 v[32:35], v73 offset:64512
  v_mfma_f32_16x16x32_bf16 v[44:47], a[240:243], v[4:7], v[44:47]
  v_mfma_f32_16x16x32_bf16 v[48:51], a[240:243], v[8:11], v[48:51]
  s_waitcnt lgkmcnt(4)
  v_mfma_f32_16x16x32_bf16 v[36:39], a[116:119], v[12:15], v[36:39]
  v_mfma_f32_16x16x32_bf16 v[40:43], a[116:119], v[16:19], v[40:43]
  v_mfma_f32_16x16x32_bf16 v[44:47], a[244:247], v[12:15], v[44:47]
  v_mfma_f32_16x16x32_bf16 v[48:51], a[244:247], v[16:19], v[48:51]
  s_waitcnt lgkmcnt(2)
  v_mfma_f32_16x16x32_bf16 v[36:39], a[120:123], v[20:23], v[36:39]
  v_mfma_f32_16x16x32_bf16 v[40:43], a[120:123], v[24:27], v[40:43]
  v_mfma_f32_16x16x32_bf16 v[44:47], a[248:251], v[20:23], v[44:47]
  v_mfma_f32_16x16x32_bf16 v[48:51], a[248:251], v[24:27], v[48:51]
  s_waitcnt lgkmcnt(0)
  v_mfma_f32_16x16x32_bf16 v[36:39], a[124:127], v[28:31], v[36:39]
  v_mfma_f32_16x16x32_bf16 v[40:43], a[124:127], v[32:35], v[40:43]
  v_mfma_f32_16x16x32_bf16 v[44:47], a[252:255], v[28:31], v[44:47]
  v_mfma_f32_16x16x32_bf16 v[48:51], a[252:255], v[32:35], v[48:51]
L_F1_epi:
  s_nop 4
  v_mul_f32 v52, s37, v36
  v_mul_f32 v53, s37, v37
  v_mul_f32 v54, s37, v38
  v_mul_f32 v55, s37, v39
  v_mul_f32 v56, s37, v40
  v_mul_f32 v57, s37, v41
  v_mul_f32 v58, s37, v42
  v_mul_f32 v59, s37, v43
  v_exp_f32 v52, v52
  v_exp_f32 v53, v53
  v_exp_f32 v54, v54
  v_exp_f32 v55, v55
  v_exp_f32 v56, v56
  v_exp_f32 v57, v57
  v_exp_f32 v58, v58
  v_exp_f32 v59, v59
  v_pk_mul_f32 v[36:37], v[36:37], v[44:45]
  v_pk_mul_f32 v[38:39], v[38:39], v[46:47]
  v_pk_mul_f32 v[40:41], v[40:41], v[48:49]
  v_pk_mul_f32 v[42:43], v[42:43], v[50:51]
  v_add_f32 v52, 1.0, v52
  v_add_f32 v53, 1.0, v53
  v_add_f32 v54, 1.0, v54
  v_add_f32 v55, 1.0, v55
  v_add_f32 v56, 1.0, v56
  v_add_f32 v57, 1.0, v57
  v_add_f32 v58, 1.0, v58
  v_add_f32 v59, 1.0, v59
  v_rcp_f32 v52, v52
  v_rcp_f32 v53, v53
  v_rcp_f32 v54, v54
  v_rcp_f32 v55, v55
  v_rcp_f32 v56, v56
  v_rcp_f32 v57, v57
  v_rcp_f32 v58, v58
  v_rcp_f32 v59, v59
  v_pk_mul_f32 v[36:37], v[36:37], v[52:53]
  v_pk_mul_f32 v[38:39], v[38:39], v[54:55]
  v_pk_mul_f32 v[40:41], v[40:41], v[56:57]
  v_pk_mul_f32 v[42:43], v[42:43], v[58:59]
  v_cvt_pk_bf16_f32 v60, v36, v37
  v_cvt_pk_bf16_f32 v61, v38, v39
  v_cvt_pk_bf16_f32 v62, v40, v41
  v_cvt_pk_bf16_f32 v63, v42, v43
  s_nop 0
  v_permlane32_swap_b32 v60, v62
  v_permlane32_swap_b32 v61, v63
  buffer_store_dwordx4 v[60:63], v68, s[4:7], s31 offen sc1
  s_add_u32 s25, s25, 1
  s_add_u32 s31, s31, 229376
  s_branch L_F1_top
L_F2:
  s_load_dwordx2 s[8:9], s[0:1], 80
  s_mov_b32 s10, 7340032
  s_mov_b32 s11, 0x20000
  s_waitcnt lgkmcnt(0)
  s_lshr_b32 s44, s21, 3
  s_mul_i32 s44, s44, 2424832
  s_and_b32 s45, s21, 7
  s_lshl_b32 s45, s45, 8
  s_add_u32 s44, s44, s45
  s_add_u32 s45, s44, 128
  v_bfe_u32 v40, v0, 5, 1
  v_mul_u32_u24 v40, 8192, v40
  v_bfe_u32 v41, v0, 4, 1
  v_mul_u32_u24 v41, 4096, v41
  v_add_u32 v40, v40, v41
  v_bfe_u32 v41, v0, 3, 1
  v_mul_u32_u24 v41, 2048, v41
  v_add_u32 v40, v40, v41
  v_lshrrev_b32 v41, 3, v0
  v_and_b32 v41, 6, v41
  v_xor_b32 v41, v41, v0
  v_and_b32 v41, 7, v41
  v_lshl_add_u32 v40, v41, 4, v40
  s_lshr_b32 s40, s20, 1
  s_mul_i32 s40, s40, 16384
  s_and_b32 s41, s20, 1
  s_mul_i32 s41, s41, 32768
  s_add_u32 s40, s40, s41
  v_add_u32 v40, s40, v40
  v_bfe_u32 v41, v0, 3, 2
  v_xor_b32 v41, s20, v41
  v_lshlrev_b32 v41, 5, v41
  v_lshrrev_b32 v42, 2, v0
  v_lshl_add_u32 v42, v42, 7, v41
  v_and_b32 v41, 3, v0
  v_lshl_add_u32 v42, v41, 3, v42
  v_add_u32 v43, 0x10000, v42
  v_add_u32 v44, s44, v40
  v_add_u32 v45, s45, v40
  s_lshl_b32 s41, s20, 10
  s_add_u32 m0, s41, 0
  s_mov_b32 s42, 0
  buffer_load_dwordx4 v44, s[8:11], s42 offen nt lds
  s_add_u32 m0, s41, 4096
  s_mov_b32 s42, 0
  buffer_load_dwordx4 v45, s[8:11], s42 offen nt lds
  s_add_u32 m0, s41, 8192
  s_mov_b32 s42, 65536
  buffer_load_dwordx4 v44, s[8:11], s42 offen nt lds
  s_add_u32 m0, s41, 12288
  s_mov_b32 s42, 65536
  buffer_load_dwordx4 v45, s[8:11], s42 offen nt lds
  s_add_u32 m0, s41, 16384
  s_mov_b32 s42, 131072
  buffer_load_dwordx4 v44, s[8:11], s42 offen nt lds
  s_add_u32 m0, s41, 20480
  s_mov_b32 s42, 131072
  buffer_load_dwordx4 v45, s[8:11], s42 offen nt lds
  s_add_u32 m0, s41, 24576
  s_mov_b32 s42, 196608
  buffer_load_dwordx4 v44, s[8:11], s42 offen nt lds
  s_add_u32 m0, s41, 28672
  s_mov_b32 s42, 196608
  buffer_load_dwordx4 v45, s[8:11], s42 offen nt lds
  s_add_u32 m0, s41, 32768
  s_mov_b32 s42, 262144
  buffer_load_dwordx4 v44, s[8:11], s42 offen nt lds
  s_add_u32 m0, s41, 36864
  s_mov_b32 s42, 262144
  buffer_load_dwordx4 v45, s[8:11], s42 offen nt lds
  s_add_u32 m0, s41, 40960
  s_mov_b32 s42, 327680
  buffer_load_dwordx4 v44, s[8:11], s42 offen nt lds
  s_add_u32 m0, s41, 45056
  s_mov_b32 s42, 327680
  buffer_load_dwordx4 v45, s[8:11], s42 offen nt lds
  s_add_u32 m0, s41, 49152
  s_mov_b32 s42, 393216
  buffer_load_dwordx4 v44, s[8:11], s42 offen nt lds
  s_add_u32 m0, s41, 53248
  s_mov_b32 s42, 393216
  buffer_load_dwordx4 v45, s[8:11], s42 offen nt lds
  s_add_u32 m0, s41, 57344
  s_mov_b32 s42, 458752
  buffer_load_dwordx4 v44, s[8:11], s42 offen nt lds
  s_add_u32 m0, s41, 61440
  s_mov_b32 s42, 458752
  buffer_load_dwordx4 v45, s[8:11], s42 offen nt lds
  s_add_u32 m0, s41, 65536
  s_mov_b32 s42, 524288
  buffer_load_dwordx4 v44, s[8:11], s42 offen nt lds
  s_add_u32 m0, s41, 69632
  s_mov_b32 s42, 524288
  buffer_load_dwordx4 v45, s[8:11], s42 offen nt lds
  s_add_u32 m0, s41, 73728
  s_mov_b32 s42, 589824
  buffer_load_dwordx4 v44, s[8:11], s42 offen nt lds
  s_add_u32 m0, s41, 77824
  s_mov_b32 s42, 589824
  buffer_load_dwordx4 v45, s[8:11], s42 offen nt lds
  s_add_u32 m0, s41, 81920
  s_mov_b32 s42, 655360
  buffer_load_dwordx4 v44, s[8:11], s42 offen nt lds
  s_add_u32 m0, s41, 86016
  s_mov_b32 s42, 655360
  buffer_load_dwordx4 v45, s[8:11], s42 offen nt lds
  s_add_u32 m0, s41, 90112
  s_mov_b32 s42, 720896
  buffer_load_dwordx4 v44, s[8:11], s42 offen nt lds
  s_add_u32 m0, s41, 94208
  s_mov_b32 s42, 720896
  buffer_load_dwordx4 v45, s[8:11], s42 offen nt lds
  s_add_u32 m0, s41, 98304
  s_mov_b32 s42, 786432
  buffer_load_dwordx4 v44, s[8:11], s42 offen nt lds
  s_add_u32 m0, s41, 102400
  s_mov_b32 s42, 786432
  buffer_load_dwordx4 v45, s[8:11], s42 offen nt lds
  s_add_u32 m0, s41, 106496
  s_mov_b32 s42, 851968
  buffer_load_dwordx4 v44, s[8:11], s42 offen nt lds
  s_add_u32 m0, s41, 110592
  s_mov_b32 s42, 851968
  buffer_load_dwordx4 v45, s[8:11], s42 offen nt lds
  s_waitcnt vmcnt(24) lgkmcnt(0)
  s_barrier
  s_add_u32 m0, s41, 114688
  s_mov_b32 s42, 917504
  buffer_load_dwordx4 v44, s[8:11], s42 offen nt lds
  s_add_u32 m0, s41, 118784
  s_mov_b32 s42, 917504
  buffer_load_dwordx4 v45, s[8:11], s42 offen nt lds
  s_add_u32 m0, s41, 122880
  s_mov_b32 s42, 983040
  buffer_load_dwordx4 v44, s[8:11], s42 offen nt lds
  s_add_u32 m0, s41, 126976
  s_mov_b32 s42, 983040
  buffer_load_dwordx4 v45, s[8:11], s42 offen nt lds
  ds_read_b64_tr_b16 a[0:1], v42 offset:0
  ds_read_b64_tr_b16 a[2:3], v42 offset:2048
  ds_read_b64_tr_b16 a[152:153], v42 offset:4096
  ds_read_b64_tr_b16 a[154:155], v42 offset:6144
  ds_read_b64_tr_b16 a[4:5], v42 offset:8192
  ds_read_b64_tr_b16 a[6:7], v42 offset:10240
  ds_read_b64_tr_b16 a[156:157], v42 offset:12288
  ds_read_b64_tr_b16 a[158:159], v42 offset:14336
  s_waitcnt vmcnt(24) lgkmcnt(0)
  s_barrier
  s_add_u32 m0, s41, 0
  s_mov_b32 s42, 1048576
  buffer_load_dwordx4 v44, s[8:11], s42 offen nt lds
  s_add_u32 m0, s41, 4096
  s_mov_b32 s42, 1048576
  buffer_load_dwordx4 v45, s[8:11], s42 offen nt lds
  s_add_u32 m0, s41, 8192
  s_mov_b32 s42, 1114112
  buffer_load_dwordx4 v44, s[8:11], s42 offen nt lds
  s_add_u32 m0, s41, 12288
  s_mov_b32 s42, 1114112
  buffer_load_dwordx4 v45, s[8:11], s42 offen nt lds
  ds_read_b64_tr_b16 a[8:9], v42 offset:16384
  ds_read_b64_tr_b16 a[10:11], v42 offset:18432
  ds_read_b64_tr_b16 a[160:161], v42 offset:20480
  ds_read_b64_tr_b16 a[162:163], v42 offset:22528
  ds_read_b64_tr_b16 a[12:13], v42 offset:24576
  ds_read_b64_tr_b16 a[14:15], v42 offset:26624
  ds_read_b64_tr_b16 a[164:165], v42 offset:28672
  ds_read_b64_tr_b16 a[166:167], v42 offset:30720
  s_waitcnt vmcnt(24) lgkmcnt(0)
  s_barrier
  s_add_u32 m0, s41, 16384
  s_mov_b32 s42, 1179648
  buffer_load_dwordx4 v44, s[8:11], s42 offen nt lds
  s_add_u32 m0, s41, 20480
  s_mov_b32 s42, 1179648
  buffer_load_dwordx4 v45, s[8:11], s42 offen nt lds
  s_add_u32 m0, s41, 24576
  s_mov_b32 s42, 1245184
  buffer_load_dwordx4 v44, s[8:11], s42 offen nt lds
  s_add_u32 m0, s41, 28672
  s_mov_b32 s42, 1245184
  buffer_load_dwordx4 v45, s[8:11], s42 offen nt lds
  ds_read_b64_tr_b16 a[16:17], v42 offset:32768
  ds_read_b64_tr_b16 a[18:19], v42 offset:34816
  ds_read_b64_tr_b16 a[168:169], v42 offset:36864
  ds_read_b64_tr_b16 a[170:171], v42 offset:38912
  ds_read_b64_tr_b16 a[20:21], v42 offset:40960
  ds_read_b64_tr_b16 a[22:23], v42 offset:43008
  ds_read_b64_tr_b16 a[172:173], v42 offset:45056
  ds_read_b64_tr_b16 a[174:175], v42 offset:47104
  s_waitcnt vmcnt(24) lgkmcnt(0)
  s_barrier
  s_add_u32 m0, s41, 32768
  s_mov_b32 s42, 1310720
  buffer_load_dwordx4 v44, s[8:11], s42 offen nt lds
  s_add_u32 m0, s41, 36864
  s_mov_b32 s42, 1310720
  buffer_load_dwordx4 v45, s[8:11], s42 offen nt lds
  s_add_u32 m0, s41, 40960
  s_mov_b32 s42, 1376256
  buffer_load_dwordx4 v44, s[8:11], s42 offen nt lds
  s_add_u32 m0, s41, 45056
  s_mov_b32 s42, 1376256
  buffer_load_dwordx4 v45, s[8:11], s42 offen nt lds
  ds_read_b64_tr_b16 a[24:25], v42 offset:49152
  ds_read_b64_tr_b16 a[26:27], v42 offset:51200
  ds_read_b64_tr_b16 a[176:177], v42 offset:53248
  ds_read_b64_tr_b16 a[178:179], v42 offset:55296
  ds_read_b64_tr_b16 a[28:29], v42 offset:57344
  ds_read_b64_tr_b16 a[30:31], v42 offset:59392
  ds_read_b64_tr_b16 a[180:181], v42 offset:61440
  ds_read_b64_tr_b16 a[182:183], v42 offset:63488
  s_waitcnt vmcnt(24) lgkmcnt(0)
  s_barrier
  s_add_u32 m0, s41, 49152
  s_mov_b32 s42, 1441792
  buffer_load_dwordx4 v44, s[8:11], s42 offen nt lds
  s_add_u32 m0, s41, 53248
  s_mov_b32 s42, 1441792
  buffer_load_dwordx4 v45, s[8:11], s42 offen nt lds
  s_add_u32 m0, s41, 57344
  s_mov_b32 s42, 1507328
  buffer_load_dwordx4 v44, s[8:11], s42 offen nt lds
  s_add_u32 m0, s41, 61440
  s_mov_b32 s42, 1507328
  buffer_load_dwordx4 v45, s[8:11], s42 offen nt lds
  ds_read_b64_tr_b16 a[32:33], v43 offset:0
  ds_read_b64_tr_b16 a[34:35], v43 offset:2048
  ds_read_b64_tr_b16 a[184:185], v43 offset:4096
  ds_read_b64_tr_b16 a[186:187], v43 offset:6144
  ds_read_b64_tr_b16 a[36:37], v43 offset:8192
  ds_read_b64_tr_b16 a[38:39], v43 offset:10240
  ds_read_b64_tr_b16 a[188:189], v43 offset:12288
  ds_read_b64_tr_b16 a[190:191], v43 offset:14336
  s_waitcnt vmcnt(24) lgkmcnt(0)
  s_barrier
  s_add_u32 m0, s41, 65536
  s_mov_b32 s42, 1572864
  buffer_load_dwordx4 v44, s[8:11], s42 offen nt lds
  s_add_u32 m0, s41, 69632
  s_mov_b32 s42, 1572864
  buffer_load_dwordx4 v45, s[8:11], s42 offen nt lds
  s_add_u32 m0, s41, 73728
  s_mov_b32 s42, 1638400
  buffer_load_dwordx4 v44, s[8:11], s42 offen nt lds
  s_add_u32 m0, s41, 77824
  s_mov_b32 s42, 1638400
  buffer_load_dwordx4 v45, s[8:11], s42 offen nt lds
  ds_read_b64_tr_b16 a[40:41], v43 offset:16384
  ds_read_b64_tr_b16 a[42:43], v43 offset:18432
  ds_read_b64_tr_b16 a[192:193], v43 offset:20480
  ds_read_b64_tr_b16 a[194:195], v43 offset:22528
  ds_read_b64_tr_b16 a[44:45], v43 offset:24576
  ds_read_b64_tr_b16 a[46:47], v43 offset:26624
  ds_read_b64_tr_b16 a[196:197], v43 offset:28672
  ds_read_b64_tr_b16 a[198:199], v43 offset:30720
  s_waitcnt vmcnt(24) lgkmcnt(0)
  s_barrier
  s_add_u32 m0, s41, 81920
  s_mov_b32 s42, 1703936
  buffer_load_dwordx4 v44, s[8:11], s42 offen nt lds
  s_add_u32 m0, s41, 86016
  s_mov_b32 s42, 1703936
  buffer_load_dwordx4 v45, s[8:11], s42 offen nt lds
  s_add_u32 m0, s41, 90112
  s_mov_b32 s42, 1769472
  buffer_load_dwordx4 v44, s[8:11], s42 offen nt lds
  s_add_u32 m0, s41, 94208
  s_mov_b32 s42, 1769472
  buffer_load_dwordx4 v45, s[8:11], s42 offen nt lds
  ds_read_b64_tr_b16 a[48:49], v43 offset:32768
  ds_read_b64_tr_b16 a[50:51], v43 offset:34816
  ds_read_b64_tr_b16 a[200:201], v43 offset:36864
  ds_read_b64_tr_b16 a[202:203], v43 offset:38912
  ds_read_b64_tr_b16 a[52:53], v43 offset:40960
  ds_read_b64_tr_b16 a[54:55], v43 offset:43008
  ds_read_b64_tr_b16 a[204:205], v43 offset:45056
  ds_read_b64_tr_b16 a[206:207], v43 offset:47104
  s_waitcnt vmcnt(24) lgkmcnt(0)
  s_barrier
  s_add_u32 m0, s41, 98304
  s_mov_b32 s42, 1835008
  buffer_load_dwordx4 v44, s[8:11], s42 offen nt lds
  s_add_u32 m0, s41, 102400
  s_mov_b32 s42, 1835008
  buffer_load_dwordx4 v45, s[8:11], s42 offen nt lds
  s_add_u32 m0, s41, 106496
  s_mov_b32 s42, 1900544
  buffer_load_dwordx4 v44, s[8:11], s42 offen nt lds
  s_add_u32 m0, s41, 110592
  s_mov_b32 s42, 1900544
  buffer_load_dwordx4 v45, s[8:11], s42 offen nt lds
  ds_read_b64_tr_b16 a[56:57], v43 offset:49152
  ds_read_b64_tr_b16 a[58:59], v43 offset:51200
  ds_read_b64_tr_b16 a[208:209], v43 offset:53248
  ds_read_b64_tr_b16 a[210:211], v43 offset:55296
  ds_read_b64_tr_b16 a[60:61], v43 offset:57344
  ds_read_b64_tr_b16 a[62:63], v43 offset:59392
  ds_read_b64_tr_b16 a[212:213], v43 offset:61440
  ds_read_b64_tr_b16 a[214:215], v43 offset:63488
  s_waitcnt vmcnt(24) lgkmcnt(0)
  s_barrier
  s_add_u32 m0, s41, 114688
  s_mov_b32 s42, 1966080
  buffer_load_dwordx4 v44, s[8:11], s42 offen nt lds
  s_add_u32 m0, s41, 118784
  s_mov_b32 s42, 1966080
  buffer_load_dwordx4 v45, s[8:11], s42 offen nt lds
  s_add_u32 m0, s41, 122880
  s_mov_b32 s42, 2031616
  buffer_load_dwordx4 v44, s[8:11], s42 offen nt lds
  s_add_u32 m0, s41, 126976
  s_mov_b32 s42, 2031616
  buffer_load_dwordx4 v45, s[8:11], s42 offen nt lds
  ds_read_b64_tr_b16 a[64:65], v42 offset:0
  ds_read_b64_tr_b16 a[66:67], v42 offset:2048
  ds_read_b64_tr_b16 a[216:217], v42 offset:4096
  ds_read_b64_tr_b16 a[218:219], v42 offset:6144
  ds_read_b64_tr_b16 a[68:69], v42 offset:8192
  ds_read_b64_tr_b16 a[70:71], v42 offset:10240
  ds_read_b64_tr_b16 a[220:221], v42 offset:12288
  ds_read_b64_tr_b16 a[222:223], v42 offset:14336
  s_waitcnt vmcnt(24) lgkmcnt(0)
  s_barrier
  s_add_u32 m0, s41, 0
  s_mov_b32 s42, 2097152
  buffer_load_dwordx4 v44, s[8:11], s42 offen nt lds
  s_add_u32 m0, s41, 4096
  s_mov_b32 s42, 2097152
  buffer_load_dwordx4 v45, s[8:11], s42 offen nt lds
  s_add_u32 m0, s41, 8192
  s_mov_b32 s42, 2162688
  buffer_load_dwordx4 v44, s[8:11], s42 offen nt lds
  s_add_u32 m0, s41, 12288
  s_mov_b32 s42, 2162688
  buffer_load_dwordx4 v45, s[8:11], s42 offen nt lds
  ds_read_b64_tr_b16 a[72:73], v42 offset:16384
  ds_read_b64_tr_b16 a[74:75], v42 offset:18432
  ds_read_b64_tr_b16 a[224:225], v42 offset:20480
  ds_read_b64_tr_b16 a[226:227], v42 offset:22528
  ds_read_b64_tr_b16 a[76:77], v42 offset:24576
  ds_read_b64_tr_b16 a[78:79], v42 offset:26624
  ds_read_b64_tr_b16 a[228:229], v42 offset:28672
  ds_read_b64_tr_b16 a[230:231], v42 offset:30720
  s_waitcnt vmcnt(24) lgkmcnt(0)
  s_barrier
  s_add_u32 m0, s41, 16384
  s_mov_b32 s42, 2228224
  buffer_load_dwordx4 v44, s[8:11], s42 offen nt lds
  s_add_u32 m0, s41, 20480
  s_mov_b32 s42, 2228224
  buffer_load_dwordx4 v45, s[8:11], s42 offen nt lds
  s_add_u32 m0, s41, 24576
  s_mov_b32 s42, 2293760
  buffer_load_dwordx4 v44, s[8:11], s42 offen nt lds
  s_add_u32 m0, s41, 28672
  s_mov_b32 s42, 2293760
  buffer_load_dwordx4 v45, s[8:11], s42 offen nt lds
  ds_read_b64_tr_b16 a[80:81], v42 offset:32768
  ds_read_b64_tr_b16 a[82:83], v42 offset:34816
  ds_read_b64_tr_b16 a[232:233], v42 offset:36864
  ds_read_b64_tr_b16 a[234:235], v42 offset:38912
  ds_read_b64_tr_b16 a[84:85], v42 offset:40960
  ds_read_b64_tr_b16 a[86:87], v42 offset:43008
  ds_read_b64_tr_b16 a[236:237], v42 offset:45056
  ds_read_b64_tr_b16 a[238:239], v42 offset:47104
  s_waitcnt vmcnt(24) lgkmcnt(0)
  s_barrier
  s_add_u32 m0, s41, 32768
  s_mov_b32 s42, 2359296
  buffer_load_dwordx4 v44, s[8:11], s42 offen nt lds
  s_add_u32 m0, s41, 36864
  s_mov_b32 s42, 2359296
  buffer_load_dwordx4 v45, s[8:11], s42 offen nt lds
  s_add_u32 m0, s41, 40960
  s_mov_b32 s42, 2424832
  buffer_load_dwordx4 v44, s[8:11], s42 offen nt lds
  s_add_u32 m0, s41, 45056
  s_mov_b32 s42, 2424832
  buffer_load_dwordx4 v45, s[8:11], s42 offen nt lds
  ds_read_b64_tr_b16 a[88:89], v42 offset:49152
  ds_read_b64_tr_b16 a[90:91], v42 offset:51200
  ds_read_b64_tr_b16 a[240:241], v42 offset:53248
  ds_read_b64_tr_b16 a[242:243], v42 offset:55296
  ds_read_b64_tr_b16 a[92:93], v42 offset:57344
  ds_read_b64_tr_b16 a[94:95], v42 offset:59392
  ds_read_b64_tr_b16 a[244:245], v42 offset:61440
  ds_read_b64_tr_b16 a[246:247], v42 offset:63488
  s_waitcnt vmcnt(24) lgkmcnt(0)
  s_barrier
  ds_read_b64_tr_b16 a[96:97], v43 offset:0
  ds_read_b64_tr_b16 a[98:99], v43 offset:2048
  ds_read_b64_tr_b16 a[248:249], v43 offset:4096
  ds_read_b64_tr_b16 a[250:251], v43 offset:6144
  ds_read_b64_tr_b16 a[100:101], v43 offset:8192
  ds_read_b64_tr_b16 a[102:103], v43 offset:10240
  ds_read_b64_tr_b16 a[252:253], v43 offset:12288
  ds_read_b64_tr_b16 a[254:255], v43 offset:14336
  s_waitcnt vmcnt(20) lgkmcnt(0)
  s_barrier
  ds_read_b64_tr_b16 a[104:105], v43 offset:16384
  ds_read_b64_tr_b16 a[106:107], v43 offset:18432
  ds_read_b64_tr_b16 v[128:129], v43 offset:20480
  ds_read_b64_tr_b16 v[130:131], v43 offset:22528
  ds_read_b64_tr_b16 a[108:109], v43 offset:24576
  ds_read_b64_tr_b16 a[110:111], v43 offset:26624
  ds_read_b64_tr_b16 v[132:133], v43 offset:28672
  ds_read_b64_tr_b16 v[134:135], v43 offset:30720
  s_waitcnt vmcnt(16) lgkmcnt(0)
  s_barrier
  ds_read_b64_tr_b16 a[112:113], v43 offset:32768
  ds_read_b64_tr_b16 a[114:115], v43 offset:34816
  ds_read_b64_tr_b16 v[136:137], v43 offset:36864
  ds_read_b64_tr_b16 v[138:139], v43 offset:38912
  ds_read_b64_tr_b16 a[116:117], v43 offset:40960
  ds_read_b64_tr_b16 a[118:119], v43 offset:43008
  ds_read_b64_tr_b16 v[140:141], v43 offset:45056
  ds_read_b64_tr_b16 v[142:143], v43 offset:47104
  s_waitcnt vmcnt(12) lgkmcnt(0)
  s_barrier
  ds_read_b64_tr_b16 a[120:121], v43 offset:49152
  ds_read_b64_tr_b16 a[122:123], v43 offset:51200
  ds_read_b64_tr_b16 v[144:145], v43 offset:53248
  ds_read_b64_tr_b16 v[146:147], v43 offset:55296
  ds_read_b64_tr_b16 a[124:125], v43 offset:57344
  ds_read_b64_tr_b16 a[126:127], v43 offset:59392
  ds_read_b64_tr_b16 v[148:149], v43 offset:61440
  ds_read_b64_tr_b16 v[150:151], v43 offset:63488
  s_waitcnt vmcnt(8) lgkmcnt(0)
  s_barrier
  ds_read_b64_tr_b16 a[128:129], v42 offset:0
  ds_read_b64_tr_b16 a[130:131], v42 offset:2048
  ds_read_b64_tr_b16 v[152:153], v42 offset:4096
  ds_read_b64_tr_b16 v[154:155], v42 offset:6144
  ds_read_b64_tr_b16 a[132:133], v42 offset:8192
  ds_read_b64_tr_b16 a[134:135], v42 offset:10240
  ds_read_b64_tr_b16 v[156:157], v42 offset:12288
  ds_read_b64_tr_b16 v[158:159], v42 offset:14336
  s_waitcnt vmcnt(4) lgkmcnt(0)
  s_barrier
  ds_read_b64_tr_b16 a[136:137], v42 offset:16384
  ds_read_b64_tr_b16 a[138:139], v42 offset:18432
  ds_read_b64_tr_b16 v[160:161], v42 offset:20480
  ds_read_b64_tr_b16 v[162:163], v42 offset:22528
  ds_read_b64_tr_b16 a[140:141], v42 offset:24576
  ds_read_b64_tr_b16 a[142:143], v42 offset:26624
  ds_read_b64_tr_b16 v[164:165], v42 offset:28672
  ds_read_b64_tr_b16 v[166:167], v42 offset:30720
  s_waitcnt vmcnt(0) lgkmcnt(0)
  s_barrier
  ds_read_b64_tr_b16 a[144:145], v42 offset:32768
  ds_read_b64_tr_b16 a[146:147], v42 offset:34816
  ds_read_b64_tr_b16 v[168:169], v42 offset:36864
  ds_read_b64_tr_b16 v[170:171], v42 offset:38912
  ds_read_b64_tr_b16 a[148:149], v42 offset:40960
  ds_read_b64_tr_b16 a[150:151], v42 offset:43008
  ds_read_b64_tr_b16 v[172:173], v42 offset:45056
  ds_read_b64_tr_b16 v[174:175], v42 offset:47104
  s_waitcnt lgkmcnt(0)
  s_barrier
  s_cmp_lt_u32 s21, 8
  s_cbranch_scc1 L_F2_keep
  v_accvgpr_write_b32 a0, 0
  v_accvgpr_write_b32 a1, 0
  v_accvgpr_write_b32 a2, 0
  v_accvgpr_write_b32 a3, 0
  v_accvgpr_write_b32 a152, 0
  v_accvgpr_write_b32 a153, 0
  v_accvgpr_write_b32 a154, 0
  v_accvgpr_write_b32 a155, 0
  s_nop 1
L_F2_keep:
  s_lshr_b32 s43, s21, 3
  s_mul_i32 s43, s43, 37
  s_lshr_b32 s44, s43, 1
  v_min_u32 v52, 19, v0
  v_add_u32 v52, s44, v52
  v_min_u32 v52, 55, v52
  v_lshlrev_b32 v52, 7, v52
  v_add_u32 v2, 1414144, v52
  s_lshl_b32 s40, s43, 11
  s_add_u32 s27, s40, 23068672
  s_lshl_b32 s62, s21, 7
  s_add_u32 s62, s62, 1421312
  s_lshl_b32 s40, s21, 13
  s_add_u32 s31, s40, 54525952
  s_lshl_b32 s40, s20, 11
  v_and_b32 v68, 3, v0
  v_lshlrev_b32 v68, 4, v68
  v_lshrrev_b32 v52, 4, v0
  v_lshl_add_u32 v68, v52, 6, v68
  v_bfe_u32 v52, v0, 2, 2
  v_lshl_add_u32 v68, v52, 8, v68
  v_add_u32 v68, s40, v68
  v_lshlrev_b32 v1, 4, v0
  s_lshl_b32 s32, s20, 12
  s_mul_i32 s33, s20, 3072
  v_mov_b32 v69, v1
  v_add_u32 v70, 0x10000, v69
  v_lshlrev_b32 v71, 2, v0
  v_add_u32 v71, 155648, v71
  s_mov_b32 s25, 0
  s_mov_b32 s26, 0
  s_mov_b32 s29, 1
  s_mov_b32 s30, 0
  s_mov_b32 s28, 0
L_F2_top:
  s_cmp_lg_u32 s28, 0
  s_cbranch_scc1 L_F2_go
  s_cmp_lg_u32 s20, 0
  s_cbranch_scc1 L_F2_park
  buffer_load_dword v3, v2, s[4:7], s30 offen sc1
  s_waitcnt vmcnt(1)
  s_barrier
  s_mov_b32 s63, s25
  s_atomic_smax s63, s[4:5], s62 glc
Lnosig_40:
  s_cmp_ge_u32 s25, 64
  s_cbranch_scc1 L_END
  s_waitcnt vmcnt(0)
  v_cmp_gt_i32 vcc, s29, v3
  s_cbranch_vccz L_F2_issue
  s_nop 3
Lpoll_41:
  buffer_load_dword v3, v2, s[4:7], s30 offen sc1
  s_sub_u32 s24, s24, 1
  s_cbranch_scc1 L_FAIL
  s_waitcnt vmcnt(0)
  v_cmp_gt_i32 vcc, s29, v3
  s_cbranch_vccz Lpolld_42
  s_sleep 1
  s_branch Lpoll_41
Lpolld_42:
  s_branch L_F2_issue
L_F2_park:
  s_waitcnt vmcnt(0)
  s_barrier
  s_cmp_ge_u32 s25, 64
  s_cbranch_scc1 L_END
L_F2_issue:
  s_barrier
  s_mov_b32 s34, s26
  s_mov_b32 s35, s27
  s_add_u32 s36, s32, 0
  s_add_u32 m0, s34, s36
  s_add_u32 s36, s35, s36
  buffer_load_dwordx4 v1, s[4:7], s36 offen offset:0 sc1 lds
  buffer_load_dwordx4 v1, s[4:7], s36 offen offset:1024 sc1 lds
  buffer_load_dwordx4 v1, s[4:7], s36 offen offset:2048 sc1 lds
  buffer_load_dwordx4 v1, s[4:7], s36 offen offset:3072 sc1 lds
  s_add_u32 s36, s32, 16384
  s_add_u32 m0, s34, s36
  s_add_u32 s36, s35, s36
  buffer_load_dwordx4 v1, s[4:7], s36 offen offset:0 sc1 lds
  buffer_load_dwordx4 v1, s[4:7], s36 offen offset:1024 sc1 lds
  buffer_load_dwordx4 v1, s[4:7], s36 offen offset:2048 sc1 lds
  buffer_load_dwordx4 v1, s[4:7], s36 offen offset:3072 sc1 lds
  s_add_u32 s36, s32, 32768
  s_add_u32 m0, s34, s36
  s_add_u32 s36, s35, s36
  buffer_load_dwordx4 v1, s[4:7], s36 offen offset:0 sc1 lds
  buffer_load_dwordx4 v1, s[4:7], s36 offen offset:1024 sc1 lds
  buffer_load_dwordx4 v1, s[4:7], s36 offen offset:2048 sc1 lds
  buffer_load_dwordx4 v1, s[4:7], s36 offen offset:3072 sc1 lds
L_F2_go:
  v_add_u32 v73, s26, v69
  v_add_u32 v74, s26, v70
  s_sub_u32 s26, 77824, s26
  s_add_u32 s27, s27, 229376
  s_add_u32 s29, s29, 1
  s_waitcnt vmcnt(8)
  s_barrier
  ds_read_b128 v[4:7], v73 offset:0
  ds_read_b128 v[8:11], v73 offset:1024
  ds_read_b128 v[12:15], v73 offset:2048
  ds_read_b128 v[16:19], v73 offset:3072
  ds_read_b128 v[20:23], v73 offset:4096
  ds_read_b128 v[24:27], v73 offset:5120
  s_waitcnt lgkmcnt(4)
  v_mfma_f32_16x16x32_bf16 v[36:39], a[0:3], v[4:7], 0
  ds_read_b128 v[28:31], v73 offset:6144
  v_mfma_f32_16x16x32_bf16 v[40:43], a[0:3], v[8:11], 0
  ds_read_b128 v[32:35], v73 offset:7168
  v_mfma_f32_16x16x32_bf16 v[44:47], a[152:155], v[4:7], 0
  s_add_u32 s36, s32, 49152
  s_add_u32 m0, s34, s36
  s_add_u32 s36, s35, s36
  buffer_load_dwordx4 v1, s[4:7], s36 offen offset:0 sc1 lds
  v_mfma_f32_16x16x32_bf16 v[48:51], a[152:155], v[8:11], 0
  buffer_load_dwordx4 v1, s[4:7], s36 offen offset:1024 sc1 lds
  s_waitcnt lgkmcnt(4)
  v_mfma_f32_16x16x32_bf16 v[36:39], a[4:7], v[12:15], v[36:39]
  ds_read_b128 v[4:7], v73 offset:8192
  v_mfma_f32_16x16x32_bf16 v[40:43], a[4:7], v[16:19], v[40:43]
  ds_read_b128 v[8:11], v73 offset:9216
  v_mfma_f32_16x16x32_bf16 v[44:47], a[156:159], v[12:15], v[44:47]
  buffer_load_dwordx4 v1, s[4:7], s36 offen offset:2048 sc1 lds
  v_mfma_f32_16x16x32_bf16 v[48:51], a[156:159], v[16:19], v[48:51]
  buffer_load_dwordx4 v1, s[4:7], s36 offen offset:3072 sc1 lds
  s_waitcnt lgkmcnt(4)
  v_mfma_f32_16x16x32_bf16 v[36:39], a[8:11], v[20:23], v[36:39]
  ds_read_b128 v[12:15], v73 offset:10240
  v_mfma_f32_16x16x32_bf16 v[40:43], a[8:11], v[24:27], v[40:43]
  ds_read_b128 v[16:19], v73 offset:11264
  v_mfma_f32_16x16x32_bf16 v[44:47], a[160:163], v[20:23], v[44:47]
  s_add_u32 s36, s33, 65536
  s_add_u32 m0, s34, s36
  s_add_u32 s36, s35, s36
  buffer_load_dwordx4 v1, s[4:7], s36 offen offset:0 sc1 lds
  v_mfma_f32_16x16x32_bf16 v[48:51], a[160:163], v[24:27], v[48:51]
  buffer_load_dwordx4 v1, s[4:7], s36 offen offset:1024 sc1 lds
  s_waitcnt lgkmcnt(4)
  v_mfma_f32_16x16x32_bf16 v[36:39], a[12:15], v[28:31], v[36:39]
  ds_read_b128 v[20:23], v73 offset:12288
  v_mfma_f32_16x16x32_bf16 v[40:43], a[12:15], v[32:35], v[40:43]
  ds_read_b128 v[24:27], v73 offset:13312
  v_mfma_f32_16x16x32_bf16 v[44:47], a[164:167], v[28:31], v[44:47]
  buffer_load_dwordx4 v1, s[4:7], s36 offen offset:2048 sc1 lds
  v_mfma_f32_16x16x32_bf16 v[48:51], a[164:167], v[32:35], v[48:51]
  s_waitcnt lgkmcnt(4)
  v_mfma_f32_16x16x32_bf16 v[36:39], a[16:19], v[4:7], v[36:39]
  ds_read_b128 v[28:31], v73 offset:14336
  v_mfma_f32_16x16x32_bf16 v[40:43], a[16:19], v[8:11], v[40:43]
  ds_read_b128 v[32:35], v73 offset:15360
  v_mfma_f32_16x16x32_bf16 v[44:47], a[168:171], v[4:7], v[44:47]
  v_mfma_f32_16x16x32_bf16 v[48:51], a[168:171], v[8:11], v[48:51]
  s_waitcnt vmcnt(11)
  s_barrier
  s_lshl_b32 s40, s20, 8
  s_add_u32 m0, s40, 155648
  s_cmp_eq_u32 s20, 0
  s_cselect_b32 s40, s30, 2147483392
  buffer_load_dword v2, s[4:7], s40 offen sc1 lds
  s_mov_b32 s34, s26
  s_mov_b32 s35, s27
  s_waitcnt lgkmcnt(4)
  v_mfma_f32_16x16x32_bf16 v[36:39], a[20:23], v[12:15], v[36:39]
  ds_read_b128 v[4:7], v73 offset:16384
  v_mfma_f32_16x16x32_bf16 v[40:43], a[20:23], v[16:19], v[40:43]
  ds_read_b128 v[8:11], v73 offset:17408
  v_mfma_f32_16x16x32_bf16 v[44:47], a[172:175], v[12:15], v[44:47]
  v_mfma_f32_16x16x32_bf16 v[48:51], a[172:175], v[16:19], v[48:51]
  s_waitcnt lgkmcnt(4)
  v_mfma_f32_16x16x32_bf16 v[36:39], a[24:27], v[20:23], v[36:39]
  ds_read_b128 v[12:15], v73 offset:18432
  v_mfma_f32_16x16x32_bf16 v[40:43], a[24:27], v[24:27], v[40:43]
  ds_read_b128 v[16:19], v73 offset:19456
  v_mfma_f32_16x16x32_bf16 v[44:47], a[176:179], v[20:23], v[44:47]
  v_mfma_f32_16x16x32_bf16 v[48:51], a[176:179], v[24:27], v[48:51]
  s_waitcnt lgkmcnt(4)
  v_mfma_f32_16x16x32_bf16 v[36:39], a[28:31], v[28:31], v[36:39]
  ds_read_b128 v[20:23], v73 offset:20480
  v_mfma_f32_16x16x32_bf16 v[40:43], a[28:31], v[32:35], v[40:43]
  ds_read_b128 v[24:27], v73 offset:21504
  v_mfma_f32_16x16x32_bf16 v[44:47], a[180:183], v[28:31], v[44:47]
  v_mfma_f32_16x16x32_bf16 v[48:51], a[180:183], v[32:35], v[48:51]
  s_waitcnt lgkmcnt(4)
  v_mfma_f32_16x16x32_bf16 v[36:39], a[32:35], v[4:7], v[36:39]
  ds_read_b128 v[28:31], v73 offset:22528
  v_mfma_f32_16x16x32_bf16 v[40:43], a[32:35], v[8:11], v[40:43]
  ds_read_b128 v[32:35], v73 offset:23552
  v_mfma_f32_16x16x32_bf16 v[44:47], a[184:187], v[4:7], v[44:47]
  v_mfma_f32_16x16x32_bf16 v[48:51], a[184:187], v[8:11], v[48:51]
  s_waitcnt lgkmcnt(4)
  v_mfma_f32_16x16x32_bf16 v[36:39], a[36:39], v[12:15], v[36:39]
  ds_read_b128 v[4:7], v73 offset:24576
  v_mfma_f32_16x16x32_bf16 v[40:43], a[36:39], v[16:19], v[40:43]
  ds_read_b128 v[8:11], v73 offset:25600
  v_mfma_f32_16x16x32_bf16 v[44:47], a[188:191], v[12:15], v[44:47]
  v_mfma_f32_16x16x32_bf16 v[48:51], a[188:191], v[16:19], v[48:51]
  s_waitcnt lgkmcnt(4)
  v_mfma_f32_16x16x32_bf16 v[36:39], a[40:43], v[20:23], v[36:39]
  ds_read_b128 v[12:15], v73 offset:26624
  v_mfma_f32_16x16x32_bf16 v[40:43], a[40:43], v[24:27], v[40:43]
  ds_read_b128 v[16:19], v73 offset:27648
  v_mfma_f32_16x16x32_bf16 v[44:47], a[192:195], v[20:23], v[44:47]
  v_mfma_f32_16x16x32_bf16 v[48:51], a[192:195], v[24:27], v[48:51]
  s_waitcnt lgkmcnt(4)
  v_mfma_f32_16x16x32_bf16 v[36:39], a[44:47], v[28:31], v[36:39]
  ds_read_b128 v[20:23], v73 offset:28672
  v_mfma_f32_16x16x32_bf16 v[40:43], a[44:47], v[32:35], v[40:43]
  ds_read_b128 v[24:27], v73 offset:29696
  v_mfma_f32_16x16x32_bf16 v[44:47], a[196:199], v[28:31], v[44:47]
  v_mfma_f32_16x16x32_bf16 v[48:51], a[196:199], v[32:35], v[48:51]
  s_waitcnt lgkmcnt(4)
  v_mfma_f32_16x16x32_bf16 v[36:39], a[48:51], v[4:7], v[36:39]
  ds_read_b128 v[28:31], v73 offset:30720
  v_mfma_f32_16x16x32_bf16 v[40:43], a[48:51], v[8:11], v[40:43]
  ds_read_b128 v[32:35], v73 offset:31744
  v_mfma_f32_16x16x32_bf16 v[44:47], a[200:203], v[4:7], v[44:47]
  v_mfma_f32_16x16x32_bf16 v[48:51], a[200:203], v[8:11], v[48:51]
  s_waitcnt vmcnt(10)
  s_cmp_lg_u32 s28, 0
  s_cbranch_scc1 L_F2_b2
  s_waitcnt vmcnt(8)
L_F2_b2:
  s_barrier
  s_waitcnt lgkmcnt(4)
  v_mfma_f32_16x16x32_bf16 v[36:39], a[52:55], v[12:15], v[36:39]
  ds_read_b128 v[4:7], v73 offset:32768
  v_mfma_f32_16x16x32_bf16 v[40:43], a[52:55], v[16:19], v[40:43]
  ds_read_b128 v[8:11], v73 offset:33792
  v_mfma_f32_16x16x32_bf16 v[44:47], a[204:207], v[12:15], v[44:47]
  v_mfma_f32_16x16x32_bf16 v[48:51], a[204:207], v[16:19], v[48:51]
  s_waitcnt lgkmcnt(4)
  v_mfma_f32_16x16x32_bf16 v[36:39], a[56:59], v[20:23], v[36:39]
  ds_read_b128 v[12:15], v73 offset:34816
  v_mfma_f32_16x16x32_bf16 v[40:43], a[56:59], v[24:27], v[40:43]
  ds_read_b128 v[16:19], v73 offset:35840
  v_mfma_f32_16x16x32_bf16 v[44:47], a[208:211], v[20:23], v[44:47]
  v_mfma_f32_16x16x32_bf16 v[48:51], a[208:211], v[24:27], v[48:51]
  s_waitcnt lgkmcnt(4)
  v_mfma_f32_16x16x32_bf16 v[36:39], a[60:63], v[28:31], v[36:39]
  ds_read_b128 v[20:23], v73 offset:36864
  v_mfma_f32_16x16x32_bf16 v[40:43], a[60:63], v[32:35], v[40:43]
  ds_read_b128 v[24:27], v73 offset:37888
  v_mfma_f32_16x16x32_bf16 v[44:47], a[212:215], v[28:31], v[44:47]
  v_mfma_f32_16x16x32_bf16 v[48:51], a[212:215], v[32:35], v[48:51]
  s_waitcnt lgkmcnt(4)
  v_mfma_f32_16x16x32_bf16 v[36:39], a[64:67], v[4:7], v[36:39]
  ds_read_b128 v[28:31], v73 offset:38912
  v_mfma_f32_16x16x32_bf16 v[40:43], a[64:67], v[8:11], v[40:43]
  ds_read_b128 v[32:35], v73 offset:39936
  v_mfma_f32_16x16x32_bf16 v[44:47], a[216:219], v[4:7], v[44:47]
  v_mfma_f32_16x16x32_bf16 v[48:51], a[216:219], v[8:11], v[48:51]
  s_waitcnt lgkmcnt(4)
  v_mfma_f32_16x16x32_bf16 v[36:39], a[68:71], v[12:15], v[36:39]
  ds_read_b128 v[4:7], v73 offset:40960
  v_mfma_f32_16x16x32_bf16 v[40:43], a[68:71], v[16:19], v[40:43]
  ds_read_b128 v[8:11], v73 offset:41984
  v_mfma_f32_16x16x32_bf16 v[44:47], a[220:223], v[12:15], v[44:47]
  v_mfma_f32_16x16x32_bf16 v[48:51], a[220:223], v[16:19], v[48:51]
  s_waitcnt lgkmcnt(4)
  v_mfma_f32_16x16x32_bf16 v[36:39], a[72:75], v[20:23], v[36:39]
  ds_read_b128 v[12:15], v73 offset:43008
  v_mfma_f32_16x16x32_bf16 v[40:43], a[72:75], v[24:27], v[40:43]
  ds_read_b128 v[16:19], v73 offset:44032
  v_mfma_f32_16x16x32_bf16 v[44:47], a[224:227], v[20:23], v[44:47]
  v_mfma_f32_16x16x32_bf16 v[48:51], a[224:227], v[24:27], v[48:51]
  s_waitcnt vmcnt(0)
  s_barrier
  ds_read_b32 v3, v71
  s_lshl_b32 s40, s20, 1
  s_add_u32 s40, s40, 1
  s_cmp_lg_u32 s40, s28
  s_cbranch_scc1 L_F2_s2
  s_mov_b32 s63, s25
  s_atomic_smax s63, s[4:5], s62 glc
Lnosig_43:
L_F2_s2:
  s_waitcnt lgkmcnt(4)
  v_mfma_f32_16x16x32_bf16 v[36:39], a[76:79], v[28:31], v[36:39]
  ds_read_b128 v[20:23], v73 offset:45056
  v_mfma_f32_16x16x32_bf16 v[40:43], a[76:79], v[32:35], v[40:43]
  ds_read_b128 v[24:27], v73 offset:46080
  v_mfma_f32_16x16x32_bf16 v[44:47], a[228:231], v[28:31], v[44:47]
  v_mfma_f32_16x16x32_bf16 v[48:51], a[228:231], v[32:35], v[48:51]
  s_waitcnt lgkmcnt(4)
  v_mfma_f32_16x16x32_bf16 v[36:39], a[80:83], v[4:7], v[36:39]
  ds_read_b128 v[28:31], v73 offset:47104
  v_mfma_f32_16x16x32_bf16 v[40:43], a[80:83], v[8:11], v[40:43]
  ds_read_b128 v[32:35], v73 offset:48128
  v_mfma_f32_16x16x32_bf16 v[44:47], a[232:235], v[4:7], v[44:47]
  v_mfma_f32_16x16x32_bf16 v[48:51], a[232:235], v[8:11], v[48:51]
  s_waitcnt lgkmcnt(4)
  v_cmp_gt_i32 vcc, s29, v3
  s_mov_b32 s28, 0
  s_cbranch_vccnz L_F2_nopf
  s_cmp_ge_u32 s25, 63
  s_cbranch_scc1 L_F2_nopf
  s_mov_b32 s28, 1
  s_waitcnt lgkmcnt(4)
  v_mfma_f32_16x16x32_bf16 v[36:39], a[84:87], v[12:15], v[36:39]
  ds_read_b128 v[4:7], v73 offset:49152
  v_mfma_f32_16x16x32_bf16 v[40:43], a[84:87], v[16:19], v[40:43]
  ds_read_b128 v[8:11], v73 offset:50176
  v_mfma_f32_16x16x32_bf16 v[44:47], a[236:239], v[12:15], v[44:47]
  s_add_u32 s36, s32, 0
  s_add_u32 m0, s34, s36
  s_add_u32 s36, s35, s36
  buffer_load_dwordx4 v1, s[4:7], s36 offen offset:0 sc1 lds
  v_mfma_f32_16x16x32_bf16 v[48:51], a[236:239], v[16:19], v[48:51]
  s_waitcnt lgkmcnt(4)
  v_mfma_f32_16x16x32_bf16 v[36:39], a[88:91], v[20:23], v[36:39]
  ds_read_b128 v[12:15], v73 offset:51200
  v_mfma_f32_16x16x32_bf16 v[40:43], a[88:91], v[24:27], v[40:43]
  ds_read_b128 v[16:19], v73 offset:52224
  v_mfma_f32_16x16x32_bf16 v[44:47], a[240:243], v[20:23], v[44:47]
  buffer_load_dwordx4 v1, s[4:7], s36 offen offset:1024 sc1 lds
  v_mfma_f32_16x16x32_bf16 v[48:51], a[240:243], v[24:27], v[48:51]
  s_waitcnt lgkmcnt(4)
  v_mfma_f32_16x16x32_bf16 v[36:39], a[92:95], v[28:31], v[36:39]
  ds_read_b128 v[20:23], v73 offset:53248
  v_mfma_f32_16x16x32_bf16 v[40:43], a[92:95], v[32:35], v[40:43]
  ds_read_b128 v[24:27], v73 offset:54272
  v_mfma_f32_16x16x32_bf16 v[44:47], a[244:247], v[28:31], v[44:47]
  buffer_load_dwordx4 v1, s[4:7], s36 offen offset:2048 sc1 lds
  v_mfma_f32_16x16x32_bf16 v[48:51], a[244:247], v[32:35], v[48:51]
  s_waitcnt lgkmcnt(4)
  v_mfma_f32_16x16x32_bf16 v[36:39], a[96:99], v[4:7], v[36:39]
  ds_read_b128 v[28:31], v73 offset:55296
  v_mfma_f32_16x16x32_bf16 v[40:43], a[96:99], v[8:11], v[40:43]
  ds_read_b128 v[32:35], v73 offset:56320
  v_mfma_f32_16x16x32_bf16 v[44:47], a[248:251], v[4:7], v[44:47]
  buffer_load_dwordx4 v1, s[4:7], s36 offen offset:3072 sc1 lds
  v_mfma_f32_16x16x32_bf16 v[48:51], a[248:251], v[8:11], v[48:51]
  s_waitcnt lgkmcnt(4)
  v_mfma_f32_16x16x32_bf16 v[36:39], a[100:103], v[12:15], v[36:39]
  ds_read_b128 v[4:7], v73 offset:57344
  v_mfma_f32_16x16x32_bf16 v[40:43], a[100:103], v[16:19], v[40:43]
  ds_read_b128 v[8:11], v73 offset:58368
  v_mfma_f32_16x16x32_bf16 v[44:47], a[252:255], v[12:15], v[44:47]
  s_add_u32 s36, s32, 16384
  s_add_u32 m0, s34, s36
  s_add_u32 s36, s35, s36
  buffer_load_dwordx4 v1, s[4:7], s36 offen offset:0 sc1 lds
  v_mfma_f32_16x16x32_bf16 v[48:51], a[252:255], v[16:19], v[48:51]
  s_waitcnt lgkmcnt(4)
  v_mfma_f32_16x16x32_bf16 v[36:39], a[104:107], v[20:23], v[36:39]
  ds_read_b128 v[12:15], v73 offset:59392
  v_mfma_f32_16x16x32_bf16 v[40:43], a[104:107], v[24:27], v[40:43]
  ds_read_b128 v[16:19], v73 offset:60416
  v_mfma_f32_16x16x32_bf16 v[44:47], v[128:131], v[20:23], v[44:47]
  buffer_load_dwordx4 v1, s[4:7], s36 offen offset:1024 sc1 lds
  v_mfma_f32_16x16x32_bf16 v[48:51], v[128:131], v[24:27], v[48:51]
  s_waitcnt lgkmcnt(4)
  v_mfma_f32_16x16x32_bf16 v[36:39], a[108:111], v[28:31], v[36:39]
  ds_read_b128 v[20:23], v73 offset:61440
  v_mfma_f32_16x16x32_bf16 v[40:43], a[108:111], v[32:35], v[40:43]
  ds_read_b128 v[24:27], v73 offset:62464
  v_mfma_f32_16x16x32_bf16 v[44:47], v[132:135], v[28:31], v[44:47]
  buffer_load_dwordx4 v1, s[4:7], s36 offen offset:2048 sc1 lds
  v_mfma_f32_16x16x32_bf16 v[48:51], v[132:135], v[32:35], v[48:51]
  s_waitcnt lgkmcnt(4)
  v_mfma_f32_16x16x32_bf16 v[36:39], a[112:115], v[4:7], v[36:39]
  ds_read_b128 v[28:31], v73 offset:63488
  v_mfma_f32_16x16x32_bf16 v[40:43], a[112:115], v[8:11], v[40:43]
  ds_read_b128 v[32:35], v73 offset:64512
  v_mfma_f32_16x16x32_bf16 v[44:47], v[136:139], v[4:7], v[44:47]
  buffer_load_dwordx4 v1, s[4:7], s36 offen offset:3072 sc1 lds
  v_mfma_f32_16x16x32_bf16 v[48:51], v[136:139], v[8:11], v[48:51]
  s_waitcnt lgkmcnt(4)
  v_mfma_f32_16x16x32_bf16 v[36:39], a[116:119], v[12:15], v[36:39]
  ds_read_b128 v[4:7], v74 offset:0
  v_mfma_f32_16x16x32_bf16 v[40:43], a[116:119], v[16:19], v[40:43]
  ds_read_b128 v[8:11], v74 offset:1024
  v_mfma_f32_16x16x32_bf16 v[44:47], v[140:143], v[12:15], v[44:47]
  s_add_u32 s36, s32, 32768
  s_add_u32 m0, s34, s36
  s_add_u32 s36, s35, s36
  buffer_load_dwordx4 v1, s[4:7], s36 offen offset:0 sc1 lds
  v_mfma_f32_16x16x32_bf16 v[48:51], v[140:143], v[16:19], v[48:51]
  s_waitcnt lgkmcnt(4)
  v_mfma_f32_16x16x32_bf16 v[36:39], a[120:123], v[20:23], v[36:39]
  ds_read_b128 v[12:15], v74 offset:2048
  v_mfma_f32_16x16x32_bf16 v[40:43], a[120:123], v[24:27], v[40:43]
  ds_read_b128 v[16:19], v74 offset:3072
  v_mfma_f32_16x16x32_bf16 v[44:47], v[144:147], v[20:23], v[44:47]
  buffer_load_dwordx4 v1, s[4:7], s36 offen offset:1024 sc1 lds
  v_mfma_f32_16x16x32_bf16 v[48:51], v[144:147], v[24:27], v[48:51]
  s_waitcnt lgkmcnt(4)
  v_mfma_f32_16x16x32_bf16 v[36:39], a[124:127], v[28:31], v[36:39]
  ds_read_b128 v[20:23], v74 offset:4096
  v_mfma_f32_16x16x32_bf16 v[40:43], a[124:127], v[32:35], v[40:43]
  ds_read_b128 v[24:27], v74 offset:5120
  v_mfma_f32_16x16x32_bf16 v[44:47], v[148:151], v[28:31], v[44:47]
  buffer_load_dwordx4 v1, s[4:7], s36 offen offset:2048 sc1 lds
  v_mfma_f32_16x16x32_bf16 v[48:51], v[148:151], v[32:35], v[48:51]
  s_waitcnt lgkmcnt(4)
  v_mfma_f32_16x16x32_bf16 v[36:39], a[128:131], v[4:7], v[36:39]
  ds_read_b128 v[28:31], v74 offset:6144
  v_mfma_f32_16x16x32_bf16 v[40:43], a[128:131], v[8:11], v[40:43]
  ds_read_b128 v[32:35], v74 offset:7168
  v_mfma_f32_16x16x32_bf16 v[44:47], v[152:155], v[4:7], v[44:47]
  buffer_load_dwordx4 v1, s[4:7], s36 offen offset:3072 sc1 lds
  v_mfma_f32_16x16x32_bf16 v[48:51], v[152:155], v[8:11], v[48:51]
  s_waitcnt lgkmcnt(4)
  v_mfma_f32_16x16x32_bf16 v[36:39], a[132:135], v[12:15], v[36:39]
  ds_read_b128 v[4:7], v74 offset:8192
  v_mfma_f32_16x16x32_bf16 v[40:43], a[132:135], v[16:19], v[40:43]
  ds_read_b128 v[8:11], v74 offset:9216
  v_mfma_f32_16x16x32_bf16 v[44:47], v[156:159], v[12:15], v[44:47]
  v_mfma_f32_16x16x32_bf16 v[48:51], v[156:159], v[16:19], v[48:51]
  s_waitcnt lgkmcnt(4)
  v_mfma_f32_16x16x32_bf16 v[36:39], a[136:139], v[20:23], v[36:39]
  ds_read_b128 v[12:15], v74 offset:10240
  v_mfma_f32_16x16x32_bf16 v[40:43], a[136:139], v[24:27], v[40:43]
  ds_read_b128 v[16:19], v74 offset:11264
  v_mfma_f32_16x16x32_bf16 v[44:47], v[160:163], v[20:23], v[44:47]
  v_mfma_f32_16x16x32_bf16 v[48:51], v[160:163], v[24:27], v[48:51]
  s_waitcnt lgkmcnt(4)
  v_mfma_f32_16x16x32_bf16 v[36:39], a[140:143], v[28:31], v[36:39]
  v_mfma_f32_16x16x32_bf16 v[40:43], a[140:143], v[32:35], v[40:43]
  v_mfma_f32_16x16x32_bf16 v[44:47], v[164:167], v[28:31], v[44:47]
  v_mfma_f32_16x16x32_bf16 v[48:51], v[164:167], v[32:35], v[48:51]
  s_waitcnt lgkmcnt(2)
  v_mfma_f32_16x16x32_bf16 v[36:39], a[144:147], v[4:7], v[36:39]
  v_mfma_f32_16x16x32_bf16 v[40:43], a[144:147], v[8:11], v[40:43]
  v_mfma_f32_16x16x32_bf16 v[44:47], v[168:171], v[4:7], v[44:47]
  v_mfma_f32_16x16x32_bf16 v[48:51], v[168:171], v[8:11], v[48:51]
  s_waitcnt lgkmcnt(0)
  v_mfma_f32_16x16x32_bf16 v[36:39], a[148:151], v[12:15], v[36:39]
  v_mfma_f32_16x16x32_bf16 v[40:43], a[148:151], v[16:19], v[40:43]
  v_mfma_f32_16x16x32_bf16 v[44:47], v[172:175], v[12:15], v[44:47]
  v_mfma_f32_16x16x32_bf16 v[48:51], v[172:175], v[16:19], v[48:51]
  s_nop 7
  s_branch L_F2_epi
L_F2_nopf:
  s_waitcnt lgkmcnt(4)
  v_mfma_f32_16x16x32_bf16 v[36:39], a[84:87], v[12:15], v[36:39]
  ds_read_b128 v[4:7], v73 offset:49152
  v_mfma_f32_16x16x32_bf16 v[40:43], a[84:87], v[16:19], v[40:43]
  ds_read_b128 v[8:11], v73 offset:50176
  v_mfma_f32_16x16x32_bf16 v[44:47], a[236:239], v[12:15], v[44:47]
  v_mfma_f32_16x16x32_bf16 v[48:51], a[236:239], v[16:19], v[48:51]
  s_waitcnt lgkmcnt(4)
  v_mfma_f32_16x16x32_bf16 v[36:39], a[88:91], v[20:23], v[36:39]
  ds_read_b128 v[12:15], v73 offset:51200
  v_mfma_f32_16x16x32_bf16 v[40:43], a[88:91], v[24:27], v[40:43]
  ds_read_b128 v[16:19], v73 offset:52224
  v_mfma_f32_16x16x32_bf16 v[44:47], a[240:243], v[20:23], v[44:47]
  v_mfma_f32_16x16x32_bf16 v[48:51], a[240:243], v[24:27], v[48:51]
  s_waitcnt lgkmcnt(4)
  v_mfma_f32_16x16x32_bf16 v[36:39], a[92:95], v[28:31], v[36:39]
  ds_read_b128 v[20:23], v73 offset:53248
  v_mfma_f32_16x16x32_bf16 v[40:43], a[92:95], v[32:35], v[40:43]
  ds_read_b128 v[24:27], v73 offset:54272
  v_mfma_f32_16x16x32_bf16 v[44:47], a[244:247], v[28:31], v[44:47]
  v_mfma_f32_16x16x32_bf16 v[48:51], a[244:247], v[32:35], v[48:51]
  s_waitcnt lgkmcnt(4)
  v_mfma_f32_16x16x32_bf16 v[36:39], a[96:99], v[4:7], v[36:39]
  ds_read_b128 v[28:31], v73 offset:55296
  v_mfma_f32_16x16x32_bf16 v[40:43], a[96:99], v[8:11], v[40:43]
  ds_read_b128 v[32:35], v73 offset:56320
  v_mfma_f32_16x16x32_bf16 v[44:47], a[248:251], v[4:7], v[44:47]
  v_mfma_f32_16x16x32_bf16 v[48:51], a[248:251], v[8:11], v[48:51]
  s_waitcnt lgkmcnt(4)
  v_mfma_f32_16x16x32_bf16 v[36:39], a[100:103], v[12:15], v[36:39]
  ds_read_b128 v[4:7], v73 offset:57344
  v_mfma_f32_16x16x32_bf16 v[40:43], a[100:103], v[16:19], v[40:43]
  ds_read_b128 v[8:11], v73 offset:58368
  v_mfma_f32_16x16x32_bf16 v[44:47], a[252:255], v[12:15], v[44:47]
  v_mfma_f32_16x16x32_bf16 v[48:51], a[252:255], v[16:19], v[48:51]
  s_waitcnt lgkmcnt(4)
  v_mfma_f32_16x16x32_bf16 v[36:39], a[104:107], v[20:23], v[36:39]
  ds_read_b128 v[12:15], v73 offset:59392
  v_mfma_f32_16x16x32_bf16 v[40:43], a[104:107], v[24:27], v[40:43]
  ds_read_b128 v[16:19], v73 offset:60416
  v_mfma_f32_16x16x32_bf16 v[44:47], v[128:131], v[20:23], v[44:47]
  v_mfma_f32_16x16x32_bf16 v[48:51], v[128:131], v[24:27], v[48:51]
  s_waitcnt lgkmcnt(4)
  v_mfma_f32_16x16x32_bf16 v[36:39], a[108:111], v[28:31], v[36:39]
  ds_read_b128 v[20:23], v73 offset:61440
  v_mfma_f32_16x16x32_bf16 v[40:43], a[108:111], v[32:35], v[40:43]
  ds_read_b128 v[24:27], v73 offset:62464
  v_mfma_f32_16x16x32_bf16 v[44:47], v[132:135], v[28:31], v[44:47]
  v_mfma_f32_16x16x32_bf16 v[48:51], v[132:135], v[32:35], v[48:51]
  s_waitcnt lgkmcnt(4)
  v_mfma_f32_16x16x32_bf16 v[36:39], a[112:115], v[4:7], v[36:39]
  ds_read_b128 v[28:31], v73 offset:63488
  v_mfma_f32_16x16x32_bf16 v[40:43], a[112:115], v[8:11], v[40:43]
  ds_read_b128 v[32:35], v73 offset:64512
  v_mfma_f32_16x16x32_bf16 v[44:47], v[136:139], v[4:7], v[44:47]
  v_mfma_f32_16x16x32_bf16 v[48:51], v[136:139], v[8:11], v[48:51]
  s_waitcnt lgkmcnt(4)
  v_mfma_f32_16x16x32_bf16 v[36:39], a[116:119], v[12:15], v[36:39]
  ds_read_b128 v[4:7], v74 offset:0
  v_mfma_f32_16x16x32_bf16 v[40:43], a[116:119], v[16:19], v[40:43]
  ds_read_b128 v[8:11], v74 offset:1024
  v_mfma_f32_16x16x32_bf16 v[44:47], v[140:143], v[12:15], v[44:47]
  v_mfma_f32_16x16x32_bf16 v[48:51], v[140:143], v[16:19], v[48:51]
  s_waitcnt lgkmcnt(4)
  v_mfma_f32_16x16x32_bf16 v[36:39], a[120:123], v[20:23], v[36:39]
  ds_read_b128 v[12:15], v74 offset:2048
  v_mfma_f32_16x16x32_bf16 v[40:43], a[120:123], v[24:27], v[40:43]
  ds_read_b128 v[16:19], v74 offset:3072
  v_mfma_f32_16x16x32_bf16 v[44:47], v[144:147], v[20:23], v[44:47]
  v_mfma_f32_16x16x32_bf16 v[48:51], v[144:147], v[24:27], v[48:51]
  s_waitcnt lgkmcnt(4)
  v_mfma_f32_16x16x32_bf16 v[36:39], a[124:127], v[28:31], v[36:39]
  ds_read_b128 v[20:23], v74 offset:4096
  v_mfma_f32_16x16x32_bf16 v[40:43], a[124:127], v[32:35], v[40:43]
  ds_read_b128 v[24:27], v74 offset:5120
  v_mfma_f32_16x16x32_bf16 v[44:47], v[148:151], v[28:31], v[44:47]
  v_mfma_f32_16x16x32_bf16 v[48:51], v[148:151], v[32:35], v[48:51]
  s_waitcnt lgkmcnt(4)
  v_mfma_f32_16x16x32_bf16 v[36:39], a[128:131], v[4:7], v[36:39]
  ds_read_b128 v[28:31], v74 offset:6144
  v_mfma_f32_16x16x32_bf16 v[40:43], a[128:131], v[8:11], v[40:43]
  ds_read_b128 v[32:35], v74 offset:7168
  v_mfma_f32_16x16x32_bf16 v[44:47], v[152:155], v[4:7], v[44:47]
  v_mfma_f32_16x16x32_bf16 v[48:51], v[152:155], v[8:11], v[48:51]
  s_waitcnt lgkmcnt(4)
  v_mfma_f32_16x16x32_bf16 v[36:39], a[132:135], v[12:15], v[36:39]
  ds_read_b128 v[4:7], v74 offset:8192
  v_mfma_f32_16x16x32_bf16 v[40:43], a[132:135], v[16:19], v[40:43]
  ds_read_b128 v[8:11], v74 offset:9216
  v_mfma_f32_16x16x32_bf16 v[44:47], v[156:159], v[12:15], v[44:47]
  v_mfma_f32_16x16x32_bf16 v[48:51], v[156:159], v[16:19], v[48:51]
  s_waitcnt lgkmcnt(4)
  v_mfma_f32_16x16x32_bf16 v[36:39], a[136:139], v[20:23], v[36:39]
  ds_read_b128 v[12:15], v74 offset:10240
  v_mfma_f32_16x16x32_bf16 v[40:43], a[136:139], v[24:27], v[40:43]
  ds_read_b128 v[16:19], v74 offset:11264
  v_mfma_f32_16x16x32_bf16 v[44:47], v[160:163], v[20:23], v[44:47]
  v_mfma_f32_16x16x32_bf16 v[48:51], v[160:163], v[24:27], v[48:51]
  s_waitcnt lgkmcnt(4)
  v_mfma_f32_16x16x32_bf16 v[36:39], a[140:143], v[28:31], v[36:39]
  v_mfma_f32_16x16x32_bf16 v[40:43], a[140:143], v[32:35], v[40:43]
  v_mfma_f32_16x16x32_bf16 v[44:47], v[164:167], v[28:31], v[44:47]
  v_mfma_f32_16x16x32_bf16 v[48:51], v[164:167], v[32:35], v[48:51]
  s_waitcnt lgkmcnt(2)
  v_mfma_f32_16x16x32_bf16 v[36:39], a[144:147], v[4:7], v[36:39]
  v_mfma_f32_16x16x32_bf16 v[40:43], a[144:147], v[8:11], v[40:43]
  v_mfma_f32_16x16x32_bf16 v[44:47], v[168:171], v[4:7], v[44:47]
  v_mfma_f32_16x16x32_bf16 v[48:51], v[168:171], v[8:11], v[48:51]
  s_waitcnt lgkmcnt(0)
  v_mfma_f32_16x16x32_bf16 v[36:39], a[148:151], v[12:15], v[36:39]
  v_mfma_f32_16x16x32_bf16 v[40:43], a[148:151], v[16:19], v[40:43]
  v_mfma_f32_16x16x32_bf16 v[44:47], v[172:175], v[12:15], v[44:47]
  v_mfma_f32_16x16x32_bf16 v[48:51], v[172:175], v[16:19], v[48:51]
L_F2_epi:
  s_nop 4
  v_cvt_pk_bf16_f32 v52, v36, v37
  v_cvt_pk_bf16_f32 v53, v38, v39
  v_cvt_pk_bf16_f32 v54, v44, v45
  v_cvt_pk_bf16_f32 v55, v46, v47
  buffer_store_dwordx4 v[52:55], v68, s[4:7], s31 offen offset:0 sc1
  v_cvt_pk_bf16_f32 v56, v40, v41
  v_cvt_pk_bf16_f32 v57, v42, v43
  v_cvt_pk_bf16_f32 v58, v48, v49
  v_cvt_pk_bf16_f32 v59, v50, v51
  buffer_store_dwordx4 v[56:59], v68, s[4:7], s31 offen offset:1024 sc1
  s_add_u32 s25, s25, 1
  s_add_u32 s31, s31, 196608
  s_branch L_F2_top
L_WOF:
  s_load_dwordx2 s[8:9], s[0:1], 40
  s_mov_b32 s10, 8388608
  s_mov_b32 s11, 0x20000
  s_waitcnt lgkmcnt(0)
  v_bfe_u32 v1, v0, 5, 1
  v_mul_u32_u24 v1, 131072, v1
  v_bfe_u32 v2, v0, 4, 1
  v_mul_u32_u24 v2, 8192, v2
  v_add_u32 v1, v1, v2
  v_bfe_u32 v2, v0, 3, 1
  v_mul_u32_u24 v2, 2048, v2
  v_add_u32 v1, v1, v2
  v_lshrrev_b32 v2, 3, v0
  v_and_b32 v2, 6, v2
  v_xor_b32 v2, v2, v0
  v_and_b32 v2, 7, v2
  v_lshl_add_u32 v1, v2, 4, v1
  v_bfe_u32 v2, v0, 3, 2
  v_xor_b32 v2, 0, v2
  v_lshlrev_b32 v2, 5, v2
  v_lshrrev_b32 v4, 2, v0
  v_lshl_add_u32 v4, v4, 7, v2
  v_and_b32 v2, 3, v0
  v_lshl_add_u32 v4, v2, 3, v4
  s_and_b32 s43, s21, 3
  s_lshl_b32 s43, s43, 2
  s_add_u32 s43, s43, s20
  s_lshr_b32 s44, s21, 2
  s_lshl_b32 s40, s43, 19
  s_lshl_b32 s41, s44, 7
  s_add_u32 s40, s40, s41
  v_add_u32 v1, s40, v1
  s_lshl_b32 s41, s20, 15
  v_add_u32 v4, s41, v4
  s_lshl_b32 s40, s44, 19
  s_lshl_b32 s45, s43, 14
  s_add_u32 s40, s40, s45
  v_lshl_add_u32 v3, v0, 4, s40
  v_xor_b32 v5, 32, v4
  v_xor_b32 v6, 64, v4
  v_xor_b32 v7, 96, v4
  s_add_u32 m0, s41, 0
  s_mov_b32 s42, 0
  buffer_load_dwordx4 v1, s[8:11], s42 offen nt lds
  s_add_u32 m0, s41, 1024
  s_mov_b32 s42, 16384
  buffer_load_dwordx4 v1, s[8:11], s42 offen nt lds
  s_add_u32 m0, s41, 2048
  s_mov_b32 s42, 4096
  buffer_load_dwordx4 v1, s[8:11], s42 offen nt lds
  s_add_u32 m0, s41, 3072
  s_mov_b32 s42, 20480
  buffer_load_dwordx4 v1, s[8:11], s42 offen nt lds
  s_add_u32 m0, s41, 4096
  s_mov_b32 s42, 32768
  buffer_load_dwordx4 v1, s[8:11], s42 offen nt lds
  s_add_u32 m0, s41, 5120
  s_mov_b32 s42, 49152
  buffer_load_dwordx4 v1, s[8:11], s42 offen nt lds
  s_add_u32 m0, s41, 6144
  s_mov_b32 s42, 36864
  buffer_load_dwordx4 v1, s[8:11], s42 offen nt lds
  s_add_u32 m0, s41, 7168
  s_mov_b32 s42, 53248
  buffer_load_dwordx4 v1, s[8:11], s42 offen nt lds
  s_add_u32 m0, s41, 8192
  s_mov_b32 s42, 65536
  buffer_load_dwordx4 v1, s[8:11], s42 offen nt lds
  s_add_u32 m0, s41, 9216
  s_mov_b32 s42, 81920
  buffer_load_dwordx4 v1, s[8:11], s42 offen nt lds
  s_add_u32 m0, s41, 10240
  s_mov_b32 s42, 69632
  buffer_load_dwordx4 v1, s[8:11], s42 offen nt lds
  s_add_u32 m0, s41, 11264
  s_mov_b32 s42, 86016
  buffer_load_dwordx4 v1, s[8:11], s42 offen nt lds
  s_add_u32 m0, s41, 12288
  s_mov_b32 s42, 98304
  buffer_load_dwordx4 v1, s[8:11], s42 offen nt lds
  s_add_u32 m0, s41, 13312
  s_mov_b32 s42, 114688
  buffer_load_dwordx4 v1, s[8:11], s42 offen nt lds
  s_add_u32 m0, s41, 14336
  s_mov_b32 s42, 102400
  buffer_load_dwordx4 v1, s[8:11], s42 offen nt lds
  s_add_u32 m0, s41, 15360
  s_mov_b32 s42, 118784
  buffer_load_dwordx4 v1, s[8:11], s42 offen nt lds
  s_add_u32 m0, s41, 16384
  s_mov_b32 s42, 262144
  buffer_load_dwordx4 v1, s[8:11], s42 offen nt lds
  s_add_u32 m0, s41, 17408
  s_mov_b32 s42, 278528
  buffer_load_dwordx4 v1, s[8:11], s42 offen nt lds
  s_add_u32 m0, s41, 18432
  s_mov_b32 s42, 266240
  buffer_load_dwordx4 v1, s[8:11], s42 offen nt lds
  s_add_u32 m0, s41, 19456
  s_mov_b32 s42, 282624
  buffer_load_dwordx4 v1, s[8:11], s42 offen nt lds
  s_add_u32 m0, s41, 20480
  s_mov_b32 s42, 294912
  buffer_load_dwordx4 v1, s[8:11], s42 offen nt lds
  s_add_u32 m0, s41, 21504
  s_mov_b32 s42, 311296
  buffer_load_dwordx4 v1, s[8:11], s42 offen nt lds
  s_add_u32 m0, s41, 22528
  s_mov_b32 s42, 299008
  buffer_load_dwordx4 v1, s[8:11], s42 offen nt lds
  s_add_u32 m0, s41, 23552
  s_mov_b32 s42, 315392
  buffer_load_dwordx4 v1, s[8:11], s42 offen nt lds
  s_add_u32 m0, s41, 24576
  s_mov_b32 s42, 327680
  buffer_load_dwordx4 v1, s[8:11], s42 offen nt lds
  s_add_u32 m0, s41, 25600
  s_mov_b32 s42, 344064
  buffer_load_dwordx4 v1, s[8:11], s42 offen nt lds
  s_add_u32 m0, s41, 26624
  s_mov_b32 s42, 331776
  buffer_load_dwordx4 v1, s[8:11], s42 offen nt lds
  s_add_u32 m0, s41, 27648
  s_mov_b32 s42, 348160
  buffer_load_dwordx4 v1, s[8:11], s42 offen nt lds
  s_add_u32 m0, s41, 28672
  s_mov_b32 s42, 360448
  buffer_load_dwordx4 v1, s[8:11], s42 offen nt lds
  s_add_u32 m0, s41, 29696
  s_mov_b32 s42, 376832
  buffer_load_dwordx4 v1, s[8:11], s42 offen nt lds
  s_add_u32 m0, s41, 30720
  s_mov_b32 s42, 364544
  buffer_load_dwordx4 v1, s[8:11], s42 offen nt lds
  s_add_u32 m0, s41, 31744
  s_mov_b32 s42, 380928
  buffer_load_dwordx4 v1, s[8:11], s42 offen nt lds
  s_waitcnt vmcnt(24)
  ds_read_b64_tr_b16 v[8:9], v4 offset:0
  ds_read_b64_tr_b16 v[10:11], v4 offset:2048
  ds_read_b64_tr_b16 v[12:13], v4 offset:4096
  ds_read_b64_tr_b16 v[14:15], v4 offset:6144
  ds_read_b64_tr_b16 v[16:17], v5 offset:0
  ds_read_b64_tr_b16 v[18:19], v5 offset:2048
  ds_read_b64_tr_b16 v[20:21], v5 offset:4096
  ds_read_b64_tr_b16 v[22:23], v5 offset:6144
  ds_read_b64_tr_b16 v[24:25], v6 offset:0
  ds_read_b64_tr_b16 v[26:27], v6 offset:2048
  ds_read_b64_tr_b16 v[28:29], v6 offset:4096
  ds_read_b64_tr_b16 v[30:31], v6 offset:6144
  ds_read_b64_tr_b16 v[32:33], v7 offset:0
  ds_read_b64_tr_b16 v[34:35], v7 offset:2048
  ds_read_b64_tr_b16 v[36:37], v7 offset:4096
  ds_read_b64_tr_b16 v[38:39], v7 offset:6144
  s_mov_b32 s42, 14680064
  s_waitcnt lgkmcnt(12)
  buffer_store_dwordx4 v[8:11], v3, s[4:7], s42 offen offset:0 sc1
  buffer_store_dwordx4 v[12:15], v3, s[4:7], s42 offen offset:1024 sc1
  s_mov_b32 s42, 14680064
  s_waitcnt lgkmcnt(8)
  buffer_store_dwordx4 v[16:19], v3, s[4:7], s42 offen offset:2048 sc1
  buffer_store_dwordx4 v[20:23], v3, s[4:7], s42 offen offset:3072 sc1
  s_mov_b32 s42, 14942208
  s_waitcnt lgkmcnt(4)
  buffer_store_dwordx4 v[24:27], v3, s[4:7], s42 offen offset:0 sc1
  buffer_store_dwordx4 v[28:31], v3, s[4:7], s42 offen offset:1024 sc1
  s_mov_b32 s42, 14942208
  s_waitcnt lgkmcnt(0)
  buffer_store_dwordx4 v[32:35], v3, s[4:7], s42 offen offset:2048 sc1
  buffer_store_dwordx4 v[36:39], v3, s[4:7], s42 offen offset:3072 sc1
  s_waitcnt vmcnt(24)
  ds_read_b64_tr_b16 v[40:41], v4 offset:8192
  ds_read_b64_tr_b16 v[42:43], v4 offset:10240
  ds_read_b64_tr_b16 v[44:45], v4 offset:12288
  ds_read_b64_tr_b16 v[46:47], v4 offset:14336
  ds_read_b64_tr_b16 v[48:49], v5 offset:8192
  ds_read_b64_tr_b16 v[50:51], v5 offset:10240
  ds_read_b64_tr_b16 v[52:53], v5 offset:12288
  ds_read_b64_tr_b16 v[54:55], v5 offset:14336
  ds_read_b64_tr_b16 v[56:57], v6 offset:8192
  ds_read_b64_tr_b16 v[58:59], v6 offset:10240
  ds_read_b64_tr_b16 v[60:61], v6 offset:12288
  ds_read_b64_tr_b16 v[62:63], v6 offset:14336
  ds_read_b64_tr_b16 v[64:65], v7 offset:8192
  ds_read_b64_tr_b16 v[66:67], v7 offset:10240
  ds_read_b64_tr_b16 v[68:69], v7 offset:12288
  ds_read_b64_tr_b16 v[70:71], v7 offset:14336
  s_mov_b32 s42, 14684160
  s_waitcnt lgkmcnt(12)
  buffer_store_dwordx4 v[40:43], v3, s[4:7], s42 offen offset:0 sc1
  buffer_store_dwordx4 v[44:47], v3, s[4:7], s42 offen offset:1024 sc1
  s_mov_b32 s42, 14684160
  s_waitcnt lgkmcnt(8)
  buffer_store_dwordx4 v[48:51], v3, s[4:7], s42 offen offset:2048 sc1
  buffer_store_dwordx4 v[52:55], v3, s[4:7], s42 offen offset:3072 sc1
  s_mov_b32 s42, 14946304
  s_waitcnt lgkmcnt(4)
  buffer_store_dwordx4 v[56:59], v3, s[4:7], s42 offen offset:0 sc1
  buffer_store_dwordx4 v[60:63], v3, s[4:7], s42 offen offset:1024 sc1
  s_mov_b32 s42, 14946304
  s_waitcnt lgkmcnt(0)
  buffer_store_dwordx4 v[64:67], v3, s[4:7], s42 offen offset:2048 sc1
  buffer_store_dwordx4 v[68:71], v3, s[4:7], s42 offen offset:3072 sc1
  s_waitcnt vmcnt(24)
  ds_read_b64_tr_b16 v[72:73], v4 offset:16384
  ds_read_b64_tr_b16 v[74:75], v4 offset:18432
  ds_read_b64_tr_b16 v[76:77], v4 offset:20480
  ds_read_b64_tr_b16 v[78:79], v4 offset:22528
  ds_read_b64_tr_b16 v[80:81], v5 offset:16384
  ds_read_b64_tr_b16 v[82:83], v5 offset:18432
  ds_read_b64_tr_b16 v[84:85], v5 offset:20480
  ds_read_b64_tr_b16 v[86:87], v5 offset:22528
  ds_read_b64_tr_b16 v[88:89], v6 offset:16384
  ds_read_b64_tr_b16 v[90:91], v6 offset:18432
  ds_read_b64_tr_b16 v[92:93], v6 offset:20480
  ds_read_b64_tr_b16 v[94:95], v6 offset:22528
  ds_read_b64_tr_b16 v[96:97], v7 offset:16384
  ds_read_b64_tr_b16 v[98:99], v7 offset:18432
  ds_read_b64_tr_b16 v[100:101], v7 offset:20480
  ds_read_b64_tr_b16 v[102:103], v7 offset:22528
  s_mov_b32 s42, 14688256
  s_waitcnt lgkmcnt(12)
  buffer_store_dwordx4 v[72:75], v3, s[4:7], s42 offen offset:0 sc1
  buffer_store_dwordx4 v[76:79], v3, s[4:7], s42 offen offset:1024 sc1
  s_mov_b32 s42, 14688256
  s_waitcnt lgkmcnt(8)
  buffer_store_dwordx4 v[80:83], v3, s[4:7], s42 offen offset:2048 sc1
  buffer_store_dwordx4 v[84:87], v3, s[4:7], s42 offen offset:3072 sc1
  s_mov_b32 s42, 14950400
  s_waitcnt lgkmcnt(4)
  buffer_store_dwordx4 v[88:91], v3, s[4:7], s42 offen offset:0 sc1
  buffer_store_dwordx4 v[92:95], v3, s[4:7], s42 offen offset:1024 sc1
  s_mov_b32 s42, 14950400
  s_waitcnt lgkmcnt(0)
  buffer_store_dwordx4 v[96:99], v3, s[4:7], s42 offen offset:2048 sc1
  buffer_store_dwordx4 v[100:103], v3, s[4:7], s42 offen offset:3072 sc1
  s_waitcnt vmcnt(24)
  ds_read_b64_tr_b16 v[104:105], v4 offset:24576
  ds_read_b64_tr_b16 v[106:107], v4 offset:26624
  ds_read_b64_tr_b16 v[108:109], v4 offset:28672
  ds_read_b64_tr_b16 v[110:111], v4 offset:30720
  ds_read_b64_tr_b16 v[112:113], v5 offset:24576
  ds_read_b64_tr_b16 v[114:115], v5 offset:26624
  ds_read_b64_tr_b16 v[116:117], v5 offset:28672
  ds_read_b64_tr_b16 v[118:119], v5 offset:30720
  ds_read_b64_tr_b16 v[120:121], v6 offset:24576
  ds_read_b64_tr_b16 v[122:123], v6 offset:26624
  ds_read_b64_tr_b16 v[124:125], v6 offset:28672
  ds_read_b64_tr_b16 v[126:127], v6 offset:30720
  ds_read_b64_tr_b16 v[128:129], v7 offset:24576
  ds_read_b64_tr_b16 v[130:131], v7 offset:26624
  ds_read_b64_tr_b16 v[132:133], v7 offset:28672
  ds_read_b64_tr_b16 v[134:135], v7 offset:30720
  s_mov_b32 s42, 14692352
  s_waitcnt lgkmcnt(12)
  buffer_store_dwordx4 v[104:107], v3, s[4:7], s42 offen offset:0 sc1
  buffer_store_dwordx4 v[108:111], v3, s[4:7], s42 offen offset:1024 sc1
  s_mov_b32 s42, 14692352
  s_waitcnt lgkmcnt(8)
  buffer_store_dwordx4 v[112:115], v3, s[4:7], s42 offen offset:2048 sc1
  buffer_store_dwordx4 v[116:119], v3, s[4:7], s42 offen offset:3072 sc1
  s_mov_b32 s42, 14954496
  s_waitcnt lgkmcnt(4)
  buffer_store_dwordx4 v[120:123], v3, s[4:7], s42 offen offset:0 sc1
  buffer_store_dwordx4 v[124:127], v3, s[4:7], s42 offen offset:1024 sc1
  s_mov_b32 s42, 14954496
  s_waitcnt lgkmcnt(0)
  buffer_store_dwordx4 v[128:131], v3, s[4:7], s42 offen offset:2048 sc1
  buffer_store_dwordx4 v[132:135], v3, s[4:7], s42 offen offset:3072 sc1
  v_min_u32 v1, 31, v0
  v_lshlrev_b32 v1, 2, v1
  v_add_u32 v1, 128, v1
  s_nop 1
Lpoll_44:
  buffer_load_dword v2, v1, s[12:15], 0 offen sc1
  s_sub_u32 s24, s24, 1
  s_cbranch_scc1 L_FAIL
  s_waitcnt vmcnt(0)
  v_cmp_gt_i32 vcc, 1, v2
  s_cbranch_vccz Lpolld_45
  s_sleep 2
  s_branch Lpoll_44
Lpolld_45:
  s_barrier
  s_lshl_b32 s40, s21, 7
  s_add_u32 s40, s40, 1432576
  s_cmp_lg_u32 s20, 0
  s_cbranch_scc1 Lnosig_46
  s_mov_b32 s63, 1
  s_atomic_smax s63, s[4:5], s40 glc
Lnosig_46:
  s_branch L_LN1
L_QK:
  v_bfe_u32 v76, v0, 3, 2
  v_xor_b32 v76, s20, v76
  v_lshlrev_b32 v76, 5, v76
  v_lshrrev_b32 v4, 2, v0
  v_lshl_add_u32 v4, v4, 7, v76
  v_and_b32 v76, 3, v0
  v_lshl_add_u32 v4, v76, 3, v4
  s_lshl_b32 s40, s20, 15
  v_add_u32 v4, s40, v4
  v_lshl_add_u32 v85, v0, 4, s40
  s_lshl_b32 s40, s20, 12
  s_add_u32 s40, s40, 131072
  v_lshl_add_u32 v1, v0, 4, s40
  s_lshr_b32 s54, s21, 4
  s_lshl_b32 s52, s54, 22
  s_sub_u32 s53, 0, s52
  v_xor_b32 v5, 32768, v4
  v_xor_b32 v2, 4096, v1
  v_xor_b32 v6, 65536, v4
  v_xor_b32 v3, 8192, v1
  v_xor_b32 v7, 98304, v4
  v_xor_b32 v84, 12288, v1
  v_bfe_u32 v8, v0, 5, 1
  v_mul_u32_u24 v8, 16384, v8
  v_bfe_u32 v76, v0, 4, 1
  v_mul_u32_u24 v76, 32768, v76
  v_add_u32 v8, v8, v76
  v_bfe_u32 v76, v0, 3, 1
  v_mul_u32_u24 v76, 131072, v76
  v_add_u32 v8, v8, v76
  v_lshrrev_b32 v76, 3, v0
  v_and_b32 v76, 6, v76
  v_xor_b32 v76, v76, v0
  v_and_b32 v76, 7, v76
  v_lshl_add_u32 v8, v76, 4, v8
  s_lshl_b32 s40, s20, 19
  v_add_u32 v8, s40, v8
  s_lshl_b32 s44, s21, 8
  s_add_u32 s45, s44, 128
  s_load_dwordx2 s[8:9], s[0:1], 16
  s_mov_b32 s10, 8388608
  s_mov_b32 s11, 0x20000
  s_waitcnt lgkmcnt(0)
  v_add_u32 v9, s44, v8
  v_add_u32 v10, s45, v8
  v_add_u32 v11, s44, v8
  v_add_u32 v12, s45, v8
  s_lshl_b32 s41, s20, 15
  s_add_u32 m0, s41, 0
  s_add_u32 s42, s52, 0
  buffer_load_dwordx4 v9, s[8:11], s42 offen lds
  s_add_u32 m0, s41, 1024
  s_add_u32 s42, s52, 65536
  buffer_load_dwordx4 v9, s[8:11], s42 offen lds
  s_add_u32 m0, s41, 2048
  s_add_u32 s42, s52, 8192
  buffer_load_dwordx4 v9, s[8:11], s42 offen lds
  s_add_u32 m0, s41, 3072
  s_add_u32 s42, s52, 73728
  buffer_load_dwordx4 v9, s[8:11], s42 offen lds
  s_add_u32 m0, s41, 4096
  s_add_u32 s42, s52, 262144
  buffer_load_dwordx4 v9, s[8:11], s42 offen lds
  s_add_u32 m0, s41, 5120
  s_add_u32 s42, s52, 327680
  buffer_load_dwordx4 v9, s[8:11], s42 offen lds
  s_add_u32 m0, s41, 6144
  s_add_u32 s42, s52, 270336
  buffer_load_dwordx4 v9, s[8:11], s42 offen lds
  s_add_u32 m0, s41, 7168
  s_add_u32 s42, s52, 335872
  buffer_load_dwordx4 v9, s[8:11], s42 offen lds
  s_add_u32 m0, s41, 8192
  s_add_u32 s42, s52, 2097152
  buffer_load_dwordx4 v9, s[8:11], s42 offen lds
  s_add_u32 m0, s41, 9216
  s_add_u32 s42, s52, 2162688
  buffer_load_dwordx4 v9, s[8:11], s42 offen lds
  s_add_u32 m0, s41, 10240
  s_add_u32 s42, s52, 2105344
  buffer_load_dwordx4 v9, s[8:11], s42 offen lds
  s_add_u32 m0, s41, 11264
  s_add_u32 s42, s52, 2170880
  buffer_load_dwordx4 v9, s[8:11], s42 offen lds
  s_add_u32 m0, s41, 12288
  s_add_u32 s42, s52, 2359296
  buffer_load_dwordx4 v9, s[8:11], s42 offen lds
  s_add_u32 m0, s41, 13312
  s_add_u32 s42, s52, 2424832
  buffer_load_dwordx4 v9, s[8:11], s42 offen lds
  s_add_u32 m0, s41, 14336
  s_add_u32 s42, s52, 2367488
  buffer_load_dwordx4 v9, s[8:11], s42 offen lds
  s_add_u32 m0, s41, 15360
  s_add_u32 s42, s52, 2433024
  buffer_load_dwordx4 v9, s[8:11], s42 offen lds
  s_add_u32 m0, s41, 16384
  s_add_u32 s42, s53, 4194304
  buffer_load_dwordx4 v9, s[8:11], s42 offen lds
  s_add_u32 m0, s41, 17408
  s_add_u32 s42, s53, 4259840
  buffer_load_dwordx4 v9, s[8:11], s42 offen lds
  s_add_u32 m0, s41, 18432
  s_add_u32 s42, s53, 4202496
  buffer_load_dwordx4 v9, s[8:11], s42 offen lds
  s_add_u32 m0, s41, 19456
  s_add_u32 s42, s53, 4268032
  buffer_load_dwordx4 v9, s[8:11], s42 offen lds
  s_add_u32 m0, s41, 20480
  s_add_u32 s42, s53, 4456448
  buffer_load_dwordx4 v9, s[8:11], s42 offen lds
  s_add_u32 m0, s41, 21504
  s_add_u32 s42, s53, 4521984
  buffer_load_dwordx4 v9, s[8:11], s42 offen lds
  s_add_u32 m0, s41, 22528
  s_add_u32 s42, s53, 4464640
  buffer_load_dwordx4 v9, s[8:11], s42 offen lds
  s_add_u32 m0, s41, 23552
  s_add_u32 s42, s53, 4530176
  buffer_load_dwordx4 v9, s[8:11], s42 offen lds
  s_waitcnt vmcnt(16) lgkmcnt(0)
  s_barrier
  s_add_u32 m0, s41, 24576
  s_add_u32 s42, s53, 6291456
  buffer_load_dwordx4 v9, s[8:11], s42 offen lds
  s_add_u32 m0, s41, 25600
  s_add_u32 s42, s53, 6356992
  buffer_load_dwordx4 v9, s[8:11], s42 offen lds
  s_add_u32 m0, s41, 26624
  s_add_u32 s42, s53, 6299648
  buffer_load_dwordx4 v9, s[8:11], s42 offen lds
  s_add_u32 m0, s41, 27648
  s_add_u32 s42, s53, 6365184
  buffer_load_dwordx4 v9, s[8:11], s42 offen lds
  s_add_u32 m0, s41, 28672
  s_add_u32 s42, s53, 6553600
  buffer_load_dwordx4 v9, s[8:11], s42 offen lds
  s_add_u32 m0, s41, 29696
  s_add_u32 s42, s53, 6619136
  buffer_load_dwordx4 v9, s[8:11], s42 offen lds
  s_add_u32 m0, s41, 30720
  s_add_u32 s42, s53, 6561792
  buffer_load_dwordx4 v9, s[8:11], s42 offen lds
  s_add_u32 m0, s41, 31744
  s_add_u32 s42, s53, 6627328
  buffer_load_dwordx4 v9, s[8:11], s42 offen lds
  ds_read_b64_tr_b16 a[0:1], v4 offset:0
  ds_read_b64_tr_b16 a[2:3], v4 offset:2048
  ds_read_b64_tr_b16 a[4:5], v4 offset:4096
  ds_read_b64_tr_b16 a[6:7], v4 offset:6144
  ds_read_b64_tr_b16 a[16:17], v5 offset:0
  ds_read_b64_tr_b16 a[18:19], v5 offset:2048
  ds_read_b64_tr_b16 a[20:21], v5 offset:4096
  ds_read_b64_tr_b16 a[22:23], v5 offset:6144
  ds_read_b64_tr_b16 a[32:33], v6 offset:0
  ds_read_b64_tr_b16 a[34:35], v6 offset:2048
  ds_read_b64_tr_b16 a[36:37], v6 offset:4096
  ds_read_b64_tr_b16 a[38:39], v6 offset:6144
  ds_read_b64_tr_b16 a[48:49], v7 offset:0
  ds_read_b64_tr_b16 a[50:51], v7 offset:2048
  ds_read_b64_tr_b16 a[52:53], v7 offset:4096
  ds_read_b64_tr_b16 a[54:55], v7 offset:6144
  s_waitcnt vmcnt(16) lgkmcnt(0)
  s_barrier
  s_add_u32 m0, s41, 0
  s_add_u32 s42, s52, 0
  buffer_load_dwordx4 v10, s[8:11], s42 offen lds
  s_add_u32 m0, s41, 1024
  s_add_u32 s42, s52, 65536
  buffer_load_dwordx4 v10, s[8:11], s42 offen lds
  s_add_u32 m0, s41, 2048
  s_add_u32 s42, s52, 8192
  buffer_load_dwordx4 v10, s[8:11], s42 offen lds
  s_add_u32 m0, s41, 3072
  s_add_u32 s42, s52, 73728
  buffer_load_dwordx4 v10, s[8:11], s42 offen lds
  s_add_u32 m0, s41, 4096
  s_add_u32 s42, s52, 262144
  buffer_load_dwordx4 v10, s[8:11], s42 offen lds
  s_add_u32 m0, s41, 5120
  s_add_u32 s42, s52, 327680
  buffer_load_dwordx4 v10, s[8:11], s42 offen lds
  s_add_u32 m0, s41, 6144
  s_add_u32 s42, s52, 270336
  buffer_load_dwordx4 v10, s[8:11], s42 offen lds
  s_add_u32 m0, s41, 7168
  s_add_u32 s42, s52, 335872
  buffer_load_dwordx4 v10, s[8:11], s42 offen lds
  ds_read_b64_tr_b16 a[8:9], v4 offset:8192
  ds_read_b64_tr_b16 a[10:11], v4 offset:10240
  ds_read_b64_tr_b16 a[12:13], v4 offset:12288
  ds_read_b64_tr_b16 a[14:15], v4 offset:14336
  ds_read_b64_tr_b16 a[24:25], v5 offset:8192
  ds_read_b64_tr_b16 a[26:27], v5 offset:10240
  ds_read_b64_tr_b16 a[28:29], v5 offset:12288
  ds_read_b64_tr_b16 a[30:31], v5 offset:14336
  ds_read_b64_tr_b16 a[40:41], v6 offset:8192
  ds_read_b64_tr_b16 a[42:43], v6 offset:10240
  ds_read_b64_tr_b16 a[44:45], v6 offset:12288
  ds_read_b64_tr_b16 a[46:47], v6 offset:14336
  ds_read_b64_tr_b16 a[56:57], v7 offset:8192
  ds_read_b64_tr_b16 a[58:59], v7 offset:10240
  ds_read_b64_tr_b16 a[60:61], v7 offset:12288
  ds_read_b64_tr_b16 a[62:63], v7 offset:14336
  s_waitcnt vmcnt(16) lgkmcnt(0)
  s_barrier
  s_add_u32 m0, s41, 8192
  s_add_u32 s42, s52, 2097152
  buffer_load_dwordx4 v10, s[8:11], s42 offen lds
  s_add_u32 m0, s41, 9216
  s_add_u32 s42, s52, 2162688
  buffer_load_dwordx4 v10, s[8:11], s42 offen lds
  s_add_u32 m0, s41, 10240
  s_add_u32 s42, s52, 2105344
  buffer_load_dwordx4 v10, s[8:11], s42 offen lds
  s_add_u32 m0, s41, 11264
  s_add_u32 s42, s52, 2170880
  buffer_load_dwordx4 v10, s[8:11], s42 offen lds
  s_add_u32 m0, s41, 12288
  s_add_u32 s42, s52, 2359296
  buffer_load_dwordx4 v10, s[8:11], s42 offen lds
  s_add_u32 m0, s41, 13312
  s_add_u32 s42, s52, 2424832
  buffer_load_dwordx4 v10, s[8:11], s42 offen lds
  s_add_u32 m0, s41, 14336
  s_add_u32 s42, s52, 2367488
  buffer_load_dwordx4 v10, s[8:11], s42 offen lds
  s_add_u32 m0, s41, 15360
  s_add_u32 s42, s52, 2433024
  buffer_load_dwordx4 v10, s[8:11], s42 offen lds
  ds_read_b64_tr_b16 a[64:65], v4 offset:16384
  ds_read_b64_tr_b16 a[66:67], v4 offset:18432
  ds_read_b64_tr_b16 a[68:69], v4 offset:20480
  ds_read_b64_tr_b16 a[70:71], v4 offset:22528
  ds_read_b64_tr_b16 a[80:81], v5 offset:16384
  ds_read_b64_tr_b16 a[82:83], v5 offset:18432
  ds_read_b64_tr_b16 a[84:85], v5 offset:20480
  ds_read_b64_tr_b16 a[86:87], v5 offset:22528
  ds_read_b64_tr_b16 a[96:97], v6 offset:16384
  ds_read_b64_tr_b16 a[98:99], v6 offset:18432
  ds_read_b64_tr_b16 a[100:101], v6 offset:20480
  ds_read_b64_tr_b16 a[102:103], v6 offset:22528
  ds_read_b64_tr_b16 a[112:113], v7 offset:16384
  ds_read_b64_tr_b16 a[114:115], v7 offset:18432
  ds_read_b64_tr_b16 a[116:117], v7 offset:20480
  ds_read_b64_tr_b16 a[118:119], v7 offset:22528
  s_waitcnt vmcnt(16) lgkmcnt(0)
  s_barrier
  s_add_u32 m0, s41, 16384
  s_add_u32 s42, s53, 4194304
  buffer_load_dwordx4 v10, s[8:11], s42 offen lds
  s_add_u32 m0, s41, 17408
  s_add_u32 s42, s53, 4259840
  buffer_load_dwordx4 v10, s[8:11], s42 offen lds
  s_add_u32 m0, s41, 18432
  s_add_u32 s42, s53, 4202496
  buffer_load_dwordx4 v10, s[8:11], s42 offen lds
  s_add_u32 m0, s41, 19456
  s_add_u32 s42, s53, 4268032
  buffer_load_dwordx4 v10, s[8:11], s42 offen lds
  s_add_u32 m0, s41, 20480
  s_add_u32 s42, s53, 4456448
  buffer_load_dwordx4 v10, s[8:11], s42 offen lds
  s_add_u32 m0, s41, 21504
  s_add_u32 s42, s53, 4521984
  buffer_load_dwordx4 v10, s[8:11], s42 offen lds
  s_add_u32 m0, s41, 22528
  s_add_u32 s42, s53, 4464640
  buffer_load_dwordx4 v10, s[8:11], s42 offen lds
  s_add_u32 m0, s41, 23552
  s_add_u32 s42, s53, 4530176
  buffer_load_dwordx4 v10, s[8:11], s42 offen lds
  ds_read_b64_tr_b16 a[72:73], v4 offset:24576
  ds_read_b64_tr_b16 a[74:75], v4 offset:26624
  ds_read_b64_tr_b16 a[76:77], v4 offset:28672
  ds_read_b64_tr_b16 a[78:79], v4 offset:30720
  ds_read_b64_tr_b16 a[88:89], v5 offset:24576
  ds_read_b64_tr_b16 a[90:91], v5 offset:26624
  ds_read_b64_tr_b16 a[92:93], v5 offset:28672
  ds_read_b64_tr_b16 a[94:95], v5 offset:30720
  ds_read_b64_tr_b16 a[104:105], v6 offset:24576
  ds_read_b64_tr_b16 a[106:107], v6 offset:26624
  ds_read_b64_tr_b16 a[108:109], v6 offset:28672
  ds_read_b64_tr_b16 a[110:111], v6 offset:30720
  ds_read_b64_tr_b16 a[120:121], v7 offset:24576
  ds_read_b64_tr_b16 a[122:123], v7 offset:26624
  ds_read_b64_tr_b16 a[124:125], v7 offset:28672
  ds_read_b64_tr_b16 a[126:127], v7 offset:30720
  s_waitcnt vmcnt(16) lgkmcnt(0)
  s_barrier
  s_add_u32 m0, s41, 24576
  s_add_u32 s42, s53, 6291456
  buffer_load_dwordx4 v10, s[8:11], s42 offen lds
  s_add_u32 m0, s41, 25600
  s_add_u32 s42, s53, 6356992
  buffer_load_dwordx4 v10, s[8:11], s42 offen lds
  s_add_u32 m0, s41, 26624
  s_add_u32 s42, s53, 6299648
  buffer_load_dwordx4 v10, s[8:11], s42 offen lds
  s_add_u32 m0, s41, 27648
  s_add_u32 s42, s53, 6365184
  buffer_load_dwordx4 v10, s[8:11], s42 offen lds
  s_add_u32 m0, s41, 28672
  s_add_u32 s42, s53, 6553600
  buffer_load_dwordx4 v10, s[8:11], s42 offen lds
  s_add_u32 m0, s41, 29696
  s_add_u32 s42, s53, 6619136
  buffer_load_dwordx4 v10, s[8:11], s42 offen lds
  s_add_u32 m0, s41, 30720
  s_add_u32 s42, s53, 6561792
  buffer_load_dwordx4 v10, s[8:11], s42 offen lds
  s_add_u32 m0, s41, 31744
  s_add_u32 s42, s53, 6627328
  buffer_load_dwordx4 v10, s[8:11], s42 offen lds
  ds_read_b64_tr_b16 a[128:129], v4 offset:0
  ds_read_b64_tr_b16 a[130:131], v4 offset:2048
  ds_read_b64_tr_b16 a[132:133], v4 offset:4096
  ds_read_b64_tr_b16 a[134:135], v4 offset:6144
  ds_read_b64_tr_b16 a[144:145], v5 offset:0
  ds_read_b64_tr_b16 a[146:147], v5 offset:2048
  ds_read_b64_tr_b16 a[148:149], v5 offset:4096
  ds_read_b64_tr_b16 a[150:151], v5 offset:6144
  ds_read_b64_tr_b16 a[160:161], v6 offset:0
  ds_read_b64_tr_b16 a[162:163], v6 offset:2048
  ds_read_b64_tr_b16 a[164:165], v6 offset:4096
  ds_read_b64_tr_b16 a[166:167], v6 offset:6144
  ds_read_b64_tr_b16 a[176:177], v7 offset:0
  ds_read_b64_tr_b16 a[178:179], v7 offset:2048
  ds_read_b64_tr_b16 a[180:181], v7 offset:4096
  ds_read_b64_tr_b16 a[182:183], v7 offset:6144
  s_waitcnt vmcnt(16) lgkmcnt(0)
  s_barrier
  s_load_dwordx2 s[8:9], s[0:1], 24
  s_mov_b32 s10, 8388608
  s_mov_b32 s11, 0x20000
  s_waitcnt lgkmcnt(0)
  s_add_u32 m0, s41, 0
  s_add_u32 s42, s52, 0
  buffer_load_dwordx4 v11, s[8:11], s42 offen lds
  s_add_u32 m0, s41, 1024
  s_add_u32 s42, s52, 65536
  buffer_load_dwordx4 v11, s[8:11], s42 offen lds
  s_add_u32 m0, s41, 2048
  s_add_u32 s42, s52, 8192
  buffer_load_dwordx4 v11, s[8:11], s42 offen lds
  s_add_u32 m0, s41, 3072
  s_add_u32 s42, s52, 73728
  buffer_load_dwordx4 v11, s[8:11], s42 offen lds
  s_add_u32 m0, s41, 4096
  s_add_u32 s42, s52, 262144
  buffer_load_dwordx4 v11, s[8:11], s42 offen lds
  s_add_u32 m0, s41, 5120
  s_add_u32 s42, s52, 327680
  buffer_load_dwordx4 v11, s[8:11], s42 offen lds
  s_add_u32 m0, s41, 6144
  s_add_u32 s42, s52, 270336
  buffer_load_dwordx4 v11, s[8:11], s42 offen lds
  s_add_u32 m0, s41, 7168
  s_add_u32 s42, s52, 335872
  buffer_load_dwordx4 v11, s[8:11], s42 offen lds
  ds_read_b64_tr_b16 a[136:137], v4 offset:8192
  ds_read_b64_tr_b16 a[138:139], v4 offset:10240
  ds_read_b64_tr_b16 a[140:141], v4 offset:12288
  ds_read_b64_tr_b16 a[142:143], v4 offset:14336
  ds_read_b64_tr_b16 a[152:153], v5 offset:8192
  ds_read_b64_tr_b16 a[154:155], v5 offset:10240
  ds_read_b64_tr_b16 a[156:157], v5 offset:12288
  ds_read_b64_tr_b16 a[158:159], v5 offset:14336
  ds_read_b64_tr_b16 a[168:169], v6 offset:8192
  ds_read_b64_tr_b16 a[170:171], v6 offset:10240
  ds_read_b64_tr_b16 a[172:173], v6 offset:12288
  ds_read_b64_tr_b16 a[174:175], v6 offset:14336
  ds_read_b64_tr_b16 a[184:185], v7 offset:8192
  ds_read_b64_tr_b16 a[186:187], v7 offset:10240
  ds_read_b64_tr_b16 a[188:189], v7 offset:12288
  ds_read_b64_tr_b16 a[190:191], v7 offset:14336
  s_waitcnt vmcnt(16) lgkmcnt(0)
  s_barrier
  s_add_u32 m0, s41, 8192
  s_add_u32 s42, s52, 2097152
  buffer_load_dwordx4 v11, s[8:11], s42 offen lds
  s_add_u32 m0, s41, 9216
  s_add_u32 s42, s52, 2162688
  buffer_load_dwordx4 v11, s[8:11], s42 offen lds
  s_add_u32 m0, s41, 10240
  s_add_u32 s42, s52, 2105344
  buffer_load_dwordx4 v11, s[8:11], s42 offen lds
  s_add_u32 m0, s41, 11264
  s_add_u32 s42, s52, 2170880
  buffer_load_dwordx4 v11, s[8:11], s42 offen lds
  s_add_u32 m0, s41, 12288
  s_add_u32 s42, s52, 2359296
  buffer_load_dwordx4 v11, s[8:11], s42 offen lds
  s_add_u32 m0, s41, 13312
  s_add_u32 s42, s52, 2424832
  buffer_load_dwordx4 v11, s[8:11], s42 offen lds
  s_add_u32 m0, s41, 14336
  s_add_u32 s42, s52, 2367488
  buffer_load_dwordx4 v11, s[8:11], s42 offen lds
  s_add_u32 m0, s41, 15360
  s_add_u32 s42, s52, 2433024
  buffer_load_dwordx4 v11, s[8:11], s42 offen lds
  ds_read_b64_tr_b16 a[192:193], v4 offset:16384
  ds_read_b64_tr_b16 a[194:195], v4 offset:18432
  ds_read_b64_tr_b16 a[196:197], v4 offset:20480
  ds_read_b64_tr_b16 a[198:199], v4 offset:22528
  ds_read_b64_tr_b16 a[208:209], v5 offset:16384
  ds_read_b64_tr_b16 a[210:211], v5 offset:18432
  ds_read_b64_tr_b16 a[212:213], v5 offset:20480
  ds_read_b64_tr_b16 a[214:215], v5 offset:22528
  ds_read_b64_tr_b16 a[224:225], v6 offset:16384
  ds_read_b64_tr_b16 a[226:227], v6 offset:18432
  ds_read_b64_tr_b16 a[228:229], v6 offset:20480
  ds_read_b64_tr_b16 a[230:231], v6 offset:22528
  ds_read_b64_tr_b16 a[240:241], v7 offset:16384
  ds_read_b64_tr_b16 a[242:243], v7 offset:18432
  ds_read_b64_tr_b16 a[244:245], v7 offset:20480
  ds_read_b64_tr_b16 a[246:247], v7 offset:22528
  s_cmp_lg_u32 s20, 0
  s_cbranch_scc1 Lchore_47
Lini_48:
  s_load_dwordx16 s[64:79], s[12:13], 128 glc
  s_load_dwordx16 s[80:95], s[12:13], 192 glc
  s_sub_u32 s24, s24, 1
  s_cbranch_scc1 L_FAIL
  s_waitcnt lgkmcnt(0)
  s_and_b64 s[64:65], s[64:65], s[66:67]
  s_and_b64 s[64:65], s[64:65], s[68:69]
  s_and_b64 s[64:65], s[64:65], s[70:71]
  s_and_b64 s[64:65], s[64:65], s[72:73]
  s_and_b64 s[64:65], s[64:65], s[74:75]
  s_and_b64 s[64:65], s[64:65], s[76:77]
  s_and_b64 s[64:65], s[64:65], s[78:79]
  s_and_b64 s[64:65], s[64:65], s[80:81]
  s_and_b64 s[64:65], s[64:65], s[82:83]
  s_and_b64 s[64:65], s[64:65], s[84:85]
  s_and_b64 s[64:65], s[64:65], s[86:87]
  s_and_b64 s[64:65], s[64:65], s[88:89]
  s_and_b64 s[64:65], s[64:65], s[90:91]
  s_and_b64 s[64:65], s[64:65], s[92:93]
  s_and_b64 s[64:65], s[64:65], s[94:95]
  s_and_b32 s64, s64, s65
  s_cbranch_scc0 Lini_48
  s_mov_b32 s46, 0xffff
  s_and_b32 s40, s21, 3
  s_lshl_b32 s40, s40, 13
  s_lshr_b32 s43, s21, 2
  s_lshl_b32 s43, s43, 10
  s_add_u32 s43, s43, s40
  s_add_u32 s43, s43, 1343488
  s_waitcnt lgkmcnt(0)
  s_memtime s[64:65]
  s_waitcnt lgkmcnt(0)
  s_load_dword s68, s[4:5], s43 glc
  s_waitcnt lgkmcnt(0)
  s_memtime s[66:67]
  s_waitcnt lgkmcnt(0)
  s_sub_u32 s64, s66, s64
  s_min_u32 s46, s46, s64
Lchore_47:
  s_waitcnt vmcnt(16) lgkmcnt(0)
  s_barrier
  s_add_u32 m0, s41, 16384
  s_add_u32 s42, s53, 4194304
  buffer_load_dwordx4 v11, s[8:11], s42 offen lds
  s_add_u32 m0, s41, 17408
  s_add_u32 s42, s53, 4259840
  buffer_load_dwordx4 v11, s[8:11], s42 offen lds
  s_add_u32 m0, s41, 18432
  s_add_u32 s42, s53, 4202496
  buffer_load_dwordx4 v11, s[8:11], s42 offen lds
  s_add_u32 m0, s41, 19456
  s_add_u32 s42, s53, 4268032
  buffer_load_dwordx4 v11, s[8:11], s42 offen lds
  s_add_u32 m0, s41, 20480
  s_add_u32 s42, s53, 4456448
  buffer_load_dwordx4 v11, s[8:11], s42 offen lds
  s_add_u32 m0, s41, 21504
  s_add_u32 s42, s53, 4521984
  buffer_load_dwordx4 v11, s[8:11], s42 offen lds
  s_add_u32 m0, s41, 22528
  s_add_u32 s42, s53, 4464640
  buffer_load_dwordx4 v11, s[8:11], s42 offen lds
  s_add_u32 m0, s41, 23552
  s_add_u32 s42, s53, 4530176
  buffer_load_dwordx4 v11, s[8:11], s42 offen lds
  ds_read_b64_tr_b16 a[200:201], v4 offset:24576
  ds_read_b64_tr_b16 a[202:203], v4 offset:26624
  ds_read_b64_tr_b16 a[204:205], v4 offset:28672
  ds_read_b64_tr_b16 a[206:207], v4 offset:30720
  ds_read_b64_tr_b16 a[216:217], v5 offset:24576
  ds_read_b64_tr_b16 a[218:219], v5 offset:26624
  ds_read_b64_tr_b16 a[220:221], v5 offset:28672
  ds_read_b64_tr_b16 a[222:223], v5 offset:30720
  ds_read_b64_tr_b16 a[232:233], v6 offset:24576
  ds_read_b64_tr_b16 a[234:235], v6 offset:26624
  ds_read_b64_tr_b16 a[236:237], v6 offset:28672
  ds_read_b64_tr_b16 a[238:239], v6 offset:30720
  ds_read_b64_tr_b16 a[248:249], v7 offset:24576
  ds_read_b64_tr_b16 a[250:251], v7 offset:26624
  ds_read_b64_tr_b16 a[252:253], v7 offset:28672
  ds_read_b64_tr_b16 a[254:255], v7 offset:30720
  s_cmp_lg_u32 s20, 0
  s_cbranch_scc1 Lchore_49
  s_waitcnt lgkmcnt(0)
  s_memtime s[64:65]
  s_waitcnt lgkmcnt(0)
  s_load_dword s68, s[4:5], s43 glc
  s_waitcnt lgkmcnt(0)
  s_memtime s[66:67]
  s_waitcnt lgkmcnt(0)
  s_sub_u32 s64, s66, s64
  s_min_u32 s46, s46, s64
Lchore_49:
  s_waitcnt vmcnt(16) lgkmcnt(0)
  s_barrier
  s_add_u32 m0, s41, 24576
  s_add_u32 s42, s53, 6291456
  buffer_load_dwordx4 v11, s[8:11], s42 offen lds
  s_add_u32 m0, s41, 25600
  s_add_u32 s42, s53, 6356992
  buffer_load_dwordx4 v11, s[8:11], s42 offen lds
  s_add_u32 m0, s41, 26624
  s_add_u32 s42, s53, 6299648
  buffer_load_dwordx4 v11, s[8:11], s42 offen lds
  s_add_u32 m0, s41, 27648
  s_add_u32 s42, s53, 6365184
  buffer_load_dwordx4 v11, s[8:11], s42 offen lds
  s_add_u32 m0, s41, 28672
  s_add_u32 s42, s53, 6553600
  buffer_load_dwordx4 v11, s[8:11], s42 offen lds
  s_add_u32 m0, s41, 29696
  s_add_u32 s42, s53, 6619136
  buffer_load_dwordx4 v11, s[8:11], s42 offen lds
  s_add_u32 m0, s41, 30720
  s_add_u32 s42, s53, 6561792
  buffer_load_dwordx4 v11, s[8:11], s42 offen lds
  s_add_u32 m0, s41, 31744
  s_add_u32 s42, s53, 6627328
  buffer_load_dwordx4 v11, s[8:11], s42 offen lds
  ds_read_b64_tr_b16 v[128:129], v4 offset:0
  ds_read_b64_tr_b16 v[130:131], v4 offset:2048
  ds_read_b64_tr_b16 v[132:133], v4 offset:4096
  ds_read_b64_tr_b16 v[134:135], v4 offset:6144
  ds_read_b64_tr_b16 v[144:145], v5 offset:0
  ds_read_b64_tr_b16 v[146:147], v5 offset:2048
  ds_read_b64_tr_b16 v[148:149], v5 offset:4096
  ds_read_b64_tr_b16 v[150:151], v5 offset:6144
  ds_read_b64_tr_b16 v[160:161], v6 offset:0
  ds_read_b64_tr_b16 v[162:163], v6 offset:2048
  ds_read_b64_tr_b16 v[164:165], v6 offset:4096
  ds_read_b64_tr_b16 v[166:167], v6 offset:6144
  ds_read_b64_tr_b16 v[176:177], v7 offset:0
  ds_read_b64_tr_b16 v[178:179], v7 offset:2048
  ds_read_b64_tr_b16 v[180:181], v7 offset:4096
  ds_read_b64_tr_b16 v[182:183], v7 offset:6144
  s_cmp_lg_u32 s20, 0
  s_cbranch_scc1 Lchore_50
  s_waitcnt lgkmcnt(0)
  s_memtime s[64:65]
  s_waitcnt lgkmcnt(0)
  s_load_dword s68, s[4:5], s43 glc
  s_waitcnt lgkmcnt(0)
  s_memtime s[66:67]
  s_waitcnt lgkmcnt(0)
  s_sub_u32 s64, s66, s64
  s_min_u32 s46, s46, s64
Lchore_50:
  s_waitcnt vmcnt(16) lgkmcnt(0)
  s_barrier
  s_add_u32 m0, s41, 0
  s_add_u32 s42, s52, 0
  buffer_load_dwordx4 v12, s[8:11], s42 offen lds
  s_add_u32 m0, s41, 1024
  s_add_u32 s42, s52, 65536
  buffer_load_dwordx4 v12, s[8:11], s42 offen lds
  s_add_u32 m0, s41, 2048
  s_add_u32 s42, s52, 8192
  buffer_load_dwordx4 v12, s[8:11], s42 offen lds
  s_add_u32 m0, s41, 3072
  s_add_u32 s42, s52, 73728
  buffer_load_dwordx4 v12, s[8:11], s42 offen lds
  s_add_u32 m0, s41, 4096
  s_add_u32 s42, s52, 262144
  buffer_load_dwordx4 v12, s[8:11], s42 offen lds
  s_add_u32 m0, s41, 5120
  s_add_u32 s42, s52, 327680
  buffer_load_dwordx4 v12, s[8:11], s42 offen lds
  s_add_u32 m0, s41, 6144
  s_add_u32 s42, s52, 270336
  buffer_load_dwordx4 v12, s[8:11], s42 offen lds
  s_add_u32 m0, s41, 7168
  s_add_u32 s42, s52, 335872
  buffer_load_dwordx4 v12, s[8:11], s42 offen lds
  ds_read_b64_tr_b16 v[136:137], v4 offset:8192
  ds_read_b64_tr_b16 v[138:139], v4 offset:10240
  ds_read_b64_tr_b16 v[140:141], v4 offset:12288
  ds_read_b64_tr_b16 v[142:143], v4 offset:14336
  ds_read_b64_tr_b16 v[152:153], v5 offset:8192
  ds_read_b64_tr_b16 v[154:155], v5 offset:10240
  ds_read_b64_tr_b16 v[156:157], v5 offset:12288
  ds_read_b64_tr_b16 v[158:159], v5 offset:14336
  ds_read_b64_tr_b16 v[168:169], v6 offset:8192
  ds_read_b64_tr_b16 v[170:171], v6 offset:10240
  ds_read_b64_tr_b16 v[172:173], v6 offset:12288
  ds_read_b64_tr_b16 v[174:175], v6 offset:14336
  ds_read_b64_tr_b16 v[184:185], v7 offset:8192
  ds_read_b64_tr_b16 v[186:187], v7 offset:10240
  ds_read_b64_tr_b16 v[188:189], v7 offset:12288
  ds_read_b64_tr_b16 v[190:191], v7 offset:14336
  s_cmp_lg_u32 s20, 0
  s_cbranch_scc1 Lchore_51
  s_waitcnt lgkmcnt(0)
  s_memtime s[64:65]
  s_waitcnt lgkmcnt(0)
  s_load_dword s68, s[4:5], s43 glc
  s_waitcnt lgkmcnt(0)
  s_memtime s[66:67]
  s_waitcnt lgkmcnt(0)
  s_sub_u32 s64, s66, s64
  s_min_u32 s46, s46, s64
Lchore_51:
  s_waitcnt vmcnt(16) lgkmcnt(0)
  s_barrier
  s_add_u32 m0, s41, 8192
  s_add_u32 s42, s52, 2097152
  buffer_load_dwordx4 v12, s[8:11], s42 offen lds
  s_add_u32 m0, s41, 9216
  s_add_u32 s42, s52, 2162688
  buffer_load_dwordx4 v12, s[8:11], s42 offen lds
  s_add_u32 m0, s41, 10240
  s_add_u32 s42, s52, 2105344
  buffer_load_dwordx4 v12, s[8:11], s42 offen lds
  s_add_u32 m0, s41, 11264
  s_add_u32 s42, s52, 2170880
  buffer_load_dwordx4 v12, s[8:11], s42 offen lds
  s_add_u32 m0, s41, 12288
  s_add_u32 s42, s52, 2359296
  buffer_load_dwordx4 v12, s[8:11], s42 offen lds
  s_add_u32 m0, s41, 13312
  s_add_u32 s42, s52, 2424832
  buffer_load_dwordx4 v12, s[8:11], s42 offen lds
  s_add_u32 m0, s41, 14336
  s_add_u32 s42, s52, 2367488
  buffer_load_dwordx4 v12, s[8:11], s42 offen lds
  s_add_u32 m0, s41, 15360
  s_add_u32 s42, s52, 2433024
  buffer_load_dwordx4 v12, s[8:11], s42 offen lds
  ds_read_b64_tr_b16 v[192:193], v4 offset:16384
  ds_read_b64_tr_b16 v[194:195], v4 offset:18432
  ds_read_b64_tr_b16 v[196:197], v4 offset:20480
  ds_read_b64_tr_b16 v[198:199], v4 offset:22528
  ds_read_b64_tr_b16 v[208:209], v5 offset:16384
  ds_read_b64_tr_b16 v[210:211], v5 offset:18432
  ds_read_b64_tr_b16 v[212:213], v5 offset:20480
  ds_read_b64_tr_b16 v[214:215], v5 offset:22528
  ds_read_b64_tr_b16 v[224:225], v6 offset:16384
  ds_read_b64_tr_b16 v[226:227], v6 offset:18432
  ds_read_b64_tr_b16 v[228:229], v6 offset:20480
  ds_read_b64_tr_b16 v[230:231], v6 offset:22528
  ds_read_b64_tr_b16 v[240:241], v7 offset:16384
  ds_read_b64_tr_b16 v[242:243], v7 offset:18432
  ds_read_b64_tr_b16 v[244:245], v7 offset:20480
  ds_read_b64_tr_b16 v[246:247], v7 offset:22528
  s_cmp_lg_u32 s20, 0
  s_cbranch_scc1 Lchore_52
  s_waitcnt lgkmcnt(0)
  s_memtime s[64:65]
  s_waitcnt lgkmcnt(0)
  s_load_dword s68, s[4:5], s43 glc
  s_waitcnt lgkmcnt(0)
  s_memtime s[66:67]
  s_waitcnt lgkmcnt(0)
  s_sub_u32 s64, s66, s64
  s_min_u32 s46, s46, s64
Lchore_52:
  s_waitcnt vmcnt(16) lgkmcnt(0)
  s_barrier
  s_add_u32 m0, s41, 16384
  s_add_u32 s42, s53, 4194304
  buffer_load_dwordx4 v12, s[8:11], s42 offen lds
  s_add_u32 m0, s41, 17408
  s_add_u32 s42, s53, 4259840
  buffer_load_dwordx4 v12, s[8:11], s42 offen lds
  s_add_u32 m0, s41, 18432
  s_add_u32 s42, s53, 4202496
  buffer_load_dwordx4 v12, s[8:11], s42 offen lds
  s_add_u32 m0, s41, 19456
  s_add_u32 s42, s53, 4268032
  buffer_load_dwordx4 v12, s[8:11], s42 offen lds
  s_add_u32 m0, s41, 20480
  s_add_u32 s42, s53, 4456448
  buffer_load_dwordx4 v12, s[8:11], s42 offen lds
  s_add_u32 m0, s41, 21504
  s_add_u32 s42, s53, 4521984
  buffer_load_dwordx4 v12, s[8:11], s42 offen lds
  s_add_u32 m0, s41, 22528
  s_add_u32 s42, s53, 4464640
  buffer_load_dwordx4 v12, s[8:11], s42 offen lds
  s_add_u32 m0, s41, 23552
  s_add_u32 s42, s53, 4530176
  buffer_load_dwordx4 v12, s[8:11], s42 offen lds
  ds_read_b64_tr_b16 v[200:201], v4 offset:24576
  ds_read_b64_tr_b16 v[202:203], v4 offset:26624
  ds_read_b64_tr_b16 v[204:205], v4 offset:28672
  ds_read_b64_tr_b16 v[206:207], v4 offset:30720
  ds_read_b64_tr_b16 v[216:217], v5 offset:24576
  ds_read_b64_tr_b16 v[218:219], v5 offset:26624
  ds_read_b64_tr_b16 v[220:221], v5 offset:28672
  ds_read_b64_tr_b16 v[222:223], v5 offset:30720
  ds_read_b64_tr_b16 v[232:233], v6 offset:24576
  ds_read_b64_tr_b16 v[234:235], v6 offset:26624
  ds_read_b64_tr_b16 v[236:237], v6 offset:28672
  ds_read_b64_tr_b16 v[238:239], v6 offset:30720
  ds_read_b64_tr_b16 v[248:249], v7 offset:24576
  ds_read_b64_tr_b16 v[250:251], v7 offset:26624
  ds_read_b64_tr_b16 v[252:253], v7 offset:28672
  ds_read_b64_tr_b16 v[254:255], v7 offset:30720
  s_cmp_lg_u32 s20, 0
  s_cbranch_scc1 Lchore_53
  s_waitcnt lgkmcnt(0)
  s_memtime s[64:65]
  s_waitcnt lgkmcnt(0)
  s_load_dword s68, s[4:5], s43 glc
  s_waitcnt lgkmcnt(0)
  s_memtime s[66:67]
  s_waitcnt lgkmcnt(0)
  s_sub_u32 s64, s66, s64
  s_min_u32 s46, s46, s64
  s_getreg_b32 s55, hwreg(HW_REG_XCC_ID)
  s_and_b32 s55, s55, 15
  s_lshl_b32 s46, s46, 8
  s_or_b32 s46, s46, s55
  s_add_u32 s40, s21, 0
  s_lshl_b32 s40, s40, 7
  s_add_u32 s40, s40, 1424384
  s_mov_b32 s63, s46
  s_atomic_smax s63, s[4:5], s40 glc
Lnosig_54:
Lchore_53:
  s_waitcnt vmcnt(16) lgkmcnt(0)
  s_barrier
  s_add_u32 m0, s41, 24576
  s_add_u32 s42, s53, 6291456
  buffer_load_dwordx4 v12, s[8:11], s42 offen lds
  s_add_u32 m0, s41, 25600
  s_add_u32 s42, s53, 6356992
  buffer_load_dwordx4 v12, s[8:11], s42 offen lds
  s_add_u32 m0, s41, 26624
  s_add_u32 s42, s53, 6299648
  buffer_load_dwordx4 v12, s[8:11], s42 offen lds
  s_add_u32 m0, s41, 27648
  s_add_u32 s42, s53, 6365184
  buffer_load_dwordx4 v12, s[8:11], s42 offen lds
  s_add_u32 m0, s41, 28672
  s_add_u32 s42, s53, 6553600
  buffer_load_dwordx4 v12, s[8:11], s42 offen lds
  s_add_u32 m0, s41, 29696
  s_add_u32 s42, s53, 6619136
  buffer_load_dwordx4 v12, s[8:11], s42 offen lds
  s_add_u32 m0, s41, 30720
  s_add_u32 s42, s53, 6561792
  buffer_load_dwordx4 v12, s[8:11], s42 offen lds
  s_add_u32 m0, s41, 31744
  s_add_u32 s42, s53, 6627328
  buffer_load_dwordx4 v12, s[8:11], s42 offen lds
  ds_read_b64_tr_b16 v[20:21], v4 offset:0
  ds_read_b64_tr_b16 v[22:23], v4 offset:2048
  ds_read_b64_tr_b16 v[24:25], v4 offset:4096
  ds_read_b64_tr_b16 v[26:27], v4 offset:6144
  ds_read_b64_tr_b16 v[28:29], v5 offset:0
  ds_read_b64_tr_b16 v[30:31], v5 offset:2048
  ds_read_b64_tr_b16 v[32:33], v5 offset:4096
  ds_read_b64_tr_b16 v[34:35], v5 offset:6144
  ds_read_b64_tr_b16 v[36:37], v6 offset:0
  ds_read_b64_tr_b16 v[38:39], v6 offset:2048
  ds_read_b64_tr_b16 v[40:41], v6 offset:4096
  ds_read_b64_tr_b16 v[42:43], v6 offset:6144
  ds_read_b64_tr_b16 v[44:45], v7 offset:0
  ds_read_b64_tr_b16 v[46:47], v7 offset:2048
  ds_read_b64_tr_b16 v[48:49], v7 offset:4096
  ds_read_b64_tr_b16 v[50:51], v7 offset:6144
  s_waitcnt lgkmcnt(0)
  s_barrier
  ds_write_b128 v85, v[20:23] offset:0
  ds_write_b128 v85, v[24:27] offset:1024
  ds_write_b128 v85, v[28:31] offset:2048
  ds_write_b128 v85, v[32:35] offset:3072
  ds_write_b128 v85, v[36:39] offset:4096
  ds_write_b128 v85, v[40:43] offset:5120
  ds_write_b128 v85, v[44:47] offset:6144
  ds_write_b128 v85, v[48:51] offset:7168
  s_waitcnt vmcnt(16) lgkmcnt(0)
  s_barrier
  ds_read_b64_tr_b16 v[20:21], v4 offset:8192
  ds_read_b64_tr_b16 v[22:23], v4 offset:10240
  ds_read_b64_tr_b16 v[24:25], v4 offset:12288
  ds_read_b64_tr_b16 v[26:27], v4 offset:14336
  ds_read_b64_tr_b16 v[28:29], v5 offset:8192
  ds_read_b64_tr_b16 v[30:31], v5 offset:10240
  ds_read_b64_tr_b16 v[32:33], v5 offset:12288
  ds_read_b64_tr_b16 v[34:35], v5 offset:14336
  ds_read_b64_tr_b16 v[36:37], v6 offset:8192
  ds_read_b64_tr_b16 v[38:39], v6 offset:10240
  ds_read_b64_tr_b16 v[40:41], v6 offset:12288
  ds_read_b64_tr_b16 v[42:43], v6 offset:14336
  ds_read_b64_tr_b16 v[44:45], v7 offset:8192
  ds_read_b64_tr_b16 v[46:47], v7 offset:10240
  ds_read_b64_tr_b16 v[48:49], v7 offset:12288
  ds_read_b64_tr_b16 v[50:51], v7 offset:14336
  s_waitcnt lgkmcnt(0)
  s_barrier
  ds_write_b128 v85, v[20:23] offset:8192
  ds_write_b128 v85, v[24:27] offset:9216
  ds_write_b128 v85, v[28:31] offset:10240
  ds_write_b128 v85, v[32:35] offset:11264
  ds_write_b128 v85, v[36:39] offset:12288
  ds_write_b128 v85, v[40:43] offset:13312
  ds_write_b128 v85, v[44:47] offset:14336
  ds_write_b128 v85, v[48:51] offset:15360
  s_waitcnt vmcnt(8) lgkmcnt(0)
  s_barrier
  ds_read_b64_tr_b16 v[20:21], v4 offset:16384
  ds_read_b64_tr_b16 v[22:23], v4 offset:18432
  ds_read_b64_tr_b16 v[24:25], v4 offset:20480
  ds_read_b64_tr_b16 v[26:27], v4 offset:22528
  ds_read_b64_tr_b16 v[28:29], v5 offset:16384
  ds_read_b64_tr_b16 v[30:31], v5 offset:18432
  ds_read_b64_tr_b16 v[32:33], v5 offset:20480
  ds_read_b64_tr_b16 v[34:35], v5 offset:22528
  ds_read_b64_tr_b16 v[36:37], v6 offset:16384
  ds_read_b64_tr_b16 v[38:39], v6 offset:18432
  ds_read_b64_tr_b16 v[40:41], v6 offset:20480
  ds_read_b64_tr_b16 v[42:43], v6 offset:22528
  ds_read_b64_tr_b16 v[44:45], v7 offset:16384
  ds_read_b64_tr_b16 v[46:47], v7 offset:18432
  ds_read_b64_tr_b16 v[48:49], v7 offset:20480
  ds_read_b64_tr_b16 v[50:51], v7 offset:22528
  s_waitcnt lgkmcnt(0)
  s_barrier
  ds_write_b128 v85, v[20:23] offset:16384
  ds_write_b128 v85, v[24:27] offset:17408
  ds_write_b128 v85, v[28:31] offset:18432
  ds_write_b128 v85, v[32:35] offset:19456
  ds_write_b128 v85, v[36:39] offset:20480
  ds_write_b128 v85, v[40:43] offset:21504
  ds_write_b128 v85, v[44:47] offset:22528
  ds_write_b128 v85, v[48:51] offset:23552
  s_waitcnt vmcnt(0) lgkmcnt(0)
  s_barrier
  ds_read_b64_tr_b16 v[20:21], v4 offset:24576
  ds_read_b64_tr_b16 v[22:23], v4 offset:26624
  ds_read_b64_tr_b16 v[24:25], v4 offset:28672
  ds_read_b64_tr_b16 v[26:27], v4 offset:30720
  ds_read_b64_tr_b16 v[28:29], v5 offset:24576
  ds_read_b64_tr_b16 v[30:31], v5 offset:26624
  ds_read_b64_tr_b16 v[32:33], v5 offset:28672
  ds_read_b64_tr_b16 v[34:35], v5 offset:30720
  ds_read_b64_tr_b16 v[36:37], v6 offset:24576
  ds_read_b64_tr_b16 v[38:39], v6 offset:26624
  ds_read_b64_tr_b16 v[40:41], v6 offset:28672
  ds_read_b64_tr_b16 v[42:43], v6 offset:30720
  ds_read_b64_tr_b16 v[44:45], v7 offset:24576
  ds_read_b64_tr_b16 v[46:47], v7 offset:26624
  ds_read_b64_tr_b16 v[48:49], v7 offset:28672
  ds_read_b64_tr_b16 v[50:51], v7 offset:30720
  s_waitcnt lgkmcnt(0)
  s_barrier
  ds_write_b128 v85, v[20:23] offset:24576
  ds_write_b128 v85, v[24:27] offset:25600
  ds_write_b128 v85, v[28:31] offset:26624
  ds_write_b128 v85, v[32:35] offset:27648
  ds_write_b128 v85, v[36:39] offset:28672
  ds_write_b128 v85, v[40:43] offset:29696
  ds_write_b128 v85, v[44:47] offset:30720
  ds_write_b128 v85, v[48:51] offset:31744
  s_waitcnt lgkmcnt(0)
  s_getreg_b32 s55, hwreg(HW_REG_XCC_ID)
  s_and_b32 s55, s55, 15
  v_min_u32 v76, 63, v0
  v_lshlrev_b32 v76, 7, v76
  v_add_u32 v76, 1424384, v76
  s_nop 1
Lpoll_55:
  buffer_load_dword v77, v76, s[4:7], 0 offen sc1
  s_sub_u32 s24, s24, 1
  s_cbranch_scc1 L_FAIL
  s_waitcnt vmcnt(0)
  v_cmp_gt_i32 vcc, 0, v77
  s_cbranch_vccz Lpolld_56
  s_sleep 1
  s_branch Lpoll_55
Lpolld_56:
  v_and_b32 v78, 15, v77
  v_cmp_ne_u32 vcc, s55, v78
  s_lshl_b32 s40, s54, 4
  s_lshl_b32 s40, 0xffff, s40
  s_or_b32 s41, vcc_lo, vcc_hi
  s_and_b32 s40, s40, s41
  s_cselect_b32 s36, 0, 8192
  v_lshrrev_b32 v77, 8, v77
  v_and_b32 v78, 3, v0
  v_lshl_or_b32 v77, v77, 2, v78
  s_nop 1
  v_min_u32_dpp v77, v77, v77 row_ror:8 row_mask:0xf bank_mask:0xf
  s_nop 1
  v_min_u32_dpp v77, v77, v77 row_ror:4 row_mask:0xf bank_mask:0xf
  v_mov_b32 v78, v77
  s_nop 1
  v_permlane16_swap_b32 v78, v77
  v_min_u32 v77, v77, v78
  v_mov_b32 v78, v77
  s_nop 1
  v_permlane32_swap_b32 v78, v77
  v_min_u32 v77, v77, v78
  s_nop 1
  v_min_u32_dpp v77, v77, v77 row_ror:2 row_mask:0xf bank_mask:0xf
  s_nop 1
  v_min_u32_dpp v77, v77, v77 row_ror:1 row_mask:0xf bank_mask:0xf
  s_nop 0
  v_readfirstlane_b32 s26, v77
  s_and_b32 s26, s26, 3
  s_lshl_b32 s26, s26, 13
  s_lshr_b32 s40, s20, 1
  s_mul_i32 s40, s40, 32768
  s_and_b32 s41, s20, 1
  s_lshl_b32 s41, s41, 10
  s_add_u32 s40, s40, s41
  s_lshl_b32 s41, s54, 12
  s_add_u32 s40, s40, s41
  v_lshl_add_u32 v86, v0, 4, s40
  v_xor_b32 v87, 0x1000, v86
  v_and_b32 v76, 2, v0
  v_cmp_eq_u32 vcc, 0, v76
  v_mov_b32 v76, 0xeeee
  v_mov_b32 v77, 0x4444
  v_cndmask_b32 v88, v76, v77, vcc
  s_lshr_b32 s40, s21, 2
  s_mul_i32 s40, s40, 32768
  s_and_b32 s41, s21, 3
  s_lshl_b32 s41, s41, 11
  s_add_u32 s47, s40, s41
  s_lshl_b32 s41, s20, 9
  s_add_u32 s47, s47, s41
  v_lshl_add_u32 v92, v0, 3, s47
  s_lshl_b32 s41, s54, 12
  s_add_u32 s40, s41, 1310720
  s_add_u32 s40, s40, s26
  v_lshrrev_b32 v76, 2, v0
  v_lshl_add_u32 v76, v76, 7, s40
  v_and_b32 v77, 3, v0
  v_lshl_add_u32 v90, v77, 2, v76
  s_mov_b32 s57, s40
  s_cmp_eq_u32 s36, 0
  s_cselect_b32 s56, 1, s20
  s_and_b32 s41, s21, 15
  s_lshl_b32 s41, s41, 7
  s_lshl_b32 s40, s20, 2
  s_add_u32 s40, s40, s41
  s_add_u32 s40, s40, 2048
  s_mov_b32 s25, 0
  s_mov_b32 s60, 0
  s_mov_b32 s61, 0
  s_mov_b32 s51, -1
  v_mov_b32 v91, 2147483392
  s_mov_b64 exec, 1
  v_mov_b32 v91, s40
  s_mov_b64 exec, -1
  v_mov_b32 v80, -1
  v_mov_b32 v81, -1
  v_mov_b32 v82, -1
  v_mov_b32 v83, -1
  v_mov_b32 v112, 0
  v_mov_b32 v113, 0
  v_mov_b32 v114, 0
  v_mov_b32 v115, 0
  v_mov_b32 v116, 0
  v_mov_b32 v117, 0
  v_mov_b32 v118, 0
  v_mov_b32 v119, 0
  v_mov_b32 v120, 0
  v_mov_b32 v121, 0
  v_mov_b32 v108, 0x3f803f80
  v_mov_b32 v109, 0x3f803f80
  v_mov_b32 v110, 0x3f803f80
  v_mov_b32 v111, 0x3f803f80
  v_lshlrev_b32 v95, 4, v0
  s_lshl_b32 s58, s20, 12
  s_add_u32 s40, s58, 149504
  s_add_u32 s58, s58, 131072
  v_lshrrev_b32 v76, 4, v0
  v_bfe_u32 v77, v0, 1, 2
  v_xor_b32 v76, v76, v77
  v_lshl_add_u32 v76, v76, 4, s40
  v_and_b32 v77, 15, v0
  v_lshl_add_u32 v123, v77, 6, v76
  v_bfe_u32 v76, v0, 3, 2
  v_xor_b32 v76, v76, v0
  v_lshl_add_u32 v124, v76, 4, s40
  v_bfe_u32 v76, v0, 4, 1
  v_lshlrev_b32 v76, 1, v76
  v_and_b32 v77, 13, v0
  v_or_b32 v76, v76, v77
  v_lshl_add_u32 v122, v76, 4, s47
  v_lshrrev_b32 v76, 5, v0
  v_lshl_add_u32 v122, v76, 8, v122
  v_and_b32 v76, 2, v0
  v_cmp_eq_u32 vcc, 0, v76
  v_mov_b32 v77, 2147483392
  s_nop 0
  v_cndmask_b32 v122, v122, v77, vcc
  s_lshl_b32 s43, s21, 2
  s_add_u32 s43, s43, s20
  s_and_b32 s46, s20, 1
  s_lshl_b32 s46, s46, 10
  s_mul_i32 s32, s21, 65536
  s_lshl_b32 s40, s20, 11
  s_add_u32 s32, s32, s40
  s_and_b32 s40, s26, 0x2000
  s_xor_b32 s40, s40, 67108864
  s_add_u32 s32, s32, s40
  s_add_u32 s30, s32, s46
  s_add_u32 s30, s30, 49152
  s_lshl_b32 s59, s21, 7
  s_add_u32 s59, s59, 1396736
  s_lshl_b32 s62, s21, 7
  s_add_u32 s62, s62, 1404928
  s_mov_b32 s38, 0x3e0293ee
  s_mov_b32 s39, s38
  s_mov_b32 s50, 0
  s_mov_b32 s49, 2147483392
  v_xor_b32 v125, 4096, v124
  v_xor_b32 v126, 8192, v124
  v_xor_b32 v127, 12288, v124
  v_readfirstlane_b32 s88, v86
  s_xor_b32 s41, s47, 131072
  v_min_u32 v76, 3, v0
  v_lshl_add_u32 v87, v76, 7, s41
  v_lshrrev_b32 v76, 4, v0
  v_lshlrev_b32 v76, 2, v76
  v_and_b32 v77, 15, v0
  v_sub_u32 v76, v77, v76
  s_lshr_b32 s41, s46, 6
  v_add_u32 v76, s41, v76
  v_and_b32 v92, 0xfffffdff, v92
  v_mov_b32 v86, 0xd028965f
  v_cmp_le_i32 s[8:9], 0, v76
  v_cmp_le_i32 s[10:11], 1, v76
  v_cmp_le_i32 s[16:17], 2, v76
  v_cmp_le_i32 s[18:19], 3, v76
  v_cmp_le_i32 s[42:43], 16, v76
  v_cmp_le_i32 s[44:45], 17, v76
  v_cmp_le_i32 s[52:53], 18, v76
  v_cmp_le_i32 s[54:55], 19, v76
  s_xor_b32 s89, s88, 1024
  s_xor_b32 s90, s88, 32768
  s_xor_b32 s91, s88, 33792
  s_mov_b32 s33, 1
  s_mov_b64 s[100:101], 0
  s_cmp_lg_u32 s20, 1
  s_cbranch_scc1 Lskip_59
Lask_57:
  s_min_i32 s47, s100, s101
  s_cmp_ge_i32 s47, s33
  s_cbranch_scc1 Lhave_58
  s_load_dwordx2 s[100:101], s[4:5], s59 glc
  s_sub_u32 s24, s24, 1
  s_cbranch_scc1 L_FAIL
  s_waitcnt lgkmcnt(0)
  s_branch Lask_57
Lhave_58:
  s_add_u32 s33, s33, 2
  s_min_u32 s33, s33, 64
  s_cmp_ge_i32 s47, s33
  s_cbranch_scc1 Lskip_59
  s_load_dwordx2 s[100:101], s[4:5], s59 glc
Lskip_59:
  s_barrier
  s_add_u32 m0, s58, 16384
  s_add_u32 s31, s32, 16384
  buffer_load_dwordx4 v95, s[4:7], s31 offen offset:0 sc1 lds
  buffer_load_dwordx4 v95, s[4:7], s31 offen offset:1024 sc1 lds
  s_add_u32 m0, s58, 2048
  s_add_u32 s31, s32, 32768
  buffer_load_dwordx4 v95, s[4:7], s31 offen offset:0 sc1 lds
  buffer_load_dwordx4 v95, s[4:7], s31 offen offset:1024 sc1 lds
  s_mov_b32 m0, s58
  s_add_u32 s31, s32, s46
  buffer_load_dwordx4 v95, s[4:7], s31 offen offset:0 sc1 lds
  s_sub_u32 s31, s32, s46
  buffer_load_dwordx4 v95, s[4:7], s31 offen offset:1024 sc1 lds
  s_and_b32 s40, s25, 3
  s_lshl_b32 s40, s40, 16
  s_add_u32 s27, s40, s26
  s_add_u32 s27, s27, 1048576
  s_xor_b32 s37, s27, s36
  s_lshl_b32 s40, s40, 2
  s_add_u32 s28, s40, s26
  s_lshr_b32 s40, s40, 5
  s_and_b32 s40, s40, 0x4000
  s_xor_b32 s28, s28, s40
  s_xor_b32 s29, s28, 0x4000
  s_xor_b32 s34, s28, 0x84000
  s_xor_b32 s48, s28, 8192
  s_lshr_b32 s40, s46, 1
  s_add_u32 s29, s29, s40
  s_xor_b32 s35, s29, 512
  s_add_u32 s92, s37, s88
  s_add_u32 s96, s27, s88
  s_xor_b32 s96, s96, 0x1000
  s_add_u32 s93, s37, s89
  s_add_u32 s97, s27, s89
  s_xor_b32 s97, s97, 0x1000
  s_add_u32 s94, s37, s90
  s_add_u32 s98, s27, s90
  s_xor_b32 s98, s98, 0x1000
  s_add_u32 s95, s37, s91
  s_add_u32 s99, s27, s91
  s_xor_b32 s99, s99, 0x1000
L_QK_top:
  v_mov_b32 v94, s25
  v_mov_b64 v[52:53], 0
  v_mov_b64 v[54:55], 0
  v_mov_b64 v[56:57], 0
  v_mov_b64 v[58:59], 0
  v_mov_b64 v[60:61], 0
  v_mov_b64 v[62:63], 0
  v_mov_b64 v[64:65], 0
  v_mov_b64 v[66:67], 0
  ds_read_b128 v[20:23], v85 offset:0
  ds_read_b128 v[24:27], v85 offset:1024
  ds_read_b128 v[28:31], v85 offset:8192
  ds_read_b128 v[32:35], v85 offset:9216
  ds_read_b128 v[36:39], v85 offset:2048
  ds_read_b128 v[40:43], v85 offset:3072
  ds_read_b128 v[44:47], v85 offset:10240
  ds_read_b128 v[48:51], v85 offset:11264
  s_waitcnt vmcnt(0)
  s_waitcnt lgkmcnt(0)
  s_barrier
  s_cmp_lg_u32 s20, 3
  s_cbranch_scc1 Lnosig_60
  s_mov_b32 s63, s50
  s_atomic_smax s63, s[4:5], s62 glc
Lnosig_60:
  s_cmp_ge_u32 s25, 64
  s_cbranch_scc1 L_QK_end
  s_cmp_eq_u32 s25, 0
  s_cbranch_scc1 L_QK_go
  s_cmp_lg_u32 s56, 0
  s_cbranch_scc1 Ltrigd_62
  buffer_load_dword v76, v90, s[4:7], 0 offen offset:0 sc1
  s_sleep 1
  buffer_load_dword v77, v90, s[4:7], 0 offen offset:0 sc1
  s_sleep 1
  buffer_load_dword v78, v90, s[4:7], 0 offen offset:0 sc1
  s_sleep 1
Ltrig_61:
  s_sub_u32 s24, s24, 1
  s_cbranch_scc1 L_FAIL
  buffer_load_dword v79, v90, s[4:7], 0 offen offset:0 sc1
  s_waitcnt vmcnt(3)
  v_cmp_gt_i32 vcc, s25, v76
  s_cbranch_vccz Ltrigd_62
  buffer_load_dword v76, v90, s[4:7], 0 offen offset:0 sc1
  s_waitcnt vmcnt(3)
  v_cmp_gt_i32 vcc, s25, v77
  s_cbranch_vccz Ltrigd_62
  buffer_load_dword v77, v90, s[4:7], 0 offen offset:0 sc1
  s_waitcnt vmcnt(3)
  v_cmp_gt_i32 vcc, s25, v78
  s_cbranch_vccz Ltrigd_62
  buffer_load_dword v78, v90, s[4:7], 0 offen offset:0 sc1
  s_waitcnt vmcnt(3)
  v_cmp_gt_i32 vcc, s25, v79
  s_cbranch_vccnz Ltrig_61
Ltrigd_62:
  s_barrier
L_QK_go:
L_QKM_again:
  buffer_load_dwordx4 v[96:99], v95, s[4:7], s92 offen offset:0 sc1
  s_nop 0
  buffer_load_dwordx4 v[100:103], v95, s[4:7], s92 offen offset:2048 sc1
  s_nop 0
  buffer_load_dwordx4 v[68:71], v95, s[4:7], s93 offen offset:0 sc1
  s_nop 0
  buffer_load_dwordx4 v[72:75], v95, s[4:7], s93 offen offset:2048 sc1
  s_nop 0
  buffer_load_dwordx4 v[4:7], v95, s[4:7], s94 offen offset:0 sc1
  s_nop 0
  buffer_load_dwordx4 v[8:11], v95, s[4:7], s94 offen offset:2048 sc1
  s_nop 0
  s_waitcnt vmcnt(5)
  v_cmp_eq_u32 vcc, -1, v96
  s_cbranch_vccnz L_QKM_g0
L_QKM_ok0:
  buffer_load_dwordx4 v[12:15], v95, s[4:7], s95 offen offset:0 sc1
  buffer_load_dwordx4 v[16:19], v95, s[4:7], s95 offen offset:2048 sc1
  v_smfmac_f32_16x16x64_bf16 v[52:55], v[96:99], a[0:7], v88
  v_smfmac_f32_16x16x64_bf16 v[60:63], v[96:99], v[128:135], v88
  s_waitcnt vmcnt(6)
  v_cmp_eq_u32 vcc, -1, v100
  v_smfmac_f32_16x16x64_bf16 v[56:59], v[96:99], a[128:135], v88
  v_smfmac_f32_16x16x64_bf16 v[64:67], v[96:99], v[20:27], v88
  s_cbranch_vccnz L_QKM_g1
L_QKM_ok1:
  buffer_load_dwordx4 v[96:99], v95, s[4:7], s96 offen offset:0 sc1
  v_smfmac_f32_16x16x64_bf16 v[52:55], v[100:103], a[8:15], v88
  ds_read_b128 v[20:23], v85 offset:4096
  v_smfmac_f32_16x16x64_bf16 v[60:63], v[100:103], v[136:143], v88
  s_waitcnt vmcnt(6)
  v_cmp_eq_u32 vcc, -1, v68
  v_smfmac_f32_16x16x64_bf16 v[56:59], v[100:103], a[136:143], v88
  ds_read_b128 v[24:27], v85 offset:5120
  v_smfmac_f32_16x16x64_bf16 v[64:67], v[100:103], v[28:35], v88
  s_cbranch_vccnz L_QKM_g2
L_QKM_ok2:
  buffer_load_dwordx4 v[100:103], v95, s[4:7], s96 offen offset:2048 sc1
  v_smfmac_f32_16x16x64_bf16 v[52:55], v[68:71], a[16:23], v88
  ds_read_b128 v[28:31], v85 offset:12288
  v_smfmac_f32_16x16x64_bf16 v[60:63], v[68:71], v[144:151], v88
  s_waitcnt vmcnt(6)
  v_cmp_eq_u32 vcc, -1, v72
  v_smfmac_f32_16x16x64_bf16 v[56:59], v[68:71], a[144:151], v88
  ds_read_b128 v[32:35], v85 offset:13312
  v_smfmac_f32_16x16x64_bf16 v[64:67], v[68:71], v[36:43], v88
  s_cbranch_vccnz L_QKM_g3
L_QKM_ok3:
  buffer_load_dwordx4 v[68:71], v95, s[4:7], s97 offen offset:0 sc1
  v_smfmac_f32_16x16x64_bf16 v[52:55], v[72:75], a[24:31], v88
  ds_read_b128 v[36:39], v85 offset:6144
  v_smfmac_f32_16x16x64_bf16 v[60:63], v[72:75], v[152:159], v88
  s_waitcnt vmcnt(6)
  v_cmp_eq_u32 vcc, -1, v4
  v_smfmac_f32_16x16x64_bf16 v[56:59], v[72:75], a[152:159], v88
  ds_read_b128 v[40:43], v85 offset:7168
  v_smfmac_f32_16x16x64_bf16 v[64:67], v[72:75], v[44:51], v88
  s_cbranch_vccnz L_QKM_g4
L_QKM_ok4:
  buffer_load_dwordx4 v[72:75], v95, s[4:7], s97 offen offset:2048 sc1
  v_smfmac_f32_16x16x64_bf16 v[52:55], v[4:7], a[32:39], v88
  ds_read_b128 v[44:47], v85 offset:14336
  v_smfmac_f32_16x16x64_bf16 v[60:63], v[4:7], v[160:167], v88
  s_waitcnt vmcnt(6)
  v_cmp_eq_u32 vcc, -1, v8
  v_smfmac_f32_16x16x64_bf16 v[56:59], v[4:7], a[160:167], v88
  ds_read_b128 v[48:51], v85 offset:15360
  s_waitcnt lgkmcnt(6)
  v_smfmac_f32_16x16x64_bf16 v[64:67], v[4:7], v[20:27], v88
  s_cbranch_vccnz L_QKM_g5
L_QKM_ok5:
  buffer_load_dwordx4 v[4:7], v95, s[4:7], s98 offen offset:0 sc1
  v_smfmac_f32_16x16x64_bf16 v[52:55], v[8:11], a[40:47], v88
  ds_read_b128 v[20:23], v85 offset:16384
  v_smfmac_f32_16x16x64_bf16 v[60:63], v[8:11], v[168:175], v88
  s_waitcnt vmcnt(6)
  v_cmp_eq_u32 vcc, -1, v12
  v_smfmac_f32_16x16x64_bf16 v[56:59], v[8:11], a[168:175], v88
  ds_read_b128 v[24:27], v85 offset:17408
  s_waitcnt lgkmcnt(6)
  v_smfmac_f32_16x16x64_bf16 v[64:67], v[8:11], v[28:35], v88
  s_cbranch_vccnz L_QKM_g6
L_QKM_ok6:
  buffer_load_dwordx4 v[8:11], v95, s[4:7], s98 offen offset:2048 sc1
  v_smfmac_f32_16x16x64_bf16 v[52:55], v[12:15], a[48:55], v88
  ds_read_b128 v[28:31], v85 offset:24576
  v_smfmac_f32_16x16x64_bf16 v[60:63], v[12:15], v[176:183], v88
  s_waitcnt vmcnt(6)
  v_cmp_eq_u32 vcc, -1, v16
  v_smfmac_f32_16x16x64_bf16 v[56:59], v[12:15], a[176:183], v88
  ds_read_b128 v[32:35], v85 offset:25600
  s_waitcnt lgkmcnt(6)
  v_smfmac_f32_16x16x64_bf16 v[64:67], v[12:15], v[36:43], v88
  s_cbranch_vccnz L_QKM_g7
L_QKM_ok7:
  buffer_load_dwordx4 v[12:15], v95, s[4:7], s99 offen offset:0 sc1
  v_smfmac_f32_16x16x64_bf16 v[52:55], v[16:19], a[56:63], v88
  ds_read_b128 v[36:39], v85 offset:18432
  v_smfmac_f32_16x16x64_bf16 v[60:63], v[16:19], v[184:191], v88
  s_waitcnt vmcnt(6)
  v_cmp_eq_u32 vcc, -1, v96
  v_smfmac_f32_16x16x64_bf16 v[56:59], v[16:19], a[184:191], v88
  ds_read_b128 v[40:43], v85 offset:19456
  s_waitcnt lgkmcnt(6)
  v_smfmac_f32_16x16x64_bf16 v[64:67], v[16:19], v[44:51], v88
  s_cbranch_vccnz L_QKM_g8
L_QKM_ok8:
  buffer_load_dwordx4 v[16:19], v95, s[4:7], s99 offen offset:2048 sc1
  v_smfmac_f32_16x16x64_bf16 v[52:55], v[96:99], a[64:71], v88
  ds_read_b128 v[44:47], v85 offset:26624
  v_smfmac_f32_16x16x64_bf16 v[60:63], v[96:99], v[192:199], v88
  s_waitcnt vmcnt(6)
  v_cmp_eq_u32 vcc, -1, v100
  v_smfmac_f32_16x16x64_bf16 v[56:59], v[96:99], a[192:199], v88
  ds_read_b128 v[48:51], v85 offset:27648
  s_waitcnt lgkmcnt(6)
  v_smfmac_f32_16x16x64_bf16 v[64:67], v[96:99], v[20:27], v88
  s_cbranch_vccnz L_QKM_g9
L_QKM_ok9:
  ds_read_b128 v[20:23], v85 offset:20480
  v_smfmac_f32_16x16x64_bf16 v[52:55], v[100:103], a[72:79], v88
  ds_read_b128 v[24:27], v85 offset:21504
  v_smfmac_f32_16x16x64_bf16 v[60:63], v[100:103], v[200:207], v88
  s_waitcnt vmcnt(5)
  v_cmp_eq_u32 vcc, -1, v68
  v_smfmac_f32_16x16x64_bf16 v[56:59], v[100:103], a[200:207], v88
  s_waitcnt lgkmcnt(6)
  v_smfmac_f32_16x16x64_bf16 v[64:67], v[100:103], v[28:35], v88
  s_cbranch_vccnz L_QKM_g10
L_QKM_ok10:
  ds_read_b128 v[28:31], v85 offset:28672
  v_smfmac_f32_16x16x64_bf16 v[52:55], v[68:71], a[80:87], v88
  ds_read_b128 v[32:35], v85 offset:29696
  v_smfmac_f32_16x16x64_bf16 v[60:63], v[68:71], v[208:215], v88
  s_waitcnt vmcnt(4)
  v_cmp_eq_u32 vcc, -1, v72
  v_smfmac_f32_16x16x64_bf16 v[56:59], v[68:71], a[208:215], v88
  s_waitcnt lgkmcnt(6)
  v_smfmac_f32_16x16x64_bf16 v[64:67], v[68:71], v[36:43], v88
  s_cbranch_vccnz L_QKM_g11
L_QKM_ok11:
  ds_read_b128 v[36:39], v85 offset:22528
  v_smfmac_f32_16x16x64_bf16 v[52:55], v[72:75], a[88:95], v88
  ds_read_b128 v[40:43], v85 offset:23552
  v_smfmac_f32_16x16x64_bf16 v[60:63], v[72:75], v[216:223], v88
  s_waitcnt vmcnt(3)
  v_cmp_eq_u32 vcc, -1, v4
  v_smfmac_f32_16x16x64_bf16 v[56:59], v[72:75], a[216:223], v88
  ds_read_b128 v[96:99], v1 offset:2048
  s_waitcnt lgkmcnt(7)
  v_smfmac_f32_16x16x64_bf16 v[64:67], v[72:75], v[44:51], v88
  s_cbranch_vccnz L_QKM_g12
L_QKM_ok12:
  ds_read_b128 v[44:47], v85 offset:30720
  v_smfmac_f32_16x16x64_bf16 v[52:55], v[4:7], a[96:103], v88
  ds_read_b128 v[48:51], v85 offset:31744
  v_smfmac_f32_16x16x64_bf16 v[60:63], v[4:7], v[224:231], v88
  s_waitcnt vmcnt(2)
  v_cmp_eq_u32 vcc, -1, v8
  v_smfmac_f32_16x16x64_bf16 v[56:59], v[4:7], a[224:231], v88
  ds_read_b128 v[100:103], v1 offset:3072
  s_waitcnt lgkmcnt(8)
  v_smfmac_f32_16x16x64_bf16 v[64:67], v[4:7], v[20:27], v88
  s_cbranch_vccnz L_QKM_g13
L_QKM_ok13:
  ds_read_b128 v[68:71], v84 offset:16384
  v_smfmac_f32_16x16x64_bf16 v[52:55], v[8:11], a[104:111], v88
  ds_read_b128 v[72:75], v84 offset:17408
  v_smfmac_f32_16x16x64_bf16 v[60:63], v[8:11], v[232:239], v88
  s_waitcnt vmcnt(1)
  v_cmp_eq_u32 vcc, -1, v12
  v_smfmac_f32_16x16x64_bf16 v[56:59], v[8:11], a[232:239], v88
  ds_read_b128 v[20:23], v1 offset:16384
  s_waitcnt lgkmcnt(9)
  v_smfmac_f32_16x16x64_bf16 v[64:67], v[8:11], v[28:35], v88
  s_cbranch_vccnz L_QKM_g14
L_QKM_ok14:
  ds_read_b128 v[24:27], v1 offset:17408
  v_smfmac_f32_16x16x64_bf16 v[52:55], v[12:15], a[112:119], v88
  ds_read_b128 v[28:31], v2 offset:16384
  v_smfmac_f32_16x16x64_bf16 v[60:63], v[12:15], v[240:247], v88
  s_waitcnt vmcnt(0)
  v_cmp_eq_u32 vcc, -1, v16
  v_smfmac_f32_16x16x64_bf16 v[56:59], v[12:15], a[240:247], v88
  ds_read_b128 v[32:35], v2 offset:17408
  s_waitcnt lgkmcnt(10)
  v_smfmac_f32_16x16x64_bf16 v[64:67], v[12:15], v[36:43], v88
  s_cbranch_vccnz L_QKM_g15
L_QKM_ok15:
  ds_read_b128 v[36:39], v3 offset:16384
  v_smfmac_f32_16x16x64_bf16 v[52:55], v[16:19], a[120:127], v88
  ds_read_b128 v[40:43], v3 offset:17408
  v_smfmac_f32_16x16x64_bf16 v[60:63], v[16:19], v[248:255], v88
  v_smfmac_f32_16x16x64_bf16 v[56:59], v[16:19], a[248:255], v88
  s_waitcnt lgkmcnt(9)
  v_smfmac_f32_16x16x64_bf16 v[64:67], v[16:19], v[44:51], v88
  s_nop 2
  v_pk_add_f32 v[52:53], v[52:53], v[54:55]
  s_nop 0
  v_pk_add_f32 v[60:61], v[60:61], v[62:63]
  v_cmp_u_f32 vcc, v52, v53
  v_cvt_pk_bf16_f32 v77, v52, v53
  v_cvt_pk_bf16_f32 v76, v60, v61
  v_pk_add_f32 v[56:57], v[56:57], v[58:59]
  v_pk_add_f32 v[64:65], v[64:65], v[66:67]
  v_cvt_pk_bf16_f32 v79, v56, v57
  v_cvt_pk_bf16_f32 v78, v64, v65
  ds_write_b128 v123, v[76:79]
  ds_read_b64_tr_b16 v[4:5], v124 offset:0
  ds_read_b64_tr_b16 v[6:7], v124 offset:8
  s_cbranch_vccnz L_QKM_nan
L_QKM_done:
  s_waitcnt lgkmcnt(2)
  s_barrier
  ds_read_b64_tr_b16 v[8:9], v125 offset:0
  ds_read_b64_tr_b16 v[10:11], v125 offset:8
  ds_read_b64_tr_b16 v[12:13], v126 offset:0
  ds_read_b64_tr_b16 v[14:15], v126 offset:8
  ds_read_b64_tr_b16 v[16:17], v127 offset:0
  ds_read_b64_tr_b16 v[18:19], v127 offset:8
  s_waitcnt lgkmcnt(6)
  v_mfma_f32_16x16x32_bf16 v[52:55], v[20:23], v[4:7], 0
  v_mfma_f32_16x16x32_bf16 v[56:59], v[24:27], v[4:7], 0
  v_mfma_f32_16x16x32_bf16 v[60:63], v[4:7], v[4:7], 0
  buffer_load_dwordx2 v[104:105], v92, s[4:7], s29 offen sc1
  buffer_load_dwordx2 v[106:107], v92, s[4:7], s35 offen sc1
  s_waitcnt lgkmcnt(4)
  v_mfma_f32_16x16x32_bf16 v[52:55], v[28:31], v[8:11], v[52:55]
  v_mfma_f32_16x16x32_bf16 v[56:59], v[32:35], v[8:11], v[56:59]
  v_mfma_f32_16x16x32_bf16 v[60:63], v[8:11], v[8:11], v[60:63]
  s_waitcnt lgkmcnt(2)
  v_mfma_f32_16x16x32_bf16 v[52:55], v[36:39], v[12:15], v[52:55]
  v_mfma_f32_16x16x32_bf16 v[56:59], v[40:43], v[12:15], v[56:59]
  v_mfma_f32_16x16x32_bf16 v[60:63], v[12:15], v[12:15], v[60:63]
  s_waitcnt lgkmcnt(0)
  v_mfma_f32_16x16x32_bf16 v[52:55], v[68:71], v[16:19], v[52:55]
  v_mfma_f32_16x16x32_bf16 v[56:59], v[72:75], v[16:19], v[56:59]
  v_mfma_f32_16x16x32_bf16 v[60:63], v[16:19], v[16:19], v[60:63]
  s_nop 5
  v_max3_f32 v64, v52, v53, v54
  v_max3_f32 v65, v55, v56, v57
  v_max3_f32 v64, v64, v58, v59
  v_max3_f32 v65, v65, v60, v61
  v_max_f32 v66, v64, v65
  v_max_f32 v67, v64, v65
  s_nop 1
  v_permlane16_swap_b32 v66, v67
  v_max_f32 v64, v66, v67
  v_max_f32 v65, v66, v67
  s_nop 1
  v_permlane32_swap_b32 v64, v65
  v_max_f32 v64, v64, v65
  v_mul_f32 v64, s38, v64
  v_pk_fma_f32 v[60:61], v[60:61], s[38:39], v[64:65] op_sel_hi:[1,1,0] neg_lo:[0,0,1] neg_hi:[0,0,1]
  v_pk_fma_f32 v[52:53], v[52:53], s[38:39], v[64:65] op_sel_hi:[1,1,0] neg_lo:[0,0,1] neg_hi:[0,0,1]
  v_exp_f32 v60, v60
  v_exp_f32 v61, v61
  v_pk_fma_f32 v[54:55], v[54:55], s[38:39], v[64:65] op_sel_hi:[1,1,0] neg_lo:[0,0,1] neg_hi:[0,0,1]
  v_pk_fma_f32 v[56:57], v[56:57], s[38:39], v[64:65] op_sel_hi:[1,1,0] neg_lo:[0,0,1] neg_hi:[0,0,1]
  v_pk_fma_f32 v[58:59], v[58:59], s[38:39], v[64:65] op_sel_hi:[1,1,0] neg_lo:[0,0,1] neg_hi:[0,0,1]
  v_cvt_pk_bf16_f32 v114, v60, v61
  v_cvt_pk_bf16_f32 v119, v60, v61
  s_waitcnt vmcnt(0)
  v_max3_u32 v89, v104, v105, v106
  v_max_u32 v89, v89, v107
  v_cmp_eq_u32 vcc, -1, v89
  v_mfma_f32_16x16x32_bf16 v[64:67], v[108:111], v[114:117], 0
  v_exp_f32 v52, v52
  v_exp_f32 v53, v53
  s_cbranch_vccnz L_QK_vbad
L_QK_vok:
  v_mfma_f32_16x16x32_bf16 v[44:47], v[104:107], v[114:117], 0
  v_exp_f32 v54, v54
  v_exp_f32 v55, v55
  v_mfma_f32_16x16x32_bf16 v[48:51], v[104:107], v[118:121], 0
  v_exp_f32 v56, v56
  v_exp_f32 v57, v57
  v_cvt_pk_bf16_f32 v76, v52, v53
  v_exp_f32 v58, v58
  v_exp_f32 v59, v59
  v_cvt_pk_bf16_f32 v77, v54, v55
  v_cvt_pk_bf16_f32 v78, v56, v57
  v_cvt_pk_bf16_f32 v79, v58, v59
  s_nop 1
  v_mfma_f32_16x16x32_bf16 v[64:67], v[108:111], v[76:79], v[64:67]
  v_mfma_f32_16x16x32_bf16 v[44:47], v[96:99], v[76:79], v[44:47]
  v_mfma_f32_16x16x32_bf16 v[48:51], v[100:103], v[76:79], v[48:51]
  buffer_store_dword v94, v91, s[4:7], s57 offen
  s_nop 4
  v_rcp_f32 v64, v64
  s_nop 0
  v_pk_mul_f32 v[44:45], v[44:45], v[64:65] op_sel_hi:[1,0]
  v_pk_mul_f32 v[46:47], v[46:47], v[64:65] op_sel_hi:[1,0]
  v_pk_mul_f32 v[48:49], v[48:49], v[64:65] op_sel_hi:[1,0]
  v_pk_mul_f32 v[50:51], v[50:51], v[64:65] op_sel_hi:[1,0]
  v_cvt_pk_bf16_f32 v52, v44, v45
  v_cvt_pk_bf16_f32 v53, v46, v47
  v_cvt_pk_bf16_f32 v54, v48, v49
  v_cvt_pk_bf16_f32 v55, v50, v51
  v_min_u32 v52, -2, v52
  v_min_u32 v53, -2, v53
  v_min_u32 v54, -2, v54
  v_min_u32 v55, -2, v55
  buffer_store_dwordx4 v[52:55], v122, s[4:7], s48 offen
  ds_read_b128 v[44:47], v1 offset:0
  ds_read_b128 v[48:51], v2 offset:1024
  s_add_u32 s32, s32, 2097152
  s_xor_b32 s32, s32, 0x2000
  s_add_u32 s33, s25, 2
  s_min_u32 s33, s33, 64
  s_xor_b32 s41, s49, 2048
  s_waitcnt lgkmcnt(0)
  buffer_store_dwordx4 v[52:55], v122, s[4:7], s28 offen sc1
  v_mfma_f32_16x16x32_bf16 v[56:59], v[20:23], v[44:47], 0
  v_mfma_f32_16x16x32_bf16 v[60:63], v[24:27], v[44:47], 0
  v_mfma_f32_16x16x32_bf16 v[64:67], v[4:7], v[44:47], 0
  ds_read_b128 v[20:23], v3 offset:0
  ds_read_b128 v[24:27], v2 offset:2048
  v_mfma_f32_16x16x32_bf16 v[56:59], v[28:31], v[48:51], v[56:59]
  v_mfma_f32_16x16x32_bf16 v[60:63], v[32:35], v[48:51], v[60:63]
  v_mfma_f32_16x16x32_bf16 v[64:67], v[8:11], v[48:51], v[64:67]
  ds_read_b128 v[28:31], v84 offset:1024
  ds_read_b128 v[32:35], v2 offset:3072
  s_waitcnt lgkmcnt(3)
  v_mfma_f32_16x16x32_bf16 v[56:59], v[36:39], v[20:23], v[56:59]
  v_mfma_f32_16x16x32_bf16 v[60:63], v[40:43], v[20:23], v[60:63]
  v_mfma_f32_16x16x32_bf16 v[64:67], v[12:15], v[20:23], v[64:67]
  s_waitcnt lgkmcnt(0)
  v_mfma_f32_16x16x32_bf16 v[56:59], v[68:71], v[28:31], v[56:59]
  v_mfma_f32_16x16x32_bf16 v[60:63], v[72:75], v[28:31], v[60:63]
  v_mfma_f32_16x16x32_bf16 v[64:67], v[16:19], v[28:31], v[64:67]
  s_cmp_lg_u32 s20, 1
  s_cbranch_scc1 Lskip_65
Lask_63:
  s_min_i32 s47, s100, s101
  s_cmp_ge_i32 s47, s33
  s_cbranch_scc1 Lhave_64
  s_load_dwordx2 s[100:101], s[4:5], s59 glc
  s_sub_u32 s24, s24, 1
  s_cbranch_scc1 L_FAIL
  s_waitcnt lgkmcnt(0)
  s_branch Lask_63
Lhave_64:
  s_add_u32 s33, s33, 2
  s_min_u32 s33, s33, 64
  s_cmp_ge_i32 s47, s33
  s_cbranch_scc1 Lskip_65
  s_load_dwordx2 s[100:101], s[4:5], s59 glc
Lskip_65:
  s_barrier
  v_cndmask_b32 v56, v86, v56, s[8:9]
  v_cndmask_b32 v57, v86, v57, s[10:11]
  v_cndmask_b32 v58, v86, v58, s[16:17]
  v_cndmask_b32 v59, v86, v59, s[18:19]
  v_cndmask_b32 v60, v86, v60, s[42:43]
  v_cndmask_b32 v61, v86, v61, s[44:45]
  v_cndmask_b32 v62, v86, v62, s[52:53]
  v_cndmask_b32 v63, v86, v63, s[54:55]
  v_max3_f32 v72, v56, v57, v58
  v_max3_f32 v73, v59, v60, v61
  v_max3_f32 v72, v72, v62, v63
  v_max3_f32 v73, v73, v64, v65
  buffer_load_dword v89, v87, s[4:7], s28 offen sc1
  v_max_f32 v74, v72, v73
  v_max_f32 v75, v72, v73
  v_mov_b64 v[68:69], -1
  v_mov_b64 v[70:71], -1
  s_add_u32 m0, s58, 16384
  s_add_u32 s31, s32, 16384
  buffer_load_dwordx4 v95, s[4:7], s31 offen offset:0 sc1 lds
  v_permlane16_swap_b32 v74, v75
  v_max_f32 v72, v74, v75
  v_max_f32 v73, v74, v75
  s_nop 1
  v_permlane32_swap_b32 v72, v73
  buffer_load_dwordx4 v95, s[4:7], s31 offen offset:1024 sc1 lds
  v_max_f32 v72, v72, v73
  v_mul_f32 v72, s38, v72
  v_pk_fma_f32 v[56:57], v[56:57], s[38:39], v[72:73] op_sel_hi:[1,1,0] neg_lo:[0,0,1] neg_hi:[0,0,1]
  v_pk_fma_f32 v[58:59], v[58:59], s[38:39], v[72:73] op_sel_hi:[1,1,0] neg_lo:[0,0,1] neg_hi:[0,0,1]
  s_add_u32 m0, s58, 2048
  s_add_u32 s31, s32, 32768
  buffer_load_dwordx4 v95, s[4:7], s31 offen offset:0 sc1 lds
  v_pk_fma_f32 v[60:61], v[60:61], s[38:39], v[72:73] op_sel_hi:[1,1,0] neg_lo:[0,0,1] neg_hi:[0,0,1]
  v_pk_fma_f32 v[62:63], v[62:63], s[38:39], v[72:73] op_sel_hi:[1,1,0] neg_lo:[0,0,1] neg_hi:[0,0,1]
  v_pk_fma_f32 v[64:65], v[64:65], s[38:39], v[72:73] op_sel_hi:[1,1,0] neg_lo:[0,0,1] neg_hi:[0,0,1]
  v_exp_f32 v56, v56
  buffer_load_dwordx4 v95, s[4:7], s31 offen offset:1024 sc1 lds
  v_exp_f32 v57, v57
  v_exp_f32 v58, v58
  v_exp_f32 v59, v59
  v_exp_f32 v60, v60
  s_mov_b32 m0, s58
  s_add_u32 s31, s32, s46
  buffer_load_dwordx4 v95, s[4:7], s31 offen offset:0 sc1 lds
  v_exp_f32 v61, v61
  v_exp_f32 v62, v62
  v_exp_f32 v63, v63
  v_exp_f32 v64, v64
  s_sub_u32 s31, s32, s46
  buffer_load_dwordx4 v95, s[4:7], s31 offen offset:1024 sc1 lds
  v_exp_f32 v65, v65
  v_cvt_pk_bf16_f32 v36, v56, v57
  v_cvt_pk_bf16_f32 v37, v58, v59
  v_cvt_pk_bf16_f32 v38, v60, v61
  buffer_store_dwordx4 v[68:71], v122, s[4:7], s34 offen sc1
  v_cvt_pk_bf16_f32 v39, v62, v63
  v_cvt_pk_bf16_f32 v114, v64, v65
  v_cvt_pk_bf16_f32 v119, v64, v65
  s_xor_b32 s40, s34, 8192
  buffer_store_dwordx4 v[68:71], v122, s[4:7], s40 offen
  s_cmp_ge_u32 s25, 0
  s_addc_u32 s50, s25, 0
  s_add_u32 s25, s25, 1
  v_mfma_f32_16x16x32_bf16 v[40:43], v[108:111], v[36:39], 0
  s_and_b32 s40, s25, 3
  s_lshl_b32 s40, s40, 16
  s_add_u32 s27, s40, s26
  v_mfma_f32_16x16x32_bf16 v[52:55], v[96:99], v[36:39], 0
  s_add_u32 s27, s27, 1048576
  s_xor_b32 s37, s27, s36
  s_lshl_b32 s40, s40, 2
  v_mfma_f32_16x16x32_bf16 v[56:59], v[100:103], v[36:39], 0
  s_add_u32 s28, s40, s26
  s_lshr_b32 s40, s40, 5
  s_and_b32 s40, s40, 0x4000
  v_mfma_f32_16x16x32_bf16 v[60:63], v[24:27], v[36:39], 0
  s_xor_b32 s28, s28, s40
  s_xor_b32 s29, s28, 0x4000
  s_xor_b32 s34, s28, 0x84000
  v_mfma_f32_16x16x32_bf16 v[64:67], v[32:35], v[36:39], 0
  s_xor_b32 s48, s28, 8192
  s_lshr_b32 s40, s46, 1
  s_add_u32 s29, s29, s40
  v_mfma_f32_16x16x32_bf16 v[40:43], v[108:111], v[114:117], v[40:43]
  s_xor_b32 s35, s29, 512
  s_add_u32 s92, s37, s88
  s_add_u32 s96, s27, s88
  v_mfma_f32_16x16x32_bf16 v[52:55], v[104:107], v[114:117], v[52:55]
  s_xor_b32 s96, s96, 0x1000
  s_add_u32 s93, s37, s89
  s_add_u32 s97, s27, s89
  v_mfma_f32_16x16x32_bf16 v[56:59], v[104:107], v[118:121], v[56:59]
  s_xor_b32 s97, s97, 0x1000
  s_add_u32 s94, s37, s90
  s_add_u32 s98, s27, s90
  v_mfma_f32_16x16x32_bf16 v[60:63], v[104:107], v[112:115], v[60:63]
  s_xor_b32 s98, s98, 0x1000
  s_add_u32 s95, s37, s91
  s_add_u32 s99, s27, s91
  v_mfma_f32_16x16x32_bf16 v[64:67], v[104:107], v[116:119], v[64:67]
  s_xor_b32 s99, s99, 0x1000
  v_rcp_f32 v40, v40
  s_nop 0
  v_pk_mul_f32 v[52:53], v[52:53], v[40:41] op_sel_hi:[1,0]
  v_pk_mul_f32 v[54:55], v[54:55], v[40:41] op_sel_hi:[1,0]
  v_pk_mul_f32 v[56:57], v[56:57], v[40:41] op_sel_hi:[1,0]
  v_pk_mul_f32 v[58:59], v[58:59], v[40:41] op_sel_hi:[1,0]
  v_pk_mul_f32 v[60:61], v[60:61], v[40:41] op_sel_hi:[1,0]
  v_pk_mul_f32 v[62:63], v[62:63], v[40:41] op_sel_hi:[1,0]
  v_pk_mul_f32 v[64:65], v[64:65], v[40:41] op_sel_hi:[1,0]
  v_pk_mul_f32 v[66:67], v[66:67], v[40:41] op_sel_hi:[1,0]
  v_cvt_pk_bf16_f32 v4, v52, v53
  v_cvt_pk_bf16_f32 v5, v54, v55
  v_cvt_pk_bf16_f32 v6, v56, v57
  v_cvt_pk_bf16_f32 v7, v58, v59
  v_cvt_pk_bf16_f32 v80, v60, v61
  v_cvt_pk_bf16_f32 v81, v62, v63
  v_cvt_pk_bf16_f32 v82, v64, v65
  v_cvt_pk_bf16_f32 v83, v66, v67
  ds_write_b128 v1, v[4:7] offset:19456
  s_mov_b32 s49, s30
  s_add_u32 s30, s30, 2097152
  s_xor_b32 s30, s30, 0x2000
  s_cmp_lt_u32 s50, s25
  s_cbranch_scc1 L_QK_keep
  s_xor_b32 s41, s49, 2048
  buffer_store_dwordx4 v[4:7], v95, s[4:7], s49 offen sc1
  buffer_store_dwordx4 v[80:83], v95, s[4:7], s41 offen sc1
L_QK_keep:
  s_nop 1
  s_branch L_QK_top
L_QK_end:
  s_branch L_END
L_QKM_nan:
  s_cmp_eq_u32 s51, s25
  s_cbranch_scc1 L_QKM_done
  s_mov_b32 s51, s25
  s_add_u32 s60, s60, 0x10000
  s_waitcnt vmcnt(0) lgkmcnt(0)
L_QKM_v0:
  s_sub_u32 s24, s24, 1
  s_cbranch_scc1 L_FAIL
  buffer_load_dwordx4 v[96:99], v95, s[4:7], s92 offen offset:0 sc1
  buffer_load_dwordx4 v[100:103], v95, s[4:7], s92 offen offset:2048 sc1
  buffer_load_dwordx4 v[68:71], v95, s[4:7], s93 offen offset:0 sc1
  buffer_load_dwordx4 v[72:75], v95, s[4:7], s93 offen offset:2048 sc1
  v_mov_b32 v89, 0
  s_waitcnt vmcnt(0)
  v_max3_u32 v89, v96, v97, v89
  v_max3_u32 v89, v98, v99, v89
  v_max3_u32 v89, v100, v101, v89
  v_max3_u32 v89, v102, v103, v89
  v_max3_u32 v89, v68, v69, v89
  v_max3_u32 v89, v70, v71, v89
  v_max3_u32 v89, v72, v73, v89
  v_max3_u32 v89, v74, v75, v89
  v_cmp_eq_u32 vcc, -1, v89
  s_cbranch_vccnz L_QKM_v0
L_QKM_v4:
  s_sub_u32 s24, s24, 1
  s_cbranch_scc1 L_FAIL
  buffer_load_dwordx4 v[4:7], v95, s[4:7], s94 offen offset:0 sc1
  buffer_load_dwordx4 v[8:11], v95, s[4:7], s94 offen offset:2048 sc1
  buffer_load_dwordx4 v[12:15], v95, s[4:7], s95 offen offset:0 sc1
  buffer_load_dwordx4 v[16:19], v95, s[4:7], s95 offen offset:2048 sc1
  v_mov_b32 v89, 0
  s_waitcnt vmcnt(0)
  v_max3_u32 v89, v4, v5, v89
  v_max3_u32 v89, v6, v7, v89
  v_max3_u32 v89, v8, v9, v89
  v_max3_u32 v89, v10, v11, v89
  v_max3_u32 v89, v12, v13, v89
  v_max3_u32 v89, v14, v15, v89
  v_max3_u32 v89, v16, v17, v89
  v_max3_u32 v89, v18, v19, v89
  v_cmp_eq_u32 vcc, -1, v89
  s_cbranch_vccnz L_QKM_v4
L_QKM_v8:
  s_sub_u32 s24, s24, 1
  s_cbranch_scc1 L_FAIL
  buffer_load_dwordx4 v[96:99], v95, s[4:7], s96 offen offset:0 sc1
  buffer_load_dwordx4 v[100:103], v95, s[4:7], s96 offen offset:2048 sc1
  buffer_load_dwordx4 v[68:71], v95, s[4:7], s97 offen offset:0 sc1
  buffer_load_dwordx4 v[72:75], v95, s[4:7], s97 offen offset:2048 sc1
  v_mov_b32 v89, 0
  s_waitcnt vmcnt(0)
  v_max3_u32 v89, v96, v97, v89
  v_max3_u32 v89, v98, v99, v89
  v_max3_u32 v89, v100, v101, v89
  v_max3_u32 v89, v102, v103, v89
  v_max3_u32 v89, v68, v69, v89
  v_max3_u32 v89, v70, v71, v89
  v_max3_u32 v89, v72, v73, v89
  v_max3_u32 v89, v74, v75, v89
  v_cmp_eq_u32 vcc, -1, v89
  s_cbranch_vccnz L_QKM_v8
L_QKM_v12:
  s_sub_u32 s24, s24, 1
  s_cbranch_scc1 L_FAIL
  buffer_load_dwordx4 v[4:7], v95, s[4:7], s98 offen offset:0 sc1
  buffer_load_dwordx4 v[8:11], v95, s[4:7], s98 offen offset:2048 sc1
  buffer_load_dwordx4 v[12:15], v95, s[4:7], s99 offen offset:0 sc1
  buffer_load_dwordx4 v[16:19], v95, s[4:7], s99 offen offset:2048 sc1
  v_mov_b32 v89, 0
  s_waitcnt vmcnt(0)
  v_max3_u32 v89, v4, v5, v89
  v_max3_u32 v89, v6, v7, v89
  v_max3_u32 v89, v8, v9, v89
  v_max3_u32 v89, v10, v11, v89
  v_max3_u32 v89, v12, v13, v89
  v_max3_u32 v89, v14, v15, v89
  v_max3_u32 v89, v16, v17, v89
  v_max3_u32 v89, v18, v19, v89
  v_cmp_eq_u32 vcc, -1, v89
  s_cbranch_vccnz L_QKM_v12
  v_mov_b64 v[52:53], 0
  v_mov_b64 v[54:55], 0
  v_mov_b64 v[56:57], 0
  v_mov_b64 v[58:59], 0
  v_mov_b64 v[60:61], 0
  v_mov_b64 v[62:63], 0
  v_mov_b64 v[64:65], 0
  v_mov_b64 v[66:67], 0
  ds_read_b128 v[20:23], v85 offset:0
  ds_read_b128 v[24:27], v85 offset:1024
  ds_read_b128 v[28:31], v85 offset:8192
  ds_read_b128 v[32:35], v85 offset:9216
  ds_read_b128 v[36:39], v85 offset:2048
  ds_read_b128 v[40:43], v85 offset:3072
  ds_read_b128 v[44:47], v85 offset:10240
  ds_read_b128 v[48:51], v85 offset:11264
  s_waitcnt lgkmcnt(0)
  s_branch L_QKM_again
L_QKM_g0:
  s_sub_u32 s24, s24, 1
  s_cbranch_scc1 L_FAIL
  s_add_u32 s60, s60, 1
  buffer_load_dwordx4 v[96:99], v95, s[4:7], s92 offen offset:0 sc1
  s_waitcnt vmcnt(0)
  v_cmp_eq_u32 vcc, -1, v96
  s_cbranch_vccnz L_QKM_g0
  v_mov_b32 v89, 0
  v_max3_u32 v89, v100, v68, v89
  v_max3_u32 v89, v72, v4, v89
  v_max3_u32 v89, v8, v8, v89
  v_cmp_eq_u32 vcc, -1, v89
  s_cbranch_vccz L_QKM_ok0
  buffer_load_dwordx4 v[100:103], v95, s[4:7], s92 offen offset:2048 sc1
  s_nop 0
  buffer_load_dwordx4 v[68:71], v95, s[4:7], s93 offen offset:0 sc1
  s_nop 0
  buffer_load_dwordx4 v[72:75], v95, s[4:7], s93 offen offset:2048 sc1
  s_nop 0
  buffer_load_dwordx4 v[4:7], v95, s[4:7], s94 offen offset:0 sc1
  s_nop 0
  buffer_load_dwordx4 v[8:11], v95, s[4:7], s94 offen offset:2048 sc1
  s_nop 0
  s_branch L_QKM_ok0
L_QKM_g1:
  s_sub_u32 s24, s24, 1
  s_cbranch_scc1 L_FAIL
  s_add_u32 s60, s60, 1
  buffer_load_dwordx4 v[100:103], v95, s[4:7], s92 offen offset:2048 sc1
  s_waitcnt vmcnt(0)
  v_cmp_eq_u32 vcc, -1, v100
  s_cbranch_vccnz L_QKM_g1
  v_mov_b32 v89, 0
  v_max3_u32 v89, v68, v72, v89
  v_max3_u32 v89, v4, v8, v89
  v_max3_u32 v89, v12, v16, v89
  v_cmp_eq_u32 vcc, -1, v89
  s_cbranch_vccz L_QKM_ok1
  buffer_load_dwordx4 v[68:71], v95, s[4:7], s93 offen offset:0 sc1
  s_nop 0
  buffer_load_dwordx4 v[72:75], v95, s[4:7], s93 offen offset:2048 sc1
  s_nop 0
  buffer_load_dwordx4 v[4:7], v95, s[4:7], s94 offen offset:0 sc1
  s_nop 0
  buffer_load_dwordx4 v[8:11], v95, s[4:7], s94 offen offset:2048 sc1
  s_nop 0
  buffer_load_dwordx4 v[12:15], v95, s[4:7], s95 offen offset:0 sc1
  s_nop 0
  buffer_load_dwordx4 v[16:19], v95, s[4:7], s95 offen offset:2048 sc1
  s_nop 0
  s_branch L_QKM_ok1
L_QKM_g2:
  s_sub_u32 s24, s24, 1
  s_cbranch_scc1 L_FAIL
  s_add_u32 s60, s60, 1
  buffer_load_dwordx4 v[68:71], v95, s[4:7], s93 offen offset:0 sc1
  s_waitcnt vmcnt(0)
  v_cmp_eq_u32 vcc, -1, v68
  s_cbranch_vccnz L_QKM_g2
  v_mov_b32 v89, 0
  v_max3_u32 v89, v72, v4, v89
  v_max3_u32 v89, v8, v12, v89
  v_max3_u32 v89, v16, v96, v89
  v_cmp_eq_u32 vcc, -1, v89
  s_cbranch_vccz L_QKM_ok2
  buffer_load_dwordx4 v[72:75], v95, s[4:7], s93 offen offset:2048 sc1
  s_nop 0
  buffer_load_dwordx4 v[4:7], v95, s[4:7], s94 offen offset:0 sc1
  s_nop 0
  buffer_load_dwordx4 v[8:11], v95, s[4:7], s94 offen offset:2048 sc1
  s_nop 0
  buffer_load_dwordx4 v[12:15], v95, s[4:7], s95 offen offset:0 sc1
  s_nop 0
  buffer_load_dwordx4 v[16:19], v95, s[4:7], s95 offen offset:2048 sc1
  s_nop 0
  buffer_load_dwordx4 v[96:99], v95, s[4:7], s96 offen offset:0 sc1
  s_nop 0
  s_branch L_QKM_ok2
L_QKM_g3:
  s_sub_u32 s24, s24, 1
  s_cbranch_scc1 L_FAIL
  s_add_u32 s60, s60, 1
  buffer_load_dwordx4 v[72:75], v95, s[4:7], s93 offen offset:2048 sc1
  s_waitcnt vmcnt(0)
  v_cmp_eq_u32 vcc, -1, v72
  s_cbranch_vccnz L_QKM_g3
  v_mov_b32 v89, 0
  v_max3_u32 v89, v4, v8, v89
  v_max3_u32 v89, v12, v16, v89
  v_max3_u32 v89, v96, v100, v89
  v_cmp_eq_u32 vcc, -1, v89
  s_cbranch_vccz L_QKM_ok3
  buffer_load_dwordx4 v[4:7], v95, s[4:7], s94 offen offset:0 sc1
  s_nop 0
  buffer_load_dwordx4 v[8:11], v95, s[4:7], s94 offen offset:2048 sc1
  s_nop 0
  buffer_load_dwordx4 v[12:15], v95, s[4:7], s95 offen offset:0 sc1
  s_nop 0
  buffer_load_dwordx4 v[16:19], v95, s[4:7], s95 offen offset:2048 sc1
  s_nop 0
  buffer_load_dwordx4 v[96:99], v95, s[4:7], s96 offen offset:0 sc1
  s_nop 0
  buffer_load_dwordx4 v[100:103], v95, s[4:7], s96 offen offset:2048 sc1
  s_nop 0
  s_branch L_QKM_ok3
L_QKM_g4:
  s_sub_u32 s24, s24, 1
  s_cbranch_scc1 L_FAIL
  s_add_u32 s60, s60, 1
  buffer_load_dwordx4 v[4:7], v95, s[4:7], s94 offen offset:0 sc1
  s_waitcnt vmcnt(0)
  v_cmp_eq_u32 vcc, -1, v4
  s_cbranch_vccnz L_QKM_g4
  v_mov_b32 v89, 0
  v_max3_u32 v89, v8, v12, v89
  v_max3_u32 v89, v16, v96, v89
  v_max3_u32 v89, v100, v68, v89
  v_cmp_eq_u32 vcc, -1, v89
  s_cbranch_vccz L_QKM_ok4
  buffer_load_dwordx4 v[8:11], v95, s[4:7], s94 offen offset:2048 sc1
  s_nop 0
  buffer_load_dwordx4 v[12:15], v95, s[4:7], s95 offen offset:0 sc1
  s_nop 0
  buffer_load_dwordx4 v[16:19], v95, s[4:7], s95 offen offset:2048 sc1
  s_nop 0
  buffer_load_dwordx4 v[96:99], v95, s[4:7], s96 offen offset:0 sc1
  s_nop 0
  buffer_load_dwordx4 v[100:103], v95, s[4:7], s96 offen offset:2048 sc1
  s_nop 0
  buffer_load_dwordx4 v[68:71], v95, s[4:7], s97 offen offset:0 sc1
  s_nop 0
  s_branch L_QKM_ok4
L_QKM_g5:
  s_sub_u32 s24, s24, 1
  s_cbranch_scc1 L_FAIL
  s_add_u32 s60, s60, 1
  buffer_load_dwordx4 v[8:11], v95, s[4:7], s94 offen offset:2048 sc1
  s_waitcnt vmcnt(0)
  v_cmp_eq_u32 vcc, -1, v8
  s_cbranch_vccnz L_QKM_g5
  v_mov_b32 v89, 0
  v_max3_u32 v89, v12, v16, v89
  v_max3_u32 v89, v96, v100, v89
  v_max3_u32 v89, v68, v72, v89
  v_cmp_eq_u32 vcc, -1, v89
  s_cbranch_vccz L_QKM_ok5
  buffer_load_dwordx4 v[12:15], v95, s[4:7], s95 offen offset:0 sc1
  s_nop 0
  buffer_load_dwordx4 v[16:19], v95, s[4:7], s95 offen offset:2048 sc1
  s_nop 0
  buffer_load_dwordx4 v[96:99], v95, s[4:7], s96 offen offset:0 sc1
  s_nop 0
  buffer_load_dwordx4 v[100:103], v95, s[4:7], s96 offen offset:2048 sc1
  s_nop 0
  buffer_load_dwordx4 v[68:71], v95, s[4:7], s97 offen offset:0 sc1
  s_nop 0
  buffer_load_dwordx4 v[72:75], v95, s[4:7], s97 offen offset:2048 sc1
  s_nop 0
  s_branch L_QKM_ok5
L_QKM_g6:
  s_sub_u32 s24, s24, 1
  s_cbranch_scc1 L_FAIL
  s_add_u32 s60, s60, 1
  buffer_load_dwordx4 v[12:15], v95, s[4:7], s95 offen offset:0 sc1
  s_waitcnt vmcnt(0)
  v_cmp_eq_u32 vcc, -1, v12
  s_cbranch_vccnz L_QKM_g6
  v_mov_b32 v89, 0
  v_max3_u32 v89, v16, v96, v89
  v_max3_u32 v89, v100, v68, v89
  v_max3_u32 v89, v72, v4, v89
  v_cmp_eq_u32 vcc, -1, v89
  s_cbranch_vccz L_QKM_ok6
  buffer_load_dwordx4 v[16:19], v95, s[4:7], s95 offen offset:2048 sc1
  s_nop 0
  buffer_load_dwordx4 v[96:99], v95, s[4:7], s96 offen offset:0 sc1
  s_nop 0
  buffer_load_dwordx4 v[100:103], v95, s[4:7], s96 offen offset:2048 sc1
  s_nop 0
  buffer_load_dwordx4 v[68:71], v95, s[4:7], s97 offen offset:0 sc1
  s_nop 0
  buffer_load_dwordx4 v[72:75], v95, s[4:7], s97 offen offset:2048 sc1
  s_nop 0
  buffer_load_dwordx4 v[4:7], v95, s[4:7], s98 offen offset:0 sc1
  s_nop 0
  s_branch L_QKM_ok6
L_QKM_g7:
  s_sub_u32 s24, s24, 1
  s_cbranch_scc1 L_FAIL
  s_add_u32 s60, s60, 1
  buffer_load_dwordx4 v[16:19], v95, s[4:7], s95 offen offset:2048 sc1
  s_waitcnt vmcnt(0)
  v_cmp_eq_u32 vcc, -1, v16
  s_cbranch_vccnz L_QKM_g7
  v_mov_b32 v89, 0
  v_max3_u32 v89, v96, v100, v89
  v_max3_u32 v89, v68, v72, v89
  v_max3_u32 v89, v4, v8, v89
  v_cmp_eq_u32 vcc, -1, v89
  s_cbranch_vccz L_QKM_ok7
  buffer_load_dwordx4 v[96:99], v95, s[4:7], s96 offen offset:0 sc1
  s_nop 0
  buffer_load_dwordx4 v[100:103], v95, s[4:7], s96 offen offset:2048 sc1
  s_nop 0
  buffer_load_dwordx4 v[68:71], v95, s[4:7], s97 offen offset:0 sc1
  s_nop 0
  buffer_load_dwordx4 v[72:75], v95, s[4:7], s97 offen offset:2048 sc1
  s_nop 0
  buffer_load_dwordx4 v[4:7], v95, s[4:7], s98 offen offset:0 sc1
  s_nop 0
  buffer_load_dwordx4 v[8:11], v95, s[4:7], s98 offen offset:2048 sc1
  s_nop 0
  s_branch L_QKM_ok7
L_QKM_g8:
  s_sub_u32 s24, s24, 1
  s_cbranch_scc1 L_FAIL
  s_add_u32 s60, s60, 256
  buffer_load_dwordx4 v[96:99], v95, s[4:7], s96 offen offset:0 sc1
  s_waitcnt vmcnt(0)
  v_cmp_eq_u32 vcc, -1, v96
  s_cbranch_vccnz L_QKM_g8
  v_mov_b32 v89, 0
  v_max3_u32 v89, v100, v68, v89
  v_max3_u32 v89, v72, v4, v89
  v_max3_u32 v89, v8, v12, v89
  v_cmp_eq_u32 vcc, -1, v89
  s_cbranch_vccz L_QKM_ok8
  buffer_load_dwordx4 v[100:103], v95, s[4:7], s96 offen offset:2048 sc1
  s_nop 0
  buffer_load_dwordx4 v[68:71], v95, s[4:7], s97 offen offset:0 sc1
  s_nop 0
  buffer_load_dwordx4 v[72:75], v95, s[4:7], s97 offen offset:2048 sc1
  s_nop 0
  buffer_load_dwordx4 v[4:7], v95, s[4:7], s98 offen offset:0 sc1
  s_nop 0
  buffer_load_dwordx4 v[8:11], v95, s[4:7], s98 offen offset:2048 sc1
  s_nop 0
  buffer_load_dwordx4 v[12:15], v95, s[4:7], s99 offen offset:0 sc1
  s_nop 0
  s_branch L_QKM_ok8
L_QKM_g9:
  s_sub_u32 s24, s24, 1
  s_cbranch_scc1 L_FAIL
  s_add_u32 s60, s60, 256
  buffer_load_dwordx4 v[100:103], v95, s[4:7], s96 offen offset:2048 sc1
  s_waitcnt vmcnt(0)
  v_cmp_eq_u32 vcc, -1, v100
  s_cbranch_vccnz L_QKM_g9
  v_mov_b32 v89, 0
  v_max3_u32 v89, v68, v72, v89
  v_max3_u32 v89, v4, v8, v89
  v_max3_u32 v89, v12, v16, v89
  v_cmp_eq_u32 vcc, -1, v89
  s_cbranch_vccz L_QKM_ok9
  buffer_load_dwordx4 v[68:71], v95, s[4:7], s97 offen offset:0 sc1
  s_nop 0
  buffer_load_dwordx4 v[72:75], v95, s[4:7], s97 offen offset:2048 sc1
  s_nop 0
  buffer_load_dwordx4 v[4:7], v95, s[4:7], s98 offen offset:0 sc1
  s_nop 0
  buffer_load_dwordx4 v[8:11], v95, s[4:7], s98 offen offset:2048 sc1
  s_nop 0
  buffer_load_dwordx4 v[12:15], v95, s[4:7], s99 offen offset:0 sc1
  s_nop 0
  buffer_load_dwordx4 v[16:19], v95, s[4:7], s99 offen offset:2048 sc1
  s_nop 0
  s_branch L_QKM_ok9
L_QKM_g10:
  s_sub_u32 s24, s24, 1
  s_cbranch_scc1 L_FAIL
  s_add_u32 s60, s60, 256
  buffer_load_dwordx4 v[68:71], v95, s[4:7], s97 offen offset:0 sc1
  s_waitcnt vmcnt(0)
  v_cmp_eq_u32 vcc, -1, v68
  s_cbranch_vccnz L_QKM_g10
  v_mov_b32 v89, 0
  v_max3_u32 v89, v72, v4, v89
  v_max3_u32 v89, v8, v12, v89
  v_max3_u32 v89, v16, v16, v89
  v_cmp_eq_u32 vcc, -1, v89
  s_cbranch_vccz L_QKM_ok10
  buffer_load_dwordx4 v[72:75], v95, s[4:7], s97 offen offset:2048 sc1
  s_nop 0
  buffer_load_dwordx4 v[4:7], v95, s[4:7], s98 offen offset:0 sc1
  s_nop 0
  buffer_load_dwordx4 v[8:11], v95, s[4:7], s98 offen offset:2048 sc1
  s_nop 0
  buffer_load_dwordx4 v[12:15], v95, s[4:7], s99 offen offset:0 sc1
  s_nop 0
  buffer_load_dwordx4 v[16:19], v95, s[4:7], s99 offen offset:2048 sc1
  s_nop 0
  s_branch L_QKM_ok10
L_QKM_g11:
  s_sub_u32 s24, s24, 1
  s_cbranch_scc1 L_FAIL
  s_add_u32 s60, s60, 256
  buffer_load_dwordx4 v[72:75], v95, s[4:7], s97 offen offset:2048 sc1
  s_waitcnt vmcnt(0)
  v_cmp_eq_u32 vcc, -1, v72
  s_cbranch_vccnz L_QKM_g11
  v_mov_b32 v89, 0
  v_max3_u32 v89, v4, v8, v89
  v_max3_u32 v89, v12, v16, v89
  v_cmp_eq_u32 vcc, -1, v89
  s_cbranch_vccz L_QKM_ok11
  buffer_load_dwordx4 v[4:7], v95, s[4:7], s98 offen offset:0 sc1
  s_nop 0
  buffer_load_dwordx4 v[8:11], v95, s[4:7], s98 offen offset:2048 sc1
  s_nop 0
  buffer_load_dwordx4 v[12:15], v95, s[4:7], s99 offen offset:0 sc1
  s_nop 0
  buffer_load_dwordx4 v[16:19], v95, s[4:7], s99 offen offset:2048 sc1
  s_nop 0
  s_branch L_QKM_ok11
L_QKM_g12:
  s_sub_u32 s24, s24, 1
  s_cbranch_scc1 L_FAIL
  s_add_u32 s60, s60, 256
  buffer_load_dwordx4 v[4:7], v95, s[4:7], s98 offen offset:0 sc1
  s_waitcnt vmcnt(0)
  v_cmp_eq_u32 vcc, -1, v4
  s_cbranch_vccnz L_QKM_g12
  v_mov_b32 v89, 0
  v_max3_u32 v89, v8, v12, v89
  v_max3_u32 v89, v16, v16, v89
  v_cmp_eq_u32 vcc, -1, v89
  s_cbranch_vccz L_QKM_ok12
  buffer_load_dwordx4 v[8:11], v95, s[4:7], s98 offen offset:2048 sc1
  s_nop 0
  buffer_load_dwordx4 v[12:15], v95, s[4:7], s99 offen offset:0 sc1
  s_nop 0
  buffer_load_dwordx4 v[16:19], v95, s[4:7], s99 offen offset:2048 sc1
  s_nop 0
  s_branch L_QKM_ok12
L_QKM_g13:
  s_sub_u32 s24, s24, 1
  s_cbranch_scc1 L_FAIL
  s_add_u32 s60, s60, 256
  buffer_load_dwordx4 v[8:11], v95, s[4:7], s98 offen offset:2048 sc1
  s_waitcnt vmcnt(0)
  v_cmp_eq_u32 vcc, -1, v8
  s_cbranch_vccnz L_QKM_g13
  v_mov_b32 v89, 0
  v_max3_u32 v89, v12, v16, v89
  v_cmp_eq_u32 vcc, -1, v89
  s_cbranch_vccz L_QKM_ok13
  buffer_load_dwordx4 v[12:15], v95, s[4:7], s99 offen offset:0 sc1
  s_nop 0
  buffer_load_dwordx4 v[16:19], v95, s[4:7], s99 offen offset:2048 sc1
  s_nop 0
  s_branch L_QKM_ok13
L_QKM_g14:
  s_sub_u32 s24, s24, 1
  s_cbranch_scc1 L_FAIL
  s_add_u32 s60, s60, 256
  buffer_load_dwordx4 v[12:15], v95, s[4:7], s99 offen offset:0 sc1
  s_waitcnt vmcnt(0)
  v_cmp_eq_u32 vcc, -1, v12
  s_cbranch_vccnz L_QKM_g14
  v_mov_b32 v89, 0
  v_max3_u32 v89, v16, v16, v89
  v_cmp_eq_u32 vcc, -1, v89
  s_cbranch_vccz L_QKM_ok14
  buffer_load_dwordx4 v[16:19], v95, s[4:7], s99 offen offset:2048 sc1
  s_nop 0
  s_branch L_QKM_ok14
L_QKM_g15:
  s_sub_u32 s24, s24, 1
  s_cbranch_scc1 L_FAIL
  s_add_u32 s60, s60, 256
  buffer_load_dwordx4 v[16:19], v95, s[4:7], s99 offen offset:2048 sc1
  s_waitcnt vmcnt(0)
  v_cmp_eq_u32 vcc, -1, v16
  s_cbranch_vccnz L_QKM_g15
  s_branch L_QKM_ok15
L_QK_vbad:
  s_sub_u32 s24, s24, 1
  s_cbranch_scc1 L_FAIL
  s_add_u32 s61, s61, 1
  buffer_load_dwordx2 v[104:105], v92, s[4:7], s29 offen sc1
  buffer_load_dwordx2 v[106:107], v92, s[4:7], s35 offen sc1
  s_waitcnt vmcnt(0)
  v_max3_u32 v89, v104, v105, v106
  v_max_u32 v89, v89, v107
  v_cmp_eq_u32 vcc, -1, v89
  s_cbranch_vccnz L_QK_vbad
  s_branch L_QK_vok
L_VO:
  v_bfe_u32 v76, v0, 3, 2
  v_xor_b32 v76, s20, v76
  v_lshlrev_b32 v76, 5, v76
  v_lshrrev_b32 v4, 2, v0
  v_lshl_add_u32 v4, v4, 7, v76
  v_and_b32 v76, 3, v0
  v_lshl_add_u32 v4, v76, 3, v4
  s_lshl_b32 s40, s20, 15
  v_add_u32 v4, s40, v4
  v_lshl_add_u32 v85, v0, 4, s40
  s_lshl_b32 s40, s20, 12
  s_add_u32 s40, s40, 131072
  v_lshl_add_u32 v1, v0, 4, s40
  s_lshr_b32 s54, s21, 4
  s_lshl_b32 s52, s54, 22
  s_sub_u32 s53, 0, s52
  v_xor_b32 v5, 32768, v4
  v_xor_b32 v2, 4096, v1
  v_xor_b32 v6, 65536, v4
  v_xor_b32 v3, 8192, v1
  v_xor_b32 v7, 98304, v4
  v_xor_b32 v84, 12288, v1
  v_bfe_u32 v8, v0, 5, 1
  v_mul_u32_u24 v8, 16384, v8
  v_bfe_u32 v76, v0, 4, 1
  v_mul_u32_u24 v76, 32768, v76
  v_add_u32 v8, v8, v76
  v_bfe_u32 v76, v0, 3, 1
  v_mul_u32_u24 v76, 131072, v76
  v_add_u32 v8, v8, v76
  v_lshrrev_b32 v76, 3, v0
  v_and_b32 v76, 6, v76
  v_xor_b32 v76, v76, v0
  v_and_b32 v76, 7, v76
  v_lshl_add_u32 v8, v76, 4, v8
  s_lshl_b32 s40, s20, 19
  v_add_u32 v8, s40, v8
  s_lshl_b32 s44, s21, 8
  s_add_u32 s45, s44, 128
  s_load_dwordx2 s[8:9], s[0:1], 32
  s_mov_b32 s10, 8388608
  s_mov_b32 s11, 0x20000
  s_waitcnt lgkmcnt(0)
  v_add_u32 v9, s44, v8
  v_add_u32 v10, s45, v8
  s_lshl_b32 s41, s20, 15
  s_add_u32 m0, s41, 0
  s_add_u32 s42, s52, 0
  buffer_load_dwordx4 v9, s[8:11], s42 offen lds
  s_add_u32 m0, s41, 1024
  s_add_u32 s42, s52, 65536
  buffer_load_dwordx4 v9, s[8:11], s42 offen lds
  s_add_u32 m0, s41, 2048
  s_add_u32 s42, s52, 8192
  buffer_load_dwordx4 v9, s[8:11], s42 offen lds
  s_add_u32 m0, s41, 3072
  s_add_u32 s42, s52, 73728
  buffer_load_dwordx4 v9, s[8:11], s42 offen lds
  s_add_u32 m0, s41, 4096
  s_add_u32 s42, s52, 262144
  buffer_load_dwordx4 v9, s[8:11], s42 offen lds
  s_add_u32 m0, s41, 5120
  s_add_u32 s42, s52, 327680
  buffer_load_dwordx4 v9, s[8:11], s42 offen lds
  s_add_u32 m0, s41, 6144
  s_add_u32 s42, s52, 270336
  buffer_load_dwordx4 v9, s[8:11], s42 offen lds
  s_add_u32 m0, s41, 7168
  s_add_u32 s42, s52, 335872
  buffer_load_dwordx4 v9, s[8:11], s42 offen lds
  s_add_u32 m0, s41, 8192
  s_add_u32 s42, s52, 2097152
  buffer_load_dwordx4 v9, s[8:11], s42 offen lds
  s_add_u32 m0, s41, 9216
  s_add_u32 s42, s52, 2162688
  buffer_load_dwordx4 v9, s[8:11], s42 offen lds
  s_add_u32 m0, s41, 10240
  s_add_u32 s42, s52, 2105344
  buffer_load_dwordx4 v9, s[8:11], s42 offen lds
  s_add_u32 m0, s41, 11264
  s_add_u32 s42, s52, 2170880
  buffer_load_dwordx4 v9, s[8:11], s42 offen lds
  s_add_u32 m0, s41, 12288
  s_add_u32 s42, s52, 2359296
  buffer_load_dwordx4 v9, s[8:11], s42 offen lds
  s_add_u32 m0, s41, 13312
  s_add_u32 s42, s52, 2424832
  buffer_load_dwordx4 v9, s[8:11], s42 offen lds
  s_add_u32 m0, s41, 14336
  s_add_u32 s42, s52, 2367488
  buffer_load_dwordx4 v9, s[8:11], s42 offen lds
  s_add_u32 m0, s41, 15360
  s_add_u32 s42, s52, 2433024
  buffer_load_dwordx4 v9, s[8:11], s42 offen lds
  s_add_u32 m0, s41, 16384
  s_add_u32 s42, s53, 4194304
  buffer_load_dwordx4 v9, s[8:11], s42 offen lds
  s_add_u32 m0, s41, 17408
  s_add_u32 s42, s53, 4259840
  buffer_load_dwordx4 v9, s[8:11], s42 offen lds
  s_add_u32 m0, s41, 18432
  s_add_u32 s42, s53, 4202496
  buffer_load_dwordx4 v9, s[8:11], s42 offen lds
  s_add_u32 m0, s41, 19456
  s_add_u32 s42, s53, 4268032
  buffer_load_dwordx4 v9, s[8:11], s42 offen lds
  s_add_u32 m0, s41, 20480
  s_add_u32 s42, s53, 4456448
  buffer_load_dwordx4 v9, s[8:11], s42 offen lds
  s_add_u32 m0, s41, 21504
  s_add_u32 s42, s53, 4521984
  buffer_load_dwordx4 v9, s[8:11], s42 offen lds
  s_add_u32 m0, s41, 22528
  s_add_u32 s42, s53, 4464640
  buffer_load_dwordx4 v9, s[8:11], s42 offen lds
  s_add_u32 m0, s41, 23552
  s_add_u32 s42, s53, 4530176
  buffer_load_dwordx4 v9, s[8:11], s42 offen lds
  s_waitcnt vmcnt(16) lgkmcnt(0)
  s_barrier
  s_add_u32 m0, s41, 24576
  s_add_u32 s42, s53, 6291456
  buffer_load_dwordx4 v9, s[8:11], s42 offen lds
  s_add_u32 m0, s41, 25600
  s_add_u32 s42, s53, 6356992
  buffer_load_dwordx4 v9, s[8:11], s42 offen lds
  s_add_u32 m0, s41, 26624
  s_add_u32 s42, s53, 6299648
  buffer_load_dwordx4 v9, s[8:11], s42 offen lds
  s_add_u32 m0, s41, 27648
  s_add_u32 s42, s53, 6365184
  buffer_load_dwordx4 v9, s[8:11], s42 offen lds
  s_add_u32 m0, s41, 28672
  s_add_u32 s42, s53, 6553600
  buffer_load_dwordx4 v9, s[8:11], s42 offen lds
  s_add_u32 m0, s41, 29696
  s_add_u32 s42, s53, 6619136
  buffer_load_dwordx4 v9, s[8:11], s42 offen lds
  s_add_u32 m0, s41, 30720
  s_add_u32 s42, s53, 6561792
  buffer_load_dwordx4 v9, s[8:11], s42 offen lds
  s_add_u32 m0, s41, 31744
  s_add_u32 s42, s53, 6627328
  buffer_load_dwordx4 v9, s[8:11], s42 offen lds
  ds_read_b64_tr_b16 v[128:129], v4 offset:0
  ds_read_b64_tr_b16 v[130:131], v4 offset:2048
  ds_read_b64_tr_b16 v[132:133], v4 offset:4096
  ds_read_b64_tr_b16 v[134:135], v4 offset:6144
  ds_read_b64_tr_b16 v[144:145], v5 offset:0
  ds_read_b64_tr_b16 v[146:147], v5 offset:2048
  ds_read_b64_tr_b16 v[148:149], v5 offset:4096
  ds_read_b64_tr_b16 v[150:151], v5 offset:6144
  ds_read_b64_tr_b16 v[160:161], v6 offset:0
  ds_read_b64_tr_b16 v[162:163], v6 offset:2048
  ds_read_b64_tr_b16 v[164:165], v6 offset:4096
  ds_read_b64_tr_b16 v[166:167], v6 offset:6144
  ds_read_b64_tr_b16 v[176:177], v7 offset:0
  ds_read_b64_tr_b16 v[178:179], v7 offset:2048
  ds_read_b64_tr_b16 v[180:181], v7 offset:4096
  ds_read_b64_tr_b16 v[182:183], v7 offset:6144
  s_waitcnt vmcnt(16) lgkmcnt(0)
  s_barrier
  s_add_u32 m0, s41, 0
  s_add_u32 s42, s52, 0
  buffer_load_dwordx4 v10, s[8:11], s42 offen lds
  s_add_u32 m0, s41, 1024
  s_add_u32 s42, s52, 65536
  buffer_load_dwordx4 v10, s[8:11], s42 offen lds
  s_add_u32 m0, s41, 2048
  s_add_u32 s42, s52, 8192
  buffer_load_dwordx4 v10, s[8:11], s42 offen lds
  s_add_u32 m0, s41, 3072
  s_add_u32 s42, s52, 73728
  buffer_load_dwordx4 v10, s[8:11], s42 offen lds
  s_add_u32 m0, s41, 4096
  s_add_u32 s42, s52, 262144
  buffer_load_dwordx4 v10, s[8:11], s42 offen lds
  s_add_u32 m0, s41, 5120
  s_add_u32 s42, s52, 327680
  buffer_load_dwordx4 v10, s[8:11], s42 offen lds
  s_add_u32 m0, s41, 6144
  s_add_u32 s42, s52, 270336
  buffer_load_dwordx4 v10, s[8:11], s42 offen lds
  s_add_u32 m0, s41, 7168
  s_add_u32 s42, s52, 335872
  buffer_load_dwordx4 v10, s[8:11], s42 offen lds
  ds_read_b64_tr_b16 v[136:137], v4 offset:8192
  ds_read_b64_tr_b16 v[138:139], v4 offset:10240
  ds_read_b64_tr_b16 v[140:141], v4 offset:12288
  ds_read_b64_tr_b16 v[142:143], v4 offset:14336
  ds_read_b64_tr_b16 v[152:153], v5 offset:8192
  ds_read_b64_tr_b16 v[154:155], v5 offset:10240
  ds_read_b64_tr_b16 v[156:157], v5 offset:12288
  ds_read_b64_tr_b16 v[158:159], v5 offset:14336
  ds_read_b64_tr_b16 v[168:169], v6 offset:8192
  ds_read_b64_tr_b16 v[170:171], v6 offset:10240
  ds_read_b64_tr_b16 v[172:173], v6 offset:12288
  ds_read_b64_tr_b16 v[174:175], v6 offset:14336
  ds_read_b64_tr_b16 v[184:185], v7 offset:8192
  ds_read_b64_tr_b16 v[186:187], v7 offset:10240
  ds_read_b64_tr_b16 v[188:189], v7 offset:12288
  ds_read_b64_tr_b16 v[190:191], v7 offset:14336
  s_waitcnt vmcnt(16) lgkmcnt(0)
  s_barrier
  s_add_u32 m0, s41, 8192
  s_add_u32 s42, s52, 2097152
  buffer_load_dwordx4 v10, s[8:11], s42 offen lds
  s_add_u32 m0, s41, 9216
  s_add_u32 s42, s52, 2162688
  buffer_load_dwordx4 v10, s[8:11], s42 offen lds
  s_add_u32 m0, s41, 10240
  s_add_u32 s42, s52, 2105344
  buffer_load_dwordx4 v10, s[8:11], s42 offen lds
  s_add_u32 m0, s41, 11264
  s_add_u32 s42, s52, 2170880
  buffer_load_dwordx4 v10, s[8:11], s42 offen lds
  s_add_u32 m0, s41, 12288
  s_add_u32 s42, s52, 2359296
  buffer_load_dwordx4 v10, s[8:11], s42 offen lds
  s_add_u32 m0, s41, 13312
  s_add_u32 s42, s52, 2424832
  buffer_load_dwordx4 v10, s[8:11], s42 offen lds
  s_add_u32 m0, s41, 14336
  s_add_u32 s42, s52, 2367488
  buffer_load_dwordx4 v10, s[8:11], s42 offen lds
  s_add_u32 m0, s41, 15360
  s_add_u32 s42, s52, 2433024
  buffer_load_dwordx4 v10, s[8:11], s42 offen lds
  ds_read_b64_tr_b16 v[192:193], v4 offset:16384
  ds_read_b64_tr_b16 v[194:195], v4 offset:18432
  ds_read_b64_tr_b16 v[196:197], v4 offset:20480
  ds_read_b64_tr_b16 v[198:199], v4 offset:22528
  ds_read_b64_tr_b16 v[208:209], v5 offset:16384
  ds_read_b64_tr_b16 v[210:211], v5 offset:18432
  ds_read_b64_tr_b16 v[212:213], v5 offset:20480
  ds_read_b64_tr_b16 v[214:215], v5 offset:22528
  ds_read_b64_tr_b16 v[224:225], v6 offset:16384
  ds_read_b64_tr_b16 v[226:227], v6 offset:18432
  ds_read_b64_tr_b16 v[228:229], v6 offset:20480
  ds_read_b64_tr_b16 v[230:231], v6 offset:22528
  ds_read_b64_tr_b16 v[240:241], v7 offset:16384
  ds_read_b64_tr_b16 v[242:243], v7 offset:18432
  ds_read_b64_tr_b16 v[244:245], v7 offset:20480
  ds_read_b64_tr_b16 v[246:247], v7 offset:22528
  s_waitcnt vmcnt(16) lgkmcnt(0)
  s_barrier
  s_add_u32 m0, s41, 16384
  s_add_u32 s42, s53, 4194304
  buffer_load_dwordx4 v10, s[8:11], s42 offen lds
  s_add_u32 m0, s41, 17408
  s_add_u32 s42, s53, 4259840
  buffer_load_dwordx4 v10, s[8:11], s42 offen lds
  s_add_u32 m0, s41, 18432
  s_add_u32 s42, s53, 4202496
  buffer_load_dwordx4 v10, s[8:11], s42 offen lds
  s_add_u32 m0, s41, 19456
  s_add_u32 s42, s53, 4268032
  buffer_load_dwordx4 v10, s[8:11], s42 offen lds
  s_add_u32 m0, s41, 20480
  s_add_u32 s42, s53, 4456448
  buffer_load_dwordx4 v10, s[8:11], s42 offen lds
  s_add_u32 m0, s41, 21504
  s_add_u32 s42, s53, 4521984
  buffer_load_dwordx4 v10, s[8:11], s42 offen lds
  s_add_u32 m0, s41, 22528
  s_add_u32 s42, s53, 4464640
  buffer_load_dwordx4 v10, s[8:11], s42 offen lds
  s_add_u32 m0, s41, 23552
  s_add_u32 s42, s53, 4530176
  buffer_load_dwordx4 v10, s[8:11], s42 offen lds
  ds_read_b64_tr_b16 v[200:201], v4 offset:24576
  ds_read_b64_tr_b16 v[202:203], v4 offset:26624
  ds_read_b64_tr_b16 v[204:205], v4 offset:28672
  ds_read_b64_tr_b16 v[206:207], v4 offset:30720
  ds_read_b64_tr_b16 v[216:217], v5 offset:24576
  ds_read_b64_tr_b16 v[218:219], v5 offset:26624
  ds_read_b64_tr_b16 v[220:221], v5 offset:28672
  ds_read_b64_tr_b16 v[222:223], v5 offset:30720
  ds_read_b64_tr_b16 v[232:233], v6 offset:24576
  ds_read_b64_tr_b16 v[234:235], v6 offset:26624
  ds_read_b64_tr_b16 v[236:237], v6 offset:28672
  ds_read_b64_tr_b16 v[238:239], v6 offset:30720
  ds_read_b64_tr_b16 v[248:249], v7 offset:24576
  ds_read_b64_tr_b16 v[250:251], v7 offset:26624
  ds_read_b64_tr_b16 v[252:253], v7 offset:28672
  ds_read_b64_tr_b16 v[254:255], v7 offset:30720
  s_cmp_lg_u32 s20, 0
  s_cbranch_scc1 Lchore_66
Lini_67:
  s_load_dwordx16 s[64:79], s[12:13], 128 glc
  s_load_dwordx16 s[80:95], s[12:13], 192 glc
  s_sub_u32 s24, s24, 1
  s_cbranch_scc1 L_FAIL
  s_waitcnt lgkmcnt(0)
  s_and_b64 s[64:65], s[64:65], s[66:67]
  s_and_b64 s[64:65], s[64:65], s[68:69]
  s_and_b64 s[64:65], s[64:65], s[70:71]
  s_and_b64 s[64:65], s[64:65], s[72:73]
  s_and_b64 s[64:65], s[64:65], s[74:75]
  s_and_b64 s[64:65], s[64:65], s[76:77]
  s_and_b64 s[64:65], s[64:65], s[78:79]
  s_and_b64 s[64:65], s[64:65], s[80:81]
  s_and_b64 s[64:65], s[64:65], s[82:83]
  s_and_b64 s[64:65], s[64:65], s[84:85]
  s_and_b64 s[64:65], s[64:65], s[86:87]
  s_and_b64 s[64:65], s[64:65], s[88:89]
  s_and_b64 s[64:65], s[64:65], s[90:91]
  s_and_b64 s[64:65], s[64:65], s[92:93]
  s_and_b64 s[64:65], s[64:65], s[94:95]
  s_and_b32 s64, s64, s65
  s_cbranch_scc0 Lini_67
  s_mov_b32 s46, 0xffff
  s_and_b32 s40, s21, 3
  s_lshl_b32 s40, s40, 13
  s_lshr_b32 s43, s21, 2
  s_lshl_b32 s43, s43, 10
  s_add_u32 s43, s43, s40
  s_add_u32 s43, s43, 1344000
  s_waitcnt lgkmcnt(0)
  s_memtime s[64:65]
  s_waitcnt lgkmcnt(0)
  s_load_dword s68, s[4:5], s43 glc
  s_waitcnt lgkmcnt(0)
  s_memtime s[66:67]
  s_waitcnt lgkmcnt(0)
  s_sub_u32 s64, s66, s64
  s_min_u32 s46, s46, s64
  s_getreg_b32 s55, hwreg(HW_REG_XCC_ID)
  s_and_b32 s55, s55, 15
  s_lshl_b32 s46, s46, 8
  s_or_b32 s46, s46, s55
  s_add_u32 s40, s21, 32
  s_lshl_b32 s40, s40, 7
  s_add_u32 s40, s40, 1424384
  s_mov_b32 s63, s46
  s_atomic_smax s63, s[4:5], s40 glc
Lnosig_68:
Lchore_66:
  s_waitcnt vmcnt(16) lgkmcnt(0)
  s_barrier
  s_add_u32 m0, s41, 24576
  s_add_u32 s42, s53, 6291456
  buffer_load_dwordx4 v10, s[8:11], s42 offen lds
  s_add_u32 m0, s41, 25600
  s_add_u32 s42, s53, 6356992
  buffer_load_dwordx4 v10, s[8:11], s42 offen lds
  s_add_u32 m0, s41, 26624
  s_add_u32 s42, s53, 6299648
  buffer_load_dwordx4 v10, s[8:11], s42 offen lds
  s_add_u32 m0, s41, 27648
  s_add_u32 s42, s53, 6365184
  buffer_load_dwordx4 v10, s[8:11], s42 offen lds
  s_add_u32 m0, s41, 28672
  s_add_u32 s42, s53, 6553600
  buffer_load_dwordx4 v10, s[8:11], s42 offen lds
  s_add_u32 m0, s41, 29696
  s_add_u32 s42, s53, 6619136
  buffer_load_dwordx4 v10, s[8:11], s42 offen lds
  s_add_u32 m0, s41, 30720
  s_add_u32 s42, s53, 6561792
  buffer_load_dwordx4 v10, s[8:11], s42 offen lds
  s_add_u32 m0, s41, 31744
  s_add_u32 s42, s53, 6627328
  buffer_load_dwordx4 v10, s[8:11], s42 offen lds
  ds_read_b64_tr_b16 v[20:21], v4 offset:0
  ds_read_b64_tr_b16 v[22:23], v4 offset:2048
  ds_read_b64_tr_b16 v[24:25], v4 offset:4096
  ds_read_b64_tr_b16 v[26:27], v4 offset:6144
  ds_read_b64_tr_b16 v[28:29], v5 offset:0
  ds_read_b64_tr_b16 v[30:31], v5 offset:2048
  ds_read_b64_tr_b16 v[32:33], v5 offset:4096
  ds_read_b64_tr_b16 v[34:35], v5 offset:6144
  ds_read_b64_tr_b16 v[36:37], v6 offset:0
  ds_read_b64_tr_b16 v[38:39], v6 offset:2048
  ds_read_b64_tr_b16 v[40:41], v6 offset:4096
  ds_read_b64_tr_b16 v[42:43], v6 offset:6144
  ds_read_b64_tr_b16 v[44:45], v7 offset:0
  ds_read_b64_tr_b16 v[46:47], v7 offset:2048
  ds_read_b64_tr_b16 v[48:49], v7 offset:4096
  ds_read_b64_tr_b16 v[50:51], v7 offset:6144
  s_waitcnt lgkmcnt(0)
  s_barrier
  ds_write_b128 v85, v[20:23] offset:0
  ds_write_b128 v85, v[24:27] offset:1024
  ds_write_b128 v85, v[28:31] offset:2048
  ds_write_b128 v85, v[32:35] offset:3072
  ds_write_b128 v85, v[36:39] offset:4096
  ds_write_b128 v85, v[40:43] offset:5120
  ds_write_b128 v85, v[44:47] offset:6144
  ds_write_b128 v85, v[48:51] offset:7168
  s_waitcnt vmcnt(16) lgkmcnt(0)
  s_barrier
  ds_read_b64_tr_b16 v[20:21], v4 offset:8192
  ds_read_b64_tr_b16 v[22:23], v4 offset:10240
  ds_read_b64_tr_b16 v[24:25], v4 offset:12288
  ds_read_b64_tr_b16 v[26:27], v4 offset:14336
  ds_read_b64_tr_b16 v[28:29], v5 offset:8192
  ds_read_b64_tr_b16 v[30:31], v5 offset:10240
  ds_read_b64_tr_b16 v[32:33], v5 offset:12288
  ds_read_b64_tr_b16 v[34:35], v5 offset:14336
  ds_read_b64_tr_b16 v[36:37], v6 offset:8192
  ds_read_b64_tr_b16 v[38:39], v6 offset:10240
  ds_read_b64_tr_b16 v[40:41], v6 offset:12288
  ds_read_b64_tr_b16 v[42:43], v6 offset:14336
  ds_read_b64_tr_b16 v[44:45], v7 offset:8192
  ds_read_b64_tr_b16 v[46:47], v7 offset:10240
  ds_read_b64_tr_b16 v[48:49], v7 offset:12288
  ds_read_b64_tr_b16 v[50:51], v7 offset:14336
  s_waitcnt lgkmcnt(0)
  s_barrier
  ds_write_b128 v85, v[20:23] offset:8192
  ds_write_b128 v85, v[24:27] offset:9216
  ds_write_b128 v85, v[28:31] offset:10240
  ds_write_b128 v85, v[32:35] offset:11264
  ds_write_b128 v85, v[36:39] offset:12288
  ds_write_b128 v85, v[40:43] offset:13312
  ds_write_b128 v85, v[44:47] offset:14336
  ds_write_b128 v85, v[48:51] offset:15360
  s_waitcnt vmcnt(8) lgkmcnt(0)
  s_barrier
  ds_read_b64_tr_b16 v[20:21], v4 offset:16384
  ds_read_b64_tr_b16 v[22:23], v4 offset:18432
  ds_read_b64_tr_b16 v[24:25], v4 offset:20480
  ds_read_b64_tr_b16 v[26:27], v4 offset:22528
  ds_read_b64_tr_b16 v[28:29], v5 offset:16384
  ds_read_b64_tr_b16 v[30:31], v5 offset:18432
  ds_read_b64_tr_b16 v[32:33], v5 offset:20480
  ds_read_b64_tr_b16 v[34:35], v5 offset:22528
  ds_read_b64_tr_b16 v[36:37], v6 offset:16384
  ds_read_b64_tr_b16 v[38:39], v6 offset:18432
  ds_read_b64_tr_b16 v[40:41], v6 offset:20480
  ds_read_b64_tr_b16 v[42:43], v6 offset:22528
  ds_read_b64_tr_b16 v[44:45], v7 offset:16384
  ds_read_b64_tr_b16 v[46:47], v7 offset:18432
  ds_read_b64_tr_b16 v[48:49], v7 offset:20480
  ds_read_b64_tr_b16 v[50:51], v7 offset:22528
  s_waitcnt lgkmcnt(0)
  s_barrier
  ds_write_b128 v85, v[20:23] offset:16384
  ds_write_b128 v85, v[24:27] offset:17408
  ds_write_b128 v85, v[28:31] offset:18432
  ds_write_b128 v85, v[32:35] offset:19456
  ds_write_b128 v85, v[36:39] offset:20480
  ds_write_b128 v85, v[40:43] offset:21504
  ds_write_b128 v85, v[44:47] offset:22528
  ds_write_b128 v85, v[48:51] offset:23552
  s_waitcnt vmcnt(0) lgkmcnt(0)
  s_barrier
  ds_read_b64_tr_b16 v[20:21], v4 offset:24576
  ds_read_b64_tr_b16 v[22:23], v4 offset:26624
  ds_read_b64_tr_b16 v[24:25], v4 offset:28672
  ds_read_b64_tr_b16 v[26:27], v4 offset:30720
  ds_read_b64_tr_b16 v[28:29], v5 offset:24576
  ds_read_b64_tr_b16 v[30:31], v5 offset:26624
  ds_read_b64_tr_b16 v[32:33], v5 offset:28672
  ds_read_b64_tr_b16 v[34:35], v5 offset:30720
  ds_read_b64_tr_b16 v[36:37], v6 offset:24576
  ds_read_b64_tr_b16 v[38:39], v6 offset:26624
  ds_read_b64_tr_b16 v[40:41], v6 offset:28672
  ds_read_b64_tr_b16 v[42:43], v6 offset:30720
  ds_read_b64_tr_b16 v[44:45], v7 offset:24576
  ds_read_b64_tr_b16 v[46:47], v7 offset:26624
  ds_read_b64_tr_b16 v[48:49], v7 offset:28672
  ds_read_b64_tr_b16 v[50:51], v7 offset:30720
  s_waitcnt lgkmcnt(0)
  s_barrier
  ds_write_b128 v85, v[20:23] offset:24576
  ds_write_b128 v85, v[24:27] offset:25600
  ds_write_b128 v85, v[28:31] offset:26624
  ds_write_b128 v85, v[32:35] offset:27648
  ds_write_b128 v85, v[36:39] offset:28672
  ds_write_b128 v85, v[40:43] offset:29696
  ds_write_b128 v85, v[44:47] offset:30720
  ds_write_b128 v85, v[48:51] offset:31744
  s_waitcnt lgkmcnt(0)
  s_lshr_b32 s40, s21, 1
  s_lshl_b32 s40, s40, 2
  v_min_u32 v76, 3, v0
  v_add_u32 v76, s40, v76
  v_lshlrev_b32 v76, 7, v76
  v_add_u32 v76, 1432576, v76
  s_nop 1
Lpoll_69:
  buffer_load_dword v77, v76, s[4:7], 0 offen sc1
  s_sub_u32 s24, s24, 1
  s_cbranch_scc1 L_FAIL
  s_waitcnt vmcnt(0)
  v_cmp_gt_i32 vcc, 1, v77
  s_cbranch_vccz Lpolld_70
  s_sleep 1
  s_branch Lpoll_69
Lpolld_70:
  s_lshl_b32 s40, s21, 18
  s_lshl_b32 s41, s20, 15
  s_add_u32 s40, s40, s41
  v_lshl_add_u32 v76, v0, 4, s40
  s_add_u32 s50, s21, s20
  s_and_b32 s50, s50, 3
  s_lshl_b32 s41, s54, 5
  s_add_u32 s41, s41, s50
  s_lshl_b32 s41, s41, 12
  s_xor_b32 s40, s41, 0
  s_add_u32 s40, s40, 14680064
  buffer_load_dwordx4 a[0:3], v76, s[4:7], s40 offen offset:0 sc1
  buffer_load_dwordx4 a[4:7], v76, s[4:7], s40 offen offset:1024 sc1
  buffer_load_dwordx4 a[8:11], v76, s[4:7], s40 offen offset:2048 sc1
  buffer_load_dwordx4 a[12:15], v76, s[4:7], s40 offen offset:3072 sc1
  s_xor_b32 s40, s41, 4096
  s_add_u32 s40, s40, 14680064
  buffer_load_dwordx4 a[16:19], v76, s[4:7], s40 offen offset:0 sc1
  buffer_load_dwordx4 a[20:23], v76, s[4:7], s40 offen offset:1024 sc1
  buffer_load_dwordx4 a[24:27], v76, s[4:7], s40 offen offset:2048 sc1
  buffer_load_dwordx4 a[28:31], v76, s[4:7], s40 offen offset:3072 sc1
  s_xor_b32 s40, s41, 8192
  s_add_u32 s40, s40, 14680064
  buffer_load_dwordx4 a[32:35], v76, s[4:7], s40 offen offset:0 sc1
  buffer_load_dwordx4 a[36:39], v76, s[4:7], s40 offen offset:1024 sc1
  buffer_load_dwordx4 a[40:43], v76, s[4:7], s40 offen offset:2048 sc1
  buffer_load_dwordx4 a[44:47], v76, s[4:7], s40 offen offset:3072 sc1
  s_xor_b32 s40, s41, 12288
  s_add_u32 s40, s40, 14680064
  buffer_load_dwordx4 a[48:51], v76, s[4:7], s40 offen offset:0 sc1
  buffer_load_dwordx4 a[52:55], v76, s[4:7], s40 offen offset:1024 sc1
  buffer_load_dwordx4 a[56:59], v76, s[4:7], s40 offen offset:2048 sc1
  buffer_load_dwordx4 a[60:63], v76, s[4:7], s40 offen offset:3072 sc1
  s_xor_b32 s40, s41, 16384
  s_add_u32 s40, s40, 14680064
  buffer_load_dwordx4 a[64:67], v76, s[4:7], s40 offen offset:0 sc1
  buffer_load_dwordx4 a[68:71], v76, s[4:7], s40 offen offset:1024 sc1
  buffer_load_dwordx4 a[72:75], v76, s[4:7], s40 offen offset:2048 sc1
  buffer_load_dwordx4 a[76:79], v76, s[4:7], s40 offen offset:3072 sc1
  s_xor_b32 s40, s41, 20480
  s_add_u32 s40, s40, 14680064
  buffer_load_dwordx4 a[80:83], v76, s[4:7], s40 offen offset:0 sc1
  buffer_load_dwordx4 a[84:87], v76, s[4:7], s40 offen offset:1024 sc1
  buffer_load_dwordx4 a[88:91], v76, s[4:7], s40 offen offset:2048 sc1
  buffer_load_dwordx4 a[92:95], v76, s[4:7], s40 offen offset:3072 sc1
  s_xor_b32 s40, s41, 24576
  s_add_u32 s40, s40, 14680064
  buffer_load_dwordx4 a[96:99], v76, s[4:7], s40 offen offset:0 sc1
  buffer_load_dwordx4 a[100:103], v76, s[4:7], s40 offen offset:1024 sc1
  buffer_load_dwordx4 a[104:107], v76, s[4:7], s40 offen offset:2048 sc1
  buffer_load_dwordx4 a[108:111], v76, s[4:7], s40 offen offset:3072 sc1
  s_xor_b32 s40, s41, 28672
  s_add_u32 s40, s40, 14680064
  buffer_load_dwordx4 a[112:115], v76, s[4:7], s40 offen offset:0 sc1
  buffer_load_dwordx4 a[116:119], v76, s[4:7], s40 offen offset:1024 sc1
  buffer_load_dwordx4 a[120:123], v76, s[4:7], s40 offen offset:2048 sc1
  buffer_load_dwordx4 a[124:127], v76, s[4:7], s40 offen offset:3072 sc1
  s_xor_b32 s40, s41, 131072
  s_add_u32 s40, s40, 14680064
  buffer_load_dwordx4 a[128:131], v76, s[4:7], s40 offen offset:0 sc1
  buffer_load_dwordx4 a[132:135], v76, s[4:7], s40 offen offset:1024 sc1
  buffer_load_dwordx4 a[136:139], v76, s[4:7], s40 offen offset:2048 sc1
  buffer_load_dwordx4 a[140:143], v76, s[4:7], s40 offen offset:3072 sc1
  s_waitcnt vmcnt(32)
  s_xor_b32 s40, s41, 135168
  s_add_u32 s40, s40, 14680064
  buffer_load_dwordx4 a[144:147], v76, s[4:7], s40 offen offset:0 sc1
  buffer_load_dwordx4 a[148:151], v76, s[4:7], s40 offen offset:1024 sc1
  buffer_load_dwordx4 a[152:155], v76, s[4:7], s40 offen offset:2048 sc1
  buffer_load_dwordx4 a[156:159], v76, s[4:7], s40 offen offset:3072 sc1
  s_waitcnt vmcnt(32)
  s_xor_b32 s40, s41, 139264
  s_add_u32 s40, s40, 14680064
  buffer_load_dwordx4 a[160:163], v76, s[4:7], s40 offen offset:0 sc1
  buffer_load_dwordx4 a[164:167], v76, s[4:7], s40 offen offset:1024 sc1
  buffer_load_dwordx4 a[168:171], v76, s[4:7], s40 offen offset:2048 sc1
  buffer_load_dwordx4 a[172:175], v76, s[4:7], s40 offen offset:3072 sc1
  s_waitcnt vmcnt(32)
  s_xor_b32 s40, s41, 143360
  s_add_u32 s40, s40, 14680064
  buffer_load_dwordx4 a[176:179], v76, s[4:7], s40 offen offset:0 sc1
  buffer_load_dwordx4 a[180:183], v76, s[4:7], s40 offen offset:1024 sc1
  buffer_load_dwordx4 a[184:187], v76, s[4:7], s40 offen offset:2048 sc1
  buffer_load_dwordx4 a[188:191], v76, s[4:7], s40 offen offset:3072 sc1
  s_waitcnt vmcnt(32)
  s_xor_b32 s40, s41, 147456
  s_add_u32 s40, s40, 14680064
  buffer_load_dwordx4 a[192:195], v76, s[4:7], s40 offen offset:0 sc1
  buffer_load_dwordx4 a[196:199], v76, s[4:7], s40 offen offset:1024 sc1
  buffer_load_dwordx4 a[200:203], v76, s[4:7], s40 offen offset:2048 sc1
  buffer_load_dwordx4 a[204:207], v76, s[4:7], s40 offen offset:3072 sc1
  s_waitcnt vmcnt(32)
  s_xor_b32 s40, s41, 151552
  s_add_u32 s40, s40, 14680064
  buffer_load_dwordx4 a[208:211], v76, s[4:7], s40 offen offset:0 sc1
  buffer_load_dwordx4 a[212:215], v76, s[4:7], s40 offen offset:1024 sc1
  buffer_load_dwordx4 a[216:219], v76, s[4:7], s40 offen offset:2048 sc1
  buffer_load_dwordx4 a[220:223], v76, s[4:7], s40 offen offset:3072 sc1
  s_waitcnt vmcnt(32)
  s_xor_b32 s40, s41, 155648
  s_add_u32 s40, s40, 14680064
  buffer_load_dwordx4 a[224:227], v76, s[4:7], s40 offen offset:0 sc1
  buffer_load_dwordx4 a[228:231], v76, s[4:7], s40 offen offset:1024 sc1
  buffer_load_dwordx4 a[232:235], v76, s[4:7], s40 offen offset:2048 sc1
  buffer_load_dwordx4 a[236:239], v76, s[4:7], s40 offen offset:3072 sc1
  s_waitcnt vmcnt(32)
  s_xor_b32 s40, s41, 159744
  s_add_u32 s40, s40, 14680064
  buffer_load_dwordx4 a[240:243], v76, s[4:7], s40 offen offset:0 sc1
  buffer_load_dwordx4 a[244:247], v76, s[4:7], s40 offen offset:1024 sc1
  buffer_load_dwordx4 a[248:251], v76, s[4:7], s40 offen offset:2048 sc1
  buffer_load_dwordx4 a[252:255], v76, s[4:7], s40 offen offset:3072 sc1
  s_waitcnt vmcnt(32)
  s_getreg_b32 s55, hwreg(HW_REG_XCC_ID)
  s_and_b32 s55, s55, 15
  v_min_u32 v76, 63, v0
  v_lshlrev_b32 v76, 7, v76
  v_add_u32 v76, 1424384, v76
  s_nop 1
Lpoll_71:
  buffer_load_dword v77, v76, s[4:7], 0 offen sc1
  s_sub_u32 s24, s24, 1
  s_cbranch_scc1 L_FAIL
  s_waitcnt vmcnt(0)
  v_cmp_gt_i32 vcc, 0, v77
  s_cbranch_vccz Lpolld_72
  s_sleep 1
  s_branch Lpoll_71
Lpolld_72:
  v_and_b32 v78, 15, v77
  v_cmp_ne_u32 vcc, s55, v78
  s_lshl_b32 s40, s54, 4
  s_lshl_b32 s40, 0xffff, s40
  s_or_b32 s41, vcc_lo, vcc_hi
  s_and_b32 s40, s40, s41
  s_cselect_b32 s36, 0, 8192
  v_lshrrev_b32 v77, 8, v77
  v_and_b32 v78, 3, v0
  v_lshl_or_b32 v77, v77, 2, v78
  s_nop 1
  v_min_u32_dpp v77, v77, v77 row_ror:8 row_mask:0xf bank_mask:0xf
  s_nop 1
  v_min_u32_dpp v77, v77, v77 row_ror:4 row_mask:0xf bank_mask:0xf
  v_mov_b32 v78, v77
  s_nop 1
  v_permlane16_swap_b32 v78, v77
  v_min_u32 v77, v77, v78
  v_mov_b32 v78, v77
  s_nop 1
  v_permlane32_swap_b32 v78, v77
  v_min_u32 v77, v77, v78
  s_nop 1
  v_min_u32_dpp v77, v77, v77 row_ror:2 row_mask:0xf bank_mask:0xf
  s_nop 1
  v_min_u32_dpp v77, v77, v77 row_ror:1 row_mask:0xf bank_mask:0xf
  s_nop 0
  v_readfirstlane_b32 s26, v77
  s_and_b32 s26, s26, 3
  s_lshl_b32 s26, s26, 13
  s_lshr_b32 s40, s20, 1
  s_mul_i32 s40, s40, 32768
  s_and_b32 s41, s20, 1
  s_lshl_b32 s41, s41, 10
  s_add_u32 s40, s40, s41
  s_lshl_b32 s41, s54, 12
  s_add_u32 s40, s40, s41
  v_lshl_add_u32 v86, v0, 4, s40
  v_xor_b32 v87, 0x1000, v86
  v_and_b32 v76, 2, v0
  v_cmp_eq_u32 vcc, 0, v76
  v_mov_b32 v76, 0xeeee
  v_mov_b32 v77, 0x4444
  v_cndmask_b32 v88, v76, v77, vcc
  s_lshr_b32 s40, s21, 2
  s_mul_i32 s40, s40, 32768
  s_and_b32 s41, s21, 3
  s_lshl_b32 s41, s41, 11
  s_add_u32 s47, s40, s41
  s_lshl_b32 s41, s20, 9
  s_add_u32 s47, s47, s41
  v_lshl_add_u32 v92, v0, 3, s47
  s_lshl_b32 s41, s54, 12
  s_add_u32 s40, s41, 1310720
  s_add_u32 s40, s40, s26
  v_lshrrev_b32 v76, 2, v0
  v_lshl_add_u32 v76, v76, 7, s40
  v_and_b32 v77, 3, v0
  v_lshl_add_u32 v90, v77, 2, v76
  s_mov_b32 s57, s40
  s_cmp_eq_u32 s36, 0
  s_cselect_b32 s56, 1, s20
  s_and_b32 s41, s21, 15
  s_lshl_b32 s41, s41, 7
  s_lshl_b32 s40, s20, 2
  s_add_u32 s40, s40, s41
  s_add_u32 s40, s40, 0
  s_mov_b32 s25, 0
  s_mov_b32 s60, 0
  s_mov_b32 s61, 0
  s_mov_b32 s51, -1
  v_mov_b32 v91, 2147483392
  s_mov_b64 exec, 1
  v_mov_b32 v91, s40
  s_mov_b64 exec, -1
  v_mov_b32 v80, -1
  v_mov_b32 v81, -1
  v_mov_b32 v82, -1
  v_mov_b32 v83, -1
  s_mul_i32 s40, s20, 32768
  s_and_b32 s41, s50, 3
  s_lshl_b32 s41, s41, 10
  s_add_u32 s40, s40, s41
  v_lshl_add_u32 v110, v0, 4, s40
  v_xor_b32 v111, 0x400, v110
  v_xor_b32 v112, 0x800, v110
  v_xor_b32 v113, 0xc00, v110
  s_mul_i32 s58, s54, 131072
  s_and_b32 s41, s50, 4
  s_lshl_b32 s41, s41, 10
  s_add_u32 s58, s58, s41
  s_mul_i32 s40, s20, 512
  v_add_u32 v90, s40, v90
  s_lshl_b32 s40, s20, 10
  s_add_u32 s40, s40, 147456
  v_lshl_add_u32 v95, v0, 4, s40
  s_and_b32 s40, s20, 1
  s_lshl_b32 s40, s40, 3
  v_bfe_u32 v4, v0, 2, 3
  v_add_u32 v4, s40, v4
  s_lshr_b32 s40, s20, 1
  s_lshl_b32 s40, s40, 3
  v_and_b32 v5, 3, v0
  v_add_u32 v5, s40, v5
  v_bfe_u32 v76, v4, 1, 1
  v_lshl_add_u32 v5, v76, 2, v5
  v_lshrrev_b32 v76, 2, v4
  v_and_b32 v77, 1, v4
  v_lshl_add_u32 v78, v76, 4, v5
  v_lshlrev_b32 v78, 4, v78
  v_lshl_add_u32 v78, v77, 3, v78
  v_add_u32 v108, 147456, v78
  s_bfe_u32 s41, s21, 0x10002
  s_mul_i32 s41, s41, 32768
  s_lshr_b32 s40, s21, 3
  s_lshl_b32 s40, s40, 11
  s_add_u32 s40, s40, s41
  s_and_b32 s41, s21, 3
  s_lshl_b32 s41, s41, 9
  s_add_u32 s40, s40, s41
  s_lshl_b32 s41, s20, 7
  s_add_u32 s40, s40, s41
  v_lshl_add_u32 v109, v0, 2, s40
  s_mov_b32 exec_lo, 0
  v_mov_b32 v109, 2147483392
  s_mov_b64 exec, -1
  v_mov_b64 v[52:53], 0
  v_mov_b64 v[54:55], 0
  v_mov_b64 v[56:57], 0
  v_mov_b64 v[58:59], 0
  ds_read_b128 v[20:23], v85 offset:0
  ds_read_b128 v[24:27], v85 offset:1024
  ds_read_b128 v[28:31], v85 offset:8192
  ds_read_b128 v[32:35], v85 offset:9216
  ds_read_b128 v[36:39], v85 offset:2048
  ds_read_b128 v[40:43], v85 offset:3072
  ds_read_b128 v[44:47], v85 offset:10240
  ds_read_b128 v[48:51], v85 offset:11264
L_VO_top:
  s_and_b32 s40, s25, 3
  s_lshl_b32 s40, s40, 16
  s_add_u32 s27, s40, s26
  s_add_u32 s27, s27, 1048576
  s_xor_b32 s37, s27, s36
  s_lshl_b32 s40, s40, 2
  s_add_u32 s28, s40, s26
  s_lshr_b32 s40, s40, 5
  s_and_b32 s40, s40, 0x4000
  s_xor_b32 s28, s28, s40
  s_xor_b32 s29, s28, 0x4000
  s_sleep 4
L_VO_retry:
  buffer_load_dwordx4 v[4:7], v86, s[4:7], s37 offen offset:0 sc1
  s_nop 0
  buffer_load_dwordx4 v[8:11], v86, s[4:7], s37 offen offset:2048 sc1
  s_nop 0
  s_waitcnt vmcnt(1) lgkmcnt(0)
  v_smfmac_f32_16x16x64_bf16 v[52:55], v[4:7], v[128:135], v88
  ds_write_b128 v1, v[4:7] offset:0
  v_max3_u32 v89, v4, v5, v6
  v_smfmac_f32_16x16x64_bf16 v[56:59], v[4:7], v[20:27], v88
  v_max3_u32 v89, v6, v7, v89
  s_waitcnt vmcnt(0)
  ds_write_b128 v1, v[8:11] offset:1024
  v_max3_u32 v89, v8, v9, v89
  v_max3_u32 v89, v10, v11, v89
  v_cmp_eq_u32 vcc, -1, v89
  s_cbranch_vccnz L_VO_bad
  s_waitcnt lgkmcnt(0)
  s_barrier
  ds_read_b128 v[12:15], v2 offset:0
  ds_read_b128 v[16:19], v2 offset:1024
  v_smfmac_f32_16x16x64_bf16 v[52:55], v[8:11], v[136:143], v88
  buffer_load_dwordx4 v[68:71], v87, s[4:7], s27 offen offset:0 sc1
  buffer_load_dwordx4 v[72:75], v87, s[4:7], s27 offen offset:2048 sc1
  ds_read_b128 v[4:7], v3 offset:0
  v_smfmac_f32_16x16x64_bf16 v[56:59], v[8:11], v[28:35], v88
  ds_read_b128 v[20:23], v85 offset:4096
  ds_read_b128 v[24:27], v85 offset:5120
  s_waitcnt lgkmcnt(4)
  v_smfmac_f32_16x16x64_bf16 v[52:55], v[12:15], v[144:151], v88
  ds_read_b128 v[8:11], v3 offset:1024
  ds_read_b128 v[28:31], v85 offset:12288
  v_smfmac_f32_16x16x64_bf16 v[56:59], v[12:15], v[36:43], v88
  ds_read_b128 v[32:35], v85 offset:13312
  s_waitcnt lgkmcnt(6)
  v_smfmac_f32_16x16x64_bf16 v[52:55], v[16:19], v[152:159], v88
  ds_read_b128 v[12:15], v84 offset:0
  ds_read_b128 v[36:39], v85 offset:6144
  v_smfmac_f32_16x16x64_bf16 v[56:59], v[16:19], v[44:51], v88
  ds_read_b128 v[40:43], v85 offset:7168
  s_waitcnt lgkmcnt(6)
  v_smfmac_f32_16x16x64_bf16 v[52:55], v[4:7], v[160:167], v88
  ds_read_b128 v[16:19], v84 offset:1024
  ds_read_b128 v[44:47], v85 offset:14336
  v_smfmac_f32_16x16x64_bf16 v[56:59], v[4:7], v[20:27], v88
  ds_read_b128 v[48:51], v85 offset:15360
  s_waitcnt lgkmcnt(6)
  v_smfmac_f32_16x16x64_bf16 v[52:55], v[8:11], v[168:175], v88
  ds_read_b128 v[20:23], v85 offset:16384
  v_smfmac_f32_16x16x64_bf16 v[56:59], v[8:11], v[28:35], v88
  ds_read_b128 v[24:27], v85 offset:17408
  s_waitcnt lgkmcnt(5)
  v_smfmac_f32_16x16x64_bf16 v[52:55], v[12:15], v[176:183], v88
  ds_read_b128 v[28:31], v85 offset:24576
  v_smfmac_f32_16x16x64_bf16 v[56:59], v[12:15], v[36:43], v88
  ds_read_b128 v[32:35], v85 offset:25600
  s_waitcnt lgkmcnt(4)
L_VO_rchk:
  s_waitcnt vmcnt(0)
  ds_write_b128 v1, v[68:71] offset:2048
  ds_write_b128 v1, v[72:75] offset:3072
  v_max3_u32 v89, v68, v69, v70
  v_max3_u32 v89, v70, v71, v89
  v_max3_u32 v89, v72, v73, v89
  v_max3_u32 v89, v74, v75, v89
  v_cmp_eq_u32 vcc, -1, v89
  s_cbranch_vccnz L_VO_rbad
  v_smfmac_f32_16x16x64_bf16 v[52:55], v[16:19], v[184:191], v88
  ds_read_b128 v[36:39], v85 offset:18432
  v_smfmac_f32_16x16x64_bf16 v[56:59], v[16:19], v[44:51], v88
  ds_read_b128 v[40:43], v85 offset:19456
  s_waitcnt lgkmcnt(6)
  s_waitcnt lgkmcnt(2)
  s_barrier
  v_smfmac_f32_16x16x64_bf16 v[52:55], v[68:71], v[192:199], v88
  ds_read_b128 v[12:15], v2 offset:2048
  ds_read_b128 v[16:19], v2 offset:3072
  v_smfmac_f32_16x16x64_bf16 v[56:59], v[68:71], v[20:27], v88
  ds_read_b128 v[44:47], v85 offset:26624
  ds_read_b128 v[48:51], v85 offset:27648
  v_smfmac_f32_16x16x64_bf16 v[52:55], v[72:75], v[200:207], v88
  ds_read_b128 v[4:7], v3 offset:2048
  ds_read_b128 v[20:23], v85 offset:20480
  v_smfmac_f32_16x16x64_bf16 v[56:59], v[72:75], v[28:35], v88
  ds_read_b128 v[24:27], v85 offset:21504
  s_waitcnt lgkmcnt(6)
  v_smfmac_f32_16x16x64_bf16 v[52:55], v[12:15], v[208:215], v88
  ds_read_b128 v[8:11], v3 offset:3072
  ds_read_b128 v[28:31], v85 offset:28672
  v_smfmac_f32_16x16x64_bf16 v[56:59], v[12:15], v[36:43], v88
  ds_read_b128 v[32:35], v85 offset:29696
  s_waitcnt lgkmcnt(6)
  v_smfmac_f32_16x16x64_bf16 v[52:55], v[16:19], v[216:223], v88
  ds_read_b128 v[12:15], v84 offset:2048
  ds_read_b128 v[36:39], v85 offset:22528
  v_smfmac_f32_16x16x64_bf16 v[56:59], v[16:19], v[44:51], v88
  ds_read_b128 v[40:43], v85 offset:23552
  s_waitcnt lgkmcnt(6)
  v_smfmac_f32_16x16x64_bf16 v[52:55], v[4:7], v[224:231], v88
  ds_read_b128 v[16:19], v84 offset:3072
  ds_read_b128 v[44:47], v85 offset:30720
  v_smfmac_f32_16x16x64_bf16 v[56:59], v[4:7], v[20:27], v88
  ds_read_b128 v[48:51], v85 offset:31744
  s_waitcnt lgkmcnt(6)
  v_smfmac_f32_16x16x64_bf16 v[52:55], v[8:11], v[232:239], v88
  v_smfmac_f32_16x16x64_bf16 v[56:59], v[8:11], v[28:35], v88
  s_waitcnt lgkmcnt(3)
  v_smfmac_f32_16x16x64_bf16 v[52:55], v[12:15], v[240:247], v88
  v_smfmac_f32_16x16x64_bf16 v[56:59], v[12:15], v[36:43], v88
  s_waitcnt lgkmcnt(0)
  v_smfmac_f32_16x16x64_bf16 v[52:55], v[16:19], v[248:255], v88
  v_smfmac_f32_16x16x64_bf16 v[56:59], v[16:19], v[44:51], v88
  s_nop 6
  v_pk_add_f32 v[52:53], v[52:53], v[54:55]
  v_pk_add_f32 v[56:57], v[56:57], v[58:59]
  v_cvt_pk_bf16_f32 v100, v52, v53
  v_cvt_pk_bf16_f32 v101, v56, v57
  v_min_u32 v100, -2, v100
  v_min_u32 v101, -2, v101
  s_cmp_eq_u32 s36, 0
  s_cbranch_scc1 Lwt_73
  buffer_store_dwordx2 v[100:101], v92, s[4:7], s29 offen
  s_branch Lwtd_74
Lwt_73:
  buffer_store_dwordx2 v[100:101], v92, s[4:7], s29 offen sc1
Lwtd_74:
  s_cmp_ge_u32 s25, 63
  s_cbranch_scc1 L_VO_end
  s_add_u32 s42, s28, s58
  s_xor_b32 s30, s42, s36
  s_xor_b32 s31, s30, 4096
  s_xor_b32 s32, s42, 131072
  s_xor_b32 s48, s32, 4096
  s_add_u32 s41, s25, 1
  v_mov_b32 v94, s41
  s_and_b32 s41, s41, 3
  s_lshl_b32 s41, s41, 16
  s_add_u32 s33, s41, s26
  s_add_u32 s33, s33, 1048576
  s_xor_b32 s49, s33, 8192
  s_xor_b32 s34, s33, 0x20000
  s_xor_b32 s35, s29, 0x84000
  buffer_store_dword v80, v109, s[4:7], s34 offen sc1
  s_xor_b32 s40, s34, 8192
  buffer_store_dword v80, v109, s[4:7], s40 offen
  s_cmp_eq_u32 s36, 0
  s_cbranch_scc1 Lwt_75
  buffer_store_dwordx2 v[80:81], v92, s[4:7], s35 offen
  s_branch Lwtd_76
Lwt_75:
  buffer_store_dwordx2 v[80:81], v92, s[4:7], s35 offen sc1
Lwtd_76:
  v_mov_b64 v[60:61], 0
  v_mov_b64 v[62:63], 0
  v_mov_b64 v[64:65], 0
  v_mov_b64 v[66:67], 0
  v_mov_b64 v[52:53], 0
  v_mov_b64 v[54:55], 0
  v_mov_b64 v[56:57], 0
  v_mov_b64 v[58:59], 0
  ds_read_b128 v[20:23], v85 offset:0
  ds_read_b128 v[24:27], v85 offset:1024
  ds_read_b128 v[28:31], v85 offset:8192
  ds_read_b128 v[32:35], v85 offset:9216
  ds_read_b128 v[36:39], v85 offset:2048
  ds_read_b128 v[40:43], v85 offset:3072
  ds_read_b128 v[44:47], v85 offset:10240
  ds_read_b128 v[48:51], v85 offset:11264
  s_cmp_eq_u32 s36, 0
  s_cbranch_scc1 Ltrigd_78
  s_mov_b64 exec, 0xffff
  buffer_load_dword v76, v90, s[4:7], 0 offen offset:2048 sc1
  s_sleep 1
  buffer_load_dword v77, v90, s[4:7], 0 offen offset:2048 sc1
  s_sleep 1
  buffer_load_dword v78, v90, s[4:7], 0 offen offset:2048 sc1
  s_sleep 1
Ltrig_77:
  s_sub_u32 s24, s24, 1
  s_cbranch_scc1 L_FAIL
  buffer_load_dword v79, v90, s[4:7], 0 offen offset:2048 sc1
  s_waitcnt vmcnt(3)
  v_cmp_gt_i32 vcc, s25, v76
  s_cbranch_vccz Ltrigd_78
  buffer_load_dword v76, v90, s[4:7], 0 offen offset:2048 sc1
  s_waitcnt vmcnt(3)
  v_cmp_gt_i32 vcc, s25, v77
  s_cbranch_vccz Ltrigd_78
  buffer_load_dword v77, v90, s[4:7], 0 offen offset:2048 sc1
  s_waitcnt vmcnt(3)
  v_cmp_gt_i32 vcc, s25, v78
  s_cbranch_vccz Ltrigd_78
  buffer_load_dword v78, v90, s[4:7], 0 offen offset:2048 sc1
  s_waitcnt vmcnt(3)
  v_cmp_gt_i32 vcc, s25, v79
  s_cbranch_vccnz Ltrig_77
Ltrigd_78:
  s_mov_b64 exec, -1
L_VOO_again:
  buffer_load_dwordx4 v[4:7], v110, s[4:7], s30 offen sc1
  s_nop 0
  buffer_load_dwordx4 v[8:11], v111, s[4:7], s30 offen sc1
  s_nop 0
  buffer_load_dwordx4 v[12:15], v112, s[4:7], s30 offen sc1
  s_nop 0
  buffer_load_dwordx4 v[16:19], v113, s[4:7], s30 offen sc1
  s_nop 0
  buffer_load_dwordx4 v[68:71], v110, s[4:7], s31 offen sc1
  s_nop 0
  s_waitcnt vmcnt(4)
  v_cmp_eq_u32 vcc, -1, v4
  s_cbranch_vccnz L_VOO_g0
L_VOO_ok0:
  buffer_load_dwordx4 v[72:75], v111, s[4:7], s31 offen sc1
  buffer_load_dwordx4 v[96:99], v112, s[4:7], s31 offen sc1
  v_smfmac_f32_16x16x64_bf16 v[60:63], v[4:7], a[0:7], v88
  s_waitcnt vmcnt(5)
  v_cmp_eq_u32 vcc, -1, v8
  v_smfmac_f32_16x16x64_bf16 v[64:67], v[4:7], a[8:15], v88
  s_cbranch_vccnz L_VOO_g1
L_VOO_ok1:
  buffer_load_dwordx4 v[4:7], v113, s[4:7], s31 offen sc1
  v_smfmac_f32_16x16x64_bf16 v[60:63], v[8:11], a[16:23], v88
  s_waitcnt vmcnt(5)
  v_cmp_eq_u32 vcc, -1, v12
  v_smfmac_f32_16x16x64_bf16 v[64:67], v[8:11], a[24:31], v88
  s_cbranch_vccnz L_VOO_g2
L_VOO_ok2:
  buffer_load_dwordx4 v[8:11], v110, s[4:7], s32 offen sc1
  v_smfmac_f32_16x16x64_bf16 v[60:63], v[12:15], a[32:39], v88
  s_waitcnt vmcnt(5)
  v_cmp_eq_u32 vcc, -1, v16
  v_smfmac_f32_16x16x64_bf16 v[64:67], v[12:15], a[40:47], v88
  s_cbranch_vccnz L_VOO_g3
L_VOO_ok3:
  buffer_load_dwordx4 v[12:15], v111, s[4:7], s32 offen sc1
  v_smfmac_f32_16x16x64_bf16 v[60:63], v[16:19], a[48:55], v88
  s_waitcnt vmcnt(5)
  v_cmp_eq_u32 vcc, -1, v68
  v_smfmac_f32_16x16x64_bf16 v[64:67], v[16:19], a[56:63], v88
  s_cbranch_vccnz L_VOO_g4
L_VOO_ok4:
  buffer_load_dwordx4 v[16:19], v112, s[4:7], s32 offen sc1
  v_smfmac_f32_16x16x64_bf16 v[60:63], v[68:71], a[64:71], v88
  s_waitcnt vmcnt(5)
  v_cmp_eq_u32 vcc, -1, v72
  v_smfmac_f32_16x16x64_bf16 v[64:67], v[68:71], a[72:79], v88
  s_cbranch_vccnz L_VOO_g5
L_VOO_ok5:
  buffer_load_dwordx4 v[68:71], v113, s[4:7], s32 offen sc1
  v_smfmac_f32_16x16x64_bf16 v[60:63], v[72:75], a[80:87], v88
  s_waitcnt vmcnt(5)
  v_cmp_eq_u32 vcc, -1, v96
  v_smfmac_f32_16x16x64_bf16 v[64:67], v[72:75], a[88:95], v88
  s_cbranch_vccnz L_VOO_g6
L_VOO_ok6:
  buffer_load_dwordx4 v[72:75], v110, s[4:7], s48 offen sc1
  v_smfmac_f32_16x16x64_bf16 v[60:63], v[96:99], a[96:103], v88
  s_waitcnt vmcnt(5)
  v_cmp_eq_u32 vcc, -1, v4
  v_smfmac_f32_16x16x64_bf16 v[64:67], v[96:99], a[104:111], v88
  s_cbranch_vccnz L_VOO_g7
L_VOO_ok7:
  buffer_load_dwordx4 v[96:99], v111, s[4:7], s48 offen sc1
  v_smfmac_f32_16x16x64_bf16 v[60:63], v[4:7], a[112:119], v88
  s_waitcnt vmcnt(5)
  v_cmp_eq_u32 vcc, -1, v8
  v_smfmac_f32_16x16x64_bf16 v[64:67], v[4:7], a[120:127], v88
  s_cbranch_vccnz L_VOO_g8
L_VOO_ok8:
  buffer_load_dwordx4 v[4:7], v112, s[4:7], s48 offen sc1
  v_smfmac_f32_16x16x64_bf16 v[60:63], v[8:11], a[128:135], v88
  s_waitcnt vmcnt(5)
  v_cmp_eq_u32 vcc, -1, v12
  v_smfmac_f32_16x16x64_bf16 v[64:67], v[8:11], a[136:143], v88
  s_cbranch_vccnz L_VOO_g9
L_VOO_ok9:
  buffer_load_dwordx4 v[8:11], v113, s[4:7], s48 offen sc1
  v_smfmac_f32_16x16x64_bf16 v[60:63], v[12:15], a[144:151], v88
  s_waitcnt vmcnt(5)
  v_cmp_eq_u32 vcc, -1, v16
  v_smfmac_f32_16x16x64_bf16 v[64:67], v[12:15], a[152:159], v88
  s_cbranch_vccnz L_VOO_g10
L_VOO_ok10:
  v_smfmac_f32_16x16x64_bf16 v[60:63], v[16:19], a[160:167], v88
  s_waitcnt vmcnt(4)
  v_cmp_eq_u32 vcc, -1, v68
  v_smfmac_f32_16x16x64_bf16 v[64:67], v[16:19], a[168:175], v88
  s_cbranch_vccnz L_VOO_g11
L_VOO_ok11:
  v_smfmac_f32_16x16x64_bf16 v[60:63], v[68:71], a[176:183], v88
  s_waitcnt vmcnt(3)
  v_cmp_eq_u32 vcc, -1, v72
  v_smfmac_f32_16x16x64_bf16 v[64:67], v[68:71], a[184:191], v88
  s_cbranch_vccnz L_VOO_g12
L_VOO_ok12:
  v_smfmac_f32_16x16x64_bf16 v[60:63], v[72:75], a[192:199], v88
  s_waitcnt vmcnt(2)
  v_cmp_eq_u32 vcc, -1, v96
  v_smfmac_f32_16x16x64_bf16 v[64:67], v[72:75], a[200:207], v88
  s_cbranch_vccnz L_VOO_g13
L_VOO_ok13:
  v_smfmac_f32_16x16x64_bf16 v[60:63], v[96:99], a[208:215], v88
  s_waitcnt vmcnt(1)
  v_cmp_eq_u32 vcc, -1, v4
  v_smfmac_f32_16x16x64_bf16 v[64:67], v[96:99], a[216:223], v88
  s_cbranch_vccnz L_VOO_g14
L_VOO_ok14:
  v_smfmac_f32_16x16x64_bf16 v[60:63], v[4:7], a[224:231], v88
  s_waitcnt vmcnt(0)
  v_cmp_eq_u32 vcc, -1, v8
  v_smfmac_f32_16x16x64_bf16 v[64:67], v[4:7], a[232:239], v88
  s_cbranch_vccnz L_VOO_g15
L_VOO_ok15:
  v_smfmac_f32_16x16x64_bf16 v[60:63], v[8:11], a[240:247], v88
  v_smfmac_f32_16x16x64_bf16 v[64:67], v[8:11], a[248:255], v88
  s_nop 6
  v_add_f32 v100, v60, v62
  v_add_f32 v102, v61, v63
  v_add_f32 v101, v64, v66
  v_add_f32 v103, v65, v67
  ds_write_b128 v95, v[100:103]
  v_cmp_u_f32 vcc, v100, v102
  s_cbranch_vccnz L_VOO_nan
L_VOO_done:
  s_waitcnt lgkmcnt(0)
  s_barrier
  ds_read2st64_b64 v[100:103], v108 offset0:0 offset1:2
  ds_read2st64_b64 v[104:107], v108 offset0:4 offset1:6
  buffer_store_dword v94, v91, s[4:7], s57 offen
  s_waitcnt lgkmcnt(1)
  v_pk_add_f32 v[100:101], v[100:101], v[102:103]
  s_waitcnt lgkmcnt(0)
  v_pk_add_f32 v[104:105], v[104:105], v[106:107]
  v_pk_add_f32 v[100:101], v[100:101], v[104:105]
  v_cvt_pk_bf16_f32 v100, v100, v101
  v_min_u32 v100, -2, v100
  buffer_store_dword v100, v109, s[4:7], s49 offen
  buffer_store_dword v100, v109, s[4:7], s33 offen sc1
  s_add_u32 s25, s25, 1
  s_branch L_VO_top
L_VO_end:
  s_branch L_END
L_VO_bad:
  s_nop 7
  s_sub_u32 s24, s24, 1
  s_cbranch_scc1 L_FAIL
  s_add_u32 s60, s60, 1
  v_mov_b64 v[52:53], 0
  v_mov_b64 v[54:55], 0
  v_mov_b64 v[56:57], 0
  v_mov_b64 v[58:59], 0
  s_nop 1
  s_branch L_VO_retry
L_VO_rbad:
  s_sub_u32 s24, s24, 1
  s_cbranch_scc1 L_FAIL
  s_add_u32 s60, s60, 0x10000
  s_waitcnt lgkmcnt(0)
  buffer_load_dwordx4 v[68:71], v87, s[4:7], s27 offen offset:0 sc1
  buffer_load_dwordx4 v[72:75], v87, s[4:7], s27 offen offset:2048 sc1
  s_branch L_VO_rchk
L_VOO_nan:
  s_cmp_eq_u32 s51, s25
  s_cbranch_scc1 L_VOO_done
  s_mov_b32 s51, s25
  s_add_u32 s61, s61, 0x10000
  s_waitcnt vmcnt(0) lgkmcnt(0)
L_VOO_v0:
  s_sub_u32 s24, s24, 1
  s_cbranch_scc1 L_FAIL
  buffer_load_dwordx4 v[4:7], v110, s[4:7], s30 offen sc1
  buffer_load_dwordx4 v[8:11], v111, s[4:7], s30 offen sc1
  buffer_load_dwordx4 v[12:15], v112, s[4:7], s30 offen sc1
  buffer_load_dwordx4 v[16:19], v113, s[4:7], s30 offen sc1
  v_mov_b32 v89, 0
  s_waitcnt vmcnt(0)
  v_max3_u32 v89, v4, v5, v89
  v_max3_u32 v89, v6, v7, v89
  v_max3_u32 v89, v8, v9, v89
  v_max3_u32 v89, v10, v11, v89
  v_max3_u32 v89, v12, v13, v89
  v_max3_u32 v89, v14, v15, v89
  v_max3_u32 v89, v16, v17, v89
  v_max3_u32 v89, v18, v19, v89
  v_cmp_eq_u32 vcc, -1, v89
  s_cbranch_vccnz L_VOO_v0
L_VOO_v4:
  s_sub_u32 s24, s24, 1
  s_cbranch_scc1 L_FAIL
  buffer_load_dwordx4 v[68:71], v110, s[4:7], s31 offen sc1
  buffer_load_dwordx4 v[72:75], v111, s[4:7], s31 offen sc1
  buffer_load_dwordx4 v[96:99], v112, s[4:7], s31 offen sc1
  buffer_load_dwordx4 v[4:7], v113, s[4:7], s31 offen sc1
  v_mov_b32 v89, 0
  s_waitcnt vmcnt(0)
  v_max3_u32 v89, v68, v69, v89
  v_max3_u32 v89, v70, v71, v89
  v_max3_u32 v89, v72, v73, v89
  v_max3_u32 v89, v74, v75, v89
  v_max3_u32 v89, v96, v97, v89
  v_max3_u32 v89, v98, v99, v89
  v_max3_u32 v89, v4, v5, v89
  v_max3_u32 v89, v6, v7, v89
  v_cmp_eq_u32 vcc, -1, v89
  s_cbranch_vccnz L_VOO_v4
L_VOO_v8:
  s_sub_u32 s24, s24, 1
  s_cbranch_scc1 L_FAIL
  buffer_load_dwordx4 v[8:11], v110, s[4:7], s32 offen sc1
  buffer_load_dwordx4 v[12:15], v111, s[4:7], s32 offen sc1
  buffer_load_dwordx4 v[16:19], v112, s[4:7], s32 offen sc1
  buffer_load_dwordx4 v[68:71], v113, s[4:7], s32 offen sc1
  v_mov_b32 v89, 0
  s_waitcnt vmcnt(0)
  v_max3_u32 v89, v8, v9, v89
  v_max3_u32 v89, v10, v11, v89
  v_max3_u32 v89, v12, v13, v89
  v_max3_u32 v89, v14, v15, v89
  v_max3_u32 v89, v16, v17, v89
  v_max3_u32 v89, v18, v19, v89
  v_max3_u32 v89, v68, v69, v89
  v_max3_u32 v89, v70, v71, v89
  v_cmp_eq_u32 vcc, -1, v89
  s_cbranch_vccnz L_VOO_v8
L_VOO_v12:
  s_sub_u32 s24, s24, 1
  s_cbranch_scc1 L_FAIL
  buffer_load_dwordx4 v[72:75], v110, s[4:7], s48 offen sc1
  buffer_load_dwordx4 v[96:99], v111, s[4:7], s48 offen sc1
  buffer_load_dwordx4 v[4:7], v112, s[4:7], s48 offen sc1
  buffer_load_dwordx4 v[8:11], v113, s[4:7], s48 offen sc1
  v_mov_b32 v89, 0
  s_waitcnt vmcnt(0)
  v_max3_u32 v89, v72, v73, v89
  v_max3_u32 v89, v74, v75, v89
  v_max3_u32 v89, v96, v97, v89
  v_max3_u32 v89, v98, v99, v89
  v_max3_u32 v89, v4, v5, v89
  v_max3_u32 v89, v6, v7, v89
  v_max3_u32 v89, v8, v9, v89
  v_max3_u32 v89, v10, v11, v89
  v_cmp_eq_u32 vcc, -1, v89
  s_cbranch_vccnz L_VOO_v12
  v_mov_b64 v[60:61], 0
  v_mov_b64 v[62:63], 0
  v_mov_b64 v[64:65], 0
  v_mov_b64 v[66:67], 0
  s_nop 1
  s_branch L_VOO_again
L_VOO_g0:
  s_sub_u32 s24, s24, 1
  s_cbranch_scc1 L_FAIL
  s_add_u32 s61, s61, 1
  buffer_load_dwordx4 v[4:7], v110, s[4:7], s30 offen sc1
  s_waitcnt vmcnt(0)
  v_cmp_eq_u32 vcc, -1, v4
  s_cbranch_vccnz L_VOO_g0
  v_mov_b32 v89, 0
  v_max3_u32 v89, v8, v12, v89
  v_max3_u32 v89, v16, v68, v89
  v_cmp_eq_u32 vcc, -1, v89
  s_cbranch_vccz L_VOO_ok0
  buffer_load_dwordx4 v[8:11], v111, s[4:7], s30 offen sc1
  s_nop 0
  buffer_load_dwordx4 v[12:15], v112, s[4:7], s30 offen sc1
  s_nop 0
  buffer_load_dwordx4 v[16:19], v113, s[4:7], s30 offen sc1
  s_nop 0
  buffer_load_dwordx4 v[68:71], v110, s[4:7], s31 offen sc1
  s_nop 0
  s_branch L_VOO_ok0
L_VOO_g1:
  s_sub_u32 s24, s24, 1
  s_cbranch_scc1 L_FAIL
  s_add_u32 s61, s61, 1
  buffer_load_dwordx4 v[8:11], v111, s[4:7], s30 offen sc1
  s_waitcnt vmcnt(0)
  v_cmp_eq_u32 vcc, -1, v8
  s_cbranch_vccnz L_VOO_g1
  v_mov_b32 v89, 0
  v_max3_u32 v89, v12, v16, v89
  v_max3_u32 v89, v68, v72, v89
  v_max3_u32 v89, v96, v96, v89
  v_cmp_eq_u32 vcc, -1, v89
  s_cbranch_vccz L_VOO_ok1
  buffer_load_dwordx4 v[12:15], v112, s[4:7], s30 offen sc1
  s_nop 0
  buffer_load_dwordx4 v[16:19], v113, s[4:7], s30 offen sc1
  s_nop 0
  buffer_load_dwordx4 v[68:71], v110, s[4:7], s31 offen sc1
  s_nop 0
  buffer_load_dwordx4 v[72:75], v111, s[4:7], s31 offen sc1
  s_nop 0
  buffer_load_dwordx4 v[96:99], v112, s[4:7], s31 offen sc1
  s_nop 0
  s_branch L_VOO_ok1
L_VOO_g2:
  s_sub_u32 s24, s24, 1
  s_cbranch_scc1 L_FAIL
  s_add_u32 s61, s61, 1
  buffer_load_dwordx4 v[12:15], v112, s[4:7], s30 offen sc1
  s_waitcnt vmcnt(0)
  v_cmp_eq_u32 vcc, -1, v12
  s_cbranch_vccnz L_VOO_g2
  v_mov_b32 v89, 0
  v_max3_u32 v89, v16, v68, v89
  v_max3_u32 v89, v72, v96, v89
  v_max3_u32 v89, v4, v4, v89
  v_cmp_eq_u32 vcc, -1, v89
  s_cbranch_vccz L_VOO_ok2
  buffer_load_dwordx4 v[16:19], v113, s[4:7], s30 offen sc1
  s_nop 0
  buffer_load_dwordx4 v[68:71], v110, s[4:7], s31 offen sc1
  s_nop 0
  buffer_load_dwordx4 v[72:75], v111, s[4:7], s31 offen sc1
  s_nop 0
  buffer_load_dwordx4 v[96:99], v112, s[4:7], s31 offen sc1
  s_nop 0
  buffer_load_dwordx4 v[4:7], v113, s[4:7], s31 offen sc1
  s_nop 0
  s_branch L_VOO_ok2
L_VOO_g3:
  s_sub_u32 s24, s24, 1
  s_cbranch_scc1 L_FAIL
  s_add_u32 s61, s61, 1
  buffer_load_dwordx4 v[16:19], v113, s[4:7], s30 offen sc1
  s_waitcnt vmcnt(0)
  v_cmp_eq_u32 vcc, -1, v16
  s_cbranch_vccnz L_VOO_g3
  v_mov_b32 v89, 0
  v_max3_u32 v89, v68, v72, v89
  v_max3_u32 v89, v96, v4, v89
  v_max3_u32 v89, v8, v8, v89
  v_cmp_eq_u32 vcc, -1, v89
  s_cbranch_vccz L_VOO_ok3
  buffer_load_dwordx4 v[68:71], v110, s[4:7], s31 offen sc1
  s_nop 0
  buffer_load_dwordx4 v[72:75], v111, s[4:7], s31 offen sc1
  s_nop 0
  buffer_load_dwordx4 v[96:99], v112, s[4:7], s31 offen sc1
  s_nop 0
  buffer_load_dwordx4 v[4:7], v113, s[4:7], s31 offen sc1
  s_nop 0
  buffer_load_dwordx4 v[8:11], v110, s[4:7], s32 offen sc1
  s_nop 0
  s_branch L_VOO_ok3
L_VOO_g4:
  s_sub_u32 s24, s24, 1
  s_cbranch_scc1 L_FAIL
  s_add_u32 s61, s61, 1
  buffer_load_dwordx4 v[68:71], v110, s[4:7], s31 offen sc1
  s_waitcnt vmcnt(0)
  v_cmp_eq_u32 vcc, -1, v68
  s_cbranch_vccnz L_VOO_g4
  v_mov_b32 v89, 0
  v_max3_u32 v89, v72, v96, v89
  v_max3_u32 v89, v4, v8, v89
  v_max3_u32 v89, v12, v12, v89
  v_cmp_eq_u32 vcc, -1, v89
  s_cbranch_vccz L_VOO_ok4
  buffer_load_dwordx4 v[72:75], v111, s[4:7], s31 offen sc1
  s_nop 0
  buffer_load_dwordx4 v[96:99], v112, s[4:7], s31 offen sc1
  s_nop 0
  buffer_load_dwordx4 v[4:7], v113, s[4:7], s31 offen sc1
  s_nop 0
  buffer_load_dwordx4 v[8:11], v110, s[4:7], s32 offen sc1
  s_nop 0
  buffer_load_dwordx4 v[12:15], v111, s[4:7], s32 offen sc1
  s_nop 0
  s_branch L_VOO_ok4
L_VOO_g5:
  s_sub_u32 s24, s24, 1
  s_cbranch_scc1 L_FAIL
  s_add_u32 s61, s61, 1
  buffer_load_dwordx4 v[72:75], v111, s[4:7], s31 offen sc1
  s_waitcnt vmcnt(0)
  v_cmp_eq_u32 vcc, -1, v72
  s_cbranch_vccnz L_VOO_g5
  v_mov_b32 v89, 0
  v_max3_u32 v89, v96, v4, v89
  v_max3_u32 v89, v8, v12, v89
  v_max3_u32 v89, v16, v16, v89
  v_cmp_eq_u32 vcc, -1, v89
  s_cbranch_vccz L_VOO_ok5
  buffer_load_dwordx4 v[96:99], v112, s[4:7], s31 offen sc1
  s_nop 0
  buffer_load_dwordx4 v[4:7], v113, s[4:7], s31 offen sc1
  s_nop 0
  buffer_load_dwordx4 v[8:11], v110, s[4:7], s32 offen sc1
  s_nop 0
  buffer_load_dwordx4 v[12:15], v111, s[4:7], s32 offen sc1
  s_nop 0
  buffer_load_dwordx4 v[16:19], v112, s[4:7], s32 offen sc1
  s_nop 0
  s_branch L_VOO_ok5
L_VOO_g6:
  s_sub_u32 s24, s24, 1
  s_cbranch_scc1 L_FAIL
  s_add_u32 s61, s61, 1
  buffer_load_dwordx4 v[96:99], v112, s[4:7], s31 offen sc1
  s_waitcnt vmcnt(0)
  v_cmp_eq_u32 vcc, -1, v96
  s_cbranch_vccnz L_VOO_g6
  v_mov_b32 v89, 0
  v_max3_u32 v89, v4, v8, v89
  v_max3_u32 v89, v12, v16, v89
  v_max3_u32 v89, v68, v68, v89
  v_cmp_eq_u32 vcc, -1, v89
  s_cbranch_vccz L_VOO_ok6
  buffer_load_dwordx4 v[4:7], v113, s[4:7], s31 offen sc1
  s_nop 0
  buffer_load_dwordx4 v[8:11], v110, s[4:7], s32 offen sc1
  s_nop 0
  buffer_load_dwordx4 v[12:15], v111, s[4:7], s32 offen sc1
  s_nop 0
  buffer_load_dwordx4 v[16:19], v112, s[4:7], s32 offen sc1
  s_nop 0
  buffer_load_dwordx4 v[68:71], v113, s[4:7], s32 offen sc1
  s_nop 0
  s_branch L_VOO_ok6
L_VOO_g7:
  s_sub_u32 s24, s24, 1
  s_cbranch_scc1 L_FAIL
  s_add_u32 s61, s61, 1
  buffer_load_dwordx4 v[4:7], v113, s[4:7], s31 offen sc1
  s_waitcnt vmcnt(0)
  v_cmp_eq_u32 vcc, -1, v4
  s_cbranch_vccnz L_VOO_g7
  v_mov_b32 v89, 0
  v_max3_u32 v89, v8, v12, v89
  v_max3_u32 v89, v16, v68, v89
  v_max3_u32 v89, v72, v72, v89
  v_cmp_eq_u32 vcc, -1, v89
  s_cbranch_vccz L_VOO_ok7
  buffer_load_dwordx4 v[8:11], v110, s[4:7], s32 offen sc1
  s_nop 0
  buffer_load_dwordx4 v[12:15], v111, s[4:7], s32 offen sc1
  s_nop 0
  buffer_load_dwordx4 v[16:19], v112, s[4:7], s32 offen sc1
  s_nop 0
  buffer_load_dwordx4 v[68:71], v113, s[4:7], s32 offen sc1
  s_nop 0
  buffer_load_dwordx4 v[72:75], v110, s[4:7], s48 offen sc1
  s_nop 0
  s_branch L_VOO_ok7
L_VOO_g8:
  s_sub_u32 s24, s24, 1
  s_cbranch_scc1 L_FAIL
  s_add_u32 s61, s61, 256
  buffer_load_dwordx4 v[8:11], v110, s[4:7], s32 offen sc1
  s_waitcnt vmcnt(0)
  v_cmp_eq_u32 vcc, -1, v8
  s_cbranch_vccnz L_VOO_g8
  v_mov_b32 v89, 0
  v_max3_u32 v89, v12, v16, v89
  v_max3_u32 v89, v68, v72, v89
  v_max3_u32 v89, v96, v96, v89
  v_cmp_eq_u32 vcc, -1, v89
  s_cbranch_vccz L_VOO_ok8
  buffer_load_dwordx4 v[12:15], v111, s[4:7], s32 offen sc1
  s_nop 0
  buffer_load_dwordx4 v[16:19], v112, s[4:7], s32 offen sc1
  s_nop 0
  buffer_load_dwordx4 v[68:71], v113, s[4:7], s32 offen sc1
  s_nop 0
  buffer_load_dwordx4 v[72:75], v110, s[4:7], s48 offen sc1
  s_nop 0
  buffer_load_dwordx4 v[96:99], v111, s[4:7], s48 offen sc1
  s_nop 0
  s_branch L_VOO_ok8
L_VOO_g9:
  s_sub_u32 s24, s24, 1
  s_cbranch_scc1 L_FAIL
  s_add_u32 s61, s61, 256
  buffer_load_dwordx4 v[12:15], v111, s[4:7], s32 offen sc1
  s_waitcnt vmcnt(0)
  v_cmp_eq_u32 vcc, -1, v12
  s_cbranch_vccnz L_VOO_g9
  v_mov_b32 v89, 0
  v_max3_u32 v89, v16, v68, v89
  v_max3_u32 v89, v72, v96, v89
  v_max3_u32 v89, v4, v4, v89
  v_cmp_eq_u32 vcc, -1, v89
  s_cbranch_vccz L_VOO_ok9
  buffer_load_dwordx4 v[16:19], v112, s[4:7], s32 offen sc1
  s_nop 0
  buffer_load_dwordx4 v[68:71], v113, s[4:7], s32 offen sc1
  s_nop 0
  buffer_load_dwordx4 v[72:75], v110, s[4:7], s48 offen sc1
  s_nop 0
  buffer_load_dwordx4 v[96:99], v111, s[4:7], s48 offen sc1
  s_nop 0
  buffer_load_dwordx4 v[4:7], v112, s[4:7], s48 offen sc1
  s_nop 0
  s_branch L_VOO_ok9
L_VOO_g10:
  s_sub_u32 s24, s24, 1
  s_cbranch_scc1 L_FAIL
  s_add_u32 s61, s61, 256
  buffer_load_dwordx4 v[16:19], v112, s[4:7], s32 offen sc1
  s_waitcnt vmcnt(0)
  v_cmp_eq_u32 vcc, -1, v16
  s_cbranch_vccnz L_VOO_g10
  v_mov_b32 v89, 0
  v_max3_u32 v89, v68, v72, v89
  v_max3_u32 v89, v96, v4, v89
  v_max3_u32 v89, v8, v8, v89
  v_cmp_eq_u32 vcc, -1, v89
  s_cbranch_vccz L_VOO_ok10
  buffer_load_dwordx4 v[68:71], v113, s[4:7], s32 offen sc1
  s_nop 0
  buffer_load_dwordx4 v[72:75], v110, s[4:7], s48 offen sc1
  s_nop 0
  buffer_load_dwordx4 v[96:99], v111, s[4:7], s48 offen sc1
  s_nop 0
  buffer_load_dwordx4 v[4:7], v112, s[4:7], s48 offen sc1
  s_nop 0
  buffer_load_dwordx4 v[8:11], v113, s[4:7], s48 offen sc1
  s_nop 0
  s_branch L_VOO_ok10
L_VOO_g11:
  s_sub_u32 s24, s24, 1
  s_cbranch_scc1 L_FAIL
  s_add_u32 s61, s61, 256
  buffer_load_dwordx4 v[68:71], v113, s[4:7], s32 offen sc1
  s_waitcnt vmcnt(0)
  v_cmp_eq_u32 vcc, -1, v68
  s_cbranch_vccnz L_VOO_g11
  v_mov_b32 v89, 0
  v_max3_u32 v89, v72, v96, v89
  v_max3_u32 v89, v4, v8, v89
  v_cmp_eq_u32 vcc, -1, v89
  s_cbranch_vccz L_VOO_ok11
  buffer_load_dwordx4 v[72:75], v110, s[4:7], s48 offen sc1
  s_nop 0
  buffer_load_dwordx4 v[96:99], v111, s[4:7], s48 offen sc1
  s_nop 0
  buffer_load_dwordx4 v[4:7], v112, s[4:7], s48 offen sc1
  s_nop 0
  buffer_load_dwordx4 v[8:11], v113, s[4:7], s48 offen sc1
  s_nop 0
  s_branch L_VOO_ok11
L_VOO_g12:
  s_sub_u32 s24, s24, 1
  s_cbranch_scc1 L_FAIL
  s_add_u32 s61, s61, 256
  buffer_load_dwordx4 v[72:75], v110, s[4:7], s48 offen sc1
  s_waitcnt vmcnt(0)
  v_cmp_eq_u32 vcc, -1, v72
  s_cbranch_vccnz L_VOO_g12
  v_mov_b32 v89, 0
  v_max3_u32 v89, v96, v4, v89
  v_max3_u32 v89, v8, v8, v89
  v_cmp_eq_u32 vcc, -1, v89
  s_cbranch_vccz L_VOO_ok12
  buffer_load_dwordx4 v[96:99], v111, s[4:7], s48 offen sc1
  s_nop 0
  buffer_load_dwordx4 v[4:7], v112, s[4:7], s48 offen sc1
  s_nop 0
  buffer_load_dwordx4 v[8:11], v113, s[4:7], s48 offen sc1
  s_nop 0
  s_branch L_VOO_ok12
L_VOO_g13:
  s_sub_u32 s24, s24, 1
  s_cbranch_scc1 L_FAIL
  s_add_u32 s61, s61, 256
  buffer_load_dwordx4 v[96:99], v111, s[4:7], s48 offen sc1
  s_waitcnt vmcnt(0)
  v_cmp_eq_u32 vcc, -1, v96
  s_cbranch_vccnz L_VOO_g13
  v_mov_b32 v89, 0
  v_max3_u32 v89, v4, v8, v89
  v_cmp_eq_u32 vcc, -1, v89
  s_cbranch_vccz L_VOO_ok13
  buffer_load_dwordx4 v[4:7], v112, s[4:7], s48 offen sc1
  s_nop 0
  buffer_load_dwordx4 v[8:11], v113, s[4:7], s48 offen sc1
  s_nop 0
  s_branch L_VOO_ok13
L_VOO_g14:
  s_sub_u32 s24, s24, 1
  s_cbranch_scc1 L_FAIL
  s_add_u32 s61, s61, 256
  buffer_load_dwordx4 v[4:7], v112, s[4:7], s48 offen sc1
  s_waitcnt vmcnt(0)
  v_cmp_eq_u32 vcc, -1, v4
  s_cbranch_vccnz L_VOO_g14
  v_mov_b32 v89, 0
  v_max3_u32 v89, v8, v8, v89
  v_cmp_eq_u32 vcc, -1, v89
  s_cbranch_vccz L_VOO_ok14
  buffer_load_dwordx4 v[8:11], v113, s[4:7], s48 offen sc1
  s_nop 0
  s_branch L_VOO_ok14
L_VOO_g15:
  s_sub_u32 s24, s24, 1
  s_cbranch_scc1 L_FAIL
  s_add_u32 s61, s61, 256
  buffer_load_dwordx4 v[8:11], v113, s[4:7], s48 offen sc1
  s_waitcnt vmcnt(0)
  v_cmp_eq_u32 vcc, -1, v8
  s_cbranch_vccnz L_VOO_g15
  s_branch L_VOO_ok15
.section .rodata,"a"
.p2align 6
.amdhsa_kernel adaLN_cond__memory_aug_recurrent_mem_tr__glu_gated_swiglu__prompt_kernel
  .amdhsa_next_free_vgpr 512
  .amdhsa_next_free_sgpr 102
  .amdhsa_accum_offset 256
  .amdhsa_group_segment_fixed_size 0
  .amdhsa_kernarg_size 128
  .amdhsa_user_sgpr_count 2
  .amdhsa_user_sgpr_kernarg_segment_ptr 1
  .amdhsa_system_sgpr_workgroup_id_x 1
  .amdhsa_float_denorm_mode_32 3
.end_amdhsa_kernel
```

```asm
; @launch grid=(256,1,1) block=(256,1,1) lds=163840
.amdgcn_target "amdgcn-amd-amdhsa--gfx950"
.text
.globl adaLN_cond__memory_aug_recurrent_mem_tr__glu_gated_swiglu__prompt_kernel
.p2align 8
.type adaLN_cond__memory_aug_recurrent_mem_tr__glu_gated_swiglu__prompt_kernel,@function
adaLN_cond__memory_aug_recurrent_mem_tr__glu_gated_swiglu__prompt_kernel:
  s_cmp_ge_u32 s2, 256
  s_cbranch_scc1 L_END
  s_load_dwordx2 s[4:5], s[0:1], 120
  s_load_dwordx2 s[12:13], s[0:1], 112
  v_lshrrev_b32 v1, 6, v0
  v_and_b32 v0, 63, v0
  v_readfirstlane_b32 s20, v1
  s_mov_b32 s6, 155222016
  s_mov_b32 s7, 0x20000
  s_mov_b32 s14, 256
  s_mov_b32 s15, 0x20000
  s_mov_b32 s24, 300000
  s_and_b32 s40, s2, 7
  s_mov_b32 s42, 0x3020100
  s_mov_b32 s43, 0x3020100
  s_cmp_eq_u32 s40, 1
  s_cselect_b32 s42, 0x1b161514, s42
  s_cselect_b32 s43, 0x1b1a1918, s43
  s_cmp_eq_u32 s40, 2
  s_cselect_b32 s42, 0xb0a0908, s42
  s_cselect_b32 s43, 0xb0a0908, s43
  s_cmp_eq_u32 s40, 3
  s_cselect_b32 s42, 0x1f1e1d1c, s42
  s_cselect_b32 s43, 0x1f1e1d1c, s43
  s_cmp_eq_u32 s40, 4
  s_cselect_b32 s42, 0x7060504, s42
  s_cselect_b32 s43, 0x7060504, s43
  s_cmp_eq_u32 s40, 5
  s_cselect_b32 s42, 0x13121110, s42
  s_cselect_b32 s43, 0x13121110, s43
  s_cmp_eq_u32 s40, 6
  s_cselect_b32 s42, 0xf0e0d0c, s42
  s_cselect_b32 s43, 0xf0e0d0c, s43
  s_cmp_eq_u32 s40, 7
  s_cselect_b32 s42, 0x1a191817, s42
  s_cselect_b32 s43, 0x17161514, s43
  s_lshr_b32 s40, s2, 6
  s_lshl_b32 s40, s40, 3
  s_lshr_b32 s42, s42, s40
  s_lshr_b32 s43, s43, s40
  s_bfe_u32 s41, s2, 0x30003
  s_and_b32 s42, s42, 31
  s_lshl_b32 s42, s42, 3
  s_add_u32 s3, s42, s41
  s_bfe_u32 s22, s43, 0x30002
  s_and_b32 s43, s43, 3
  s_lshl_b32 s43, s43, 3
  s_add_u32 s23, s43, s41
  s_waitcnt lgkmcnt(0)
  s_add_u32 s4, s4, 0x1fffff
  s_addc_u32 s5, s5, 0
  s_and_b32 s4, s4, 0xffe00000
  s_cmp_lg_u32 s20, 3
  s_cbranch_scc1 L_NOPRE
  s_getpc_b64 s[40:41]
L_PC:
  s_lshr_b32 s42, s2, 3
  v_lshlrev_b32 v1, 12, v0
  s_lshl_b32 s42, s42, 7
  v_add_u32 v1, s42, v1
  v_min_u32 v1, L_LAST-L_PC, v1
  global_load_dword v255, v1, s[40:41]
L_NOPRE:
  s_cmp_ge_u32 s22, 4
  s_cbranch_scc1 L_TRAIL
  s_lshr_b32 s40, s22, 1
  s_bitcmp1_b32 s22, 0
  s_cbranch_scc0 L_REC
  s_lshl_b32 s40, s40, 5
  s_add_u32 s21, s40, s23
  s_branch L_QKV
L_REC:
  s_lshl_b32 s40, s40, 4
  s_lshr_b32 s41, s23, 1
  s_add_u32 s21, s40, s41
  s_bitcmp1_b32 s23, 0
  s_cbranch_scc1 L_VO
  s_branch L_QK
L_TRAIL:
  s_mov_b32 s21, s23
  s_cmp_eq_u32 s22, 6
  s_cbranch_scc1 L_MOD
  s_sub_u32 s40, s22, 4
  s_lshl_b32 s40, s40, 5
  s_add_u32 s21, s40, s23
  s_cmp_lg_u32 s22, 7
  s_cbranch_scc1 L_WOF
L_INIT:
  s_lshl_b32 s40, s23, 2
  s_add_u32 s40, s40, s20
  s_lshl_b32 s40, s40, 12
  s_add_u32 s41, s40, 1048576
  s_add_u32 s42, s40, 0x80000
  v_lshlrev_b32 v1, 4, v0
  v_mov_b32 v4, -1
  v_mov_b32 v5, -1
  v_mov_b32 v6, -1
  v_mov_b32 v7, -1
  s_cmp_lt_u32 s23, 4
  s_cselect_b32 s41, 2147483392, s41
  buffer_store_dwordx4 v[4:7], v1, s[4:7], s41 offen offset:0 sc1
  buffer_store_dwordx4 v[4:7], v1, s[4:7], s41 offen offset:1024 sc1
  buffer_store_dwordx4 v[4:7], v1, s[4:7], s41 offen offset:2048 sc1
  buffer_store_dwordx4 v[4:7], v1, s[4:7], s41 offen offset:3072 sc1
  buffer_store_dwordx4 v[4:7], v1, s[4:7], s40 offen offset:0 sc1
  buffer_store_dwordx4 v[4:7], v1, s[4:7], s40 offen offset:1024 sc1
  buffer_store_dwordx4 v[4:7], v1, s[4:7], s40 offen offset:2048 sc1
  buffer_store_dwordx4 v[4:7], v1, s[4:7], s40 offen offset:3072 sc1
  buffer_store_dwordx4 v[4:7], v1, s[4:7], s42 offen offset:0 sc1
  buffer_store_dwordx4 v[4:7], v1, s[4:7], s42 offen offset:1024 sc1
  buffer_store_dwordx4 v[4:7], v1, s[4:7], s42 offen offset:2048 sc1
  buffer_store_dwordx4 v[4:7], v1, s[4:7], s42 offen offset:3072 sc1
  s_load_dwordx2 s[16:17], s[0:1], 8
  s_mov_b32 s18, 16384
  s_mov_b32 s19, 0x20000
  s_waitcnt lgkmcnt(0)
  s_and_b32 s40, s20, 1
  s_lshl_b32 s40, s40, 3
  v_bfe_u32 v8, v0, 2, 3
  v_add_u32 v8, s40, v8
  s_lshr_b32 s40, s20, 1
  s_lshl_b32 s40, s40, 3
  v_and_b32 v9, 3, v0
  v_add_u32 v9, s40, v9
  v_bfe_u32 v10, v8, 1, 1
  v_lshl_add_u32 v9, v10, 2, v9
  v_lshrrev_b32 v10, 2, v8
  v_and_b32 v11, 1, v8
  v_lshl_add_u32 v10, v10, 1, v11
  s_lshl_b32 s40, s23, 6
  v_lshl_add_u32 v10, v10, 11, s40
  v_lshl_add_u32 v10, v9, 1, v10
  buffer_load_ushort v11, v10, s[16:19], 0 offen
  buffer_load_ushort v12, v10, s[16:19], 0 offen offset:32
  s_bfe_u32 s41, s23, 0x10002
  s_mul_i32 s41, s41, 32768
  s_lshr_b32 s40, s23, 3
  s_lshl_b32 s40, s40, 11
  s_add_u32 s40, s40, s41
  s_and_b32 s41, s23, 3
  s_lshl_b32 s41, s41, 9
  s_add_u32 s40, s40, s41
  s_lshl_b32 s41, s20, 7
  s_add_u32 s40, s40, s41
  s_add_u32 s40, s40, 1048576
  s_add_u32 s41, s40, 0x4000
  v_and_b32 v8, 31, v0
  v_lshlrev_b32 v8, 2, v8
  v_lshrrev_b32 v9, 5, v0
  v_lshl_add_u32 v8, v9, 13, v8
  s_waitcnt vmcnt(0)
  v_lshl_or_b32 v11, v12, 16, v11
  v_min_u32 v11, -2, v11
  buffer_store_dword v11, v8, s[4:7], s40 offen sc1
  buffer_store_dword v11, v8, s[4:7], s41 offen sc1
  s_lshl_b32 s40, s23, 2
  s_add_u32 s40, s40, 128
  s_cmp_eq_u32 s20, 0
  s_cselect_b32 s40, s40, 2147483392
  v_mov_b32 v2, 2147483392
  s_mov_b64 exec, 1
  v_mov_b32 v2, s40
  s_mov_b64 exec, -1
  v_mov_b32 v3, 1
  s_waitcnt vmcnt(0)
  s_barrier
  buffer_store_dword v3, v2, s[12:15], 0 offen sc1
  s_branch L_LN1
L_MOD:
  s_load_dwordx2 s[16:17], s[0:1], 88
  s_mov_b32 s18, 2048
  s_mov_b32 s19, 0x20000
  s_waitcnt lgkmcnt(0)
  s_load_dwordx2 s[8:9], s[0:1], 96
  s_mov_b32 s10, 12582912
  s_mov_b32 s11, 0x20000
  s_waitcnt lgkmcnt(0)
  s_lshl_b32 s40, s20, 9
  v_lshl_add_u32 v1, v0, 3, s40
  buffer_load_dwordx2 v[8:9], v1, s[16:19], 0 offen
  v_bfe_u32 v2, v0, 5, 1
  v_mul_u32_u24 v2, 98304, v2
  v_bfe_u32 v3, v0, 4, 1
  v_mul_u32_u24 v3, 24576, v3
  v_add_u32 v2, v2, v3
  v_bfe_u32 v3, v0, 3, 1
  v_mul_u32_u24 v3, 12288, v3
  v_add_u32 v2, v2, v3
  v_lshrrev_b32 v3, 3, v0
  v_and_b32 v3, 6, v3
  v_xor_b32 v3, v3, v0
  v_and_b32 v3, 7, v3
  v_lshl_add_u32 v2, v3, 4, v2
  s_lshr_b32 s40, s20, 1
  s_mul_i32 s40, s40, 49152
  s_and_b32 s41, s20, 1
  s_mul_i32 s41, s41, 196608
  s_add_u32 s40, s40, s41
  s_lshl_b32 s41, s21, 7
  s_add_u32 s40, s40, s41
  v_add_u32 v2, s40, v2
  s_lshl_b32 s41, s20, 10
  s_add_u32 m0, s41, 0
  s_mov_b32 s42, 0
  buffer_load_dwordx4 v2, s[8:11], s42 offen nt lds
  s_add_u32 m0, s41, 4096
  s_mov_b32 s42, 393216
  buffer_load_dwordx4 v2, s[8:11], s42 offen nt lds
  s_add_u32 m0, s41, 8192
  s_mov_b32 s42, 786432
  buffer_load_dwordx4 v2, s[8:11], s42 offen nt lds
  s_add_u32 m0, s41, 12288
  s_mov_b32 s42, 1179648
  buffer_load_dwordx4 v2, s[8:11], s42 offen nt lds
  s_add_u32 m0, s41, 16384
  s_mov_b32 s42, 1572864
  buffer_load_dwordx4 v2, s[8:11], s42 offen nt lds
  s_add_u32 m0, s41, 20480
  s_mov_b32 s42, 1966080
  buffer_load_dwordx4 v2, s[8:11], s42 offen nt lds
  s_add_u32 m0, s41, 24576
  s_mov_b32 s42, 2359296
  buffer_load_dwordx4 v2, s[8:11], s42 offen nt lds
  s_add_u32 m0, s41, 28672
  s_mov_b32 s42, 2752512
  buffer_load_dwordx4 v2, s[8:11], s42 offen nt lds
  s_add_u32 m0, s41, 32768
  s_mov_b32 s42, 3145728
  buffer_load_dwordx4 v2, s[8:11], s42 offen nt lds
  s_add_u32 m0, s41, 36864
  s_mov_b32 s42, 3538944
  buffer_load_dwordx4 v2, s[8:11], s42 offen nt lds
  s_add_u32 m0, s41, 40960
  s_mov_b32 s42, 3932160
  buffer_load_dwordx4 v2, s[8:11], s42 offen nt lds
  s_add_u32 m0, s41, 45056
  s_mov_b32 s42, 4325376
  buffer_load_dwordx4 v2, s[8:11], s42 offen nt lds
  s_add_u32 m0, s41, 49152
  s_mov_b32 s42, 4718592
  buffer_load_dwordx4 v2, s[8:11], s42 offen nt lds
  s_add_u32 m0, s41, 53248
  s_mov_b32 s42, 5111808
  buffer_load_dwordx4 v2, s[8:11], s42 offen nt lds
  s_add_u32 m0, s41, 57344
  s_mov_b32 s42, 5505024
  buffer_load_dwordx4 v2, s[8:11], s42 offen nt lds
  s_add_u32 m0, s41, 61440
  s_mov_b32 s42, 5898240
  buffer_load_dwordx4 v2, s[8:11], s42 offen nt lds
  s_add_u32 m0, s41, 65536
  s_mov_b32 s42, 6291456
  buffer_load_dwordx4 v2, s[8:11], s42 offen nt lds
  s_add_u32 m0, s41, 69632
  s_mov_b32 s42, 6684672
  buffer_load_dwordx4 v2, s[8:11], s42 offen nt lds
  s_add_u32 m0, s41, 73728
  s_mov_b32 s42, 7077888
  buffer_load_dwordx4 v2, s[8:11], s42 offen nt lds
  s_add_u32 m0, s41, 77824
  s_mov_b32 s42, 7471104
  buffer_load_dwordx4 v2, s[8:11], s42 offen nt lds
  s_add_u32 m0, s41, 81920
  s_mov_b32 s42, 7864320
  buffer_load_dwordx4 v2, s[8:11], s42 offen nt lds
  s_add_u32 m0, s41, 86016
  s_mov_b32 s42, 8257536
  buffer_load_dwordx4 v2, s[8:11], s42 offen nt lds
  s_add_u32 m0, s41, 90112
  s_mov_b32 s42, 8650752
  buffer_load_dwordx4 v2, s[8:11], s42 offen nt lds
  s_add_u32 m0, s41, 94208
  s_mov_b32 s42, 9043968
  buffer_load_dwordx4 v2, s[8:11], s42 offen nt lds
  s_add_u32 m0, s41, 98304
  s_mov_b32 s42, 9437184
  buffer_load_dwordx4 v2, s[8:11], s42 offen nt lds
  s_add_u32 m0, s41, 102400
  s_mov_b32 s42, 9830400
  buffer_load_dwordx4 v2, s[8:11], s42 offen nt lds
  s_add_u32 m0, s41, 106496
  s_mov_b32 s42, 10223616
  buffer_load_dwordx4 v2, s[8:11], s42 offen nt lds
  s_add_u32 m0, s41, 110592
  s_mov_b32 s42, 10616832
  buffer_load_dwordx4 v2, s[8:11], s42 offen nt lds
  s_add_u32 m0, s41, 114688
  s_mov_b32 s42, 11010048
  buffer_load_dwordx4 v2, s[8:11], s42 offen nt lds
  s_add_u32 m0, s41, 118784
  s_mov_b32 s42, 11403264
  buffer_load_dwordx4 v2, s[8:11], s42 offen nt lds
  s_add_u32 m0, s41, 122880
  s_mov_b32 s42, 11796480
  buffer_load_dwordx4 v2, s[8:11], s42 offen nt lds
  s_add_u32 m0, s41, 126976
  s_mov_b32 s42, 12189696
  buffer_load_dwordx4 v2, s[8:11], s42 offen nt lds
  v_bfe_u32 v3, v0, 3, 2
  v_xor_b32 v3, s20, v3
  v_lshlrev_b32 v3, 5, v3
  v_lshrrev_b32 v4, 2, v0
  v_lshl_add_u32 v4, v4, 7, v3
  v_and_b32 v3, 3, v0
  v_lshl_add_u32 v4, v3, 3, v4
  v_add_u32 v5, 0x10000, v4
  v_lshrrev_b32 v6, 4, v0
  v_lshlrev_b32 v6, 4, v6
  v_add_u32 v6, 0x20000, v6
  v_add_u32 v1, 0x20000, v1
  s_mov_b32 s37, 0xbfb8aa3b
  s_waitcnt vmcnt(32)
  v_lshlrev_b32 v10, 16, v8
  v_and_b32 v11, 0xffff0000, v8
  v_lshlrev_b32 v12, 16, v9
  v_and_b32 v13, 0xffff0000, v9
  v_mul_f32 v14, s37, v10
  v_mul_f32 v15, s37, v11
  v_mul_f32 v16, s37, v12
  v_mul_f32 v17, s37, v13
  v_exp_f32 v14, v14
  v_exp_f32 v15, v15
  v_exp_f32 v16, v16
  v_exp_f32 v17, v17
  v_add_f32 v14, 1.0, v14
  v_add_f32 v15, 1.0, v15
  v_add_f32 v16, 1.0, v16
  v_add_f32 v17, 1.0, v17
  v_rcp_f32 v14, v14
  v_rcp_f32 v15, v15
  v_rcp_f32 v16, v16
  v_rcp_f32 v17, v17
  v_mul_f32 v10, v10, v14
  v_mul_f32 v11, v11, v15
  v_mul_f32 v12, v12, v16
  v_mul_f32 v13, v13, v17
  v_cvt_pk_bf16_f32 v8, v10, v11
  v_cvt_pk_bf16_f32 v9, v12, v13
  ds_write_b64 v1, v[8:9]
  s_waitcnt vmcnt(28) lgkmcnt(0)
  s_barrier
  ds_read_b64_tr_b16 v[24:25], v4 offset:0
  ds_read_b64_tr_b16 v[26:27], v4 offset:2048
  ds_read_b128 v[28:31], v6 offset:0
  ds_read_b64_tr_b16 v[32:33], v4 offset:4096
  ds_read_b64_tr_b16 v[34:35], v4 offset:6144
  ds_read_b128 v[36:39], v6 offset:64
  ds_read_b64_tr_b16 v[40:41], v4 offset:8192
  ds_read_b64_tr_b16 v[42:43], v4 offset:10240
  ds_read_b128 v[44:47], v6 offset:128
  ds_read_b64_tr_b16 v[48:49], v4 offset:12288
  ds_read_b64_tr_b16 v[50:51], v4 offset:14336
  ds_read_b128 v[52:55], v6 offset:192
  s_waitcnt lgkmcnt(9)
  v_mfma_f32_16x16x32_bf16 v[20:23], v[24:27], v[28:31], 0
  s_waitcnt lgkmcnt(6)
  v_mfma_f32_16x16x32_bf16 v[20:23], v[32:35], v[36:39], v[20:23]
  s_waitcnt lgkmcnt(3)
  v_mfma_f32_16x16x32_bf16 v[20:23], v[40:43], v[44:47], v[20:23]
  s_waitcnt lgkmcnt(0)
  v_mfma_f32_16x16x32_bf16 v[20:23], v[48:51], v[52:55], v[20:23]
  s_waitcnt vmcnt(24) lgkmcnt(0)
  s_barrier
  ds_read_b64_tr_b16 v[24:25], v4 offset:16384
  ds_read_b64_tr_b16 v[26:27], v4 offset:18432
  ds_read_b128 v[28:31], v6 offset:256
  ds_read_b64_tr_b16 v[32:33], v4 offset:20480
  ds_read_b64_tr_b16 v[34:35], v4 offset:22528
  ds_read_b128 v[36:39], v6 offset:320
  ds_read_b64_tr_b16 v[40:41], v4 offset:24576
  ds_read_b64_tr_b16 v[42:43], v4 offset:26624
  ds_read_b128 v[44:47], v6 offset:384
  ds_read_b64_tr_b16 v[48:49], v4 offset:28672
  ds_read_b64_tr_b16 v[50:51], v4 offset:30720
  ds_read_b128 v[52:55], v6 offset:448
  s_waitcnt lgkmcnt(9)
  v_mfma_f32_16x16x32_bf16 v[20:23], v[24:27], v[28:31], v[20:23]
  s_waitcnt lgkmcnt(6)
  v_mfma_f32_16x16x32_bf16 v[20:23], v[32:35], v[36:39], v[20:23]
  s_waitcnt lgkmcnt(3)
  v_mfma_f32_16x16x32_bf16 v[20:23], v[40:43], v[44:47], v[20:23]
  s_waitcnt lgkmcnt(0)
  v_mfma_f32_16x16x32_bf16 v[20:23], v[48:51], v[52:55], v[20:23]
  s_waitcnt vmcnt(20) lgkmcnt(0)
  s_barrier
  ds_read_b64_tr_b16 v[24:25], v4 offset:32768
  ds_read_b64_tr_b16 v[26:27], v4 offset:34816
  ds_read_b128 v[28:31], v6 offset:512
  ds_read_b64_tr_b16 v[32:33], v4 offset:36864
  ds_read_b64_tr_b16 v[34:35], v4 offset:38912
  ds_read_b128 v[36:39], v6 offset:576
  ds_read_b64_tr_b16 v[40:41], v4 offset:40960
  ds_read_b64_tr_b16 v[42:43], v4 offset:43008
  ds_read_b128 v[44:47], v6 offset:640
  ds_read_b64_tr_b16 v[48:49], v4 offset:45056
  ds_read_b64_tr_b16 v[50:51], v4 offset:47104
  ds_read_b128 v[52:55], v6 offset:704
  s_waitcnt lgkmcnt(9)
  v_mfma_f32_16x16x32_bf16 v[20:23], v[24:27], v[28:31], v[20:23]
  s_waitcnt lgkmcnt(6)
  v_mfma_f32_16x16x32_bf16 v[20:23], v[32:35], v[36:39], v[20:23]
  s_waitcnt lgkmcnt(3)
  v_mfma_f32_16x16x32_bf16 v[20:23], v[40:43], v[44:47], v[20:23]
  s_waitcnt lgkmcnt(0)
  v_mfma_f32_16x16x32_bf16 v[20:23], v[48:51], v[52:55], v[20:23]
  s_waitcnt vmcnt(16) lgkmcnt(0)
  s_barrier
  ds_read_b64_tr_b16 v[24:25], v4 offset:49152
  ds_read_b64_tr_b16 v[26:27], v4 offset:51200
  ds_read_b128 v[28:31], v6 offset:768
  ds_read_b64_tr_b16 v[32:33], v4 offset:53248
  ds_read_b64_tr_b16 v[34:35], v4 offset:55296
  ds_read_b128 v[36:39], v6 offset:832
  ds_read_b64_tr_b16 v[40:41], v4 offset:57344
  ds_read_b64_tr_b16 v[42:43], v4 offset:59392
  ds_read_b128 v[44:47], v6 offset:896
  ds_read_b64_tr_b16 v[48:49], v4 offset:61440
  ds_read_b64_tr_b16 v[50:51], v4 offset:63488
  ds_read_b128 v[52:55], v6 offset:960
  s_waitcnt lgkmcnt(9)
  v_mfma_f32_16x16x32_bf16 v[20:23], v[24:27], v[28:31], v[20:23]
  s_waitcnt lgkmcnt(6)
  v_mfma_f32_16x16x32_bf16 v[20:23], v[32:35], v[36:39], v[20:23]
  s_waitcnt lgkmcnt(3)
  v_mfma_f32_16x16x32_bf16 v[20:23], v[40:43], v[44:47], v[20:23]
  s_waitcnt lgkmcnt(0)
  v_mfma_f32_16x16x32_bf16 v[20:23], v[48:51], v[52:55], v[20:23]
  s_waitcnt vmcnt(12) lgkmcnt(0)
  s_barrier
  ds_read_b64_tr_b16 v[24:25], v5 offset:0
  ds_read_b64_tr_b16 v[26:27], v5 offset:2048
  ds_read_b128 v[28:31], v6 offset:1024
  ds_read_b64_tr_b16 v[32:33], v5 offset:4096
  ds_read_b64_tr_b16 v[34:35], v5 offset:6144
  ds_read_b128 v[36:39], v6 offset:1088
  ds_read_b64_tr_b16 v[40:41], v5 offset:8192
  ds_read_b64_tr_b16 v[42:43], v5 offset:10240
  ds_read_b128 v[44:47], v6 offset:1152
  ds_read_b64_tr_b16 v[48:49], v5 offset:12288
  ds_read_b64_tr_b16 v[50:51], v5 offset:14336
  ds_read_b128 v[52:55], v6 offset:1216
  s_waitcnt lgkmcnt(9)
  v_mfma_f32_16x16x32_bf16 v[20:23], v[24:27], v[28:31], v[20:23]
  s_waitcnt lgkmcnt(6)
  v_mfma_f32_16x16x32_bf16 v[20:23], v[32:35], v[36:39], v[20:23]
  s_waitcnt lgkmcnt(3)
  v_mfma_f32_16x16x32_bf16 v[20:23], v[40:43], v[44:47], v[20:23]
  s_waitcnt lgkmcnt(0)
  v_mfma_f32_16x16x32_bf16 v[20:23], v[48:51], v[52:55], v[20:23]
  s_waitcnt vmcnt(8) lgkmcnt(0)
  s_barrier
  ds_read_b64_tr_b16 v[24:25], v5 offset:16384
  ds_read_b64_tr_b16 v[26:27], v5 offset:18432
  ds_read_b128 v[28:31], v6 offset:1280
  ds_read_b64_tr_b16 v[32:33], v5 offset:20480
  ds_read_b64_tr_b16 v[34:35], v5 offset:22528
  ds_read_b128 v[36:39], v6 offset:1344
  ds_read_b64_tr_b16 v[40:41], v5 offset:24576
  ds_read_b64_tr_b16 v[42:43], v5 offset:26624
  ds_read_b128 v[44:47], v6 offset:1408
  ds_read_b64_tr_b16 v[48:49], v5 offset:28672
  ds_read_b64_tr_b16 v[50:51], v5 offset:30720
  ds_read_b128 v[52:55], v6 offset:1472
  s_waitcnt lgkmcnt(9)
  v_mfma_f32_16x16x32_bf16 v[20:23], v[24:27], v[28:31], v[20:23]
  s_waitcnt lgkmcnt(6)
  v_mfma_f32_16x16x32_bf16 v[20:23], v[32:35], v[36:39], v[20:23]
  s_waitcnt lgkmcnt(3)
  v_mfma_f32_16x16x32_bf16 v[20:23], v[40:43], v[44:47], v[20:23]
  s_waitcnt lgkmcnt(0)
  v_mfma_f32_16x16x32_bf16 v[20:23], v[48:51], v[52:55], v[20:23]
  s_waitcnt vmcnt(4) lgkmcnt(0)
  s_barrier
  ds_read_b64_tr_b16 v[24:25], v5 offset:32768
  ds_read_b64_tr_b16 v[26:27], v5 offset:34816
  ds_read_b128 v[28:31], v6 offset:1536
  ds_read_b64_tr_b16 v[32:33], v5 offset:36864
  ds_read_b64_tr_b16 v[34:35], v5 offset:38912
  ds_read_b128 v[36:39], v6 offset:1600
  ds_read_b64_tr_b16 v[40:41], v5 offset:40960
  ds_read_b64_tr_b16 v[42:43], v5 offset:43008
  ds_read_b128 v[44:47], v6 offset:1664
  ds_read_b64_tr_b16 v[48:49], v5 offset:45056
  ds_read_b64_tr_b16 v[50:51], v5 offset:47104
  ds_read_b128 v[52:55], v6 offset:1728
  s_waitcnt lgkmcnt(9)
  v_mfma_f32_16x16x32_bf16 v[20:23], v[24:27], v[28:31], v[20:23]
  s_waitcnt lgkmcnt(6)
  v_mfma_f32_16x16x32_bf16 v[20:23], v[32:35], v[36:39], v[20:23]
  s_waitcnt lgkmcnt(3)
  v_mfma_f32_16x16x32_bf16 v[20:23], v[40:43], v[44:47], v[20:23]
  s_waitcnt lgkmcnt(0)
  v_mfma_f32_16x16x32_bf16 v[20:23], v[48:51], v[52:55], v[20:23]
  s_waitcnt vmcnt(0) lgkmcnt(0)
  s_barrier
  ds_read_b64_tr_b16 v[24:25], v5 offset:49152
  ds_read_b64_tr_b16 v[26:27], v5 offset:51200
  ds_read_b128 v[28:31], v6 offset:1792
  ds_read_b64_tr_b16 v[32:33], v5 offset:53248
  ds_read_b64_tr_b16 v[34:35], v5 offset:55296
  ds_read_b128 v[36:39], v6 offset:1856
  ds_read_b64_tr_b16 v[40:41], v5 offset:57344
  ds_read_b64_tr_b16 v[42:43], v5 offset:59392
  ds_read_b128 v[44:47], v6 offset:1920
  ds_read_b64_tr_b16 v[48:49], v5 offset:61440
  ds_read_b64_tr_b16 v[50:51], v5 offset:63488
  ds_read_b128 v[52:55], v6 offset:1984
  s_waitcnt lgkmcnt(9)
  v_mfma_f32_16x16x32_bf16 v[20:23], v[24:27], v[28:31], v[20:23]
  s_waitcnt lgkmcnt(6)
  v_mfma_f32_16x16x32_bf16 v[20:23], v[32:35], v[36:39], v[20:23]
  s_waitcnt lgkmcnt(3)
  v_mfma_f32_16x16x32_bf16 v[20:23], v[40:43], v[44:47], v[20:23]
  s_waitcnt lgkmcnt(0)
  v_mfma_f32_16x16x32_bf16 v[20:23], v[48:51], v[52:55], v[20:23]
  s_lshl_b32 s40, s21, 8
  s_lshl_b32 s41, s20, 6
  s_add_u32 s40, s40, s41
  s_add_u32 s40, s40, 1572864
  v_and_b32 v2, 15, v0
  v_cmp_eq_u32 vcc, 0, v2
  v_mov_b32 v3, 2147483392
  s_nop 0
  v_cndmask_b32 v1, v3, v0, vcc
  v_cvt_pk_bf16_f32 v8, v20, v21
  v_cvt_pk_bf16_f32 v9, v22, v23
  v_lshlrev_b32 v20, 16, v8
  v_and_b32 v21, 0xffff0000, v8
  v_lshlrev_b32 v22, 16, v9
  v_and_b32 v23, 0xffff0000, v9
  buffer_store_dwordx4 v[20:23], v1, s[4:7], s40 offen sc1
  v_min_u32 v2, 31, v0
  v_lshlrev_b32 v2, 2, v2
  v_add_u32 v2, 128, v2
  s_nop 1
Lpoll_1:
  buffer_load_dword v3, v2, s[12:15], 0 offen sc1
  s_sub_u32 s24, s24, 1
  s_cbranch_scc1 L_FAIL
  s_waitcnt vmcnt(0)
  v_cmp_gt_i32 vcc, 1, v3
  s_cbranch_vccz Lpolld_2
  s_sleep 2
  s_branch Lpoll_1
Lpolld_2:
  s_lshl_b32 s40, s21, 7
  s_add_u32 s40, s40, 1376256
  v_mov_b32 v2, 2147483392
  s_mov_b64 exec, 1
  v_mov_b32 v2, s40
  s_mov_b64 exec, -1
  v_mov_b32 v3, 1
  s_barrier
  s_cmp_lg_u32 s20, 0
  s_cbranch_scc1 L_MOD_done
  buffer_store_dword v3, v2, s[4:7], 0 offen sc1
L_MOD_done:
  s_cmp_lg_u32 s22, 6
  s_cbranch_scc1 L_ROLE
L_LN1:
  s_load_dwordx2 s[16:17], s[0:1], 0
  s_mov_b32 s18, 4194304
  s_mov_b32 s19, 0x20000
  s_waitcnt lgkmcnt(0)
  s_sub_u32 s43, 7, s22
  s_lshl_b32 s43, s43, 5
  s_add_u32 s43, s43, s23
  s_lshl_b32 s43, s43, 2
  s_add_u32 s43, s43, s20
  s_lshl_b32 s44, s43, 13
  s_add_u32 s45, s44, 4096
  v_lshlrev_b32 v1, 3, v0
  v_lshlrev_b32 v2, 4, v0
  buffer_load_dwordx2 v[8:9], v1, s[16:19], s44 offen offset:0 nt
  buffer_load_dwordx2 v[10:11], v1, s[16:19], s44 offen offset:512 nt
  buffer_load_dwordx2 v[12:13], v1, s[16:19], s44 offen offset:1024 nt
  buffer_load_dwordx2 v[14:15], v1, s[16:19], s44 offen offset:1536 nt
  buffer_load_dwordx2 v[16:17], v1, s[16:19], s44 offen offset:2048 nt
  buffer_load_dwordx2 v[18:19], v1, s[16:19], s44 offen offset:2560 nt
  buffer_load_dwordx2 v[20:21], v1, s[16:19], s44 offen offset:3072 nt
  buffer_load_dwordx2 v[22:23], v1, s[16:19], s44 offen offset:3584 nt
  buffer_load_dwordx2 v[24:25], v1, s[16:19], s45 offen offset:0 nt
  buffer_load_dwordx2 v[26:27], v1, s[16:19], s45 offen offset:512 nt
  buffer_load_dwordx2 v[28:29], v1, s[16:19], s45 offen offset:1024 nt
  buffer_load_dwordx2 v[30:31], v1, s[16:19], s45 offen offset:1536 nt
  buffer_load_dwordx2 v[32:33], v1, s[16:19], s45 offen offset:2048 nt
  buffer_load_dwordx2 v[34:35], v1, s[16:19], s45 offen offset:2560 nt
  buffer_load_dwordx2 v[36:37], v1, s[16:19], s45 offen offset:3072 nt
  buffer_load_dwordx2 v[38:39], v1, s[16:19], s45 offen offset:3584 nt
  s_waitcnt vmcnt(0)
  v_lshlrev_b32 v40, 16, v8
  v_and_b32 v41, 0xffff0000, v8
  v_lshlrev_b32 v42, 16, v9
  v_and_b32 v43, 0xffff0000, v9
  v_lshlrev_b32 v44, 16, v10
  v_and_b32 v45, 0xffff0000, v10
  v_lshlrev_b32 v46, 16, v11
  v_and_b32 v47, 0xffff0000, v11
  v_lshlrev_b32 v48, 16, v12
  v_and_b32 v49, 0xffff0000, v12
  v_lshlrev_b32 v50, 16, v13
  v_and_b32 v51, 0xffff0000, v13
  v_lshlrev_b32 v52, 16, v14
  v_and_b32 v53, 0xffff0000, v14
  v_lshlrev_b32 v54, 16, v15
  v_and_b32 v55, 0xffff0000, v15
  v_lshlrev_b32 v56, 16, v16
  v_and_b32 v57, 0xffff0000, v16
  v_lshlrev_b32 v58, 16, v17
  v_and_b32 v59, 0xffff0000, v17
  v_lshlrev_b32 v60, 16, v18
  v_and_b32 v61, 0xffff0000, v18
  v_lshlrev_b32 v62, 16, v19
  v_and_b32 v63, 0xffff0000, v19
  v_lshlrev_b32 v64, 16, v20
  v_and_b32 v65, 0xffff0000, v20
  v_lshlrev_b32 v66, 16, v21
  v_and_b32 v67, 0xffff0000, v21
  v_lshlrev_b32 v68, 16, v22
  v_and_b32 v69, 0xffff0000, v22
  v_lshlrev_b32 v70, 16, v23
  v_and_b32 v71, 0xffff0000, v23
  v_lshlrev_b32 v72, 16, v24
  v_and_b32 v73, 0xffff0000, v24
  v_lshlrev_b32 v74, 16, v25
  v_and_b32 v75, 0xffff0000, v25
  v_lshlrev_b32 v76, 16, v26
  v_and_b32 v77, 0xffff0000, v26
  v_lshlrev_b32 v78, 16, v27
  v_and_b32 v79, 0xffff0000, v27
  v_lshlrev_b32 v80, 16, v28
  v_and_b32 v81, 0xffff0000, v28
  v_lshlrev_b32 v82, 16, v29
  v_and_b32 v83, 0xffff0000, v29
  v_lshlrev_b32 v84, 16, v30
  v_and_b32 v85, 0xffff0000, v30
  v_lshlrev_b32 v86, 16, v31
  v_and_b32 v87, 0xffff0000, v31
  v_lshlrev_b32 v88, 16, v32
  v_and_b32 v89, 0xffff0000, v32
  v_lshlrev_b32 v90, 16, v33
  v_and_b32 v91, 0xffff0000, v33
  v_lshlrev_b32 v92, 16, v34
  v_and_b32 v93, 0xffff0000, v34
  v_lshlrev_b32 v94, 16, v35
  v_and_b32 v95, 0xffff0000, v35
  v_lshlrev_b32 v96, 16, v36
  v_and_b32 v97, 0xffff0000, v36
  v_lshlrev_b32 v98, 16, v37
  v_and_b32 v99, 0xffff0000, v37
  v_lshlrev_b32 v100, 16, v38
  v_and_b32 v101, 0xffff0000, v38
  v_lshlrev_b32 v102, 16, v39
  v_and_b32 v103, 0xffff0000, v39
  v_pk_add_f32 v[104:105], v[40:41], v[42:43]
  v_pk_add_f32 v[108:109], v[56:57], v[58:59]
  v_pk_add_f32 v[112:113], v[72:73], v[74:75]
  v_pk_add_f32 v[116:117], v[88:89], v[90:91]
  v_pk_add_f32 v[104:105], v[104:105], v[44:45]
  v_pk_add_f32 v[108:109], v[108:109], v[60:61]
  v_pk_add_f32 v[112:113], v[112:113], v[76:77]
  v_pk_add_f32 v[116:117], v[116:117], v[92:93]
  v_pk_add_f32 v[104:105], v[104:105], v[46:47]
  v_pk_add_f32 v[108:109], v[108:109], v[62:63]
  v_pk_add_f32 v[112:113], v[112:113], v[78:79]
  v_pk_add_f32 v[116:117], v[116:117], v[94:95]
  v_pk_add_f32 v[104:105], v[104:105], v[48:49]
  v_pk_add_f32 v[108:109], v[108:109], v[64:65]
  v_pk_add_f32 v[112:113], v[112:113], v[80:81]
  v_pk_add_f32 v[116:117], v[116:117], v[96:97]
  v_pk_add_f32 v[104:105], v[104:105], v[50:51]
  v_pk_add_f32 v[108:109], v[108:109], v[66:67]
  v_pk_add_f32 v[112:113], v[112:113], v[82:83]
  v_pk_add_f32 v[116:117], v[116:117], v[98:99]
  v_pk_add_f32 v[104:105], v[104:105], v[52:53]
  v_pk_add_f32 v[108:109], v[108:109], v[68:69]
  v_pk_add_f32 v[112:113], v[112:113], v[84:85]
  v_pk_add_f32 v[116:117], v[116:117], v[100:101]
  v_pk_add_f32 v[104:105], v[104:105], v[54:55]
  v_pk_add_f32 v[108:109], v[108:109], v[70:71]
  v_pk_add_f32 v[112:113], v[112:113], v[86:87]
  v_pk_add_f32 v[116:117], v[116:117], v[102:103]
  v_add_f32 v104, v104, v105
  v_add_f32 v108, v108, v109
  v_add_f32 v112, v112, v113
  v_add_f32 v116, v116, v117
  v_add_f32_dpp v104, v104, v104 row_ror:8 row_mask:0xf bank_mask:0xf
  v_add_f32_dpp v108, v108, v108 row_ror:8 row_mask:0xf bank_mask:0xf
  v_add_f32_dpp v112, v112, v112 row_ror:8 row_mask:0xf bank_mask:0xf
  v_add_f32_dpp v116, v116, v116 row_ror:8 row_mask:0xf bank_mask:0xf
  v_add_f32_dpp v104, v104, v104 row_ror:4 row_mask:0xf bank_mask:0xf
  v_add_f32_dpp v108, v108, v108 row_ror:4 row_mask:0xf bank_mask:0xf
  v_add_f32_dpp v112, v112, v112 row_ror:4 row_mask:0xf bank_mask:0xf
  v_add_f32_dpp v116, v116, v116 row_ror:4 row_mask:0xf bank_mask:0xf
  v_add_f32_dpp v104, v104, v104 row_ror:2 row_mask:0xf bank_mask:0xf
  v_add_f32_dpp v108, v108, v108 row_ror:2 row_mask:0xf bank_mask:0xf
  v_add_f32_dpp v112, v112, v112 row_ror:2 row_mask:0xf bank_mask:0xf
  v_add_f32_dpp v116, v116, v116 row_ror:2 row_mask:0xf bank_mask:0xf
  v_add_f32_dpp v104, v104, v104 row_ror:1 row_mask:0xf bank_mask:0xf
  v_add_f32_dpp v108, v108, v108 row_ror:1 row_mask:0xf bank_mask:0xf
  v_add_f32_dpp v112, v112, v112 row_ror:1 row_mask:0xf bank_mask:0xf
  v_add_f32_dpp v116, v116, v116 row_ror:1 row_mask:0xf bank_mask:0xf
  v_mov_b32 v105, v104
  v_mov_b32 v109, v108
  v_mov_b32 v113, v112
  v_mov_b32 v117, v116
  v_permlane16_swap_b32 v105, v104
  v_permlane16_swap_b32 v109, v108
  v_permlane16_swap_b32 v113, v112
  v_permlane16_swap_b32 v117, v116
  v_add_f32 v104, v104, v105
  v_add_f32 v108, v108, v109
  v_add_f32 v112, v112, v113
  v_add_f32 v116, v116, v117
  v_mov_b32 v105, v104
  v_mov_b32 v109, v108
  v_mov_b32 v113, v112
  v_mov_b32 v117, v116
  v_permlane32_swap_b32 v105, v104
  v_permlane32_swap_b32 v109, v108
  v_permlane32_swap_b32 v113, v112
  v_permlane32_swap_b32 v117, v116
  v_add_f32 v104, v104, v105
  v_add_f32 v108, v108, v109
  v_add_f32 v112, v112, v113
  v_add_f32 v116, v116, v117
  v_mul_f32 v104, 0xba800000, v104
  v_mul_f32 v108, 0xba800000, v108
  v_mul_f32 v112, 0xba800000, v112
  v_mul_f32 v116, 0xba800000, v116
  v_pk_add_f32 v[40:41], v[40:41], v[104:105] op_sel_hi:[1,0]
  v_pk_add_f32 v[56:57], v[56:57], v[108:109] op_sel_hi:[1,0]
  v_pk_add_f32 v[72:73], v[72:73], v[112:113] op_sel_hi:[1,0]
  v_pk_add_f32 v[88:89], v[88:89], v[116:117] op_sel_hi:[1,0]
  v_pk_add_f32 v[42:43], v[42:43], v[104:105] op_sel_hi:[1,0]
  v_pk_add_f32 v[58:59], v[58:59], v[108:109] op_sel_hi:[1,0]
  v_pk_add_f32 v[74:75], v[74:75], v[112:113] op_sel_hi:[1,0]
  v_pk_add_f32 v[90:91], v[90:91], v[116:117] op_sel_hi:[1,0]
  v_pk_add_f32 v[44:45], v[44:45], v[104:105] op_sel_hi:[1,0]
  v_pk_add_f32 v[60:61], v[60:61], v[108:109] op_sel_hi:[1,0]
  v_pk_add_f32 v[76:77], v[76:77], v[112:113] op_sel_hi:[1,0]
  v_pk_add_f32 v[92:93], v[92:93], v[116:117] op_sel_hi:[1,0]
  v_pk_add_f32 v[46:47], v[46:47], v[104:105] op_sel_hi:[1,0]
  v_pk_add_f32 v[62:63], v[62:63], v[108:109] op_sel_hi:[1,0]
  v_pk_add_f32 v[78:79], v[78:79], v[112:113] op_sel_hi:[1,0]
  v_pk_add_f32 v[94:95], v[94:95], v[116:117] op_sel_hi:[1,0]
  v_pk_add_f32 v[48:49], v[48:49], v[104:105] op_sel_hi:[1,0]
  v_pk_add_f32 v[64:65], v[64:65], v[108:109] op_sel_hi:[1,0]
  v_pk_add_f32 v[80:81], v[80:81], v[112:113] op_sel_hi:[1,0]
  v_pk_add_f32 v[96:97], v[96:97], v[116:117] op_sel_hi:[1,0]
  v_pk_add_f32 v[50:51], v[50:51], v[104:105] op_sel_hi:[1,0]
  v_pk_add_f32 v[66:67], v[66:67], v[108:109] op_sel_hi:[1,0]
  v_pk_add_f32 v[82:83], v[82:83], v[112:113] op_sel_hi:[1,0]
  v_pk_add_f32 v[98:99], v[98:99], v[116:117] op_sel_hi:[1,0]
  v_pk_add_f32 v[52:53], v[52:53], v[104:105] op_sel_hi:[1,0]
  v_pk_add_f32 v[68:69], v[68:69], v[108:109] op_sel_hi:[1,0]
  v_pk_add_f32 v[84:85], v[84:85], v[112:113] op_sel_hi:[1,0]
  v_pk_add_f32 v[100:101], v[100:101], v[116:117] op_sel_hi:[1,0]
  v_pk_add_f32 v[54:55], v[54:55], v[104:105] op_sel_hi:[1,0]
  v_pk_add_f32 v[70:71], v[70:71], v[108:109] op_sel_hi:[1,0]
  v_pk_add_f32 v[86:87], v[86:87], v[112:113] op_sel_hi:[1,0]
  v_pk_add_f32 v[102:103], v[102:103], v[116:117] op_sel_hi:[1,0]
  v_pk_mul_f32 v[104:105], v[40:41], v[40:41]
  v_pk_mul_f32 v[108:109], v[56:57], v[56:57]
  v_pk_mul_f32 v[112:113], v[72:73], v[72:73]
  v_pk_mul_f32 v[116:117], v[88:89], v[88:89]
  v_pk_fma_f32 v[104:105], v[42:43], v[42:43], v[104:105]
  v_pk_fma_f32 v[108:109], v[58:59], v[58:59], v[108:109]
  v_pk_fma_f32 v[112:113], v[74:75], v[74:75], v[112:113]
  v_pk_fma_f32 v[116:117], v[90:91], v[90:91], v[116:117]
  v_pk_fma_f32 v[104:105], v[44:45], v[44:45], v[104:105]
  v_pk_fma_f32 v[108:109], v[60:61], v[60:61], v[108:109]
  v_pk_fma_f32 v[112:113], v[76:77], v[76:77], v[112:113]
  v_pk_fma_f32 v[116:117], v[92:93], v[92:93], v[116:117]
  v_pk_fma_f32 v[104:105], v[46:47], v[46:47], v[104:105]
  v_pk_fma_f32 v[108:109], v[62:63], v[62:63], v[108:109]
  v_pk_fma_f32 v[112:113], v[78:79], v[78:79], v[112:113]
  v_pk_fma_f32 v[116:117], v[94:95], v[94:95], v[116:117]
  v_pk_fma_f32 v[104:105], v[48:49], v[48:49], v[104:105]
  v_pk_fma_f32 v[108:109], v[64:65], v[64:65], v[108:109]
  v_pk_fma_f32 v[112:113], v[80:81], v[80:81], v[112:113]
  v_pk_fma_f32 v[116:117], v[96:97], v[96:97], v[116:117]
  v_pk_fma_f32 v[104:105], v[50:51], v[50:51], v[104:105]
  v_pk_fma_f32 v[108:109], v[66:67], v[66:67], v[108:109]
  v_pk_fma_f32 v[112:113], v[82:83], v[82:83], v[112:113]
  v_pk_fma_f32 v[116:117], v[98:99], v[98:99], v[116:117]
  v_pk_fma_f32 v[104:105], v[52:53], v[52:53], v[104:105]
  v_pk_fma_f32 v[108:109], v[68:69], v[68:69], v[108:109]
  v_pk_fma_f32 v[112:113], v[84:85], v[84:85], v[112:113]
  v_pk_fma_f32 v[116:117], v[100:101], v[100:101], v[116:117]
  v_pk_fma_f32 v[104:105], v[54:55], v[54:55], v[104:105]
  v_pk_fma_f32 v[108:109], v[70:71], v[70:71], v[108:109]
  v_pk_fma_f32 v[112:113], v[86:87], v[86:87], v[112:113]
  v_pk_fma_f32 v[116:117], v[102:103], v[102:103], v[116:117]
  v_add_f32 v104, v104, v105
  v_add_f32 v108, v108, v109
  v_add_f32 v112, v112, v113
  v_add_f32 v116, v116, v117
  v_add_f32_dpp v104, v104, v104 row_ror:8 row_mask:0xf bank_mask:0xf
  v_add_f32_dpp v108, v108, v108 row_ror:8 row_mask:0xf bank_mask:0xf
  v_add_f32_dpp v112, v112, v112 row_ror:8 row_mask:0xf bank_mask:0xf
  v_add_f32_dpp v116, v116, v116 row_ror:8 row_mask:0xf bank_mask:0xf
  v_add_f32_dpp v104, v104, v104 row_ror:4 row_mask:0xf bank_mask:0xf
  v_add_f32_dpp v108, v108, v108 row_ror:4 row_mask:0xf bank_mask:0xf
  v_add_f32_dpp v112, v112, v112 row_ror:4 row_mask:0xf bank_mask:0xf
  v_add_f32_dpp v116, v116, v116 row_ror:4 row_mask:0xf bank_mask:0xf
  v_add_f32_dpp v104, v104, v104 row_ror:2 row_mask:0xf bank_mask:0xf
  v_add_f32_dpp v108, v108, v108 row_ror:2 row_mask:0xf bank_mask:0xf
  v_add_f32_dpp v112, v112, v112 row_ror:2 row_mask:0xf bank_mask:0xf
  v_add_f32_dpp v116, v116, v116 row_ror:2 row_mask:0xf bank_mask:0xf
  v_add_f32_dpp v104, v104, v104 row_ror:1 row_mask:0xf bank_mask:0xf
  v_add_f32_dpp v108, v108, v108 row_ror:1 row_mask:0xf bank_mask:0xf
  v_add_f32_dpp v112, v112, v112 row_ror:1 row_mask:0xf bank_mask:0xf
  v_add_f32_dpp v116, v116, v116 row_ror:1 row_mask:0xf bank_mask:0xf
  v_mov_b32 v105, v104
  v_mov_b32 v109, v108
  v_mov_b32 v113, v112
  v_mov_b32 v117, v116
  v_permlane16_swap_b32 v105, v104
  v_permlane16_swap_b32 v109, v108
  v_permlane16_swap_b32 v113, v112
  v_permlane16_swap_b32 v117, v116
  v_add_f32 v104, v104, v105
  v_add_f32 v108, v108, v109
  v_add_f32 v112, v112, v113
  v_add_f32 v116, v116, v117
  v_mov_b32 v105, v104
  v_mov_b32 v109, v108
  v_mov_b32 v113, v112
  v_mov_b32 v117, v116
  v_permlane32_swap_b32 v105, v104
  v_permlane32_swap_b32 v109, v108
  v_permlane32_swap_b32 v113, v112
  v_permlane32_swap_b32 v117, v116
  v_add_f32 v104, v104, v105
  v_add_f32 v108, v108, v109
  v_add_f32 v112, v112, v113
  v_add_f32 v116, v116, v117
  v_mul_f32 v104, 0x3a800000, v104
  v_mul_f32 v108, 0x3a800000, v108
  v_mul_f32 v112, 0x3a800000, v112
  v_mul_f32 v116, 0x3a800000, v116
  v_add_f32 v104, 0x3727c5ac, v104
  v_add_f32 v108, 0x3727c5ac, v108
  v_add_f32 v112, 0x3727c5ac, v112
  v_add_f32 v116, 0x3727c5ac, v116
  v_rsq_f32 v104, v104
  v_rsq_f32 v108, v108
  v_rsq_f32 v112, v112
  v_rsq_f32 v116, v116
  v_pk_mul_f32 v[40:41], v[40:41], v[104:105] op_sel_hi:[1,0]
  v_pk_mul_f32 v[56:57], v[56:57], v[108:109] op_sel_hi:[1,0]
  v_pk_mul_f32 v[72:73], v[72:73], v[112:113] op_sel_hi:[1,0]
  v_pk_mul_f32 v[88:89], v[88:89], v[116:117] op_sel_hi:[1,0]
  v_pk_mul_f32 v[42:43], v[42:43], v[104:105] op_sel_hi:[1,0]
  v_pk_mul_f32 v[58:59], v[58:59], v[108:109] op_sel_hi:[1,0]
  v_pk_mul_f32 v[74:75], v[74:75], v[112:113] op_sel_hi:[1,0]
  v_pk_mul_f32 v[90:91], v[90:91], v[116:117] op_sel_hi:[1,0]
  v_pk_mul_f32 v[44:45], v[44:45], v[104:105] op_sel_hi:[1,0]
  v_pk_mul_f32 v[60:61], v[60:61], v[108:109] op_sel_hi:[1,0]
  v_pk_mul_f32 v[76:77], v[76:77], v[112:113] op_sel_hi:[1,0]
  v_pk_mul_f32 v[92:93], v[92:93], v[116:117] op_sel_hi:[1,0]
  v_pk_mul_f32 v[46:47], v[46:47], v[104:105] op_sel_hi:[1,0]
  v_pk_mul_f32 v[62:63], v[62:63], v[108:109] op_sel_hi:[1,0]
  v_pk_mul_f32 v[78:79], v[78:79], v[112:113] op_sel_hi:[1,0]
  v_pk_mul_f32 v[94:95], v[94:95], v[116:117] op_sel_hi:[1,0]
  v_pk_mul_f32 v[48:49], v[48:49], v[104:105] op_sel_hi:[1,0]
  v_pk_mul_f32 v[64:65], v[64:65], v[108:109] op_sel_hi:[1,0]
  v_pk_mul_f32 v[80:81], v[80:81], v[112:113] op_sel_hi:[1,0]
  v_pk_mul_f32 v[96:97], v[96:97], v[116:117] op_sel_hi:[1,0]
  v_pk_mul_f32 v[50:51], v[50:51], v[104:105] op_sel_hi:[1,0]
  v_pk_mul_f32 v[66:67], v[66:67], v[108:109] op_sel_hi:[1,0]
  v_pk_mul_f32 v[82:83], v[82:83], v[112:113] op_sel_hi:[1,0]
  v_pk_mul_f32 v[98:99], v[98:99], v[116:117] op_sel_hi:[1,0]
  v_pk_mul_f32 v[52:53], v[52:53], v[104:105] op_sel_hi:[1,0]
  v_pk_mul_f32 v[68:69], v[68:69], v[108:109] op_sel_hi:[1,0]
  v_pk_mul_f32 v[84:85], v[84:85], v[112:113] op_sel_hi:[1,0]
  v_pk_mul_f32 v[100:101], v[100:101], v[116:117] op_sel_hi:[1,0]
  v_pk_mul_f32 v[54:55], v[54:55], v[104:105] op_sel_hi:[1,0]
  v_pk_mul_f32 v[70:71], v[70:71], v[108:109] op_sel_hi:[1,0]
  v_pk_mul_f32 v[86:87], v[86:87], v[112:113] op_sel_hi:[1,0]
  v_pk_mul_f32 v[102:103], v[102:103], v[116:117] op_sel_hi:[1,0]
  v_min_u32 v3, 31, v0
  v_lshlrev_b32 v3, 2, v3
  v_add_u32 v3, 128, v3
  s_nop 1
Lpoll_3:
  buffer_load_dword v4, v3, s[12:15], 0 offen sc1
  s_sub_u32 s24, s24, 1
  s_cbranch_scc1 L_FAIL
  s_waitcnt vmcnt(0)
  v_cmp_gt_i32 vcc, 1, v4
  s_cbranch_vccz Lpolld_4
  s_sleep 2
  s_branch Lpoll_3
Lpolld_4:
  v_min_u32 v3, 31, v0
  v_lshlrev_b32 v3, 7, v3
  v_add_u32 v3, 1376256, v3
  s_nop 1
Lpoll_5:
  buffer_load_dword v4, v3, s[4:7], 0 offen sc1
  s_sub_u32 s24, s24, 1
  s_cbranch_scc1 L_FAIL
  s_waitcnt vmcnt(0)
  v_cmp_gt_i32 vcc, 1, v4
  s_cbranch_vccz Lpolld_6
  s_sleep 2
  s_branch Lpoll_5
Lpolld_6:
  s_mov_b32 s40, 1572864
  buffer_load_dwordx4 v[136:139], v2, s[4:7], s40 offen offset:0 sc1
  buffer_load_dwordx4 v[140:143], v2, s[4:7], s40 offen offset:1024 sc1
  buffer_load_dwordx4 v[144:147], v2, s[4:7], s40 offen offset:2048 sc1
  buffer_load_dwordx4 v[148:151], v2, s[4:7], s40 offen offset:3072 sc1
  s_mov_b32 s40, 1576960
  buffer_load_dwordx4 v[120:123], v2, s[4:7], s40 offen offset:0 sc1
  buffer_load_dwordx4 v[124:127], v2, s[4:7], s40 offen offset:1024 sc1
  buffer_load_dwordx4 v[128:131], v2, s[4:7], s40 offen offset:2048 sc1
  buffer_load_dwordx4 v[132:135], v2, s[4:7], s40 offen offset:3072 sc1
  s_waitcnt vmcnt(0)
  v_add_f32 v120, 1.0, v120
  v_add_f32 v121, 1.0, v121
  v_add_f32 v122, 1.0, v122
  v_add_f32 v123, 1.0, v123
  v_add_f32 v124, 1.0, v124
  v_add_f32 v125, 1.0, v125
  v_add_f32 v126, 1.0, v126
  v_add_f32 v127, 1.0, v127
  v_add_f32 v128, 1.0, v128
  v_add_f32 v129, 1.0, v129
  v_add_f32 v130, 1.0, v130
  v_add_f32 v131, 1.0, v131
  v_add_f32 v132, 1.0, v132
  v_add_f32 v133, 1.0, v133
  v_add_f32 v134, 1.0, v134
  v_add_f32 v135, 1.0, v135
  s_add_u32 s44, s44, 2097152
  s_add_u32 s45, s45, 2097152
  v_pk_fma_f32 v[40:41], v[40:41], v[120:121], v[136:137]
  v_pk_fma_f32 v[42:43], v[42:43], v[122:123], v[138:139]
  v_pk_fma_f32 v[44:45], v[44:45], v[124:125], v[140:141]
  v_pk_fma_f32 v[46:47], v[46:47], v[126:127], v[142:143]
  v_pk_fma_f32 v[48:49], v[48:49], v[128:129], v[144:145]
  v_pk_fma_f32 v[50:51], v[50:51], v[130:131], v[146:147]
  v_pk_fma_f32 v[52:53], v[52:53], v[132:133], v[148:149]
  v_pk_fma_f32 v[54:55], v[54:55], v[134:135], v[150:151]
  v_cvt_pk_bf16_f32 v8, v40, v41
  v_cvt_pk_bf16_f32 v9, v42, v43
  v_cvt_pk_bf16_f32 v10, v44, v45
  v_cvt_pk_bf16_f32 v11, v46, v47
  v_cvt_pk_bf16_f32 v12, v48, v49
  v_cvt_pk_bf16_f32 v13, v50, v51
  v_cvt_pk_bf16_f32 v14, v52, v53
  v_cvt_pk_bf16_f32 v15, v54, v55
  buffer_store_dwordx4 v[8:11], v2, s[4:7], s44 offen offset:0 sc1
  buffer_store_dwordx4 v[12:15], v2, s[4:7], s44 offen offset:1024 sc1
  v_pk_fma_f32 v[56:57], v[56:57], v[120:121], v[136:137]
  v_pk_fma_f32 v[58:59], v[58:59], v[122:123], v[138:139]
  v_pk_fma_f32 v[60:61], v[60:61], v[124:125], v[140:141]
  v_pk_fma_f32 v[62:63], v[62:63], v[126:127], v[142:143]
  v_pk_fma_f32 v[64:65], v[64:65], v[128:129], v[144:145]
  v_pk_fma_f32 v[66:67], v[66:67], v[130:131], v[146:147]
  v_pk_fma_f32 v[68:69], v[68:69], v[132:133], v[148:149]
  v_pk_fma_f32 v[70:71], v[70:71], v[134:135], v[150:151]
  v_cvt_pk_bf16_f32 v16, v56, v57
  v_cvt_pk_bf16_f32 v17, v58, v59
  v_cvt_pk_bf16_f32 v18, v60, v61
  v_cvt_pk_bf16_f32 v19, v62, v63
  v_cvt_pk_bf16_f32 v20, v64, v65
  v_cvt_pk_bf16_f32 v21, v66, v67
  v_cvt_pk_bf16_f32 v22, v68, v69
  v_cvt_pk_bf16_f32 v23, v70, v71
  buffer_store_dwordx4 v[16:19], v2, s[4:7], s44 offen offset:2048 sc1
  buffer_store_dwordx4 v[20:23], v2, s[4:7], s44 offen offset:3072 sc1
  v_pk_fma_f32 v[72:73], v[72:73], v[120:121], v[136:137]
  v_pk_fma_f32 v[74:75], v[74:75], v[122:123], v[138:139]
  v_pk_fma_f32 v[76:77], v[76:77], v[124:125], v[140:141]
  v_pk_fma_f32 v[78:79], v[78:79], v[126:127], v[142:143]
  v_pk_fma_f32 v[80:81], v[80:81], v[128:129], v[144:145]
  v_pk_fma_f32 v[82:83], v[82:83], v[130:131], v[146:147]
  v_pk_fma_f32 v[84:85], v[84:85], v[132:133], v[148:149]
  v_pk_fma_f32 v[86:87], v[86:87], v[134:135], v[150:151]
  v_cvt_pk_bf16_f32 v24, v72, v73
  v_cvt_pk_bf16_f32 v25, v74, v75
  v_cvt_pk_bf16_f32 v26, v76, v77
  v_cvt_pk_bf16_f32 v27, v78, v79
  v_cvt_pk_bf16_f32 v28, v80, v81
  v_cvt_pk_bf16_f32 v29, v82, v83
  v_cvt_pk_bf16_f32 v30, v84, v85
  v_cvt_pk_bf16_f32 v31, v86, v87
  buffer_store_dwordx4 v[24:27], v2, s[4:7], s45 offen offset:0 sc1
  buffer_store_dwordx4 v[28:31], v2, s[4:7], s45 offen offset:1024 sc1
  v_pk_fma_f32 v[88:89], v[88:89], v[120:121], v[136:137]
  v_pk_fma_f32 v[90:91], v[90:91], v[122:123], v[138:139]
  v_pk_fma_f32 v[92:93], v[92:93], v[124:125], v[140:141]
  v_pk_fma_f32 v[94:95], v[94:95], v[126:127], v[142:143]
  v_pk_fma_f32 v[96:97], v[96:97], v[128:129], v[144:145]
  v_pk_fma_f32 v[98:99], v[98:99], v[130:131], v[146:147]
  v_pk_fma_f32 v[100:101], v[100:101], v[132:133], v[148:149]
  v_pk_fma_f32 v[102:103], v[102:103], v[134:135], v[150:151]
  v_cvt_pk_bf16_f32 v32, v88, v89
  v_cvt_pk_bf16_f32 v33, v90, v91
  v_cvt_pk_bf16_f32 v34, v92, v93
  v_cvt_pk_bf16_f32 v35, v94, v95
  v_cvt_pk_bf16_f32 v36, v96, v97
  v_cvt_pk_bf16_f32 v37, v98, v99
  v_cvt_pk_bf16_f32 v38, v100, v101
  v_cvt_pk_bf16_f32 v39, v102, v103
  buffer_store_dwordx4 v[32:35], v2, s[4:7], s45 offen offset:2048 sc1
  buffer_store_dwordx4 v[36:39], v2, s[4:7], s45 offen offset:3072 sc1
  s_lshr_b32 s40, s43, 3
  s_lshl_b32 s40, s40, 7
  s_and_b32 s41, s43, 7
  s_lshl_b32 s41, s41, 2
  s_add_u32 s40, s40, s41
  s_add_u32 s40, s40, 1388544
  v_mov_b32 v3, 2147483392
  s_mov_b64 exec, 1
  v_mov_b32 v3, s40
  s_mov_b64 exec, -1
  v_mov_b32 v4, 1
  s_waitcnt vmcnt(0)
  buffer_store_dword v4, v3, s[4:7], 0 offen sc1
  s_cmp_lg_u32 s20, 2
  s_cbranch_scc1 Lnotlb_7
  v_lshlrev_b32 v1, 21, v0
  s_mov_b32 s40, 0x1fff80
  buffer_load_dword v2, v1, s[4:7], s40 offen
  s_add_u32 s40, s40, 134217728
  buffer_load_dword v2, v1, s[4:7], s40 offen
  s_waitcnt vmcnt(0)
Lnotlb_7:
  s_mov_b32 s40, 1404928
  s_cmp_lt_u32 s22, 6
  s_cselect_b32 s40, 1404928, s40
  v_mov_b32 v1, s40
  s_nop 1
Lpoll_8:
  buffer_load_dword v2, v1, s[4:7], 0 offen sc1
  s_sub_u32 s24, s24, 1
  s_cbranch_scc1 L_FAIL
  s_waitcnt vmcnt(0)
  v_cmp_gt_i32 vcc, 0, v2
  s_cbranch_vccz Lpolld_9
  s_sleep 8
  s_branch Lpoll_8
Lpolld_9:
  s_sub_u32 s40, s22, 3
  s_lshl_b32 s40, s40, 5
  s_add_u32 s21, s40, s23
  s_cmp_lt_u32 s22, 6
  s_cbranch_scc1 L_MOD
L_ROLE:
  s_sub_u32 s21, s3, 128
  s_cmp_lt_u32 s3, 160
  s_cbranch_scc1 L_WO
  s_sub_u32 s21, s3, 160
  s_cmp_lt_u32 s3, 216
  s_cbranch_scc1 L_F1
  s_sub_u32 s21, s3, 216
  s_cmp_lt_u32 s3, 224
  s_cbranch_scc1 L_LN2
  s_sub_u32 s21, s3, 224
  s_cmp_lt_u32 s3, 248
  s_cbranch_scc1 L_F2
  s_sub_u32 s21, s3, 248
  s_branch L_FIN
L_FAIL:
  s_mov_b64 exec, -1
  s_lshl_b32 s40, s2, 8
  s_add_u32 s40, s40, s25
  s_add_u32 s40, s40, 0x70000000
  v_mov_b32 v1, 60
  v_mov_b32 v2, s40
  buffer_store_dword v2, v1, s[12:15], 0 offen
L_END:
  s_endpgm
L_LN2:
  s_load_dwordx2 s[16:17], s[0:1], 0
  s_mov_b32 s18, 4194304
  s_mov_b32 s19, 0x20000
  s_waitcnt lgkmcnt(0)
  s_mov_b32 s25, 0
  s_mov_b32 s29, 1
  s_mov_b32 s26, 0
  s_cmp_eq_u32 s20, 0
  s_cselect_b32 s31, 0, 2147483392
  s_lshl_b32 s40, s21, 8
  s_lshl_b32 s41, s20, 15
  s_add_u32 s40, s40, s41
  v_and_b32 v6, 15, v0
  v_lshl_add_u32 v1, v6, 4, s40
  v_lshrrev_b32 v6, 4, v0
  v_lshl_add_u32 v1, v6, 11, v1
  v_and_b32 v6, 3, v0
  v_lshrrev_b32 v7, 5, v0
  v_lshrrev_b32 v8, 2, v0
  s_lshl_b32 s40, s20, 10
  v_lshl_add_u32 v5, v8, 4, s40
  s_lshl_b32 s40, s21, 13
  s_lshl_b32 s41, s20, 9
  s_add_u32 s40, s40, s41
  v_and_b32 v9, 31, v0
  v_lshl_add_u32 v10, v9, 4, s40
  v_lshl_add_u32 v10, v7, 11, v10
  v_min_u32 v16, 63, v0
  v_lshlrev_b32 v16, 7, v16
  v_add_u32 v16, 1424384, v16
  s_nop 1
Lpoll_10:
  buffer_load_dword v17, v16, s[4:7], 0 offen sc1
  s_sub_u32 s24, s24, 1
  s_cbranch_scc1 L_FAIL
  s_waitcnt vmcnt(0)
  v_cmp_gt_i32 vcc, 0, v17
  s_cbranch_vccz Lpolld_11
  s_sleep 1
  s_branch Lpoll_10
Lpolld_11:
  v_lshrrev_b32 v17, 8, v17
  v_and_b32 v18, 3, v0
  v_lshl_or_b32 v17, v17, 2, v18
  s_nop 1
  v_min_u32_dpp v17, v17, v17 row_ror:8 row_mask:0xf bank_mask:0xf
  s_nop 1
  v_min_u32_dpp v17, v17, v17 row_ror:4 row_mask:0xf bank_mask:0xf
  v_mov_b32 v18, v17
  s_nop 1
  v_permlane16_swap_b32 v18, v17
  v_min_u32 v17, v17, v18
  v_mov_b32 v18, v17
  s_nop 1
  v_permlane32_swap_b32 v18, v17
  v_min_u32 v17, v17, v18
  s_nop 1
  v_min_u32_dpp v17, v17, v17 row_ror:2 row_mask:0xf bank_mask:0xf
  s_nop 1
  v_min_u32_dpp v17, v17, v17 row_ror:1 row_mask:0xf bank_mask:0xf
  s_nop 0
  v_readfirstlane_b32 s27, v17
  s_and_b32 s27, s27, 3
  s_lshl_b32 s27, s27, 13
  s_and_b32 s27, s27, 0x2000
  s_xor_b32 s27, s27, 16785408
  v_min_u32 v2, 63, v0
  v_lshlrev_b32 v2, 7, v2
  v_add_u32 v2, 1380352, v2
  s_nop 1
Lpoll_12:
  buffer_load_dword v3, v2, s[4:7], 0 offen sc1
  s_sub_u32 s24, s24, 1
  s_cbranch_scc1 L_FAIL
  s_waitcnt vmcnt(0)
  v_cmp_gt_i32 vcc, 1, v3
  s_cbranch_vccz Lpolld_13
  s_sleep 2
  s_branch Lpoll_12
Lpolld_13:
  s_mov_b32 s40, 1585152
  buffer_load_dwordx4 v[64:67], v5, s[4:7], s40 offen offset:0 sc1
  buffer_load_dwordx4 v[68:71], v5, s[4:7], s40 offen offset:256 sc1
  buffer_load_dwordx4 v[72:75], v5, s[4:7], s40 offen offset:512 sc1
  buffer_load_dwordx4 v[76:79], v5, s[4:7], s40 offen offset:768 sc1
  s_mov_b32 s40, 1589248
  buffer_load_dwordx4 v[80:83], v5, s[4:7], s40 offen offset:0 sc1
  buffer_load_dwordx4 v[84:87], v5, s[4:7], s40 offen offset:256 sc1
  buffer_load_dwordx4 v[88:91], v5, s[4:7], s40 offen offset:512 sc1
  buffer_load_dwordx4 v[92:95], v5, s[4:7], s40 offen offset:768 sc1
  s_mov_b32 s40, 1581056
  buffer_load_dwordx4 v[48:51], v5, s[4:7], s40 offen offset:0 sc1
  buffer_load_dwordx4 v[52:55], v5, s[4:7], s40 offen offset:256 sc1
  buffer_load_dwordx4 v[56:59], v5, s[4:7], s40 offen offset:512 sc1
  buffer_load_dwordx4 v[60:63], v5, s[4:7], s40 offen offset:768 sc1
  s_waitcnt vmcnt(0)
  v_lshrrev_b32 v48, 16, v48
  v_lshrrev_b32 v50, 16, v50
  v_lshrrev_b32 v52, 16, v52
  v_lshrrev_b32 v54, 16, v54
  v_lshrrev_b32 v56, 16, v56
  v_lshrrev_b32 v58, 16, v58
  v_lshrrev_b32 v60, 16, v60
  v_lshrrev_b32 v62, 16, v62
  v_add_f32 v80, 1.0, v80
  v_add_f32 v81, 1.0, v81
  v_add_f32 v82, 1.0, v82
  v_add_f32 v83, 1.0, v83
  v_add_f32 v84, 1.0, v84
  v_add_f32 v85, 1.0, v85
  v_add_f32 v86, 1.0, v86
  v_add_f32 v87, 1.0, v87
  v_add_f32 v88, 1.0, v88
  v_add_f32 v89, 1.0, v89
  v_add_f32 v90, 1.0, v90
  v_add_f32 v91, 1.0, v91
  v_add_f32 v92, 1.0, v92
  v_add_f32 v93, 1.0, v93
  v_add_f32 v94, 1.0, v94
  v_add_f32 v95, 1.0, v95
  v_min_u32 v2, 31, v0
  v_lshlrev_b32 v2, 7, v2
  v_add_u32 v2, 1409024, v2
  s_lshl_b32 s62, s21, 7
  s_add_u32 s62, s62, 1413120
  s_lshl_b32 s30, s20, 11
  v_lshl_add_u32 v11, v6, 9, s30
  v_lshl_add_u32 v11, v8, 3, v11
  s_lshl_b32 s40, s20, 5
  s_add_u32 s40, s40, 8192
  v_lshl_add_u32 v12, v6, 3, s40
  v_lshlrev_b32 v13, 3, v6
  v_add_u32 v13, 8192, v13
  s_add_u32 m0, s30, 0
  s_add_u32 s40, s26, 0
  buffer_load_dwordx4 v10, s[16:19], s40 offen nt lds
  s_add_u32 m0, s30, 1024
  s_add_u32 s40, s26, 4096
  buffer_load_dwordx4 v10, s[16:19], s40 offen nt lds
  buffer_load_dword v3, v2, s[4:7], s31 offen sc1
  s_waitcnt vmcnt(1)
  ds_read_b64 v[24:25], v11 offset:0
  ds_read_b64 v[26:27], v11 offset:128
  ds_read_b64 v[28:29], v11 offset:256
  ds_read_b64 v[30:31], v11 offset:384
  s_waitcnt lgkmcnt(0)
L_LN2_top:
  v_lshlrev_b32 v96, 16, v24
  v_and_b32 v97, 0xffff0000, v24
  v_lshlrev_b32 v98, 16, v25
  v_and_b32 v99, 0xffff0000, v25
  v_lshlrev_b32 v100, 16, v26
  v_and_b32 v101, 0xffff0000, v26
  v_lshlrev_b32 v102, 16, v27
  v_and_b32 v103, 0xffff0000, v27
  v_lshlrev_b32 v104, 16, v28
  v_and_b32 v105, 0xffff0000, v28
  v_lshlrev_b32 v106, 16, v29
  v_and_b32 v107, 0xffff0000, v29
  v_lshlrev_b32 v108, 16, v30
  v_and_b32 v109, 0xffff0000, v30
  v_lshlrev_b32 v110, 16, v31
  v_and_b32 v111, 0xffff0000, v31
  s_cmp_lg_u32 s20, 0
  s_cbranch_scc1 Lgo_14
  s_waitcnt vmcnt(0)
  v_cmp_gt_i32 vcc, s29, v3
  s_cbranch_vccz Lgo_14
  s_nop 3
Lpoll_15:
  buffer_load_dword v3, v2, s[4:7], 0 offen sc1
  s_sub_u32 s24, s24, 1
  s_cbranch_scc1 L_FAIL
  s_waitcnt vmcnt(0)
  v_cmp_gt_i32 vcc, s29, v3
  s_cbranch_vccz Lpolld_16
  s_sleep 1
  s_branch Lpoll_15
Lpolld_16:
Lgo_14:
  s_barrier
  s_add_u32 s40, s27, 0
  buffer_load_dwordx4 v[112:115], v1, s[4:7], s40 offen sc1
  s_add_u32 s40, s27, 16384
  buffer_load_dwordx4 v[116:119], v1, s[4:7], s40 offen sc1
  s_add_u32 s40, s27, 131072
  buffer_load_dwordx4 v[120:123], v1, s[4:7], s40 offen sc1
  s_add_u32 s40, s27, 147456
  buffer_load_dwordx4 v[124:127], v1, s[4:7], s40 offen sc1
  s_add_u32 s40, s27, 262144
  buffer_load_dwordx4 v[128:131], v1, s[4:7], s40 offen sc1
  s_add_u32 s40, s27, 278528
  buffer_load_dwordx4 v[132:135], v1, s[4:7], s40 offen sc1
  s_add_u32 s40, s27, 393216
  buffer_load_dwordx4 v[136:139], v1, s[4:7], s40 offen sc1
  s_add_u32 s40, s27, 409600
  buffer_load_dwordx4 v[140:143], v1, s[4:7], s40 offen sc1
  s_add_u32 m0, s30, 0
  s_add_u32 s40, s26, 65536
  buffer_load_dwordx4 v10, s[16:19], s40 offen nt lds
  s_add_u32 m0, s30, 1024
  s_add_u32 s40, s26, 69632
  buffer_load_dwordx4 v10, s[16:19], s40 offen nt lds
  s_waitcnt vmcnt(9)
  v_dot2c_f32_bf16 v96, v112, v48
  v_dot2c_f32_bf16 v97, v112, v49
  v_dot2c_f32_bf16 v98, v113, v50
  v_dot2c_f32_bf16 v99, v113, v51
  v_dot2c_f32_bf16 v100, v114, v52
  v_dot2c_f32_bf16 v101, v114, v53
  v_dot2c_f32_bf16 v102, v115, v54
  v_dot2c_f32_bf16 v103, v115, v55
  s_waitcnt vmcnt(8)
  v_dot2c_f32_bf16 v104, v116, v56
  v_dot2c_f32_bf16 v105, v116, v57
  v_dot2c_f32_bf16 v106, v117, v58
  v_dot2c_f32_bf16 v107, v117, v59
  v_dot2c_f32_bf16 v108, v118, v60
  v_dot2c_f32_bf16 v109, v118, v61
  v_dot2c_f32_bf16 v110, v119, v62
  v_dot2c_f32_bf16 v111, v119, v63
  s_waitcnt vmcnt(7)
  v_dot2c_f32_bf16 v96, v120, v48
  v_dot2c_f32_bf16 v97, v120, v49
  v_dot2c_f32_bf16 v98, v121, v50
  v_dot2c_f32_bf16 v99, v121, v51
  v_dot2c_f32_bf16 v100, v122, v52
  v_dot2c_f32_bf16 v101, v122, v53
  v_dot2c_f32_bf16 v102, v123, v54
  v_dot2c_f32_bf16 v103, v123, v55
  s_waitcnt vmcnt(6)
  v_dot2c_f32_bf16 v104, v124, v56
  v_dot2c_f32_bf16 v105, v124, v57
  v_dot2c_f32_bf16 v106, v125, v58
  v_dot2c_f32_bf16 v107, v125, v59
  v_dot2c_f32_bf16 v108, v126, v60
  v_dot2c_f32_bf16 v109, v126, v61
  v_dot2c_f32_bf16 v110, v127, v62
  v_dot2c_f32_bf16 v111, v127, v63
  s_waitcnt vmcnt(5)
  v_dot2c_f32_bf16 v96, v128, v48
  v_dot2c_f32_bf16 v97, v128, v49
  v_dot2c_f32_bf16 v98, v129, v50
  v_dot2c_f32_bf16 v99, v129, v51
  v_dot2c_f32_bf16 v100, v130, v52
  v_dot2c_f32_bf16 v101, v130, v53
  v_dot2c_f32_bf16 v102, v131, v54
  v_dot2c_f32_bf16 v103, v131, v55
  s_waitcnt vmcnt(4)
  v_dot2c_f32_bf16 v104, v132, v56
  v_dot2c_f32_bf16 v105, v132, v57
  v_dot2c_f32_bf16 v106, v133, v58
  v_dot2c_f32_bf16 v107, v133, v59
  v_dot2c_f32_bf16 v108, v134, v60
  v_dot2c_f32_bf16 v109, v134, v61
  v_dot2c_f32_bf16 v110, v135, v62
  v_dot2c_f32_bf16 v111, v135, v63
  s_waitcnt vmcnt(3)
  v_dot2c_f32_bf16 v96, v136, v48
  v_dot2c_f32_bf16 v97, v136, v49
  v_dot2c_f32_bf16 v98, v137, v50
  v_dot2c_f32_bf16 v99, v137, v51
  v_dot2c_f32_bf16 v100, v138, v52
  v_dot2c_f32_bf16 v101, v138, v53
  v_dot2c_f32_bf16 v102, v139, v54
  v_dot2c_f32_bf16 v103, v139, v55
  s_waitcnt vmcnt(2)
  v_dot2c_f32_bf16 v104, v140, v56
  v_dot2c_f32_bf16 v105, v140, v57
  v_dot2c_f32_bf16 v106, v141, v58
  v_dot2c_f32_bf16 v107, v141, v59
  v_dot2c_f32_bf16 v108, v142, v60
  v_dot2c_f32_bf16 v109, v142, v61
  v_dot2c_f32_bf16 v110, v143, v62
  v_dot2c_f32_bf16 v111, v143, v63
  s_nop 2
  v_pk_add_f32 v[32:33], v[96:97], v[98:99]
  v_pk_add_f32 v[32:33], v[32:33], v[100:101]
  v_pk_add_f32 v[32:33], v[32:33], v[102:103]
  v_pk_add_f32 v[32:33], v[32:33], v[104:105]
  v_pk_add_f32 v[32:33], v[32:33], v[106:107]
  v_pk_add_f32 v[32:33], v[32:33], v[108:109]
  v_pk_add_f32 v[32:33], v[32:33], v[110:111]
  v_add_f32 v32, v32, v33
  s_nop 1
  v_add_f32_dpp v32, v32, v32 row_ror:4 row_mask:0xf bank_mask:0xf
  s_nop 1
  v_add_f32_dpp v32, v32, v32 row_ror:8 row_mask:0xf bank_mask:0xf
  v_mov_b32 v33, v32
  s_nop 1
  v_permlane16_swap_b32 v33, v32
  v_add_f32 v32, v32, v33
  v_mov_b32 v33, v32
  s_nop 1
  v_permlane32_swap_b32 v33, v32
  v_add_f32 v32, v32, v33
  v_mul_f32 v32, 0x3b800000, v32
  v_pk_add_f32 v[112:113], v[96:97], v[32:33] op_sel_hi:[1,0] neg_lo:[0,1] neg_hi:[0,1]
  v_pk_add_f32 v[114:115], v[98:99], v[32:33] op_sel_hi:[1,0] neg_lo:[0,1] neg_hi:[0,1]
  v_pk_add_f32 v[116:117], v[100:101], v[32:33] op_sel_hi:[1,0] neg_lo:[0,1] neg_hi:[0,1]
  v_pk_add_f32 v[118:119], v[102:103], v[32:33] op_sel_hi:[1,0] neg_lo:[0,1] neg_hi:[0,1]
  v_pk_add_f32 v[120:121], v[104:105], v[32:33] op_sel_hi:[1,0] neg_lo:[0,1] neg_hi:[0,1]
  v_pk_add_f32 v[122:123], v[106:107], v[32:33] op_sel_hi:[1,0] neg_lo:[0,1] neg_hi:[0,1]
  v_pk_add_f32 v[124:125], v[108:109], v[32:33] op_sel_hi:[1,0] neg_lo:[0,1] neg_hi:[0,1]
  v_pk_add_f32 v[126:127], v[110:111], v[32:33] op_sel_hi:[1,0] neg_lo:[0,1] neg_hi:[0,1]
  v_pk_mul_f32 v[34:35], v[112:113], v[112:113]
  v_pk_fma_f32 v[34:35], v[114:115], v[114:115], v[34:35]
  v_pk_fma_f32 v[34:35], v[116:117], v[116:117], v[34:35]
  v_pk_fma_f32 v[34:35], v[118:119], v[118:119], v[34:35]
  v_pk_fma_f32 v[34:35], v[120:121], v[120:121], v[34:35]
  v_pk_fma_f32 v[34:35], v[122:123], v[122:123], v[34:35]
  v_pk_fma_f32 v[34:35], v[124:125], v[124:125], v[34:35]
  v_pk_fma_f32 v[34:35], v[126:127], v[126:127], v[34:35]
  v_add_f32 v34, v34, v35
  s_nop 1
  v_add_f32_dpp v34, v34, v34 row_ror:4 row_mask:0xf bank_mask:0xf
  s_nop 1
  v_add_f32_dpp v34, v34, v34 row_ror:8 row_mask:0xf bank_mask:0xf
  v_mov_b32 v35, v34
  s_nop 1
  v_permlane16_swap_b32 v35, v34
  v_add_f32 v34, v34, v35
  v_mov_b32 v35, v34
  s_nop 1
  v_permlane32_swap_b32 v35, v34
  v_add_f32 v34, v34, v35
  v_mov_b32 v33, v34
  ds_write_b64 v12, v[32:33]
  v_cvt_pk_bf16_f32 v16, v96, v97
  v_cvt_pk_bf16_f32 v17, v98, v99
  v_cvt_pk_bf16_f32 v18, v100, v101
  v_cvt_pk_bf16_f32 v19, v102, v103
  v_cvt_pk_bf16_f32 v20, v104, v105
  v_cvt_pk_bf16_f32 v21, v106, v107
  v_cvt_pk_bf16_f32 v22, v108, v109
  v_cvt_pk_bf16_f32 v23, v110, v111
  s_waitcnt lgkmcnt(0)
  s_barrier
  ds_read2_b64 v[36:39], v13 offset0:0 offset1:4
  ds_read2_b64 v[40:43], v13 offset0:8 offset1:12
  s_add_u32 s40, s27, 1048576
  buffer_store_dwordx4 v[16:19], v1, s[4:7], s40 offen sc1
  s_add_u32 s40, s27, 1064960
  buffer_store_dwordx4 v[20:23], v1, s[4:7], s40 offen sc1
  s_waitcnt lgkmcnt(0)
  v_pk_add_f32 v[34:35], v[36:37], v[38:39]
  v_pk_add_f32 v[44:45], v[40:41], v[42:43]
  v_pk_add_f32 v[34:35], v[34:35], v[44:45]
  v_mul_f32 v34, 0x3e800000, v34
  v_mul_f32 v35, 0x3b800000, v35
  v_sub_f32 v36, v36, v34
  v_sub_f32 v38, v38, v34
  v_sub_f32 v40, v40, v34
  v_sub_f32 v42, v42, v34
  v_fmac_f32 v35, v36, v36
  v_fmac_f32 v35, v38, v38
  v_fmac_f32 v35, v40, v40
  v_fmac_f32 v35, v42, v42
  v_mul_f32 v35, 0x3e800000, v35
  v_add_f32 v35, 0x3727c5ac, v35
  v_rsq_f32 v44, v35
  v_sub_f32 v32, v32, v34
  v_mul_f32 v32, v32, v44
  v_pk_fma_f32 v[112:113], v[112:113], v[44:45], v[32:33] op_sel_hi:[1,0,0]
  v_pk_fma_f32 v[114:115], v[114:115], v[44:45], v[32:33] op_sel_hi:[1,0,0]
  v_pk_fma_f32 v[116:117], v[116:117], v[44:45], v[32:33] op_sel_hi:[1,0,0]
  v_pk_fma_f32 v[118:119], v[118:119], v[44:45], v[32:33] op_sel_hi:[1,0,0]
  v_pk_fma_f32 v[112:113], v[112:113], v[80:81], v[64:65]
  v_pk_fma_f32 v[114:115], v[114:115], v[82:83], v[66:67]
  v_pk_fma_f32 v[116:117], v[116:117], v[84:85], v[68:69]
  v_pk_fma_f32 v[118:119], v[118:119], v[86:87], v[70:71]
  v_cvt_pk_bf16_f32 v128, v112, v113
  v_cvt_pk_bf16_f32 v129, v114, v115
  v_cvt_pk_bf16_f32 v130, v116, v117
  v_cvt_pk_bf16_f32 v131, v118, v119
  s_add_u32 s40, s27, 917504
  buffer_store_dwordx4 v[128:131], v1, s[4:7], s40 offen sc1
  v_pk_fma_f32 v[120:121], v[120:121], v[44:45], v[32:33] op_sel_hi:[1,0,0]
  v_pk_fma_f32 v[122:123], v[122:123], v[44:45], v[32:33] op_sel_hi:[1,0,0]
  v_pk_fma_f32 v[124:125], v[124:125], v[44:45], v[32:33] op_sel_hi:[1,0,0]
  v_pk_fma_f32 v[126:127], v[126:127], v[44:45], v[32:33] op_sel_hi:[1,0,0]
  v_pk_fma_f32 v[120:121], v[120:121], v[88:89], v[72:73]
  v_pk_fma_f32 v[122:123], v[122:123], v[90:91], v[74:75]
  v_pk_fma_f32 v[124:125], v[124:125], v[92:93], v[76:77]
  v_pk_fma_f32 v[126:127], v[126:127], v[94:95], v[78:79]
  v_cvt_pk_bf16_f32 v132, v120, v121
  v_cvt_pk_bf16_f32 v133, v122, v123
  v_cvt_pk_bf16_f32 v134, v124, v125
  v_cvt_pk_bf16_f32 v135, v126, v127
  s_add_u32 s40, s27, 933888
  buffer_store_dwordx4 v[132:135], v1, s[4:7], s40 offen sc1
  buffer_load_dword v3, v2, s[4:7], s31 offen sc1
  s_waitcnt vmcnt(5)
  ds_read_b64 v[24:25], v11 offset:0
  ds_read_b64 v[26:27], v11 offset:128
  ds_read_b64 v[28:29], v11 offset:256
  ds_read_b64 v[30:31], v11 offset:384
  s_waitcnt vmcnt(1) lgkmcnt(0)
  s_barrier
  s_cmp_lg_u32 s20, 0
  s_cbranch_scc1 Lnosig_17
  s_mov_b32 s63, s29
  s_atomic_smax s63, s[4:5], s62 glc
Lnosig_17:
  s_add_u32 s25, s25, 1
  s_add_u32 s29, s29, 1
  s_add_u32 s26, s26, 65536
  s_add_u32 s27, s27, 2097152
  s_xor_b32 s27, s27, 0x2000
  s_cmp_lt_u32 s25, 64
  s_cbranch_scc1 L_LN2_top
  s_branch L_END
L_FIN:
  s_load_dwordx2 s[16:17], s[0:1], 104
  s_mov_b32 s18, 4194304
  s_mov_b32 s19, 0x20000
  s_waitcnt lgkmcnt(0)
  s_mov_b32 s25, 0
  s_mov_b32 s29, 1
  s_mov_b32 s26, 0
  s_cmp_eq_u32 s20, 0
  s_cselect_b32 s31, 0, 2147483392
  s_lshl_b32 s40, s21, 8
  s_lshl_b32 s41, s20, 15
  s_add_u32 s40, s40, s41
  v_and_b32 v6, 15, v0
  v_lshl_add_u32 v1, v6, 4, s40
  v_lshrrev_b32 v6, 4, v0
  v_lshl_add_u32 v1, v6, 11, v1
  v_and_b32 v6, 3, v0
  v_lshrrev_b32 v7, 5, v0
  v_lshrrev_b32 v8, 2, v0
  s_lshl_b32 s40, s20, 10
  v_lshl_add_u32 v5, v8, 4, s40
  s_lshl_b32 s40, s21, 13
  s_lshl_b32 s41, s20, 9
  s_add_u32 s40, s40, s41
  v_and_b32 v9, 31, v0
  v_lshl_add_u32 v10, v9, 4, s40
  v_lshl_add_u32 v10, v7, 11, v10
  v_min_u32 v16, 63, v0
  v_lshlrev_b32 v16, 7, v16
  v_add_u32 v16, 1424384, v16
  s_nop 1
Lpoll_18:
  buffer_load_dword v17, v16, s[4:7], 0 offen sc1
  s_sub_u32 s24, s24, 1
  s_cbranch_scc1 L_FAIL
  s_waitcnt vmcnt(0)
  v_cmp_gt_i32 vcc, 0, v17
  s_cbranch_vccz Lpolld_19
  s_sleep 1
  s_branch Lpoll_18
Lpolld_19:
  v_lshrrev_b32 v17, 8, v17
  v_and_b32 v18, 3, v0
  v_lshl_or_b32 v17, v17, 2, v18
  s_nop 1
  v_min_u32_dpp v17, v17, v17 row_ror:8 row_mask:0xf bank_mask:0xf
  s_nop 1
  v_min_u32_dpp v17, v17, v17 row_ror:4 row_mask:0xf bank_mask:0xf
  v_mov_b32 v18, v17
  s_nop 1
  v_permlane16_swap_b32 v18, v17
  v_min_u32 v17, v17, v18
  v_mov_b32 v18, v17
  s_nop 1
  v_permlane32_swap_b32 v18, v17
  v_min_u32 v17, v17, v18
  s_nop 1
  v_min_u32_dpp v17, v17, v17 row_ror:2 row_mask:0xf bank_mask:0xf
  s_nop 1
  v_min_u32_dpp v17, v17, v17 row_ror:1 row_mask:0xf bank_mask:0xf
  s_nop 0
  v_readfirstlane_b32 s27, v17
  s_and_b32 s27, s27, 3
  s_lshl_b32 s27, s27, 13
  s_and_b32 s27, s27, 0x2000
  s_xor_b32 s27, s27, 16785408
  v_min_u32 v2, 63, v0
  v_lshlrev_b32 v2, 7, v2
  v_add_u32 v2, 1380352, v2
  s_nop 1
Lpoll_20:
  buffer_load_dword v3, v2, s[4:7], 0 offen sc1
  s_sub_u32 s24, s24, 1
  s_cbranch_scc1 L_FAIL
  s_waitcnt vmcnt(0)
  v_cmp_gt_i32 vcc, 1, v3
  s_cbranch_vccz Lpolld_21
  s_sleep 2
  s_branch Lpoll_20
Lpolld_21:
  s_mov_b32 s40, 1593344
  buffer_load_dwordx4 v[48:51], v5, s[4:7], s40 offen offset:0 sc1
  buffer_load_dwordx4 v[52:55], v5, s[4:7], s40 offen offset:256 sc1
  buffer_load_dwordx4 v[56:59], v5, s[4:7], s40 offen offset:512 sc1
  buffer_load_dwordx4 v[60:63], v5, s[4:7], s40 offen offset:768 sc1
  s_waitcnt vmcnt(0)
  v_lshrrev_b32 v48, 16, v48
  v_lshrrev_b32 v50, 16, v50
  v_lshrrev_b32 v52, 16, v52
  v_lshrrev_b32 v54, 16, v54
  v_lshrrev_b32 v56, 16, v56
  v_lshrrev_b32 v58, 16, v58
  v_lshrrev_b32 v60, 16, v60
  v_lshrrev_b32 v62, 16, v62
  v_min_u32 v2, 23, v0
  v_lshlrev_b32 v2, 7, v2
  v_add_u32 v2, 1421312, v2
  s_mul_i32 s30, s20, 2176
  v_mul_u32_u24 v11, 544, v6
  v_lshl_add_u32 v11, v8, 3, v11
  v_add_u32 v11, s30, v11
  v_mul_u32_u24 v12, 544, v7
  v_lshl_add_u32 v12, v9, 4, v12
  v_add_u32 v12, s30, v12
  buffer_load_dword v3, v2, s[4:7], s31 offen sc1
  s_nop 0
L_FIN_top:
  s_cmp_lg_u32 s20, 0
  s_cbranch_scc1 Lgo_22
  s_waitcnt vmcnt(0)
  v_cmp_gt_i32 vcc, s29, v3
  s_cbranch_vccz Lgo_22
  s_nop 3
Lpoll_23:
  buffer_load_dword v3, v2, s[4:7], 0 offen sc1
  s_sub_u32 s24, s24, 1
  s_cbranch_scc1 L_FAIL
  s_waitcnt vmcnt(0)
  v_cmp_gt_i32 vcc, s29, v3
  s_cbranch_vccz Lpolld_24
  s_sleep 1
  s_branch Lpoll_23
Lpolld_24:
Lgo_22:
  s_barrier
  s_add_u32 s40, s27, 1048576
  buffer_load_dwordx4 v[16:19], v1, s[4:7], s40 offen sc1
  s_add_u32 s40, s27, 1064960
  buffer_load_dwordx4 v[20:23], v1, s[4:7], s40 offen sc1
  s_add_u32 s40, s27, 524288
  buffer_load_dwordx4 v[112:115], v1, s[4:7], s40 offen sc1
  s_add_u32 s40, s27, 540672
  buffer_load_dwordx4 v[116:119], v1, s[4:7], s40 offen sc1
  s_add_u32 s40, s27, 655360
  buffer_load_dwordx4 v[120:123], v1, s[4:7], s40 offen sc1
  s_add_u32 s40, s27, 671744
  buffer_load_dwordx4 v[124:127], v1, s[4:7], s40 offen sc1
  s_add_u32 s40, s27, 786432
  buffer_load_dwordx4 v[128:131], v1, s[4:7], s40 offen sc1
  s_add_u32 s40, s27, 802816
  buffer_load_dwordx4 v[132:135], v1, s[4:7], s40 offen sc1
  s_waitcnt vmcnt(6)
  v_lshlrev_b32 v96, 16, v16
  v_and_b32 v97, 0xffff0000, v16
  v_lshlrev_b32 v98, 16, v17
  v_and_b32 v99, 0xffff0000, v17
  v_lshlrev_b32 v100, 16, v18
  v_and_b32 v101, 0xffff0000, v18
  v_lshlrev_b32 v102, 16, v19
  v_and_b32 v103, 0xffff0000, v19
  v_lshlrev_b32 v104, 16, v20
  v_and_b32 v105, 0xffff0000, v20
  v_lshlrev_b32 v106, 16, v21
  v_and_b32 v107, 0xffff0000, v21
  v_lshlrev_b32 v108, 16, v22
  v_and_b32 v109, 0xffff0000, v22
  v_lshlrev_b32 v110, 16, v23
  v_and_b32 v111, 0xffff0000, v23
  s_waitcnt vmcnt(5)
  v_dot2c_f32_bf16 v96, v112, v48
  v_dot2c_f32_bf16 v97, v112, v49
  v_dot2c_f32_bf16 v98, v113, v50
  v_dot2c_f32_bf16 v99, v113, v51
  v_dot2c_f32_bf16 v100, v114, v52
  v_dot2c_f32_bf16 v101, v114, v53
  v_dot2c_f32_bf16 v102, v115, v54
  v_dot2c_f32_bf16 v103, v115, v55
  s_waitcnt vmcnt(4)
  v_dot2c_f32_bf16 v104, v116, v56
  v_dot2c_f32_bf16 v105, v116, v57
  v_dot2c_f32_bf16 v106, v117, v58
  v_dot2c_f32_bf16 v107, v117, v59
  v_dot2c_f32_bf16 v108, v118, v60
  v_dot2c_f32_bf16 v109, v118, v61
  v_dot2c_f32_bf16 v110, v119, v62
  v_dot2c_f32_bf16 v111, v119, v63
  s_waitcnt vmcnt(3)
  v_dot2c_f32_bf16 v96, v120, v48
  v_dot2c_f32_bf16 v97, v120, v49
  v_dot2c_f32_bf16 v98, v121, v50
  v_dot2c_f32_bf16 v99, v121, v51
  v_dot2c_f32_bf16 v100, v122, v52
  v_dot2c_f32_bf16 v101, v122, v53
  v_dot2c_f32_bf16 v102, v123, v54
  v_dot2c_f32_bf16 v103, v123, v55
  s_waitcnt vmcnt(2)
  v_dot2c_f32_bf16 v104, v124, v56
  v_dot2c_f32_bf16 v105, v124, v57
  v_dot2c_f32_bf16 v106, v125, v58
  v_dot2c_f32_bf16 v107, v125, v59
  v_dot2c_f32_bf16 v108, v126, v60
  v_dot2c_f32_bf16 v109, v126, v61
  v_dot2c_f32_bf16 v110, v127, v62
  v_dot2c_f32_bf16 v111, v127, v63
  s_waitcnt vmcnt(1)
  v_dot2c_f32_bf16 v96, v128, v48
  v_dot2c_f32_bf16 v97, v128, v49
  v_dot2c_f32_bf16 v98, v129, v50
  v_dot2c_f32_bf16 v99, v129, v51
  v_dot2c_f32_bf16 v100, v130, v52
  v_dot2c_f32_bf16 v101, v130, v53
  v_dot2c_f32_bf16 v102, v131, v54
  v_dot2c_f32_bf16 v103, v131, v55
  s_waitcnt vmcnt(0)
  v_dot2c_f32_bf16 v104, v132, v56
  v_dot2c_f32_bf16 v105, v132, v57
  v_dot2c_f32_bf16 v106, v133, v58
  v_dot2c_f32_bf16 v107, v133, v59
  v_dot2c_f32_bf16 v108, v134, v60
  v_dot2c_f32_bf16 v109, v134, v61
  v_dot2c_f32_bf16 v110, v135, v62
  v_dot2c_f32_bf16 v111, v135, v63
  s_nop 2
  buffer_load_dword v3, v2, s[4:7], s31 offen sc1
  v_cvt_pk_bf16_f32 v16, v96, v97
  v_cvt_pk_bf16_f32 v17, v98, v99
  v_cvt_pk_bf16_f32 v18, v100, v101
  v_cvt_pk_bf16_f32 v19, v102, v103
  v_cvt_pk_bf16_f32 v20, v104, v105
  v_cvt_pk_bf16_f32 v21, v106, v107
  v_cvt_pk_bf16_f32 v22, v108, v109
  v_cvt_pk_bf16_f32 v23, v110, v111
  ds_write_b64 v11, v[16:17] offset:0
  ds_write_b64 v11, v[18:19] offset:128
  ds_write_b64 v11, v[20:21] offset:256
  ds_write_b64 v11, v[22:23] offset:384
  ds_read_b128 v[112:115], v12 offset:0
  ds_read_b128 v[116:119], v12 offset:1088
  s_add_u32 s40, s26, 0
  s_waitcnt lgkmcnt(1)
  buffer_store_dwordx4 v[112:115], v10, s[16:19], s40 offen
  s_add_u32 s40, s26, 4096
  s_waitcnt lgkmcnt(0)
  buffer_store_dwordx4 v[116:119], v10, s[16:19], s40 offen
  s_add_u32 s25, s25, 1
  s_add_u32 s29, s29, 1
  s_add_u32 s26, s26, 65536
  s_add_u32 s27, s27, 2097152
  s_xor_b32 s27, s27, 0x2000
  s_cmp_lt_u32 s25, 64
  s_cbranch_scc1 L_FIN_top
  s_branch L_END
L_QKV:
  v_lshrrev_b32 v60, 3, v0
  v_and_b32 v61, 6, v60
  v_xor_b32 v61, v61, v0
  v_and_b32 v61, 7, v61
  v_lshlrev_b32 v61, 4, v61
  v_lshl_add_u32 v1, v60, 11, v61
  s_lshl_b32 s40, s20, 14
  v_add_u32 v1, s40, v1
  s_lshl_b32 s32, s20, 10
  v_and_b32 v60, 6, v0
  v_lshrrev_b32 v61, 4, v0
  v_xor_b32 v60, v60, v61
  v_lshlrev_b32 v60, 4, v60
  v_and_b32 v61, 15, v0
  v_lshl_add_u32 v77, v61, 7, v60
  v_xor_b32 v78, 64, v77
  s_and_b32 s43, s21, 1
  s_lshr_b32 s44, s21, 1
  s_lshl_b32 s44, s44, 8
  s_add_u32 s45, s44, 128
  s_lshl_b32 s46, s43, 7
  s_add_u32 s46, s46, s44
  s_load_dwordx4 s[48:51], s[0:1], 16
  s_waitcnt lgkmcnt(0)
  s_cmp_eq_u32 s43, 0
  s_cselect_b32 s8, s48, s50
  s_cselect_b32 s9, s49, s51
  s_mov_b32 s10, 8388608
  s_mov_b32 s11, 0x20000
  v_bfe_u32 v4, v0, 5, 1
  v_mul_u32_u24 v4, 32768, v4
  v_bfe_u32 v5, v0, 4, 1
  v_mul_u32_u24 v5, 16384, v5
  v_add_u32 v4, v4, v5
  v_bfe_u32 v5, v0, 3, 1
  v_mul_u32_u24 v5, 8192, v5
  v_add_u32 v4, v4, v5
  v_lshrrev_b32 v5, 3, v0
  v_and_b32 v5, 6, v5
  v_xor_b32 v5, v5, v0
  v_and_b32 v5, 7, v5
  v_lshl_add_u32 v4, v5, 4, v4
  s_lshr_b32 s40, s20, 1
  s_mul_i32 s40, s40, 2097152
  s_and_b32 s41, s20, 1
  s_mul_i32 s41, s41, 65536
  s_add_u32 s40, s40, s41
  v_add_u32 v4, s40, v4
  v_bfe_u32 v5, v0, 3, 2
  v_xor_b32 v5, s20, v5
  v_lshlrev_b32 v5, 5, v5
  v_lshrrev_b32 v6, 2, v0
  v_lshl_add_u32 v6, v6, 7, v5
  v_and_b32 v5, 3, v0
  v_lshl_add_u32 v6, v5, 3, v6
  v_add_u32 v7, 0x10000, v6
  v_add_u32 v8, s44, v4
  v_add_u32 v9, s45, v4
  v_add_u32 v10, s46, v4
  s_lshl_b32 s41, s20, 10
  s_add_u32 m0, s41, 0
  s_mov_b32 s42, 0
  buffer_load_dwordx4 v8, s[8:11], s42 offen lds
  s_add_u32 m0, s41, 4096
  s_mov_b32 s42, 0
  buffer_load_dwordx4 v9, s[8:11], s42 offen lds
  s_add_u32 m0, s41, 8192
  s_mov_b32 s42, 131072
  buffer_load_dwordx4 v8, s[8:11], s42 offen lds
  s_add_u32 m0, s41, 12288
  s_mov_b32 s42, 131072
  buffer_load_dwordx4 v9, s[8:11], s42 offen lds
  s_add_u32 m0, s41, 16384
  s_mov_b32 s42, 262144
  buffer_load_dwordx4 v8, s[8:11], s42 offen lds
  s_add_u32 m0, s41, 20480
  s_mov_b32 s42, 262144
  buffer_load_dwordx4 v9, s[8:11], s42 offen lds
  s_add_u32 m0, s41, 24576
  s_mov_b32 s42, 393216
  buffer_load_dwordx4 v8, s[8:11], s42 offen lds
  s_add_u32 m0, s41, 28672
  s_mov_b32 s42, 393216
  buffer_load_dwordx4 v9, s[8:11], s42 offen lds
  s_add_u32 m0, s41, 32768
  s_mov_b32 s42, 524288
  buffer_load_dwordx4 v8, s[8:11], s42 offen lds
  s_add_u32 m0, s41, 36864
  s_mov_b32 s42, 524288
  buffer_load_dwordx4 v9, s[8:11], s42 offen lds
  s_add_u32 m0, s41, 40960
  s_mov_b32 s42, 655360
  buffer_load_dwordx4 v8, s[8:11], s42 offen lds
  s_add_u32 m0, s41, 45056
  s_mov_b32 s42, 655360
  buffer_load_dwordx4 v9, s[8:11], s42 offen lds
  s_add_u32 m0, s41, 49152
  s_mov_b32 s42, 786432
  buffer_load_dwordx4 v8, s[8:11], s42 offen lds
  s_add_u32 m0, s41, 53248
  s_mov_b32 s42, 786432
  buffer_load_dwordx4 v9, s[8:11], s42 offen lds
  s_add_u32 m0, s41, 57344
  s_mov_b32 s42, 917504
  buffer_load_dwordx4 v8, s[8:11], s42 offen lds
  s_add_u32 m0, s41, 61440
  s_mov_b32 s42, 917504
  buffer_load_dwordx4 v9, s[8:11], s42 offen lds
  s_add_u32 m0, s41, 65536
  s_mov_b32 s42, 1048576
  buffer_load_dwordx4 v8, s[8:11], s42 offen lds
  s_add_u32 m0, s41, 69632
  s_mov_b32 s42, 1048576
  buffer_load_dwordx4 v9, s[8:11], s42 offen lds
  s_add_u32 m0, s41, 73728
  s_mov_b32 s42, 1179648
  buffer_load_dwordx4 v8, s[8:11], s42 offen lds
  s_add_u32 m0, s41, 77824
  s_mov_b32 s42, 1179648
  buffer_load_dwordx4 v9, s[8:11], s42 offen lds
  s_add_u32 m0, s41, 81920
  s_mov_b32 s42, 1310720
  buffer_load_dwordx4 v8, s[8:11], s42 offen lds
  s_add_u32 m0, s41, 86016
  s_mov_b32 s42, 1310720
  buffer_load_dwordx4 v9, s[8:11], s42 offen lds
  s_add_u32 m0, s41, 90112
  s_mov_b32 s42, 1441792
  buffer_load_dwordx4 v8, s[8:11], s42 offen lds
  s_add_u32 m0, s41, 94208
  s_mov_b32 s42, 1441792
  buffer_load_dwordx4 v9, s[8:11], s42 offen lds
  s_add_u32 m0, s41, 98304
  s_mov_b32 s42, 1572864
  buffer_load_dwordx4 v8, s[8:11], s42 offen lds
  s_add_u32 m0, s41, 102400
  s_mov_b32 s42, 1572864
  buffer_load_dwordx4 v9, s[8:11], s42 offen lds
  s_add_u32 m0, s41, 106496
  s_mov_b32 s42, 1703936
  buffer_load_dwordx4 v8, s[8:11], s42 offen lds
  s_add_u32 m0, s41, 110592
  s_mov_b32 s42, 1703936
  buffer_load_dwordx4 v9, s[8:11], s42 offen lds
  s_waitcnt vmcnt(24) lgkmcnt(0)
  s_barrier
  s_add_u32 m0, s41, 114688
  s_mov_b32 s42, 1835008
  buffer_load_dwordx4 v8, s[8:11], s42 offen lds
  s_add_u32 m0, s41, 118784
  s_mov_b32 s42, 1835008
  buffer_load_dwordx4 v9, s[8:11], s42 offen lds
  s_add_u32 m0, s41, 122880
  s_mov_b32 s42, 1966080
  buffer_load_dwordx4 v8, s[8:11], s42 offen lds
  s_add_u32 m0, s41, 126976
  s_mov_b32 s42, 1966080
  buffer_load_dwordx4 v9, s[8:11], s42 offen lds
  ds_read_b64_tr_b16 a[0:1], v6 offset:0
  ds_read_b64_tr_b16 a[2:3], v6 offset:2048
  ds_read_b64_tr_b16 a[128:129], v6 offset:4096
  ds_read_b64_tr_b16 a[130:131], v6 offset:6144
  ds_read_b64_tr_b16 a[4:5], v6 offset:8192
  ds_read_b64_tr_b16 a[6:7], v6 offset:10240
  ds_read_b64_tr_b16 a[132:133], v6 offset:12288
  ds_read_b64_tr_b16 a[134:135], v6 offset:14336
  s_waitcnt vmcnt(24) lgkmcnt(0)
  s_barrier
  s_add_u32 m0, s41, 0
  s_mov_b32 s42, 4194304
  buffer_load_dwordx4 v8, s[8:11], s42 offen lds
  s_add_u32 m0, s41, 4096
  s_mov_b32 s42, 4194304
  buffer_load_dwordx4 v9, s[8:11], s42 offen lds
  s_add_u32 m0, s41, 8192
  s_mov_b32 s42, 4325376
  buffer_load_dwordx4 v8, s[8:11], s42 offen lds
  s_add_u32 m0, s41, 12288
  s_mov_b32 s42, 4325376
  buffer_load_dwordx4 v9, s[8:11], s42 offen lds
  ds_read_b64_tr_b16 a[8:9], v6 offset:16384
  ds_read_b64_tr_b16 a[10:11], v6 offset:18432
  ds_read_b64_tr_b16 a[136:137], v6 offset:20480
  ds_read_b64_tr_b16 a[138:139], v6 offset:22528
  ds_read_b64_tr_b16 a[12:13], v6 offset:24576
  ds_read_b64_tr_b16 a[14:15], v6 offset:26624
  ds_read_b64_tr_b16 a[140:141], v6 offset:28672
  ds_read_b64_tr_b16 a[142:143], v6 offset:30720
  s_waitcnt vmcnt(24) lgkmcnt(0)
  s_barrier
  s_add_u32 m0, s41, 16384
  s_mov_b32 s42, 4456448
  buffer_load_dwordx4 v8, s[8:11], s42 offen lds
  s_add_u32 m0, s41, 20480
  s_mov_b32 s42, 4456448
  buffer_load_dwordx4 v9, s[8:11], s42 offen lds
  s_add_u32 m0, s41, 24576
  s_mov_b32 s42, 4587520
  buffer_load_dwordx4 v8, s[8:11], s42 offen lds
  s_add_u32 m0, s41, 28672
  s_mov_b32 s42, 4587520
  buffer_load_dwordx4 v9, s[8:11], s42 offen lds
  ds_read_b64_tr_b16 a[16:17], v6 offset:32768
  ds_read_b64_tr_b16 a[18:19], v6 offset:34816
  ds_read_b64_tr_b16 a[144:145], v6 offset:36864
  ds_read_b64_tr_b16 a[146:147], v6 offset:38912
  ds_read_b64_tr_b16 a[20:21], v6 offset:40960
  ds_read_b64_tr_b16 a[22:23], v6 offset:43008
  ds_read_b64_tr_b16 a[148:149], v6 offset:45056
  ds_read_b64_tr_b16 a[150:151], v6 offset:47104
  s_waitcnt vmcnt(24) lgkmcnt(0)
  s_barrier
  s_add_u32 m0, s41, 32768
  s_mov_b32 s42, 4718592
  buffer_load_dwordx4 v8, s[8:11], s42 offen lds
  s_add_u32 m0, s41, 36864
  s_mov_b32 s42, 4718592
  buffer_load_dwordx4 v9, s[8:11], s42 offen lds
  s_add_u32 m0, s41, 40960
  s_mov_b32 s42, 4849664
  buffer_load_dwordx4 v8, s[8:11], s42 offen lds
  s_add_u32 m0, s41, 45056
  s_mov_b32 s42, 4849664
  buffer_load_dwordx4 v9, s[8:11], s42 offen lds
  ds_read_b64_tr_b16 a[24:25], v6 offset:49152
  ds_read_b64_tr_b16 a[26:27], v6 offset:51200
  ds_read_b64_tr_b16 a[152:153], v6 offset:53248
  ds_read_b64_tr_b16 a[154:155], v6 offset:55296
  ds_read_b64_tr_b16 a[28:29], v6 offset:57344
  ds_read_b64_tr_b16 a[30:31], v6 offset:59392
  ds_read_b64_tr_b16 a[156:157], v6 offset:61440
  ds_read_b64_tr_b16 a[158:159], v6 offset:63488
  s_waitcnt vmcnt(24) lgkmcnt(0)
  s_barrier
  s_add_u32 m0, s41, 49152
  s_mov_b32 s42, 4980736
  buffer_load_dwordx4 v8, s[8:11], s42 offen lds
  s_add_u32 m0, s41, 53248
  s_mov_b32 s42, 4980736
  buffer_load_dwordx4 v9, s[8:11], s42 offen lds
  s_add_u32 m0, s41, 57344
  s_mov_b32 s42, 5111808
  buffer_load_dwordx4 v8, s[8:11], s42 offen lds
  s_add_u32 m0, s41, 61440
  s_mov_b32 s42, 5111808
  buffer_load_dwordx4 v9, s[8:11], s42 offen lds
  ds_read_b64_tr_b16 a[32:33], v7 offset:0
  ds_read_b64_tr_b16 a[34:35], v7 offset:2048
  ds_read_b64_tr_b16 a[160:161], v7 offset:4096
  ds_read_b64_tr_b16 a[162:163], v7 offset:6144
  ds_read_b64_tr_b16 a[36:37], v7 offset:8192
  ds_read_b64_tr_b16 a[38:39], v7 offset:10240
  ds_read_b64_tr_b16 a[164:165], v7 offset:12288
  ds_read_b64_tr_b16 a[166:167], v7 offset:14336
  s_waitcnt vmcnt(24) lgkmcnt(0)
  s_barrier
  s_add_u32 m0, s41, 65536
  s_mov_b32 s42, 5242880
  buffer_load_dwordx4 v8, s[8:11], s42 offen lds
  s_add_u32 m0, s41, 69632
  s_mov_b32 s42, 5242880
  buffer_load_dwordx4 v9, s[8:11], s42 offen lds
  s_add_u32 m0, s41, 73728
  s_mov_b32 s42, 5373952
  buffer_load_dwordx4 v8, s[8:11], s42 offen lds
  s_add_u32 m0, s41, 77824
  s_mov_b32 s42, 5373952
  buffer_load_dwordx4 v9, s[8:11], s42 offen lds
  ds_read_b64_tr_b16 a[40:41], v7 offset:16384
  ds_read_b64_tr_b16 a[42:43], v7 offset:18432
  ds_read_b64_tr_b16 a[168:169], v7 offset:20480
  ds_read_b64_tr_b16 a[170:171], v7 offset:22528
  ds_read_b64_tr_b16 a[44:45], v7 offset:24576
  ds_read_b64_tr_b16 a[46:47], v7 offset:26624
  ds_read_b64_tr_b16 a[172:173], v7 offset:28672
  ds_read_b64_tr_b16 a[174:175], v7 offset:30720
  s_waitcnt vmcnt(24) lgkmcnt(0)
  s_barrier
  s_add_u32 m0, s41, 81920
  s_mov_b32 s42, 5505024
  buffer_load_dwordx4 v8, s[8:11], s42 offen lds
  s_add_u32 m0, s41, 86016
  s_mov_b32 s42, 5505024
  buffer_load_dwordx4 v9, s[8:11], s42 offen lds
  s_add_u32 m0, s41, 90112
  s_mov_b32 s42, 5636096
  buffer_load_dwordx4 v8, s[8:11], s42 offen lds
  s_add_u32 m0, s41, 94208
  s_mov_b32 s42, 5636096
  buffer_load_dwordx4 v9, s[8:11], s42 offen lds
  ds_read_b64_tr_b16 a[48:49], v7 offset:32768
  ds_read_b64_tr_b16 a[50:51], v7 offset:34816
  ds_read_b64_tr_b16 a[176:177], v7 offset:36864
  ds_read_b64_tr_b16 a[178:179], v7 offset:38912
  ds_read_b64_tr_b16 a[52:53], v7 offset:40960
  ds_read_b64_tr_b16 a[54:55], v7 offset:43008
  ds_read_b64_tr_b16 a[180:181], v7 offset:45056
  ds_read_b64_tr_b16 a[182:183], v7 offset:47104
  s_waitcnt vmcnt(24) lgkmcnt(0)
  s_barrier
  s_add_u32 m0, s41, 98304
  s_mov_b32 s42, 5767168
  buffer_load_dwordx4 v8, s[8:11], s42 offen lds
  s_add_u32 m0, s41, 102400
  s_mov_b32 s42, 5767168
  buffer_load_dwordx4 v9, s[8:11], s42 offen lds
  s_add_u32 m0, s41, 106496
  s_mov_b32 s42, 5898240
  buffer_load_dwordx4 v8, s[8:11], s42 offen lds
  s_add_u32 m0, s41, 110592
  s_mov_b32 s42, 5898240
  buffer_load_dwordx4 v9, s[8:11], s42 offen lds
  ds_read_b64_tr_b16 a[56:57], v7 offset:49152
  ds_read_b64_tr_b16 a[58:59], v7 offset:51200
  ds_read_b64_tr_b16 a[184:185], v7 offset:53248
  ds_read_b64_tr_b16 a[186:187], v7 offset:55296
  ds_read_b64_tr_b16 a[60:61], v7 offset:57344
  ds_read_b64_tr_b16 a[62:63], v7 offset:59392
  ds_read_b64_tr_b16 a[188:189], v7 offset:61440
  ds_read_b64_tr_b16 a[190:191], v7 offset:63488
  s_waitcnt vmcnt(24) lgkmcnt(0)
  s_barrier
  s_add_u32 m0, s41, 114688
  s_mov_b32 s42, 6029312
  buffer_load_dwordx4 v8, s[8:11], s42 offen lds
  s_add_u32 m0, s41, 118784
  s_mov_b32 s42, 6029312
  buffer_load_dwordx4 v9, s[8:11], s42 offen lds
  s_add_u32 m0, s41, 122880
  s_mov_b32 s42, 6160384
  buffer_load_dwordx4 v8, s[8:11], s42 offen lds
  s_add_u32 m0, s41, 126976
  s_mov_b32 s42, 6160384
  buffer_load_dwordx4 v9, s[8:11], s42 offen lds
  ds_read_b64_tr_b16 a[64:65], v6 offset:0
  ds_read_b64_tr_b16 a[66:67], v6 offset:2048
  ds_read_b64_tr_b16 a[192:193], v6 offset:4096
  ds_read_b64_tr_b16 a[194:195], v6 offset:6144
  ds_read_b64_tr_b16 a[68:69], v6 offset:8192
  ds_read_b64_tr_b16 a[70:71], v6 offset:10240
  ds_read_b64_tr_b16 a[196:197], v6 offset:12288
  ds_read_b64_tr_b16 a[198:199], v6 offset:14336
  s_waitcnt vmcnt(24) lgkmcnt(0)
  s_barrier
  s_load_dwordx2 s[8:9], s[0:1], 32
  s_mov_b32 s10, 8388608
  s_mov_b32 s11, 0x20000
  s_waitcnt lgkmcnt(0)
  s_add_u32 m0, s41, 0
  s_mov_b32 s42, 0
  buffer_load_dwordx4 v10, s[8:11], s42 offen lds
  s_add_u32 m0, s41, 4096
  s_mov_b32 s42, 131072
  buffer_load_dwordx4 v10, s[8:11], s42 offen lds
  s_add_u32 m0, s41, 8192
  s_mov_b32 s42, 262144
  buffer_load_dwordx4 v10, s[8:11], s42 offen lds
  s_add_u32 m0, s41, 12288
  s_mov_b32 s42, 393216
  buffer_load_dwordx4 v10, s[8:11], s42 offen lds
  ds_read_b64_tr_b16 a[72:73], v6 offset:16384
  ds_read_b64_tr_b16 a[74:75], v6 offset:18432
  ds_read_b64_tr_b16 a[200:201], v6 offset:20480
  ds_read_b64_tr_b16 a[202:203], v6 offset:22528
  ds_read_b64_tr_b16 a[76:77], v6 offset:24576
  ds_read_b64_tr_b16 a[78:79], v6 offset:26624
  ds_read_b64_tr_b16 a[204:205], v6 offset:28672
  ds_read_b64_tr_b16 a[206:207], v6 offset:30720
  s_waitcnt vmcnt(24) lgkmcnt(0)
  s_barrier
  s_add_u32 m0, s41, 16384
  s_mov_b32 s42, 524288
  buffer_load_dwordx4 v10, s[8:11], s42 offen lds
  s_add_u32 m0, s41, 20480
  s_mov_b32 s42, 655360
  buffer_load_dwordx4 v10, s[8:11], s42 offen lds
  s_add_u32 m0, s41, 24576
  s_mov_b32 s42, 786432
  buffer_load_dwordx4 v10, s[8:11], s42 offen lds
  s_add_u32 m0, s41, 28672
  s_mov_b32 s42, 917504
  buffer_load_dwordx4 v10, s[8:11], s42 offen lds
  ds_read_b64_tr_b16 a[80:81], v6 offset:32768
  ds_read_b64_tr_b16 a[82:83], v6 offset:34816
  ds_read_b64_tr_b16 a[208:209], v6 offset:36864
  ds_read_b64_tr_b16 a[210:211], v6 offset:38912
  ds_read_b64_tr_b16 a[84:85], v6 offset:40960
  ds_read_b64_tr_b16 a[86:87], v6 offset:43008
  ds_read_b64_tr_b16 a[212:213], v6 offset:45056
  ds_read_b64_tr_b16 a[214:215], v6 offset:47104
  s_cmp_lg_u32 s20, 0
  s_cbranch_scc1 L_QKV_noinit
Lini_25:
  s_load_dwordx16 s[64:79], s[12:13], 128 glc
  s_load_dwordx16 s[80:95], s[12:13], 192 glc
  s_sub_u32 s24, s24, 1
  s_cbranch_scc1 L_FAIL
  s_waitcnt lgkmcnt(0)
  s_and_b64 s[64:65], s[64:65], s[66:67]
  s_and_b64 s[64:65], s[64:65], s[68:69]
  s_and_b64 s[64:65], s[64:65], s[70:71]
  s_and_b64 s[64:65], s[64:65], s[72:73]
  s_and_b64 s[64:65], s[64:65], s[74:75]
  s_and_b64 s[64:65], s[64:65], s[76:77]
  s_and_b64 s[64:65], s[64:65], s[78:79]
  s_and_b64 s[64:65], s[64:65], s[80:81]
  s_and_b64 s[64:65], s[64:65], s[82:83]
  s_and_b64 s[64:65], s[64:65], s[84:85]
  s_and_b64 s[64:65], s[64:65], s[86:87]
  s_and_b64 s[64:65], s[64:65], s[88:89]
  s_and_b64 s[64:65], s[64:65], s[90:91]
  s_and_b64 s[64:65], s[64:65], s[92:93]
  s_and_b64 s[64:65], s[64:65], s[94:95]
  s_and_b32 s64, s64, s65
  s_cbranch_scc0 Lini_25
L_QKV_noinit:
  s_waitcnt vmcnt(24) lgkmcnt(0)
  s_barrier
  s_add_u32 m0, s41, 32768
  s_mov_b32 s42, 1048576
  buffer_load_dwordx4 v10, s[8:11], s42 offen lds
  s_add_u32 m0, s41, 36864
  s_mov_b32 s42, 1179648
  buffer_load_dwordx4 v10, s[8:11], s42 offen lds
  s_add_u32 m0, s41, 40960
  s_mov_b32 s42, 1310720
  buffer_load_dwordx4 v10, s[8:11], s42 offen lds
  s_add_u32 m0, s41, 45056
  s_mov_b32 s42, 1441792
  buffer_load_dwordx4 v10, s[8:11], s42 offen lds
  ds_read_b64_tr_b16 a[88:89], v6 offset:49152
  ds_read_b64_tr_b16 a[90:91], v6 offset:51200
  ds_read_b64_tr_b16 a[216:217], v6 offset:53248
  ds_read_b64_tr_b16 a[218:219], v6 offset:55296
  ds_read_b64_tr_b16 a[92:93], v6 offset:57344
  ds_read_b64_tr_b16 a[94:95], v6 offset:59392
  ds_read_b64_tr_b16 a[220:221], v6 offset:61440
  ds_read_b64_tr_b16 a[222:223], v6 offset:63488
  s_waitcnt vmcnt(24) lgkmcnt(0)
  s_barrier
  s_add_u32 m0, s41, 49152
  s_mov_b32 s42, 1572864
  buffer_load_dwordx4 v10, s[8:11], s42 offen lds
  s_add_u32 m0, s41, 53248
  s_mov_b32 s42, 1703936
  buffer_load_dwordx4 v10, s[8:11], s42 offen lds
  s_add_u32 m0, s41, 57344
  s_mov_b32 s42, 1835008
  buffer_load_dwordx4 v10, s[8:11], s42 offen lds
  s_add_u32 m0, s41, 61440
  s_mov_b32 s42, 1966080
  buffer_load_dwordx4 v10, s[8:11], s42 offen lds
  ds_read_b64_tr_b16 a[96:97], v7 offset:0
  ds_read_b64_tr_b16 a[98:99], v7 offset:2048
  ds_read_b64_tr_b16 a[224:225], v7 offset:4096
  ds_read_b64_tr_b16 a[226:227], v7 offset:6144
  ds_read_b64_tr_b16 a[100:101], v7 offset:8192
  ds_read_b64_tr_b16 a[102:103], v7 offset:10240
  ds_read_b64_tr_b16 a[228:229], v7 offset:12288
  ds_read_b64_tr_b16 a[230:231], v7 offset:14336
  s_waitcnt vmcnt(24) lgkmcnt(0)
  s_barrier
  s_add_u32 m0, s41, 65536
  s_mov_b32 s42, 4194304
  buffer_load_dwordx4 v10, s[8:11], s42 offen lds
  s_add_u32 m0, s41, 69632
  s_mov_b32 s42, 4325376
  buffer_load_dwordx4 v10, s[8:11], s42 offen lds
  s_add_u32 m0, s41, 73728
  s_mov_b32 s42, 4456448
  buffer_load_dwordx4 v10, s[8:11], s42 offen lds
  s_add_u32 m0, s41, 77824
  s_mov_b32 s42, 4587520
  buffer_load_dwordx4 v10, s[8:11], s42 offen lds
  ds_read_b64_tr_b16 a[104:105], v7 offset:16384
  ds_read_b64_tr_b16 a[106:107], v7 offset:18432
  ds_read_b64_tr_b16 a[232:233], v7 offset:20480
  ds_read_b64_tr_b16 a[234:235], v7 offset:22528
  ds_read_b64_tr_b16 a[108:109], v7 offset:24576
  ds_read_b64_tr_b16 a[110:111], v7 offset:26624
  ds_read_b64_tr_b16 a[236:237], v7 offset:28672
  ds_read_b64_tr_b16 a[238:239], v7 offset:30720
  s_waitcnt vmcnt(24) lgkmcnt(0)
  s_barrier
  s_add_u32 m0, s41, 81920
  s_mov_b32 s42, 4718592
  buffer_load_dwordx4 v10, s[8:11], s42 offen lds
  s_add_u32 m0, s41, 86016
  s_mov_b32 s42, 4849664
  buffer_load_dwordx4 v10, s[8:11], s42 offen lds
  s_add_u32 m0, s41, 90112
  s_mov_b32 s42, 4980736
  buffer_load_dwordx4 v10, s[8:11], s42 offen lds
  s_add_u32 m0, s41, 94208
  s_mov_b32 s42, 5111808
  buffer_load_dwordx4 v10, s[8:11], s42 offen lds
  ds_read_b64_tr_b16 a[112:113], v7 offset:32768
  ds_read_b64_tr_b16 a[114:115], v7 offset:34816
  ds_read_b64_tr_b16 a[240:241], v7 offset:36864
  ds_read_b64_tr_b16 a[242:243], v7 offset:38912
  ds_read_b64_tr_b16 a[116:117], v7 offset:40960
  ds_read_b64_tr_b16 a[118:119], v7 offset:43008
  ds_read_b64_tr_b16 a[244:245], v7 offset:45056
  ds_read_b64_tr_b16 a[246:247], v7 offset:47104
  s_waitcnt vmcnt(24) lgkmcnt(0)
  s_barrier
  s_add_u32 m0, s41, 98304
  s_mov_b32 s42, 5242880
  buffer_load_dwordx4 v10, s[8:11], s42 offen lds
  s_add_u32 m0, s41, 102400
  s_mov_b32 s42, 5373952
  buffer_load_dwordx4 v10, s[8:11], s42 offen lds
  s_add_u32 m0, s41, 106496
  s_mov_b32 s42, 5505024
  buffer_load_dwordx4 v10, s[8:11], s42 offen lds
  s_add_u32 m0, s41, 110592
  s_mov_b32 s42, 5636096
  buffer_load_dwordx4 v10, s[8:11], s42 offen lds
  ds_read_b64_tr_b16 a[120:121], v7 offset:49152
  ds_read_b64_tr_b16 a[122:123], v7 offset:51200
  ds_read_b64_tr_b16 a[248:249], v7 offset:53248
  ds_read_b64_tr_b16 a[250:251], v7 offset:55296
  ds_read_b64_tr_b16 a[124:125], v7 offset:57344
  ds_read_b64_tr_b16 a[126:127], v7 offset:59392
  ds_read_b64_tr_b16 a[252:253], v7 offset:61440
  ds_read_b64_tr_b16 a[254:255], v7 offset:63488
  s_waitcnt vmcnt(24) lgkmcnt(0)
  s_barrier
  s_add_u32 m0, s41, 114688
  s_mov_b32 s42, 5767168
  buffer_load_dwordx4 v10, s[8:11], s42 offen lds
  s_add_u32 m0, s41, 118784
  s_mov_b32 s42, 5898240
  buffer_load_dwordx4 v10, s[8:11], s42 offen lds
  s_add_u32 m0, s41, 122880
  s_mov_b32 s42, 6029312
  buffer_load_dwordx4 v10, s[8:11], s42 offen lds
  s_add_u32 m0, s41, 126976
  s_mov_b32 s42, 6160384
  buffer_load_dwordx4 v10, s[8:11], s42 offen lds
  ds_read_b64_tr_b16 v[128:129], v6 offset:0
  ds_read_b64_tr_b16 v[130:131], v6 offset:2048
  ds_read_b64_tr_b16 v[132:133], v6 offset:4096
  ds_read_b64_tr_b16 v[134:135], v6 offset:6144
  ds_read_b64_tr_b16 v[136:137], v6 offset:8192
  ds_read_b64_tr_b16 v[138:139], v6 offset:10240
  ds_read_b64_tr_b16 v[140:141], v6 offset:12288
  ds_read_b64_tr_b16 v[142:143], v6 offset:14336
  s_waitcnt vmcnt(24) lgkmcnt(0)
  s_barrier
  ds_read_b64_tr_b16 v[144:145], v6 offset:16384
  ds_read_b64_tr_b16 v[146:147], v6 offset:18432
  ds_read_b64_tr_b16 v[148:149], v6 offset:20480
  ds_read_b64_tr_b16 v[150:151], v6 offset:22528
  ds_read_b64_tr_b16 v[152:153], v6 offset:24576
  ds_read_b64_tr_b16 v[154:155], v6 offset:26624
  ds_read_b64_tr_b16 v[156:157], v6 offset:28672
  ds_read_b64_tr_b16 v[158:159], v6 offset:30720
  s_waitcnt vmcnt(20) lgkmcnt(0)
  s_barrier
  ds_read_b64_tr_b16 v[160:161], v6 offset:32768
  ds_read_b64_tr_b16 v[162:163], v6 offset:34816
  ds_read_b64_tr_b16 v[164:165], v6 offset:36864
  ds_read_b64_tr_b16 v[166:167], v6 offset:38912
  ds_read_b64_tr_b16 v[168:169], v6 offset:40960
  ds_read_b64_tr_b16 v[170:171], v6 offset:43008
  ds_read_b64_tr_b16 v[172:173], v6 offset:45056
  ds_read_b64_tr_b16 v[174:175], v6 offset:47104
  s_waitcnt vmcnt(16) lgkmcnt(0)
  s_barrier
  ds_read_b64_tr_b16 v[176:177], v6 offset:49152
  ds_read_b64_tr_b16 v[178:179], v6 offset:51200
  ds_read_b64_tr_b16 v[180:181], v6 offset:53248
  ds_read_b64_tr_b16 v[182:183], v6 offset:55296
  ds_read_b64_tr_b16 v[184:185], v6 offset:57344
  ds_read_b64_tr_b16 v[186:187], v6 offset:59392
  ds_read_b64_tr_b16 v[188:189], v6 offset:61440
  ds_read_b64_tr_b16 v[190:191], v6 offset:63488
  s_waitcnt vmcnt(12) lgkmcnt(0)
  s_barrier
  ds_read_b64_tr_b16 v[192:193], v7 offset:0
  ds_read_b64_tr_b16 v[194:195], v7 offset:2048
  ds_read_b64_tr_b16 v[196:197], v7 offset:4096
  ds_read_b64_tr_b16 v[198:199], v7 offset:6144
  ds_read_b64_tr_b16 v[200:201], v7 offset:8192
  ds_read_b64_tr_b16 v[202:203], v7 offset:10240
  ds_read_b64_tr_b16 v[204:205], v7 offset:12288
  ds_read_b64_tr_b16 v[206:207], v7 offset:14336
  s_waitcnt vmcnt(8) lgkmcnt(0)
  s_barrier
  ds_read_b64_tr_b16 v[208:209], v7 offset:16384
  ds_read_b64_tr_b16 v[210:211], v7 offset:18432
  ds_read_b64_tr_b16 v[212:213], v7 offset:20480
  ds_read_b64_tr_b16 v[214:215], v7 offset:22528
  ds_read_b64_tr_b16 v[216:217], v7 offset:24576
  ds_read_b64_tr_b16 v[218:219], v7 offset:26624
  ds_read_b64_tr_b16 v[220:221], v7 offset:28672
  ds_read_b64_tr_b16 v[222:223], v7 offset:30720
  s_waitcnt vmcnt(4) lgkmcnt(0)
  s_barrier
  ds_read_b64_tr_b16 v[224:225], v7 offset:32768
  ds_read_b64_tr_b16 v[226:227], v7 offset:34816
  ds_read_b64_tr_b16 v[228:229], v7 offset:36864
  ds_read_b64_tr_b16 v[230:231], v7 offset:38912
  ds_read_b64_tr_b16 v[232:233], v7 offset:40960
  ds_read_b64_tr_b16 v[234:235], v7 offset:43008
  ds_read_b64_tr_b16 v[236:237], v7 offset:45056
  ds_read_b64_tr_b16 v[238:239], v7 offset:47104
  s_waitcnt vmcnt(0) lgkmcnt(0)
  s_barrier
  ds_read_b64_tr_b16 v[240:241], v7 offset:49152
  ds_read_b64_tr_b16 v[242:243], v7 offset:51200
  ds_read_b64_tr_b16 v[244:245], v7 offset:53248
  ds_read_b64_tr_b16 v[246:247], v7 offset:55296
  ds_read_b64_tr_b16 v[248:249], v7 offset:57344
  ds_read_b64_tr_b16 v[250:251], v7 offset:59392
  ds_read_b64_tr_b16 v[252:253], v7 offset:61440
  ds_read_b64_tr_b16 v[254:255], v7 offset:63488
  s_waitcnt lgkmcnt(0)
  s_barrier
  s_lshr_b32 s62, s21, 1
  s_lshl_b32 s62, s62, 7
  s_and_b32 s40, s21, 1
  s_lshl_b32 s40, s40, 2
  s_add_u32 s62, s62, s40
  s_add_u32 s62, s62, 1396736
  s_mov_b32 s27, 2097152
  s_lshr_b32 s40, s21, 1
  s_mul_i32 s31, s40, 65536
  s_and_b32 s41, s21, 1
  s_lshl_b32 s42, s20, 11
  s_lshl_b32 s40, s41, 14
  s_add_u32 s40, s40, s42
  v_lshl_add_u32 v76, v0, 4, s40
  s_lshl_b32 s40, s41, 10
  s_add_u32 s40, s40, s42
  s_add_u32 s40, s40, 32768
  v_lshl_add_u32 v83, v0, 4, s40
  v_lshrrev_b32 v2, 3, v0
  v_lshlrev_b32 v2, 7, v2
  v_and_b32 v3, 7, v0
  v_lshl_add_u32 v2, v3, 2, v2
  v_add_u32 v2, 1388544, v2
  s_mov_b32 s25, 0
  s_mov_b32 s37, 2147483392
  s_mov_b32 s30, 0
  s_mov_b32 s34, s32
  s_mov_b32 s35, s27
  v_mov_b32 v81, v77
  v_mov_b32 v82, v78
  s_nop 1
Lpoll_26:
  buffer_load_dword v3, v2, s[4:7], 0 offen sc1
  s_sub_u32 s24, s24, 1
  s_cbranch_scc1 L_FAIL
  s_waitcnt vmcnt(0)
  v_cmp_gt_i32 vcc, 1, v3
  s_cbranch_vccz Lpolld_27
  s_sleep 1
  s_branch Lpoll_26
Lpolld_27:
  s_add_u32 m0, s34, 0
  s_nop 0
  buffer_load_dwordx4 v1, s[4:7], s35 offen offset:0 sc1 lds
  s_add_u32 m0, s34, 3968
  s_nop 0
  buffer_load_dwordx4 v1, s[4:7], s35 offen offset:128 sc1 lds
  s_add_u32 m0, s34, 7936
  s_nop 0
  buffer_load_dwordx4 v1, s[4:7], s35 offen offset:256 sc1 lds
  s_add_u32 m0, s34, 11904
  s_nop 0
  buffer_load_dwordx4 v1, s[4:7], s35 offen offset:384 sc1 lds
  s_add_u32 m0, s34, 15872
  s_nop 0
  buffer_load_dwordx4 v1, s[4:7], s35 offen offset:512 sc1 lds
  s_add_u32 m0, s34, 19840
  s_nop 0
  buffer_load_dwordx4 v1, s[4:7], s35 offen offset:640 sc1 lds
  s_add_u32 m0, s34, 23808
  s_nop 0
  buffer_load_dwordx4 v1, s[4:7], s35 offen offset:768 sc1 lds
  s_add_u32 m0, s34, 27776
  s_nop 0
  buffer_load_dwordx4 v1, s[4:7], s35 offen offset:896 sc1 lds
  s_add_u32 m0, s34, 31744
  s_nop 0
  buffer_load_dwordx4 v1, s[4:7], s35 offen offset:1024 sc1 lds
  s_add_u32 m0, s34, 35712
  s_nop 0
  buffer_load_dwordx4 v1, s[4:7], s35 offen offset:1152 sc1 lds
  s_add_u32 m0, s34, 39680
  s_nop 0
  buffer_load_dwordx4 v1, s[4:7], s35 offen offset:1280 sc1 lds
  s_add_u32 m0, s34, 43648
  s_nop 0
  buffer_load_dwordx4 v1, s[4:7], s35 offen offset:1408 sc1 lds
  s_add_u32 m0, s34, 47616
  s_nop 0
  buffer_load_dwordx4 v1, s[4:7], s35 offen offset:1536 sc1 lds
  s_add_u32 m0, s34, 51584
  s_nop 0
  buffer_load_dwordx4 v1, s[4:7], s35 offen offset:1664 sc1 lds
  s_add_u32 m0, s34, 55552
  s_nop 0
  buffer_load_dwordx4 v1, s[4:7], s35 offen offset:1792 sc1 lds
  s_add_u32 m0, s34, 59520
  s_nop 0
  buffer_load_dwordx4 v1, s[4:7], s35 offen offset:1920 sc1 lds
  v_min_u32 v60, 63, v0
  v_lshlrev_b32 v60, 7, v60
  v_add_u32 v60, 1424384, v60
  s_nop 1
Lpoll_28:
  buffer_load_dword v61, v60, s[4:7], 0 offen sc1
  s_sub_u32 s24, s24, 1
  s_cbranch_scc1 L_FAIL
  s_waitcnt vmcnt(0)
  v_cmp_gt_i32 vcc, 0, v61
  s_cbranch_vccz Lpolld_29
  s_sleep 1
  s_branch Lpoll_28
Lpolld_29:
  v_lshrrev_b32 v61, 8, v61
  v_and_b32 v62, 3, v0
  v_lshl_or_b32 v61, v61, 2, v62
  s_nop 1
  v_min_u32_dpp v61, v61, v61 row_ror:8 row_mask:0xf bank_mask:0xf
  s_nop 1
  v_min_u32_dpp v61, v61, v61 row_ror:4 row_mask:0xf bank_mask:0xf
  v_mov_b32 v62, v61
  s_nop 1
  v_permlane16_swap_b32 v62, v61
  v_min_u32 v61, v61, v62
  v_mov_b32 v62, v61
  s_nop 1
  v_permlane32_swap_b32 v62, v61
  v_min_u32 v61, v61, v62
  s_nop 1
  v_min_u32_dpp v61, v61, v61 row_ror:2 row_mask:0xf bank_mask:0xf
  s_nop 1
  v_min_u32_dpp v61, v61, v61 row_ror:1 row_mask:0xf bank_mask:0xf
  s_nop 0
  v_readfirstlane_b32 s40, v61
  s_and_b32 s40, s40, 3
  s_lshl_b32 s40, s40, 13
  s_and_b32 s40, s40, 0x2000
  s_xor_b32 s40, s40, 16777216
  s_add_u32 s31, s31, s40
  s_barrier
  ds_read_b128 v[4:7], v81 offset:0
  ds_read_b128 v[8:11], v81 offset:2048
  ds_read_b128 v[12:15], v82 offset:0
  ds_read_b128 v[16:19], v82 offset:2048
  ds_read_b128 v[20:23], v81 offset:4096
  ds_read_b128 v[24:27], v81 offset:6144
  s_lshr_b32 s40, s21, 1
  s_lshl_b32 s40, s40, 7
  s_add_u32 s40, s40, 1404928
  v_mov_b32 v84, s40
  v_mov_b32 v85, -1
L_QKV_top:
  s_waitcnt lgkmcnt(4)
  v_cvt_pk_bf16_f32 v60, v36, v37
  v_cvt_pk_bf16_f32 v61, v38, v39
  v_mfma_f32_16x16x32_bf16 v[36:39], a[0:3], v[4:7], 0
  v_cvt_pk_bf16_f32 v62, v44, v45
  v_cvt_pk_bf16_f32 v63, v46, v47
  v_mfma_f32_16x16x32_bf16 v[44:47], a[128:131], v[4:7], 0
  v_cvt_pk_bf16_f32 v64, v40, v41
  v_cvt_pk_bf16_f32 v65, v42, v43
  v_mfma_f32_16x16x32_bf16 v[40:43], a[0:3], v[8:11], 0
  v_cvt_pk_bf16_f32 v66, v48, v49
  v_cvt_pk_bf16_f32 v67, v50, v51
  v_mfma_f32_16x16x32_bf16 v[48:51], a[128:131], v[8:11], 0
  v_cvt_pk_bf16_f32 v68, v52, v53
  v_cvt_pk_bf16_f32 v69, v54, v55
  v_mfma_f32_16x16x32_bf16 v[52:55], v[4:7], v[128:131], 0
  ds_read_b128 v[28:31], v82 offset:4096
  v_cvt_pk_bf16_f32 v70, v56, v57
  v_cvt_pk_bf16_f32 v71, v58, v59
  v_mfma_f32_16x16x32_bf16 v[56:59], v[8:11], v[128:131], 0
  ds_read_b128 v[32:35], v82 offset:6144
  s_waitcnt lgkmcnt(4)
  v_mfma_f32_16x16x32_bf16 v[36:39], a[4:7], v[12:15], v[36:39]
  ds_read_b128 v[4:7], v81 offset:8192
  v_mfma_f32_16x16x32_bf16 v[44:47], a[132:135], v[12:15], v[44:47]
  ds_read_b128 v[8:11], v81 offset:10240
  v_mfma_f32_16x16x32_bf16 v[40:43], a[4:7], v[16:19], v[40:43]
  buffer_store_dwordx4 v[60:63], v76, s[4:7], s37 offen offset:0 sc1
  v_mfma_f32_16x16x32_bf16 v[48:51], a[132:135], v[16:19], v[48:51]
  buffer_store_dwordx4 v[64:67], v76, s[4:7], s37 offen offset:1024 sc1
  v_mfma_f32_16x16x32_bf16 v[52:55], v[12:15], v[132:135], v[52:55]
  v_mfma_f32_16x16x32_bf16 v[56:59], v[16:19], v[132:135], v[56:59]
  s_waitcnt lgkmcnt(4)
  v_mfma_f32_16x16x32_bf16 v[36:39], a[8:11], v[20:23], v[36:39]
  ds_read_b128 v[12:15], v82 offset:8192
  v_mfma_f32_16x16x32_bf16 v[44:47], a[136:139], v[20:23], v[44:47]
  ds_read_b128 v[16:19], v82 offset:10240
  v_mfma_f32_16x16x32_bf16 v[40:43], a[8:11], v[24:27], v[40:43]
  buffer_store_dwordx4 v[68:71], v83, s[4:7], s37 offen sc1
  v_mfma_f32_16x16x32_bf16 v[48:51], a[136:139], v[24:27], v[48:51]
  v_cmp_gt_i32 vcc, 1, v3
  v_mfma_f32_16x16x32_bf16 v[52:55], v[20:23], v[136:139], v[52:55]
  v_mfma_f32_16x16x32_bf16 v[56:59], v[24:27], v[136:139], v[56:59]
  s_xor_b32 s34, s34, 0x10000
  s_add_u32 s35, s35, 65536
  s_cbranch_vccz L_QKV_have
  s_nop 4
Lpoll_30:
  buffer_load_dword v3, v2, s[4:7], s30 offen sc1
  s_sub_u32 s24, s24, 1
  s_cbranch_scc1 L_FAIL
  s_waitcnt vmcnt(0)
  v_cmp_gt_i32 vcc, 1, v3
  s_cbranch_vccz Lpolld_31
  s_sleep 1
  s_branch Lpoll_30
Lpolld_31:
L_QKV_have:
  s_barrier
  s_waitcnt lgkmcnt(4)
  v_mfma_f32_16x16x32_bf16 v[36:39], a[12:15], v[28:31], v[36:39]
  ds_read_b128 v[20:23], v81 offset:12288
  v_mfma_f32_16x16x32_bf16 v[44:47], a[140:143], v[28:31], v[44:47]
  ds_read_b128 v[24:27], v81 offset:14336
  v_mfma_f32_16x16x32_bf16 v[40:43], a[12:15], v[32:35], v[40:43]
  s_add_u32 m0, s34, 0
  s_nop 0
  buffer_load_dwordx4 v1, s[4:7], s35 offen offset:0 sc1 lds
  v_mfma_f32_16x16x32_bf16 v[48:51], a[140:143], v[32:35], v[48:51]
  v_mfma_f32_16x16x32_bf16 v[52:55], v[28:31], v[140:143], v[52:55]
  v_mfma_f32_16x16x32_bf16 v[56:59], v[32:35], v[140:143], v[56:59]
  s_waitcnt lgkmcnt(4)
  v_mfma_f32_16x16x32_bf16 v[36:39], a[16:19], v[4:7], v[36:39]
  ds_read_b128 v[28:31], v82 offset:12288
  v_mfma_f32_16x16x32_bf16 v[44:47], a[144:147], v[4:7], v[44:47]
  ds_read_b128 v[32:35], v82 offset:14336
  v_mfma_f32_16x16x32_bf16 v[40:43], a[16:19], v[8:11], v[40:43]
  s_add_u32 m0, s34, 3968
  s_nop 0
  buffer_load_dwordx4 v1, s[4:7], s35 offen offset:128 sc1 lds
  v_mfma_f32_16x16x32_bf16 v[48:51], a[144:147], v[8:11], v[48:51]
  v_mfma_f32_16x16x32_bf16 v[52:55], v[4:7], v[144:147], v[52:55]
  v_mfma_f32_16x16x32_bf16 v[56:59], v[8:11], v[144:147], v[56:59]
  s_waitcnt lgkmcnt(4)
  v_mfma_f32_16x16x32_bf16 v[36:39], a[20:23], v[12:15], v[36:39]
  ds_read_b128 v[4:7], v81 offset:16384
  v_mfma_f32_16x16x32_bf16 v[44:47], a[148:151], v[12:15], v[44:47]
  ds_read_b128 v[8:11], v81 offset:18432
  v_mfma_f32_16x16x32_bf16 v[40:43], a[20:23], v[16:19], v[40:43]
  s_add_u32 m0, s34, 7936
  s_nop 0
  buffer_load_dwordx4 v1, s[4:7], s35 offen offset:256 sc1 lds
  v_mfma_f32_16x16x32_bf16 v[48:51], a[148:151], v[16:19], v[48:51]
  v_mfma_f32_16x16x32_bf16 v[52:55], v[12:15], v[148:151], v[52:55]
  v_mfma_f32_16x16x32_bf16 v[56:59], v[16:19], v[148:151], v[56:59]
  s_waitcnt lgkmcnt(4)
  v_mfma_f32_16x16x32_bf16 v[36:39], a[24:27], v[20:23], v[36:39]
  ds_read_b128 v[12:15], v82 offset:16384
  v_mfma_f32_16x16x32_bf16 v[44:47], a[152:155], v[20:23], v[44:47]
  ds_read_b128 v[16:19], v82 offset:18432
  v_mfma_f32_16x16x32_bf16 v[40:43], a[24:27], v[24:27], v[40:43]
  s_add_u32 m0, s34, 11904
  s_nop 0
  buffer_load_dwordx4 v1, s[4:7], s35 offen offset:384 sc1 lds
  v_mfma_f32_16x16x32_bf16 v[48:51], a[152:155], v[24:27], v[48:51]
  v_mfma_f32_16x16x32_bf16 v[52:55], v[20:23], v[152:155], v[52:55]
  v_mfma_f32_16x16x32_bf16 v[56:59], v[24:27], v[152:155], v[56:59]
  s_waitcnt lgkmcnt(4)
  v_mfma_f32_16x16x32_bf16 v[36:39], a[28:31], v[28:31], v[36:39]
  ds_read_b128 v[20:23], v81 offset:20480
  v_mfma_f32_16x16x32_bf16 v[44:47], a[156:159], v[28:31], v[44:47]
  ds_read_b128 v[24:27], v81 offset:22528
  v_mfma_f32_16x16x32_bf16 v[40:43], a[28:31], v[32:35], v[40:43]
  s_add_u32 m0, s34, 15872
  s_nop 0
  buffer_load_dwordx4 v1, s[4:7], s35 offen offset:512 sc1 lds
  v_mfma_f32_16x16x32_bf16 v[48:51], a[156:159], v[32:35], v[48:51]
  v_mfma_f32_16x16x32_bf16 v[52:55], v[28:31], v[156:159], v[52:55]
  v_mfma_f32_16x16x32_bf16 v[56:59], v[32:35], v[156:159], v[56:59]
  s_waitcnt lgkmcnt(4)
  v_mfma_f32_16x16x32_bf16 v[36:39], a[32:35], v[4:7], v[36:39]
  ds_read_b128 v[28:31], v82 offset:20480
  v_mfma_f32_16x16x32_bf16 v[44:47], a[160:163], v[4:7], v[44:47]
  ds_read_b128 v[32:35], v82 offset:22528
  v_mfma_f32_16x16x32_bf16 v[40:43], a[32:35], v[8:11], v[40:43]
  s_add_u32 m0, s34, 19840
  s_nop 0
  buffer_load_dwordx4 v1, s[4:7], s35 offen offset:640 sc1 lds
  v_mfma_f32_16x16x32_bf16 v[48:51], a[160:163], v[8:11], v[48:51]
  v_mfma_f32_16x16x32_bf16 v[52:55], v[4:7], v[160:163], v[52:55]
  v_mfma_f32_16x16x32_bf16 v[56:59], v[8:11], v[160:163], v[56:59]
  s_waitcnt lgkmcnt(4)
  v_mfma_f32_16x16x32_bf16 v[36:39], a[36:39], v[12:15], v[36:39]
  ds_read_b128 v[4:7], v81 offset:24576
  v_mfma_f32_16x16x32_bf16 v[44:47], a[164:167], v[12:15], v[44:47]
  ds_read_b128 v[8:11], v81 offset:26624
  v_mfma_f32_16x16x32_bf16 v[40:43], a[36:39], v[16:19], v[40:43]
  s_add_u32 m0, s34, 23808
  s_nop 0
  buffer_load_dwordx4 v1, s[4:7], s35 offen offset:768 sc1 lds
  v_mfma_f32_16x16x32_bf16 v[48:51], a[164:167], v[16:19], v[48:51]
  v_mfma_f32_16x16x32_bf16 v[52:55], v[12:15], v[164:167], v[52:55]
  v_mfma_f32_16x16x32_bf16 v[56:59], v[16:19], v[164:167], v[56:59]
  s_waitcnt lgkmcnt(4)
  v_mfma_f32_16x16x32_bf16 v[36:39], a[40:43], v[20:23], v[36:39]
  ds_read_b128 v[12:15], v82 offset:24576
  v_mfma_f32_16x16x32_bf16 v[44:47], a[168:171], v[20:23], v[44:47]
  ds_read_b128 v[16:19], v82 offset:26624
  v_mfma_f32_16x16x32_bf16 v[40:43], a[40:43], v[24:27], v[40:43]
  s_add_u32 m0, s34, 27776
  s_nop 0
  buffer_load_dwordx4 v1, s[4:7], s35 offen offset:896 sc1 lds
  v_mfma_f32_16x16x32_bf16 v[48:51], a[168:171], v[24:27], v[48:51]
  v_mfma_f32_16x16x32_bf16 v[52:55], v[20:23], v[168:171], v[52:55]
  v_mfma_f32_16x16x32_bf16 v[56:59], v[24:27], v[168:171], v[56:59]
  s_waitcnt lgkmcnt(4)
  v_mfma_f32_16x16x32_bf16 v[36:39], a[44:47], v[28:31], v[36:39]
  ds_read_b128 v[20:23], v81 offset:28672
  v_mfma_f32_16x16x32_bf16 v[44:47], a[172:175], v[28:31], v[44:47]
  ds_read_b128 v[24:27], v81 offset:30720
  v_mfma_f32_16x16x32_bf16 v[40:43], a[44:47], v[32:35], v[40:43]
  s_add_u32 m0, s34, 31744
  s_nop 0
  buffer_load_dwordx4 v1, s[4:7], s35 offen offset:1024 sc1 lds
  v_mfma_f32_16x16x32_bf16 v[48:51], a[172:175], v[32:35], v[48:51]
  v_mfma_f32_16x16x32_bf16 v[52:55], v[28:31], v[172:175], v[52:55]
  v_mfma_f32_16x16x32_bf16 v[56:59], v[32:35], v[172:175], v[56:59]
  s_waitcnt vmcnt(9)
  s_barrier
  s_cmp_lg_u32 s20, 0
  s_cbranch_scc1 Lnosig_32
  s_mov_b32 s63, s25
  s_atomic_smax s63, s[4:5], s62 glc
Lnosig_32:
  s_waitcnt lgkmcnt(4)
  v_mfma_f32_16x16x32_bf16 v[36:39], a[48:51], v[4:7], v[36:39]
  ds_read_b128 v[28:31], v82 offset:28672
  v_mfma_f32_16x16x32_bf16 v[44:47], a[176:179], v[4:7], v[44:47]
  ds_read_b128 v[32:35], v82 offset:30720
  v_mfma_f32_16x16x32_bf16 v[40:43], a[48:51], v[8:11], v[40:43]
  s_add_u32 m0, s34, 35712
  s_nop 0
  buffer_load_dwordx4 v1, s[4:7], s35 offen offset:1152 sc1 lds
  v_mfma_f32_16x16x32_bf16 v[48:51], a[176:179], v[8:11], v[48:51]
  v_mfma_f32_16x16x32_bf16 v[52:55], v[4:7], v[176:179], v[52:55]
  v_mfma_f32_16x16x32_bf16 v[56:59], v[8:11], v[176:179], v[56:59]
  s_waitcnt lgkmcnt(4)
  v_mfma_f32_16x16x32_bf16 v[36:39], a[52:55], v[12:15], v[36:39]
  ds_read_b128 v[4:7], v81 offset:32768
  v_mfma_f32_16x16x32_bf16 v[44:47], a[180:183], v[12:15], v[44:47]
  ds_read_b128 v[8:11], v81 offset:34816
  v_mfma_f32_16x16x32_bf16 v[40:43], a[52:55], v[16:19], v[40:43]
  s_add_u32 m0, s34, 39680
  s_nop 0
  buffer_load_dwordx4 v1, s[4:7], s35 offen offset:1280 sc1 lds
  v_mfma_f32_16x16x32_bf16 v[48:51], a[180:183], v[16:19], v[48:51]
  v_mfma_f32_16x16x32_bf16 v[52:55], v[12:15], v[180:183], v[52:55]
  v_mfma_f32_16x16x32_bf16 v[56:59], v[16:19], v[180:183], v[56:59]
  s_waitcnt lgkmcnt(4)
  v_mfma_f32_16x16x32_bf16 v[36:39], a[56:59], v[20:23], v[36:39]
  ds_read_b128 v[12:15], v82 offset:32768
  v_mfma_f32_16x16x32_bf16 v[44:47], a[184:187], v[20:23], v[44:47]
  ds_read_b128 v[16:19], v82 offset:34816
  v_mfma_f32_16x16x32_bf16 v[40:43], a[56:59], v[24:27], v[40:43]
  s_add_u32 m0, s34, 43648
  s_nop 0
  buffer_load_dwordx4 v1, s[4:7], s35 offen offset:1408 sc1 lds
  v_mfma_f32_16x16x32_bf16 v[48:51], a[184:187], v[24:27], v[48:51]
  v_mfma_f32_16x16x32_bf16 v[52:55], v[20:23], v[184:187], v[52:55]
  v_mfma_f32_16x16x32_bf16 v[56:59], v[24:27], v[184:187], v[56:59]
  s_waitcnt lgkmcnt(4)
  v_mfma_f32_16x16x32_bf16 v[36:39], a[60:63], v[28:31], v[36:39]
  ds_read_b128 v[20:23], v81 offset:36864
  v_mfma_f32_16x16x32_bf16 v[44:47], a[188:191], v[28:31], v[44:47]
  ds_read_b128 v[24:27], v81 offset:38912
  v_mfma_f32_16x16x32_bf16 v[40:43], a[60:63], v[32:35], v[40:43]
  s_add_u32 m0, s34, 47616
  s_nop 0
  buffer_load_dwordx4 v1, s[4:7], s35 offen offset:1536 sc1 lds
  v_mfma_f32_16x16x32_bf16 v[48:51], a[188:191], v[32:35], v[48:51]
  v_mfma_f32_16x16x32_bf16 v[52:55], v[28:31], v[188:191], v[52:55]
  v_mfma_f32_16x16x32_bf16 v[56:59], v[32:35], v[188:191], v[56:59]
  s_waitcnt lgkmcnt(4)
  v_mfma_f32_16x16x32_bf16 v[36:39], a[64:67], v[4:7], v[36:39]
  ds_read_b128 v[28:31], v82 offset:36864
  v_mfma_f32_16x16x32_bf16 v[44:47], a[192:195], v[4:7], v[44:47]
  ds_read_b128 v[32:35], v82 offset:38912
  v_mfma_f32_16x16x32_bf16 v[40:43], a[64:67], v[8:11], v[40:43]
  s_add_u32 m0, s34, 51584
  s_nop 0
  buffer_load_dwordx4 v1, s[4:7], s35 offen offset:1664 sc1 lds
  v_mfma_f32_16x16x32_bf16 v[48:51], a[192:195], v[8:11], v[48:51]
  v_mfma_f32_16x16x32_bf16 v[52:55], v[4:7], v[192:195], v[52:55]
  v_mfma_f32_16x16x32_bf16 v[56:59], v[8:11], v[192:195], v[56:59]
  s_waitcnt lgkmcnt(4)
  v_mfma_f32_16x16x32_bf16 v[36:39], a[68:71], v[12:15], v[36:39]
  ds_read_b128 v[4:7], v81 offset:40960
  v_mfma_f32_16x16x32_bf16 v[44:47], a[196:199], v[12:15], v[44:47]
  ds_read_b128 v[8:11], v81 offset:43008
  v_mfma_f32_16x16x32_bf16 v[40:43], a[68:71], v[16:19], v[40:43]
  s_add_u32 m0, s34, 55552
  s_nop 0
  buffer_load_dwordx4 v1, s[4:7], s35 offen offset:1792 sc1 lds
  v_mfma_f32_16x16x32_bf16 v[48:51], a[196:199], v[16:19], v[48:51]
  v_mfma_f32_16x16x32_bf16 v[52:55], v[12:15], v[196:199], v[52:55]
  v_mfma_f32_16x16x32_bf16 v[56:59], v[16:19], v[196:199], v[56:59]
  s_waitcnt lgkmcnt(4)
  v_mfma_f32_16x16x32_bf16 v[36:39], a[72:75], v[20:23], v[36:39]
  ds_read_b128 v[12:15], v82 offset:40960
  v_mfma_f32_16x16x32_bf16 v[44:47], a[200:203], v[20:23], v[44:47]
  ds_read_b128 v[16:19], v82 offset:43008
  v_mfma_f32_16x16x32_bf16 v[40:43], a[72:75], v[24:27], v[40:43]
  s_add_u32 m0, s34, 59520
  s_nop 0
  buffer_load_dwordx4 v1, s[4:7], s35 offen offset:1920 sc1 lds
  v_mfma_f32_16x16x32_bf16 v[48:51], a[200:203], v[24:27], v[48:51]
  v_mfma_f32_16x16x32_bf16 v[52:55], v[20:23], v[200:203], v[52:55]
  v_mfma_f32_16x16x32_bf16 v[56:59], v[24:27], v[200:203], v[56:59]
  s_waitcnt lgkmcnt(4)
  v_mfma_f32_16x16x32_bf16 v[36:39], a[76:79], v[28:31], v[36:39]
  ds_read_b128 v[20:23], v81 offset:45056
  v_mfma_f32_16x16x32_bf16 v[44:47], a[204:207], v[28:31], v[44:47]
  ds_read_b128 v[24:27], v81 offset:47104
  v_mfma_f32_16x16x32_bf16 v[40:43], a[76:79], v[32:35], v[40:43]
  v_mfma_f32_16x16x32_bf16 v[48:51], a[204:207], v[32:35], v[48:51]
  v_mfma_f32_16x16x32_bf16 v[52:55], v[28:31], v[204:207], v[52:55]
  v_mfma_f32_16x16x32_bf16 v[56:59], v[32:35], v[204:207], v[56:59]
  s_waitcnt lgkmcnt(4)
  v_mfma_f32_16x16x32_bf16 v[36:39], a[80:83], v[4:7], v[36:39]
  ds_read_b128 v[28:31], v82 offset:45056
  v_mfma_f32_16x16x32_bf16 v[44:47], a[208:211], v[4:7], v[44:47]
  ds_read_b128 v[32:35], v82 offset:47104
  v_mfma_f32_16x16x32_bf16 v[40:43], a[80:83], v[8:11], v[40:43]
  s_add_u32 s30, s25, 2
  s_and_b32 s30, s30, 56
  s_lshl_b32 s30, s30, 7
  buffer_load_dword v3, v2, s[4:7], s30 offen sc1
  v_mfma_f32_16x16x32_bf16 v[48:51], a[208:211], v[8:11], v[48:51]
  v_mfma_f32_16x16x32_bf16 v[52:55], v[4:7], v[208:211], v[52:55]
  v_mfma_f32_16x16x32_bf16 v[56:59], v[8:11], v[208:211], v[56:59]
  s_waitcnt lgkmcnt(4)
  v_mfma_f32_16x16x32_bf16 v[36:39], a[84:87], v[12:15], v[36:39]
  ds_read_b128 v[4:7], v81 offset:49152
  v_mfma_f32_16x16x32_bf16 v[44:47], a[212:215], v[12:15], v[44:47]
  ds_read_b128 v[8:11], v81 offset:51200
  v_mfma_f32_16x16x32_bf16 v[40:43], a[84:87], v[16:19], v[40:43]
  v_mfma_f32_16x16x32_bf16 v[48:51], a[212:215], v[16:19], v[48:51]
  v_mfma_f32_16x16x32_bf16 v[52:55], v[12:15], v[212:215], v[52:55]
  v_mfma_f32_16x16x32_bf16 v[56:59], v[16:19], v[212:215], v[56:59]
  s_waitcnt lgkmcnt(4)
  v_mfma_f32_16x16x32_bf16 v[36:39], a[88:91], v[20:23], v[36:39]
  ds_read_b128 v[12:15], v82 offset:49152
  v_mfma_f32_16x16x32_bf16 v[44:47], a[216:219], v[20:23], v[44:47]
  ds_read_b128 v[16:19], v82 offset:51200
  v_mfma_f32_16x16x32_bf16 v[40:43], a[88:91], v[24:27], v[40:43]
  v_mfma_f32_16x16x32_bf16 v[48:51], a[216:219], v[24:27], v[48:51]
  v_mfma_f32_16x16x32_bf16 v[52:55], v[20:23], v[216:219], v[52:55]
  v_mfma_f32_16x16x32_bf16 v[56:59], v[24:27], v[216:219], v[56:59]
  s_waitcnt lgkmcnt(4)
  v_mfma_f32_16x16x32_bf16 v[36:39], a[92:95], v[28:31], v[36:39]
  ds_read_b128 v[20:23], v81 offset:53248
  v_mfma_f32_16x16x32_bf16 v[44:47], a[220:223], v[28:31], v[44:47]
  ds_read_b128 v[24:27], v81 offset:55296
  v_mfma_f32_16x16x32_bf16 v[40:43], a[92:95], v[32:35], v[40:43]
  v_mfma_f32_16x16x32_bf16 v[48:51], a[220:223], v[32:35], v[48:51]
  v_mfma_f32_16x16x32_bf16 v[52:55], v[28:31], v[220:223], v[52:55]
  v_mfma_f32_16x16x32_bf16 v[56:59], v[32:35], v[220:223], v[56:59]
  s_waitcnt lgkmcnt(4)
  v_mfma_f32_16x16x32_bf16 v[36:39], a[96:99], v[4:7], v[36:39]
  ds_read_b128 v[28:31], v82 offset:53248
  v_mfma_f32_16x16x32_bf16 v[44:47], a[224:227], v[4:7], v[44:47]
  ds_read_b128 v[32:35], v82 offset:55296
  v_mfma_f32_16x16x32_bf16 v[40:43], a[96:99], v[8:11], v[40:43]
  v_mfma_f32_16x16x32_bf16 v[48:51], a[224:227], v[8:11], v[48:51]
  v_mfma_f32_16x16x32_bf16 v[52:55], v[4:7], v[224:227], v[52:55]
  v_mfma_f32_16x16x32_bf16 v[56:59], v[8:11], v[224:227], v[56:59]
  s_waitcnt lgkmcnt(4)
  v_mfma_f32_16x16x32_bf16 v[36:39], a[100:103], v[12:15], v[36:39]
  ds_read_b128 v[4:7], v81 offset:57344
  v_mfma_f32_16x16x32_bf16 v[44:47], a[228:231], v[12:15], v[44:47]
  ds_read_b128 v[8:11], v81 offset:59392
  v_mfma_f32_16x16x32_bf16 v[40:43], a[100:103], v[16:19], v[40:43]
  v_mfma_f32_16x16x32_bf16 v[48:51], a[228:231], v[16:19], v[48:51]
  v_mfma_f32_16x16x32_bf16 v[52:55], v[12:15], v[228:231], v[52:55]
  v_mfma_f32_16x16x32_bf16 v[56:59], v[16:19], v[228:231], v[56:59]
  s_waitcnt lgkmcnt(4)
  v_mfma_f32_16x16x32_bf16 v[36:39], a[104:107], v[20:23], v[36:39]
  ds_read_b128 v[12:15], v82 offset:57344
  v_mfma_f32_16x16x32_bf16 v[44:47], a[232:235], v[20:23], v[44:47]
  ds_read_b128 v[16:19], v82 offset:59392
  v_mfma_f32_16x16x32_bf16 v[40:43], a[104:107], v[24:27], v[40:43]
  v_mfma_f32_16x16x32_bf16 v[48:51], a[232:235], v[24:27], v[48:51]
  v_mfma_f32_16x16x32_bf16 v[52:55], v[20:23], v[232:235], v[52:55]
  v_mfma_f32_16x16x32_bf16 v[56:59], v[24:27], v[232:235], v[56:59]
  s_waitcnt lgkmcnt(4)
  v_mfma_f32_16x16x32_bf16 v[36:39], a[108:111], v[28:31], v[36:39]
  ds_read_b128 v[20:23], v81 offset:61440
  v_mfma_f32_16x16x32_bf16 v[44:47], a[236:239], v[28:31], v[44:47]
  ds_read_b128 v[24:27], v81 offset:63488
  v_mfma_f32_16x16x32_bf16 v[40:43], a[108:111], v[32:35], v[40:43]
  v_mfma_f32_16x16x32_bf16 v[48:51], a[236:239], v[32:35], v[48:51]
  v_mfma_f32_16x16x32_bf16 v[52:55], v[28:31], v[236:239], v[52:55]
  v_mfma_f32_16x16x32_bf16 v[56:59], v[32:35], v[236:239], v[56:59]
  s_waitcnt lgkmcnt(4)
  v_mfma_f32_16x16x32_bf16 v[36:39], a[112:115], v[4:7], v[36:39]
  ds_read_b128 v[28:31], v82 offset:61440
  v_mfma_f32_16x16x32_bf16 v[44:47], a[240:243], v[4:7], v[44:47]
  ds_read_b128 v[32:35], v82 offset:63488
  v_mfma_f32_16x16x32_bf16 v[40:43], a[112:115], v[8:11], v[40:43]
  v_mfma_f32_16x16x32_bf16 v[48:51], a[240:243], v[8:11], v[48:51]
  v_mfma_f32_16x16x32_bf16 v[52:55], v[4:7], v[240:243], v[52:55]
  v_mfma_f32_16x16x32_bf16 v[56:59], v[8:11], v[240:243], v[56:59]
  s_waitcnt vmcnt(0)
  s_barrier
  v_xor_b32 v81, 0x10000, v81
  v_xor_b32 v82, 0x10000, v82
  s_waitcnt lgkmcnt(4)
  v_mfma_f32_16x16x32_bf16 v[36:39], a[116:119], v[12:15], v[36:39]
  ds_read_b128 v[4:7], v81 offset:0
  v_mfma_f32_16x16x32_bf16 v[44:47], a[244:247], v[12:15], v[44:47]
  ds_read_b128 v[8:11], v81 offset:2048
  v_mfma_f32_16x16x32_bf16 v[40:43], a[116:119], v[16:19], v[40:43]
  v_mfma_f32_16x16x32_bf16 v[48:51], a[244:247], v[16:19], v[48:51]
  v_mfma_f32_16x16x32_bf16 v[52:55], v[12:15], v[244:247], v[52:55]
  v_mfma_f32_16x16x32_bf16 v[56:59], v[16:19], v[244:247], v[56:59]
  s_waitcnt lgkmcnt(4)
  v_mfma_f32_16x16x32_bf16 v[36:39], a[120:123], v[20:23], v[36:39]
  ds_read_b128 v[12:15], v82 offset:0
  v_mfma_f32_16x16x32_bf16 v[44:47], a[248:251], v[20:23], v[44:47]
  ds_read_b128 v[16:19], v82 offset:2048
  v_mfma_f32_16x16x32_bf16 v[40:43], a[120:123], v[24:27], v[40:43]
  v_mfma_f32_16x16x32_bf16 v[48:51], a[248:251], v[24:27], v[48:51]
  v_mfma_f32_16x16x32_bf16 v[52:55], v[20:23], v[248:251], v[52:55]
  v_mfma_f32_16x16x32_bf16 v[56:59], v[24:27], v[248:251], v[56:59]
  s_waitcnt lgkmcnt(4)
  v_mfma_f32_16x16x32_bf16 v[36:39], a[124:127], v[28:31], v[36:39]
  ds_read_b128 v[20:23], v81 offset:4096
  v_mfma_f32_16x16x32_bf16 v[44:47], a[252:255], v[28:31], v[44:47]
  ds_read_b128 v[24:27], v81 offset:6144
  v_mfma_f32_16x16x32_bf16 v[40:43], a[124:127], v[32:35], v[40:43]
  v_mfma_f32_16x16x32_bf16 v[48:51], a[252:255], v[32:35], v[48:51]
  v_mfma_f32_16x16x32_bf16 v[52:55], v[28:31], v[252:255], v[52:55]
  v_mfma_f32_16x16x32_bf16 v[56:59], v[32:35], v[252:255], v[56:59]
  s_mov_b32 s37, s31
  s_add_u32 s31, s31, 2097152
  s_xor_b32 s31, s31, 0x2000
  s_add_u32 s25, s25, 1
  s_cmp_lt_u32 s25, 64
  s_cbranch_scc1 L_QKV_top
  v_cvt_pk_bf16_f32 v60, v36, v37
  v_cvt_pk_bf16_f32 v61, v38, v39
  v_cvt_pk_bf16_f32 v62, v44, v45
  v_cvt_pk_bf16_f32 v63, v46, v47
  v_cvt_pk_bf16_f32 v64, v40, v41
  v_cvt_pk_bf16_f32 v65, v42, v43
  v_cvt_pk_bf16_f32 v66, v48, v49
  v_cvt_pk_bf16_f32 v67, v50, v51
  v_cvt_pk_bf16_f32 v68, v52, v53
  v_cvt_pk_bf16_f32 v69, v54, v55
  v_cvt_pk_bf16_f32 v70, v56, v57
  v_cvt_pk_bf16_f32 v71, v58, v59
  buffer_store_dwordx4 v[60:63], v76, s[4:7], s37 offen offset:0 sc1
  buffer_store_dwordx4 v[64:67], v76, s[4:7], s37 offen offset:1024 sc1
  buffer_store_dwordx4 v[68:71], v83, s[4:7], s37 offen sc1
  s_waitcnt vmcnt(0) lgkmcnt(0)
  s_barrier
  s_cmp_lg_u32 s20, 0
  s_cbranch_scc1 Lnosig_33
  s_mov_b32 s63, s25
  s_atomic_smax s63, s[4:5], s62 glc
Lnosig_33:
  s_branch L_END
L_WO:
  v_lshlrev_b32 v1, 4, v0
  s_lshl_b32 s32, s20, 12
  s_min_u32 s33, s32, 0x2000
  v_mov_b32 v69, v1
  v_add_u32 v70, 0x10000, v69
  s_load_dwordx2 s[8:9], s[0:1], 40
  s_mov_b32 s10, 8388608
  s_mov_b32 s11, 0x20000
  s_waitcnt lgkmcnt(0)
  s_lshr_b32 s44, s21, 3
  s_mul_i32 s44, s44, 2097152
  s_and_b32 s45, s21, 7
  s_lshl_b32 s45, s45, 8
  s_add_u32 s44, s44, s45
  s_add_u32 s45, s44, 128
  v_bfe_u32 v4, v0, 5, 1
  v_mul_u32_u24 v4, 8192, v4
  v_bfe_u32 v5, v0, 4, 1
  v_mul_u32_u24 v5, 4096, v5
  v_add_u32 v4, v4, v5
  v_bfe_u32 v5, v0, 3, 1
  v_mul_u32_u24 v5, 2048, v5
  v_add_u32 v4, v4, v5
  v_lshrrev_b32 v5, 3, v0
  v_and_b32 v5, 6, v5
  v_xor_b32 v5, v5, v0
  v_and_b32 v5, 7, v5
  v_lshl_add_u32 v4, v5, 4, v4
  s_lshr_b32 s40, s20, 1
  s_mul_i32 s40, s40, 131072
  s_and_b32 s41, s20, 1
  s_mul_i32 s41, s41, 16384
  s_add_u32 s40, s40, s41
  v_add_u32 v4, s40, v4
  v_bfe_u32 v5, v0, 3, 2
  v_xor_b32 v5, s20, v5
  v_lshlrev_b32 v5, 5, v5
  v_lshrrev_b32 v6, 2, v0
  v_lshl_add_u32 v6, v6, 7, v5
  v_and_b32 v5, 3, v0
  v_lshl_add_u32 v6, v5, 3, v6
  v_add_u32 v7, 0x10000, v6
  v_add_u32 v8, s44, v4
  v_add_u32 v9, s45, v4
  s_lshl_b32 s41, s20, 10
  s_add_u32 m0, s41, 0
  s_mov_b32 s42, 0
  buffer_load_dwordx4 v8, s[8:11], s42 offen nt lds
  s_add_u32 m0, s41, 4096
  s_mov_b32 s42, 0
  buffer_load_dwordx4 v9, s[8:11], s42 offen nt lds
  s_add_u32 m0, s41, 8192
  s_mov_b32 s42, 32768
  buffer_load_dwordx4 v8, s[8:11], s42 offen nt lds
  s_add_u32 m0, s41, 12288
  s_mov_b32 s42, 32768
  buffer_load_dwordx4 v9, s[8:11], s42 offen nt lds
  s_add_u32 m0, s41, 16384
  s_mov_b32 s42, 65536
  buffer_load_dwordx4 v8, s[8:11], s42 offen nt lds
  s_add_u32 m0, s41, 20480
  s_mov_b32 s42, 65536
  buffer_load_dwordx4 v9, s[8:11], s42 offen nt lds
  s_add_u32 m0, s41, 24576
  s_mov_b32 s42, 98304
  buffer_load_dwordx4 v8, s[8:11], s42 offen nt lds
  s_add_u32 m0, s41, 28672
  s_mov_b32 s42, 98304
  buffer_load_dwordx4 v9, s[8:11], s42 offen nt lds
  s_add_u32 m0, s41, 32768
  s_mov_b32 s42, 262144
  buffer_load_dwordx4 v8, s[8:11], s42 offen nt lds
  s_add_u32 m0, s41, 36864
  s_mov_b32 s42, 262144
  buffer_load_dwordx4 v9, s[8:11], s42 offen nt lds
  s_add_u32 m0, s41, 40960
  s_mov_b32 s42, 294912
  buffer_load_dwordx4 v8, s[8:11], s42 offen nt lds
  s_add_u32 m0, s41, 45056
  s_mov_b32 s42, 294912
  buffer_load_dwordx4 v9, s[8:11], s42 offen nt lds
  s_add_u32 m0, s41, 49152
  s_mov_b32 s42, 327680
  buffer_load_dwordx4 v8, s[8:11], s42 offen nt lds
  s_add_u32 m0, s41, 53248
  s_mov_b32 s42, 327680
  buffer_load_dwordx4 v9, s[8:11], s42 offen nt lds
  s_add_u32 m0, s41, 57344
  s_mov_b32 s42, 360448
  buffer_load_dwordx4 v8, s[8:11], s42 offen nt lds
  s_add_u32 m0, s41, 61440
  s_mov_b32 s42, 360448
  buffer_load_dwordx4 v9, s[8:11], s42 offen nt lds
  s_add_u32 m0, s41, 65536
  s_mov_b32 s42, 524288
  buffer_load_dwordx4 v8, s[8:11], s42 offen nt lds
  s_add_u32 m0, s41, 69632
  s_mov_b32 s42, 524288
  buffer_load_dwordx4 v9, s[8:11], s42 offen nt lds
  s_add_u32 m0, s41, 73728
  s_mov_b32 s42, 557056
  buffer_load_dwordx4 v8, s[8:11], s42 offen nt lds
  s_add_u32 m0, s41, 77824
  s_mov_b32 s42, 557056
  buffer_load_dwordx4 v9, s[8:11], s42 offen nt lds
  s_add_u32 m0, s41, 81920
  s_mov_b32 s42, 589824
  buffer_load_dwordx4 v8, s[8:11], s42 offen nt lds
  s_add_u32 m0, s41, 86016
  s_mov_b32 s42, 589824
  buffer_load_dwordx4 v9, s[8:11], s42 offen nt lds
  s_add_u32 m0, s41, 90112
  s_mov_b32 s42, 622592
  buffer_load_dwordx4 v8, s[8:11], s42 offen nt lds
  s_add_u32 m0, s41, 94208
  s_mov_b32 s42, 622592
  buffer_load_dwordx4 v9, s[8:11], s42 offen nt lds
  s_add_u32 m0, s41, 98304
  s_mov_b32 s42, 786432
  buffer_load_dwordx4 v8, s[8:11], s42 offen nt lds
  s_add_u32 m0, s41, 102400
  s_mov_b32 s42, 786432
  buffer_load_dwordx4 v9, s[8:11], s42 offen nt lds
  s_add_u32 m0, s41, 106496
  s_mov_b32 s42, 819200
  buffer_load_dwordx4 v8, s[8:11], s42 offen nt lds
  s_add_u32 m0, s41, 110592
  s_mov_b32 s42, 819200
  buffer_load_dwordx4 v9, s[8:11], s42 offen nt lds
  s_waitcnt vmcnt(24) lgkmcnt(0)
  s_barrier
  s_add_u32 m0, s41, 114688
  s_mov_b32 s42, 851968
  buffer_load_dwordx4 v8, s[8:11], s42 offen nt lds
  s_add_u32 m0, s41, 118784
  s_mov_b32 s42, 851968
  buffer_load_dwordx4 v9, s[8:11], s42 offen nt lds
  s_add_u32 m0, s41, 122880
  s_mov_b32 s42, 884736
  buffer_load_dwordx4 v8, s[8:11], s42 offen nt lds
  s_add_u32 m0, s41, 126976
  s_mov_b32 s42, 884736
  buffer_load_dwordx4 v9, s[8:11], s42 offen nt lds
  ds_read_b64_tr_b16 a[0:1], v6 offset:0
  ds_read_b64_tr_b16 a[2:3], v6 offset:2048
  ds_read_b64_tr_b16 a[128:129], v6 offset:4096
  ds_read_b64_tr_b16 a[130:131], v6 offset:6144
  ds_read_b64_tr_b16 a[4:5], v6 offset:8192
  ds_read_b64_tr_b16 a[6:7], v6 offset:10240
  ds_read_b64_tr_b16 a[132:133], v6 offset:12288
  ds_read_b64_tr_b16 a[134:135], v6 offset:14336
  s_waitcnt vmcnt(24) lgkmcnt(0)
  s_barrier
  s_add_u32 m0, s41, 0
  s_mov_b32 s42, 1048576
  buffer_load_dwordx4 v8, s[8:11], s42 offen nt lds
  s_add_u32 m0, s41, 4096
  s_mov_b32 s42, 1048576
  buffer_load_dwordx4 v9, s[8:11], s42 offen nt lds
  s_add_u32 m0, s41, 8192
  s_mov_b32 s42, 1081344
  buffer_load_dwordx4 v8, s[8:11], s42 offen nt lds
  s_add_u32 m0, s41, 12288
  s_mov_b32 s42, 1081344
  buffer_load_dwordx4 v9, s[8:11], s42 offen nt lds
  ds_read_b64_tr_b16 a[8:9], v6 offset:16384
  ds_read_b64_tr_b16 a[10:11], v6 offset:18432
  ds_read_b64_tr_b16 a[136:137], v6 offset:20480
  ds_read_b64_tr_b16 a[138:139], v6 offset:22528
  ds_read_b64_tr_b16 a[12:13], v6 offset:24576
  ds_read_b64_tr_b16 a[14:15], v6 offset:26624
  ds_read_b64_tr_b16 a[140:141], v6 offset:28672
  ds_read_b64_tr_b16 a[142:143], v6 offset:30720
  s_waitcnt vmcnt(24) lgkmcnt(0)
  s_barrier
  s_add_u32 m0, s41, 16384
  s_mov_b32 s42, 1114112
  buffer_load_dwordx4 v8, s[8:11], s42 offen nt lds
  s_add_u32 m0, s41, 20480
  s_mov_b32 s42, 1114112
  buffer_load_dwordx4 v9, s[8:11], s42 offen nt lds
  s_add_u32 m0, s41, 24576
  s_mov_b32 s42, 1146880
  buffer_load_dwordx4 v8, s[8:11], s42 offen nt lds
  s_add_u32 m0, s41, 28672
  s_mov_b32 s42, 1146880
  buffer_load_dwordx4 v9, s[8:11], s42 offen nt lds
  ds_read_b64_tr_b16 a[16:17], v6 offset:32768
  ds_read_b64_tr_b16 a[18:19], v6 offset:34816
  ds_read_b64_tr_b16 a[144:145], v6 offset:36864
  ds_read_b64_tr_b16 a[146:147], v6 offset:38912
  ds_read_b64_tr_b16 a[20:21], v6 offset:40960
  ds_read_b64_tr_b16 a[22:23], v6 offset:43008
  ds_read_b64_tr_b16 a[148:149], v6 offset:45056
  ds_read_b64_tr_b16 a[150:151], v6 offset:47104
  s_waitcnt vmcnt(24) lgkmcnt(0)
  s_barrier
  s_add_u32 m0, s41, 32768
  s_mov_b32 s42, 1310720
  buffer_load_dwordx4 v8, s[8:11], s42 offen nt lds
  s_add_u32 m0, s41, 36864
  s_mov_b32 s42, 1310720
  buffer_load_dwordx4 v9, s[8:11], s42 offen nt lds
  s_add_u32 m0, s41, 40960
  s_mov_b32 s42, 1343488
  buffer_load_dwordx4 v8, s[8:11], s42 offen nt lds
  s_add_u32 m0, s41, 45056
  s_mov_b32 s42, 1343488
  buffer_load_dwordx4 v9, s[8:11], s42 offen nt lds
  ds_read_b64_tr_b16 a[24:25], v6 offset:49152
  ds_read_b64_tr_b16 a[26:27], v6 offset:51200
  ds_read_b64_tr_b16 a[152:153], v6 offset:53248
  ds_read_b64_tr_b16 a[154:155], v6 offset:55296
  ds_read_b64_tr_b16 a[28:29], v6 offset:57344
  ds_read_b64_tr_b16 a[30:31], v6 offset:59392
  ds_read_b64_tr_b16 a[156:157], v6 offset:61440
  ds_read_b64_tr_b16 a[158:159], v6 offset:63488
  s_waitcnt vmcnt(24) lgkmcnt(0)
  s_barrier
  s_add_u32 m0, s41, 49152
  s_mov_b32 s42, 1376256
  buffer_load_dwordx4 v8, s[8:11], s42 offen nt lds
  s_add_u32 m0, s41, 53248
  s_mov_b32 s42, 1376256
  buffer_load_dwordx4 v9, s[8:11], s42 offen nt lds
  s_add_u32 m0, s41, 57344
  s_mov_b32 s42, 1409024
  buffer_load_dwordx4 v8, s[8:11], s42 offen nt lds
  s_add_u32 m0, s41, 61440
  s_mov_b32 s42, 1409024
  buffer_load_dwordx4 v9, s[8:11], s42 offen nt lds
  ds_read_b64_tr_b16 a[32:33], v7 offset:0
  ds_read_b64_tr_b16 a[34:35], v7 offset:2048
  ds_read_b64_tr_b16 a[160:161], v7 offset:4096
  ds_read_b64_tr_b16 a[162:163], v7 offset:6144
  ds_read_b64_tr_b16 a[36:37], v7 offset:8192
  ds_read_b64_tr_b16 a[38:39], v7 offset:10240
  ds_read_b64_tr_b16 a[164:165], v7 offset:12288
  ds_read_b64_tr_b16 a[166:167], v7 offset:14336
  s_waitcnt vmcnt(24) lgkmcnt(0)
  s_barrier
  s_add_u32 m0, s41, 65536
  s_mov_b32 s42, 1572864
  buffer_load_dwordx4 v8, s[8:11], s42 offen nt lds
  s_add_u32 m0, s41, 69632
  s_mov_b32 s42, 1572864
  buffer_load_dwordx4 v9, s[8:11], s42 offen nt lds
  s_add_u32 m0, s41, 73728
  s_mov_b32 s42, 1605632
  buffer_load_dwordx4 v8, s[8:11], s42 offen nt lds
  s_add_u32 m0, s41, 77824
  s_mov_b32 s42, 1605632
  buffer_load_dwordx4 v9, s[8:11], s42 offen nt lds
  ds_read_b64_tr_b16 a[40:41], v7 offset:16384
  ds_read_b64_tr_b16 a[42:43], v7 offset:18432
  ds_read_b64_tr_b16 a[168:169], v7 offset:20480
  ds_read_b64_tr_b16 a[170:171], v7 offset:22528
  ds_read_b64_tr_b16 a[44:45], v7 offset:24576
  ds_read_b64_tr_b16 a[46:47], v7 offset:26624
  ds_read_b64_tr_b16 a[172:173], v7 offset:28672
  ds_read_b64_tr_b16 a[174:175], v7 offset:30720
  s_waitcnt vmcnt(24) lgkmcnt(0)
  s_barrier
  s_add_u32 m0, s41, 81920
  s_mov_b32 s42, 1638400
  buffer_load_dwordx4 v8, s[8:11], s42 offen nt lds
  s_add_u32 m0, s41, 86016
  s_mov_b32 s42, 1638400
  buffer_load_dwordx4 v9, s[8:11], s42 offen nt lds
  s_add_u32 m0, s41, 90112
  s_mov_b32 s42, 1671168
  buffer_load_dwordx4 v8, s[8:11], s42 offen nt lds
  s_add_u32 m0, s41, 94208
  s_mov_b32 s42, 1671168
  buffer_load_dwordx4 v9, s[8:11], s42 offen nt lds
  ds_read_b64_tr_b16 a[48:49], v7 offset:32768
  ds_read_b64_tr_b16 a[50:51], v7 offset:34816
  ds_read_b64_tr_b16 a[176:177], v7 offset:36864
  ds_read_b64_tr_b16 a[178:179], v7 offset:38912
  ds_read_b64_tr_b16 a[52:53], v7 offset:40960
  ds_read_b64_tr_b16 a[54:55], v7 offset:43008
  ds_read_b64_tr_b16 a[180:181], v7 offset:45056
  ds_read_b64_tr_b16 a[182:183], v7 offset:47104
  s_waitcnt vmcnt(24) lgkmcnt(0)
  s_barrier
  s_add_u32 m0, s41, 98304
  s_mov_b32 s42, 1835008
  buffer_load_dwordx4 v8, s[8:11], s42 offen nt lds
  s_add_u32 m0, s41, 102400
  s_mov_b32 s42, 1835008
  buffer_load_dwordx4 v9, s[8:11], s42 offen nt lds
  s_add_u32 m0, s41, 106496
  s_mov_b32 s42, 1867776
  buffer_load_dwordx4 v8, s[8:11], s42 offen nt lds
  s_add_u32 m0, s41, 110592
  s_mov_b32 s42, 1867776
  buffer_load_dwordx4 v9, s[8:11], s42 offen nt lds
  ds_read_b64_tr_b16 a[56:57], v7 offset:49152
  ds_read_b64_tr_b16 a[58:59], v7 offset:51200
  ds_read_b64_tr_b16 a[184:185], v7 offset:53248
  ds_read_b64_tr_b16 a[186:187], v7 offset:55296
  ds_read_b64_tr_b16 a[60:61], v7 offset:57344
  ds_read_b64_tr_b16 a[62:63], v7 offset:59392
  ds_read_b64_tr_b16 a[188:189], v7 offset:61440
  ds_read_b64_tr_b16 a[190:191], v7 offset:63488
  s_waitcnt vmcnt(24) lgkmcnt(0)
  s_barrier
  s_add_u32 m0, s41, 114688
  s_mov_b32 s42, 1900544
  buffer_load_dwordx4 v8, s[8:11], s42 offen nt lds
  s_add_u32 m0, s41, 118784
  s_mov_b32 s42, 1900544
  buffer_load_dwordx4 v9, s[8:11], s42 offen nt lds
  s_add_u32 m0, s41, 122880
  s_mov_b32 s42, 1933312
  buffer_load_dwordx4 v8, s[8:11], s42 offen nt lds
  s_add_u32 m0, s41, 126976
  s_mov_b32 s42, 1933312
  buffer_load_dwordx4 v9, s[8:11], s42 offen nt lds
  ds_read_b64_tr_b16 a[64:65], v6 offset:0
  ds_read_b64_tr_b16 a[66:67], v6 offset:2048
  ds_read_b64_tr_b16 a[192:193], v6 offset:4096
  ds_read_b64_tr_b16 a[194:195], v6 offset:6144
  ds_read_b64_tr_b16 a[68:69], v6 offset:8192
  ds_read_b64_tr_b16 a[70:71], v6 offset:10240
  ds_read_b64_tr_b16 a[196:197], v6 offset:12288
  ds_read_b64_tr_b16 a[198:199], v6 offset:14336
  s_waitcnt vmcnt(24) lgkmcnt(0)
  s_barrier
  ds_read_b64_tr_b16 a[72:73], v6 offset:16384
  ds_read_b64_tr_b16 a[74:75], v6 offset:18432
  ds_read_b64_tr_b16 a[200:201], v6 offset:20480
  ds_read_b64_tr_b16 a[202:203], v6 offset:22528
  ds_read_b64_tr_b16 a[76:77], v6 offset:24576
  ds_read_b64_tr_b16 a[78:79], v6 offset:26624
  ds_read_b64_tr_b16 a[204:205], v6 offset:28672
  ds_read_b64_tr_b16 a[206:207], v6 offset:30720
  s_waitcnt vmcnt(20) lgkmcnt(0)
  s_barrier
  ds_read_b64_tr_b16 a[80:81], v6 offset:32768
  ds_read_b64_tr_b16 a[82:83], v6 offset:34816
  ds_read_b64_tr_b16 a[208:209], v6 offset:36864
  ds_read_b64_tr_b16 a[210:211], v6 offset:38912
  ds_read_b64_tr_b16 a[84:85], v6 offset:40960
  ds_read_b64_tr_b16 a[86:87], v6 offset:43008
  ds_read_b64_tr_b16 a[212:213], v6 offset:45056
  ds_read_b64_tr_b16 a[214:215], v6 offset:47104
  s_waitcnt vmcnt(16) lgkmcnt(0)
  s_barrier
  ds_read_b64_tr_b16 a[88:89], v6 offset:49152
  ds_read_b64_tr_b16 a[90:91], v6 offset:51200
  ds_read_b64_tr_b16 a[216:217], v6 offset:53248
  ds_read_b64_tr_b16 a[218:219], v6 offset:55296
  ds_read_b64_tr_b16 a[92:93], v6 offset:57344
  ds_read_b64_tr_b16 a[94:95], v6 offset:59392
  ds_read_b64_tr_b16 a[220:221], v6 offset:61440
  ds_read_b64_tr_b16 a[222:223], v6 offset:63488
  s_waitcnt vmcnt(12) lgkmcnt(0)
  s_barrier
  ds_read_b64_tr_b16 a[96:97], v7 offset:0
  ds_read_b64_tr_b16 a[98:99], v7 offset:2048
  ds_read_b64_tr_b16 a[224:225], v7 offset:4096
  ds_read_b64_tr_b16 a[226:227], v7 offset:6144
  ds_read_b64_tr_b16 a[100:101], v7 offset:8192
  ds_read_b64_tr_b16 a[102:103], v7 offset:10240
  ds_read_b64_tr_b16 a[228:229], v7 offset:12288
  ds_read_b64_tr_b16 a[230:231], v7 offset:14336
  s_waitcnt vmcnt(8) lgkmcnt(0)
  s_barrier
  ds_read_b64_tr_b16 a[104:105], v7 offset:16384
  ds_read_b64_tr_b16 a[106:107], v7 offset:18432
  ds_read_b64_tr_b16 a[232:233], v7 offset:20480
  ds_read_b64_tr_b16 a[234:235], v7 offset:22528
  ds_read_b64_tr_b16 a[108:109], v7 offset:24576
  ds_read_b64_tr_b16 a[110:111], v7 offset:26624
  ds_read_b64_tr_b16 a[236:237], v7 offset:28672
  ds_read_b64_tr_b16 a[238:239], v7 offset:30720
  s_waitcnt vmcnt(4) lgkmcnt(0)
  s_barrier
  ds_read_b64_tr_b16 a[112:113], v7 offset:32768
  ds_read_b64_tr_b16 a[114:115], v7 offset:34816
  ds_read_b64_tr_b16 a[240:241], v7 offset:36864
  ds_read_b64_tr_b16 a[242:243], v7 offset:38912
  ds_read_b64_tr_b16 a[116:117], v7 offset:40960
  ds_read_b64_tr_b16 a[118:119], v7 offset:43008
  ds_read_b64_tr_b16 a[244:245], v7 offset:45056
  ds_read_b64_tr_b16 a[246:247], v7 offset:47104
  s_waitcnt vmcnt(0) lgkmcnt(0)
  s_barrier
  ds_read_b64_tr_b16 a[120:121], v7 offset:49152
  ds_read_b64_tr_b16 a[122:123], v7 offset:51200
  ds_read_b64_tr_b16 a[248:249], v7 offset:53248
  ds_read_b64_tr_b16 a[250:251], v7 offset:55296
  ds_read_b64_tr_b16 a[124:125], v7 offset:57344
  ds_read_b64_tr_b16 a[126:127], v7 offset:59392
  ds_read_b64_tr_b16 a[252:253], v7 offset:61440
  ds_read_b64_tr_b16 a[254:255], v7 offset:63488
  s_waitcnt lgkmcnt(0)
  s_barrier
  s_and_b32 s43, s21, 24
  v_min_u32 v2, 7, v0
  v_add_u32 v2, s43, v2
  v_lshlrev_b32 v2, 7, v2
  v_add_u32 v2, 1404928, v2
  s_lshl_b32 s62, s21, 7
  s_add_u32 s62, s62, 1409024
  v_min_u32 v52, 63, v0
  v_lshlrev_b32 v52, 7, v52
  v_add_u32 v52, 1424384, v52
  s_nop 1
Lpoll_34:
  buffer_load_dword v53, v52, s[4:7], 0 offen sc1
  s_sub_u32 s24, s24, 1
  s_cbranch_scc1 L_FAIL
  s_waitcnt vmcnt(0)
  v_cmp_gt_i32 vcc, 0, v53
  s_cbranch_vccz Lpolld_35
  s_sleep 1
  s_branch Lpoll_34
Lpolld_35:
  v_lshrrev_b32 v53, 8, v53
  v_and_b32 v54, 3, v0
  v_lshl_or_b32 v53, v53, 2, v54
  s_nop 1
  v_min_u32_dpp v53, v53, v53 row_ror:8 row_mask:0xf bank_mask:0xf
  s_nop 1
  v_min_u32_dpp v53, v53, v53 row_ror:4 row_mask:0xf bank_mask:0xf
  v_mov_b32 v54, v53
  s_nop 1
  v_permlane16_swap_b32 v54, v53
  v_min_u32 v53, v53, v54
  v_mov_b32 v54, v53
  s_nop 1
  v_permlane32_swap_b32 v54, v53
  v_min_u32 v53, v53, v54
  s_nop 1
  v_min_u32_dpp v53, v53, v53 row_ror:2 row_mask:0xf bank_mask:0xf
  s_nop 1
  v_min_u32_dpp v53, v53, v53 row_ror:1 row_mask:0xf bank_mask:0xf
  s_nop 0
  v_readfirstlane_b32 s38, v53
  s_and_b32 s38, s38, 3
  s_lshl_b32 s38, s38, 13
  s_and_b32 s38, s38, 0x2000
  s_xor_b32 s38, s38, 16785408
  s_xor_b32 s27, s38, 0x2000
  s_lshr_b32 s40, s20, 1
  s_add_u32 s40, s40, s43
  s_mul_i32 s40, s40, 65536
  s_and_b32 s41, s20, 1
  s_lshl_b32 s41, s41, 12
  s_add_u32 s40, s40, s41
  s_add_u32 s40, s40, 49152
  s_add_u32 s27, s27, s40
  s_lshl_b32 s40, s21, 14
  s_add_u32 s40, s40, s38
  s_add_u32 s31, s40, 0
  s_lshl_b32 s40, s20, 11
  v_and_b32 v68, 3, v0
  v_lshlrev_b32 v68, 4, v68
  v_lshrrev_b32 v52, 4, v0
  v_lshl_add_u32 v68, v52, 6, v68
  v_bfe_u32 v52, v0, 2, 2
  v_lshl_add_u32 v68, v52, 8, v68
  v_add_u32 v68, s40, v68
  v_lshlrev_b32 v71, 2, v0
  v_add_u32 v71, 131072, v71
  s_mov_b32 s25, 0
  s_mov_b32 s26, 0
  s_mov_b32 s29, 1
  s_mov_b32 s30, 0
  s_mov_b32 s28, 0
L_WO_top:
  s_cmp_eq_u32 s28, 1
  s_cbranch_scc1 L_WO_go
  s_cmp_eq_u32 s28, 2
  s_cbranch_scc1 L_WO_mid
  s_cmp_lg_u32 s20, 0
  s_cbranch_scc1 L_WO_park
  buffer_load_dword v3, v2, s[4:7], s30 offen sc1
  s_waitcnt vmcnt(1)
  s_barrier
  s_mov_b32 s63, s25
  s_atomic_smax s63, s[4:5], s62 glc
Lnosig_36:
  s_cmp_ge_u32 s25, 64
  s_cbranch_scc1 L_END
  s_waitcnt vmcnt(0)
  v_cmp_gt_i32 vcc, s29, v3
  s_cbranch_vccz L_WO_issue
  s_nop 3
Lpoll_37:
  buffer_load_dword v3, v2, s[4:7], s30 offen sc1
  s_sub_u32 s24, s24, 1
  s_cbranch_scc1 L_FAIL
  s_waitcnt vmcnt(0)
  v_cmp_gt_i32 vcc, s29, v3
  s_cbranch_vccz Lpolld_38
  s_sleep 1
  s_branch Lpoll_37
Lpolld_38:
  s_branch L_WO_issue
L_WO_park:
  s_waitcnt vmcnt(0)
  s_barrier
  s_cmp_ge_u32 s25, 64
  s_cbranch_scc1 L_END
L_WO_issue:
  s_barrier
L_WO_mid:
  s_mov_b32 s34, s26
  s_mov_b32 s35, s27
  s_add_u32 s36, s32, 0
  s_add_u32 m0, s34, s36
  s_add_u32 s36, s35, 0
  buffer_load_dwordx4 v1, s[4:7], s36 offen offset:0 sc1 lds
  s_nop 0
  buffer_load_dwordx4 v1, s[4:7], s36 offen offset:1024 sc1 lds
  s_nop 0
  buffer_load_dwordx4 v1, s[4:7], s36 offen offset:2048 sc1 lds
  s_nop 0
  buffer_load_dwordx4 v1, s[4:7], s36 offen offset:3072 sc1 lds
  s_nop 0
  s_add_u32 s36, s32, 16384
  s_add_u32 m0, s34, s36
  s_add_u32 s36, s35, 131072
  buffer_load_dwordx4 v1, s[4:7], s36 offen offset:0 sc1 lds
  s_nop 0
  buffer_load_dwordx4 v1, s[4:7], s36 offen offset:1024 sc1 lds
  s_nop 0
  buffer_load_dwordx4 v1, s[4:7], s36 offen offset:2048 sc1 lds
  s_nop 0
  buffer_load_dwordx4 v1, s[4:7], s36 offen offset:3072 sc1 lds
  s_nop 0
  s_add_u32 s36, s32, 32768
  s_add_u32 m0, s34, s36
  s_add_u32 s36, s35, 262144
  buffer_load_dwordx4 v1, s[4:7], s36 offen offset:0 sc1 lds
  s_nop 0
  buffer_load_dwordx4 v1, s[4:7], s36 offen offset:1024 sc1 lds
  s_nop 0
  buffer_load_dwordx4 v1, s[4:7], s36 offen offset:2048 sc1 lds
  s_nop 0
  buffer_load_dwordx4 v1, s[4:7], s36 offen offset:3072 sc1 lds
  s_nop 0
  s_cmp_eq_u32 s28, 0
  s_cbranch_scc1 L_WO_go
  s_mov_b32 s28, 0
  s_waitcnt vmcnt(12)
  s_barrier
  s_cmp_lg_u32 s20, 0
  s_cbranch_scc1 Lnosig_39
  s_mov_b32 s63, s25
  s_atomic_smax s63, s[4:5], s62 glc
Lnosig_39:
L_WO_go:
  v_add_u32 v73, s26, v69
  v_add_u32 v74, s26, v70
  s_sub_u32 s26, 65536, s26
  s_add_u32 s27, s27, 2097152
  s_xor_b32 s27, s27, 0x2000
  s_add_u32 s29, s29, 1
  s_waitcnt vmcnt(8)
  s_barrier
  ds_read_b128 v[4:7], v73 offset:0
  ds_read_b128 v[8:11], v73 offset:1024
  ds_read_b128 v[12:15], v73 offset:2048
  ds_read_b128 v[16:19], v73 offset:3072
  ds_read_b128 v[20:23], v73 offset:4096
  ds_read_b128 v[24:27], v73 offset:5120
  s_waitcnt lgkmcnt(4)
  v_mfma_f32_16x16x32_bf16 v[36:39], a[0:3], v[4:7], 0
  ds_read_b128 v[28:31], v73 offset:6144
  v_mfma_f32_16x16x32_bf16 v[40:43], a[0:3], v[8:11], 0
  ds_read_b128 v[32:35], v73 offset:7168
  v_mfma_f32_16x16x32_bf16 v[44:47], a[128:131], v[4:7], 0
  s_add_u32 s36, s32, 49152
  s_add_u32 m0, s34, s36
  s_add_u32 s36, s35, 393216
  buffer_load_dwordx4 v1, s[4:7], s36 offen offset:0 sc1 lds
  v_mfma_f32_16x16x32_bf16 v[48:51], a[128:131], v[8:11], 0
  s_waitcnt lgkmcnt(4)
  v_mfma_f32_16x16x32_bf16 v[36:39], a[4:7], v[12:15], v[36:39]
  ds_read_b128 v[4:7], v73 offset:8192
  v_mfma_f32_16x16x32_bf16 v[40:43], a[4:7], v[16:19], v[40:43]
  ds_read_b128 v[8:11], v73 offset:9216
  v_mfma_f32_16x16x32_bf16 v[44:47], a[132:135], v[12:15], v[44:47]
  buffer_load_dwordx4 v1, s[4:7], s36 offen offset:1024 sc1 lds
  v_mfma_f32_16x16x32_bf16 v[48:51], a[132:135], v[16:19], v[48:51]
  s_waitcnt lgkmcnt(4)
  v_mfma_f32_16x16x32_bf16 v[36:39], a[8:11], v[20:23], v[36:39]
  ds_read_b128 v[12:15], v73 offset:10240
  v_mfma_f32_16x16x32_bf16 v[40:43], a[8:11], v[24:27], v[40:43]
  ds_read_b128 v[16:19], v73 offset:11264
  v_mfma_f32_16x16x32_bf16 v[44:47], a[136:139], v[20:23], v[44:47]
  buffer_load_dwordx4 v1, s[4:7], s36 offen offset:2048 sc1 lds
  v_mfma_f32_16x16x32_bf16 v[48:51], a[136:139], v[24:27], v[48:51]
  s_waitcnt lgkmcnt(4)
  v_mfma_f32_16x16x32_bf16 v[36:39], a[12:15], v[28:31], v[36:39]
  ds_read_b128 v[20:23], v73 offset:12288
  v_mfma_f32_16x16x32_bf16 v[40:43], a[12:15], v[32:35], v[40:43]
  ds_read_b128 v[24:27], v73 offset:13312
  v_mfma_f32_16x16x32_bf16 v[44:47], a[140:143], v[28:31], v[44:47]
  buffer_load_dwordx4 v1, s[4:7], s36 offen offset:3072 sc1 lds
  v_mfma_f32_16x16x32_bf16 v[48:51], a[140:143], v[32:35], v[48:51]
  s_waitcnt lgkmcnt(4)
  v_mfma_f32_16x16x32_bf16 v[36:39], a[16:19], v[4:7], v[36:39]
  ds_read_b128 v[28:31], v73 offset:14336
  v_mfma_f32_16x16x32_bf16 v[40:43], a[16:19], v[8:11], v[40:43]
  ds_read_b128 v[32:35], v73 offset:15360
  v_mfma_f32_16x16x32_bf16 v[44:47], a[144:147], v[4:7], v[44:47]
  v_mfma_f32_16x16x32_bf16 v[48:51], a[144:147], v[8:11], v[48:51]
  s_waitcnt vmcnt(8)
  s_barrier
  s_mov_b32 s34, s26
  s_mov_b32 s35, s27
  s_waitcnt lgkmcnt(4)
  v_mfma_f32_16x16x32_bf16 v[36:39], a[20:23], v[12:15], v[36:39]
  ds_read_b128 v[4:7], v73 offset:16384
  v_mfma_f32_16x16x32_bf16 v[40:43], a[20:23], v[16:19], v[40:43]
  ds_read_b128 v[8:11], v73 offset:17408
  v_mfma_f32_16x16x32_bf16 v[44:47], a[148:151], v[12:15], v[44:47]
  v_mfma_f32_16x16x32_bf16 v[48:51], a[148:151], v[16:19], v[48:51]
  s_waitcnt lgkmcnt(4)
  v_mfma_f32_16x16x32_bf16 v[36:39], a[24:27], v[20:23], v[36:39]
  ds_read_b128 v[12:15], v73 offset:18432
  v_mfma_f32_16x16x32_bf16 v[40:43], a[24:27], v[24:27], v[40:43]
  ds_read_b128 v[16:19], v73 offset:19456
  v_mfma_f32_16x16x32_bf16 v[44:47], a[152:155], v[20:23], v[44:47]
  v_mfma_f32_16x16x32_bf16 v[48:51], a[152:155], v[24:27], v[48:51]
  s_waitcnt lgkmcnt(4)
  v_mfma_f32_16x16x32_bf16 v[36:39], a[28:31], v[28:31], v[36:39]
  ds_read_b128 v[20:23], v73 offset:20480
  v_mfma_f32_16x16x32_bf16 v[40:43], a[28:31], v[32:35], v[40:43]
  ds_read_b128 v[24:27], v73 offset:21504
  v_mfma_f32_16x16x32_bf16 v[44:47], a[156:159], v[28:31], v[44:47]
  v_mfma_f32_16x16x32_bf16 v[48:51], a[156:159], v[32:35], v[48:51]
  s_waitcnt lgkmcnt(4)
  v_mfma_f32_16x16x32_bf16 v[36:39], a[32:35], v[4:7], v[36:39]
  ds_read_b128 v[28:31], v73 offset:22528
  v_mfma_f32_16x16x32_bf16 v[40:43], a[32:35], v[8:11], v[40:43]
  ds_read_b128 v[32:35], v73 offset:23552
  v_mfma_f32_16x16x32_bf16 v[44:47], a[160:163], v[4:7], v[44:47]
  v_mfma_f32_16x16x32_bf16 v[48:51], a[160:163], v[8:11], v[48:51]
  s_waitcnt lgkmcnt(4)
  v_mfma_f32_16x16x32_bf16 v[36:39], a[36:39], v[12:15], v[36:39]
  ds_read_b128 v[4:7], v73 offset:24576
  v_mfma_f32_16x16x32_bf16 v[40:43], a[36:39], v[16:19], v[40:43]
  ds_read_b128 v[8:11], v73 offset:25600
  v_mfma_f32_16x16x32_bf16 v[44:47], a[164:167], v[12:15], v[44:47]
  v_mfma_f32_16x16x32_bf16 v[48:51], a[164:167], v[16:19], v[48:51]
  s_waitcnt lgkmcnt(4)
  v_mfma_f32_16x16x32_bf16 v[36:39], a[40:43], v[20:23], v[36:39]
  ds_read_b128 v[12:15], v73 offset:26624
  v_mfma_f32_16x16x32_bf16 v[40:43], a[40:43], v[24:27], v[40:43]
  ds_read_b128 v[16:19], v73 offset:27648
  v_mfma_f32_16x16x32_bf16 v[44:47], a[168:171], v[20:23], v[44:47]
  v_mfma_f32_16x16x32_bf16 v[48:51], a[168:171], v[24:27], v[48:51]
  s_waitcnt lgkmcnt(4)
  v_mfma_f32_16x16x32_bf16 v[36:39], a[44:47], v[28:31], v[36:39]
  ds_read_b128 v[20:23], v73 offset:28672
  v_mfma_f32_16x16x32_bf16 v[40:43], a[44:47], v[32:35], v[40:43]
  ds_read_b128 v[24:27], v73 offset:29696
  v_mfma_f32_16x16x32_bf16 v[44:47], a[172:175], v[28:31], v[44:47]
  v_mfma_f32_16x16x32_bf16 v[48:51], a[172:175], v[32:35], v[48:51]
  s_lshl_b32 s40, s20, 8
  s_add_u32 m0, s40, 131072
  s_cmp_eq_u32 s20, 0
  s_cselect_b32 s40, s30, 2147483392
  buffer_load_dword v2, s[4:7], s40 offen sc1 lds
  s_waitcnt lgkmcnt(4)
  v_mfma_f32_16x16x32_bf16 v[36:39], a[48:51], v[4:7], v[36:39]
  ds_read_b128 v[28:31], v73 offset:30720
  v_mfma_f32_16x16x32_bf16 v[40:43], a[48:51], v[8:11], v[40:43]
  ds_read_b128 v[32:35], v73 offset:31744
  v_mfma_f32_16x16x32_bf16 v[44:47], a[176:179], v[4:7], v[44:47]
  v_mfma_f32_16x16x32_bf16 v[48:51], a[176:179], v[8:11], v[48:51]
  s_waitcnt vmcnt(5)
  s_barrier
  s_lshl_b32 s40, s20, 1
  s_add_u32 s40, s40, 1
  s_cmp_lg_u32 s40, s28
  s_cbranch_scc1 L_WO_s2
  s_mov_b32 s63, s25
  s_atomic_smax s63, s[4:5], s62 glc
Lnosig_40:
L_WO_s2:
  s_waitcnt lgkmcnt(4)
  v_mfma_f32_16x16x32_bf16 v[36:39], a[52:55], v[12:15], v[36:39]
  ds_read_b128 v[4:7], v73 offset:32768
  v_mfma_f32_16x16x32_bf16 v[40:43], a[52:55], v[16:19], v[40:43]
  ds_read_b128 v[8:11], v73 offset:33792
  v_mfma_f32_16x16x32_bf16 v[44:47], a[180:183], v[12:15], v[44:47]
  v_mfma_f32_16x16x32_bf16 v[48:51], a[180:183], v[16:19], v[48:51]
  s_waitcnt lgkmcnt(4)
  v_mfma_f32_16x16x32_bf16 v[36:39], a[56:59], v[20:23], v[36:39]
  ds_read_b128 v[12:15], v73 offset:34816
  v_mfma_f32_16x16x32_bf16 v[40:43], a[56:59], v[24:27], v[40:43]
  ds_read_b128 v[16:19], v73 offset:35840
  v_mfma_f32_16x16x32_bf16 v[44:47], a[184:187], v[20:23], v[44:47]
  v_mfma_f32_16x16x32_bf16 v[48:51], a[184:187], v[24:27], v[48:51]
  s_waitcnt lgkmcnt(4)
  v_mfma_f32_16x16x32_bf16 v[36:39], a[60:63], v[28:31], v[36:39]
  ds_read_b128 v[20:23], v73 offset:36864
  v_mfma_f32_16x16x32_bf16 v[40:43], a[60:63], v[32:35], v[40:43]
  ds_read_b128 v[24:27], v73 offset:37888
  v_mfma_f32_16x16x32_bf16 v[44:47], a[188:191], v[28:31], v[44:47]
  v_mfma_f32_16x16x32_bf16 v[48:51], a[188:191], v[32:35], v[48:51]
  s_waitcnt lgkmcnt(4)
  v_mfma_f32_16x16x32_bf16 v[36:39], a[64:67], v[4:7], v[36:39]
  ds_read_b128 v[28:31], v73 offset:38912
  v_mfma_f32_16x16x32_bf16 v[40:43], a[64:67], v[8:11], v[40:43]
  ds_read_b128 v[32:35], v73 offset:39936
  v_mfma_f32_16x16x32_bf16 v[44:47], a[192:195], v[4:7], v[44:47]
  v_mfma_f32_16x16x32_bf16 v[48:51], a[192:195], v[8:11], v[48:51]
  s_waitcnt lgkmcnt(4)
  v_mfma_f32_16x16x32_bf16 v[36:39], a[68:71], v[12:15], v[36:39]
  ds_read_b128 v[4:7], v73 offset:40960
  v_mfma_f32_16x16x32_bf16 v[40:43], a[68:71], v[16:19], v[40:43]
  ds_read_b128 v[8:11], v73 offset:41984
  v_mfma_f32_16x16x32_bf16 v[44:47], a[196:199], v[12:15], v[44:47]
  v_mfma_f32_16x16x32_bf16 v[48:51], a[196:199], v[16:19], v[48:51]
  s_waitcnt lgkmcnt(4)
  v_mfma_f32_16x16x32_bf16 v[36:39], a[72:75], v[20:23], v[36:39]
  ds_read_b128 v[12:15], v73 offset:43008
  v_mfma_f32_16x16x32_bf16 v[40:43], a[72:75], v[24:27], v[40:43]
  ds_read_b128 v[16:19], v73 offset:44032
  v_mfma_f32_16x16x32_bf16 v[44:47], a[200:203], v[20:23], v[44:47]
  v_mfma_f32_16x16x32_bf16 v[48:51], a[200:203], v[24:27], v[48:51]
  s_waitcnt vmcnt(0)
  s_barrier
  ds_read_b32 v3, v71
  s_waitcnt lgkmcnt(4)
  v_mfma_f32_16x16x32_bf16 v[36:39], a[76:79], v[28:31], v[36:39]
  ds_read_b128 v[20:23], v73 offset:45056
  v_mfma_f32_16x16x32_bf16 v[40:43], a[76:79], v[32:35], v[40:43]
  ds_read_b128 v[24:27], v73 offset:46080
  v_mfma_f32_16x16x32_bf16 v[44:47], a[204:207], v[28:31], v[44:47]
  v_mfma_f32_16x16x32_bf16 v[48:51], a[204:207], v[32:35], v[48:51]
  s_waitcnt lgkmcnt(4)
  v_mfma_f32_16x16x32_bf16 v[36:39], a[80:83], v[4:7], v[36:39]
  ds_read_b128 v[28:31], v73 offset:47104
  v_mfma_f32_16x16x32_bf16 v[40:43], a[80:83], v[8:11], v[40:43]
  ds_read_b128 v[32:35], v73 offset:48128
  v_mfma_f32_16x16x32_bf16 v[44:47], a[208:211], v[4:7], v[44:47]
  v_mfma_f32_16x16x32_bf16 v[48:51], a[208:211], v[8:11], v[48:51]
  s_waitcnt lgkmcnt(4)
  v_cmp_gt_i32 vcc, s29, v3
  s_mov_b32 s28, 0
  s_cbranch_vccnz L_WO_nopf
  s_cmp_ge_u32 s25, 63
  s_cbranch_scc1 L_WO_nopf
  s_mov_b32 s28, 1
  s_waitcnt lgkmcnt(4)
  v_mfma_f32_16x16x32_bf16 v[36:39], a[84:87], v[12:15], v[36:39]
  ds_read_b128 v[4:7], v73 offset:49152
  v_mfma_f32_16x16x32_bf16 v[40:43], a[84:87], v[16:19], v[40:43]
  ds_read_b128 v[8:11], v73 offset:50176
  v_mfma_f32_16x16x32_bf16 v[44:47], a[212:215], v[12:15], v[44:47]
  s_add_u32 s36, s32, 0
  s_add_u32 m0, s34, s36
  s_add_u32 s36, s35, 0
  buffer_load_dwordx4 v1, s[4:7], s36 offen offset:0 sc1 lds
  v_mfma_f32_16x16x32_bf16 v[48:51], a[212:215], v[16:19], v[48:51]
  buffer_load_dwordx4 v1, s[4:7], s36 offen offset:1024 sc1 lds
  s_waitcnt lgkmcnt(4)
  v_mfma_f32_16x16x32_bf16 v[36:39], a[88:91], v[20:23], v[36:39]
  ds_read_b128 v[12:15], v73 offset:51200
  v_mfma_f32_16x16x32_bf16 v[40:43], a[88:91], v[24:27], v[40:43]
  ds_read_b128 v[16:19], v73 offset:52224
  v_mfma_f32_16x16x32_bf16 v[44:47], a[216:219], v[20:23], v[44:47]
  buffer_load_dwordx4 v1, s[4:7], s36 offen offset:2048 sc1 lds
  v_mfma_f32_16x16x32_bf16 v[48:51], a[216:219], v[24:27], v[48:51]
  buffer_load_dwordx4 v1, s[4:7], s36 offen offset:3072 sc1 lds
  s_waitcnt lgkmcnt(4)
  v_mfma_f32_16x16x32_bf16 v[36:39], a[92:95], v[28:31], v[36:39]
  ds_read_b128 v[20:23], v73 offset:53248
  v_mfma_f32_16x16x32_bf16 v[40:43], a[92:95], v[32:35], v[40:43]
  ds_read_b128 v[24:27], v73 offset:54272
  v_mfma_f32_16x16x32_bf16 v[44:47], a[220:223], v[28:31], v[44:47]
  s_add_u32 s36, s32, 16384
  s_add_u32 m0, s34, s36
  s_add_u32 s36, s35, 131072
  buffer_load_dwordx4 v1, s[4:7], s36 offen offset:0 sc1 lds
  v_mfma_f32_16x16x32_bf16 v[48:51], a[220:223], v[32:35], v[48:51]
  buffer_load_dwordx4 v1, s[4:7], s36 offen offset:1024 sc1 lds
  s_waitcnt lgkmcnt(4)
  v_mfma_f32_16x16x32_bf16 v[36:39], a[96:99], v[4:7], v[36:39]
  ds_read_b128 v[28:31], v73 offset:55296
  v_mfma_f32_16x16x32_bf16 v[40:43], a[96:99], v[8:11], v[40:43]
  ds_read_b128 v[32:35], v73 offset:56320
  v_mfma_f32_16x16x32_bf16 v[44:47], a[224:227], v[4:7], v[44:47]
  buffer_load_dwordx4 v1, s[4:7], s36 offen offset:2048 sc1 lds
  v_mfma_f32_16x16x32_bf16 v[48:51], a[224:227], v[8:11], v[48:51]
  buffer_load_dwordx4 v1, s[4:7], s36 offen offset:3072 sc1 lds
  s_waitcnt lgkmcnt(4)
  v_mfma_f32_16x16x32_bf16 v[36:39], a[100:103], v[12:15], v[36:39]
  ds_read_b128 v[4:7], v73 offset:57344
  v_mfma_f32_16x16x32_bf16 v[40:43], a[100:103], v[16:19], v[40:43]
  ds_read_b128 v[8:11], v73 offset:58368
  v_mfma_f32_16x16x32_bf16 v[44:47], a[228:231], v[12:15], v[44:47]
  s_add_u32 s36, s32, 32768
  s_add_u32 m0, s34, s36
  s_add_u32 s36, s35, 262144
  buffer_load_dwordx4 v1, s[4:7], s36 offen offset:0 sc1 lds
  v_mfma_f32_16x16x32_bf16 v[48:51], a[228:231], v[16:19], v[48:51]
  buffer_load_dwordx4 v1, s[4:7], s36 offen offset:1024 sc1 lds
  s_waitcnt lgkmcnt(4)
  v_mfma_f32_16x16x32_bf16 v[36:39], a[104:107], v[20:23], v[36:39]
  ds_read_b128 v[12:15], v73 offset:59392
  v_mfma_f32_16x16x32_bf16 v[40:43], a[104:107], v[24:27], v[40:43]
  ds_read_b128 v[16:19], v73 offset:60416
  v_mfma_f32_16x16x32_bf16 v[44:47], a[232:235], v[20:23], v[44:47]
  buffer_load_dwordx4 v1, s[4:7], s36 offen offset:2048 sc1 lds
  v_mfma_f32_16x16x32_bf16 v[48:51], a[232:235], v[24:27], v[48:51]
  buffer_load_dwordx4 v1, s[4:7], s36 offen offset:3072 sc1 lds
  s_waitcnt lgkmcnt(4)
  v_mfma_f32_16x16x32_bf16 v[36:39], a[108:111], v[28:31], v[36:39]
  ds_read_b128 v[20:23], v73 offset:61440
  v_mfma_f32_16x16x32_bf16 v[40:43], a[108:111], v[32:35], v[40:43]
  ds_read_b128 v[24:27], v73 offset:62464
  v_mfma_f32_16x16x32_bf16 v[44:47], a[236:239], v[28:31], v[44:47]
  v_mfma_f32_16x16x32_bf16 v[48:51], a[236:239], v[32:35], v[48:51]
  s_waitcnt lgkmcnt(4)
  v_mfma_f32_16x16x32_bf16 v[36:39], a[112:115], v[4:7], v[36:39]
  ds_read_b128 v[28:31], v73 offset:63488
  v_mfma_f32_16x16x32_bf16 v[40:43], a[112:115], v[8:11], v[40:43]
  ds_read_b128 v[32:35], v73 offset:64512
  v_mfma_f32_16x16x32_bf16 v[44:47], a[240:243], v[4:7], v[44:47]
  v_mfma_f32_16x16x32_bf16 v[48:51], a[240:243], v[8:11], v[48:51]
  s_waitcnt lgkmcnt(4)
  v_mfma_f32_16x16x32_bf16 v[36:39], a[116:119], v[12:15], v[36:39]
  v_mfma_f32_16x16x32_bf16 v[40:43], a[116:119], v[16:19], v[40:43]
  v_mfma_f32_16x16x32_bf16 v[44:47], a[244:247], v[12:15], v[44:47]
  v_mfma_f32_16x16x32_bf16 v[48:51], a[244:247], v[16:19], v[48:51]
  s_waitcnt lgkmcnt(2)
  v_mfma_f32_16x16x32_bf16 v[36:39], a[120:123], v[20:23], v[36:39]
  v_mfma_f32_16x16x32_bf16 v[40:43], a[120:123], v[24:27], v[40:43]
  v_mfma_f32_16x16x32_bf16 v[44:47], a[248:251], v[20:23], v[44:47]
  v_mfma_f32_16x16x32_bf16 v[48:51], a[248:251], v[24:27], v[48:51]
  s_waitcnt lgkmcnt(0)
  v_mfma_f32_16x16x32_bf16 v[36:39], a[124:127], v[28:31], v[36:39]
  v_mfma_f32_16x16x32_bf16 v[40:43], a[124:127], v[32:35], v[40:43]
  v_mfma_f32_16x16x32_bf16 v[44:47], a[252:255], v[28:31], v[44:47]
  v_mfma_f32_16x16x32_bf16 v[48:51], a[252:255], v[32:35], v[48:51]
  s_nop 7
  s_branch L_WO_epi
L_WO_nopf:
  s_waitcnt lgkmcnt(4)
  v_mfma_f32_16x16x32_bf16 v[36:39], a[84:87], v[12:15], v[36:39]
  ds_read_b128 v[4:7], v73 offset:49152
  v_mfma_f32_16x16x32_bf16 v[40:43], a[84:87], v[16:19], v[40:43]
  ds_read_b128 v[8:11], v73 offset:50176
  v_mfma_f32_16x16x32_bf16 v[44:47], a[212:215], v[12:15], v[44:47]
  v_mfma_f32_16x16x32_bf16 v[48:51], a[212:215], v[16:19], v[48:51]
  s_waitcnt lgkmcnt(4)
  v_mfma_f32_16x16x32_bf16 v[36:39], a[88:91], v[20:23], v[36:39]
  ds_read_b128 v[12:15], v73 offset:51200
  v_mfma_f32_16x16x32_bf16 v[40:43], a[88:91], v[24:27], v[40:43]
  ds_read_b128 v[16:19], v73 offset:52224
  v_mfma_f32_16x16x32_bf16 v[44:47], a[216:219], v[20:23], v[44:47]
  v_mfma_f32_16x16x32_bf16 v[48:51], a[216:219], v[24:27], v[48:51]
  s_waitcnt lgkmcnt(4)
  v_mfma_f32_16x16x32_bf16 v[36:39], a[92:95], v[28:31], v[36:39]
  ds_read_b128 v[20:23], v73 offset:53248
  v_mfma_f32_16x16x32_bf16 v[40:43], a[92:95], v[32:35], v[40:43]
  ds_read_b128 v[24:27], v73 offset:54272
  v_mfma_f32_16x16x32_bf16 v[44:47], a[220:223], v[28:31], v[44:47]
  v_mfma_f32_16x16x32_bf16 v[48:51], a[220:223], v[32:35], v[48:51]
  s_barrier
  s_lshl_b32 s40, s20, 8
  s_add_u32 m0, s40, 131072
  s_cmp_eq_u32 s20, 0
  s_cselect_b32 s40, s30, 2147483392
  buffer_load_dword v2, s[4:7], s40 offen sc1 lds
  s_waitcnt lgkmcnt(4)
  v_mfma_f32_16x16x32_bf16 v[36:39], a[96:99], v[4:7], v[36:39]
  ds_read_b128 v[28:31], v73 offset:55296
  v_mfma_f32_16x16x32_bf16 v[40:43], a[96:99], v[8:11], v[40:43]
  ds_read_b128 v[32:35], v73 offset:56320
  v_mfma_f32_16x16x32_bf16 v[44:47], a[224:227], v[4:7], v[44:47]
  v_mfma_f32_16x16x32_bf16 v[48:51], a[224:227], v[8:11], v[48:51]
  s_waitcnt lgkmcnt(4)
  v_mfma_f32_16x16x32_bf16 v[36:39], a[100:103], v[12:15], v[36:39]
  ds_read_b128 v[4:7], v73 offset:57344
  v_mfma_f32_16x16x32_bf16 v[40:43], a[100:103], v[16:19], v[40:43]
  ds_read_b128 v[8:11], v73 offset:58368
  v_mfma_f32_16x16x32_bf16 v[44:47], a[228:231], v[12:15], v[44:47]
  v_mfma_f32_16x16x32_bf16 v[48:51], a[228:231], v[16:19], v[48:51]
  s_waitcnt lgkmcnt(4)
  v_mfma_f32_16x16x32_bf16 v[36:39], a[104:107], v[20:23], v[36:39]
  ds_read_b128 v[12:15], v73 offset:59392
  v_mfma_f32_16x16x32_bf16 v[40:43], a[104:107], v[24:27], v[40:43]
  ds_read_b128 v[16:19], v73 offset:60416
  v_mfma_f32_16x16x32_bf16 v[44:47], a[232:235], v[20:23], v[44:47]
  v_mfma_f32_16x16x32_bf16 v[48:51], a[232:235], v[24:27], v[48:51]
  s_waitcnt lgkmcnt(4)
  v_mfma_f32_16x16x32_bf16 v[36:39], a[108:111], v[28:31], v[36:39]
  ds_read_b128 v[20:23], v73 offset:61440
  v_mfma_f32_16x16x32_bf16 v[40:43], a[108:111], v[32:35], v[40:43]
  ds_read_b128 v[24:27], v73 offset:62464
  v_mfma_f32_16x16x32_bf16 v[44:47], a[236:239], v[28:31], v[44:47]
  v_mfma_f32_16x16x32_bf16 v[48:51], a[236:239], v[32:35], v[48:51]
  s_waitcnt lgkmcnt(4)
  v_mfma_f32_16x16x32_bf16 v[36:39], a[112:115], v[4:7], v[36:39]
  ds_read_b128 v[28:31], v73 offset:63488
  v_mfma_f32_16x16x32_bf16 v[40:43], a[112:115], v[8:11], v[40:43]
  ds_read_b128 v[32:35], v73 offset:64512
  v_mfma_f32_16x16x32_bf16 v[44:47], a[240:243], v[4:7], v[44:47]
  v_mfma_f32_16x16x32_bf16 v[48:51], a[240:243], v[8:11], v[48:51]
  s_waitcnt lgkmcnt(4)
  v_mfma_f32_16x16x32_bf16 v[36:39], a[116:119], v[12:15], v[36:39]
  v_mfma_f32_16x16x32_bf16 v[40:43], a[116:119], v[16:19], v[40:43]
  v_mfma_f32_16x16x32_bf16 v[44:47], a[244:247], v[12:15], v[44:47]
  v_mfma_f32_16x16x32_bf16 v[48:51], a[244:247], v[16:19], v[48:51]
  s_waitcnt vmcnt(0)
  s_barrier
  ds_read_b32 v3, v71
  s_waitcnt lgkmcnt(2)
  v_mfma_f32_16x16x32_bf16 v[36:39], a[120:123], v[20:23], v[36:39]
  v_mfma_f32_16x16x32_bf16 v[40:43], a[120:123], v[24:27], v[40:43]
  v_mfma_f32_16x16x32_bf16 v[44:47], a[248:251], v[20:23], v[44:47]
  v_mfma_f32_16x16x32_bf16 v[48:51], a[248:251], v[24:27], v[48:51]
  s_waitcnt lgkmcnt(0)
  v_mfma_f32_16x16x32_bf16 v[36:39], a[124:127], v[28:31], v[36:39]
  v_mfma_f32_16x16x32_bf16 v[40:43], a[124:127], v[32:35], v[40:43]
  v_mfma_f32_16x16x32_bf16 v[44:47], a[252:255], v[28:31], v[44:47]
  v_mfma_f32_16x16x32_bf16 v[48:51], a[252:255], v[32:35], v[48:51]
  v_cmp_gt_i32 vcc, s29, v3
  s_cmp_eq_u64 vcc, 0
  s_cselect_b32 s28, 2, 0
  s_cmp_lt_u32 s25, 63
  s_cselect_b32 s28, s28, 0
L_WO_epi:
  v_cvt_pk_bf16_f32 v52, v36, v37
  v_cvt_pk_bf16_f32 v53, v38, v39
  v_cvt_pk_bf16_f32 v54, v44, v45
  v_cvt_pk_bf16_f32 v55, v46, v47
  buffer_store_dwordx4 v[52:55], v68, s[4:7], s31 offen offset:0 sc1
  v_cvt_pk_bf16_f32 v56, v40, v41
  v_cvt_pk_bf16_f32 v57, v42, v43
  v_cvt_pk_bf16_f32 v58, v48, v49
  v_cvt_pk_bf16_f32 v59, v50, v51
  buffer_store_dwordx4 v[56:59], v68, s[4:7], s31 offen offset:1024 sc1
  s_add_u32 s25, s25, 1
  s_add_u32 s31, s31, 2097152
  s_xor_b32 s31, s31, 0x2000
  s_branch L_WO_top
L_F1:
  v_lshlrev_b32 v1, 4, v0
  s_lshl_b32 s32, s20, 12
  s_min_u32 s33, s32, 0x2000
  v_mov_b32 v69, v1
  v_add_u32 v70, 0x10000, v69
  v_and_b32 v1, 3, v0
  v_lshlrev_b32 v1, 4, v1
  v_lshrrev_b32 v52, 4, v0
  v_lshl_add_u32 v1, v52, 6, v1
  v_bfe_u32 v52, v0, 2, 2
  v_lshl_add_u32 v1, v52, 8, v1
  s_load_dwordx2 s[8:9], s[0:1], 64
  s_mov_b32 s10, 7340032
  s_mov_b32 s11, 0x20000
  s_waitcnt lgkmcnt(0)
  s_lshl_b32 s44, s21, 7
  v_bfe_u32 v4, v0, 5, 1
  v_mul_u32_u24 v4, 28672, v4
  v_bfe_u32 v5, v0, 4, 1
  v_mul_u32_u24 v5, 14336, v5
  v_add_u32 v4, v4, v5
  v_bfe_u32 v5, v0, 3, 1
  v_mul_u32_u24 v5, 7168, v5
  v_add_u32 v4, v4, v5
  v_lshrrev_b32 v5, 3, v0
  v_and_b32 v5, 6, v5
  v_xor_b32 v5, v5, v0
  v_and_b32 v5, 7, v5
  v_lshl_add_u32 v4, v5, 4, v4
  s_lshr_b32 s40, s20, 1
  s_mul_i32 s40, s40, 458752
  s_and_b32 s41, s20, 1
  s_mul_i32 s41, s41, 57344
  s_add_u32 s40, s40, s41
  v_add_u32 v4, s40, v4
  v_bfe_u32 v5, v0, 3, 2
  v_xor_b32 v5, s20, v5
  v_lshlrev_b32 v5, 5, v5
  v_lshrrev_b32 v6, 2, v0
  v_lshl_add_u32 v6, v6, 7, v5
  v_and_b32 v5, 3, v0
  v_lshl_add_u32 v6, v5, 3, v6
  v_add_u32 v7, 0x10000, v6
  v_add_u32 v8, s44, v4
  v_add_u32 v9, s44, v4
  s_lshl_b32 s41, s20, 10
  s_add_u32 m0, s41, 0
  s_mov_b32 s42, 0
  buffer_load_dwordx4 v8, s[8:11], s42 offen nt lds
  s_add_u32 m0, s41, 4096
  s_mov_b32 s42, 114688
  buffer_load_dwordx4 v8, s[8:11], s42 offen nt lds
  s_add_u32 m0, s41, 8192
  s_mov_b32 s42, 229376
  buffer_load_dwordx4 v8, s[8:11], s42 offen nt lds
  s_add_u32 m0, s41, 12288
  s_mov_b32 s42, 344064
  buffer_load_dwordx4 v8, s[8:11], s42 offen nt lds
  s_add_u32 m0, s41, 16384
  s_mov_b32 s42, 917504
  buffer_load_dwordx4 v8, s[8:11], s42 offen nt lds
  s_add_u32 m0, s41, 20480
  s_mov_b32 s42, 1032192
  buffer_load_dwordx4 v8, s[8:11], s42 offen nt lds
  s_add_u32 m0, s41, 24576
  s_mov_b32 s42, 1146880
  buffer_load_dwordx4 v8, s[8:11], s42 offen nt lds
  s_add_u32 m0, s41, 28672
  s_mov_b32 s42, 1261568
  buffer_load_dwordx4 v8, s[8:11], s42 offen nt lds
  s_add_u32 m0, s41, 32768
  s_mov_b32 s42, 1835008
  buffer_load_dwordx4 v8, s[8:11], s42 offen nt lds
  s_add_u32 m0, s41, 36864
  s_mov_b32 s42, 1949696
  buffer_load_dwordx4 v8, s[8:11], s42 offen nt lds
  s_add_u32 m0, s41, 40960
  s_mov_b32 s42, 2064384
  buffer_load_dwordx4 v8, s[8:11], s42 offen nt lds
  s_add_u32 m0, s41, 45056
  s_mov_b32 s42, 2179072
  buffer_load_dwordx4 v8, s[8:11], s42 offen nt lds
  s_add_u32 m0, s41, 49152
  s_mov_b32 s42, 2752512
  buffer_load_dwordx4 v8, s[8:11], s42 offen nt lds
  s_add_u32 m0, s41, 53248
  s_mov_b32 s42, 2867200
  buffer_load_dwordx4 v8, s[8:11], s42 offen nt lds
  s_add_u32 m0, s41, 57344
  s_mov_b32 s42, 2981888
  buffer_load_dwordx4 v8, s[8:11], s42 offen nt lds
  s_add_u32 m0, s41, 61440
  s_mov_b32 s42, 3096576
  buffer_load_dwordx4 v8, s[8:11], s42 offen nt lds
  s_add_u32 m0, s41, 65536
  s_mov_b32 s42, 3670016
  buffer_load_dwordx4 v8, s[8:11], s42 offen nt lds
  s_add_u32 m0, s41, 69632
  s_mov_b32 s42, 3784704
  buffer_load_dwordx4 v8, s[8:11], s42 offen nt lds
  s_add_u32 m0, s41, 73728
  s_mov_b32 s42, 3899392
  buffer_load_dwordx4 v8, s[8:11], s42 offen nt lds
  s_add_u32 m0, s41, 77824
  s_mov_b32 s42, 4014080
  buffer_load_dwordx4 v8, s[8:11], s42 offen nt lds
  s_add_u32 m0, s41, 81920
  s_mov_b32 s42, 4587520
  buffer_load_dwordx4 v8, s[8:11], s42 offen nt lds
  s_add_u32 m0, s41, 86016
  s_mov_b32 s42, 4702208
  buffer_load_dwordx4 v8, s[8:11], s42 offen nt lds
  s_add_u32 m0, s41, 90112
  s_mov_b32 s42, 4816896
  buffer_load_dwordx4 v8, s[8:11], s42 offen nt lds
  s_add_u32 m0, s41, 94208
  s_mov_b32 s42, 4931584
  buffer_load_dwordx4 v8, s[8:11], s42 offen nt lds
  s_add_u32 m0, s41, 98304
  s_mov_b32 s42, 5505024
  buffer_load_dwordx4 v8, s[8:11], s42 offen nt lds
  s_add_u32 m0, s41, 102400
  s_mov_b32 s42, 5619712
  buffer_load_dwordx4 v8, s[8:11], s42 offen nt lds
  s_add_u32 m0, s41, 106496
  s_mov_b32 s42, 5734400
  buffer_load_dwordx4 v8, s[8:11], s42 offen nt lds
  s_add_u32 m0, s41, 110592
  s_mov_b32 s42, 5849088
  buffer_load_dwordx4 v8, s[8:11], s42 offen nt lds
  s_waitcnt vmcnt(24) lgkmcnt(0)
  s_barrier
  s_add_u32 m0, s41, 114688
  s_mov_b32 s42, 6422528
  buffer_load_dwordx4 v8, s[8:11], s42 offen nt lds
  s_add_u32 m0, s41, 118784
  s_mov_b32 s42, 6537216
  buffer_load_dwordx4 v8, s[8:11], s42 offen nt lds
  s_add_u32 m0, s41, 122880
  s_mov_b32 s42, 6651904
  buffer_load_dwordx4 v8, s[8:11], s42 offen nt lds
  s_add_u32 m0, s41, 126976
  s_mov_b32 s42, 6766592
  buffer_load_dwordx4 v8, s[8:11], s42 offen nt lds
  ds_read_b64_tr_b16 a[0:1], v6 offset:0
  ds_read_b64_tr_b16 a[2:3], v6 offset:2048
  ds_read_b64_tr_b16 a[4:5], v6 offset:4096
  ds_read_b64_tr_b16 a[6:7], v6 offset:6144
  ds_read_b64_tr_b16 a[8:9], v6 offset:8192
  ds_read_b64_tr_b16 a[10:11], v6 offset:10240
  ds_read_b64_tr_b16 a[12:13], v6 offset:12288
  ds_read_b64_tr_b16 a[14:15], v6 offset:14336
  s_waitcnt vmcnt(24) lgkmcnt(0)
  s_barrier
  s_load_dwordx2 s[8:9], s[0:1], 72
  s_mov_b32 s10, 7340032
  s_mov_b32 s11, 0x20000
  s_waitcnt lgkmcnt(0)
  s_add_u32 m0, s41, 0
  s_mov_b32 s42, 0
  buffer_load_dwordx4 v9, s[8:11], s42 offen nt lds
  s_add_u32 m0, s41, 4096
  s_mov_b32 s42, 114688
  buffer_load_dwordx4 v9, s[8:11], s42 offen nt lds
  s_add_u32 m0, s41, 8192
  s_mov_b32 s42, 229376
  buffer_load_dwordx4 v9, s[8:11], s42 offen nt lds
  s_add_u32 m0, s41, 12288
  s_mov_b32 s42, 344064
  buffer_load_dwordx4 v9, s[8:11], s42 offen nt lds
  ds_read_b64_tr_b16 a[16:17], v6 offset:16384
  ds_read_b64_tr_b16 a[18:19], v6 offset:18432
  ds_read_b64_tr_b16 a[20:21], v6 offset:20480
  ds_read_b64_tr_b16 a[22:23], v6 offset:22528
  ds_read_b64_tr_b16 a[24:25], v6 offset:24576
  ds_read_b64_tr_b16 a[26:27], v6 offset:26624
  ds_read_b64_tr_b16 a[28:29], v6 offset:28672
  ds_read_b64_tr_b16 a[30:31], v6 offset:30720
  s_waitcnt vmcnt(24) lgkmcnt(0)
  s_barrier
  s_add_u32 m0, s41, 16384
  s_mov_b32 s42, 917504
  buffer_load_dwordx4 v9, s[8:11], s42 offen nt lds
  s_add_u32 m0, s41, 20480
  s_mov_b32 s42, 1032192
  buffer_load_dwordx4 v9, s[8:11], s42 offen nt lds
  s_add_u32 m0, s41, 24576
  s_mov_b32 s42, 1146880
  buffer_load_dwordx4 v9, s[8:11], s42 offen nt lds
  s_add_u32 m0, s41, 28672
  s_mov_b32 s42, 1261568
  buffer_load_dwordx4 v9, s[8:11], s42 offen nt lds
  ds_read_b64_tr_b16 a[32:33], v6 offset:32768
  ds_read_b64_tr_b16 a[34:35], v6 offset:34816
  ds_read_b64_tr_b16 a[36:37], v6 offset:36864
  ds_read_b64_tr_b16 a[38:39], v6 offset:38912
  ds_read_b64_tr_b16 a[40:41], v6 offset:40960
  ds_read_b64_tr_b16 a[42:43], v6 offset:43008
  ds_read_b64_tr_b16 a[44:45], v6 offset:45056
  ds_read_b64_tr_b16 a[46:47], v6 offset:47104
  s_waitcnt vmcnt(24) lgkmcnt(0)
  s_barrier
  s_add_u32 m0, s41, 32768
  s_mov_b32 s42, 1835008
  buffer_load_dwordx4 v9, s[8:11], s42 offen nt lds
  s_add_u32 m0, s41, 36864
  s_mov_b32 s42, 1949696
  buffer_load_dwordx4 v9, s[8:11], s42 offen nt lds
  s_add_u32 m0, s41, 40960
  s_mov_b32 s42, 2064384
  buffer_load_dwordx4 v9, s[8:11], s42 offen nt lds
  s_add_u32 m0, s41, 45056
  s_mov_b32 s42, 2179072
  buffer_load_dwordx4 v9, s[8:11], s42 offen nt lds
  ds_read_b64_tr_b16 a[48:49], v6 offset:49152
  ds_read_b64_tr_b16 a[50:51], v6 offset:51200
  ds_read_b64_tr_b16 a[52:53], v6 offset:53248
  ds_read_b64_tr_b16 a[54:55], v6 offset:55296
  ds_read_b64_tr_b16 a[56:57], v6 offset:57344
  ds_read_b64_tr_b16 a[58:59], v6 offset:59392
  ds_read_b64_tr_b16 a[60:61], v6 offset:61440
  ds_read_b64_tr_b16 a[62:63], v6 offset:63488
  s_waitcnt vmcnt(24) lgkmcnt(0)
  s_barrier
  s_add_u32 m0, s41, 49152
  s_mov_b32 s42, 2752512
  buffer_load_dwordx4 v9, s[8:11], s42 offen nt lds
  s_add_u32 m0, s41, 53248
  s_mov_b32 s42, 2867200
  buffer_load_dwordx4 v9, s[8:11], s42 offen nt lds
  s_add_u32 m0, s41, 57344
  s_mov_b32 s42, 2981888
  buffer_load_dwordx4 v9, s[8:11], s42 offen nt lds
  s_add_u32 m0, s41, 61440
  s_mov_b32 s42, 3096576
  buffer_load_dwordx4 v9, s[8:11], s42 offen nt lds
  ds_read_b64_tr_b16 a[64:65], v7 offset:0
  ds_read_b64_tr_b16 a[66:67], v7 offset:2048
  ds_read_b64_tr_b16 a[68:69], v7 offset:4096
  ds_read_b64_tr_b16 a[70:71], v7 offset:6144
  ds_read_b64_tr_b16 a[72:73], v7 offset:8192
  ds_read_b64_tr_b16 a[74:75], v7 offset:10240
  ds_read_b64_tr_b16 a[76:77], v7 offset:12288
  ds_read_b64_tr_b16 a[78:79], v7 offset:14336
  s_waitcnt vmcnt(24) lgkmcnt(0)
  s_barrier
  s_add_u32 m0, s41, 65536
  s_mov_b32 s42, 3670016
  buffer_load_dwordx4 v9, s[8:11], s42 offen nt lds
  s_add_u32 m0, s41, 69632
  s_mov_b32 s42, 3784704
  buffer_load_dwordx4 v9, s[8:11], s42 offen nt lds
  s_add_u32 m0, s41, 73728
  s_mov_b32 s42, 3899392
  buffer_load_dwordx4 v9, s[8:11], s42 offen nt lds
  s_add_u32 m0, s41, 77824
  s_mov_b32 s42, 4014080
  buffer_load_dwordx4 v9, s[8:11], s42 offen nt lds
  ds_read_b64_tr_b16 a[80:81], v7 offset:16384
  ds_read_b64_tr_b16 a[82:83], v7 offset:18432
  ds_read_b64_tr_b16 a[84:85], v7 offset:20480
  ds_read_b64_tr_b16 a[86:87], v7 offset:22528
  ds_read_b64_tr_b16 a[88:89], v7 offset:24576
  ds_read_b64_tr_b16 a[90:91], v7 offset:26624
  ds_read_b64_tr_b16 a[92:93], v7 offset:28672
  ds_read_b64_tr_b16 a[94:95], v7 offset:30720
  s_waitcnt vmcnt(24) lgkmcnt(0)
  s_barrier
  s_add_u32 m0, s41, 81920
  s_mov_b32 s42, 4587520
  buffer_load_dwordx4 v9, s[8:11], s42 offen nt lds
  s_add_u32 m0, s41, 86016
  s_mov_b32 s42, 4702208
  buffer_load_dwordx4 v9, s[8:11], s42 offen nt lds
  s_add_u32 m0, s41, 90112
  s_mov_b32 s42, 4816896
  buffer_load_dwordx4 v9, s[8:11], s42 offen nt lds
  s_add_u32 m0, s41, 94208
  s_mov_b32 s42, 4931584
  buffer_load_dwordx4 v9, s[8:11], s42 offen nt lds
  ds_read_b64_tr_b16 a[96:97], v7 offset:32768
  ds_read_b64_tr_b16 a[98:99], v7 offset:34816
  ds_read_b64_tr_b16 a[100:101], v7 offset:36864
  ds_read_b64_tr_b16 a[102:103], v7 offset:38912
  ds_read_b64_tr_b16 a[104:105], v7 offset:40960
  ds_read_b64_tr_b16 a[106:107], v7 offset:43008
  ds_read_b64_tr_b16 a[108:109], v7 offset:45056
  ds_read_b64_tr_b16 a[110:111], v7 offset:47104
  s_waitcnt vmcnt(24) lgkmcnt(0)
  s_barrier
  s_add_u32 m0, s41, 98304
  s_mov_b32 s42, 5505024
  buffer_load_dwordx4 v9, s[8:11], s42 offen nt lds
  s_add_u32 m0, s41, 102400
  s_mov_b32 s42, 5619712
  buffer_load_dwordx4 v9, s[8:11], s42 offen nt lds
  s_add_u32 m0, s41, 106496
  s_mov_b32 s42, 5734400
  buffer_load_dwordx4 v9, s[8:11], s42 offen nt lds
  s_add_u32 m0, s41, 110592
  s_mov_b32 s42, 5849088
  buffer_load_dwordx4 v9, s[8:11], s42 offen nt lds
  ds_read_b64_tr_b16 a[112:113], v7 offset:49152
  ds_read_b64_tr_b16 a[114:115], v7 offset:51200
  ds_read_b64_tr_b16 a[116:117], v7 offset:53248
  ds_read_b64_tr_b16 a[118:119], v7 offset:55296
  ds_read_b64_tr_b16 a[120:121], v7 offset:57344
  ds_read_b64_tr_b16 a[122:123], v7 offset:59392
  ds_read_b64_tr_b16 a[124:125], v7 offset:61440
  ds_read_b64_tr_b16 a[126:127], v7 offset:63488
  s_waitcnt vmcnt(24) lgkmcnt(0)
  s_barrier
  s_add_u32 m0, s41, 114688
  s_mov_b32 s42, 6422528
  buffer_load_dwordx4 v9, s[8:11], s42 offen nt lds
  s_add_u32 m0, s41, 118784
  s_mov_b32 s42, 6537216
  buffer_load_dwordx4 v9, s[8:11], s42 offen nt lds
  s_add_u32 m0, s41, 122880
  s_mov_b32 s42, 6651904
  buffer_load_dwordx4 v9, s[8:11], s42 offen nt lds
  s_add_u32 m0, s41, 126976
  s_mov_b32 s42, 6766592
  buffer_load_dwordx4 v9, s[8:11], s42 offen nt lds
  ds_read_b64_tr_b16 a[128:129], v6 offset:0
  ds_read_b64_tr_b16 a[130:131], v6 offset:2048
  ds_read_b64_tr_b16 a[132:133], v6 offset:4096
  ds_read_b64_tr_b16 a[134:135], v6 offset:6144
  ds_read_b64_tr_b16 a[136:137], v6 offset:8192
  ds_read_b64_tr_b16 a[138:139], v6 offset:10240
  ds_read_b64_tr_b16 a[140:141], v6 offset:12288
  ds_read_b64_tr_b16 a[142:143], v6 offset:14336
  s_waitcnt vmcnt(24) lgkmcnt(0)
  s_barrier
  ds_read_b64_tr_b16 a[144:145], v6 offset:16384
  ds_read_b64_tr_b16 a[146:147], v6 offset:18432
  ds_read_b64_tr_b16 a[148:149], v6 offset:20480
  ds_read_b64_tr_b16 a[150:151], v6 offset:22528
  ds_read_b64_tr_b16 a[152:153], v6 offset:24576
  ds_read_b64_tr_b16 a[154:155], v6 offset:26624
  ds_read_b64_tr_b16 a[156:157], v6 offset:28672
  ds_read_b64_tr_b16 a[158:159], v6 offset:30720
  s_waitcnt vmcnt(20) lgkmcnt(0)
  s_barrier
  ds_read_b64_tr_b16 a[160:161], v6 offset:32768
  ds_read_b64_tr_b16 a[162:163], v6 offset:34816
  ds_read_b64_tr_b16 a[164:165], v6 offset:36864
  ds_read_b64_tr_b16 a[166:167], v6 offset:38912
  ds_read_b64_tr_b16 a[168:169], v6 offset:40960
  ds_read_b64_tr_b16 a[170:171], v6 offset:43008
  ds_read_b64_tr_b16 a[172:173], v6 offset:45056
  ds_read_b64_tr_b16 a[174:175], v6 offset:47104
  s_waitcnt vmcnt(16) lgkmcnt(0)
  s_barrier
  ds_read_b64_tr_b16 a[176:177], v6 offset:49152
  ds_read_b64_tr_b16 a[178:179], v6 offset:51200
  ds_read_b64_tr_b16 a[180:181], v6 offset:53248
  ds_read_b64_tr_b16 a[182:183], v6 offset:55296
  ds_read_b64_tr_b16 a[184:185], v6 offset:57344
  ds_read_b64_tr_b16 a[186:187], v6 offset:59392
  ds_read_b64_tr_b16 a[188:189], v6 offset:61440
  ds_read_b64_tr_b16 a[190:191], v6 offset:63488
  s_waitcnt vmcnt(12) lgkmcnt(0)
  s_barrier
  ds_read_b64_tr_b16 a[192:193], v7 offset:0
  ds_read_b64_tr_b16 a[194:195], v7 offset:2048
  ds_read_b64_tr_b16 a[196:197], v7 offset:4096
  ds_read_b64_tr_b16 a[198:199], v7 offset:6144
  ds_read_b64_tr_b16 a[200:201], v7 offset:8192
  ds_read_b64_tr_b16 a[202:203], v7 offset:10240
  ds_read_b64_tr_b16 a[204:205], v7 offset:12288
  ds_read_b64_tr_b16 a[206:207], v7 offset:14336
  s_waitcnt vmcnt(8) lgkmcnt(0)
  s_barrier
  ds_read_b64_tr_b16 a[208:209], v7 offset:16384
  ds_read_b64_tr_b16 a[210:211], v7 offset:18432
  ds_read_b64_tr_b16 a[212:213], v7 offset:20480
  ds_read_b64_tr_b16 a[214:215], v7 offset:22528
  ds_read_b64_tr_b16 a[216:217], v7 offset:24576
  ds_read_b64_tr_b16 a[218:219], v7 offset:26624
  ds_read_b64_tr_b16 a[220:221], v7 offset:28672
  ds_read_b64_tr_b16 a[222:223], v7 offset:30720
  s_waitcnt vmcnt(4) lgkmcnt(0)
  s_barrier
  ds_read_b64_tr_b16 a[224:225], v7 offset:32768
  ds_read_b64_tr_b16 a[226:227], v7 offset:34816
  ds_read_b64_tr_b16 a[228:229], v7 offset:36864
  ds_read_b64_tr_b16 a[230:231], v7 offset:38912
  ds_read_b64_tr_b16 a[232:233], v7 offset:40960
  ds_read_b64_tr_b16 a[234:235], v7 offset:43008
  ds_read_b64_tr_b16 a[236:237], v7 offset:45056
  ds_read_b64_tr_b16 a[238:239], v7 offset:47104
  s_waitcnt vmcnt(0) lgkmcnt(0)
  s_barrier
  ds_read_b64_tr_b16 a[240:241], v7 offset:49152
  ds_read_b64_tr_b16 a[242:243], v7 offset:51200
  ds_read_b64_tr_b16 a[244:245], v7 offset:53248
  ds_read_b64_tr_b16 a[246:247], v7 offset:55296
  ds_read_b64_tr_b16 a[248:249], v7 offset:57344
  ds_read_b64_tr_b16 a[250:251], v7 offset:59392
  ds_read_b64_tr_b16 a[252:253], v7 offset:61440
  ds_read_b64_tr_b16 a[254:255], v7 offset:63488
  s_waitcnt lgkmcnt(0)
  s_barrier
  v_min_u32 v2, 7, v0
  v_lshlrev_b32 v2, 7, v2
  v_add_u32 v2, 1413120, v2
  s_lshl_b32 s62, s21, 7
  s_add_u32 s62, s62, 1414144
  v_min_u32 v52, 63, v0
  v_lshlrev_b32 v52, 7, v52
  v_add_u32 v52, 1424384, v52
  s_nop 1
Lpoll_41:
  buffer_load_dword v53, v52, s[4:7], 0 offen sc1
  s_sub_u32 s24, s24, 1
  s_cbranch_scc1 L_FAIL
  s_waitcnt vmcnt(0)
  v_cmp_gt_i32 vcc, 0, v53
  s_cbranch_vccz Lpolld_42
  s_sleep 1
  s_branch Lpoll_41
Lpolld_42:
  v_lshrrev_b32 v53, 8, v53
  v_and_b32 v54, 3, v0
  v_lshl_or_b32 v53, v53, 2, v54
  s_nop 1
  v_min_u32_dpp v53, v53, v53 row_ror:8 row_mask:0xf bank_mask:0xf
  s_nop 1
  v_min_u32_dpp v53, v53, v53 row_ror:4 row_mask:0xf bank_mask:0xf
  v_mov_b32 v54, v53
  s_nop 1
  v_permlane16_swap_b32 v54, v53
  v_min_u32 v53, v53, v54
  v_mov_b32 v54, v53
  s_nop 1
  v_permlane32_swap_b32 v54, v53
  v_min_u32 v53, v53, v54
  s_nop 1
  v_min_u32_dpp v53, v53, v53 row_ror:2 row_mask:0xf bank_mask:0xf
  s_nop 1
  v_min_u32_dpp v53, v53, v53 row_ror:1 row_mask:0xf bank_mask:0xf
  s_nop 0
  v_readfirstlane_b32 s38, v53
  s_and_b32 s38, s38, 3
  s_lshl_b32 s38, s38, 13
  s_and_b32 s38, s38, 0x2000
  s_xor_b32 s38, s38, 16785408
  s_lshr_b32 s40, s20, 1
  s_lshl_b32 s40, s40, 14
  s_and_b32 s41, s20, 1
  s_lshl_b32 s41, s41, 12
  s_add_u32 s27, s40, s41
  s_lshr_b32 s40, s21, 1
  s_lshl_b32 s40, s40, 14
  s_and_b32 s41, s21, 1
  s_lshl_b32 s41, s41, 12
  s_add_u32 s31, s40, s41
  s_add_u32 s27, s27, s38
  s_add_u32 s27, s27, 917504
  s_add_u32 s31, s31, s38
  s_add_u32 s31, s31, 1179648
  s_lshr_b32 s40, s20, 1
  s_lshl_b32 s40, s40, 11
  s_and_b32 s41, s20, 1
  s_lshl_b32 s41, s41, 9
  s_add_u32 s40, s40, s41
  v_and_b32 v52, 31, v0
  v_lshl_add_u32 v68, v52, 4, s40
  v_lshrrev_b32 v52, 5, v0
  v_lshl_add_u32 v68, v52, 10, v68
  s_mov_b32 s37, 0xbfb8aa3b
  v_lshlrev_b32 v71, 2, v0
  v_add_u32 v71, 131072, v71
  s_mov_b32 s25, 0
  s_mov_b32 s26, 0
  s_mov_b32 s29, 1
  s_mov_b32 s30, 0
  s_mov_b32 s28, 0
L_F1_top:
  s_cmp_eq_u32 s28, 1
  s_cbranch_scc1 L_F1_go
  s_cmp_eq_u32 s28, 2
  s_cbranch_scc1 L_F1_mid
  s_cmp_lg_u32 s20, 0
  s_cbranch_scc1 L_F1_park
  buffer_load_dword v3, v2, s[4:7], s30 offen sc1
  s_waitcnt vmcnt(1)
  s_barrier
  s_mov_b32 s63, s25
  s_atomic_smax s63, s[4:5], s62 glc
Lnosig_43:
  s_cmp_ge_u32 s25, 64
  s_cbranch_scc1 L_END
  s_waitcnt vmcnt(0)
  v_cmp_gt_i32 vcc, s29, v3
  s_cbranch_vccz L_F1_issue
  s_nop 3
Lpoll_44:
  buffer_load_dword v3, v2, s[4:7], s30 offen sc1
  s_sub_u32 s24, s24, 1
  s_cbranch_scc1 L_FAIL
  s_waitcnt vmcnt(0)
  v_cmp_gt_i32 vcc, s29, v3
  s_cbranch_vccz Lpolld_45
  s_sleep 1
  s_branch Lpoll_44
Lpolld_45:
  s_branch L_F1_issue
L_F1_park:
  s_waitcnt vmcnt(0)
  s_barrier
  s_cmp_ge_u32 s25, 64
  s_cbranch_scc1 L_END
L_F1_issue:
  s_barrier
L_F1_mid:
  s_mov_b32 s34, s26
  s_mov_b32 s35, s27
  s_add_u32 s36, s32, 0
  s_add_u32 m0, s34, s36
  s_add_u32 s36, s35, 0
  buffer_load_dwordx4 v1, s[4:7], s36 offen offset:0 sc1 lds
  s_nop 0
  buffer_load_dwordx4 v1, s[4:7], s36 offen offset:1024 sc1 lds
  s_nop 0
  buffer_load_dwordx4 v1, s[4:7], s36 offen offset:2048 sc1 lds
  s_nop 0
  buffer_load_dwordx4 v1, s[4:7], s36 offen offset:3072 sc1 lds
  s_nop 0
  s_add_u32 s36, s32, 16384
  s_add_u32 m0, s34, s36
  s_add_u32 s36, s35, 32768
  buffer_load_dwordx4 v1, s[4:7], s36 offen offset:0 sc1 lds
  s_nop 0
  buffer_load_dwordx4 v1, s[4:7], s36 offen offset:1024 sc1 lds
  s_nop 0
  buffer_load_dwordx4 v1, s[4:7], s36 offen offset:2048 sc1 lds
  s_nop 0
  buffer_load_dwordx4 v1, s[4:7], s36 offen offset:3072 sc1 lds
  s_nop 0
  s_add_u32 s36, s32, 32768
  s_add_u32 m0, s34, s36
  s_add_u32 s36, s35, 65536
  buffer_load_dwordx4 v1, s[4:7], s36 offen offset:0 sc1 lds
  s_nop 0
  buffer_load_dwordx4 v1, s[4:7], s36 offen offset:1024 sc1 lds
  s_nop 0
  buffer_load_dwordx4 v1, s[4:7], s36 offen offset:2048 sc1 lds
  s_nop 0
  buffer_load_dwordx4 v1, s[4:7], s36 offen offset:3072 sc1 lds
  s_nop 0
  s_cmp_eq_u32 s28, 0
  s_cbranch_scc1 L_F1_go
  s_mov_b32 s28, 0
  s_waitcnt vmcnt(12)
  s_barrier
  s_cmp_lg_u32 s20, 0
  s_cbranch_scc1 Lnosig_46
  s_mov_b32 s63, s25
  s_atomic_smax s63, s[4:5], s62 glc
Lnosig_46:
L_F1_go:
  v_add_u32 v73, s26, v69
  v_add_u32 v74, s26, v70
  s_sub_u32 s26, 65536, s26
  s_add_u32 s27, s27, 2097152
  s_xor_b32 s27, s27, 0x2000
  s_add_u32 s29, s29, 1
  s_waitcnt vmcnt(8)
  s_barrier
  ds_read_b128 v[4:7], v73 offset:0
  ds_read_b128 v[8:11], v73 offset:1024
  ds_read_b128 v[12:15], v73 offset:2048
  ds_read_b128 v[16:19], v73 offset:3072
  ds_read_b128 v[20:23], v73 offset:4096
  ds_read_b128 v[24:27], v73 offset:5120
  s_waitcnt lgkmcnt(4)
  v_mfma_f32_16x16x32_bf16 v[36:39], a[0:3], v[4:7], 0
  ds_read_b128 v[28:31], v73 offset:6144
  v_mfma_f32_16x16x32_bf16 v[40:43], a[0:3], v[8:11], 0
  ds_read_b128 v[32:35], v73 offset:7168
  v_mfma_f32_16x16x32_bf16 v[44:47], a[128:131], v[4:7], 0
  s_add_u32 s36, s32, 49152
  s_add_u32 m0, s34, s36
  s_add_u32 s36, s35, 98304
  buffer_load_dwordx4 v1, s[4:7], s36 offen offset:0 sc1 lds
  v_mfma_f32_16x16x32_bf16 v[48:51], a[128:131], v[8:11], 0
  s_waitcnt lgkmcnt(4)
  v_mfma_f32_16x16x32_bf16 v[36:39], a[4:7], v[12:15], v[36:39]
  ds_read_b128 v[4:7], v73 offset:8192
  v_mfma_f32_16x16x32_bf16 v[40:43], a[4:7], v[16:19], v[40:43]
  ds_read_b128 v[8:11], v73 offset:9216
  v_mfma_f32_16x16x32_bf16 v[44:47], a[132:135], v[12:15], v[44:47]
  buffer_load_dwordx4 v1, s[4:7], s36 offen offset:1024 sc1 lds
  v_mfma_f32_16x16x32_bf16 v[48:51], a[132:135], v[16:19], v[48:51]
  s_waitcnt lgkmcnt(4)
  v_mfma_f32_16x16x32_bf16 v[36:39], a[8:11], v[20:23], v[36:39]
  ds_read_b128 v[12:15], v73 offset:10240
  v_mfma_f32_16x16x32_bf16 v[40:43], a[8:11], v[24:27], v[40:43]
  ds_read_b128 v[16:19], v73 offset:11264
  v_mfma_f32_16x16x32_bf16 v[44:47], a[136:139], v[20:23], v[44:47]
  buffer_load_dwordx4 v1, s[4:7], s36 offen offset:2048 sc1 lds
  v_mfma_f32_16x16x32_bf16 v[48:51], a[136:139], v[24:27], v[48:51]
  s_waitcnt lgkmcnt(4)
  v_mfma_f32_16x16x32_bf16 v[36:39], a[12:15], v[28:31], v[36:39]
  ds_read_b128 v[20:23], v73 offset:12288
  v_mfma_f32_16x16x32_bf16 v[40:43], a[12:15], v[32:35], v[40:43]
  ds_read_b128 v[24:27], v73 offset:13312
  v_mfma_f32_16x16x32_bf16 v[44:47], a[140:143], v[28:31], v[44:47]
  buffer_load_dwordx4 v1, s[4:7], s36 offen offset:3072 sc1 lds
  v_mfma_f32_16x16x32_bf16 v[48:51], a[140:143], v[32:35], v[48:51]
  s_waitcnt lgkmcnt(4)
  v_mfma_f32_16x16x32_bf16 v[36:39], a[16:19], v[4:7], v[36:39]
  ds_read_b128 v[28:31], v73 offset:14336
  v_mfma_f32_16x16x32_bf16 v[40:43], a[16:19], v[8:11], v[40:43]
  ds_read_b128 v[32:35], v73 offset:15360
  v_mfma_f32_16x16x32_bf16 v[44:47], a[144:147], v[4:7], v[44:47]
  v_mfma_f32_16x16x32_bf16 v[48:51], a[144:147], v[8:11], v[48:51]
  s_waitcnt vmcnt(8)
  s_barrier
  s_mov_b32 s34, s26
  s_mov_b32 s35, s27
  s_waitcnt lgkmcnt(4)
  v_mfma_f32_16x16x32_bf16 v[36:39], a[20:23], v[12:15], v[36:39]
  ds_read_b128 v[4:7], v73 offset:16384
  v_mfma_f32_16x16x32_bf16 v[40:43], a[20:23], v[16:19], v[40:43]
  ds_read_b128 v[8:11], v73 offset:17408
  v_mfma_f32_16x16x32_bf16 v[44:47], a[148:151], v[12:15], v[44:47]
  v_mfma_f32_16x16x32_bf16 v[48:51], a[148:151], v[16:19], v[48:51]
  s_waitcnt lgkmcnt(4)
  v_mfma_f32_16x16x32_bf16 v[36:39], a[24:27], v[20:23], v[36:39]
  ds_read_b128 v[12:15], v73 offset:18432
  v_mfma_f32_16x16x32_bf16 v[40:43], a[24:27], v[24:27], v[40:43]
  ds_read_b128 v[16:19], v73 offset:19456
  v_mfma_f32_16x16x32_bf16 v[44:47], a[152:155], v[20:23], v[44:47]
  v_mfma_f32_16x16x32_bf16 v[48:51], a[152:155], v[24:27], v[48:51]
  s_waitcnt lgkmcnt(4)
  v_mfma_f32_16x16x32_bf16 v[36:39], a[28:31], v[28:31], v[36:39]
  ds_read_b128 v[20:23], v73 offset:20480
  v_mfma_f32_16x16x32_bf16 v[40:43], a[28:31], v[32:35], v[40:43]
  ds_read_b128 v[24:27], v73 offset:21504
  v_mfma_f32_16x16x32_bf16 v[44:47], a[156:159], v[28:31], v[44:47]
  v_mfma_f32_16x16x32_bf16 v[48:51], a[156:159], v[32:35], v[48:51]
  s_waitcnt lgkmcnt(4)
  v_mfma_f32_16x16x32_bf16 v[36:39], a[32:35], v[4:7], v[36:39]
  ds_read_b128 v[28:31], v73 offset:22528
  v_mfma_f32_16x16x32_bf16 v[40:43], a[32:35], v[8:11], v[40:43]
  ds_read_b128 v[32:35], v73 offset:23552
  v_mfma_f32_16x16x32_bf16 v[44:47], a[160:163], v[4:7], v[44:47]
  v_mfma_f32_16x16x32_bf16 v[48:51], a[160:163], v[8:11], v[48:51]
  s_waitcnt lgkmcnt(4)
  v_mfma_f32_16x16x32_bf16 v[36:39], a[36:39], v[12:15], v[36:39]
  ds_read_b128 v[4:7], v73 offset:24576
  v_mfma_f32_16x16x32_bf16 v[40:43], a[36:39], v[16:19], v[40:43]
  ds_read_b128 v[8:11], v73 offset:25600
  v_mfma_f32_16x16x32_bf16 v[44:47], a[164:167], v[12:15], v[44:47]
  v_mfma_f32_16x16x32_bf16 v[48:51], a[164:167], v[16:19], v[48:51]
  s_waitcnt lgkmcnt(4)
  v_mfma_f32_16x16x32_bf16 v[36:39], a[40:43], v[20:23], v[36:39]
  ds_read_b128 v[12:15], v73 offset:26624
  v_mfma_f32_16x16x32_bf16 v[40:43], a[40:43], v[24:27], v[40:43]
  ds_read_b128 v[16:19], v73 offset:27648
  v_mfma_f32_16x16x32_bf16 v[44:47], a[168:171], v[20:23], v[44:47]
  v_mfma_f32_16x16x32_bf16 v[48:51], a[168:171], v[24:27], v[48:51]
  s_waitcnt lgkmcnt(4)
  v_mfma_f32_16x16x32_bf16 v[36:39], a[44:47], v[28:31], v[36:39]
  ds_read_b128 v[20:23], v73 offset:28672
  v_mfma_f32_16x16x32_bf16 v[40:43], a[44:47], v[32:35], v[40:43]
  ds_read_b128 v[24:27], v73 offset:29696
  v_mfma_f32_16x16x32_bf16 v[44:47], a[172:175], v[28:31], v[44:47]
  v_mfma_f32_16x16x32_bf16 v[48:51], a[172:175], v[32:35], v[48:51]
  s_lshl_b32 s40, s20, 8
  s_add_u32 m0, s40, 131072
  s_cmp_eq_u32 s20, 0
  s_cselect_b32 s40, s30, 2147483392
  buffer_load_dword v2, s[4:7], s40 offen sc1 lds
  s_waitcnt lgkmcnt(4)
  v_mfma_f32_16x16x32_bf16 v[36:39], a[48:51], v[4:7], v[36:39]
  ds_read_b128 v[28:31], v73 offset:30720
  v_mfma_f32_16x16x32_bf16 v[40:43], a[48:51], v[8:11], v[40:43]
  ds_read_b128 v[32:35], v73 offset:31744
  v_mfma_f32_16x16x32_bf16 v[44:47], a[176:179], v[4:7], v[44:47]
  v_mfma_f32_16x16x32_bf16 v[48:51], a[176:179], v[8:11], v[48:51]
  s_waitcnt vmcnt(5)
  s_barrier
  s_lshl_b32 s40, s20, 1
  s_add_u32 s40, s40, 1
  s_cmp_lg_u32 s40, s28
  s_cbranch_scc1 L_F1_s2
  s_mov_b32 s63, s25
  s_atomic_smax s63, s[4:5], s62 glc
Lnosig_47:
L_F1_s2:
  s_waitcnt lgkmcnt(4)
  v_mfma_f32_16x16x32_bf16 v[36:39], a[52:55], v[12:15], v[36:39]
  ds_read_b128 v[4:7], v73 offset:32768
  v_mfma_f32_16x16x32_bf16 v[40:43], a[52:55], v[16:19], v[40:43]
  ds_read_b128 v[8:11], v73 offset:33792
  v_mfma_f32_16x16x32_bf16 v[44:47], a[180:183], v[12:15], v[44:47]
  v_mfma_f32_16x16x32_bf16 v[48:51], a[180:183], v[16:19], v[48:51]
  s_waitcnt lgkmcnt(4)
  v_mfma_f32_16x16x32_bf16 v[36:39], a[56:59], v[20:23], v[36:39]
  ds_read_b128 v[12:15], v73 offset:34816
  v_mfma_f32_16x16x32_bf16 v[40:43], a[56:59], v[24:27], v[40:43]
  ds_read_b128 v[16:19], v73 offset:35840
  v_mfma_f32_16x16x32_bf16 v[44:47], a[184:187], v[20:23], v[44:47]
  v_mfma_f32_16x16x32_bf16 v[48:51], a[184:187], v[24:27], v[48:51]
  s_waitcnt lgkmcnt(4)
  v_mfma_f32_16x16x32_bf16 v[36:39], a[60:63], v[28:31], v[36:39]
  ds_read_b128 v[20:23], v73 offset:36864
  v_mfma_f32_16x16x32_bf16 v[40:43], a[60:63], v[32:35], v[40:43]
  ds_read_b128 v[24:27], v73 offset:37888
  v_mfma_f32_16x16x32_bf16 v[44:47], a[188:191], v[28:31], v[44:47]
  v_mfma_f32_16x16x32_bf16 v[48:51], a[188:191], v[32:35], v[48:51]
  s_waitcnt lgkmcnt(4)
  v_mfma_f32_16x16x32_bf16 v[36:39], a[64:67], v[4:7], v[36:39]
  ds_read_b128 v[28:31], v73 offset:38912
  v_mfma_f32_16x16x32_bf16 v[40:43], a[64:67], v[8:11], v[40:43]
  ds_read_b128 v[32:35], v73 offset:39936
  v_mfma_f32_16x16x32_bf16 v[44:47], a[192:195], v[4:7], v[44:47]
  v_mfma_f32_16x16x32_bf16 v[48:51], a[192:195], v[8:11], v[48:51]
  s_waitcnt lgkmcnt(4)
  v_mfma_f32_16x16x32_bf16 v[36:39], a[68:71], v[12:15], v[36:39]
  ds_read_b128 v[4:7], v73 offset:40960
  v_mfma_f32_16x16x32_bf16 v[40:43], a[68:71], v[16:19], v[40:43]
  ds_read_b128 v[8:11], v73 offset:41984
  v_mfma_f32_16x16x32_bf16 v[44:47], a[196:199], v[12:15], v[44:47]
  v_mfma_f32_16x16x32_bf16 v[48:51], a[196:199], v[16:19], v[48:51]
  s_waitcnt lgkmcnt(4)
  v_mfma_f32_16x16x32_bf16 v[36:39], a[72:75], v[20:23], v[36:39]
  ds_read_b128 v[12:15], v73 offset:43008
  v_mfma_f32_16x16x32_bf16 v[40:43], a[72:75], v[24:27], v[40:43]
  ds_read_b128 v[16:19], v73 offset:44032
  v_mfma_f32_16x16x32_bf16 v[44:47], a[200:203], v[20:23], v[44:47]
  v_mfma_f32_16x16x32_bf16 v[48:51], a[200:203], v[24:27], v[48:51]
  s_waitcnt vmcnt(0)
  s_barrier
  ds_read_b32 v3, v71
  s_waitcnt lgkmcnt(4)
  v_mfma_f32_16x16x32_bf16 v[36:39], a[76:79], v[28:31], v[36:39]
  ds_read_b128 v[20:23], v73 offset:45056
  v_mfma_f32_16x16x32_bf16 v[40:43], a[76:79], v[32:35], v[40:43]
  ds_read_b128 v[24:27], v73 offset:46080
  v_mfma_f32_16x16x32_bf16 v[44:47], a[204:207], v[28:31], v[44:47]
  v_mfma_f32_16x16x32_bf16 v[48:51], a[204:207], v[32:35], v[48:51]
  s_waitcnt lgkmcnt(4)
  v_mfma_f32_16x16x32_bf16 v[36:39], a[80:83], v[4:7], v[36:39]
  ds_read_b128 v[28:31], v73 offset:47104
  v_mfma_f32_16x16x32_bf16 v[40:43], a[80:83], v[8:11], v[40:43]
  ds_read_b128 v[32:35], v73 offset:48128
  v_mfma_f32_16x16x32_bf16 v[44:47], a[208:211], v[4:7], v[44:47]
  v_mfma_f32_16x16x32_bf16 v[48:51], a[208:211], v[8:11], v[48:51]
  s_waitcnt lgkmcnt(4)
  v_cmp_gt_i32 vcc, s29, v3
  s_mov_b32 s28, 0
  s_cbranch_vccnz L_F1_nopf
  s_cmp_ge_u32 s25, 63
  s_cbranch_scc1 L_F1_nopf
  s_mov_b32 s28, 1
  s_waitcnt lgkmcnt(4)
  v_mfma_f32_16x16x32_bf16 v[36:39], a[84:87], v[12:15], v[36:39]
  ds_read_b128 v[4:7], v73 offset:49152
  v_mfma_f32_16x16x32_bf16 v[40:43], a[84:87], v[16:19], v[40:43]
  ds_read_b128 v[8:11], v73 offset:50176
  v_mfma_f32_16x16x32_bf16 v[44:47], a[212:215], v[12:15], v[44:47]
  s_add_u32 s36, s32, 0
  s_add_u32 m0, s34, s36
  s_add_u32 s36, s35, 0
  buffer_load_dwordx4 v1, s[4:7], s36 offen offset:0 sc1 lds
  v_mfma_f32_16x16x32_bf16 v[48:51], a[212:215], v[16:19], v[48:51]
  buffer_load_dwordx4 v1, s[4:7], s36 offen offset:1024 sc1 lds
  s_waitcnt lgkmcnt(4)
  v_mfma_f32_16x16x32_bf16 v[36:39], a[88:91], v[20:23], v[36:39]
  ds_read_b128 v[12:15], v73 offset:51200
  v_mfma_f32_16x16x32_bf16 v[40:43], a[88:91], v[24:27], v[40:43]
  ds_read_b128 v[16:19], v73 offset:52224
  v_mfma_f32_16x16x32_bf16 v[44:47], a[216:219], v[20:23], v[44:47]
  buffer_load_dwordx4 v1, s[4:7], s36 offen offset:2048 sc1 lds
  v_mfma_f32_16x16x32_bf16 v[48:51], a[216:219], v[24:27], v[48:51]
  buffer_load_dwordx4 v1, s[4:7], s36 offen offset:3072 sc1 lds
  s_waitcnt lgkmcnt(4)
  v_mfma_f32_16x16x32_bf16 v[36:39], a[92:95], v[28:31], v[36:39]
  ds_read_b128 v[20:23], v73 offset:53248
  v_mfma_f32_16x16x32_bf16 v[40:43], a[92:95], v[32:35], v[40:43]
  ds_read_b128 v[24:27], v73 offset:54272
  v_mfma_f32_16x16x32_bf16 v[44:47], a[220:223], v[28:31], v[44:47]
  s_add_u32 s36, s32, 16384
  s_add_u32 m0, s34, s36
  s_add_u32 s36, s35, 32768
  buffer_load_dwordx4 v1, s[4:7], s36 offen offset:0 sc1 lds
  v_mfma_f32_16x16x32_bf16 v[48:51], a[220:223], v[32:35], v[48:51]
  buffer_load_dwordx4 v1, s[4:7], s36 offen offset:1024 sc1 lds
  s_waitcnt lgkmcnt(4)
  v_mfma_f32_16x16x32_bf16 v[36:39], a[96:99], v[4:7], v[36:39]
  ds_read_b128 v[28:31], v73 offset:55296
  v_mfma_f32_16x16x32_bf16 v[40:43], a[96:99], v[8:11], v[40:43]
  ds_read_b128 v[32:35], v73 offset:56320
  v_mfma_f32_16x16x32_bf16 v[44:47], a[224:227], v[4:7], v[44:47]
  buffer_load_dwordx4 v1, s[4:7], s36 offen offset:2048 sc1 lds
  v_mfma_f32_16x16x32_bf16 v[48:51], a[224:227], v[8:11], v[48:51]
  buffer_load_dwordx4 v1, s[4:7], s36 offen offset:3072 sc1 lds
  s_waitcnt lgkmcnt(4)
  v_mfma_f32_16x16x32_bf16 v[36:39], a[100:103], v[12:15], v[36:39]
  ds_read_b128 v[4:7], v73 offset:57344
  v_mfma_f32_16x16x32_bf16 v[40:43], a[100:103], v[16:19], v[40:43]
  ds_read_b128 v[8:11], v73 offset:58368
  v_mfma_f32_16x16x32_bf16 v[44:47], a[228:231], v[12:15], v[44:47]
  s_add_u32 s36, s32, 32768
  s_add_u32 m0, s34, s36
  s_add_u32 s36, s35, 65536
  buffer_load_dwordx4 v1, s[4:7], s36 offen offset:0 sc1 lds
  v_mfma_f32_16x16x32_bf16 v[48:51], a[228:231], v[16:19], v[48:51]
  buffer_load_dwordx4 v1, s[4:7], s36 offen offset:1024 sc1 lds
  s_waitcnt lgkmcnt(4)
  v_mfma_f32_16x16x32_bf16 v[36:39], a[104:107], v[20:23], v[36:39]
  ds_read_b128 v[12:15], v73 offset:59392
  v_mfma_f32_16x16x32_bf16 v[40:43], a[104:107], v[24:27], v[40:43]
  ds_read_b128 v[16:19], v73 offset:60416
  v_mfma_f32_16x16x32_bf16 v[44:47], a[232:235], v[20:23], v[44:47]
  buffer_load_dwordx4 v1, s[4:7], s36 offen offset:2048 sc1 lds
  v_mfma_f32_16x16x32_bf16 v[48:51], a[232:235], v[24:27], v[48:51]
  buffer_load_dwordx4 v1, s[4:7], s36 offen offset:3072 sc1 lds
  s_waitcnt lgkmcnt(4)
  v_mfma_f32_16x16x32_bf16 v[36:39], a[108:111], v[28:31], v[36:39]
  ds_read_b128 v[20:23], v73 offset:61440
  v_mfma_f32_16x16x32_bf16 v[40:43], a[108:111], v[32:35], v[40:43]
  ds_read_b128 v[24:27], v73 offset:62464
  v_mfma_f32_16x16x32_bf16 v[44:47], a[236:239], v[28:31], v[44:47]
  v_mfma_f32_16x16x32_bf16 v[48:51], a[236:239], v[32:35], v[48:51]
  s_waitcnt lgkmcnt(4)
  v_mfma_f32_16x16x32_bf16 v[36:39], a[112:115], v[4:7], v[36:39]
  ds_read_b128 v[28:31], v73 offset:63488
  v_mfma_f32_16x16x32_bf16 v[40:43], a[112:115], v[8:11], v[40:43]
  ds_read_b128 v[32:35], v73 offset:64512
  v_mfma_f32_16x16x32_bf16 v[44:47], a[240:243], v[4:7], v[44:47]
  v_mfma_f32_16x16x32_bf16 v[48:51], a[240:243], v[8:11], v[48:51]
  s_waitcnt lgkmcnt(4)
  v_mfma_f32_16x16x32_bf16 v[36:39], a[116:119], v[12:15], v[36:39]
  v_mfma_f32_16x16x32_bf16 v[40:43], a[116:119], v[16:19], v[40:43]
  v_mfma_f32_16x16x32_bf16 v[44:47], a[244:247], v[12:15], v[44:47]
  v_mfma_f32_16x16x32_bf16 v[48:51], a[244:247], v[16:19], v[48:51]
  s_waitcnt lgkmcnt(2)
  v_mfma_f32_16x16x32_bf16 v[36:39], a[120:123], v[20:23], v[36:39]
  v_mfma_f32_16x16x32_bf16 v[40:43], a[120:123], v[24:27], v[40:43]
  v_mfma_f32_16x16x32_bf16 v[44:47], a[248:251], v[20:23], v[44:47]
  v_mfma_f32_16x16x32_bf16 v[48:51], a[248:251], v[24:27], v[48:51]
  s_waitcnt lgkmcnt(0)
  v_mfma_f32_16x16x32_bf16 v[36:39], a[124:127], v[28:31], v[36:39]
  v_mfma_f32_16x16x32_bf16 v[40:43], a[124:127], v[32:35], v[40:43]
  v_mfma_f32_16x16x32_bf16 v[44:47], a[252:255], v[28:31], v[44:47]
  v_mfma_f32_16x16x32_bf16 v[48:51], a[252:255], v[32:35], v[48:51]
  s_nop 7
  s_branch L_F1_epi
L_F1_nopf:
  s_waitcnt lgkmcnt(4)
  v_mfma_f32_16x16x32_bf16 v[36:39], a[84:87], v[12:15], v[36:39]
  ds_read_b128 v[4:7], v73 offset:49152
  v_mfma_f32_16x16x32_bf16 v[40:43], a[84:87], v[16:19], v[40:43]
  ds_read_b128 v[8:11], v73 offset:50176
  v_mfma_f32_16x16x32_bf16 v[44:47], a[212:215], v[12:15], v[44:47]
  v_mfma_f32_16x16x32_bf16 v[48:51], a[212:215], v[16:19], v[48:51]
  s_waitcnt lgkmcnt(4)
  v_mfma_f32_16x16x32_bf16 v[36:39], a[88:91], v[20:23], v[36:39]
  ds_read_b128 v[12:15], v73 offset:51200
  v_mfma_f32_16x16x32_bf16 v[40:43], a[88:91], v[24:27], v[40:43]
  ds_read_b128 v[16:19], v73 offset:52224
  v_mfma_f32_16x16x32_bf16 v[44:47], a[216:219], v[20:23], v[44:47]
  v_mfma_f32_16x16x32_bf16 v[48:51], a[216:219], v[24:27], v[48:51]
  s_waitcnt lgkmcnt(4)
  v_mfma_f32_16x16x32_bf16 v[36:39], a[92:95], v[28:31], v[36:39]
  ds_read_b128 v[20:23], v73 offset:53248
  v_mfma_f32_16x16x32_bf16 v[40:43], a[92:95], v[32:35], v[40:43]
  ds_read_b128 v[24:27], v73 offset:54272
  v_mfma_f32_16x16x32_bf16 v[44:47], a[220:223], v[28:31], v[44:47]
  v_mfma_f32_16x16x32_bf16 v[48:51], a[220:223], v[32:35], v[48:51]
  s_barrier
  s_lshl_b32 s40, s20, 8
  s_add_u32 m0, s40, 131072
  s_cmp_eq_u32 s20, 0
  s_cselect_b32 s40, s30, 2147483392
  buffer_load_dword v2, s[4:7], s40 offen sc1 lds
  s_waitcnt lgkmcnt(4)
  v_mfma_f32_16x16x32_bf16 v[36:39], a[96:99], v[4:7], v[36:39]
  ds_read_b128 v[28:31], v73 offset:55296
  v_mfma_f32_16x16x32_bf16 v[40:43], a[96:99], v[8:11], v[40:43]
  ds_read_b128 v[32:35], v73 offset:56320
  v_mfma_f32_16x16x32_bf16 v[44:47], a[224:227], v[4:7], v[44:47]
  v_mfma_f32_16x16x32_bf16 v[48:51], a[224:227], v[8:11], v[48:51]
  s_waitcnt lgkmcnt(4)
  v_mfma_f32_16x16x32_bf16 v[36:39], a[100:103], v[12:15], v[36:39]
  ds_read_b128 v[4:7], v73 offset:57344
  v_mfma_f32_16x16x32_bf16 v[40:43], a[100:103], v[16:19], v[40:43]
  ds_read_b128 v[8:11], v73 offset:58368
  v_mfma_f32_16x16x32_bf16 v[44:47], a[228:231], v[12:15], v[44:47]
  v_mfma_f32_16x16x32_bf16 v[48:51], a[228:231], v[16:19], v[48:51]
  s_waitcnt lgkmcnt(4)
  v_mfma_f32_16x16x32_bf16 v[36:39], a[104:107], v[20:23], v[36:39]
  ds_read_b128 v[12:15], v73 offset:59392
  v_mfma_f32_16x16x32_bf16 v[40:43], a[104:107], v[24:27], v[40:43]
  ds_read_b128 v[16:19], v73 offset:60416
  v_mfma_f32_16x16x32_bf16 v[44:47], a[232:235], v[20:23], v[44:47]
  v_mfma_f32_16x16x32_bf16 v[48:51], a[232:235], v[24:27], v[48:51]
  s_waitcnt lgkmcnt(4)
  v_mfma_f32_16x16x32_bf16 v[36:39], a[108:111], v[28:31], v[36:39]
  ds_read_b128 v[20:23], v73 offset:61440
  v_mfma_f32_16x16x32_bf16 v[40:43], a[108:111], v[32:35], v[40:43]
  ds_read_b128 v[24:27], v73 offset:62464
  v_mfma_f32_16x16x32_bf16 v[44:47], a[236:239], v[28:31], v[44:47]
  v_mfma_f32_16x16x32_bf16 v[48:51], a[236:239], v[32:35], v[48:51]
  s_waitcnt lgkmcnt(4)
  v_mfma_f32_16x16x32_bf16 v[36:39], a[112:115], v[4:7], v[36:39]
  ds_read_b128 v[28:31], v73 offset:63488
  v_mfma_f32_16x16x32_bf16 v[40:43], a[112:115], v[8:11], v[40:43]
  ds_read_b128 v[32:35], v73 offset:64512
  v_mfma_f32_16x16x32_bf16 v[44:47], a[240:243], v[4:7], v[44:47]
  v_mfma_f32_16x16x32_bf16 v[48:51], a[240:243], v[8:11], v[48:51]
  s_waitcnt lgkmcnt(4)
  v_mfma_f32_16x16x32_bf16 v[36:39], a[116:119], v[12:15], v[36:39]
  v_mfma_f32_16x16x32_bf16 v[40:43], a[116:119], v[16:19], v[40:43]
  v_mfma_f32_16x16x32_bf16 v[44:47], a[244:247], v[12:15], v[44:47]
  v_mfma_f32_16x16x32_bf16 v[48:51], a[244:247], v[16:19], v[48:51]
  s_waitcnt vmcnt(0)
  s_barrier
  ds_read_b32 v3, v71
  s_waitcnt lgkmcnt(2)
  v_mfma_f32_16x16x32_bf16 v[36:39], a[120:123], v[20:23], v[36:39]
  v_mfma_f32_16x16x32_bf16 v[40:43], a[120:123], v[24:27], v[40:43]
  v_mfma_f32_16x16x32_bf16 v[44:47], a[248:251], v[20:23], v[44:47]
  v_mfma_f32_16x16x32_bf16 v[48:51], a[248:251], v[24:27], v[48:51]
  s_waitcnt lgkmcnt(0)
  v_mfma_f32_16x16x32_bf16 v[36:39], a[124:127], v[28:31], v[36:39]
  v_mfma_f32_16x16x32_bf16 v[40:43], a[124:127], v[32:35], v[40:43]
  v_mfma_f32_16x16x32_bf16 v[44:47], a[252:255], v[28:31], v[44:47]
  v_mfma_f32_16x16x32_bf16 v[48:51], a[252:255], v[32:35], v[48:51]
  v_cmp_gt_i32 vcc, s29, v3
  s_cmp_eq_u64 vcc, 0
  s_cselect_b32 s28, 2, 0
  s_cmp_lt_u32 s25, 63
  s_cselect_b32 s28, s28, 0
L_F1_epi:
  v_mul_f32 v52, s37, v36
  v_mul_f32 v53, s37, v37
  v_mul_f32 v54, s37, v38
  v_mul_f32 v55, s37, v39
  v_mul_f32 v56, s37, v40
  v_mul_f32 v57, s37, v41
  v_mul_f32 v58, s37, v42
  v_mul_f32 v59, s37, v43
  v_exp_f32 v52, v52
  v_exp_f32 v53, v53
  v_exp_f32 v54, v54
  v_exp_f32 v55, v55
  v_exp_f32 v56, v56
  v_exp_f32 v57, v57
  v_exp_f32 v58, v58
  v_exp_f32 v59, v59
  v_pk_mul_f32 v[36:37], v[36:37], v[44:45]
  v_pk_mul_f32 v[38:39], v[38:39], v[46:47]
  v_pk_mul_f32 v[40:41], v[40:41], v[48:49]
  v_pk_mul_f32 v[42:43], v[42:43], v[50:51]
  v_add_f32 v52, 1.0, v52
  v_add_f32 v53, 1.0, v53
  v_add_f32 v54, 1.0, v54
  v_add_f32 v55, 1.0, v55
  v_add_f32 v56, 1.0, v56
  v_add_f32 v57, 1.0, v57
  v_add_f32 v58, 1.0, v58
  v_add_f32 v59, 1.0, v59
  v_rcp_f32 v52, v52
  v_rcp_f32 v53, v53
  v_rcp_f32 v54, v54
  v_rcp_f32 v55, v55
  v_rcp_f32 v56, v56
  v_rcp_f32 v57, v57
  v_rcp_f32 v58, v58
  v_rcp_f32 v59, v59
  v_pk_mul_f32 v[36:37], v[36:37], v[52:53]
  v_pk_mul_f32 v[38:39], v[38:39], v[54:55]
  v_pk_mul_f32 v[40:41], v[40:41], v[56:57]
  v_pk_mul_f32 v[42:43], v[42:43], v[58:59]
  v_cvt_pk_bf16_f32 v60, v36, v37
  v_cvt_pk_bf16_f32 v61, v38, v39
  v_cvt_pk_bf16_f32 v62, v40, v41
  v_cvt_pk_bf16_f32 v63, v42, v43
  s_nop 0
  v_permlane32_swap_b32 v60, v62
  v_permlane32_swap_b32 v61, v63
  buffer_store_dwordx4 v[60:63], v68, s[4:7], s31 offen sc1
  s_add_u32 s25, s25, 1
  s_add_u32 s31, s31, 2097152
  s_xor_b32 s31, s31, 0x2000
  s_branch L_F1_top
L_F2:
  v_lshlrev_b32 v1, 4, v0
  s_lshl_b32 s32, s20, 12
  s_min_u32 s33, s32, 0x2000
  v_mov_b32 v69, v1
  v_add_u32 v70, 0x10000, v69
  s_load_dwordx2 s[8:9], s[0:1], 80
  s_mov_b32 s10, 7340032
  s_mov_b32 s11, 0x20000
  s_waitcnt lgkmcnt(0)
  s_lshr_b32 s44, s21, 3
  s_mul_i32 s44, s44, 2490368
  s_and_b32 s45, s21, 7
  s_lshl_b32 s45, s45, 8
  s_add_u32 s44, s44, s45
  s_add_u32 s45, s44, 128
  s_cmp_ge_u32 s21, 16
  s_cselect_b32 s40, 131072, 0
  s_sub_u32 s44, s44, s40
  s_sub_u32 s45, s45, s40
  v_bfe_u32 v4, v0, 5, 1
  v_mul_u32_u24 v4, 8192, v4
  v_bfe_u32 v5, v0, 4, 1
  v_mul_u32_u24 v5, 4096, v5
  v_add_u32 v4, v4, v5
  v_bfe_u32 v5, v0, 3, 1
  v_mul_u32_u24 v5, 2048, v5
  v_add_u32 v4, v4, v5
  v_lshrrev_b32 v5, 3, v0
  v_and_b32 v5, 6, v5
  v_xor_b32 v5, v5, v0
  v_and_b32 v5, 7, v5
  v_lshl_add_u32 v4, v5, 4, v4
  s_lshr_b32 s40, s20, 1
  s_mul_i32 s40, s40, 16384
  s_and_b32 s41, s20, 1
  s_mul_i32 s41, s41, 32768
  s_add_u32 s40, s40, s41
  v_add_u32 v4, s40, v4
  v_bfe_u32 v5, v0, 3, 2
  v_xor_b32 v5, s20, v5
  v_lshlrev_b32 v5, 5, v5
  v_lshrrev_b32 v6, 2, v0
  v_lshl_add_u32 v6, v6, 7, v5
  v_and_b32 v5, 3, v0
  v_lshl_add_u32 v6, v5, 3, v6
  v_add_u32 v7, 0x10000, v6
  v_add_u32 v8, s44, v4
  v_add_u32 v9, s45, v4
  s_lshl_b32 s41, s20, 10
  s_add_u32 m0, s41, 0
  s_mov_b32 s42, 0
  buffer_load_dwordx4 v8, s[8:11], s42 offen nt lds
  s_add_u32 m0, s41, 4096
  s_mov_b32 s42, 0
  buffer_load_dwordx4 v9, s[8:11], s42 offen nt lds
  s_add_u32 m0, s41, 8192
  s_mov_b32 s42, 65536
  buffer_load_dwordx4 v8, s[8:11], s42 offen nt lds
  s_add_u32 m0, s41, 12288
  s_mov_b32 s42, 65536
  buffer_load_dwordx4 v9, s[8:11], s42 offen nt lds
  s_add_u32 m0, s41, 16384
  s_mov_b32 s42, 131072
  buffer_load_dwordx4 v8, s[8:11], s42 offen nt lds
  s_add_u32 m0, s41, 20480
  s_mov_b32 s42, 131072
  buffer_load_dwordx4 v9, s[8:11], s42 offen nt lds
  s_add_u32 m0, s41, 24576
  s_mov_b32 s42, 196608
  buffer_load_dwordx4 v8, s[8:11], s42 offen nt lds
  s_add_u32 m0, s41, 28672
  s_mov_b32 s42, 196608
  buffer_load_dwordx4 v9, s[8:11], s42 offen nt lds
  s_add_u32 m0, s41, 32768
  s_mov_b32 s42, 262144
  buffer_load_dwordx4 v8, s[8:11], s42 offen nt lds
  s_add_u32 m0, s41, 36864
  s_mov_b32 s42, 262144
  buffer_load_dwordx4 v9, s[8:11], s42 offen nt lds
  s_add_u32 m0, s41, 40960
  s_mov_b32 s42, 327680
  buffer_load_dwordx4 v8, s[8:11], s42 offen nt lds
  s_add_u32 m0, s41, 45056
  s_mov_b32 s42, 327680
  buffer_load_dwordx4 v9, s[8:11], s42 offen nt lds
  s_add_u32 m0, s41, 49152
  s_mov_b32 s42, 393216
  buffer_load_dwordx4 v8, s[8:11], s42 offen nt lds
  s_add_u32 m0, s41, 53248
  s_mov_b32 s42, 393216
  buffer_load_dwordx4 v9, s[8:11], s42 offen nt lds
  s_add_u32 m0, s41, 57344
  s_mov_b32 s42, 458752
  buffer_load_dwordx4 v8, s[8:11], s42 offen nt lds
  s_add_u32 m0, s41, 61440
  s_mov_b32 s42, 458752
  buffer_load_dwordx4 v9, s[8:11], s42 offen nt lds
  s_add_u32 m0, s41, 65536
  s_mov_b32 s42, 524288
  buffer_load_dwordx4 v8, s[8:11], s42 offen nt lds
  s_add_u32 m0, s41, 69632
  s_mov_b32 s42, 524288
  buffer_load_dwordx4 v9, s[8:11], s42 offen nt lds
  s_add_u32 m0, s41, 73728
  s_mov_b32 s42, 589824
  buffer_load_dwordx4 v8, s[8:11], s42 offen nt lds
  s_add_u32 m0, s41, 77824
  s_mov_b32 s42, 589824
  buffer_load_dwordx4 v9, s[8:11], s42 offen nt lds
  s_add_u32 m0, s41, 81920
  s_mov_b32 s42, 655360
  buffer_load_dwordx4 v8, s[8:11], s42 offen nt lds
  s_add_u32 m0, s41, 86016
  s_mov_b32 s42, 655360
  buffer_load_dwordx4 v9, s[8:11], s42 offen nt lds
  s_add_u32 m0, s41, 90112
  s_mov_b32 s42, 720896
  buffer_load_dwordx4 v8, s[8:11], s42 offen nt lds
  s_add_u32 m0, s41, 94208
  s_mov_b32 s42, 720896
  buffer_load_dwordx4 v9, s[8:11], s42 offen nt lds
  s_add_u32 m0, s41, 98304
  s_mov_b32 s42, 786432
  buffer_load_dwordx4 v8, s[8:11], s42 offen nt lds
  s_add_u32 m0, s41, 102400
  s_mov_b32 s42, 786432
  buffer_load_dwordx4 v9, s[8:11], s42 offen nt lds
  s_add_u32 m0, s41, 106496
  s_mov_b32 s42, 851968
  buffer_load_dwordx4 v8, s[8:11], s42 offen nt lds
  s_add_u32 m0, s41, 110592
  s_mov_b32 s42, 851968
  buffer_load_dwordx4 v9, s[8:11], s42 offen nt lds
  s_waitcnt vmcnt(24) lgkmcnt(0)
  s_barrier
  s_add_u32 m0, s41, 114688
  s_mov_b32 s42, 917504
  buffer_load_dwordx4 v8, s[8:11], s42 offen nt lds
  s_add_u32 m0, s41, 118784
  s_mov_b32 s42, 917504
  buffer_load_dwordx4 v9, s[8:11], s42 offen nt lds
  s_add_u32 m0, s41, 122880
  s_mov_b32 s42, 983040
  buffer_load_dwordx4 v8, s[8:11], s42 offen nt lds
  s_add_u32 m0, s41, 126976
  s_mov_b32 s42, 983040
  buffer_load_dwordx4 v9, s[8:11], s42 offen nt lds
  ds_read_b64_tr_b16 a[0:1], v6 offset:0
  ds_read_b64_tr_b16 a[2:3], v6 offset:2048
  ds_read_b64_tr_b16 a[152:153], v6 offset:4096
  ds_read_b64_tr_b16 a[154:155], v6 offset:6144
  ds_read_b64_tr_b16 a[4:5], v6 offset:8192
  ds_read_b64_tr_b16 a[6:7], v6 offset:10240
  ds_read_b64_tr_b16 a[156:157], v6 offset:12288
  ds_read_b64_tr_b16 a[158:159], v6 offset:14336
  s_waitcnt vmcnt(24) lgkmcnt(0)
  s_barrier
  s_add_u32 m0, s41, 0
  s_mov_b32 s42, 1048576
  buffer_load_dwordx4 v8, s[8:11], s42 offen nt lds
  s_add_u32 m0, s41, 4096
  s_mov_b32 s42, 1048576
  buffer_load_dwordx4 v9, s[8:11], s42 offen nt lds
  s_add_u32 m0, s41, 8192
  s_mov_b32 s42, 1114112
  buffer_load_dwordx4 v8, s[8:11], s42 offen nt lds
  s_add_u32 m0, s41, 12288
  s_mov_b32 s42, 1114112
  buffer_load_dwordx4 v9, s[8:11], s42 offen nt lds
  ds_read_b64_tr_b16 a[8:9], v6 offset:16384
  ds_read_b64_tr_b16 a[10:11], v6 offset:18432
  ds_read_b64_tr_b16 a[160:161], v6 offset:20480
  ds_read_b64_tr_b16 a[162:163], v6 offset:22528
  ds_read_b64_tr_b16 a[12:13], v6 offset:24576
  ds_read_b64_tr_b16 a[14:15], v6 offset:26624
  ds_read_b64_tr_b16 a[164:165], v6 offset:28672
  ds_read_b64_tr_b16 a[166:167], v6 offset:30720
  s_waitcnt vmcnt(24) lgkmcnt(0)
  s_barrier
  s_add_u32 m0, s41, 16384
  s_mov_b32 s42, 1179648
  buffer_load_dwordx4 v8, s[8:11], s42 offen nt lds
  s_add_u32 m0, s41, 20480
  s_mov_b32 s42, 1179648
  buffer_load_dwordx4 v9, s[8:11], s42 offen nt lds
  s_add_u32 m0, s41, 24576
  s_mov_b32 s42, 1245184
  buffer_load_dwordx4 v8, s[8:11], s42 offen nt lds
  s_add_u32 m0, s41, 28672
  s_mov_b32 s42, 1245184
  buffer_load_dwordx4 v9, s[8:11], s42 offen nt lds
  ds_read_b64_tr_b16 a[16:17], v6 offset:32768
  ds_read_b64_tr_b16 a[18:19], v6 offset:34816
  ds_read_b64_tr_b16 a[168:169], v6 offset:36864
  ds_read_b64_tr_b16 a[170:171], v6 offset:38912
  ds_read_b64_tr_b16 a[20:21], v6 offset:40960
  ds_read_b64_tr_b16 a[22:23], v6 offset:43008
  ds_read_b64_tr_b16 a[172:173], v6 offset:45056
  ds_read_b64_tr_b16 a[174:175], v6 offset:47104
  s_waitcnt vmcnt(24) lgkmcnt(0)
  s_barrier
  s_add_u32 m0, s41, 32768
  s_mov_b32 s42, 1310720
  buffer_load_dwordx4 v8, s[8:11], s42 offen nt lds
  s_add_u32 m0, s41, 36864
  s_mov_b32 s42, 1310720
  buffer_load_dwordx4 v9, s[8:11], s42 offen nt lds
  s_add_u32 m0, s41, 40960
  s_mov_b32 s42, 1376256
  buffer_load_dwordx4 v8, s[8:11], s42 offen nt lds
  s_add_u32 m0, s41, 45056
  s_mov_b32 s42, 1376256
  buffer_load_dwordx4 v9, s[8:11], s42 offen nt lds
  ds_read_b64_tr_b16 a[24:25], v6 offset:49152
  ds_read_b64_tr_b16 a[26:27], v6 offset:51200
  ds_read_b64_tr_b16 a[176:177], v6 offset:53248
  ds_read_b64_tr_b16 a[178:179], v6 offset:55296
  ds_read_b64_tr_b16 a[28:29], v6 offset:57344
  ds_read_b64_tr_b16 a[30:31], v6 offset:59392
  ds_read_b64_tr_b16 a[180:181], v6 offset:61440
  ds_read_b64_tr_b16 a[182:183], v6 offset:63488
  s_waitcnt vmcnt(24) lgkmcnt(0)
  s_barrier
  s_add_u32 m0, s41, 49152
  s_mov_b32 s42, 1441792
  buffer_load_dwordx4 v8, s[8:11], s42 offen nt lds
  s_add_u32 m0, s41, 53248
  s_mov_b32 s42, 1441792
  buffer_load_dwordx4 v9, s[8:11], s42 offen nt lds
  s_add_u32 m0, s41, 57344
  s_mov_b32 s42, 1507328
  buffer_load_dwordx4 v8, s[8:11], s42 offen nt lds
  s_add_u32 m0, s41, 61440
  s_mov_b32 s42, 1507328
  buffer_load_dwordx4 v9, s[8:11], s42 offen nt lds
  ds_read_b64_tr_b16 a[32:33], v7 offset:0
  ds_read_b64_tr_b16 a[34:35], v7 offset:2048
  ds_read_b64_tr_b16 a[184:185], v7 offset:4096
  ds_read_b64_tr_b16 a[186:187], v7 offset:6144
  ds_read_b64_tr_b16 a[36:37], v7 offset:8192
  ds_read_b64_tr_b16 a[38:39], v7 offset:10240
  ds_read_b64_tr_b16 a[188:189], v7 offset:12288
  ds_read_b64_tr_b16 a[190:191], v7 offset:14336
  s_waitcnt vmcnt(24) lgkmcnt(0)
  s_barrier
  s_add_u32 m0, s41, 65536
  s_mov_b32 s42, 1572864
  buffer_load_dwordx4 v8, s[8:11], s42 offen nt lds
  s_add_u32 m0, s41, 69632
  s_mov_b32 s42, 1572864
  buffer_load_dwordx4 v9, s[8:11], s42 offen nt lds
  s_add_u32 m0, s41, 73728
  s_mov_b32 s42, 1638400
  buffer_load_dwordx4 v8, s[8:11], s42 offen nt lds
  s_add_u32 m0, s41, 77824
  s_mov_b32 s42, 1638400
  buffer_load_dwordx4 v9, s[8:11], s42 offen nt lds
  ds_read_b64_tr_b16 a[40:41], v7 offset:16384
  ds_read_b64_tr_b16 a[42:43], v7 offset:18432
  ds_read_b64_tr_b16 a[192:193], v7 offset:20480
  ds_read_b64_tr_b16 a[194:195], v7 offset:22528
  ds_read_b64_tr_b16 a[44:45], v7 offset:24576
  ds_read_b64_tr_b16 a[46:47], v7 offset:26624
  ds_read_b64_tr_b16 a[196:197], v7 offset:28672
  ds_read_b64_tr_b16 a[198:199], v7 offset:30720
  s_waitcnt vmcnt(24) lgkmcnt(0)
  s_barrier
  s_add_u32 m0, s41, 81920
  s_mov_b32 s42, 1703936
  buffer_load_dwordx4 v8, s[8:11], s42 offen nt lds
  s_add_u32 m0, s41, 86016
  s_mov_b32 s42, 1703936
  buffer_load_dwordx4 v9, s[8:11], s42 offen nt lds
  s_add_u32 m0, s41, 90112
  s_mov_b32 s42, 1769472
  buffer_load_dwordx4 v8, s[8:11], s42 offen nt lds
  s_add_u32 m0, s41, 94208
  s_mov_b32 s42, 1769472
  buffer_load_dwordx4 v9, s[8:11], s42 offen nt lds
  ds_read_b64_tr_b16 a[48:49], v7 offset:32768
  ds_read_b64_tr_b16 a[50:51], v7 offset:34816
  ds_read_b64_tr_b16 a[200:201], v7 offset:36864
  ds_read_b64_tr_b16 a[202:203], v7 offset:38912
  ds_read_b64_tr_b16 a[52:53], v7 offset:40960
  ds_read_b64_tr_b16 a[54:55], v7 offset:43008
  ds_read_b64_tr_b16 a[204:205], v7 offset:45056
  ds_read_b64_tr_b16 a[206:207], v7 offset:47104
  s_waitcnt vmcnt(24) lgkmcnt(0)
  s_barrier
  s_add_u32 m0, s41, 98304
  s_mov_b32 s42, 1835008
  buffer_load_dwordx4 v8, s[8:11], s42 offen nt lds
  s_add_u32 m0, s41, 102400
  s_mov_b32 s42, 1835008
  buffer_load_dwordx4 v9, s[8:11], s42 offen nt lds
  s_add_u32 m0, s41, 106496
  s_mov_b32 s42, 1900544
  buffer_load_dwordx4 v8, s[8:11], s42 offen nt lds
  s_add_u32 m0, s41, 110592
  s_mov_b32 s42, 1900544
  buffer_load_dwordx4 v9, s[8:11], s42 offen nt lds
  ds_read_b64_tr_b16 a[56:57], v7 offset:49152
  ds_read_b64_tr_b16 a[58:59], v7 offset:51200
  ds_read_b64_tr_b16 a[208:209], v7 offset:53248
  ds_read_b64_tr_b16 a[210:211], v7 offset:55296
  ds_read_b64_tr_b16 a[60:61], v7 offset:57344
  ds_read_b64_tr_b16 a[62:63], v7 offset:59392
  ds_read_b64_tr_b16 a[212:213], v7 offset:61440
  ds_read_b64_tr_b16 a[214:215], v7 offset:63488
  s_waitcnt vmcnt(24) lgkmcnt(0)
  s_barrier
  s_add_u32 m0, s41, 114688
  s_mov_b32 s42, 1966080
  buffer_load_dwordx4 v8, s[8:11], s42 offen nt lds
  s_add_u32 m0, s41, 118784
  s_mov_b32 s42, 1966080
  buffer_load_dwordx4 v9, s[8:11], s42 offen nt lds
  s_add_u32 m0, s41, 122880
  s_mov_b32 s42, 2031616
  buffer_load_dwordx4 v8, s[8:11], s42 offen nt lds
  s_add_u32 m0, s41, 126976
  s_mov_b32 s42, 2031616
  buffer_load_dwordx4 v9, s[8:11], s42 offen nt lds
  ds_read_b64_tr_b16 a[64:65], v6 offset:0
  ds_read_b64_tr_b16 a[66:67], v6 offset:2048
  ds_read_b64_tr_b16 a[216:217], v6 offset:4096
  ds_read_b64_tr_b16 a[218:219], v6 offset:6144
  ds_read_b64_tr_b16 a[68:69], v6 offset:8192
  ds_read_b64_tr_b16 a[70:71], v6 offset:10240
  ds_read_b64_tr_b16 a[220:221], v6 offset:12288
  ds_read_b64_tr_b16 a[222:223], v6 offset:14336
  s_waitcnt vmcnt(24) lgkmcnt(0)
  s_barrier
  s_add_u32 m0, s41, 0
  s_mov_b32 s42, 2097152
  buffer_load_dwordx4 v8, s[8:11], s42 offen nt lds
  s_add_u32 m0, s41, 4096
  s_mov_b32 s42, 2097152
  buffer_load_dwordx4 v9, s[8:11], s42 offen nt lds
  s_add_u32 m0, s41, 8192
  s_mov_b32 s42, 2162688
  buffer_load_dwordx4 v8, s[8:11], s42 offen nt lds
  s_add_u32 m0, s41, 12288
  s_mov_b32 s42, 2162688
  buffer_load_dwordx4 v9, s[8:11], s42 offen nt lds
  ds_read_b64_tr_b16 a[72:73], v6 offset:16384
  ds_read_b64_tr_b16 a[74:75], v6 offset:18432
  ds_read_b64_tr_b16 a[224:225], v6 offset:20480
  ds_read_b64_tr_b16 a[226:227], v6 offset:22528
  ds_read_b64_tr_b16 a[76:77], v6 offset:24576
  ds_read_b64_tr_b16 a[78:79], v6 offset:26624
  ds_read_b64_tr_b16 a[228:229], v6 offset:28672
  ds_read_b64_tr_b16 a[230:231], v6 offset:30720
  s_waitcnt vmcnt(24) lgkmcnt(0)
  s_barrier
  s_add_u32 m0, s41, 16384
  s_mov_b32 s42, 2228224
  buffer_load_dwordx4 v8, s[8:11], s42 offen nt lds
  s_add_u32 m0, s41, 20480
  s_mov_b32 s42, 2228224
  buffer_load_dwordx4 v9, s[8:11], s42 offen nt lds
  s_add_u32 m0, s41, 24576
  s_mov_b32 s42, 2293760
  buffer_load_dwordx4 v8, s[8:11], s42 offen nt lds
  s_add_u32 m0, s41, 28672
  s_mov_b32 s42, 2293760
  buffer_load_dwordx4 v9, s[8:11], s42 offen nt lds
  ds_read_b64_tr_b16 a[80:81], v6 offset:32768
  ds_read_b64_tr_b16 a[82:83], v6 offset:34816
  ds_read_b64_tr_b16 a[232:233], v6 offset:36864
  ds_read_b64_tr_b16 a[234:235], v6 offset:38912
  ds_read_b64_tr_b16 a[84:85], v6 offset:40960
  ds_read_b64_tr_b16 a[86:87], v6 offset:43008
  ds_read_b64_tr_b16 a[236:237], v6 offset:45056
  ds_read_b64_tr_b16 a[238:239], v6 offset:47104
  s_waitcnt vmcnt(24) lgkmcnt(0)
  s_barrier
  s_add_u32 m0, s41, 32768
  s_mov_b32 s42, 2359296
  buffer_load_dwordx4 v8, s[8:11], s42 offen nt lds
  s_add_u32 m0, s41, 36864
  s_mov_b32 s42, 2359296
  buffer_load_dwordx4 v9, s[8:11], s42 offen nt lds
  s_add_u32 m0, s41, 40960
  s_mov_b32 s42, 2424832
  buffer_load_dwordx4 v8, s[8:11], s42 offen nt lds
  s_add_u32 m0, s41, 45056
  s_mov_b32 s42, 2424832
  buffer_load_dwordx4 v9, s[8:11], s42 offen nt lds
  ds_read_b64_tr_b16 a[88:89], v6 offset:49152
  ds_read_b64_tr_b16 a[90:91], v6 offset:51200
  ds_read_b64_tr_b16 a[240:241], v6 offset:53248
  ds_read_b64_tr_b16 a[242:243], v6 offset:55296
  ds_read_b64_tr_b16 a[92:93], v6 offset:57344
  ds_read_b64_tr_b16 a[94:95], v6 offset:59392
  ds_read_b64_tr_b16 a[244:245], v6 offset:61440
  ds_read_b64_tr_b16 a[246:247], v6 offset:63488
  s_waitcnt vmcnt(24) lgkmcnt(0)
  s_barrier
  ds_read_b64_tr_b16 a[96:97], v7 offset:0
  ds_read_b64_tr_b16 a[98:99], v7 offset:2048
  ds_read_b64_tr_b16 a[248:249], v7 offset:4096
  ds_read_b64_tr_b16 a[250:251], v7 offset:6144
  ds_read_b64_tr_b16 a[100:101], v7 offset:8192
  ds_read_b64_tr_b16 a[102:103], v7 offset:10240
  ds_read_b64_tr_b16 a[252:253], v7 offset:12288
  ds_read_b64_tr_b16 a[254:255], v7 offset:14336
  s_waitcnt vmcnt(20) lgkmcnt(0)
  s_barrier
  ds_read_b64_tr_b16 a[104:105], v7 offset:16384
  ds_read_b64_tr_b16 a[106:107], v7 offset:18432
  ds_read_b64_tr_b16 v[128:129], v7 offset:20480
  ds_read_b64_tr_b16 v[130:131], v7 offset:22528
  ds_read_b64_tr_b16 a[108:109], v7 offset:24576
  ds_read_b64_tr_b16 a[110:111], v7 offset:26624
  ds_read_b64_tr_b16 v[132:133], v7 offset:28672
  ds_read_b64_tr_b16 v[134:135], v7 offset:30720
  s_waitcnt vmcnt(16) lgkmcnt(0)
  s_barrier
  ds_read_b64_tr_b16 a[112:113], v7 offset:32768
  ds_read_b64_tr_b16 a[114:115], v7 offset:34816
  ds_read_b64_tr_b16 v[136:137], v7 offset:36864
  ds_read_b64_tr_b16 v[138:139], v7 offset:38912
  ds_read_b64_tr_b16 a[116:117], v7 offset:40960
  ds_read_b64_tr_b16 a[118:119], v7 offset:43008
  ds_read_b64_tr_b16 v[140:141], v7 offset:45056
  ds_read_b64_tr_b16 v[142:143], v7 offset:47104
  s_waitcnt vmcnt(12) lgkmcnt(0)
  s_barrier
  ds_read_b64_tr_b16 a[120:121], v7 offset:49152
  ds_read_b64_tr_b16 a[122:123], v7 offset:51200
  ds_read_b64_tr_b16 v[144:145], v7 offset:53248
  ds_read_b64_tr_b16 v[146:147], v7 offset:55296
  ds_read_b64_tr_b16 a[124:125], v7 offset:57344
  ds_read_b64_tr_b16 a[126:127], v7 offset:59392
  ds_read_b64_tr_b16 v[148:149], v7 offset:61440
  ds_read_b64_tr_b16 v[150:151], v7 offset:63488
  s_waitcnt vmcnt(8) lgkmcnt(0)
  s_barrier
  ds_read_b64_tr_b16 a[128:129], v6 offset:0
  ds_read_b64_tr_b16 a[130:131], v6 offset:2048
  ds_read_b64_tr_b16 v[152:153], v6 offset:4096
  ds_read_b64_tr_b16 v[154:155], v6 offset:6144
  ds_read_b64_tr_b16 a[132:133], v6 offset:8192
  ds_read_b64_tr_b16 a[134:135], v6 offset:10240
  ds_read_b64_tr_b16 v[156:157], v6 offset:12288
  ds_read_b64_tr_b16 v[158:159], v6 offset:14336
  s_waitcnt vmcnt(4) lgkmcnt(0)
  s_barrier
  ds_read_b64_tr_b16 a[136:137], v6 offset:16384
  ds_read_b64_tr_b16 a[138:139], v6 offset:18432
  ds_read_b64_tr_b16 v[160:161], v6 offset:20480
  ds_read_b64_tr_b16 v[162:163], v6 offset:22528
  ds_read_b64_tr_b16 a[140:141], v6 offset:24576
  ds_read_b64_tr_b16 a[142:143], v6 offset:26624
  ds_read_b64_tr_b16 v[164:165], v6 offset:28672
  ds_read_b64_tr_b16 v[166:167], v6 offset:30720
  s_waitcnt vmcnt(0) lgkmcnt(0)
  s_barrier
  ds_read_b64_tr_b16 a[144:145], v6 offset:32768
  ds_read_b64_tr_b16 a[146:147], v6 offset:34816
  ds_read_b64_tr_b16 v[168:169], v6 offset:36864
  ds_read_b64_tr_b16 v[170:171], v6 offset:38912
  ds_read_b64_tr_b16 a[148:149], v6 offset:40960
  ds_read_b64_tr_b16 a[150:151], v6 offset:43008
  ds_read_b64_tr_b16 v[172:173], v6 offset:45056
  ds_read_b64_tr_b16 v[174:175], v6 offset:47104
  s_waitcnt lgkmcnt(0)
  s_barrier
  s_cmp_lt_u32 s21, 16
  s_cbranch_scc1 L_F2_keep
  v_accvgpr_write_b32 a0, 0
  v_accvgpr_write_b32 a1, 0
  v_accvgpr_write_b32 a2, 0
  v_accvgpr_write_b32 a3, 0
  v_accvgpr_write_b32 a4, 0
  v_accvgpr_write_b32 a5, 0
  v_accvgpr_write_b32 a6, 0
  v_accvgpr_write_b32 a7, 0
  v_accvgpr_write_b32 a152, 0
  v_accvgpr_write_b32 a153, 0
  v_accvgpr_write_b32 a154, 0
  v_accvgpr_write_b32 a155, 0
  v_accvgpr_write_b32 a156, 0
  v_accvgpr_write_b32 a157, 0
  v_accvgpr_write_b32 a158, 0
  v_accvgpr_write_b32 a159, 0
  s_nop 1
L_F2_keep:
  v_min_u32 v52, 63, v0
  v_lshlrev_b32 v52, 7, v52
  v_add_u32 v52, 1424384, v52
  s_nop 1
Lpoll_48:
  buffer_load_dword v53, v52, s[4:7], 0 offen sc1
  s_sub_u32 s24, s24, 1
  s_cbranch_scc1 L_FAIL
  s_waitcnt vmcnt(0)
  v_cmp_gt_i32 vcc, 0, v53
  s_cbranch_vccz Lpolld_49
  s_sleep 1
  s_branch Lpoll_48
Lpolld_49:
  v_lshrrev_b32 v53, 8, v53
  v_and_b32 v54, 3, v0
  v_lshl_or_b32 v53, v53, 2, v54
  s_nop 1
  v_min_u32_dpp v53, v53, v53 row_ror:8 row_mask:0xf bank_mask:0xf
  s_nop 1
  v_min_u32_dpp v53, v53, v53 row_ror:4 row_mask:0xf bank_mask:0xf
  v_mov_b32 v54, v53
  s_nop 1
  v_permlane16_swap_b32 v54, v53
  v_min_u32 v53, v53, v54
  v_mov_b32 v54, v53
  s_nop 1
  v_permlane32_swap_b32 v54, v53
  v_min_u32 v53, v53, v54
  s_nop 1
  v_min_u32_dpp v53, v53, v53 row_ror:2 row_mask:0xf bank_mask:0xf
  s_nop 1
  v_min_u32_dpp v53, v53, v53 row_ror:1 row_mask:0xf bank_mask:0xf
  s_nop 0
  v_readfirstlane_b32 s38, v53
  s_and_b32 s38, s38, 3
  s_lshl_b32 s38, s38, 13
  s_and_b32 s38, s38, 0x2000
  s_xor_b32 s38, s38, 16785408
  s_lshr_b32 s43, s21, 3
  s_mul_i32 s43, s43, 19
  s_min_u32 s43, s43, 37
  v_min_u32 v2, 18, v0
  v_add_u32 v2, s43, v2
  v_lshlrev_b32 v2, 7, v2
  v_add_u32 v2, 1414144, v2
  s_add_u32 s44, s43, s20
  s_min_u32 s45, s20, 2
  s_add_u32 s45, s45, s43
  s_lshr_b32 s40, s44, 1
  s_lshl_b32 s40, s40, 14
  s_and_b32 s41, s44, 1
  s_lshl_b32 s41, s41, 12
  s_add_u32 s27, s40, s41
  s_lshr_b32 s40, s45, 1
  s_lshl_b32 s40, s40, 14
  s_and_b32 s41, s45, 1
  s_lshl_b32 s41, s41, 12
  s_add_u32 s39, s40, s41
  s_sub_u32 s39, s39, s27
  s_add_u32 s27, s27, s38
  s_add_u32 s27, s27, 1179648
  s_lshl_b32 s62, s21, 7
  s_add_u32 s62, s62, 1421312
  s_lshl_b32 s40, s21, 14
  s_add_u32 s40, s40, s38
  s_add_u32 s31, s40, 524288
  s_lshl_b32 s40, s20, 11
  v_and_b32 v68, 3, v0
  v_lshlrev_b32 v68, 4, v68
  v_lshrrev_b32 v52, 4, v0
  v_lshl_add_u32 v68, v52, 6, v68
  v_bfe_u32 v52, v0, 2, 2
  v_lshl_add_u32 v68, v52, 8, v68
  v_add_u32 v68, s40, v68
  v_lshlrev_b32 v71, 2, v0
  v_add_u32 v71, 155648, v71
  s_mov_b32 s25, 0
  s_mov_b32 s26, 0
  s_mov_b32 s29, 1
  s_mov_b32 s30, 0
  s_mov_b32 s28, 0
L_F2_top:
  s_cmp_eq_u32 s28, 1
  s_cbranch_scc1 L_F2_go
  s_cmp_eq_u32 s28, 2
  s_cbranch_scc1 L_F2_mid
  s_cmp_lg_u32 s20, 0
  s_cbranch_scc1 L_F2_park
  buffer_load_dword v3, v2, s[4:7], s30 offen sc1
  s_waitcnt vmcnt(1)
  s_barrier
  s_mov_b32 s63, s25
  s_atomic_smax s63, s[4:5], s62 glc
Lnosig_50:
  s_cmp_ge_u32 s25, 64
  s_cbranch_scc1 L_END
  s_waitcnt vmcnt(0)
  v_cmp_gt_i32 vcc, s29, v3
  s_cbranch_vccz L_F2_issue
  s_nop 3
Lpoll_51:
  buffer_load_dword v3, v2, s[4:7], s30 offen sc1
  s_sub_u32 s24, s24, 1
  s_cbranch_scc1 L_FAIL
  s_waitcnt vmcnt(0)
  v_cmp_gt_i32 vcc, s29, v3
  s_cbranch_vccz Lpolld_52
  s_sleep 1
  s_branch Lpoll_51
Lpolld_52:
  s_branch L_F2_issue
L_F2_park:
  s_waitcnt vmcnt(0)
  s_barrier
  s_cmp_ge_u32 s25, 64
  s_cbranch_scc1 L_END
L_F2_issue:
  s_barrier
L_F2_mid:
  s_mov_b32 s34, s26
  s_mov_b32 s35, s27
  s_add_u32 s36, s32, 0
  s_add_u32 m0, s34, s36
  s_add_u32 s36, s35, 0
  buffer_load_dwordx4 v1, s[4:7], s36 offen offset:0 sc1 lds
  s_nop 0
  buffer_load_dwordx4 v1, s[4:7], s36 offen offset:1024 sc1 lds
  s_nop 0
  buffer_load_dwordx4 v1, s[4:7], s36 offen offset:2048 sc1 lds
  s_nop 0
  buffer_load_dwordx4 v1, s[4:7], s36 offen offset:3072 sc1 lds
  s_nop 0
  s_add_u32 s36, s32, 16384
  s_add_u32 m0, s34, s36
  s_add_u32 s36, s35, 32768
  buffer_load_dwordx4 v1, s[4:7], s36 offen offset:0 sc1 lds
  s_nop 0
  buffer_load_dwordx4 v1, s[4:7], s36 offen offset:1024 sc1 lds
  s_nop 0
  buffer_load_dwordx4 v1, s[4:7], s36 offen offset:2048 sc1 lds
  s_nop 0
  buffer_load_dwordx4 v1, s[4:7], s36 offen offset:3072 sc1 lds
  s_nop 0
  s_add_u32 s36, s32, 32768
  s_add_u32 m0, s34, s36
  s_add_u32 s36, s35, 65536
  buffer_load_dwordx4 v1, s[4:7], s36 offen offset:0 sc1 lds
  s_nop 0
  buffer_load_dwordx4 v1, s[4:7], s36 offen offset:1024 sc1 lds
  s_nop 0
  buffer_load_dwordx4 v1, s[4:7], s36 offen offset:2048 sc1 lds
  s_nop 0
  buffer_load_dwordx4 v1, s[4:7], s36 offen offset:3072 sc1 lds
  s_nop 0
  s_cmp_eq_u32 s28, 0
  s_cbranch_scc1 L_F2_go
  s_mov_b32 s28, 0
  s_waitcnt vmcnt(12)
  s_barrier
  s_cmp_lg_u32 s20, 0
  s_cbranch_scc1 Lnosig_53
  s_mov_b32 s63, s25
  s_atomic_smax s63, s[4:5], s62 glc
Lnosig_53:
L_F2_go:
  v_add_u32 v73, s26, v69
  v_add_u32 v74, s26, v70
  s_sub_u32 s26, 77824, s26
  s_add_u32 s27, s27, 2097152
  s_xor_b32 s27, s27, 0x2000
  s_add_u32 s29, s29, 1
  s_waitcnt vmcnt(8)
  s_barrier
  ds_read_b128 v[4:7], v73 offset:0
  ds_read_b128 v[8:11], v73 offset:1024
  ds_read_b128 v[12:15], v73 offset:2048
  ds_read_b128 v[16:19], v73 offset:3072
  ds_read_b128 v[20:23], v73 offset:4096
  ds_read_b128 v[24:27], v73 offset:5120
  s_waitcnt lgkmcnt(4)
  v_mfma_f32_16x16x32_bf16 v[36:39], a[0:3], v[4:7], 0
  ds_read_b128 v[28:31], v73 offset:6144
  v_mfma_f32_16x16x32_bf16 v[40:43], a[0:3], v[8:11], 0
  ds_read_b128 v[32:35], v73 offset:7168
  v_mfma_f32_16x16x32_bf16 v[44:47], a[152:155], v[4:7], 0
  s_add_u32 s36, s32, 49152
  s_add_u32 m0, s34, s36
  s_add_u32 s36, s35, 98304
  buffer_load_dwordx4 v1, s[4:7], s36 offen offset:0 sc1 lds
  v_mfma_f32_16x16x32_bf16 v[48:51], a[152:155], v[8:11], 0
  buffer_load_dwordx4 v1, s[4:7], s36 offen offset:1024 sc1 lds
  s_waitcnt lgkmcnt(4)
  v_mfma_f32_16x16x32_bf16 v[36:39], a[4:7], v[12:15], v[36:39]
  ds_read_b128 v[4:7], v73 offset:8192
  v_mfma_f32_16x16x32_bf16 v[40:43], a[4:7], v[16:19], v[40:43]
  ds_read_b128 v[8:11], v73 offset:9216
  v_mfma_f32_16x16x32_bf16 v[44:47], a[156:159], v[12:15], v[44:47]
  buffer_load_dwordx4 v1, s[4:7], s36 offen offset:2048 sc1 lds
  v_mfma_f32_16x16x32_bf16 v[48:51], a[156:159], v[16:19], v[48:51]
  buffer_load_dwordx4 v1, s[4:7], s36 offen offset:3072 sc1 lds
  s_waitcnt lgkmcnt(4)
  v_mfma_f32_16x16x32_bf16 v[36:39], a[8:11], v[20:23], v[36:39]
  ds_read_b128 v[12:15], v73 offset:10240
  v_mfma_f32_16x16x32_bf16 v[40:43], a[8:11], v[24:27], v[40:43]
  ds_read_b128 v[16:19], v73 offset:11264
  v_mfma_f32_16x16x32_bf16 v[44:47], a[160:163], v[20:23], v[44:47]
  s_add_u32 s36, s33, 65536
  s_add_u32 m0, s34, s36
  s_add_u32 s36, s35, 131072
  s_add_u32 s36, s36, s39
  buffer_load_dwordx4 v1, s[4:7], s36 offen offset:0 sc1 lds
  v_mfma_f32_16x16x32_bf16 v[48:51], a[160:163], v[24:27], v[48:51]
  buffer_load_dwordx4 v1, s[4:7], s36 offen offset:1024 sc1 lds
  s_waitcnt lgkmcnt(4)
  v_mfma_f32_16x16x32_bf16 v[36:39], a[12:15], v[28:31], v[36:39]
  ds_read_b128 v[20:23], v73 offset:12288
  v_mfma_f32_16x16x32_bf16 v[40:43], a[12:15], v[32:35], v[40:43]
  ds_read_b128 v[24:27], v73 offset:13312
  v_mfma_f32_16x16x32_bf16 v[44:47], a[164:167], v[28:31], v[44:47]
  buffer_load_dwordx4 v1, s[4:7], s36 offen offset:2048 sc1 lds
  v_mfma_f32_16x16x32_bf16 v[48:51], a[164:167], v[32:35], v[48:51]
  buffer_load_dwordx4 v1, s[4:7], s36 offen offset:3072 sc1 lds
  s_waitcnt lgkmcnt(4)
  v_mfma_f32_16x16x32_bf16 v[36:39], a[16:19], v[4:7], v[36:39]
  ds_read_b128 v[28:31], v73 offset:14336
  v_mfma_f32_16x16x32_bf16 v[40:43], a[16:19], v[8:11], v[40:43]
  ds_read_b128 v[32:35], v73 offset:15360
  v_mfma_f32_16x16x32_bf16 v[44:47], a[168:171], v[4:7], v[44:47]
  v_mfma_f32_16x16x32_bf16 v[48:51], a[168:171], v[8:11], v[48:51]
  s_waitcnt vmcnt(12)
  s_barrier
  s_mov_b32 s34, s26
  s_mov_b32 s35, s27
  s_waitcnt lgkmcnt(4)
  v_mfma_f32_16x16x32_bf16 v[36:39], a[20:23], v[12:15], v[36:39]
  ds_read_b128 v[4:7], v73 offset:16384
  v_mfma_f32_16x16x32_bf16 v[40:43], a[20:23], v[16:19], v[40:43]
  ds_read_b128 v[8:11], v73 offset:17408
  v_mfma_f32_16x16x32_bf16 v[44:47], a[172:175], v[12:15], v[44:47]
  v_mfma_f32_16x16x32_bf16 v[48:51], a[172:175], v[16:19], v[48:51]
  s_waitcnt lgkmcnt(4)
  v_mfma_f32_16x16x32_bf16 v[36:39], a[24:27], v[20:23], v[36:39]
  ds_read_b128 v[12:15], v73 offset:18432
  v_mfma_f32_16x16x32_bf16 v[40:43], a[24:27], v[24:27], v[40:43]
  ds_read_b128 v[16:19], v73 offset:19456
  v_mfma_f32_16x16x32_bf16 v[44:47], a[176:179], v[20:23], v[44:47]
  v_mfma_f32_16x16x32_bf16 v[48:51], a[176:179], v[24:27], v[48:51]
  s_waitcnt lgkmcnt(4)
  v_mfma_f32_16x16x32_bf16 v[36:39], a[28:31], v[28:31], v[36:39]
  ds_read_b128 v[20:23], v73 offset:20480
  v_mfma_f32_16x16x32_bf16 v[40:43], a[28:31], v[32:35], v[40:43]
  ds_read_b128 v[24:27], v73 offset:21504
  v_mfma_f32_16x16x32_bf16 v[44:47], a[180:183], v[28:31], v[44:47]
  v_mfma_f32_16x16x32_bf16 v[48:51], a[180:183], v[32:35], v[48:51]
  s_waitcnt lgkmcnt(4)
  v_mfma_f32_16x16x32_bf16 v[36:39], a[32:35], v[4:7], v[36:39]
  ds_read_b128 v[28:31], v73 offset:22528
  v_mfma_f32_16x16x32_bf16 v[40:43], a[32:35], v[8:11], v[40:43]
  ds_read_b128 v[32:35], v73 offset:23552
  v_mfma_f32_16x16x32_bf16 v[44:47], a[184:187], v[4:7], v[44:47]
  v_mfma_f32_16x16x32_bf16 v[48:51], a[184:187], v[8:11], v[48:51]
  s_waitcnt lgkmcnt(4)
  v_mfma_f32_16x16x32_bf16 v[36:39], a[36:39], v[12:15], v[36:39]
  ds_read_b128 v[4:7], v73 offset:24576
  v_mfma_f32_16x16x32_bf16 v[40:43], a[36:39], v[16:19], v[40:43]
  ds_read_b128 v[8:11], v73 offset:25600
  v_mfma_f32_16x16x32_bf16 v[44:47], a[188:191], v[12:15], v[44:47]
  v_mfma_f32_16x16x32_bf16 v[48:51], a[188:191], v[16:19], v[48:51]
  s_waitcnt lgkmcnt(4)
  v_mfma_f32_16x16x32_bf16 v[36:39], a[40:43], v[20:23], v[36:39]
  ds_read_b128 v[12:15], v73 offset:26624
  v_mfma_f32_16x16x32_bf16 v[40:43], a[40:43], v[24:27], v[40:43]
  ds_read_b128 v[16:19], v73 offset:27648
  v_mfma_f32_16x16x32_bf16 v[44:47], a[192:195], v[20:23], v[44:47]
  v_mfma_f32_16x16x32_bf16 v[48:51], a[192:195], v[24:27], v[48:51]
  s_waitcnt lgkmcnt(4)
  v_mfma_f32_16x16x32_bf16 v[36:39], a[44:47], v[28:31], v[36:39]
  ds_read_b128 v[20:23], v73 offset:28672
  v_mfma_f32_16x16x32_bf16 v[40:43], a[44:47], v[32:35], v[40:43]
  ds_read_b128 v[24:27], v73 offset:29696
  v_mfma_f32_16x16x32_bf16 v[44:47], a[196:199], v[28:31], v[44:47]
  v_mfma_f32_16x16x32_bf16 v[48:51], a[196:199], v[32:35], v[48:51]
  s_lshl_b32 s40, s20, 8
  s_add_u32 m0, s40, 155648
  s_cmp_eq_u32 s20, 0
  s_cselect_b32 s40, s30, 2147483392
  buffer_load_dword v2, s[4:7], s40 offen sc1 lds
  s_waitcnt lgkmcnt(4)
  v_mfma_f32_16x16x32_bf16 v[36:39], a[48:51], v[4:7], v[36:39]
  ds_read_b128 v[28:31], v73 offset:30720
  v_mfma_f32_16x16x32_bf16 v[40:43], a[48:51], v[8:11], v[40:43]
  ds_read_b128 v[32:35], v73 offset:31744
  v_mfma_f32_16x16x32_bf16 v[44:47], a[200:203], v[4:7], v[44:47]
  v_mfma_f32_16x16x32_bf16 v[48:51], a[200:203], v[8:11], v[48:51]
  s_waitcnt vmcnt(9)
  s_barrier
  s_lshl_b32 s40, s20, 1
  s_add_u32 s40, s40, 1
  s_cmp_lg_u32 s40, s28
  s_cbranch_scc1 L_F2_s2
  s_mov_b32 s63, s25
  s_atomic_smax s63, s[4:5], s62 glc
Lnosig_54:
L_F2_s2:
  s_waitcnt lgkmcnt(4)
  v_mfma_f32_16x16x32_bf16 v[36:39], a[52:55], v[12:15], v[36:39]
  ds_read_b128 v[4:7], v73 offset:32768
  v_mfma_f32_16x16x32_bf16 v[40:43], a[52:55], v[16:19], v[40:43]
  ds_read_b128 v[8:11], v73 offset:33792
  v_mfma_f32_16x16x32_bf16 v[44:47], a[204:207], v[12:15], v[44:47]
  v_mfma_f32_16x16x32_bf16 v[48:51], a[204:207], v[16:19], v[48:51]
  s_waitcnt lgkmcnt(4)
  v_mfma_f32_16x16x32_bf16 v[36:39], a[56:59], v[20:23], v[36:39]
  ds_read_b128 v[12:15], v73 offset:34816
  v_mfma_f32_16x16x32_bf16 v[40:43], a[56:59], v[24:27], v[40:43]
  ds_read_b128 v[16:19], v73 offset:35840
  v_mfma_f32_16x16x32_bf16 v[44:47], a[208:211], v[20:23], v[44:47]
  v_mfma_f32_16x16x32_bf16 v[48:51], a[208:211], v[24:27], v[48:51]
  s_waitcnt lgkmcnt(4)
  v_mfma_f32_16x16x32_bf16 v[36:39], a[60:63], v[28:31], v[36:39]
  ds_read_b128 v[20:23], v73 offset:36864
  v_mfma_f32_16x16x32_bf16 v[40:43], a[60:63], v[32:35], v[40:43]
  ds_read_b128 v[24:27], v73 offset:37888
  v_mfma_f32_16x16x32_bf16 v[44:47], a[212:215], v[28:31], v[44:47]
  v_mfma_f32_16x16x32_bf16 v[48:51], a[212:215], v[32:35], v[48:51]
  s_waitcnt lgkmcnt(4)
  v_mfma_f32_16x16x32_bf16 v[36:39], a[64:67], v[4:7], v[36:39]
  ds_read_b128 v[28:31], v73 offset:38912
  v_mfma_f32_16x16x32_bf16 v[40:43], a[64:67], v[8:11], v[40:43]
  ds_read_b128 v[32:35], v73 offset:39936
  v_mfma_f32_16x16x32_bf16 v[44:47], a[216:219], v[4:7], v[44:47]
  v_mfma_f32_16x16x32_bf16 v[48:51], a[216:219], v[8:11], v[48:51]
  s_waitcnt lgkmcnt(4)
  v_mfma_f32_16x16x32_bf16 v[36:39], a[68:71], v[12:15], v[36:39]
  ds_read_b128 v[4:7], v73 offset:40960
  v_mfma_f32_16x16x32_bf16 v[40:43], a[68:71], v[16:19], v[40:43]
  ds_read_b128 v[8:11], v73 offset:41984
  v_mfma_f32_16x16x32_bf16 v[44:47], a[220:223], v[12:15], v[44:47]
  v_mfma_f32_16x16x32_bf16 v[48:51], a[220:223], v[16:19], v[48:51]
  s_waitcnt lgkmcnt(4)
  v_mfma_f32_16x16x32_bf16 v[36:39], a[72:75], v[20:23], v[36:39]
  ds_read_b128 v[12:15], v73 offset:43008
  v_mfma_f32_16x16x32_bf16 v[40:43], a[72:75], v[24:27], v[40:43]
  ds_read_b128 v[16:19], v73 offset:44032
  v_mfma_f32_16x16x32_bf16 v[44:47], a[224:227], v[20:23], v[44:47]
  v_mfma_f32_16x16x32_bf16 v[48:51], a[224:227], v[24:27], v[48:51]
  s_waitcnt vmcnt(0)
  s_barrier
  ds_read_b32 v3, v71
  s_waitcnt lgkmcnt(4)
  v_mfma_f32_16x16x32_bf16 v[36:39], a[76:79], v[28:31], v[36:39]
  ds_read_b128 v[20:23], v73 offset:45056
  v_mfma_f32_16x16x32_bf16 v[40:43], a[76:79], v[32:35], v[40:43]
  ds_read_b128 v[24:27], v73 offset:46080
  v_mfma_f32_16x16x32_bf16 v[44:47], a[228:231], v[28:31], v[44:47]
  v_mfma_f32_16x16x32_bf16 v[48:51], a[228:231], v[32:35], v[48:51]
  s_waitcnt lgkmcnt(4)
  v_mfma_f32_16x16x32_bf16 v[36:39], a[80:83], v[4:7], v[36:39]
  ds_read_b128 v[28:31], v73 offset:47104
  v_mfma_f32_16x16x32_bf16 v[40:43], a[80:83], v[8:11], v[40:43]
  ds_read_b128 v[32:35], v73 offset:48128
  v_mfma_f32_16x16x32_bf16 v[44:47], a[232:235], v[4:7], v[44:47]
  v_mfma_f32_16x16x32_bf16 v[48:51], a[232:235], v[8:11], v[48:51]
  s_waitcnt lgkmcnt(4)
  v_cmp_gt_i32 vcc, s29, v3
  s_mov_b32 s28, 0
  s_cbranch_vccnz L_F2_nopf
  s_cmp_ge_u32 s25, 63
  s_cbranch_scc1 L_F2_nopf
  s_mov_b32 s28, 1
  s_waitcnt lgkmcnt(4)
  v_mfma_f32_16x16x32_bf16 v[36:39], a[84:87], v[12:15], v[36:39]
  ds_read_b128 v[4:7], v73 offset:49152
  v_mfma_f32_16x16x32_bf16 v[40:43], a[84:87], v[16:19], v[40:43]
  ds_read_b128 v[8:11], v73 offset:50176
  v_mfma_f32_16x16x32_bf16 v[44:47], a[236:239], v[12:15], v[44:47]
  s_add_u32 s36, s32, 0
  s_add_u32 m0, s34, s36
  s_add_u32 s36, s35, 0
  buffer_load_dwordx4 v1, s[4:7], s36 offen offset:0 sc1 lds
  v_mfma_f32_16x16x32_bf16 v[48:51], a[236:239], v[16:19], v[48:51]
  s_waitcnt lgkmcnt(4)
  v_mfma_f32_16x16x32_bf16 v[36:39], a[88:91], v[20:23], v[36:39]
  ds_read_b128 v[12:15], v73 offset:51200
  v_mfma_f32_16x16x32_bf16 v[40:43], a[88:91], v[24:27], v[40:43]
  ds_read_b128 v[16:19], v73 offset:52224
  v_mfma_f32_16x16x32_bf16 v[44:47], a[240:243], v[20:23], v[44:47]
  buffer_load_dwordx4 v1, s[4:7], s36 offen offset:1024 sc1 lds
  v_mfma_f32_16x16x32_bf16 v[48:51], a[240:243], v[24:27], v[48:51]
  s_waitcnt lgkmcnt(4)
  v_mfma_f32_16x16x32_bf16 v[36:39], a[92:95], v[28:31], v[36:39]
  ds_read_b128 v[20:23], v73 offset:53248
  v_mfma_f32_16x16x32_bf16 v[40:43], a[92:95], v[32:35], v[40:43]
  ds_read_b128 v[24:27], v73 offset:54272
  v_mfma_f32_16x16x32_bf16 v[44:47], a[244:247], v[28:31], v[44:47]
  buffer_load_dwordx4 v1, s[4:7], s36 offen offset:2048 sc1 lds
  v_mfma_f32_16x16x32_bf16 v[48:51], a[244:247], v[32:35], v[48:51]
  s_waitcnt lgkmcnt(4)
  v_mfma_f32_16x16x32_bf16 v[36:39], a[96:99], v[4:7], v[36:39]
  ds_read_b128 v[28:31], v73 offset:55296
  v_mfma_f32_16x16x32_bf16 v[40:43], a[96:99], v[8:11], v[40:43]
  ds_read_b128 v[32:35], v73 offset:56320
  v_mfma_f32_16x16x32_bf16 v[44:47], a[248:251], v[4:7], v[44:47]
  buffer_load_dwordx4 v1, s[4:7], s36 offen offset:3072 sc1 lds
  v_mfma_f32_16x16x32_bf16 v[48:51], a[248:251], v[8:11], v[48:51]
  s_waitcnt lgkmcnt(4)
  v_mfma_f32_16x16x32_bf16 v[36:39], a[100:103], v[12:15], v[36:39]
  ds_read_b128 v[4:7], v73 offset:57344
  v_mfma_f32_16x16x32_bf16 v[40:43], a[100:103], v[16:19], v[40:43]
  ds_read_b128 v[8:11], v73 offset:58368
  v_mfma_f32_16x16x32_bf16 v[44:47], a[252:255], v[12:15], v[44:47]
  s_add_u32 s36, s32, 16384
  s_add_u32 m0, s34, s36
  s_add_u32 s36, s35, 32768
  buffer_load_dwordx4 v1, s[4:7], s36 offen offset:0 sc1 lds
  v_mfma_f32_16x16x32_bf16 v[48:51], a[252:255], v[16:19], v[48:51]
  s_waitcnt lgkmcnt(4)
  v_mfma_f32_16x16x32_bf16 v[36:39], a[104:107], v[20:23], v[36:39]
  ds_read_b128 v[12:15], v73 offset:59392
  v_mfma_f32_16x16x32_bf16 v[40:43], a[104:107], v[24:27], v[40:43]
  ds_read_b128 v[16:19], v73 offset:60416
  v_mfma_f32_16x16x32_bf16 v[44:47], v[128:131], v[20:23], v[44:47]
  buffer_load_dwordx4 v1, s[4:7], s36 offen offset:1024 sc1 lds
  v_mfma_f32_16x16x32_bf16 v[48:51], v[128:131], v[24:27], v[48:51]
  s_waitcnt lgkmcnt(4)
  v_mfma_f32_16x16x32_bf16 v[36:39], a[108:111], v[28:31], v[36:39]
  ds_read_b128 v[20:23], v73 offset:61440
  v_mfma_f32_16x16x32_bf16 v[40:43], a[108:111], v[32:35], v[40:43]
  ds_read_b128 v[24:27], v73 offset:62464
  v_mfma_f32_16x16x32_bf16 v[44:47], v[132:135], v[28:31], v[44:47]
  buffer_load_dwordx4 v1, s[4:7], s36 offen offset:2048 sc1 lds
  v_mfma_f32_16x16x32_bf16 v[48:51], v[132:135], v[32:35], v[48:51]
  s_waitcnt lgkmcnt(4)
  v_mfma_f32_16x16x32_bf16 v[36:39], a[112:115], v[4:7], v[36:39]
  ds_read_b128 v[28:31], v73 offset:63488
  v_mfma_f32_16x16x32_bf16 v[40:43], a[112:115], v[8:11], v[40:43]
  ds_read_b128 v[32:35], v73 offset:64512
  v_mfma_f32_16x16x32_bf16 v[44:47], v[136:139], v[4:7], v[44:47]
  buffer_load_dwordx4 v1, s[4:7], s36 offen offset:3072 sc1 lds
  v_mfma_f32_16x16x32_bf16 v[48:51], v[136:139], v[8:11], v[48:51]
  s_waitcnt lgkmcnt(4)
  v_mfma_f32_16x16x32_bf16 v[36:39], a[116:119], v[12:15], v[36:39]
  ds_read_b128 v[4:7], v74 offset:0
  v_mfma_f32_16x16x32_bf16 v[40:43], a[116:119], v[16:19], v[40:43]
  ds_read_b128 v[8:11], v74 offset:1024
  v_mfma_f32_16x16x32_bf16 v[44:47], v[140:143], v[12:15], v[44:47]
  s_add_u32 s36, s32, 32768
  s_add_u32 m0, s34, s36
  s_add_u32 s36, s35, 65536
  buffer_load_dwordx4 v1, s[4:7], s36 offen offset:0 sc1 lds
  v_mfma_f32_16x16x32_bf16 v[48:51], v[140:143], v[16:19], v[48:51]
  s_waitcnt lgkmcnt(4)
  v_mfma_f32_16x16x32_bf16 v[36:39], a[120:123], v[20:23], v[36:39]
  ds_read_b128 v[12:15], v74 offset:2048
  v_mfma_f32_16x16x32_bf16 v[40:43], a[120:123], v[24:27], v[40:43]
  ds_read_b128 v[16:19], v74 offset:3072
  v_mfma_f32_16x16x32_bf16 v[44:47], v[144:147], v[20:23], v[44:47]
  buffer_load_dwordx4 v1, s[4:7], s36 offen offset:1024 sc1 lds
  v_mfma_f32_16x16x32_bf16 v[48:51], v[144:147], v[24:27], v[48:51]
  s_waitcnt lgkmcnt(4)
  v_mfma_f32_16x16x32_bf16 v[36:39], a[124:127], v[28:31], v[36:39]
  ds_read_b128 v[20:23], v74 offset:4096
  v_mfma_f32_16x16x32_bf16 v[40:43], a[124:127], v[32:35], v[40:43]
  ds_read_b128 v[24:27], v74 offset:5120
  v_mfma_f32_16x16x32_bf16 v[44:47], v[148:151], v[28:31], v[44:47]
  buffer_load_dwordx4 v1, s[4:7], s36 offen offset:2048 sc1 lds
  v_mfma_f32_16x16x32_bf16 v[48:51], v[148:151], v[32:35], v[48:51]
  s_waitcnt lgkmcnt(4)
  v_mfma_f32_16x16x32_bf16 v[36:39], a[128:131], v[4:7], v[36:39]
  ds_read_b128 v[28:31], v74 offset:6144
  v_mfma_f32_16x16x32_bf16 v[40:43], a[128:131], v[8:11], v[40:43]
  ds_read_b128 v[32:35], v74 offset:7168
  v_mfma_f32_16x16x32_bf16 v[44:47], v[152:155], v[4:7], v[44:47]
  buffer_load_dwordx4 v1, s[4:7], s36 offen offset:3072 sc1 lds
  v_mfma_f32_16x16x32_bf16 v[48:51], v[152:155], v[8:11], v[48:51]
  s_waitcnt lgkmcnt(4)
  v_mfma_f32_16x16x32_bf16 v[36:39], a[132:135], v[12:15], v[36:39]
  ds_read_b128 v[4:7], v74 offset:8192
  v_mfma_f32_16x16x32_bf16 v[40:43], a[132:135], v[16:19], v[40:43]
  ds_read_b128 v[8:11], v74 offset:9216
  v_mfma_f32_16x16x32_bf16 v[44:47], v[156:159], v[12:15], v[44:47]
  v_mfma_f32_16x16x32_bf16 v[48:51], v[156:159], v[16:19], v[48:51]
  s_waitcnt lgkmcnt(4)
  v_mfma_f32_16x16x32_bf16 v[36:39], a[136:139], v[20:23], v[36:39]
  ds_read_b128 v[12:15], v74 offset:10240
  v_mfma_f32_16x16x32_bf16 v[40:43], a[136:139], v[24:27], v[40:43]
  ds_read_b128 v[16:19], v74 offset:11264
  v_mfma_f32_16x16x32_bf16 v[44:47], v[160:163], v[20:23], v[44:47]
  v_mfma_f32_16x16x32_bf16 v[48:51], v[160:163], v[24:27], v[48:51]
  s_waitcnt lgkmcnt(4)
  v_mfma_f32_16x16x32_bf16 v[36:39], a[140:143], v[28:31], v[36:39]
  v_mfma_f32_16x16x32_bf16 v[40:43], a[140:143], v[32:35], v[40:43]
  v_mfma_f32_16x16x32_bf16 v[44:47], v[164:167], v[28:31], v[44:47]
  v_mfma_f32_16x16x32_bf16 v[48:51], v[164:167], v[32:35], v[48:51]
  s_waitcnt lgkmcnt(2)
  v_mfma_f32_16x16x32_bf16 v[36:39], a[144:147], v[4:7], v[36:39]
  v_mfma_f32_16x16x32_bf16 v[40:43], a[144:147], v[8:11], v[40:43]
  v_mfma_f32_16x16x32_bf16 v[44:47], v[168:171], v[4:7], v[44:47]
  v_mfma_f32_16x16x32_bf16 v[48:51], v[168:171], v[8:11], v[48:51]
  s_waitcnt lgkmcnt(0)
  v_mfma_f32_16x16x32_bf16 v[36:39], a[148:151], v[12:15], v[36:39]
  v_mfma_f32_16x16x32_bf16 v[40:43], a[148:151], v[16:19], v[40:43]
  v_mfma_f32_16x16x32_bf16 v[44:47], v[172:175], v[12:15], v[44:47]
  v_mfma_f32_16x16x32_bf16 v[48:51], v[172:175], v[16:19], v[48:51]
  s_nop 7
  s_branch L_F2_epi
L_F2_nopf:
  s_waitcnt lgkmcnt(4)
  v_mfma_f32_16x16x32_bf16 v[36:39], a[84:87], v[12:15], v[36:39]
  ds_read_b128 v[4:7], v73 offset:49152
  v_mfma_f32_16x16x32_bf16 v[40:43], a[84:87], v[16:19], v[40:43]
  ds_read_b128 v[8:11], v73 offset:50176
  v_mfma_f32_16x16x32_bf16 v[44:47], a[236:239], v[12:15], v[44:47]
  v_mfma_f32_16x16x32_bf16 v[48:51], a[236:239], v[16:19], v[48:51]
  s_waitcnt lgkmcnt(4)
  v_mfma_f32_16x16x32_bf16 v[36:39], a[88:91], v[20:23], v[36:39]
  ds_read_b128 v[12:15], v73 offset:51200
  v_mfma_f32_16x16x32_bf16 v[40:43], a[88:91], v[24:27], v[40:43]
  ds_read_b128 v[16:19], v73 offset:52224
  v_mfma_f32_16x16x32_bf16 v[44:47], a[240:243], v[20:23], v[44:47]
  v_mfma_f32_16x16x32_bf16 v[48:51], a[240:243], v[24:27], v[48:51]
  s_waitcnt lgkmcnt(4)
  v_mfma_f32_16x16x32_bf16 v[36:39], a[92:95], v[28:31], v[36:39]
  ds_read_b128 v[20:23], v73 offset:53248
  v_mfma_f32_16x16x32_bf16 v[40:43], a[92:95], v[32:35], v[40:43]
  ds_read_b128 v[24:27], v73 offset:54272
  v_mfma_f32_16x16x32_bf16 v[44:47], a[244:247], v[28:31], v[44:47]
  v_mfma_f32_16x16x32_bf16 v[48:51], a[244:247], v[32:35], v[48:51]
  s_waitcnt lgkmcnt(4)
  v_mfma_f32_16x16x32_bf16 v[36:39], a[96:99], v[4:7], v[36:39]
  ds_read_b128 v[28:31], v73 offset:55296
  v_mfma_f32_16x16x32_bf16 v[40:43], a[96:99], v[8:11], v[40:43]
  ds_read_b128 v[32:35], v73 offset:56320
  v_mfma_f32_16x16x32_bf16 v[44:47], a[248:251], v[4:7], v[44:47]
  v_mfma_f32_16x16x32_bf16 v[48:51], a[248:251], v[8:11], v[48:51]
  s_waitcnt lgkmcnt(4)
  v_mfma_f32_16x16x32_bf16 v[36:39], a[100:103], v[12:15], v[36:39]
  ds_read_b128 v[4:7], v73 offset:57344
  v_mfma_f32_16x16x32_bf16 v[40:43], a[100:103], v[16:19], v[40:43]
  ds_read_b128 v[8:11], v73 offset:58368
  v_mfma_f32_16x16x32_bf16 v[44:47], a[252:255], v[12:15], v[44:47]
  v_mfma_f32_16x16x32_bf16 v[48:51], a[252:255], v[16:19], v[48:51]
  s_waitcnt lgkmcnt(4)
  v_mfma_f32_16x16x32_bf16 v[36:39], a[104:107], v[20:23], v[36:39]
  ds_read_b128 v[12:15], v73 offset:59392
  v_mfma_f32_16x16x32_bf16 v[40:43], a[104:107], v[24:27], v[40:43]
  ds_read_b128 v[16:19], v73 offset:60416
  v_mfma_f32_16x16x32_bf16 v[44:47], v[128:131], v[20:23], v[44:47]
  v_mfma_f32_16x16x32_bf16 v[48:51], v[128:131], v[24:27], v[48:51]
  s_waitcnt lgkmcnt(4)
  v_mfma_f32_16x16x32_bf16 v[36:39], a[108:111], v[28:31], v[36:39]
  ds_read_b128 v[20:23], v73 offset:61440
  v_mfma_f32_16x16x32_bf16 v[40:43], a[108:111], v[32:35], v[40:43]
  ds_read_b128 v[24:27], v73 offset:62464
  v_mfma_f32_16x16x32_bf16 v[44:47], v[132:135], v[28:31], v[44:47]
  v_mfma_f32_16x16x32_bf16 v[48:51], v[132:135], v[32:35], v[48:51]
  s_waitcnt lgkmcnt(4)
  v_mfma_f32_16x16x32_bf16 v[36:39], a[112:115], v[4:7], v[36:39]
  ds_read_b128 v[28:31], v73 offset:63488
  v_mfma_f32_16x16x32_bf16 v[40:43], a[112:115], v[8:11], v[40:43]
  ds_read_b128 v[32:35], v73 offset:64512
  v_mfma_f32_16x16x32_bf16 v[44:47], v[136:139], v[4:7], v[44:47]
  v_mfma_f32_16x16x32_bf16 v[48:51], v[136:139], v[8:11], v[48:51]
  s_waitcnt lgkmcnt(4)
  v_mfma_f32_16x16x32_bf16 v[36:39], a[116:119], v[12:15], v[36:39]
  ds_read_b128 v[4:7], v74 offset:0
  v_mfma_f32_16x16x32_bf16 v[40:43], a[116:119], v[16:19], v[40:43]
  ds_read_b128 v[8:11], v74 offset:1024
  v_mfma_f32_16x16x32_bf16 v[44:47], v[140:143], v[12:15], v[44:47]
  v_mfma_f32_16x16x32_bf16 v[48:51], v[140:143], v[16:19], v[48:51]
  s_barrier
  s_lshl_b32 s40, s20, 8
  s_add_u32 m0, s40, 155648
  s_cmp_eq_u32 s20, 0
  s_cselect_b32 s40, s30, 2147483392
  buffer_load_dword v2, s[4:7], s40 offen sc1 lds
  s_waitcnt lgkmcnt(4)
  v_mfma_f32_16x16x32_bf16 v[36:39], a[120:123], v[20:23], v[36:39]
  ds_read_b128 v[12:15], v74 offset:2048
  v_mfma_f32_16x16x32_bf16 v[40:43], a[120:123], v[24:27], v[40:43]
  ds_read_b128 v[16:19], v74 offset:3072
  v_mfma_f32_16x16x32_bf16 v[44:47], v[144:147], v[20:23], v[44:47]
  v_mfma_f32_16x16x32_bf16 v[48:51], v[144:147], v[24:27], v[48:51]
  s_waitcnt lgkmcnt(4)
  v_mfma_f32_16x16x32_bf16 v[36:39], a[124:127], v[28:31], v[36:39]
  ds_read_b128 v[20:23], v74 offset:4096
  v_mfma_f32_16x16x32_bf16 v[40:43], a[124:127], v[32:35], v[40:43]
  ds_read_b128 v[24:27], v74 offset:5120
  v_mfma_f32_16x16x32_bf16 v[44:47], v[148:151], v[28:31], v[44:47]
  v_mfma_f32_16x16x32_bf16 v[48:51], v[148:151], v[32:35], v[48:51]
  s_waitcnt lgkmcnt(4)
  v_mfma_f32_16x16x32_bf16 v[36:39], a[128:131], v[4:7], v[36:39]
  ds_read_b128 v[28:31], v74 offset:6144
  v_mfma_f32_16x16x32_bf16 v[40:43], a[128:131], v[8:11], v[40:43]
  ds_read_b128 v[32:35], v74 offset:7168
  v_mfma_f32_16x16x32_bf16 v[44:47], v[152:155], v[4:7], v[44:47]
  v_mfma_f32_16x16x32_bf16 v[48:51], v[152:155], v[8:11], v[48:51]
  s_waitcnt lgkmcnt(4)
  v_mfma_f32_16x16x32_bf16 v[36:39], a[132:135], v[12:15], v[36:39]
  ds_read_b128 v[4:7], v74 offset:8192
  v_mfma_f32_16x16x32_bf16 v[40:43], a[132:135], v[16:19], v[40:43]
  ds_read_b128 v[8:11], v74 offset:9216
  v_mfma_f32_16x16x32_bf16 v[44:47], v[156:159], v[12:15], v[44:47]
  v_mfma_f32_16x16x32_bf16 v[48:51], v[156:159], v[16:19], v[48:51]
  s_waitcnt lgkmcnt(4)
  v_mfma_f32_16x16x32_bf16 v[36:39], a[136:139], v[20:23], v[36:39]
  ds_read_b128 v[12:15], v74 offset:10240
  v_mfma_f32_16x16x32_bf16 v[40:43], a[136:139], v[24:27], v[40:43]
  ds_read_b128 v[16:19], v74 offset:11264
  v_mfma_f32_16x16x32_bf16 v[44:47], v[160:163], v[20:23], v[44:47]
  v_mfma_f32_16x16x32_bf16 v[48:51], v[160:163], v[24:27], v[48:51]
  s_waitcnt lgkmcnt(4)
  v_mfma_f32_16x16x32_bf16 v[36:39], a[140:143], v[28:31], v[36:39]
  v_mfma_f32_16x16x32_bf16 v[40:43], a[140:143], v[32:35], v[40:43]
  v_mfma_f32_16x16x32_bf16 v[44:47], v[164:167], v[28:31], v[44:47]
  v_mfma_f32_16x16x32_bf16 v[48:51], v[164:167], v[32:35], v[48:51]
  s_waitcnt vmcnt(0)
  s_barrier
  ds_read_b32 v3, v71
  s_waitcnt lgkmcnt(2)
  v_mfma_f32_16x16x32_bf16 v[36:39], a[144:147], v[4:7], v[36:39]
  v_mfma_f32_16x16x32_bf16 v[40:43], a[144:147], v[8:11], v[40:43]
  v_mfma_f32_16x16x32_bf16 v[44:47], v[168:171], v[4:7], v[44:47]
  v_mfma_f32_16x16x32_bf16 v[48:51], v[168:171], v[8:11], v[48:51]
  s_waitcnt lgkmcnt(0)
  v_mfma_f32_16x16x32_bf16 v[36:39], a[148:151], v[12:15], v[36:39]
  v_mfma_f32_16x16x32_bf16 v[40:43], a[148:151], v[16:19], v[40:43]
  v_mfma_f32_16x16x32_bf16 v[44:47], v[172:175], v[12:15], v[44:47]
  v_mfma_f32_16x16x32_bf16 v[48:51], v[172:175], v[16:19], v[48:51]
  v_cmp_gt_i32 vcc, s29, v3
  s_cmp_eq_u64 vcc, 0
  s_cselect_b32 s28, 2, 0
  s_cmp_lt_u32 s25, 63
  s_cselect_b32 s28, s28, 0
L_F2_epi:
  v_cvt_pk_bf16_f32 v52, v36, v37
  v_cvt_pk_bf16_f32 v53, v38, v39
  v_cvt_pk_bf16_f32 v54, v44, v45
  v_cvt_pk_bf16_f32 v55, v46, v47
  buffer_store_dwordx4 v[52:55], v68, s[4:7], s31 offen offset:0 sc1
  v_cvt_pk_bf16_f32 v56, v40, v41
  v_cvt_pk_bf16_f32 v57, v42, v43
  v_cvt_pk_bf16_f32 v58, v48, v49
  v_cvt_pk_bf16_f32 v59, v50, v51
  buffer_store_dwordx4 v[56:59], v68, s[4:7], s31 offen offset:1024 sc1
  s_add_u32 s25, s25, 1
  s_add_u32 s31, s31, 2097152
  s_xor_b32 s31, s31, 0x2000
  s_branch L_F2_top
L_WOF:
  s_load_dwordx2 s[8:9], s[0:1], 40
  s_mov_b32 s10, 8388608
  s_mov_b32 s11, 0x20000
  s_waitcnt lgkmcnt(0)
  v_bfe_u32 v1, v0, 5, 1
  v_mul_u32_u24 v1, 131072, v1
  v_bfe_u32 v2, v0, 4, 1
  v_mul_u32_u24 v2, 8192, v2
  v_add_u32 v1, v1, v2
  v_bfe_u32 v2, v0, 3, 1
  v_mul_u32_u24 v2, 2048, v2
  v_add_u32 v1, v1, v2
  v_lshrrev_b32 v2, 3, v0
  v_and_b32 v2, 6, v2
  v_xor_b32 v2, v2, v0
  v_and_b32 v2, 7, v2
  v_lshl_add_u32 v1, v2, 4, v1
  v_bfe_u32 v2, v0, 3, 2
  v_xor_b32 v2, 0, v2
  v_lshlrev_b32 v2, 5, v2
  v_lshrrev_b32 v4, 2, v0
  v_lshl_add_u32 v4, v4, 7, v2
  v_and_b32 v2, 3, v0
  v_lshl_add_u32 v4, v2, 3, v4
  s_and_b32 s43, s21, 3
  s_lshl_b32 s43, s43, 2
  s_add_u32 s43, s43, s20
  s_lshr_b32 s44, s21, 2
  s_lshl_b32 s40, s43, 19
  s_lshl_b32 s41, s44, 7
  s_add_u32 s40, s40, s41
  v_add_u32 v1, s40, v1
  s_lshl_b32 s41, s20, 15
  v_add_u32 v4, s41, v4
  s_lshl_b32 s40, s44, 19
  s_lshl_b32 s45, s43, 14
  s_add_u32 s40, s40, s45
  v_lshl_add_u32 v3, v0, 4, s40
  v_xor_b32 v5, 32, v4
  v_xor_b32 v6, 64, v4
  v_xor_b32 v7, 96, v4
  s_add_u32 m0, s41, 0
  s_mov_b32 s42, 0
  buffer_load_dwordx4 v1, s[8:11], s42 offen nt lds
  s_add_u32 m0, s41, 1024
  s_mov_b32 s42, 16384
  buffer_load_dwordx4 v1, s[8:11], s42 offen nt lds
  s_add_u32 m0, s41, 2048
  s_mov_b32 s42, 4096
  buffer_load_dwordx4 v1, s[8:11], s42 offen nt lds
  s_add_u32 m0, s41, 3072
  s_mov_b32 s42, 20480
  buffer_load_dwordx4 v1, s[8:11], s42 offen nt lds
  s_add_u32 m0, s41, 4096
  s_mov_b32 s42, 32768
  buffer_load_dwordx4 v1, s[8:11], s42 offen nt lds
  s_add_u32 m0, s41, 5120
  s_mov_b32 s42, 49152
  buffer_load_dwordx4 v1, s[8:11], s42 offen nt lds
  s_add_u32 m0, s41, 6144
  s_mov_b32 s42, 36864
  buffer_load_dwordx4 v1, s[8:11], s42 offen nt lds
  s_add_u32 m0, s41, 7168
  s_mov_b32 s42, 53248
  buffer_load_dwordx4 v1, s[8:11], s42 offen nt lds
  s_add_u32 m0, s41, 8192
  s_mov_b32 s42, 65536
  buffer_load_dwordx4 v1, s[8:11], s42 offen nt lds
  s_add_u32 m0, s41, 9216
  s_mov_b32 s42, 81920
  buffer_load_dwordx4 v1, s[8:11], s42 offen nt lds
  s_add_u32 m0, s41, 10240
  s_mov_b32 s42, 69632
  buffer_load_dwordx4 v1, s[8:11], s42 offen nt lds
  s_add_u32 m0, s41, 11264
  s_mov_b32 s42, 86016
  buffer_load_dwordx4 v1, s[8:11], s42 offen nt lds
  s_add_u32 m0, s41, 12288
  s_mov_b32 s42, 98304
  buffer_load_dwordx4 v1, s[8:11], s42 offen nt lds
  s_add_u32 m0, s41, 13312
  s_mov_b32 s42, 114688
  buffer_load_dwordx4 v1, s[8:11], s42 offen nt lds
  s_add_u32 m0, s41, 14336
  s_mov_b32 s42, 102400
  buffer_load_dwordx4 v1, s[8:11], s42 offen nt lds
  s_add_u32 m0, s41, 15360
  s_mov_b32 s42, 118784
  buffer_load_dwordx4 v1, s[8:11], s42 offen nt lds
  s_add_u32 m0, s41, 16384
  s_mov_b32 s42, 262144
  buffer_load_dwordx4 v1, s[8:11], s42 offen nt lds
  s_add_u32 m0, s41, 17408
  s_mov_b32 s42, 278528
  buffer_load_dwordx4 v1, s[8:11], s42 offen nt lds
  s_add_u32 m0, s41, 18432
  s_mov_b32 s42, 266240
  buffer_load_dwordx4 v1, s[8:11], s42 offen nt lds
  s_add_u32 m0, s41, 19456
  s_mov_b32 s42, 282624
  buffer_load_dwordx4 v1, s[8:11], s42 offen nt lds
  s_add_u32 m0, s41, 20480
  s_mov_b32 s42, 294912
  buffer_load_dwordx4 v1, s[8:11], s42 offen nt lds
  s_add_u32 m0, s41, 21504
  s_mov_b32 s42, 311296
  buffer_load_dwordx4 v1, s[8:11], s42 offen nt lds
  s_add_u32 m0, s41, 22528
  s_mov_b32 s42, 299008
  buffer_load_dwordx4 v1, s[8:11], s42 offen nt lds
  s_add_u32 m0, s41, 23552
  s_mov_b32 s42, 315392
  buffer_load_dwordx4 v1, s[8:11], s42 offen nt lds
  s_add_u32 m0, s41, 24576
  s_mov_b32 s42, 327680
  buffer_load_dwordx4 v1, s[8:11], s42 offen nt lds
  s_add_u32 m0, s41, 25600
  s_mov_b32 s42, 344064
  buffer_load_dwordx4 v1, s[8:11], s42 offen nt lds
  s_add_u32 m0, s41, 26624
  s_mov_b32 s42, 331776
  buffer_load_dwordx4 v1, s[8:11], s42 offen nt lds
  s_add_u32 m0, s41, 27648
  s_mov_b32 s42, 348160
  buffer_load_dwordx4 v1, s[8:11], s42 offen nt lds
  s_add_u32 m0, s41, 28672
  s_mov_b32 s42, 360448
  buffer_load_dwordx4 v1, s[8:11], s42 offen nt lds
  s_add_u32 m0, s41, 29696
  s_mov_b32 s42, 376832
  buffer_load_dwordx4 v1, s[8:11], s42 offen nt lds
  s_add_u32 m0, s41, 30720
  s_mov_b32 s42, 364544
  buffer_load_dwordx4 v1, s[8:11], s42 offen nt lds
  s_add_u32 m0, s41, 31744
  s_mov_b32 s42, 380928
  buffer_load_dwordx4 v1, s[8:11], s42 offen nt lds
  s_waitcnt vmcnt(24)
  ds_read_b64_tr_b16 v[8:9], v4 offset:0
  ds_read_b64_tr_b16 v[10:11], v4 offset:2048
  ds_read_b64_tr_b16 v[12:13], v4 offset:4096
  ds_read_b64_tr_b16 v[14:15], v4 offset:6144
  ds_read_b64_tr_b16 v[16:17], v5 offset:0
  ds_read_b64_tr_b16 v[18:19], v5 offset:2048
  ds_read_b64_tr_b16 v[20:21], v5 offset:4096
  ds_read_b64_tr_b16 v[22:23], v5 offset:6144
  ds_read_b64_tr_b16 v[24:25], v6 offset:0
  ds_read_b64_tr_b16 v[26:27], v6 offset:2048
  ds_read_b64_tr_b16 v[28:29], v6 offset:4096
  ds_read_b64_tr_b16 v[30:31], v6 offset:6144
  ds_read_b64_tr_b16 v[32:33], v7 offset:0
  ds_read_b64_tr_b16 v[34:35], v7 offset:2048
  ds_read_b64_tr_b16 v[36:37], v7 offset:4096
  ds_read_b64_tr_b16 v[38:39], v7 offset:6144
  s_mov_b32 s42, 6291456
  s_waitcnt lgkmcnt(12)
  buffer_store_dwordx4 v[8:11], v3, s[4:7], s42 offen offset:0 sc1
  buffer_store_dwordx4 v[12:15], v3, s[4:7], s42 offen offset:1024 sc1
  s_mov_b32 s42, 6291456
  s_waitcnt lgkmcnt(8)
  buffer_store_dwordx4 v[16:19], v3, s[4:7], s42 offen offset:2048 sc1
  buffer_store_dwordx4 v[20:23], v3, s[4:7], s42 offen offset:3072 sc1
  s_mov_b32 s42, 6553600
  s_waitcnt lgkmcnt(4)
  buffer_store_dwordx4 v[24:27], v3, s[4:7], s42 offen offset:0 sc1
  buffer_store_dwordx4 v[28:31], v3, s[4:7], s42 offen offset:1024 sc1
  s_mov_b32 s42, 6553600
  s_waitcnt lgkmcnt(0)
  buffer_store_dwordx4 v[32:35], v3, s[4:7], s42 offen offset:2048 sc1
  buffer_store_dwordx4 v[36:39], v3, s[4:7], s42 offen offset:3072 sc1
  s_waitcnt vmcnt(24)
  ds_read_b64_tr_b16 v[40:41], v4 offset:8192
  ds_read_b64_tr_b16 v[42:43], v4 offset:10240
  ds_read_b64_tr_b16 v[44:45], v4 offset:12288
  ds_read_b64_tr_b16 v[46:47], v4 offset:14336
  ds_read_b64_tr_b16 v[48:49], v5 offset:8192
  ds_read_b64_tr_b16 v[50:51], v5 offset:10240
  ds_read_b64_tr_b16 v[52:53], v5 offset:12288
  ds_read_b64_tr_b16 v[54:55], v5 offset:14336
  ds_read_b64_tr_b16 v[56:57], v6 offset:8192
  ds_read_b64_tr_b16 v[58:59], v6 offset:10240
  ds_read_b64_tr_b16 v[60:61], v6 offset:12288
  ds_read_b64_tr_b16 v[62:63], v6 offset:14336
  ds_read_b64_tr_b16 v[64:65], v7 offset:8192
  ds_read_b64_tr_b16 v[66:67], v7 offset:10240
  ds_read_b64_tr_b16 v[68:69], v7 offset:12288
  ds_read_b64_tr_b16 v[70:71], v7 offset:14336
  s_mov_b32 s42, 6295552
  s_waitcnt lgkmcnt(12)
  buffer_store_dwordx4 v[40:43], v3, s[4:7], s42 offen offset:0 sc1
  buffer_store_dwordx4 v[44:47], v3, s[4:7], s42 offen offset:1024 sc1
  s_mov_b32 s42, 6295552
  s_waitcnt lgkmcnt(8)
  buffer_store_dwordx4 v[48:51], v3, s[4:7], s42 offen offset:2048 sc1
  buffer_store_dwordx4 v[52:55], v3, s[4:7], s42 offen offset:3072 sc1
  s_mov_b32 s42, 6557696
  s_waitcnt lgkmcnt(4)
  buffer_store_dwordx4 v[56:59], v3, s[4:7], s42 offen offset:0 sc1
  buffer_store_dwordx4 v[60:63], v3, s[4:7], s42 offen offset:1024 sc1
  s_mov_b32 s42, 6557696
  s_waitcnt lgkmcnt(0)
  buffer_store_dwordx4 v[64:67], v3, s[4:7], s42 offen offset:2048 sc1
  buffer_store_dwordx4 v[68:71], v3, s[4:7], s42 offen offset:3072 sc1
  s_waitcnt vmcnt(24)
  ds_read_b64_tr_b16 v[72:73], v4 offset:16384
  ds_read_b64_tr_b16 v[74:75], v4 offset:18432
  ds_read_b64_tr_b16 v[76:77], v4 offset:20480
  ds_read_b64_tr_b16 v[78:79], v4 offset:22528
  ds_read_b64_tr_b16 v[80:81], v5 offset:16384
  ds_read_b64_tr_b16 v[82:83], v5 offset:18432
  ds_read_b64_tr_b16 v[84:85], v5 offset:20480
  ds_read_b64_tr_b16 v[86:87], v5 offset:22528
  ds_read_b64_tr_b16 v[88:89], v6 offset:16384
  ds_read_b64_tr_b16 v[90:91], v6 offset:18432
  ds_read_b64_tr_b16 v[92:93], v6 offset:20480
  ds_read_b64_tr_b16 v[94:95], v6 offset:22528
  ds_read_b64_tr_b16 v[96:97], v7 offset:16384
  ds_read_b64_tr_b16 v[98:99], v7 offset:18432
  ds_read_b64_tr_b16 v[100:101], v7 offset:20480
  ds_read_b64_tr_b16 v[102:103], v7 offset:22528
  s_mov_b32 s42, 6299648
  s_waitcnt lgkmcnt(12)
  buffer_store_dwordx4 v[72:75], v3, s[4:7], s42 offen offset:0 sc1
  buffer_store_dwordx4 v[76:79], v3, s[4:7], s42 offen offset:1024 sc1
  s_mov_b32 s42, 6299648
  s_waitcnt lgkmcnt(8)
  buffer_store_dwordx4 v[80:83], v3, s[4:7], s42 offen offset:2048 sc1
  buffer_store_dwordx4 v[84:87], v3, s[4:7], s42 offen offset:3072 sc1
  s_mov_b32 s42, 6561792
  s_waitcnt lgkmcnt(4)
  buffer_store_dwordx4 v[88:91], v3, s[4:7], s42 offen offset:0 sc1
  buffer_store_dwordx4 v[92:95], v3, s[4:7], s42 offen offset:1024 sc1
  s_mov_b32 s42, 6561792
  s_waitcnt lgkmcnt(0)
  buffer_store_dwordx4 v[96:99], v3, s[4:7], s42 offen offset:2048 sc1
  buffer_store_dwordx4 v[100:103], v3, s[4:7], s42 offen offset:3072 sc1
  s_waitcnt vmcnt(24)
  ds_read_b64_tr_b16 v[104:105], v4 offset:24576
  ds_read_b64_tr_b16 v[106:107], v4 offset:26624
  ds_read_b64_tr_b16 v[108:109], v4 offset:28672
  ds_read_b64_tr_b16 v[110:111], v4 offset:30720
  ds_read_b64_tr_b16 v[112:113], v5 offset:24576
  ds_read_b64_tr_b16 v[114:115], v5 offset:26624
  ds_read_b64_tr_b16 v[116:117], v5 offset:28672
  ds_read_b64_tr_b16 v[118:119], v5 offset:30720
  ds_read_b64_tr_b16 v[120:121], v6 offset:24576
  ds_read_b64_tr_b16 v[122:123], v6 offset:26624
  ds_read_b64_tr_b16 v[124:125], v6 offset:28672
  ds_read_b64_tr_b16 v[126:127], v6 offset:30720
  ds_read_b64_tr_b16 v[128:129], v7 offset:24576
  ds_read_b64_tr_b16 v[130:131], v7 offset:26624
  ds_read_b64_tr_b16 v[132:133], v7 offset:28672
  ds_read_b64_tr_b16 v[134:135], v7 offset:30720
  s_mov_b32 s42, 6303744
  s_waitcnt lgkmcnt(12)
  buffer_store_dwordx4 v[104:107], v3, s[4:7], s42 offen offset:0 sc1
  buffer_store_dwordx4 v[108:111], v3, s[4:7], s42 offen offset:1024 sc1
  s_mov_b32 s42, 6303744
  s_waitcnt lgkmcnt(8)
  buffer_store_dwordx4 v[112:115], v3, s[4:7], s42 offen offset:2048 sc1
  buffer_store_dwordx4 v[116:119], v3, s[4:7], s42 offen offset:3072 sc1
  s_mov_b32 s42, 6565888
  s_waitcnt lgkmcnt(4)
  buffer_store_dwordx4 v[120:123], v3, s[4:7], s42 offen offset:0 sc1
  buffer_store_dwordx4 v[124:127], v3, s[4:7], s42 offen offset:1024 sc1
  s_mov_b32 s42, 6565888
  s_waitcnt lgkmcnt(0)
  buffer_store_dwordx4 v[128:131], v3, s[4:7], s42 offen offset:2048 sc1
  buffer_store_dwordx4 v[132:135], v3, s[4:7], s42 offen offset:3072 sc1
  v_min_u32 v1, 31, v0
  v_lshlrev_b32 v1, 2, v1
  v_add_u32 v1, 128, v1
  s_nop 1
Lpoll_55:
  buffer_load_dword v2, v1, s[12:15], 0 offen sc1
  s_sub_u32 s24, s24, 1
  s_cbranch_scc1 L_FAIL
  s_waitcnt vmcnt(0)
  v_cmp_gt_i32 vcc, 1, v2
  s_cbranch_vccz Lpolld_56
  s_sleep 2
  s_branch Lpoll_55
Lpolld_56:
  s_barrier
  s_lshl_b32 s40, s21, 7
  s_add_u32 s40, s40, 1432576
  s_cmp_lg_u32 s20, 0
  s_cbranch_scc1 Lnosig_57
  s_mov_b32 s63, 1
  s_atomic_smax s63, s[4:5], s40 glc
Lnosig_57:
  s_branch L_LN1
L_QK:
  v_bfe_u32 v76, v0, 3, 2
  v_xor_b32 v76, s20, v76
  v_lshlrev_b32 v76, 5, v76
  v_lshrrev_b32 v4, 2, v0
  v_lshl_add_u32 v4, v4, 7, v76
  v_and_b32 v76, 3, v0
  v_lshl_add_u32 v4, v76, 3, v4
  s_lshl_b32 s40, s20, 15
  v_add_u32 v4, s40, v4
  v_lshl_add_u32 v85, v0, 4, s40
  s_lshl_b32 s40, s20, 12
  s_add_u32 s40, s40, 131072
  v_lshl_add_u32 v1, v0, 4, s40
  s_lshr_b32 s54, s21, 4
  s_lshl_b32 s52, s54, 22
  s_sub_u32 s53, 0, s52
  v_xor_b32 v5, 32768, v4
  v_xor_b32 v2, 4096, v1
  v_xor_b32 v6, 65536, v4
  v_xor_b32 v3, 8192, v1
  v_xor_b32 v7, 98304, v4
  v_xor_b32 v84, 12288, v1
  v_bfe_u32 v8, v0, 5, 1
  v_mul_u32_u24 v8, 16384, v8
  v_bfe_u32 v76, v0, 4, 1
  v_mul_u32_u24 v76, 32768, v76
  v_add_u32 v8, v8, v76
  v_bfe_u32 v76, v0, 3, 1
  v_mul_u32_u24 v76, 131072, v76
  v_add_u32 v8, v8, v76
  v_lshrrev_b32 v76, 3, v0
  v_and_b32 v76, 6, v76
  v_xor_b32 v76, v76, v0
  v_and_b32 v76, 7, v76
  v_lshl_add_u32 v8, v76, 4, v8
  s_lshl_b32 s40, s20, 19
  v_add_u32 v8, s40, v8
  s_lshl_b32 s44, s21, 8
  s_add_u32 s45, s44, 128
  s_load_dwordx2 s[8:9], s[0:1], 16
  s_mov_b32 s10, 8388608
  s_mov_b32 s11, 0x20000
  s_waitcnt lgkmcnt(0)
  v_add_u32 v9, s44, v8
  v_add_u32 v10, s45, v8
  v_add_u32 v11, s44, v8
  v_add_u32 v12, s45, v8
  s_lshl_b32 s41, s20, 15
  s_add_u32 m0, s41, 0
  s_add_u32 s42, s52, 0
  buffer_load_dwordx4 v9, s[8:11], s42 offen lds
  s_add_u32 m0, s41, 1024
  s_add_u32 s42, s52, 65536
  buffer_load_dwordx4 v9, s[8:11], s42 offen lds
  s_add_u32 m0, s41, 2048
  s_add_u32 s42, s52, 8192
  buffer_load_dwordx4 v9, s[8:11], s42 offen lds
  s_add_u32 m0, s41, 3072
  s_add_u32 s42, s52, 73728
  buffer_load_dwordx4 v9, s[8:11], s42 offen lds
  s_add_u32 m0, s41, 4096
  s_add_u32 s42, s52, 262144
  buffer_load_dwordx4 v9, s[8:11], s42 offen lds
  s_add_u32 m0, s41, 5120
  s_add_u32 s42, s52, 327680
  buffer_load_dwordx4 v9, s[8:11], s42 offen lds
  s_add_u32 m0, s41, 6144
  s_add_u32 s42, s52, 270336
  buffer_load_dwordx4 v9, s[8:11], s42 offen lds
  s_add_u32 m0, s41, 7168
  s_add_u32 s42, s52, 335872
  buffer_load_dwordx4 v9, s[8:11], s42 offen lds
  s_add_u32 m0, s41, 8192
  s_add_u32 s42, s52, 2097152
  buffer_load_dwordx4 v9, s[8:11], s42 offen lds
  s_add_u32 m0, s41, 9216
  s_add_u32 s42, s52, 2162688
  buffer_load_dwordx4 v9, s[8:11], s42 offen lds
  s_add_u32 m0, s41, 10240
  s_add_u32 s42, s52, 2105344
  buffer_load_dwordx4 v9, s[8:11], s42 offen lds
  s_add_u32 m0, s41, 11264
  s_add_u32 s42, s52, 2170880
  buffer_load_dwordx4 v9, s[8:11], s42 offen lds
  s_add_u32 m0, s41, 12288
  s_add_u32 s42, s52, 2359296
  buffer_load_dwordx4 v9, s[8:11], s42 offen lds
  s_add_u32 m0, s41, 13312
  s_add_u32 s42, s52, 2424832
  buffer_load_dwordx4 v9, s[8:11], s42 offen lds
  s_add_u32 m0, s41, 14336
  s_add_u32 s42, s52, 2367488
  buffer_load_dwordx4 v9, s[8:11], s42 offen lds
  s_add_u32 m0, s41, 15360
  s_add_u32 s42, s52, 2433024
  buffer_load_dwordx4 v9, s[8:11], s42 offen lds
  s_add_u32 m0, s41, 16384
  s_add_u32 s42, s53, 4194304
  buffer_load_dwordx4 v9, s[8:11], s42 offen lds
  s_add_u32 m0, s41, 17408
  s_add_u32 s42, s53, 4259840
  buffer_load_dwordx4 v9, s[8:11], s42 offen lds
  s_add_u32 m0, s41, 18432
  s_add_u32 s42, s53, 4202496
  buffer_load_dwordx4 v9, s[8:11], s42 offen lds
  s_add_u32 m0, s41, 19456
  s_add_u32 s42, s53, 4268032
  buffer_load_dwordx4 v9, s[8:11], s42 offen lds
  s_add_u32 m0, s41, 20480
  s_add_u32 s42, s53, 4456448
  buffer_load_dwordx4 v9, s[8:11], s42 offen lds
  s_add_u32 m0, s41, 21504
  s_add_u32 s42, s53, 4521984
  buffer_load_dwordx4 v9, s[8:11], s42 offen lds
  s_add_u32 m0, s41, 22528
  s_add_u32 s42, s53, 4464640
  buffer_load_dwordx4 v9, s[8:11], s42 offen lds
  s_add_u32 m0, s41, 23552
  s_add_u32 s42, s53, 4530176
  buffer_load_dwordx4 v9, s[8:11], s42 offen lds
  s_waitcnt vmcnt(16) lgkmcnt(0)
  s_barrier
  s_add_u32 m0, s41, 24576
  s_add_u32 s42, s53, 6291456
  buffer_load_dwordx4 v9, s[8:11], s42 offen lds
  s_add_u32 m0, s41, 25600
  s_add_u32 s42, s53, 6356992
  buffer_load_dwordx4 v9, s[8:11], s42 offen lds
  s_add_u32 m0, s41, 26624
  s_add_u32 s42, s53, 6299648
  buffer_load_dwordx4 v9, s[8:11], s42 offen lds
  s_add_u32 m0, s41, 27648
  s_add_u32 s42, s53, 6365184
  buffer_load_dwordx4 v9, s[8:11], s42 offen lds
  s_add_u32 m0, s41, 28672
  s_add_u32 s42, s53, 6553600
  buffer_load_dwordx4 v9, s[8:11], s42 offen lds
  s_add_u32 m0, s41, 29696
  s_add_u32 s42, s53, 6619136
  buffer_load_dwordx4 v9, s[8:11], s42 offen lds
  s_add_u32 m0, s41, 30720
  s_add_u32 s42, s53, 6561792
  buffer_load_dwordx4 v9, s[8:11], s42 offen lds
  s_add_u32 m0, s41, 31744
  s_add_u32 s42, s53, 6627328
  buffer_load_dwordx4 v9, s[8:11], s42 offen lds
  ds_read_b64_tr_b16 a[0:1], v4 offset:0
  ds_read_b64_tr_b16 a[2:3], v4 offset:2048
  ds_read_b64_tr_b16 a[4:5], v4 offset:4096
  ds_read_b64_tr_b16 a[6:7], v4 offset:6144
  ds_read_b64_tr_b16 a[16:17], v5 offset:0
  ds_read_b64_tr_b16 a[18:19], v5 offset:2048
  ds_read_b64_tr_b16 a[20:21], v5 offset:4096
  ds_read_b64_tr_b16 a[22:23], v5 offset:6144
  ds_read_b64_tr_b16 a[32:33], v6 offset:0
  ds_read_b64_tr_b16 a[34:35], v6 offset:2048
  ds_read_b64_tr_b16 a[36:37], v6 offset:4096
  ds_read_b64_tr_b16 a[38:39], v6 offset:6144
  ds_read_b64_tr_b16 a[48:49], v7 offset:0
  ds_read_b64_tr_b16 a[50:51], v7 offset:2048
  ds_read_b64_tr_b16 a[52:53], v7 offset:4096
  ds_read_b64_tr_b16 a[54:55], v7 offset:6144
  s_waitcnt vmcnt(16) lgkmcnt(0)
  s_barrier
  s_add_u32 m0, s41, 0
  s_add_u32 s42, s52, 0
  buffer_load_dwordx4 v10, s[8:11], s42 offen lds
  s_add_u32 m0, s41, 1024
  s_add_u32 s42, s52, 65536
  buffer_load_dwordx4 v10, s[8:11], s42 offen lds
  s_add_u32 m0, s41, 2048
  s_add_u32 s42, s52, 8192
  buffer_load_dwordx4 v10, s[8:11], s42 offen lds
  s_add_u32 m0, s41, 3072
  s_add_u32 s42, s52, 73728
  buffer_load_dwordx4 v10, s[8:11], s42 offen lds
  s_add_u32 m0, s41, 4096
  s_add_u32 s42, s52, 262144
  buffer_load_dwordx4 v10, s[8:11], s42 offen lds
  s_add_u32 m0, s41, 5120
  s_add_u32 s42, s52, 327680
  buffer_load_dwordx4 v10, s[8:11], s42 offen lds
  s_add_u32 m0, s41, 6144
  s_add_u32 s42, s52, 270336
  buffer_load_dwordx4 v10, s[8:11], s42 offen lds
  s_add_u32 m0, s41, 7168
  s_add_u32 s42, s52, 335872
  buffer_load_dwordx4 v10, s[8:11], s42 offen lds
  ds_read_b64_tr_b16 a[8:9], v4 offset:8192
  ds_read_b64_tr_b16 a[10:11], v4 offset:10240
  ds_read_b64_tr_b16 a[12:13], v4 offset:12288
  ds_read_b64_tr_b16 a[14:15], v4 offset:14336
  ds_read_b64_tr_b16 a[24:25], v5 offset:8192
  ds_read_b64_tr_b16 a[26:27], v5 offset:10240
  ds_read_b64_tr_b16 a[28:29], v5 offset:12288
  ds_read_b64_tr_b16 a[30:31], v5 offset:14336
  ds_read_b64_tr_b16 a[40:41], v6 offset:8192
  ds_read_b64_tr_b16 a[42:43], v6 offset:10240
  ds_read_b64_tr_b16 a[44:45], v6 offset:12288
  ds_read_b64_tr_b16 a[46:47], v6 offset:14336
  ds_read_b64_tr_b16 a[56:57], v7 offset:8192
  ds_read_b64_tr_b16 a[58:59], v7 offset:10240
  ds_read_b64_tr_b16 a[60:61], v7 offset:12288
  ds_read_b64_tr_b16 a[62:63], v7 offset:14336
  s_waitcnt vmcnt(16) lgkmcnt(0)
  s_barrier
  s_add_u32 m0, s41, 8192
  s_add_u32 s42, s52, 2097152
  buffer_load_dwordx4 v10, s[8:11], s42 offen lds
  s_add_u32 m0, s41, 9216
  s_add_u32 s42, s52, 2162688
  buffer_load_dwordx4 v10, s[8:11], s42 offen lds
  s_add_u32 m0, s41, 10240
  s_add_u32 s42, s52, 2105344
  buffer_load_dwordx4 v10, s[8:11], s42 offen lds
  s_add_u32 m0, s41, 11264
  s_add_u32 s42, s52, 2170880
  buffer_load_dwordx4 v10, s[8:11], s42 offen lds
  s_add_u32 m0, s41, 12288
  s_add_u32 s42, s52, 2359296
  buffer_load_dwordx4 v10, s[8:11], s42 offen lds
  s_add_u32 m0, s41, 13312
  s_add_u32 s42, s52, 2424832
  buffer_load_dwordx4 v10, s[8:11], s42 offen lds
  s_add_u32 m0, s41, 14336
  s_add_u32 s42, s52, 2367488
  buffer_load_dwordx4 v10, s[8:11], s42 offen lds
  s_add_u32 m0, s41, 15360
  s_add_u32 s42, s52, 2433024
  buffer_load_dwordx4 v10, s[8:11], s42 offen lds
  ds_read_b64_tr_b16 a[64:65], v4 offset:16384
  ds_read_b64_tr_b16 a[66:67], v4 offset:18432
  ds_read_b64_tr_b16 a[68:69], v4 offset:20480
  ds_read_b64_tr_b16 a[70:71], v4 offset:22528
  ds_read_b64_tr_b16 a[80:81], v5 offset:16384
  ds_read_b64_tr_b16 a[82:83], v5 offset:18432
  ds_read_b64_tr_b16 a[84:85], v5 offset:20480
  ds_read_b64_tr_b16 a[86:87], v5 offset:22528
  ds_read_b64_tr_b16 a[96:97], v6 offset:16384
  ds_read_b64_tr_b16 a[98:99], v6 offset:18432
  ds_read_b64_tr_b16 a[100:101], v6 offset:20480
  ds_read_b64_tr_b16 a[102:103], v6 offset:22528
  ds_read_b64_tr_b16 a[112:113], v7 offset:16384
  ds_read_b64_tr_b16 a[114:115], v7 offset:18432
  ds_read_b64_tr_b16 a[116:117], v7 offset:20480
  ds_read_b64_tr_b16 a[118:119], v7 offset:22528
  s_waitcnt vmcnt(16) lgkmcnt(0)
  s_barrier
  s_add_u32 m0, s41, 16384
  s_add_u32 s42, s53, 4194304
  buffer_load_dwordx4 v10, s[8:11], s42 offen lds
  s_add_u32 m0, s41, 17408
  s_add_u32 s42, s53, 4259840
  buffer_load_dwordx4 v10, s[8:11], s42 offen lds
  s_add_u32 m0, s41, 18432
  s_add_u32 s42, s53, 4202496
  buffer_load_dwordx4 v10, s[8:11], s42 offen lds
  s_add_u32 m0, s41, 19456
  s_add_u32 s42, s53, 4268032
  buffer_load_dwordx4 v10, s[8:11], s42 offen lds
  s_add_u32 m0, s41, 20480
  s_add_u32 s42, s53, 4456448
  buffer_load_dwordx4 v10, s[8:11], s42 offen lds
  s_add_u32 m0, s41, 21504
  s_add_u32 s42, s53, 4521984
  buffer_load_dwordx4 v10, s[8:11], s42 offen lds
  s_add_u32 m0, s41, 22528
  s_add_u32 s42, s53, 4464640
  buffer_load_dwordx4 v10, s[8:11], s42 offen lds
  s_add_u32 m0, s41, 23552
  s_add_u32 s42, s53, 4530176
  buffer_load_dwordx4 v10, s[8:11], s42 offen lds
  ds_read_b64_tr_b16 a[72:73], v4 offset:24576
  ds_read_b64_tr_b16 a[74:75], v4 offset:26624
  ds_read_b64_tr_b16 a[76:77], v4 offset:28672
  ds_read_b64_tr_b16 a[78:79], v4 offset:30720
  ds_read_b64_tr_b16 a[88:89], v5 offset:24576
  ds_read_b64_tr_b16 a[90:91], v5 offset:26624
  ds_read_b64_tr_b16 a[92:93], v5 offset:28672
  ds_read_b64_tr_b16 a[94:95], v5 offset:30720
  ds_read_b64_tr_b16 a[104:105], v6 offset:24576
  ds_read_b64_tr_b16 a[106:107], v6 offset:26624
  ds_read_b64_tr_b16 a[108:109], v6 offset:28672
  ds_read_b64_tr_b16 a[110:111], v6 offset:30720
  ds_read_b64_tr_b16 a[120:121], v7 offset:24576
  ds_read_b64_tr_b16 a[122:123], v7 offset:26624
  ds_read_b64_tr_b16 a[124:125], v7 offset:28672
  ds_read_b64_tr_b16 a[126:127], v7 offset:30720
  s_waitcnt vmcnt(16) lgkmcnt(0)
  s_barrier
  s_add_u32 m0, s41, 24576
  s_add_u32 s42, s53, 6291456
  buffer_load_dwordx4 v10, s[8:11], s42 offen lds
  s_add_u32 m0, s41, 25600
  s_add_u32 s42, s53, 6356992
  buffer_load_dwordx4 v10, s[8:11], s42 offen lds
  s_add_u32 m0, s41, 26624
  s_add_u32 s42, s53, 6299648
  buffer_load_dwordx4 v10, s[8:11], s42 offen lds
  s_add_u32 m0, s41, 27648
  s_add_u32 s42, s53, 6365184
  buffer_load_dwordx4 v10, s[8:11], s42 offen lds
  s_add_u32 m0, s41, 28672
  s_add_u32 s42, s53, 6553600
  buffer_load_dwordx4 v10, s[8:11], s42 offen lds
  s_add_u32 m0, s41, 29696
  s_add_u32 s42, s53, 6619136
  buffer_load_dwordx4 v10, s[8:11], s42 offen lds
  s_add_u32 m0, s41, 30720
  s_add_u32 s42, s53, 6561792
  buffer_load_dwordx4 v10, s[8:11], s42 offen lds
  s_add_u32 m0, s41, 31744
  s_add_u32 s42, s53, 6627328
  buffer_load_dwordx4 v10, s[8:11], s42 offen lds
  ds_read_b64_tr_b16 a[128:129], v4 offset:0
  ds_read_b64_tr_b16 a[130:131], v4 offset:2048
  ds_read_b64_tr_b16 a[132:133], v4 offset:4096
  ds_read_b64_tr_b16 a[134:135], v4 offset:6144
  ds_read_b64_tr_b16 a[144:145], v5 offset:0
  ds_read_b64_tr_b16 a[146:147], v5 offset:2048
  ds_read_b64_tr_b16 a[148:149], v5 offset:4096
  ds_read_b64_tr_b16 a[150:151], v5 offset:6144
  ds_read_b64_tr_b16 a[160:161], v6 offset:0
  ds_read_b64_tr_b16 a[162:163], v6 offset:2048
  ds_read_b64_tr_b16 a[164:165], v6 offset:4096
  ds_read_b64_tr_b16 a[166:167], v6 offset:6144
  ds_read_b64_tr_b16 a[176:177], v7 offset:0
  ds_read_b64_tr_b16 a[178:179], v7 offset:2048
  ds_read_b64_tr_b16 a[180:181], v7 offset:4096
  ds_read_b64_tr_b16 a[182:183], v7 offset:6144
  s_waitcnt vmcnt(16) lgkmcnt(0)
  s_barrier
  s_load_dwordx2 s[8:9], s[0:1], 24
  s_mov_b32 s10, 8388608
  s_mov_b32 s11, 0x20000
  s_waitcnt lgkmcnt(0)
  s_add_u32 m0, s41, 0
  s_add_u32 s42, s52, 0
  buffer_load_dwordx4 v11, s[8:11], s42 offen lds
  s_add_u32 m0, s41, 1024
  s_add_u32 s42, s52, 65536
  buffer_load_dwordx4 v11, s[8:11], s42 offen lds
  s_add_u32 m0, s41, 2048
  s_add_u32 s42, s52, 8192
  buffer_load_dwordx4 v11, s[8:11], s42 offen lds
  s_add_u32 m0, s41, 3072
  s_add_u32 s42, s52, 73728
  buffer_load_dwordx4 v11, s[8:11], s42 offen lds
  s_add_u32 m0, s41, 4096
  s_add_u32 s42, s52, 262144
  buffer_load_dwordx4 v11, s[8:11], s42 offen lds
  s_add_u32 m0, s41, 5120
  s_add_u32 s42, s52, 327680
  buffer_load_dwordx4 v11, s[8:11], s42 offen lds
  s_add_u32 m0, s41, 6144
  s_add_u32 s42, s52, 270336
  buffer_load_dwordx4 v11, s[8:11], s42 offen lds
  s_add_u32 m0, s41, 7168
  s_add_u32 s42, s52, 335872
  buffer_load_dwordx4 v11, s[8:11], s42 offen lds
  ds_read_b64_tr_b16 a[136:137], v4 offset:8192
  ds_read_b64_tr_b16 a[138:139], v4 offset:10240
  ds_read_b64_tr_b16 a[140:141], v4 offset:12288
  ds_read_b64_tr_b16 a[142:143], v4 offset:14336
  ds_read_b64_tr_b16 a[152:153], v5 offset:8192
  ds_read_b64_tr_b16 a[154:155], v5 offset:10240
  ds_read_b64_tr_b16 a[156:157], v5 offset:12288
  ds_read_b64_tr_b16 a[158:159], v5 offset:14336
  ds_read_b64_tr_b16 a[168:169], v6 offset:8192
  ds_read_b64_tr_b16 a[170:171], v6 offset:10240
  ds_read_b64_tr_b16 a[172:173], v6 offset:12288
  ds_read_b64_tr_b16 a[174:175], v6 offset:14336
  ds_read_b64_tr_b16 a[184:185], v7 offset:8192
  ds_read_b64_tr_b16 a[186:187], v7 offset:10240
  ds_read_b64_tr_b16 a[188:189], v7 offset:12288
  ds_read_b64_tr_b16 a[190:191], v7 offset:14336
  s_waitcnt vmcnt(16) lgkmcnt(0)
  s_barrier
  s_add_u32 m0, s41, 8192
  s_add_u32 s42, s52, 2097152
  buffer_load_dwordx4 v11, s[8:11], s42 offen lds
  s_add_u32 m0, s41, 9216
  s_add_u32 s42, s52, 2162688
  buffer_load_dwordx4 v11, s[8:11], s42 offen lds
  s_add_u32 m0, s41, 10240
  s_add_u32 s42, s52, 2105344
  buffer_load_dwordx4 v11, s[8:11], s42 offen lds
  s_add_u32 m0, s41, 11264
  s_add_u32 s42, s52, 2170880
  buffer_load_dwordx4 v11, s[8:11], s42 offen lds
  s_add_u32 m0, s41, 12288
  s_add_u32 s42, s52, 2359296
  buffer_load_dwordx4 v11, s[8:11], s42 offen lds
  s_add_u32 m0, s41, 13312
  s_add_u32 s42, s52, 2424832
  buffer_load_dwordx4 v11, s[8:11], s42 offen lds
  s_add_u32 m0, s41, 14336
  s_add_u32 s42, s52, 2367488
  buffer_load_dwordx4 v11, s[8:11], s42 offen lds
  s_add_u32 m0, s41, 15360
  s_add_u32 s42, s52, 2433024
  buffer_load_dwordx4 v11, s[8:11], s42 offen lds
  ds_read_b64_tr_b16 a[192:193], v4 offset:16384
  ds_read_b64_tr_b16 a[194:195], v4 offset:18432
  ds_read_b64_tr_b16 a[196:197], v4 offset:20480
  ds_read_b64_tr_b16 a[198:199], v4 offset:22528
  ds_read_b64_tr_b16 a[208:209], v5 offset:16384
  ds_read_b64_tr_b16 a[210:211], v5 offset:18432
  ds_read_b64_tr_b16 a[212:213], v5 offset:20480
  ds_read_b64_tr_b16 a[214:215], v5 offset:22528
  ds_read_b64_tr_b16 a[224:225], v6 offset:16384
  ds_read_b64_tr_b16 a[226:227], v6 offset:18432
  ds_read_b64_tr_b16 a[228:229], v6 offset:20480
  ds_read_b64_tr_b16 a[230:231], v6 offset:22528
  ds_read_b64_tr_b16 a[240:241], v7 offset:16384
  ds_read_b64_tr_b16 a[242:243], v7 offset:18432
  ds_read_b64_tr_b16 a[244:245], v7 offset:20480
  ds_read_b64_tr_b16 a[246:247], v7 offset:22528
  s_waitcnt vmcnt(16) lgkmcnt(0)
  s_barrier
  s_add_u32 m0, s41, 16384
  s_add_u32 s42, s53, 4194304
  buffer_load_dwordx4 v11, s[8:11], s42 offen lds
  s_add_u32 m0, s41, 17408
  s_add_u32 s42, s53, 4259840
  buffer_load_dwordx4 v11, s[8:11], s42 offen lds
  s_add_u32 m0, s41, 18432
  s_add_u32 s42, s53, 4202496
  buffer_load_dwordx4 v11, s[8:11], s42 offen lds
  s_add_u32 m0, s41, 19456
  s_add_u32 s42, s53, 4268032
  buffer_load_dwordx4 v11, s[8:11], s42 offen lds
  s_add_u32 m0, s41, 20480
  s_add_u32 s42, s53, 4456448
  buffer_load_dwordx4 v11, s[8:11], s42 offen lds
  s_add_u32 m0, s41, 21504
  s_add_u32 s42, s53, 4521984
  buffer_load_dwordx4 v11, s[8:11], s42 offen lds
  s_add_u32 m0, s41, 22528
  s_add_u32 s42, s53, 4464640
  buffer_load_dwordx4 v11, s[8:11], s42 offen lds
  s_add_u32 m0, s41, 23552
  s_add_u32 s42, s53, 4530176
  buffer_load_dwordx4 v11, s[8:11], s42 offen lds
  ds_read_b64_tr_b16 a[200:201], v4 offset:24576
  ds_read_b64_tr_b16 a[202:203], v4 offset:26624
  ds_read_b64_tr_b16 a[204:205], v4 offset:28672
  ds_read_b64_tr_b16 a[206:207], v4 offset:30720
  ds_read_b64_tr_b16 a[216:217], v5 offset:24576
  ds_read_b64_tr_b16 a[218:219], v5 offset:26624
  ds_read_b64_tr_b16 a[220:221], v5 offset:28672
  ds_read_b64_tr_b16 a[222:223], v5 offset:30720
  ds_read_b64_tr_b16 a[232:233], v6 offset:24576
  ds_read_b64_tr_b16 a[234:235], v6 offset:26624
  ds_read_b64_tr_b16 a[236:237], v6 offset:28672
  ds_read_b64_tr_b16 a[238:239], v6 offset:30720
  ds_read_b64_tr_b16 a[248:249], v7 offset:24576
  ds_read_b64_tr_b16 a[250:251], v7 offset:26624
  ds_read_b64_tr_b16 a[252:253], v7 offset:28672
  ds_read_b64_tr_b16 a[254:255], v7 offset:30720
  s_waitcnt vmcnt(16) lgkmcnt(0)
  s_barrier
  s_add_u32 m0, s41, 24576
  s_add_u32 s42, s53, 6291456
  buffer_load_dwordx4 v11, s[8:11], s42 offen lds
  s_add_u32 m0, s41, 25600
  s_add_u32 s42, s53, 6356992
  buffer_load_dwordx4 v11, s[8:11], s42 offen lds
  s_add_u32 m0, s41, 26624
  s_add_u32 s42, s53, 6299648
  buffer_load_dwordx4 v11, s[8:11], s42 offen lds
  s_add_u32 m0, s41, 27648
  s_add_u32 s42, s53, 6365184
  buffer_load_dwordx4 v11, s[8:11], s42 offen lds
  s_add_u32 m0, s41, 28672
  s_add_u32 s42, s53, 6553600
  buffer_load_dwordx4 v11, s[8:11], s42 offen lds
  s_add_u32 m0, s41, 29696
  s_add_u32 s42, s53, 6619136
  buffer_load_dwordx4 v11, s[8:11], s42 offen lds
  s_add_u32 m0, s41, 30720
  s_add_u32 s42, s53, 6561792
  buffer_load_dwordx4 v11, s[8:11], s42 offen lds
  s_add_u32 m0, s41, 31744
  s_add_u32 s42, s53, 6627328
  buffer_load_dwordx4 v11, s[8:11], s42 offen lds
  ds_read_b64_tr_b16 v[128:129], v4 offset:0
  ds_read_b64_tr_b16 v[130:131], v4 offset:2048
  ds_read_b64_tr_b16 v[132:133], v4 offset:4096
  ds_read_b64_tr_b16 v[134:135], v4 offset:6144
  ds_read_b64_tr_b16 v[144:145], v5 offset:0
  ds_read_b64_tr_b16 v[146:147], v5 offset:2048
  ds_read_b64_tr_b16 v[148:149], v5 offset:4096
  ds_read_b64_tr_b16 v[150:151], v5 offset:6144
  ds_read_b64_tr_b16 v[160:161], v6 offset:0
  ds_read_b64_tr_b16 v[162:163], v6 offset:2048
  ds_read_b64_tr_b16 v[164:165], v6 offset:4096
  ds_read_b64_tr_b16 v[166:167], v6 offset:6144
  ds_read_b64_tr_b16 v[176:177], v7 offset:0
  ds_read_b64_tr_b16 v[178:179], v7 offset:2048
  ds_read_b64_tr_b16 v[180:181], v7 offset:4096
  ds_read_b64_tr_b16 v[182:183], v7 offset:6144
  s_waitcnt vmcnt(16) lgkmcnt(0)
  s_barrier
  s_add_u32 m0, s41, 0
  s_add_u32 s42, s52, 0
  buffer_load_dwordx4 v12, s[8:11], s42 offen lds
  s_add_u32 m0, s41, 1024
  s_add_u32 s42, s52, 65536
  buffer_load_dwordx4 v12, s[8:11], s42 offen lds
  s_add_u32 m0, s41, 2048
  s_add_u32 s42, s52, 8192
  buffer_load_dwordx4 v12, s[8:11], s42 offen lds
  s_add_u32 m0, s41, 3072
  s_add_u32 s42, s52, 73728
  buffer_load_dwordx4 v12, s[8:11], s42 offen lds
  s_add_u32 m0, s41, 4096
  s_add_u32 s42, s52, 262144
  buffer_load_dwordx4 v12, s[8:11], s42 offen lds
  s_add_u32 m0, s41, 5120
  s_add_u32 s42, s52, 327680
  buffer_load_dwordx4 v12, s[8:11], s42 offen lds
  s_add_u32 m0, s41, 6144
  s_add_u32 s42, s52, 270336
  buffer_load_dwordx4 v12, s[8:11], s42 offen lds
  s_add_u32 m0, s41, 7168
  s_add_u32 s42, s52, 335872
  buffer_load_dwordx4 v12, s[8:11], s42 offen lds
  ds_read_b64_tr_b16 v[136:137], v4 offset:8192
  ds_read_b64_tr_b16 v[138:139], v4 offset:10240
  ds_read_b64_tr_b16 v[140:141], v4 offset:12288
  ds_read_b64_tr_b16 v[142:143], v4 offset:14336
  ds_read_b64_tr_b16 v[152:153], v5 offset:8192
  ds_read_b64_tr_b16 v[154:155], v5 offset:10240
  ds_read_b64_tr_b16 v[156:157], v5 offset:12288
  ds_read_b64_tr_b16 v[158:159], v5 offset:14336
  ds_read_b64_tr_b16 v[168:169], v6 offset:8192
  ds_read_b64_tr_b16 v[170:171], v6 offset:10240
  ds_read_b64_tr_b16 v[172:173], v6 offset:12288
  ds_read_b64_tr_b16 v[174:175], v6 offset:14336
  ds_read_b64_tr_b16 v[184:185], v7 offset:8192
  ds_read_b64_tr_b16 v[186:187], v7 offset:10240
  ds_read_b64_tr_b16 v[188:189], v7 offset:12288
  ds_read_b64_tr_b16 v[190:191], v7 offset:14336
  s_cmp_lg_u32 s20, 0
  s_cbranch_scc1 Lchore_58
Lini_59:
  s_load_dwordx16 s[64:79], s[12:13], 128 glc
  s_load_dwordx16 s[80:95], s[12:13], 192 glc
  s_sub_u32 s24, s24, 1
  s_cbranch_scc1 L_FAIL
  s_waitcnt lgkmcnt(0)
  s_and_b64 s[64:65], s[64:65], s[66:67]
  s_and_b64 s[64:65], s[64:65], s[68:69]
  s_and_b64 s[64:65], s[64:65], s[70:71]
  s_and_b64 s[64:65], s[64:65], s[72:73]
  s_and_b64 s[64:65], s[64:65], s[74:75]
  s_and_b64 s[64:65], s[64:65], s[76:77]
  s_and_b64 s[64:65], s[64:65], s[78:79]
  s_and_b64 s[64:65], s[64:65], s[80:81]
  s_and_b64 s[64:65], s[64:65], s[82:83]
  s_and_b64 s[64:65], s[64:65], s[84:85]
  s_and_b64 s[64:65], s[64:65], s[86:87]
  s_and_b64 s[64:65], s[64:65], s[88:89]
  s_and_b64 s[64:65], s[64:65], s[90:91]
  s_and_b64 s[64:65], s[64:65], s[92:93]
  s_and_b64 s[64:65], s[64:65], s[94:95]
  s_and_b32 s64, s64, s65
  s_cbranch_scc0 Lini_59
  s_mov_b32 s46, 0xffff
  s_and_b32 s40, s21, 3
  s_lshl_b32 s40, s40, 13
  s_lshr_b32 s43, s21, 2
  s_lshl_b32 s43, s43, 10
  s_add_u32 s43, s43, s40
  s_add_u32 s43, s43, 1343488
  s_waitcnt lgkmcnt(0)
  s_memtime s[64:65]
  s_waitcnt lgkmcnt(0)
  s_load_dword s68, s[4:5], s43 glc
  s_waitcnt lgkmcnt(0)
  s_memtime s[66:67]
  s_waitcnt lgkmcnt(0)
  s_sub_u32 s64, s66, s64
  s_min_u32 s46, s46, s64
Lchore_58:
  s_waitcnt vmcnt(16) lgkmcnt(0)
  s_barrier
  s_add_u32 m0, s41, 8192
  s_add_u32 s42, s52, 2097152
  buffer_load_dwordx4 v12, s[8:11], s42 offen lds
  s_add_u32 m0, s41, 9216
  s_add_u32 s42, s52, 2162688
  buffer_load_dwordx4 v12, s[8:11], s42 offen lds
  s_add_u32 m0, s41, 10240
  s_add_u32 s42, s52, 2105344
  buffer_load_dwordx4 v12, s[8:11], s42 offen lds
  s_add_u32 m0, s41, 11264
  s_add_u32 s42, s52, 2170880
  buffer_load_dwordx4 v12, s[8:11], s42 offen lds
  s_add_u32 m0, s41, 12288
  s_add_u32 s42, s52, 2359296
  buffer_load_dwordx4 v12, s[8:11], s42 offen lds
  s_add_u32 m0, s41, 13312
  s_add_u32 s42, s52, 2424832
  buffer_load_dwordx4 v12, s[8:11], s42 offen lds
  s_add_u32 m0, s41, 14336
  s_add_u32 s42, s52, 2367488
  buffer_load_dwordx4 v12, s[8:11], s42 offen lds
  s_add_u32 m0, s41, 15360
  s_add_u32 s42, s52, 2433024
  buffer_load_dwordx4 v12, s[8:11], s42 offen lds
  ds_read_b64_tr_b16 v[192:193], v4 offset:16384
  ds_read_b64_tr_b16 v[194:195], v4 offset:18432
  ds_read_b64_tr_b16 v[196:197], v4 offset:20480
  ds_read_b64_tr_b16 v[198:199], v4 offset:22528
  ds_read_b64_tr_b16 v[208:209], v5 offset:16384
  ds_read_b64_tr_b16 v[210:211], v5 offset:18432
  ds_read_b64_tr_b16 v[212:213], v5 offset:20480
  ds_read_b64_tr_b16 v[214:215], v5 offset:22528
  ds_read_b64_tr_b16 v[224:225], v6 offset:16384
  ds_read_b64_tr_b16 v[226:227], v6 offset:18432
  ds_read_b64_tr_b16 v[228:229], v6 offset:20480
  ds_read_b64_tr_b16 v[230:231], v6 offset:22528
  ds_read_b64_tr_b16 v[240:241], v7 offset:16384
  ds_read_b64_tr_b16 v[242:243], v7 offset:18432
  ds_read_b64_tr_b16 v[244:245], v7 offset:20480
  ds_read_b64_tr_b16 v[246:247], v7 offset:22528
  s_cmp_lg_u32 s20, 0
  s_cbranch_scc1 Lchore_60
  s_waitcnt lgkmcnt(0)
  s_memtime s[64:65]
  s_waitcnt lgkmcnt(0)
  s_load_dword s68, s[4:5], s43 glc
  s_waitcnt lgkmcnt(0)
  s_memtime s[66:67]
  s_waitcnt lgkmcnt(0)
  s_sub_u32 s64, s66, s64
  s_min_u32 s46, s46, s64
  s_getreg_b32 s55, hwreg(HW_REG_XCC_ID)
  s_and_b32 s55, s55, 15
  s_lshl_b32 s46, s46, 8
  s_or_b32 s46, s46, s55
  s_add_u32 s40, s21, 0
  s_lshl_b32 s40, s40, 7
  s_add_u32 s40, s40, 1424384
  s_mov_b32 s63, s46
  s_atomic_smax s63, s[4:5], s40 glc
Lnosig_61:
Lchore_60:
  s_waitcnt vmcnt(16) lgkmcnt(0)
  s_barrier
  s_add_u32 m0, s41, 16384
  s_add_u32 s42, s53, 4194304
  buffer_load_dwordx4 v12, s[8:11], s42 offen lds
  s_add_u32 m0, s41, 17408
  s_add_u32 s42, s53, 4259840
  buffer_load_dwordx4 v12, s[8:11], s42 offen lds
  s_add_u32 m0, s41, 18432
  s_add_u32 s42, s53, 4202496
  buffer_load_dwordx4 v12, s[8:11], s42 offen lds
  s_add_u32 m0, s41, 19456
  s_add_u32 s42, s53, 4268032
  buffer_load_dwordx4 v12, s[8:11], s42 offen lds
  s_add_u32 m0, s41, 20480
  s_add_u32 s42, s53, 4456448
  buffer_load_dwordx4 v12, s[8:11], s42 offen lds
  s_add_u32 m0, s41, 21504
  s_add_u32 s42, s53, 4521984
  buffer_load_dwordx4 v12, s[8:11], s42 offen lds
  s_add_u32 m0, s41, 22528
  s_add_u32 s42, s53, 4464640
  buffer_load_dwordx4 v12, s[8:11], s42 offen lds
  s_add_u32 m0, s41, 23552
  s_add_u32 s42, s53, 4530176
  buffer_load_dwordx4 v12, s[8:11], s42 offen lds
  ds_read_b64_tr_b16 v[200:201], v4 offset:24576
  ds_read_b64_tr_b16 v[202:203], v4 offset:26624
  ds_read_b64_tr_b16 v[204:205], v4 offset:28672
  ds_read_b64_tr_b16 v[206:207], v4 offset:30720
  ds_read_b64_tr_b16 v[216:217], v5 offset:24576
  ds_read_b64_tr_b16 v[218:219], v5 offset:26624
  ds_read_b64_tr_b16 v[220:221], v5 offset:28672
  ds_read_b64_tr_b16 v[222:223], v5 offset:30720
  ds_read_b64_tr_b16 v[232:233], v6 offset:24576
  ds_read_b64_tr_b16 v[234:235], v6 offset:26624
  ds_read_b64_tr_b16 v[236:237], v6 offset:28672
  ds_read_b64_tr_b16 v[238:239], v6 offset:30720
  ds_read_b64_tr_b16 v[248:249], v7 offset:24576
  ds_read_b64_tr_b16 v[250:251], v7 offset:26624
  ds_read_b64_tr_b16 v[252:253], v7 offset:28672
  ds_read_b64_tr_b16 v[254:255], v7 offset:30720
  s_waitcnt vmcnt(16) lgkmcnt(0)
  s_barrier
  s_add_u32 m0, s41, 24576
  s_add_u32 s42, s53, 6291456
  buffer_load_dwordx4 v12, s[8:11], s42 offen lds
  s_add_u32 m0, s41, 25600
  s_add_u32 s42, s53, 6356992
  buffer_load_dwordx4 v12, s[8:11], s42 offen lds
  s_add_u32 m0, s41, 26624
  s_add_u32 s42, s53, 6299648
  buffer_load_dwordx4 v12, s[8:11], s42 offen lds
  s_add_u32 m0, s41, 27648
  s_add_u32 s42, s53, 6365184
  buffer_load_dwordx4 v12, s[8:11], s42 offen lds
  s_add_u32 m0, s41, 28672
  s_add_u32 s42, s53, 6553600
  buffer_load_dwordx4 v12, s[8:11], s42 offen lds
  s_add_u32 m0, s41, 29696
  s_add_u32 s42, s53, 6619136
  buffer_load_dwordx4 v12, s[8:11], s42 offen lds
  s_add_u32 m0, s41, 30720
  s_add_u32 s42, s53, 6561792
  buffer_load_dwordx4 v12, s[8:11], s42 offen lds
  s_add_u32 m0, s41, 31744
  s_add_u32 s42, s53, 6627328
  buffer_load_dwordx4 v12, s[8:11], s42 offen lds
  ds_read_b64_tr_b16 v[20:21], v4 offset:0
  ds_read_b64_tr_b16 v[22:23], v4 offset:2048
  ds_read_b64_tr_b16 v[24:25], v4 offset:4096
  ds_read_b64_tr_b16 v[26:27], v4 offset:6144
  ds_read_b64_tr_b16 v[28:29], v5 offset:0
  ds_read_b64_tr_b16 v[30:31], v5 offset:2048
  ds_read_b64_tr_b16 v[32:33], v5 offset:4096
  ds_read_b64_tr_b16 v[34:35], v5 offset:6144
  ds_read_b64_tr_b16 v[36:37], v6 offset:0
  ds_read_b64_tr_b16 v[38:39], v6 offset:2048
  ds_read_b64_tr_b16 v[40:41], v6 offset:4096
  ds_read_b64_tr_b16 v[42:43], v6 offset:6144
  ds_read_b64_tr_b16 v[44:45], v7 offset:0
  ds_read_b64_tr_b16 v[46:47], v7 offset:2048
  ds_read_b64_tr_b16 v[48:49], v7 offset:4096
  ds_read_b64_tr_b16 v[50:51], v7 offset:6144
  s_waitcnt lgkmcnt(0)
  s_barrier
  ds_write_b128 v85, v[20:23] offset:0
  ds_write_b128 v85, v[24:27] offset:1024
  ds_write_b128 v85, v[28:31] offset:2048
  ds_write_b128 v85, v[32:35] offset:3072
  ds_write_b128 v85, v[36:39] offset:4096
  ds_write_b128 v85, v[40:43] offset:5120
  ds_write_b128 v85, v[44:47] offset:6144
  ds_write_b128 v85, v[48:51] offset:7168
  s_waitcnt vmcnt(16) lgkmcnt(0)
  s_barrier
  ds_read_b64_tr_b16 v[20:21], v4 offset:8192
  ds_read_b64_tr_b16 v[22:23], v4 offset:10240
  ds_read_b64_tr_b16 v[24:25], v4 offset:12288
  ds_read_b64_tr_b16 v[26:27], v4 offset:14336
  ds_read_b64_tr_b16 v[28:29], v5 offset:8192
  ds_read_b64_tr_b16 v[30:31], v5 offset:10240
  ds_read_b64_tr_b16 v[32:33], v5 offset:12288
  ds_read_b64_tr_b16 v[34:35], v5 offset:14336
  ds_read_b64_tr_b16 v[36:37], v6 offset:8192
  ds_read_b64_tr_b16 v[38:39], v6 offset:10240
  ds_read_b64_tr_b16 v[40:41], v6 offset:12288
  ds_read_b64_tr_b16 v[42:43], v6 offset:14336
  ds_read_b64_tr_b16 v[44:45], v7 offset:8192
  ds_read_b64_tr_b16 v[46:47], v7 offset:10240
  ds_read_b64_tr_b16 v[48:49], v7 offset:12288
  ds_read_b64_tr_b16 v[50:51], v7 offset:14336
  s_waitcnt lgkmcnt(0)
  s_barrier
  ds_write_b128 v85, v[20:23] offset:8192
  ds_write_b128 v85, v[24:27] offset:9216
  ds_write_b128 v85, v[28:31] offset:10240
  ds_write_b128 v85, v[32:35] offset:11264
  ds_write_b128 v85, v[36:39] offset:12288
  ds_write_b128 v85, v[40:43] offset:13312
  ds_write_b128 v85, v[44:47] offset:14336
  ds_write_b128 v85, v[48:51] offset:15360
  s_waitcnt vmcnt(8) lgkmcnt(0)
  s_barrier
  ds_read_b64_tr_b16 v[20:21], v4 offset:16384
  ds_read_b64_tr_b16 v[22:23], v4 offset:18432
  ds_read_b64_tr_b16 v[24:25], v4 offset:20480
  ds_read_b64_tr_b16 v[26:27], v4 offset:22528
  ds_read_b64_tr_b16 v[28:29], v5 offset:16384
  ds_read_b64_tr_b16 v[30:31], v5 offset:18432
  ds_read_b64_tr_b16 v[32:33], v5 offset:20480
  ds_read_b64_tr_b16 v[34:35], v5 offset:22528
  ds_read_b64_tr_b16 v[36:37], v6 offset:16384
  ds_read_b64_tr_b16 v[38:39], v6 offset:18432
  ds_read_b64_tr_b16 v[40:41], v6 offset:20480
  ds_read_b64_tr_b16 v[42:43], v6 offset:22528
  ds_read_b64_tr_b16 v[44:45], v7 offset:16384
  ds_read_b64_tr_b16 v[46:47], v7 offset:18432
  ds_read_b64_tr_b16 v[48:49], v7 offset:20480
  ds_read_b64_tr_b16 v[50:51], v7 offset:22528
  s_waitcnt lgkmcnt(0)
  s_barrier
  ds_write_b128 v85, v[20:23] offset:16384
  ds_write_b128 v85, v[24:27] offset:17408
  ds_write_b128 v85, v[28:31] offset:18432
  ds_write_b128 v85, v[32:35] offset:19456
  ds_write_b128 v85, v[36:39] offset:20480
  ds_write_b128 v85, v[40:43] offset:21504
  ds_write_b128 v85, v[44:47] offset:22528
  ds_write_b128 v85, v[48:51] offset:23552
  s_waitcnt vmcnt(0) lgkmcnt(0)
  s_barrier
  ds_read_b64_tr_b16 v[20:21], v4 offset:24576
  ds_read_b64_tr_b16 v[22:23], v4 offset:26624
  ds_read_b64_tr_b16 v[24:25], v4 offset:28672
  ds_read_b64_tr_b16 v[26:27], v4 offset:30720
  ds_read_b64_tr_b16 v[28:29], v5 offset:24576
  ds_read_b64_tr_b16 v[30:31], v5 offset:26624
  ds_read_b64_tr_b16 v[32:33], v5 offset:28672
  ds_read_b64_tr_b16 v[34:35], v5 offset:30720
  ds_read_b64_tr_b16 v[36:37], v6 offset:24576
  ds_read_b64_tr_b16 v[38:39], v6 offset:26624
  ds_read_b64_tr_b16 v[40:41], v6 offset:28672
  ds_read_b64_tr_b16 v[42:43], v6 offset:30720
  ds_read_b64_tr_b16 v[44:45], v7 offset:24576
  ds_read_b64_tr_b16 v[46:47], v7 offset:26624
  ds_read_b64_tr_b16 v[48:49], v7 offset:28672
  ds_read_b64_tr_b16 v[50:51], v7 offset:30720
  s_waitcnt lgkmcnt(0)
  s_barrier
  ds_write_b128 v85, v[20:23] offset:24576
  ds_write_b128 v85, v[24:27] offset:25600
  ds_write_b128 v85, v[28:31] offset:26624
  ds_write_b128 v85, v[32:35] offset:27648
  ds_write_b128 v85, v[36:39] offset:28672
  ds_write_b128 v85, v[40:43] offset:29696
  ds_write_b128 v85, v[44:47] offset:30720
  ds_write_b128 v85, v[48:51] offset:31744
  s_waitcnt lgkmcnt(0)
  s_getreg_b32 s55, hwreg(HW_REG_XCC_ID)
  s_and_b32 s55, s55, 15
  v_min_u32 v76, 63, v0
  v_lshlrev_b32 v76, 7, v76
  v_add_u32 v76, 1424384, v76
  s_nop 1
Lpoll_62:
  buffer_load_dword v77, v76, s[4:7], 0 offen sc1
  s_sub_u32 s24, s24, 1
  s_cbranch_scc1 L_FAIL
  s_waitcnt vmcnt(0)
  v_cmp_gt_i32 vcc, 0, v77
  s_cbranch_vccz Lpolld_63
  s_sleep 1
  s_branch Lpoll_62
Lpolld_63:
  v_and_b32 v78, 15, v77
  v_cmp_ne_u32 vcc, s55, v78
  s_lshl_b32 s40, s54, 4
  s_lshl_b32 s40, 0xffff, s40
  s_or_b32 s41, vcc_lo, vcc_hi
  s_and_b32 s40, s40, s41
  s_cselect_b32 s36, 0, 8192
  v_lshrrev_b32 v77, 8, v77
  v_and_b32 v78, 3, v0
  v_lshl_or_b32 v77, v77, 2, v78
  s_nop 1
  v_min_u32_dpp v77, v77, v77 row_ror:8 row_mask:0xf bank_mask:0xf
  s_nop 1
  v_min_u32_dpp v77, v77, v77 row_ror:4 row_mask:0xf bank_mask:0xf
  v_mov_b32 v78, v77
  s_nop 1
  v_permlane16_swap_b32 v78, v77
  v_min_u32 v77, v77, v78
  v_mov_b32 v78, v77
  s_nop 1
  v_permlane32_swap_b32 v78, v77
  v_min_u32 v77, v77, v78
  s_nop 1
  v_min_u32_dpp v77, v77, v77 row_ror:2 row_mask:0xf bank_mask:0xf
  s_nop 1
  v_min_u32_dpp v77, v77, v77 row_ror:1 row_mask:0xf bank_mask:0xf
  s_nop 0
  v_readfirstlane_b32 s26, v77
  s_and_b32 s26, s26, 3
  s_lshl_b32 s26, s26, 13
  s_lshr_b32 s40, s20, 1
  s_mul_i32 s40, s40, 32768
  s_and_b32 s41, s20, 1
  s_lshl_b32 s41, s41, 10
  s_add_u32 s40, s40, s41
  s_lshl_b32 s41, s54, 12
  s_add_u32 s40, s40, s41
  v_lshl_add_u32 v86, v0, 4, s40
  v_xor_b32 v87, 0x1000, v86
  v_and_b32 v76, 2, v0
  v_cmp_eq_u32 vcc, 0, v76
  v_mov_b32 v76, 0xeeee
  v_mov_b32 v77, 0x4444
  v_cndmask_b32 v88, v76, v77, vcc
  s_lshr_b32 s40, s21, 2
  s_mul_i32 s40, s40, 32768
  s_and_b32 s41, s21, 3
  s_lshl_b32 s41, s41, 11
  s_add_u32 s47, s40, s41
  s_lshl_b32 s41, s20, 9
  s_add_u32 s47, s47, s41
  v_lshl_add_u32 v92, v0, 3, s47
  s_lshl_b32 s41, s54, 12
  s_add_u32 s40, s41, 1310720
  s_add_u32 s40, s40, s26
  v_lshrrev_b32 v76, 2, v0
  v_lshl_add_u32 v76, v76, 7, s40
  v_and_b32 v77, 3, v0
  v_lshl_add_u32 v90, v77, 2, v76
  s_mov_b32 s57, s40
  s_cmp_eq_u32 s36, 0
  s_cselect_b32 s56, 1, s20
  s_and_b32 s41, s21, 15
  s_lshl_b32 s41, s41, 7
  s_lshl_b32 s40, s20, 2
  s_add_u32 s40, s40, s41
  s_add_u32 s40, s40, 2048
  s_mov_b32 s25, 0
  s_mov_b32 s60, 0
  s_mov_b32 s61, 0
  s_mov_b32 s51, -1
  v_mov_b32 v91, 2147483392
  s_mov_b64 exec, 1
  v_mov_b32 v91, s40
  s_mov_b64 exec, -1
  v_mov_b32 v80, -1
  v_mov_b32 v81, -1
  v_mov_b32 v82, -1
  v_mov_b32 v83, -1
  v_mov_b32 v112, 0
  v_mov_b32 v113, 0
  v_mov_b32 v114, 0
  v_mov_b32 v115, 0
  v_mov_b32 v116, 0
  v_mov_b32 v117, 0
  v_mov_b32 v118, 0
  v_mov_b32 v119, 0
  v_mov_b32 v120, 0
  v_mov_b32 v121, 0
  v_mov_b32 v108, 0x3f803f80
  v_mov_b32 v109, 0x3f803f80
  v_mov_b32 v110, 0x3f803f80
  v_mov_b32 v111, 0x3f803f80
  v_lshlrev_b32 v95, 4, v0
  s_lshl_b32 s58, s20, 12
  s_add_u32 s40, s58, 149504
  s_add_u32 s58, s58, 131072
  v_lshrrev_b32 v76, 4, v0
  v_bfe_u32 v77, v0, 1, 2
  v_xor_b32 v76, v76, v77
  v_lshl_add_u32 v76, v76, 4, s40
  v_and_b32 v77, 15, v0
  v_lshl_add_u32 v123, v77, 6, v76
  v_bfe_u32 v76, v0, 3, 2
  v_xor_b32 v76, v76, v0
  v_lshl_add_u32 v124, v76, 4, s40
  v_bfe_u32 v76, v0, 4, 1
  v_lshlrev_b32 v76, 1, v76
  v_and_b32 v77, 13, v0
  v_or_b32 v76, v76, v77
  v_lshl_add_u32 v122, v76, 4, s47
  v_lshrrev_b32 v76, 5, v0
  v_lshl_add_u32 v122, v76, 8, v122
  v_and_b32 v76, 2, v0
  v_cmp_eq_u32 vcc, 0, v76
  v_mov_b32 v77, 2147483392
  s_nop 0
  v_cndmask_b32 v122, v122, v77, vcc
  s_lshl_b32 s43, s21, 2
  s_add_u32 s43, s43, s20
  s_and_b32 s46, s20, 1
  s_lshl_b32 s46, s46, 10
  s_mul_i32 s32, s21, 65536
  s_lshl_b32 s40, s20, 11
  s_add_u32 s32, s32, s40
  s_and_b32 s40, s26, 0x2000
  s_xor_b32 s40, s40, 16777216
  s_add_u32 s32, s32, s40
  s_add_u32 s30, s32, s46
  s_add_u32 s30, s30, 49152
  s_lshl_b32 s59, s21, 7
  s_add_u32 s59, s59, 1396736
  s_lshl_b32 s62, s21, 7
  s_add_u32 s62, s62, 1404928
  s_mov_b32 s38, 0x3e0293ee
  s_mov_b32 s39, s38
  v_xor_b32 v125, 4096, v124
  v_xor_b32 v126, 8192, v124
  v_xor_b32 v127, 12288, v124
  v_readfirstlane_b32 s88, v86
  s_xor_b32 s41, s47, 131072
  v_min_u32 v76, 3, v0
  v_lshl_add_u32 v87, v76, 7, s41
  v_lshrrev_b32 v76, 4, v0
  v_lshlrev_b32 v76, 2, v76
  v_and_b32 v77, 15, v0
  v_sub_u32 v76, v77, v76
  s_lshr_b32 s41, s46, 6
  v_add_u32 v76, s41, v76
  v_and_b32 v92, 0xfffffdff, v92
  v_mov_b32 v86, 0xd028965f
  v_cmp_le_i32 s[8:9], 0, v76
  v_cmp_le_i32 s[10:11], 1, v76
  v_cmp_le_i32 s[16:17], 2, v76
  v_cmp_le_i32 s[18:19], 3, v76
  v_cmp_le_i32 s[42:43], 16, v76
  v_cmp_le_i32 s[44:45], 17, v76
  v_cmp_le_i32 s[52:53], 18, v76
  v_cmp_le_i32 s[54:55], 19, v76
  s_xor_b32 s89, s88, 1024
  s_xor_b32 s90, s88, 32768
  s_xor_b32 s91, s88, 33792
  v_lshrrev_b32 v76, 4, v0
  v_lshl_add_u32 v76, v76, 7, s57
  v_and_b32 v77, 15, v0
  v_lshl_add_u32 v90, v77, 2, v76
  s_mov_b32 s25, 0
  s_and_b32 s40, s25, 3
  s_lshl_b32 s40, s40, 16
  s_add_u32 s27, s40, s26
  s_add_u32 s27, s27, 1048576
  s_xor_b32 s37, s27, s36
  s_lshl_b32 s40, s40, 2
  s_add_u32 s28, s40, s26
  s_lshr_b32 s40, s40, 5
  s_and_b32 s40, s40, 0x4000
  s_xor_b32 s28, s28, s40
  s_xor_b32 s29, s28, 0x4000
  s_xor_b32 s40, s28, 8192
  buffer_load_dword v89, v122, s[4:7], s40 offen sc1
  s_mov_b32 s25, 1
  s_and_b32 s40, s25, 3
  s_lshl_b32 s40, s40, 16
  s_add_u32 s27, s40, s26
  s_add_u32 s27, s27, 1048576
  s_xor_b32 s37, s27, s36
  s_lshl_b32 s40, s40, 2
  s_add_u32 s28, s40, s26
  s_lshr_b32 s40, s40, 5
  s_and_b32 s40, s40, 0x4000
  s_xor_b32 s28, s28, s40
  s_xor_b32 s29, s28, 0x4000
  s_xor_b32 s40, s28, 8192
  buffer_load_dword v89, v122, s[4:7], s40 offen sc1
  s_mov_b32 s25, 2
  s_and_b32 s40, s25, 3
  s_lshl_b32 s40, s40, 16
  s_add_u32 s27, s40, s26
  s_add_u32 s27, s27, 1048576
  s_xor_b32 s37, s27, s36
  s_lshl_b32 s40, s40, 2
  s_add_u32 s28, s40, s26
  s_lshr_b32 s40, s40, 5
  s_and_b32 s40, s40, 0x4000
  s_xor_b32 s28, s28, s40
  s_xor_b32 s29, s28, 0x4000
  s_xor_b32 s40, s28, 8192
  buffer_load_dword v89, v122, s[4:7], s40 offen sc1
  s_mov_b32 s25, 3
  s_and_b32 s40, s25, 3
  s_lshl_b32 s40, s40, 16
  s_add_u32 s27, s40, s26
  s_add_u32 s27, s27, 1048576
  s_xor_b32 s37, s27, s36
  s_lshl_b32 s40, s40, 2
  s_add_u32 s28, s40, s26
  s_lshr_b32 s40, s40, 5
  s_and_b32 s40, s40, 0x4000
  s_xor_b32 s28, s28, s40
  s_xor_b32 s29, s28, 0x4000
  s_xor_b32 s40, s28, 8192
  buffer_load_dword v89, v122, s[4:7], s40 offen sc1
  buffer_load_dword v89, v90, s[4:7], 0 offen offset:0 sc1
  s_mov_b32 s25, 0
  s_mov_b32 s33, 1
  s_mov_b64 s[100:101], 0
  s_cmp_lg_u32 s20, 1
  s_cbranch_scc1 Lskip_66
Lask_64:
  s_min_i32 s47, s100, s101
  s_cmp_ge_i32 s47, s33
  s_cbranch_scc1 Lhave_65
  s_load_dwordx2 s[100:101], s[4:5], s59 glc
  s_sub_u32 s24, s24, 1
  s_cbranch_scc1 L_FAIL
  s_waitcnt lgkmcnt(0)
  s_branch Lask_64
Lhave_65:
  s_add_u32 s33, s33, 2
  s_min_u32 s33, s33, 64
  s_cmp_ge_i32 s47, s33
  s_cbranch_scc1 Lskip_66
  s_load_dwordx2 s[100:101], s[4:5], s59 glc
Lskip_66:
  s_barrier
  s_add_u32 m0, s58, 16384
  s_add_u32 s31, s32, 16384
  buffer_load_dwordx4 v95, s[4:7], s31 offen offset:0 sc1 lds
  buffer_load_dwordx4 v95, s[4:7], s31 offen offset:1024 sc1 lds
  s_add_u32 m0, s58, 2048
  s_add_u32 s31, s32, 32768
  buffer_load_dwordx4 v95, s[4:7], s31 offen offset:0 sc1 lds
  buffer_load_dwordx4 v95, s[4:7], s31 offen offset:1024 sc1 lds
  s_mov_b32 m0, s58
  s_add_u32 s31, s32, s46
  buffer_load_dwordx4 v95, s[4:7], s31 offen offset:0 sc1 lds
  s_sub_u32 s31, s32, s46
  buffer_load_dwordx4 v95, s[4:7], s31 offen offset:1024 sc1 lds
  s_and_b32 s40, s25, 3
  s_lshl_b32 s40, s40, 16
  s_add_u32 s27, s40, s26
  s_add_u32 s27, s27, 1048576
  s_xor_b32 s37, s27, s36
  s_lshl_b32 s40, s40, 2
  s_add_u32 s28, s40, s26
  s_lshr_b32 s40, s40, 5
  s_and_b32 s40, s40, 0x4000
  s_xor_b32 s28, s28, s40
  s_xor_b32 s29, s28, 0x4000
  s_xor_b32 s34, s28, 0x84000
  s_xor_b32 s48, s28, 8192
  s_lshr_b32 s40, s46, 1
  s_add_u32 s29, s29, s40
  s_xor_b32 s35, s29, 512
  s_add_u32 s92, s37, s88
  s_add_u32 s96, s27, s88
  s_xor_b32 s96, s96, 0x1000
  s_add_u32 s93, s37, s89
  s_add_u32 s97, s27, s89
  s_xor_b32 s97, s97, 0x1000
  s_add_u32 s94, s37, s90
  s_add_u32 s98, s27, s90
  s_xor_b32 s98, s98, 0x1000
  s_add_u32 s95, s37, s91
  s_add_u32 s99, s27, s91
  s_xor_b32 s99, s99, 0x1000
L_QK_top:
  v_mov_b32_e64 v94, s25
  v_mov_b64 v[52:53], 0
  v_mov_b64 v[54:55], 0
  v_mov_b64 v[56:57], 0
  v_mov_b64 v[58:59], 0
  v_mov_b64 v[60:61], 0
  v_mov_b64 v[62:63], 0
  v_mov_b64 v[64:65], 0
  v_mov_b64 v[66:67], 0
  ds_read_b128 v[20:23], v85 offset:0
  ds_read_b128 v[24:27], v85 offset:1024
  ds_read_b128 v[28:31], v85 offset:8192
  ds_read_b128 v[32:35], v85 offset:9216
  ds_read_b128 v[36:39], v85 offset:2048
  ds_read_b128 v[40:43], v85 offset:3072
  ds_read_b128 v[44:47], v85 offset:10240
  ds_read_b128 v[48:51], v85 offset:11264
  s_nop 0
  s_waitcnt lgkmcnt(0)
  s_and_b32 s40, s25, 63
  s_cselect_b32 s40, s56, 1
  s_cmp_lg_u32 s40, 0
  s_cbranch_scc1 L_QK_park
  v_mov_b32 v76, -1
  s_sleep 4
  s_nop 0
  s_nop 0
L_QK_spin:
  s_sub_u32 s24, s24, 1
  s_nop 0
  s_nop 0
  s_cbranch_scc1 L_FAIL
  s_nop 0
  s_waitcnt vmcnt(40)
  buffer_load_dword v76, v90, s[4:7], 0 offen sc1
  s_nop 3
  v_cmp_gt_i32_e64 vcc, s25, v76
  s_cbranch_vccz L_QK_rel
  buffer_load_dword v76, v90, s[4:7], 0 offen sc1
  s_nop 3
  v_cmp_gt_i32 vcc, s25, v76
  s_cbranch_vccz L_QK_rel
  buffer_load_dword v76, v90, s[4:7], 0 offen sc1
  s_nop 3
  v_cmp_gt_i32 vcc, s25, v76
  s_cbranch_vccz L_QK_rel
  buffer_load_dword v76, v90, s[4:7], 0 offen sc1
  s_nop 3
  v_cmp_gt_i32_e64 vcc, s25, v76
  s_cbranch_vccnz L_QK_spin
L_QK_rel:
  s_barrier
  s_mov_b64 exec, -1
L_QK_go:
L_QKM_again:
  buffer_load_dwordx4 v[96:99], v95, s[4:7], s92 offen offset:0 sc1
  s_nop 0
  buffer_load_dwordx4 v[100:103], v95, s[4:7], s92 offen offset:2048 sc1
  s_nop 0
  buffer_load_dwordx4 v[68:71], v95, s[4:7], s93 offen offset:0 sc1
  s_nop 0
  buffer_load_dwordx4 v[72:75], v95, s[4:7], s93 offen offset:2048 sc1
  s_nop 0
  buffer_load_dwordx4 v[4:7], v95, s[4:7], s94 offen offset:0 sc1
  s_nop 0
  buffer_load_dwordx4 v[8:11], v95, s[4:7], s94 offen offset:2048 sc1
  s_nop 0
  s_waitcnt vmcnt(5)
  v_cmp_eq_u32_e64 vcc, -1, v96
  s_cbranch_vccnz L_QKM_g0
L_QKM_ok0:
  v_smfmac_f32_16x16x64_bf16 v[52:55], v[96:99], a[0:7], v88
  buffer_load_dwordx4 v[12:15], v95, s[4:7], s95 offen offset:0 sc1
  buffer_load_dwordx4 v[16:19], v95, s[4:7], s95 offen offset:2048 sc1
  s_cmp_eq_u32 s20, 0
  s_cbranch_scc1 L_QK_sig
L_QK_sigd:
  v_smfmac_f32_16x16x64_bf16 v[60:63], v[96:99], v[128:135], v88
  s_waitcnt vmcnt(6)
  v_cmp_eq_u32 vcc, -1, v100
  v_smfmac_f32_16x16x64_bf16 v[56:59], v[96:99], a[128:135], v88
  v_smfmac_f32_16x16x64_bf16 v[64:67], v[96:99], v[20:27], v88
  s_cbranch_vccnz L_QKM_g1
L_QKM_ok1:
  v_smfmac_f32_16x16x64_bf16 v[52:55], v[100:103], a[8:15], v88
  buffer_load_dwordx4 v[96:99], v95, s[4:7], s96 offen offset:0 sc1
  ds_read_b128 v[20:23], v85 offset:4096
  v_smfmac_f32_16x16x64_bf16 v[60:63], v[100:103], v[136:143], v88
  s_waitcnt vmcnt(6)
  v_cmp_eq_u32 vcc, -1, v68
  v_smfmac_f32_16x16x64_bf16 v[56:59], v[100:103], a[136:143], v88
  ds_read_b128 v[24:27], v85 offset:5120
  v_smfmac_f32_16x16x64_bf16 v[64:67], v[100:103], v[28:35], v88
  s_cbranch_vccnz L_QKM_g2
L_QKM_ok2:
  v_smfmac_f32_16x16x64_bf16 v[52:55], v[68:71], a[16:23], v88
  buffer_load_dwordx4 v[100:103], v95, s[4:7], s96 offen offset:2048 sc1
  ds_read_b128 v[28:31], v85 offset:12288
  v_smfmac_f32_16x16x64_bf16 v[60:63], v[68:71], v[144:151], v88
  s_waitcnt vmcnt(6)
  v_cmp_eq_u32 vcc, -1, v72
  v_smfmac_f32_16x16x64_bf16 v[56:59], v[68:71], a[144:151], v88
  ds_read_b128 v[32:35], v85 offset:13312
  v_smfmac_f32_16x16x64_bf16 v[64:67], v[68:71], v[36:43], v88
  s_cbranch_vccnz L_QKM_g3
L_QKM_ok3:
  v_smfmac_f32_16x16x64_bf16 v[52:55], v[72:75], a[24:31], v88
  buffer_load_dwordx4 v[68:71], v95, s[4:7], s97 offen offset:0 sc1
  ds_read_b128 v[36:39], v85 offset:6144
  v_smfmac_f32_16x16x64_bf16 v[60:63], v[72:75], v[152:159], v88
  s_waitcnt vmcnt(6)
  v_cmp_eq_u32 vcc, -1, v4
  v_smfmac_f32_16x16x64_bf16 v[56:59], v[72:75], a[152:159], v88
  ds_read_b128 v[40:43], v85 offset:7168
  v_smfmac_f32_16x16x64_bf16 v[64:67], v[72:75], v[44:51], v88
  s_cbranch_vccnz L_QKM_g4
L_QKM_ok4:
  v_smfmac_f32_16x16x64_bf16 v[52:55], v[4:7], a[32:39], v88
  buffer_load_dwordx4 v[72:75], v95, s[4:7], s97 offen offset:2048 sc1
  ds_read_b128 v[44:47], v85 offset:14336
  v_smfmac_f32_16x16x64_bf16 v[60:63], v[4:7], v[160:167], v88
  s_waitcnt vmcnt(6)
  v_cmp_eq_u32_e64 vcc, -1, v8
  v_smfmac_f32_16x16x64_bf16 v[56:59], v[4:7], a[160:167], v88
  ds_read_b128 v[48:51], v85 offset:15360
  s_nop 0
  s_waitcnt lgkmcnt(6)
  v_smfmac_f32_16x16x64_bf16 v[64:67], v[4:7], v[20:27], v88
  s_cbranch_vccnz L_QKM_g5
L_QKM_ok5:
  v_smfmac_f32_16x16x64_bf16 v[52:55], v[8:11], a[40:47], v88
  buffer_load_dwordx4 v[4:7], v95, s[4:7], s98 offen offset:0 sc1
  ds_read_b128 v[20:23], v85 offset:16384
  v_smfmac_f32_16x16x64_bf16 v[60:63], v[8:11], v[168:175], v88
  s_waitcnt vmcnt(6)
  v_cmp_eq_u32 vcc, -1, v12
  v_smfmac_f32_16x16x64_bf16 v[56:59], v[8:11], a[168:175], v88
  ds_read_b128 v[24:27], v85 offset:17408
  s_waitcnt lgkmcnt(6)
  v_smfmac_f32_16x16x64_bf16 v[64:67], v[8:11], v[28:35], v88
  s_cbranch_vccnz L_QKM_g6
L_QKM_ok6:
  v_smfmac_f32_16x16x64_bf16 v[52:55], v[12:15], a[48:55], v88
  buffer_load_dwordx4 v[8:11], v95, s[4:7], s98 offen offset:2048 sc1
  ds_read_b128 v[28:31], v85 offset:24576
  v_smfmac_f32_16x16x64_bf16 v[60:63], v[12:15], v[176:183], v88
  s_waitcnt vmcnt(6)
  v_cmp_eq_u32 vcc, -1, v16
  v_smfmac_f32_16x16x64_bf16 v[56:59], v[12:15], a[176:183], v88
  ds_read_b128 v[32:35], v85 offset:25600
  s_waitcnt lgkmcnt(6)
  v_smfmac_f32_16x16x64_bf16 v[64:67], v[12:15], v[36:43], v88
  s_cbranch_vccnz L_QKM_g7
L_QKM_ok7:
  v_smfmac_f32_16x16x64_bf16 v[52:55], v[16:19], a[56:63], v88
  buffer_load_dwordx4 v[12:15], v95, s[4:7], s99 offen offset:0 sc1
  ds_read_b128 v[36:39], v85 offset:18432
  v_smfmac_f32_16x16x64_bf16 v[60:63], v[16:19], v[184:191], v88
  s_waitcnt vmcnt(6)
  v_cmp_eq_u32_e64 vcc, -1, v96
  v_smfmac_f32_16x16x64_bf16 v[56:59], v[16:19], a[184:191], v88
  ds_read_b128 v[40:43], v85 offset:19456
  s_nop 0
  s_waitcnt lgkmcnt(6)
  v_smfmac_f32_16x16x64_bf16 v[64:67], v[16:19], v[44:51], v88
  s_cbranch_vccnz L_QKM_g8
L_QKM_ok8:
  v_smfmac_f32_16x16x64_bf16 v[52:55], v[96:99], a[64:71], v88
  buffer_load_dwordx4 v[16:19], v95, s[4:7], s99 offen offset:2048 sc1
  ds_read_b128 v[44:47], v85 offset:26624
  v_smfmac_f32_16x16x64_bf16 v[60:63], v[96:99], v[192:199], v88
  s_waitcnt vmcnt(6)
  v_cmp_eq_u32 vcc, -1, v100
  v_smfmac_f32_16x16x64_bf16 v[56:59], v[96:99], a[192:199], v88
  ds_read_b128 v[48:51], v85 offset:27648
  s_waitcnt lgkmcnt(6)
  v_smfmac_f32_16x16x64_bf16 v[64:67], v[96:99], v[20:27], v88
  s_cbranch_vccnz L_QKM_g9
L_QKM_ok9:
  v_smfmac_f32_16x16x64_bf16 v[52:55], v[100:103], a[72:79], v88
  ds_read_b128 v[20:23], v85 offset:20480
  v_smfmac_f32_16x16x64_bf16 v[60:63], v[100:103], v[200:207], v88
  s_waitcnt vmcnt(5)
  v_cmp_eq_u32 vcc, -1, v68
  v_smfmac_f32_16x16x64_bf16 v[56:59], v[100:103], a[200:207], v88
  ds_read_b128 v[24:27], v85 offset:21504
  s_waitcnt lgkmcnt(6)
  v_smfmac_f32_16x16x64_bf16 v[64:67], v[100:103], v[28:35], v88
  s_cbranch_vccnz L_QKM_g10
L_QKM_ok10:
  v_smfmac_f32_16x16x64_bf16 v[52:55], v[68:71], a[80:87], v88
  ds_read_b128 v[28:31], v85 offset:28672
  v_smfmac_f32_16x16x64_bf16 v[60:63], v[68:71], v[208:215], v88
  s_waitcnt vmcnt(4)
  v_cmp_eq_u32 vcc, -1, v72
  v_smfmac_f32_16x16x64_bf16 v[56:59], v[68:71], a[208:215], v88
  ds_read_b128 v[32:35], v85 offset:29696
  s_waitcnt lgkmcnt(6)
  v_smfmac_f32_16x16x64_bf16 v[64:67], v[68:71], v[36:43], v88
  s_cbranch_vccnz L_QKM_g11
L_QKM_ok11:
  v_smfmac_f32_16x16x64_bf16 v[52:55], v[72:75], a[88:95], v88
  ds_read_b128 v[36:39], v85 offset:22528
  ds_read_b128 v[40:43], v85 offset:23552
  v_smfmac_f32_16x16x64_bf16 v[60:63], v[72:75], v[216:223], v88
  s_waitcnt vmcnt(3)
  v_cmp_eq_u32 vcc, -1, v4
  v_smfmac_f32_16x16x64_bf16 v[56:59], v[72:75], a[216:223], v88
  ds_read_b128 v[96:99], v1 offset:2048
  s_waitcnt lgkmcnt(7)
  v_smfmac_f32_16x16x64_bf16 v[64:67], v[72:75], v[44:51], v88
  s_cbranch_vccnz L_QKM_g12
L_QKM_ok12:
  v_smfmac_f32_16x16x64_bf16 v[52:55], v[4:7], a[96:103], v88
  ds_read_b128 v[44:47], v85 offset:30720
  ds_read_b128 v[48:51], v85 offset:31744
  v_smfmac_f32_16x16x64_bf16 v[60:63], v[4:7], v[224:231], v88
  s_waitcnt vmcnt(2)
  v_cmp_eq_u32_e64 vcc, -1, v8
  v_smfmac_f32_16x16x64_bf16 v[56:59], v[4:7], a[224:231], v88
  ds_read_b128 v[100:103], v1 offset:3072
  s_nop 0
  s_waitcnt lgkmcnt(8)
  v_smfmac_f32_16x16x64_bf16 v[64:67], v[4:7], v[20:27], v88
  s_cbranch_vccnz L_QKM_g13
L_QKM_ok13:
  v_smfmac_f32_16x16x64_bf16 v[52:55], v[8:11], a[104:111], v88
  ds_read_b128 v[68:71], v84 offset:16384
  ds_read_b128 v[72:75], v84 offset:17408
  v_smfmac_f32_16x16x64_bf16 v[60:63], v[8:11], v[232:239], v88
  s_waitcnt vmcnt(1)
  v_cmp_eq_u32 vcc, -1, v12
  v_smfmac_f32_16x16x64_bf16 v[56:59], v[8:11], a[232:239], v88
  ds_read_b128 v[20:23], v1 offset:16384
  s_waitcnt lgkmcnt(9)
  v_smfmac_f32_16x16x64_bf16 v[64:67], v[8:11], v[28:35], v88
  s_cbranch_vccnz L_QKM_g14
L_QKM_ok14:
  v_smfmac_f32_16x16x64_bf16 v[52:55], v[12:15], a[112:119], v88
  ds_read_b128 v[24:27], v1 offset:17408
  ds_read_b128 v[28:31], v2 offset:16384
  v_smfmac_f32_16x16x64_bf16 v[60:63], v[12:15], v[240:247], v88
  s_waitcnt vmcnt(0)
  v_cmp_eq_u32 vcc, -1, v16
  v_smfmac_f32_16x16x64_bf16 v[56:59], v[12:15], a[240:247], v88
  ds_read_b128 v[32:35], v2 offset:17408
  s_waitcnt lgkmcnt(10)
  v_smfmac_f32_16x16x64_bf16 v[64:67], v[12:15], v[36:43], v88
  s_cbranch_vccnz L_QKM_g15
L_QKM_ok15:
  v_smfmac_f32_16x16x64_bf16 v[52:55], v[16:19], a[120:127], v88
  ds_read_b128 v[36:39], v3 offset:16384
  v_smfmac_f32_16x16x64_bf16 v[60:63], v[16:19], v[248:255], v88
  ds_read_b128 v[40:43], v3 offset:17408
  v_smfmac_f32_16x16x64_bf16 v[56:59], v[16:19], a[248:255], v88
  s_waitcnt lgkmcnt(9)
  v_smfmac_f32_16x16x64_bf16 v[64:67], v[16:19], v[44:51], v88
  s_nop 1
  v_pk_add_f32 v[52:53], v[52:53], v[54:55]
  s_nop 0
  v_pk_add_f32 v[60:61], v[60:61], v[62:63]
  v_cmp_u_f32 vcc, v52, v53
  v_cvt_pk_bf16_f32 v77, v52, v53
  v_cvt_pk_bf16_f32 v76, v60, v61
  v_pk_add_f32 v[56:57], v[56:57], v[58:59]
  v_pk_add_f32 v[64:65], v[64:65], v[66:67]
  v_cvt_pk_bf16_f32 v79, v56, v57
  v_cvt_pk_bf16_f32 v78, v64, v65
  ds_write_b128 v123, v[76:79]
  ds_read_b64_tr_b16 v[4:5], v124 offset:0
  ds_read_b64_tr_b16 v[6:7], v124 offset:8
  s_cbranch_vccnz L_QKM_nan
L_QKM_done:
  s_waitcnt lgkmcnt(2)
  s_barrier
  ds_read_b64_tr_b16 v[8:9], v125 offset:0
  ds_read_b64_tr_b16 v[10:11], v125 offset:8
  ds_read_b64_tr_b16 v[12:13], v126 offset:0
  ds_read_b64_tr_b16 v[14:15], v126 offset:8
  ds_read_b64_tr_b16 v[16:17], v127 offset:0
  ds_read_b64_tr_b16 v[18:19], v127 offset:8
  s_waitcnt lgkmcnt(6)
  v_mfma_f32_16x16x32_bf16 v[52:55], v[20:23], v[4:7], 0
  v_mfma_f32_16x16x32_bf16 v[56:59], v[24:27], v[4:7], 0
  v_mfma_f32_16x16x32_bf16 v[60:63], v[4:7], v[4:7], 0
  buffer_load_dwordx2 v[104:105], v92, s[4:7], s29 offen sc1
  buffer_load_dwordx2 v[106:107], v92, s[4:7], s35 offen sc1
  s_waitcnt lgkmcnt(4)
  v_mfma_f32_16x16x32_bf16 v[52:55], v[28:31], v[8:11], v[52:55]
  v_mfma_f32_16x16x32_bf16 v[56:59], v[32:35], v[8:11], v[56:59]
  v_mfma_f32_16x16x32_bf16 v[60:63], v[8:11], v[8:11], v[60:63]
  s_waitcnt lgkmcnt(2)
  v_mfma_f32_16x16x32_bf16 v[52:55], v[36:39], v[12:15], v[52:55]
  v_mfma_f32_16x16x32_bf16 v[56:59], v[40:43], v[12:15], v[56:59]
  v_mfma_f32_16x16x32_bf16 v[60:63], v[12:15], v[12:15], v[60:63]
  s_waitcnt lgkmcnt(0)
  v_mfma_f32_16x16x32_bf16 v[52:55], v[68:71], v[16:19], v[52:55]
  v_mfma_f32_16x16x32_bf16 v[56:59], v[72:75], v[16:19], v[56:59]
  v_mfma_f32_16x16x32_bf16 v[60:63], v[16:19], v[16:19], v[60:63]
  s_nop 5
  v_max3_f32 v64, v52, v53, v54
  v_max3_f32 v65, v55, v56, v57
  v_max3_f32 v64, v64, v58, v59
  v_max3_f32 v65, v65, v60, v61
  v_max_f32 v66, v64, v65
  v_max_f32 v67, v64, v65
  s_nop 1
  v_permlane16_swap_b32 v66, v67
  v_max_f32 v64, v66, v67
  v_max_f32 v65, v66, v67
  s_nop 1
  v_permlane32_swap_b32 v64, v65
  v_max_f32 v64, v64, v65
  v_mul_f32 v64, s38, v64
  v_pk_fma_f32 v[60:61], v[60:61], s[38:39], v[64:65] op_sel_hi:[1,1,0] neg_lo:[0,0,1] neg_hi:[0,0,1]
  v_pk_fma_f32 v[52:53], v[52:53], s[38:39], v[64:65] op_sel_hi:[1,1,0] neg_lo:[0,0,1] neg_hi:[0,0,1]
  v_exp_f32 v60, v60
  v_exp_f32 v61, v61
  v_pk_fma_f32 v[54:55], v[54:55], s[38:39], v[64:65] op_sel_hi:[1,1,0] neg_lo:[0,0,1] neg_hi:[0,0,1]
  v_pk_fma_f32 v[56:57], v[56:57], s[38:39], v[64:65] op_sel_hi:[1,1,0] neg_lo:[0,0,1] neg_hi:[0,0,1]
  v_pk_fma_f32 v[58:59], v[58:59], s[38:39], v[64:65] op_sel_hi:[1,1,0] neg_lo:[0,0,1] neg_hi:[0,0,1]
  v_cvt_pk_bf16_f32 v114, v60, v61
  v_cvt_pk_bf16_f32 v119, v60, v61
  s_waitcnt vmcnt(0)
  v_max3_u32 v89, v104, v105, v106
  v_max_u32 v89, v89, v107
  v_cmp_eq_u32 vcc, -1, v89
  v_mfma_f32_16x16x32_bf16 v[64:67], v[108:111], v[114:117], 0
  v_exp_f32_e64 v52, v52
  v_exp_f32_e64 v53, v53
  s_cbranch_vccnz L_QK_vbad
L_QK_vok:
  v_mfma_f32_16x16x32_bf16 v[44:47], v[104:107], v[114:117], 0
  v_exp_f32 v54, v54
  v_exp_f32 v55, v55
  v_mfma_f32_16x16x32_bf16 v[48:51], v[104:107], v[118:121], 0
  v_exp_f32 v56, v56
  v_exp_f32 v57, v57
  v_cvt_pk_bf16_f32 v76, v52, v53
  v_exp_f32 v58, v58
  v_exp_f32 v59, v59
  v_cvt_pk_bf16_f32 v77, v54, v55
  v_cvt_pk_bf16_f32 v78, v56, v57
  v_cvt_pk_bf16_f32 v79, v58, v59
  s_nop 1
  v_mfma_f32_16x16x32_bf16 v[64:67], v[108:111], v[76:79], v[64:67]
  buffer_store_dword v94, v91, s[4:7], s57 offen
  v_mfma_f32_16x16x32_bf16 v[44:47], v[96:99], v[76:79], v[44:47]
  v_mfma_f32_16x16x32_bf16 v[48:51], v[100:103], v[76:79], v[48:51]
  s_nop 4
  v_rcp_f32 v64, v64
  s_nop 0
  v_pk_mul_f32 v[44:45], v[44:45], v[64:65] op_sel_hi:[1,0]
  v_pk_mul_f32 v[46:47], v[46:47], v[64:65] op_sel_hi:[1,0]
  v_pk_mul_f32 v[48:49], v[48:49], v[64:65] op_sel_hi:[1,0]
  v_pk_mul_f32 v[50:51], v[50:51], v[64:65] op_sel_hi:[1,0]
  v_cvt_pk_bf16_f32 v52, v44, v45
  v_cvt_pk_bf16_f32 v53, v46, v47
  v_cvt_pk_bf16_f32 v54, v48, v49
  v_cvt_pk_bf16_f32 v55, v50, v51
  buffer_store_dwordx4 v[52:55], v122, s[4:7], s48 offen
  ds_read_b128 v[44:47], v1 offset:0
  ds_read_b128 v[48:51], v2 offset:1024
  s_add_u32 s32, s32, 2097152
  s_xor_b32 s32, s32, 0x2000
  s_add_u32 s33, s25, 2
  s_min_u32 s33, s33, 64
  s_waitcnt lgkmcnt(0)
  buffer_store_dwordx4 v[52:55], v122, s[4:7], s28 offen sc1
  v_mfma_f32_16x16x32_bf16 v[56:59], v[20:23], v[44:47], 0
  v_mfma_f32_16x16x32_bf16 v[60:63], v[24:27], v[44:47], 0
  v_mfma_f32_16x16x32_bf16 v[64:67], v[4:7], v[44:47], 0
  ds_read_b128 v[20:23], v3 offset:0
  ds_read_b128 v[24:27], v2 offset:2048
  v_mfma_f32_16x16x32_bf16 v[56:59], v[28:31], v[48:51], v[56:59]
  v_mfma_f32_16x16x32_bf16 v[60:63], v[32:35], v[48:51], v[60:63]
  v_mfma_f32_16x16x32_bf16 v[64:67], v[8:11], v[48:51], v[64:67]
  ds_read_b128 v[28:31], v84 offset:1024
  ds_read_b128 v[32:35], v2 offset:3072
  s_waitcnt lgkmcnt(3)
  v_mfma_f32_16x16x32_bf16 v[56:59], v[36:39], v[20:23], v[56:59]
  v_mfma_f32_16x16x32_bf16 v[60:63], v[40:43], v[20:23], v[60:63]
  v_mfma_f32_16x16x32_bf16 v[64:67], v[12:15], v[20:23], v[64:67]
  s_waitcnt lgkmcnt(0)
  v_mfma_f32_16x16x32_bf16 v[56:59], v[68:71], v[28:31], v[56:59]
  v_mfma_f32_16x16x32_bf16 v[60:63], v[72:75], v[28:31], v[60:63]
  v_mfma_f32_16x16x32_bf16 v[64:67], v[16:19], v[28:31], v[64:67]
  s_cmp_lg_u32 s20, 1
  s_cbranch_scc1 Lskip_69
Lask_67:
  s_min_i32 s47, s100, s101
  s_cmp_ge_i32 s47, s33
  s_cbranch_scc1 Lhave_68
  s_load_dwordx2 s[100:101], s[4:5], s59 glc
  s_sub_u32 s24, s24, 1
  s_cbranch_scc1 L_FAIL
  s_waitcnt lgkmcnt(0)
  s_branch Lask_67
Lhave_68:
  s_add_u32 s33, s33, 2
  s_min_u32 s33, s33, 64
  s_cmp_ge_i32 s47, s33
  s_nop 0
  s_nop 0
  s_cbranch_scc1 Lskip_69
  s_load_dwordx2 s[100:101], s[4:5], s59 glc
Lskip_69:
  s_barrier
  v_cndmask_b32 v56, v86, v56, s[8:9]
  v_cndmask_b32 v57, v86, v57, s[10:11]
  v_cndmask_b32 v58, v86, v58, s[16:17]
  v_cndmask_b32 v59, v86, v59, s[18:19]
  v_cndmask_b32 v60, v86, v60, s[42:43]
  v_cndmask_b32 v61, v86, v61, s[44:45]
  v_cndmask_b32 v62, v86, v62, s[52:53]
  v_cndmask_b32 v63, v86, v63, s[54:55]
  v_max3_f32 v72, v56, v57, v58
  v_max3_f32 v73, v59, v60, v61
  buffer_load_dword v89, v87, s[4:7], s28 offen sc1
  v_max3_f32 v72, v72, v62, v63
  v_max3_f32 v73, v73, v64, v65
  s_add_u32 m0, s58, 16384
  s_add_u32 s31, s32, 16384
  buffer_load_dwordx4 v95, s[4:7], s31 offen offset:0 sc1 lds
  v_max_f32 v74, v72, v73
  v_max_f32 v75, v72, v73
  buffer_load_dwordx4 v95, s[4:7], s31 offen offset:1024 sc1 lds
  s_nop 0
  v_permlane16_swap_b32 v74, v75
  v_max_f32 v72, v74, v75
  s_add_u32 m0, s58, 2048
  s_add_u32 s31, s32, 32768
  buffer_load_dwordx4 v95, s[4:7], s31 offen offset:0 sc1 lds
  v_max_f32 v73, v74, v75
  s_nop 1
  v_permlane32_swap_b32 v72, v73
  buffer_load_dwordx4 v95, s[4:7], s31 offen offset:1024 sc1 lds
  v_max_f32 v72, v72, v73
  v_mul_f32 v72, s38, v72
  s_mov_b32 m0, s58
  s_add_u32 s31, s32, s46
  buffer_load_dwordx4 v95, s[4:7], s31 offen offset:0 sc1 lds
  v_pk_fma_f32 v[56:57], v[56:57], s[38:39], v[72:73] op_sel_hi:[1,1,0] neg_lo:[0,0,1] neg_hi:[0,0,1]
  v_pk_fma_f32 v[58:59], v[58:59], s[38:39], v[72:73] op_sel_hi:[1,1,0] neg_lo:[0,0,1] neg_hi:[0,0,1]
  s_sub_u32 s31, s32, s46
  buffer_load_dwordx4 v95, s[4:7], s31 offen offset:1024 sc1 lds
  v_pk_fma_f32 v[60:61], v[60:61], s[38:39], v[72:73] op_sel_hi:[1,1,0] neg_lo:[0,0,1] neg_hi:[0,0,1]
  v_pk_fma_f32 v[62:63], v[62:63], s[38:39], v[72:73] op_sel_hi:[1,1,0] neg_lo:[0,0,1] neg_hi:[0,0,1]
  buffer_store_dwordx4 v[80:83], v122, s[4:7], s34 offen sc1
  v_pk_fma_f32 v[64:65], v[64:65], s[38:39], v[72:73] op_sel_hi:[1,1,0] neg_lo:[0,0,1] neg_hi:[0,0,1]
  v_exp_f32 v56, v56
  s_xor_b32 s40, s34, 8192
  buffer_store_dwordx4 v[80:83], v122, s[4:7], s40 offen
  v_exp_f32 v57, v57
  v_exp_f32 v58, v58
  v_exp_f32 v59, v59
  v_exp_f32 v60, v60
  v_exp_f32 v61, v61
  v_exp_f32 v62, v62
  v_exp_f32 v63, v63
  v_exp_f32 v64, v64
  v_exp_f32 v65, v65
  v_cvt_pk_bf16_f32 v36, v56, v57
  v_cvt_pk_bf16_f32 v37, v58, v59
  v_cvt_pk_bf16_f32 v38, v60, v61
  v_cvt_pk_bf16_f32 v39, v62, v63
  v_cvt_pk_bf16_f32 v114, v64, v65
  v_cvt_pk_bf16_f32 v119, v64, v65
  s_add_u32 s25, s25, 1
  s_xor_b32 s41, s30, 2048
  v_mfma_f32_16x16x32_bf16 v[40:43], v[108:111], v[36:39], 0
  s_and_b32 s40, s25, 3
  s_lshl_b32 s40, s40, 16
  s_add_u32 s27, s40, s26
  v_mfma_f32_16x16x32_bf16 v[52:55], v[96:99], v[36:39], 0
  s_add_u32 s27, s27, 1048576
  s_xor_b32 s37, s27, s36
  s_lshl_b32 s40, s40, 2
  v_mfma_f32_16x16x32_bf16 v[56:59], v[100:103], v[36:39], 0
  s_add_u32 s28, s40, s26
  s_lshr_b32 s40, s40, 5
  s_and_b32 s40, s40, 0x4000
  v_mfma_f32_16x16x32_bf16 v[60:63], v[24:27], v[36:39], 0
  s_xor_b32 s28, s28, s40
  s_xor_b32 s29, s28, 0x4000
  s_xor_b32 s34, s28, 0x84000
  v_mfma_f32_16x16x32_bf16 v[64:67], v[32:35], v[36:39], 0
  s_xor_b32 s48, s28, 8192
  s_lshr_b32 s40, s46, 1
  s_add_u32 s29, s29, s40
  v_mfma_f32_16x16x32_bf16 v[40:43], v[108:111], v[114:117], v[40:43]
  s_xor_b32 s35, s29, 512
  s_add_u32 s92, s37, s88
  s_add_u32 s96, s27, s88
  v_mfma_f32_16x16x32_bf16 v[52:55], v[104:107], v[114:117], v[52:55]
  s_xor_b32 s96, s96, 0x1000
  s_add_u32 s93, s37, s89
  s_add_u32 s97, s27, s89
  v_mfma_f32_16x16x32_bf16 v[56:59], v[104:107], v[118:121], v[56:59]
  s_xor_b32 s97, s97, 0x1000
  s_add_u32 s94, s37, s90
  s_add_u32 s98, s27, s90
  v_mfma_f32_16x16x32_bf16 v[60:63], v[104:107], v[112:115], v[60:63]
  s_xor_b32 s98, s98, 0x1000
  s_add_u32 s95, s37, s91
  s_add_u32 s99, s27, s91
  v_mfma_f32_16x16x32_bf16 v[64:67], v[104:107], v[116:119], v[64:67]
  s_xor_b32 s99, s99, 0x1000
  v_rcp_f32 v40, v40
  s_nop 0
  v_pk_mul_f32 v[52:53], v[52:53], v[40:41] op_sel_hi:[1,0]
  v_pk_mul_f32 v[54:55], v[54:55], v[40:41] op_sel_hi:[1,0]
  v_pk_mul_f32 v[56:57], v[56:57], v[40:41] op_sel_hi:[1,0]
  v_pk_mul_f32 v[58:59], v[58:59], v[40:41] op_sel_hi:[1,0]
  v_cvt_pk_bf16_f32 v4, v52, v53
  v_cvt_pk_bf16_f32 v5, v54, v55
  v_cvt_pk_bf16_f32 v6, v56, v57
  v_cvt_pk_bf16_f32 v7, v58, v59
  buffer_store_dwordx4 v[4:7], v95, s[4:7], s30 offen sc1
  v_pk_mul_f32 v[60:61], v[60:61], v[40:41] op_sel_hi:[1,0]
  v_pk_mul_f32 v[62:63], v[62:63], v[40:41] op_sel_hi:[1,0]
  v_pk_mul_f32 v[64:65], v[64:65], v[40:41] op_sel_hi:[1,0]
  v_pk_mul_f32 v[66:67], v[66:67], v[40:41] op_sel_hi:[1,0]
  v_cvt_pk_bf16_f32 v8, v60, v61
  v_cvt_pk_bf16_f32 v9, v62, v63
  v_cvt_pk_bf16_f32 v10, v64, v65
  v_cvt_pk_bf16_f32 v11, v66, v67
  buffer_store_dwordx4 v[8:11], v95, s[4:7], s41 offen sc1
  s_add_u32 s30, s30, 2097152
  s_xor_b32 s30, s30, 0x2000
  s_branch L_QK_top
L_QK_park:
  s_waitcnt vmcnt(0)
  s_cmp_lt_u32 s25, 64
  s_cbranch_scc1 L_QK_rel
  s_barrier
  s_cmp_lg_u32 s20, 0
  s_cbranch_scc1 Lnosig_70
  s_mov_b32 s63, s25
  s_atomic_smax s63, s[4:5], s62 glc
Lnosig_70:
  s_branch L_END
L_QKM_nan:
  s_cmp_eq_u32 s51, s25
  s_cbranch_scc1 L_QKM_done
  s_mov_b32 s51, s25
  s_add_u32 s60, s60, 0x10000
  s_waitcnt vmcnt(0) lgkmcnt(0)
L_QKM_v0:
  s_sub_u32 s24, s24, 1
  s_cbranch_scc1 L_FAIL
  buffer_load_dwordx4 v[96:99], v95, s[4:7], s92 offen offset:0 sc1
  buffer_load_dwordx4 v[100:103], v95, s[4:7], s92 offen offset:2048 sc1
  buffer_load_dwordx4 v[68:71], v95, s[4:7], s93 offen offset:0 sc1
  buffer_load_dwordx4 v[72:75], v95, s[4:7], s93 offen offset:2048 sc1
  v_mov_b32 v89, 0
  s_waitcnt vmcnt(0)
  v_max3_u32 v89, v96, v97, v89
  v_max3_u32 v89, v98, v99, v89
  v_max3_u32 v89, v100, v101, v89
  v_max3_u32 v89, v102, v103, v89
  v_max3_u32 v89, v68, v69, v89
  v_max3_u32 v89, v70, v71, v89
  v_max3_u32 v89, v72, v73, v89
  v_max3_u32 v89, v74, v75, v89
  v_cmp_eq_u32 vcc, -1, v89
  s_cbranch_vccnz L_QKM_v0
L_QKM_v4:
  s_sub_u32 s24, s24, 1
  s_cbranch_scc1 L_FAIL
  buffer_load_dwordx4 v[4:7], v95, s[4:7], s94 offen offset:0 sc1
  buffer_load_dwordx4 v[8:11], v95, s[4:7], s94 offen offset:2048 sc1
  buffer_load_dwordx4 v[12:15], v95, s[4:7], s95 offen offset:0 sc1
  buffer_load_dwordx4 v[16:19], v95, s[4:7], s95 offen offset:2048 sc1
  v_mov_b32 v89, 0
  s_waitcnt vmcnt(0)
  v_max3_u32 v89, v4, v5, v89
  v_max3_u32 v89, v6, v7, v89
  v_max3_u32 v89, v8, v9, v89
  v_max3_u32 v89, v10, v11, v89
  v_max3_u32 v89, v12, v13, v89
  v_max3_u32 v89, v14, v15, v89
  v_max3_u32 v89, v16, v17, v89
  v_max3_u32 v89, v18, v19, v89
  v_cmp_eq_u32 vcc, -1, v89
  s_cbranch_vccnz L_QKM_v4
L_QKM_v8:
  s_sub_u32 s24, s24, 1
  s_cbranch_scc1 L_FAIL
  buffer_load_dwordx4 v[96:99], v95, s[4:7], s96 offen offset:0 sc1
  buffer_load_dwordx4 v[100:103], v95, s[4:7], s96 offen offset:2048 sc1
  buffer_load_dwordx4 v[68:71], v95, s[4:7], s97 offen offset:0 sc1
  buffer_load_dwordx4 v[72:75], v95, s[4:7], s97 offen offset:2048 sc1
  v_mov_b32 v89, 0
  s_waitcnt vmcnt(0)
  v_max3_u32 v89, v96, v97, v89
  v_max3_u32 v89, v98, v99, v89
  v_max3_u32 v89, v100, v101, v89
  v_max3_u32 v89, v102, v103, v89
  v_max3_u32 v89, v68, v69, v89
  v_max3_u32 v89, v70, v71, v89
  v_max3_u32 v89, v72, v73, v89
  v_max3_u32 v89, v74, v75, v89
  v_cmp_eq_u32 vcc, -1, v89
  s_cbranch_vccnz L_QKM_v8
L_QKM_v12:
  s_sub_u32 s24, s24, 1
  s_cbranch_scc1 L_FAIL
  buffer_load_dwordx4 v[4:7], v95, s[4:7], s98 offen offset:0 sc1
  buffer_load_dwordx4 v[8:11], v95, s[4:7], s98 offen offset:2048 sc1
  buffer_load_dwordx4 v[12:15], v95, s[4:7], s99 offen offset:0 sc1
  buffer_load_dwordx4 v[16:19], v95, s[4:7], s99 offen offset:2048 sc1
  v_mov_b32 v89, 0
  s_waitcnt vmcnt(0)
  v_max3_u32 v89, v4, v5, v89
  v_max3_u32 v89, v6, v7, v89
  v_max3_u32 v89, v8, v9, v89
  v_max3_u32 v89, v10, v11, v89
  v_max3_u32 v89, v12, v13, v89
  v_max3_u32 v89, v14, v15, v89
  v_max3_u32 v89, v16, v17, v89
  v_max3_u32 v89, v18, v19, v89
  v_cmp_eq_u32 vcc, -1, v89
  s_cbranch_vccnz L_QKM_v12
  v_mov_b64 v[52:53], 0
  v_mov_b64 v[54:55], 0
  v_mov_b64 v[56:57], 0
  v_mov_b64 v[58:59], 0
  v_mov_b64 v[60:61], 0
  v_mov_b64 v[62:63], 0
  v_mov_b64 v[64:65], 0
  v_mov_b64 v[66:67], 0
  ds_read_b128 v[20:23], v85 offset:0
  ds_read_b128 v[24:27], v85 offset:1024
  ds_read_b128 v[28:31], v85 offset:8192
  ds_read_b128 v[32:35], v85 offset:9216
  ds_read_b128 v[36:39], v85 offset:2048
  ds_read_b128 v[40:43], v85 offset:3072
  ds_read_b128 v[44:47], v85 offset:10240
  ds_read_b128 v[48:51], v85 offset:11264
  s_waitcnt lgkmcnt(0)
  s_branch L_QKM_again
L_QKM_g0:
  s_sub_u32 s24, s24, 1
  s_cbranch_scc1 L_FAIL
  s_add_u32 s60, s60, 1
  buffer_load_dwordx4 v[96:99], v95, s[4:7], s92 offen offset:0 sc1
  s_waitcnt vmcnt(0)
  v_cmp_eq_u32 vcc, -1, v96
  s_cbranch_vccnz L_QKM_g0
  v_mov_b32 v89, 0
  v_max3_u32 v89, v100, v68, v89
  v_max3_u32 v89, v72, v4, v89
  v_max3_u32 v89, v8, v8, v89
  v_cmp_eq_u32 vcc, -1, v89
  s_cbranch_vccz L_QKM_ok0
  buffer_load_dwordx4 v[100:103], v95, s[4:7], s92 offen offset:2048 sc1
  s_nop 0
  buffer_load_dwordx4 v[68:71], v95, s[4:7], s93 offen offset:0 sc1
  s_nop 0
  buffer_load_dwordx4 v[72:75], v95, s[4:7], s93 offen offset:2048 sc1
  s_nop 0
  buffer_load_dwordx4 v[4:7], v95, s[4:7], s94 offen offset:0 sc1
  s_nop 0
  buffer_load_dwordx4 v[8:11], v95, s[4:7], s94 offen offset:2048 sc1
  s_nop 0
  s_branch L_QKM_ok0
L_QKM_g1:
  s_sub_u32 s24, s24, 1
  s_cbranch_scc1 L_FAIL
  s_add_u32 s60, s60, 1
  buffer_load_dwordx4 v[100:103], v95, s[4:7], s92 offen offset:2048 sc1
  s_waitcnt vmcnt(0)
  v_cmp_eq_u32 vcc, -1, v100
  s_cbranch_vccnz L_QKM_g1
  v_mov_b32 v89, 0
  v_max3_u32 v89, v68, v72, v89
  v_max3_u32 v89, v4, v8, v89
  v_max3_u32 v89, v12, v16, v89
  v_cmp_eq_u32 vcc, -1, v89
  s_cbranch_vccz L_QKM_ok1
  buffer_load_dwordx4 v[68:71], v95, s[4:7], s93 offen offset:0 sc1
  s_nop 0
  buffer_load_dwordx4 v[72:75], v95, s[4:7], s93 offen offset:2048 sc1
  s_nop 0
  buffer_load_dwordx4 v[4:7], v95, s[4:7], s94 offen offset:0 sc1
  s_nop 0
  buffer_load_dwordx4 v[8:11], v95, s[4:7], s94 offen offset:2048 sc1
  s_nop 0
  buffer_load_dwordx4 v[12:15], v95, s[4:7], s95 offen offset:0 sc1
  s_nop 0
  buffer_load_dwordx4 v[16:19], v95, s[4:7], s95 offen offset:2048 sc1
  s_nop 0
  s_branch L_QKM_ok1
L_QKM_g2:
  s_sub_u32 s24, s24, 1
  s_cbranch_scc1 L_FAIL
  s_add_u32 s60, s60, 1
  buffer_load_dwordx4 v[68:71], v95, s[4:7], s93 offen offset:0 sc1
  s_waitcnt vmcnt(0)
  v_cmp_eq_u32 vcc, -1, v68
  s_cbranch_vccnz L_QKM_g2
  v_mov_b32 v89, 0
  v_max3_u32 v89, v72, v4, v89
  v_max3_u32 v89, v8, v12, v89
  v_max3_u32 v89, v16, v96, v89
  v_cmp_eq_u32 vcc, -1, v89
  s_cbranch_vccz L_QKM_ok2
  buffer_load_dwordx4 v[72:75], v95, s[4:7], s93 offen offset:2048 sc1
  s_nop 0
  buffer_load_dwordx4 v[4:7], v95, s[4:7], s94 offen offset:0 sc1
  s_nop 0
  buffer_load_dwordx4 v[8:11], v95, s[4:7], s94 offen offset:2048 sc1
  s_nop 0
  buffer_load_dwordx4 v[12:15], v95, s[4:7], s95 offen offset:0 sc1
  s_nop 0
  buffer_load_dwordx4 v[16:19], v95, s[4:7], s95 offen offset:2048 sc1
  s_nop 0
  buffer_load_dwordx4 v[96:99], v95, s[4:7], s96 offen offset:0 sc1
  s_nop 0
  s_branch L_QKM_ok2
L_QKM_g3:
  s_sub_u32 s24, s24, 1
  s_cbranch_scc1 L_FAIL
  s_add_u32 s60, s60, 1
  buffer_load_dwordx4 v[72:75], v95, s[4:7], s93 offen offset:2048 sc1
  s_waitcnt vmcnt(0)
  v_cmp_eq_u32 vcc, -1, v72
  s_cbranch_vccnz L_QKM_g3
  v_mov_b32 v89, 0
  v_max3_u32 v89, v4, v8, v89
  v_max3_u32 v89, v12, v16, v89
  v_max3_u32 v89, v96, v100, v89
  v_cmp_eq_u32 vcc, -1, v89
  s_cbranch_vccz L_QKM_ok3
  buffer_load_dwordx4 v[4:7], v95, s[4:7], s94 offen offset:0 sc1
  s_nop 0
  buffer_load_dwordx4 v[8:11], v95, s[4:7], s94 offen offset:2048 sc1
  s_nop 0
  buffer_load_dwordx4 v[12:15], v95, s[4:7], s95 offen offset:0 sc1
  s_nop 0
  buffer_load_dwordx4 v[16:19], v95, s[4:7], s95 offen offset:2048 sc1
  s_nop 0
  buffer_load_dwordx4 v[96:99], v95, s[4:7], s96 offen offset:0 sc1
  s_nop 0
  buffer_load_dwordx4 v[100:103], v95, s[4:7], s96 offen offset:2048 sc1
  s_nop 0
  s_branch L_QKM_ok3
L_QKM_g4:
  s_sub_u32 s24, s24, 1
  s_cbranch_scc1 L_FAIL
  s_add_u32 s60, s60, 1
  buffer_load_dwordx4 v[4:7], v95, s[4:7], s94 offen offset:0 sc1
  s_waitcnt vmcnt(0)
  v_cmp_eq_u32 vcc, -1, v4
  s_cbranch_vccnz L_QKM_g4
  v_mov_b32 v89, 0
  v_max3_u32 v89, v8, v12, v89
  v_max3_u32 v89, v16, v96, v89
  v_max3_u32 v89, v100, v68, v89
  v_cmp_eq_u32 vcc, -1, v89
  s_cbranch_vccz L_QKM_ok4
  buffer_load_dwordx4 v[8:11], v95, s[4:7], s94 offen offset:2048 sc1
  s_nop 0
  buffer_load_dwordx4 v[12:15], v95, s[4:7], s95 offen offset:0 sc1
  s_nop 0
  buffer_load_dwordx4 v[16:19], v95, s[4:7], s95 offen offset:2048 sc1
  s_nop 0
  buffer_load_dwordx4 v[96:99], v95, s[4:7], s96 offen offset:0 sc1
  s_nop 0
  buffer_load_dwordx4 v[100:103], v95, s[4:7], s96 offen offset:2048 sc1
  s_nop 0
  buffer_load_dwordx4 v[68:71], v95, s[4:7], s97 offen offset:0 sc1
  s_nop 0
  s_branch L_QKM_ok4
L_QKM_g5:
  s_sub_u32 s24, s24, 1
  s_cbranch_scc1 L_FAIL
  s_add_u32 s60, s60, 1
  buffer_load_dwordx4 v[8:11], v95, s[4:7], s94 offen offset:2048 sc1
  s_waitcnt vmcnt(0)
  v_cmp_eq_u32 vcc, -1, v8
  s_cbranch_vccnz L_QKM_g5
  v_mov_b32 v89, 0
  v_max3_u32 v89, v12, v16, v89
  v_max3_u32 v89, v96, v100, v89
  v_max3_u32 v89, v68, v72, v89
  v_cmp_eq_u32 vcc, -1, v89
  s_cbranch_vccz L_QKM_ok5
  buffer_load_dwordx4 v[12:15], v95, s[4:7], s95 offen offset:0 sc1
  s_nop 0
  buffer_load_dwordx4 v[16:19], v95, s[4:7], s95 offen offset:2048 sc1
  s_nop 0
  buffer_load_dwordx4 v[96:99], v95, s[4:7], s96 offen offset:0 sc1
  s_nop 0
  buffer_load_dwordx4 v[100:103], v95, s[4:7], s96 offen offset:2048 sc1
  s_nop 0
  buffer_load_dwordx4 v[68:71], v95, s[4:7], s97 offen offset:0 sc1
  s_nop 0
  buffer_load_dwordx4 v[72:75], v95, s[4:7], s97 offen offset:2048 sc1
  s_nop 0
  s_branch L_QKM_ok5
L_QKM_g6:
  s_sub_u32 s24, s24, 1
  s_cbranch_scc1 L_FAIL
  s_add_u32 s60, s60, 1
  buffer_load_dwordx4 v[12:15], v95, s[4:7], s95 offen offset:0 sc1
  s_waitcnt vmcnt(0)
  v_cmp_eq_u32 vcc, -1, v12
  s_cbranch_vccnz L_QKM_g6
  v_mov_b32 v89, 0
  v_max3_u32 v89, v16, v96, v89
  v_max3_u32 v89, v100, v68, v89
  v_max3_u32 v89, v72, v4, v89
  v_cmp_eq_u32 vcc, -1, v89
  s_cbranch_vccz L_QKM_ok6
  buffer_load_dwordx4 v[16:19], v95, s[4:7], s95 offen offset:2048 sc1
  s_nop 0
  buffer_load_dwordx4 v[96:99], v95, s[4:7], s96 offen offset:0 sc1
  s_nop 0
  buffer_load_dwordx4 v[100:103], v95, s[4:7], s96 offen offset:2048 sc1
  s_nop 0
  buffer_load_dwordx4 v[68:71], v95, s[4:7], s97 offen offset:0 sc1
  s_nop 0
  buffer_load_dwordx4 v[72:75], v95, s[4:7], s97 offen offset:2048 sc1
  s_nop 0
  buffer_load_dwordx4 v[4:7], v95, s[4:7], s98 offen offset:0 sc1
  s_nop 0
  s_branch L_QKM_ok6
L_QKM_g7:
  s_sub_u32 s24, s24, 1
  s_cbranch_scc1 L_FAIL
  s_add_u32 s60, s60, 1
  buffer_load_dwordx4 v[16:19], v95, s[4:7], s95 offen offset:2048 sc1
  s_waitcnt vmcnt(0)
  v_cmp_eq_u32 vcc, -1, v16
  s_cbranch_vccnz L_QKM_g7
  v_mov_b32 v89, 0
  v_max3_u32 v89, v96, v100, v89
  v_max3_u32 v89, v68, v72, v89
  v_max3_u32 v89, v4, v8, v89
  v_cmp_eq_u32 vcc, -1, v89
  s_cbranch_vccz L_QKM_ok7
  buffer_load_dwordx4 v[96:99], v95, s[4:7], s96 offen offset:0 sc1
  s_nop 0
  buffer_load_dwordx4 v[100:103], v95, s[4:7], s96 offen offset:2048 sc1
  s_nop 0
  buffer_load_dwordx4 v[68:71], v95, s[4:7], s97 offen offset:0 sc1
  s_nop 0
  buffer_load_dwordx4 v[72:75], v95, s[4:7], s97 offen offset:2048 sc1
  s_nop 0
  buffer_load_dwordx4 v[4:7], v95, s[4:7], s98 offen offset:0 sc1
  s_nop 0
  buffer_load_dwordx4 v[8:11], v95, s[4:7], s98 offen offset:2048 sc1
  s_nop 0
  s_branch L_QKM_ok7
L_QKM_g8:
  s_sub_u32 s24, s24, 1
  s_cbranch_scc1 L_FAIL
  s_add_u32 s60, s60, 256
  buffer_load_dwordx4 v[96:99], v95, s[4:7], s96 offen offset:0 sc1
  s_waitcnt vmcnt(0)
  v_cmp_eq_u32 vcc, -1, v96
  s_cbranch_vccnz L_QKM_g8
  v_mov_b32 v89, 0
  v_max3_u32 v89, v100, v68, v89
  v_max3_u32 v89, v72, v4, v89
  v_max3_u32 v89, v8, v12, v89
  v_cmp_eq_u32 vcc, -1, v89
  s_cbranch_vccz L_QKM_ok8
  buffer_load_dwordx4 v[100:103], v95, s[4:7], s96 offen offset:2048 sc1
  s_nop 0
  buffer_load_dwordx4 v[68:71], v95, s[4:7], s97 offen offset:0 sc1
  s_nop 0
  buffer_load_dwordx4 v[72:75], v95, s[4:7], s97 offen offset:2048 sc1
  s_nop 0
  buffer_load_dwordx4 v[4:7], v95, s[4:7], s98 offen offset:0 sc1
  s_nop 0
  buffer_load_dwordx4 v[8:11], v95, s[4:7], s98 offen offset:2048 sc1
  s_nop 0
  buffer_load_dwordx4 v[12:15], v95, s[4:7], s99 offen offset:0 sc1
  s_nop 0
  s_branch L_QKM_ok8
L_QKM_g9:
  s_sub_u32 s24, s24, 1
  s_cbranch_scc1 L_FAIL
  s_add_u32 s60, s60, 256
  buffer_load_dwordx4 v[100:103], v95, s[4:7], s96 offen offset:2048 sc1
  s_waitcnt vmcnt(0)
  v_cmp_eq_u32 vcc, -1, v100
  s_cbranch_vccnz L_QKM_g9
  v_mov_b32 v89, 0
  v_max3_u32 v89, v68, v72, v89
  v_max3_u32 v89, v4, v8, v89
  v_max3_u32 v89, v12, v16, v89
  v_cmp_eq_u32 vcc, -1, v89
  s_cbranch_vccz L_QKM_ok9
  buffer_load_dwordx4 v[68:71], v95, s[4:7], s97 offen offset:0 sc1
  s_nop 0
  buffer_load_dwordx4 v[72:75], v95, s[4:7], s97 offen offset:2048 sc1
  s_nop 0
  buffer_load_dwordx4 v[4:7], v95, s[4:7], s98 offen offset:0 sc1
  s_nop 0
  buffer_load_dwordx4 v[8:11], v95, s[4:7], s98 offen offset:2048 sc1
  s_nop 0
  buffer_load_dwordx4 v[12:15], v95, s[4:7], s99 offen offset:0 sc1
  s_nop 0
  buffer_load_dwordx4 v[16:19], v95, s[4:7], s99 offen offset:2048 sc1
  s_nop 0
  s_branch L_QKM_ok9
L_QKM_g10:
  s_sub_u32 s24, s24, 1
  s_cbranch_scc1 L_FAIL
  s_add_u32 s60, s60, 256
  buffer_load_dwordx4 v[68:71], v95, s[4:7], s97 offen offset:0 sc1
  s_waitcnt vmcnt(0)
  v_cmp_eq_u32 vcc, -1, v68
  s_cbranch_vccnz L_QKM_g10
  v_mov_b32 v89, 0
  v_max3_u32 v89, v72, v4, v89
  v_max3_u32 v89, v8, v12, v89
  v_max3_u32 v89, v16, v16, v89
  v_cmp_eq_u32 vcc, -1, v89
  s_cbranch_vccz L_QKM_ok10
  buffer_load_dwordx4 v[72:75], v95, s[4:7], s97 offen offset:2048 sc1
  s_nop 0
  buffer_load_dwordx4 v[4:7], v95, s[4:7], s98 offen offset:0 sc1
  s_nop 0
  buffer_load_dwordx4 v[8:11], v95, s[4:7], s98 offen offset:2048 sc1
  s_nop 0
  buffer_load_dwordx4 v[12:15], v95, s[4:7], s99 offen offset:0 sc1
  s_nop 0
  buffer_load_dwordx4 v[16:19], v95, s[4:7], s99 offen offset:2048 sc1
  s_nop 0
  s_branch L_QKM_ok10
L_QKM_g11:
  s_sub_u32 s24, s24, 1
  s_cbranch_scc1 L_FAIL
  s_add_u32 s60, s60, 256
  buffer_load_dwordx4 v[72:75], v95, s[4:7], s97 offen offset:2048 sc1
  s_waitcnt vmcnt(0)
  v_cmp_eq_u32 vcc, -1, v72
  s_cbranch_vccnz L_QKM_g11
  v_mov_b32 v89, 0
  v_max3_u32 v89, v4, v8, v89
  v_max3_u32 v89, v12, v16, v89
  v_cmp_eq_u32 vcc, -1, v89
  s_cbranch_vccz L_QKM_ok11
  buffer_load_dwordx4 v[4:7], v95, s[4:7], s98 offen offset:0 sc1
  s_nop 0
  buffer_load_dwordx4 v[8:11], v95, s[4:7], s98 offen offset:2048 sc1
  s_nop 0
  buffer_load_dwordx4 v[12:15], v95, s[4:7], s99 offen offset:0 sc1
  s_nop 0
  buffer_load_dwordx4 v[16:19], v95, s[4:7], s99 offen offset:2048 sc1
  s_nop 0
  s_branch L_QKM_ok11
L_QKM_g12:
  s_sub_u32 s24, s24, 1
  s_cbranch_scc1 L_FAIL
  s_add_u32 s60, s60, 256
  buffer_load_dwordx4 v[4:7], v95, s[4:7], s98 offen offset:0 sc1
  s_waitcnt vmcnt(0)
  v_cmp_eq_u32 vcc, -1, v4
  s_cbranch_vccnz L_QKM_g12
  v_mov_b32 v89, 0
  v_max3_u32 v89, v8, v12, v89
  v_max3_u32 v89, v16, v16, v89
  v_cmp_eq_u32 vcc, -1, v89
  s_cbranch_vccz L_QKM_ok12
  buffer_load_dwordx4 v[8:11], v95, s[4:7], s98 offen offset:2048 sc1
  s_nop 0
  buffer_load_dwordx4 v[12:15], v95, s[4:7], s99 offen offset:0 sc1
  s_nop 0
  buffer_load_dwordx4 v[16:19], v95, s[4:7], s99 offen offset:2048 sc1
  s_nop 0
  s_branch L_QKM_ok12
L_QKM_g13:
  s_sub_u32 s24, s24, 1
  s_cbranch_scc1 L_FAIL
  s_add_u32 s60, s60, 256
  buffer_load_dwordx4 v[8:11], v95, s[4:7], s98 offen offset:2048 sc1
  s_waitcnt vmcnt(0)
  v_cmp_eq_u32 vcc, -1, v8
  s_cbranch_vccnz L_QKM_g13
  v_mov_b32 v89, 0
  v_max3_u32 v89, v12, v16, v89
  v_cmp_eq_u32 vcc, -1, v89
  s_cbranch_vccz L_QKM_ok13
  buffer_load_dwordx4 v[12:15], v95, s[4:7], s99 offen offset:0 sc1
  s_nop 0
  buffer_load_dwordx4 v[16:19], v95, s[4:7], s99 offen offset:2048 sc1
  s_nop 0
  s_branch L_QKM_ok13
L_QKM_g14:
  s_sub_u32 s24, s24, 1
  s_cbranch_scc1 L_FAIL
  s_add_u32 s60, s60, 256
  buffer_load_dwordx4 v[12:15], v95, s[4:7], s99 offen offset:0 sc1
  s_waitcnt vmcnt(0)
  v_cmp_eq_u32 vcc, -1, v12
  s_cbranch_vccnz L_QKM_g14
  v_mov_b32 v89, 0
  v_max3_u32 v89, v16, v16, v89
  v_cmp_eq_u32 vcc, -1, v89
  s_cbranch_vccz L_QKM_ok14
  buffer_load_dwordx4 v[16:19], v95, s[4:7], s99 offen offset:2048 sc1
  s_nop 0
  s_branch L_QKM_ok14
L_QKM_g15:
  s_sub_u32 s24, s24, 1
  s_cbranch_scc1 L_FAIL
  s_add_u32 s60, s60, 256
  buffer_load_dwordx4 v[16:19], v95, s[4:7], s99 offen offset:2048 sc1
  s_waitcnt vmcnt(0)
  v_cmp_eq_u32 vcc, -1, v16
  s_cbranch_vccnz L_QKM_g15
  s_branch L_QKM_ok15
L_QK_sig:
  s_mov_b32 s63, s25
  s_atomic_smax s63, s[4:5], s62 glc
Lnosig_71:
  s_branch L_QK_sigd
L_QK_vbad:
  s_sub_u32 s24, s24, 1
  s_cbranch_scc1 L_FAIL
  s_add_u32 s61, s61, 1
  buffer_load_dwordx2 v[104:105], v92, s[4:7], s29 offen sc1
  buffer_load_dwordx2 v[106:107], v92, s[4:7], s35 offen sc1
  s_waitcnt vmcnt(0)
  v_max3_u32 v89, v104, v105, v106
  v_max_u32 v89, v89, v107
  v_cmp_eq_u32 vcc, -1, v89
  s_cbranch_vccnz L_QK_vbad
  s_branch L_QK_vok
L_VO:
  v_bfe_u32 v76, v0, 3, 2
  v_xor_b32 v76, s20, v76
  v_lshlrev_b32 v76, 5, v76
  v_lshrrev_b32 v4, 2, v0
  v_lshl_add_u32 v4, v4, 7, v76
  v_and_b32 v76, 3, v0
  v_lshl_add_u32 v4, v76, 3, v4
  s_lshl_b32 s40, s20, 15
  v_add_u32 v4, s40, v4
  v_lshl_add_u32 v85, v0, 4, s40
  s_lshl_b32 s40, s20, 12
  s_add_u32 s40, s40, 131072
  v_lshl_add_u32 v1, v0, 4, s40
  s_lshr_b32 s54, s21, 4
  s_lshl_b32 s52, s54, 22
  s_sub_u32 s53, 0, s52
  v_xor_b32 v5, 32768, v4
  v_xor_b32 v2, 4096, v1
  v_xor_b32 v6, 65536, v4
  v_xor_b32 v3, 8192, v1
  v_xor_b32 v7, 98304, v4
  v_xor_b32 v84, 12288, v1
  v_bfe_u32 v8, v0, 5, 1
  v_mul_u32_u24 v8, 16384, v8
  v_bfe_u32 v76, v0, 4, 1
  v_mul_u32_u24 v76, 32768, v76
  v_add_u32 v8, v8, v76
  v_bfe_u32 v76, v0, 3, 1
  v_mul_u32_u24 v76, 131072, v76
  v_add_u32 v8, v8, v76
  v_lshrrev_b32 v76, 3, v0
  v_and_b32 v76, 6, v76
  v_xor_b32 v76, v76, v0
  v_and_b32 v76, 7, v76
  v_lshl_add_u32 v8, v76, 4, v8
  s_lshl_b32 s40, s20, 19
  v_add_u32 v8, s40, v8
  s_lshl_b32 s44, s21, 8
  s_add_u32 s45, s44, 128
  s_load_dwordx2 s[8:9], s[0:1], 32
  s_mov_b32 s10, 8388608
  s_mov_b32 s11, 0x20000
  s_waitcnt lgkmcnt(0)
  v_add_u32 v9, s44, v8
  v_add_u32 v10, s45, v8
  s_lshl_b32 s41, s20, 15
  s_add_u32 m0, s41, 0
  s_add_u32 s42, s52, 0
  buffer_load_dwordx4 v9, s[8:11], s42 offen lds
  s_add_u32 m0, s41, 1024
  s_add_u32 s42, s52, 65536
  buffer_load_dwordx4 v9, s[8:11], s42 offen lds
  s_add_u32 m0, s41, 2048
  s_add_u32 s42, s52, 8192
  buffer_load_dwordx4 v9, s[8:11], s42 offen lds
  s_add_u32 m0, s41, 3072
  s_add_u32 s42, s52, 73728
  buffer_load_dwordx4 v9, s[8:11], s42 offen lds
  s_add_u32 m0, s41, 4096
  s_add_u32 s42, s52, 262144
  buffer_load_dwordx4 v9, s[8:11], s42 offen lds
  s_add_u32 m0, s41, 5120
  s_add_u32 s42, s52, 327680
  buffer_load_dwordx4 v9, s[8:11], s42 offen lds
  s_add_u32 m0, s41, 6144
  s_add_u32 s42, s52, 270336
  buffer_load_dwordx4 v9, s[8:11], s42 offen lds
  s_add_u32 m0, s41, 7168
  s_add_u32 s42, s52, 335872
  buffer_load_dwordx4 v9, s[8:11], s42 offen lds
  s_add_u32 m0, s41, 8192
  s_add_u32 s42, s52, 2097152
  buffer_load_dwordx4 v9, s[8:11], s42 offen lds
  s_add_u32 m0, s41, 9216
  s_add_u32 s42, s52, 2162688
  buffer_load_dwordx4 v9, s[8:11], s42 offen lds
  s_add_u32 m0, s41, 10240
  s_add_u32 s42, s52, 2105344
  buffer_load_dwordx4 v9, s[8:11], s42 offen lds
  s_add_u32 m0, s41, 11264
  s_add_u32 s42, s52, 2170880
  buffer_load_dwordx4 v9, s[8:11], s42 offen lds
  s_add_u32 m0, s41, 12288
  s_add_u32 s42, s52, 2359296
  buffer_load_dwordx4 v9, s[8:11], s42 offen lds
  s_add_u32 m0, s41, 13312
  s_add_u32 s42, s52, 2424832
  buffer_load_dwordx4 v9, s[8:11], s42 offen lds
  s_add_u32 m0, s41, 14336
  s_add_u32 s42, s52, 2367488
  buffer_load_dwordx4 v9, s[8:11], s42 offen lds
  s_add_u32 m0, s41, 15360
  s_add_u32 s42, s52, 2433024
  buffer_load_dwordx4 v9, s[8:11], s42 offen lds
  s_add_u32 m0, s41, 16384
  s_add_u32 s42, s53, 4194304
  buffer_load_dwordx4 v9, s[8:11], s42 offen lds
  s_add_u32 m0, s41, 17408
  s_add_u32 s42, s53, 4259840
  buffer_load_dwordx4 v9, s[8:11], s42 offen lds
  s_add_u32 m0, s41, 18432
  s_add_u32 s42, s53, 4202496
  buffer_load_dwordx4 v9, s[8:11], s42 offen lds
  s_add_u32 m0, s41, 19456
  s_add_u32 s42, s53, 4268032
  buffer_load_dwordx4 v9, s[8:11], s42 offen lds
  s_add_u32 m0, s41, 20480
  s_add_u32 s42, s53, 4456448
  buffer_load_dwordx4 v9, s[8:11], s42 offen lds
  s_add_u32 m0, s41, 21504
  s_add_u32 s42, s53, 4521984
  buffer_load_dwordx4 v9, s[8:11], s42 offen lds
  s_add_u32 m0, s41, 22528
  s_add_u32 s42, s53, 4464640
  buffer_load_dwordx4 v9, s[8:11], s42 offen lds
  s_add_u32 m0, s41, 23552
  s_add_u32 s42, s53, 4530176
  buffer_load_dwordx4 v9, s[8:11], s42 offen lds
  s_waitcnt vmcnt(16) lgkmcnt(0)
  s_barrier
  s_add_u32 m0, s41, 24576
  s_add_u32 s42, s53, 6291456
  buffer_load_dwordx4 v9, s[8:11], s42 offen lds
  s_add_u32 m0, s41, 25600
  s_add_u32 s42, s53, 6356992
  buffer_load_dwordx4 v9, s[8:11], s42 offen lds
  s_add_u32 m0, s41, 26624
  s_add_u32 s42, s53, 6299648
  buffer_load_dwordx4 v9, s[8:11], s42 offen lds
  s_add_u32 m0, s41, 27648
  s_add_u32 s42, s53, 6365184
  buffer_load_dwordx4 v9, s[8:11], s42 offen lds
  s_add_u32 m0, s41, 28672
  s_add_u32 s42, s53, 6553600
  buffer_load_dwordx4 v9, s[8:11], s42 offen lds
  s_add_u32 m0, s41, 29696
  s_add_u32 s42, s53, 6619136
  buffer_load_dwordx4 v9, s[8:11], s42 offen lds
  s_add_u32 m0, s41, 30720
  s_add_u32 s42, s53, 6561792
  buffer_load_dwordx4 v9, s[8:11], s42 offen lds
  s_add_u32 m0, s41, 31744
  s_add_u32 s42, s53, 6627328
  buffer_load_dwordx4 v9, s[8:11], s42 offen lds
  ds_read_b64_tr_b16 v[128:129], v4 offset:0
  ds_read_b64_tr_b16 v[130:131], v4 offset:2048
  ds_read_b64_tr_b16 v[132:133], v4 offset:4096
  ds_read_b64_tr_b16 v[134:135], v4 offset:6144
  ds_read_b64_tr_b16 v[144:145], v5 offset:0
  ds_read_b64_tr_b16 v[146:147], v5 offset:2048
  ds_read_b64_tr_b16 v[148:149], v5 offset:4096
  ds_read_b64_tr_b16 v[150:151], v5 offset:6144
  ds_read_b64_tr_b16 v[160:161], v6 offset:0
  ds_read_b64_tr_b16 v[162:163], v6 offset:2048
  ds_read_b64_tr_b16 v[164:165], v6 offset:4096
  ds_read_b64_tr_b16 v[166:167], v6 offset:6144
  ds_read_b64_tr_b16 v[176:177], v7 offset:0
  ds_read_b64_tr_b16 v[178:179], v7 offset:2048
  ds_read_b64_tr_b16 v[180:181], v7 offset:4096
  ds_read_b64_tr_b16 v[182:183], v7 offset:6144
  s_waitcnt vmcnt(16) lgkmcnt(0)
  s_barrier
  s_add_u32 m0, s41, 0
  s_add_u32 s42, s52, 0
  buffer_load_dwordx4 v10, s[8:11], s42 offen lds
  s_add_u32 m0, s41, 1024
  s_add_u32 s42, s52, 65536
  buffer_load_dwordx4 v10, s[8:11], s42 offen lds
  s_add_u32 m0, s41, 2048
  s_add_u32 s42, s52, 8192
  buffer_load_dwordx4 v10, s[8:11], s42 offen lds
  s_add_u32 m0, s41, 3072
  s_add_u32 s42, s52, 73728
  buffer_load_dwordx4 v10, s[8:11], s42 offen lds
  s_add_u32 m0, s41, 4096
  s_add_u32 s42, s52, 262144
  buffer_load_dwordx4 v10, s[8:11], s42 offen lds
  s_add_u32 m0, s41, 5120
  s_add_u32 s42, s52, 327680
  buffer_load_dwordx4 v10, s[8:11], s42 offen lds
  s_add_u32 m0, s41, 6144
  s_add_u32 s42, s52, 270336
  buffer_load_dwordx4 v10, s[8:11], s42 offen lds
  s_add_u32 m0, s41, 7168
  s_add_u32 s42, s52, 335872
  buffer_load_dwordx4 v10, s[8:11], s42 offen lds
  ds_read_b64_tr_b16 v[136:137], v4 offset:8192
  ds_read_b64_tr_b16 v[138:139], v4 offset:10240
  ds_read_b64_tr_b16 v[140:141], v4 offset:12288
  ds_read_b64_tr_b16 v[142:143], v4 offset:14336
  ds_read_b64_tr_b16 v[152:153], v5 offset:8192
  ds_read_b64_tr_b16 v[154:155], v5 offset:10240
  ds_read_b64_tr_b16 v[156:157], v5 offset:12288
  ds_read_b64_tr_b16 v[158:159], v5 offset:14336
  ds_read_b64_tr_b16 v[168:169], v6 offset:8192
  ds_read_b64_tr_b16 v[170:171], v6 offset:10240
  ds_read_b64_tr_b16 v[172:173], v6 offset:12288
  ds_read_b64_tr_b16 v[174:175], v6 offset:14336
  ds_read_b64_tr_b16 v[184:185], v7 offset:8192
  ds_read_b64_tr_b16 v[186:187], v7 offset:10240
  ds_read_b64_tr_b16 v[188:189], v7 offset:12288
  ds_read_b64_tr_b16 v[190:191], v7 offset:14336
  s_waitcnt vmcnt(16) lgkmcnt(0)
  s_barrier
  s_add_u32 m0, s41, 8192
  s_add_u32 s42, s52, 2097152
  buffer_load_dwordx4 v10, s[8:11], s42 offen lds
  s_add_u32 m0, s41, 9216
  s_add_u32 s42, s52, 2162688
  buffer_load_dwordx4 v10, s[8:11], s42 offen lds
  s_add_u32 m0, s41, 10240
  s_add_u32 s42, s52, 2105344
  buffer_load_dwordx4 v10, s[8:11], s42 offen lds
  s_add_u32 m0, s41, 11264
  s_add_u32 s42, s52, 2170880
  buffer_load_dwordx4 v10, s[8:11], s42 offen lds
  s_add_u32 m0, s41, 12288
  s_add_u32 s42, s52, 2359296
  buffer_load_dwordx4 v10, s[8:11], s42 offen lds
  s_add_u32 m0, s41, 13312
  s_add_u32 s42, s52, 2424832
  buffer_load_dwordx4 v10, s[8:11], s42 offen lds
  s_add_u32 m0, s41, 14336
  s_add_u32 s42, s52, 2367488
  buffer_load_dwordx4 v10, s[8:11], s42 offen lds
  s_add_u32 m0, s41, 15360
  s_add_u32 s42, s52, 2433024
  buffer_load_dwordx4 v10, s[8:11], s42 offen lds
  ds_read_b64_tr_b16 v[192:193], v4 offset:16384
  ds_read_b64_tr_b16 v[194:195], v4 offset:18432
  ds_read_b64_tr_b16 v[196:197], v4 offset:20480
  ds_read_b64_tr_b16 v[198:199], v4 offset:22528
  ds_read_b64_tr_b16 v[208:209], v5 offset:16384
  ds_read_b64_tr_b16 v[210:211], v5 offset:18432
  ds_read_b64_tr_b16 v[212:213], v5 offset:20480
  ds_read_b64_tr_b16 v[214:215], v5 offset:22528
  ds_read_b64_tr_b16 v[224:225], v6 offset:16384
  ds_read_b64_tr_b16 v[226:227], v6 offset:18432
  ds_read_b64_tr_b16 v[228:229], v6 offset:20480
  ds_read_b64_tr_b16 v[230:231], v6 offset:22528
  ds_read_b64_tr_b16 v[240:241], v7 offset:16384
  ds_read_b64_tr_b16 v[242:243], v7 offset:18432
  ds_read_b64_tr_b16 v[244:245], v7 offset:20480
  ds_read_b64_tr_b16 v[246:247], v7 offset:22528
  s_waitcnt vmcnt(16) lgkmcnt(0)
  s_barrier
  s_add_u32 m0, s41, 16384
  s_add_u32 s42, s53, 4194304
  buffer_load_dwordx4 v10, s[8:11], s42 offen lds
  s_add_u32 m0, s41, 17408
  s_add_u32 s42, s53, 4259840
  buffer_load_dwordx4 v10, s[8:11], s42 offen lds
  s_add_u32 m0, s41, 18432
  s_add_u32 s42, s53, 4202496
  buffer_load_dwordx4 v10, s[8:11], s42 offen lds
  s_add_u32 m0, s41, 19456
  s_add_u32 s42, s53, 4268032
  buffer_load_dwordx4 v10, s[8:11], s42 offen lds
  s_add_u32 m0, s41, 20480
  s_add_u32 s42, s53, 4456448
  buffer_load_dwordx4 v10, s[8:11], s42 offen lds
  s_add_u32 m0, s41, 21504
  s_add_u32 s42, s53, 4521984
  buffer_load_dwordx4 v10, s[8:11], s42 offen lds
  s_add_u32 m0, s41, 22528
  s_add_u32 s42, s53, 4464640
  buffer_load_dwordx4 v10, s[8:11], s42 offen lds
  s_add_u32 m0, s41, 23552
  s_add_u32 s42, s53, 4530176
  buffer_load_dwordx4 v10, s[8:11], s42 offen lds
  ds_read_b64_tr_b16 v[200:201], v4 offset:24576
  ds_read_b64_tr_b16 v[202:203], v4 offset:26624
  ds_read_b64_tr_b16 v[204:205], v4 offset:28672
  ds_read_b64_tr_b16 v[206:207], v4 offset:30720
  ds_read_b64_tr_b16 v[216:217], v5 offset:24576
  ds_read_b64_tr_b16 v[218:219], v5 offset:26624
  ds_read_b64_tr_b16 v[220:221], v5 offset:28672
  ds_read_b64_tr_b16 v[222:223], v5 offset:30720
  ds_read_b64_tr_b16 v[232:233], v6 offset:24576
  ds_read_b64_tr_b16 v[234:235], v6 offset:26624
  ds_read_b64_tr_b16 v[236:237], v6 offset:28672
  ds_read_b64_tr_b16 v[238:239], v6 offset:30720
  ds_read_b64_tr_b16 v[248:249], v7 offset:24576
  ds_read_b64_tr_b16 v[250:251], v7 offset:26624
  ds_read_b64_tr_b16 v[252:253], v7 offset:28672
  ds_read_b64_tr_b16 v[254:255], v7 offset:30720
  s_cmp_lg_u32 s20, 0
  s_cbranch_scc1 Lchore_72
Lini_73:
  s_load_dwordx16 s[64:79], s[12:13], 128 glc
  s_load_dwordx16 s[80:95], s[12:13], 192 glc
  s_sub_u32 s24, s24, 1
  s_cbranch_scc1 L_FAIL
  s_waitcnt lgkmcnt(0)
  s_and_b64 s[64:65], s[64:65], s[66:67]
  s_and_b64 s[64:65], s[64:65], s[68:69]
  s_and_b64 s[64:65], s[64:65], s[70:71]
  s_and_b64 s[64:65], s[64:65], s[72:73]
  s_and_b64 s[64:65], s[64:65], s[74:75]
  s_and_b64 s[64:65], s[64:65], s[76:77]
  s_and_b64 s[64:65], s[64:65], s[78:79]
  s_and_b64 s[64:65], s[64:65], s[80:81]
  s_and_b64 s[64:65], s[64:65], s[82:83]
  s_and_b64 s[64:65], s[64:65], s[84:85]
  s_and_b64 s[64:65], s[64:65], s[86:87]
  s_and_b64 s[64:65], s[64:65], s[88:89]
  s_and_b64 s[64:65], s[64:65], s[90:91]
  s_and_b64 s[64:65], s[64:65], s[92:93]
  s_and_b64 s[64:65], s[64:65], s[94:95]
  s_and_b32 s64, s64, s65
  s_cbranch_scc0 Lini_73
  s_mov_b32 s46, 0xffff
  s_and_b32 s40, s21, 3
  s_lshl_b32 s40, s40, 13
  s_lshr_b32 s43, s21, 2
  s_lshl_b32 s43, s43, 10
  s_add_u32 s43, s43, s40
  s_add_u32 s43, s43, 1344000
  s_waitcnt lgkmcnt(0)
  s_memtime s[64:65]
  s_waitcnt lgkmcnt(0)
  s_load_dword s68, s[4:5], s43 glc
  s_waitcnt lgkmcnt(0)
  s_memtime s[66:67]
  s_waitcnt lgkmcnt(0)
  s_sub_u32 s64, s66, s64
  s_min_u32 s46, s46, s64
  s_getreg_b32 s55, hwreg(HW_REG_XCC_ID)
  s_and_b32 s55, s55, 15
  s_lshl_b32 s46, s46, 8
  s_or_b32 s46, s46, s55
  s_add_u32 s40, s21, 32
  s_lshl_b32 s40, s40, 7
  s_add_u32 s40, s40, 1424384
  s_mov_b32 s63, s46
  s_atomic_smax s63, s[4:5], s40 glc
Lnosig_74:
Lchore_72:
  s_waitcnt vmcnt(16) lgkmcnt(0)
  s_barrier
  s_add_u32 m0, s41, 24576
  s_add_u32 s42, s53, 6291456
  buffer_load_dwordx4 v10, s[8:11], s42 offen lds
  s_add_u32 m0, s41, 25600
  s_add_u32 s42, s53, 6356992
  buffer_load_dwordx4 v10, s[8:11], s42 offen lds
  s_add_u32 m0, s41, 26624
  s_add_u32 s42, s53, 6299648
  buffer_load_dwordx4 v10, s[8:11], s42 offen lds
  s_add_u32 m0, s41, 27648
  s_add_u32 s42, s53, 6365184
  buffer_load_dwordx4 v10, s[8:11], s42 offen lds
  s_add_u32 m0, s41, 28672
  s_add_u32 s42, s53, 6553600
  buffer_load_dwordx4 v10, s[8:11], s42 offen lds
  s_add_u32 m0, s41, 29696
  s_add_u32 s42, s53, 6619136
  buffer_load_dwordx4 v10, s[8:11], s42 offen lds
  s_add_u32 m0, s41, 30720
  s_add_u32 s42, s53, 6561792
  buffer_load_dwordx4 v10, s[8:11], s42 offen lds
  s_add_u32 m0, s41, 31744
  s_add_u32 s42, s53, 6627328
  buffer_load_dwordx4 v10, s[8:11], s42 offen lds
  ds_read_b64_tr_b16 v[20:21], v4 offset:0
  ds_read_b64_tr_b16 v[22:23], v4 offset:2048
  ds_read_b64_tr_b16 v[24:25], v4 offset:4096
  ds_read_b64_tr_b16 v[26:27], v4 offset:6144
  ds_read_b64_tr_b16 v[28:29], v5 offset:0
  ds_read_b64_tr_b16 v[30:31], v5 offset:2048
  ds_read_b64_tr_b16 v[32:33], v5 offset:4096
  ds_read_b64_tr_b16 v[34:35], v5 offset:6144
  ds_read_b64_tr_b16 v[36:37], v6 offset:0
  ds_read_b64_tr_b16 v[38:39], v6 offset:2048
  ds_read_b64_tr_b16 v[40:41], v6 offset:4096
  ds_read_b64_tr_b16 v[42:43], v6 offset:6144
  ds_read_b64_tr_b16 v[44:45], v7 offset:0
  ds_read_b64_tr_b16 v[46:47], v7 offset:2048
  ds_read_b64_tr_b16 v[48:49], v7 offset:4096
  ds_read_b64_tr_b16 v[50:51], v7 offset:6144
  s_waitcnt lgkmcnt(0)
  s_barrier
  ds_write_b128 v85, v[20:23] offset:0
  ds_write_b128 v85, v[24:27] offset:1024
  ds_write_b128 v85, v[28:31] offset:2048
  ds_write_b128 v85, v[32:35] offset:3072
  ds_write_b128 v85, v[36:39] offset:4096
  ds_write_b128 v85, v[40:43] offset:5120
  ds_write_b128 v85, v[44:47] offset:6144
  ds_write_b128 v85, v[48:51] offset:7168
  s_waitcnt vmcnt(16) lgkmcnt(0)
  s_barrier
  ds_read_b64_tr_b16 v[20:21], v4 offset:8192
  ds_read_b64_tr_b16 v[22:23], v4 offset:10240
  ds_read_b64_tr_b16 v[24:25], v4 offset:12288
  ds_read_b64_tr_b16 v[26:27], v4 offset:14336
  ds_read_b64_tr_b16 v[28:29], v5 offset:8192
  ds_read_b64_tr_b16 v[30:31], v5 offset:10240
  ds_read_b64_tr_b16 v[32:33], v5 offset:12288
  ds_read_b64_tr_b16 v[34:35], v5 offset:14336
  ds_read_b64_tr_b16 v[36:37], v6 offset:8192
  ds_read_b64_tr_b16 v[38:39], v6 offset:10240
  ds_read_b64_tr_b16 v[40:41], v6 offset:12288
  ds_read_b64_tr_b16 v[42:43], v6 offset:14336
  ds_read_b64_tr_b16 v[44:45], v7 offset:8192
  ds_read_b64_tr_b16 v[46:47], v7 offset:10240
  ds_read_b64_tr_b16 v[48:49], v7 offset:12288
  ds_read_b64_tr_b16 v[50:51], v7 offset:14336
  s_waitcnt lgkmcnt(0)
  s_barrier
  ds_write_b128 v85, v[20:23] offset:8192
  ds_write_b128 v85, v[24:27] offset:9216
  ds_write_b128 v85, v[28:31] offset:10240
  ds_write_b128 v85, v[32:35] offset:11264
  ds_write_b128 v85, v[36:39] offset:12288
  ds_write_b128 v85, v[40:43] offset:13312
  ds_write_b128 v85, v[44:47] offset:14336
  ds_write_b128 v85, v[48:51] offset:15360
  s_waitcnt vmcnt(8) lgkmcnt(0)
  s_barrier
  ds_read_b64_tr_b16 v[20:21], v4 offset:16384
  ds_read_b64_tr_b16 v[22:23], v4 offset:18432
  ds_read_b64_tr_b16 v[24:25], v4 offset:20480
  ds_read_b64_tr_b16 v[26:27], v4 offset:22528
  ds_read_b64_tr_b16 v[28:29], v5 offset:16384
  ds_read_b64_tr_b16 v[30:31], v5 offset:18432
  ds_read_b64_tr_b16 v[32:33], v5 offset:20480
  ds_read_b64_tr_b16 v[34:35], v5 offset:22528
  ds_read_b64_tr_b16 v[36:37], v6 offset:16384
  ds_read_b64_tr_b16 v[38:39], v6 offset:18432
  ds_read_b64_tr_b16 v[40:41], v6 offset:20480
  ds_read_b64_tr_b16 v[42:43], v6 offset:22528
  ds_read_b64_tr_b16 v[44:45], v7 offset:16384
  ds_read_b64_tr_b16 v[46:47], v7 offset:18432
  ds_read_b64_tr_b16 v[48:49], v7 offset:20480
  ds_read_b64_tr_b16 v[50:51], v7 offset:22528
  s_waitcnt lgkmcnt(0)
  s_barrier
  ds_write_b128 v85, v[20:23] offset:16384
  ds_write_b128 v85, v[24:27] offset:17408
  ds_write_b128 v85, v[28:31] offset:18432
  ds_write_b128 v85, v[32:35] offset:19456
  ds_write_b128 v85, v[36:39] offset:20480
  ds_write_b128 v85, v[40:43] offset:21504
  ds_write_b128 v85, v[44:47] offset:22528
  ds_write_b128 v85, v[48:51] offset:23552
  s_waitcnt vmcnt(0) lgkmcnt(0)
  s_barrier
  ds_read_b64_tr_b16 v[20:21], v4 offset:24576
  ds_read_b64_tr_b16 v[22:23], v4 offset:26624
  ds_read_b64_tr_b16 v[24:25], v4 offset:28672
  ds_read_b64_tr_b16 v[26:27], v4 offset:30720
  ds_read_b64_tr_b16 v[28:29], v5 offset:24576
  ds_read_b64_tr_b16 v[30:31], v5 offset:26624
  ds_read_b64_tr_b16 v[32:33], v5 offset:28672
  ds_read_b64_tr_b16 v[34:35], v5 offset:30720
  ds_read_b64_tr_b16 v[36:37], v6 offset:24576
  ds_read_b64_tr_b16 v[38:39], v6 offset:26624
  ds_read_b64_tr_b16 v[40:41], v6 offset:28672
  ds_read_b64_tr_b16 v[42:43], v6 offset:30720
  ds_read_b64_tr_b16 v[44:45], v7 offset:24576
  ds_read_b64_tr_b16 v[46:47], v7 offset:26624
  ds_read_b64_tr_b16 v[48:49], v7 offset:28672
  ds_read_b64_tr_b16 v[50:51], v7 offset:30720
  s_waitcnt lgkmcnt(0)
  s_barrier
  ds_write_b128 v85, v[20:23] offset:24576
  ds_write_b128 v85, v[24:27] offset:25600
  ds_write_b128 v85, v[28:31] offset:26624
  ds_write_b128 v85, v[32:35] offset:27648
  ds_write_b128 v85, v[36:39] offset:28672
  ds_write_b128 v85, v[40:43] offset:29696
  ds_write_b128 v85, v[44:47] offset:30720
  ds_write_b128 v85, v[48:51] offset:31744
  s_waitcnt lgkmcnt(0)
  s_lshr_b32 s40, s21, 1
  s_lshl_b32 s40, s40, 2
  v_min_u32 v76, 3, v0
  v_add_u32 v76, s40, v76
  v_lshlrev_b32 v76, 7, v76
  v_add_u32 v76, 1432576, v76
  s_nop 1
Lpoll_75:
  buffer_load_dword v77, v76, s[4:7], 0 offen sc1
  s_sub_u32 s24, s24, 1
  s_cbranch_scc1 L_FAIL
  s_waitcnt vmcnt(0)
  v_cmp_gt_i32 vcc, 1, v77
  s_cbranch_vccz Lpolld_76
  s_sleep 1
  s_branch Lpoll_75
Lpolld_76:
  s_lshl_b32 s40, s21, 18
  s_lshl_b32 s41, s20, 15
  s_add_u32 s40, s40, s41
  v_lshl_add_u32 v76, v0, 4, s40
  s_add_u32 s50, s21, s20
  s_and_b32 s50, s50, 3
  s_lshl_b32 s41, s54, 5
  s_add_u32 s41, s41, s50
  s_lshl_b32 s41, s41, 12
  s_xor_b32 s40, s41, 0
  s_add_u32 s40, s40, 6291456
  buffer_load_dwordx4 a[0:3], v76, s[4:7], s40 offen offset:0 sc1
  buffer_load_dwordx4 a[4:7], v76, s[4:7], s40 offen offset:1024 sc1
  buffer_load_dwordx4 a[8:11], v76, s[4:7], s40 offen offset:2048 sc1
  buffer_load_dwordx4 a[12:15], v76, s[4:7], s40 offen offset:3072 sc1
  s_xor_b32 s40, s41, 4096
  s_add_u32 s40, s40, 6291456
  buffer_load_dwordx4 a[16:19], v76, s[4:7], s40 offen offset:0 sc1
  buffer_load_dwordx4 a[20:23], v76, s[4:7], s40 offen offset:1024 sc1
  buffer_load_dwordx4 a[24:27], v76, s[4:7], s40 offen offset:2048 sc1
  buffer_load_dwordx4 a[28:31], v76, s[4:7], s40 offen offset:3072 sc1
  s_xor_b32 s40, s41, 8192
  s_add_u32 s40, s40, 6291456
  buffer_load_dwordx4 a[32:35], v76, s[4:7], s40 offen offset:0 sc1
  buffer_load_dwordx4 a[36:39], v76, s[4:7], s40 offen offset:1024 sc1
  buffer_load_dwordx4 a[40:43], v76, s[4:7], s40 offen offset:2048 sc1
  buffer_load_dwordx4 a[44:47], v76, s[4:7], s40 offen offset:3072 sc1
  s_xor_b32 s40, s41, 12288
  s_add_u32 s40, s40, 6291456
  buffer_load_dwordx4 a[48:51], v76, s[4:7], s40 offen offset:0 sc1
  buffer_load_dwordx4 a[52:55], v76, s[4:7], s40 offen offset:1024 sc1
  buffer_load_dwordx4 a[56:59], v76, s[4:7], s40 offen offset:2048 sc1
  buffer_load_dwordx4 a[60:63], v76, s[4:7], s40 offen offset:3072 sc1
  s_xor_b32 s40, s41, 16384
  s_add_u32 s40, s40, 6291456
  buffer_load_dwordx4 a[64:67], v76, s[4:7], s40 offen offset:0 sc1
  buffer_load_dwordx4 a[68:71], v76, s[4:7], s40 offen offset:1024 sc1
  buffer_load_dwordx4 a[72:75], v76, s[4:7], s40 offen offset:2048 sc1
  buffer_load_dwordx4 a[76:79], v76, s[4:7], s40 offen offset:3072 sc1
  s_xor_b32 s40, s41, 20480
  s_add_u32 s40, s40, 6291456
  buffer_load_dwordx4 a[80:83], v76, s[4:7], s40 offen offset:0 sc1
  buffer_load_dwordx4 a[84:87], v76, s[4:7], s40 offen offset:1024 sc1
  buffer_load_dwordx4 a[88:91], v76, s[4:7], s40 offen offset:2048 sc1
  buffer_load_dwordx4 a[92:95], v76, s[4:7], s40 offen offset:3072 sc1
  s_xor_b32 s40, s41, 24576
  s_add_u32 s40, s40, 6291456
  buffer_load_dwordx4 a[96:99], v76, s[4:7], s40 offen offset:0 sc1
  buffer_load_dwordx4 a[100:103], v76, s[4:7], s40 offen offset:1024 sc1
  buffer_load_dwordx4 a[104:107], v76, s[4:7], s40 offen offset:2048 sc1
  buffer_load_dwordx4 a[108:111], v76, s[4:7], s40 offen offset:3072 sc1
  s_xor_b32 s40, s41, 28672
  s_add_u32 s40, s40, 6291456
  buffer_load_dwordx4 a[112:115], v76, s[4:7], s40 offen offset:0 sc1
  buffer_load_dwordx4 a[116:119], v76, s[4:7], s40 offen offset:1024 sc1
  buffer_load_dwordx4 a[120:123], v76, s[4:7], s40 offen offset:2048 sc1
  buffer_load_dwordx4 a[124:127], v76, s[4:7], s40 offen offset:3072 sc1
  s_xor_b32 s40, s41, 131072
  s_add_u32 s40, s40, 6291456
  buffer_load_dwordx4 a[128:131], v76, s[4:7], s40 offen offset:0 sc1
  buffer_load_dwordx4 a[132:135], v76, s[4:7], s40 offen offset:1024 sc1
  buffer_load_dwordx4 a[136:139], v76, s[4:7], s40 offen offset:2048 sc1
  buffer_load_dwordx4 a[140:143], v76, s[4:7], s40 offen offset:3072 sc1
  s_waitcnt vmcnt(32)
  s_xor_b32 s40, s41, 135168
  s_add_u32 s40, s40, 6291456
  buffer_load_dwordx4 a[144:147], v76, s[4:7], s40 offen offset:0 sc1
  buffer_load_dwordx4 a[148:151], v76, s[4:7], s40 offen offset:1024 sc1
  buffer_load_dwordx4 a[152:155], v76, s[4:7], s40 offen offset:2048 sc1
  buffer_load_dwordx4 a[156:159], v76, s[4:7], s40 offen offset:3072 sc1
  s_waitcnt vmcnt(32)
  s_xor_b32 s40, s41, 139264
  s_add_u32 s40, s40, 6291456
  buffer_load_dwordx4 a[160:163], v76, s[4:7], s40 offen offset:0 sc1
  buffer_load_dwordx4 a[164:167], v76, s[4:7], s40 offen offset:1024 sc1
  buffer_load_dwordx4 a[168:171], v76, s[4:7], s40 offen offset:2048 sc1
  buffer_load_dwordx4 a[172:175], v76, s[4:7], s40 offen offset:3072 sc1
  s_waitcnt vmcnt(32)
  s_xor_b32 s40, s41, 143360
  s_add_u32 s40, s40, 6291456
  buffer_load_dwordx4 a[176:179], v76, s[4:7], s40 offen offset:0 sc1
  buffer_load_dwordx4 a[180:183], v76, s[4:7], s40 offen offset:1024 sc1
  buffer_load_dwordx4 a[184:187], v76, s[4:7], s40 offen offset:2048 sc1
  buffer_load_dwordx4 a[188:191], v76, s[4:7], s40 offen offset:3072 sc1
  s_waitcnt vmcnt(32)
  s_xor_b32 s40, s41, 147456
  s_add_u32 s40, s40, 6291456
  buffer_load_dwordx4 a[192:195], v76, s[4:7], s40 offen offset:0 sc1
  buffer_load_dwordx4 a[196:199], v76, s[4:7], s40 offen offset:1024 sc1
  buffer_load_dwordx4 a[200:203], v76, s[4:7], s40 offen offset:2048 sc1
  buffer_load_dwordx4 a[204:207], v76, s[4:7], s40 offen offset:3072 sc1
  s_waitcnt vmcnt(32)
  s_xor_b32 s40, s41, 151552
  s_add_u32 s40, s40, 6291456
  buffer_load_dwordx4 a[208:211], v76, s[4:7], s40 offen offset:0 sc1
  buffer_load_dwordx4 a[212:215], v76, s[4:7], s40 offen offset:1024 sc1
  buffer_load_dwordx4 a[216:219], v76, s[4:7], s40 offen offset:2048 sc1
  buffer_load_dwordx4 a[220:223], v76, s[4:7], s40 offen offset:3072 sc1
  s_waitcnt vmcnt(32)
  s_xor_b32 s40, s41, 155648
  s_add_u32 s40, s40, 6291456
  buffer_load_dwordx4 a[224:227], v76, s[4:7], s40 offen offset:0 sc1
  buffer_load_dwordx4 a[228:231], v76, s[4:7], s40 offen offset:1024 sc1
  buffer_load_dwordx4 a[232:235], v76, s[4:7], s40 offen offset:2048 sc1
  buffer_load_dwordx4 a[236:239], v76, s[4:7], s40 offen offset:3072 sc1
  s_waitcnt vmcnt(32)
  s_xor_b32 s40, s41, 159744
  s_add_u32 s40, s40, 6291456
  buffer_load_dwordx4 a[240:243], v76, s[4:7], s40 offen offset:0 sc1
  buffer_load_dwordx4 a[244:247], v76, s[4:7], s40 offen offset:1024 sc1
  buffer_load_dwordx4 a[248:251], v76, s[4:7], s40 offen offset:2048 sc1
  buffer_load_dwordx4 a[252:255], v76, s[4:7], s40 offen offset:3072 sc1
  s_waitcnt vmcnt(32)
  s_cmp_lg_u32 s20, 2
  s_cbranch_scc1 Lnotlb_77
  v_lshlrev_b32 v77, 21, v0
  s_mov_b32 s40, 0x1fff80
  buffer_load_dword v78, v77, s[4:7], s40 offen
  s_add_u32 s40, s40, 134217728
  buffer_load_dword v78, v77, s[4:7], s40 offen
  s_waitcnt vmcnt(0)
Lnotlb_77:
  s_getreg_b32 s55, hwreg(HW_REG_XCC_ID)
  s_and_b32 s55, s55, 15
  v_min_u32 v76, 63, v0
  v_lshlrev_b32 v76, 7, v76
  v_add_u32 v76, 1424384, v76
  s_nop 1
Lpoll_78:
  buffer_load_dword v77, v76, s[4:7], 0 offen sc1
  s_sub_u32 s24, s24, 1
  s_cbranch_scc1 L_FAIL
  s_waitcnt vmcnt(0)
  v_cmp_gt_i32 vcc, 0, v77
  s_cbranch_vccz Lpolld_79
  s_sleep 1
  s_branch Lpoll_78
Lpolld_79:
  v_and_b32 v78, 15, v77
  v_cmp_ne_u32 vcc, s55, v78
  s_lshl_b32 s40, s54, 4
  s_lshl_b32 s40, 0xffff, s40
  s_or_b32 s41, vcc_lo, vcc_hi
  s_and_b32 s40, s40, s41
  s_cselect_b32 s36, 0, 8192
  v_lshrrev_b32 v77, 8, v77
  v_and_b32 v78, 3, v0
  v_lshl_or_b32 v77, v77, 2, v78
  s_nop 1
  v_min_u32_dpp v77, v77, v77 row_ror:8 row_mask:0xf bank_mask:0xf
  s_nop 1
  v_min_u32_dpp v77, v77, v77 row_ror:4 row_mask:0xf bank_mask:0xf
  v_mov_b32 v78, v77
  s_nop 1
  v_permlane16_swap_b32 v78, v77
  v_min_u32 v77, v77, v78
  v_mov_b32 v78, v77
  s_nop 1
  v_permlane32_swap_b32 v78, v77
  v_min_u32 v77, v77, v78
  s_nop 1
  v_min_u32_dpp v77, v77, v77 row_ror:2 row_mask:0xf bank_mask:0xf
  s_nop 1
  v_min_u32_dpp v77, v77, v77 row_ror:1 row_mask:0xf bank_mask:0xf
  s_nop 0
  v_readfirstlane_b32 s26, v77
  s_and_b32 s26, s26, 3
  s_lshl_b32 s26, s26, 13
  s_lshr_b32 s40, s20, 1
  s_mul_i32 s40, s40, 32768
  s_and_b32 s41, s20, 1
  s_lshl_b32 s41, s41, 10
  s_add_u32 s40, s40, s41
  s_lshl_b32 s41, s54, 12
  s_add_u32 s40, s40, s41
  v_lshl_add_u32 v86, v0, 4, s40
  v_xor_b32 v87, 0x1000, v86
  v_and_b32 v76, 2, v0
  v_cmp_eq_u32 vcc, 0, v76
  v_mov_b32 v76, 0xeeee
  v_mov_b32 v77, 0x4444
  v_cndmask_b32 v88, v76, v77, vcc
  s_lshr_b32 s40, s21, 2
  s_mul_i32 s40, s40, 32768
  s_and_b32 s41, s21, 3
  s_lshl_b32 s41, s41, 11
  s_add_u32 s47, s40, s41
  s_lshl_b32 s41, s20, 9
  s_add_u32 s47, s47, s41
  v_lshl_add_u32 v92, v0, 3, s47
  s_lshl_b32 s41, s54, 12
  s_add_u32 s40, s41, 1310720
  s_add_u32 s40, s40, s26
  v_lshrrev_b32 v76, 2, v0
  v_lshl_add_u32 v76, v76, 7, s40
  v_and_b32 v77, 3, v0
  v_lshl_add_u32 v90, v77, 2, v76
  s_mov_b32 s57, s40
  s_cmp_eq_u32 s36, 0
  s_cselect_b32 s56, 1, s20
  s_and_b32 s41, s21, 15
  s_lshl_b32 s41, s41, 7
  s_lshl_b32 s40, s20, 2
  s_add_u32 s40, s40, s41
  s_add_u32 s40, s40, 0
  s_mov_b32 s25, 0
  s_mov_b32 s60, 0
  s_mov_b32 s61, 0
  s_mov_b32 s51, -1
  v_mov_b32 v91, 2147483392
  s_mov_b64 exec, 1
  v_mov_b32 v91, s40
  s_mov_b64 exec, -1
  v_mov_b32 v80, -1
  v_mov_b32 v81, -1
  v_mov_b32 v82, -1
  v_mov_b32 v83, -1
  s_mul_i32 s40, s20, 32768
  s_and_b32 s41, s50, 3
  s_lshl_b32 s41, s41, 10
  s_add_u32 s40, s40, s41
  v_lshl_add_u32 v110, v0, 4, s40
  v_xor_b32 v111, 0x400, v110
  v_xor_b32 v112, 0x800, v110
  v_xor_b32 v113, 0xc00, v110
  s_mul_i32 s58, s54, 131072
  s_and_b32 s41, s50, 4
  s_lshl_b32 s41, s41, 10
  s_add_u32 s58, s58, s41
  s_bfe_u32 s40, s21, 0x20002
  s_lshl_b32 s40, s40, 7
  s_and_b32 s41, s21, 3
  s_lshl_b32 s41, s41, 4
  s_add_u32 s40, s40, s41
  s_lshl_b32 s41, s20, 2
  s_add_u32 s41, s41, s40
  s_cmp_eq_u32 s20, 0
  s_cselect_b32 s40, s40, s41
  s_mov_b64 exec, 1
  v_mov_b32 v91, s40
  s_mov_b64 exec, -1
  s_mul_i32 s40, s20, 512
  v_add_u32 v90, s40, v90
  s_lshl_b32 s40, s20, 10
  s_add_u32 s40, s40, 147456
  v_lshl_add_u32 v95, v0, 4, s40
  s_and_b32 s40, s20, 1
  s_lshl_b32 s40, s40, 3
  v_bfe_u32 v4, v0, 2, 3
  v_add_u32 v4, s40, v4
  s_lshr_b32 s40, s20, 1
  s_lshl_b32 s40, s40, 3
  v_and_b32 v5, 3, v0
  v_add_u32 v5, s40, v5
  v_bfe_u32 v76, v4, 1, 1
  v_lshl_add_u32 v5, v76, 2, v5
  v_lshrrev_b32 v76, 2, v4
  v_and_b32 v77, 1, v4
  v_lshl_add_u32 v78, v76, 4, v5
  v_lshlrev_b32 v78, 4, v78
  v_lshl_add_u32 v78, v77, 3, v78
  v_add_u32 v108, 147456, v78
  s_bfe_u32 s41, s21, 0x10002
  s_mul_i32 s41, s41, 32768
  s_lshr_b32 s40, s21, 3
  s_lshl_b32 s40, s40, 11
  s_add_u32 s40, s40, s41
  s_and_b32 s41, s21, 3
  s_lshl_b32 s41, s41, 9
  s_add_u32 s40, s40, s41
  s_lshl_b32 s41, s20, 7
  s_add_u32 s40, s40, s41
  v_lshl_add_u32 v109, v0, 2, s40
  s_mov_b32 exec_lo, 0
  v_mov_b32 v109, 2147483392
  s_mov_b64 exec, -1
  s_mov_b32 s25, 0
  s_and_b32 s40, s25, 3
  s_lshl_b32 s40, s40, 16
  s_add_u32 s27, s40, s26
  s_add_u32 s27, s27, 1048576
  s_xor_b32 s37, s27, s36
  s_lshl_b32 s40, s40, 2
  s_add_u32 s28, s40, s26
  s_lshr_b32 s40, s40, 5
  s_and_b32 s40, s40, 0x4000
  s_xor_b32 s28, s28, s40
  s_xor_b32 s29, s28, 0x4000
  s_xor_b32 s40, s29, 0
  buffer_load_dword v89, v92, s[4:7], s40 offen sc1
  s_xor_b32 s40, s27, 8192
  buffer_load_dword v89, v109, s[4:7], s40 offen sc1
  s_mov_b32 s25, 1
  s_and_b32 s40, s25, 3
  s_lshl_b32 s40, s40, 16
  s_add_u32 s27, s40, s26
  s_add_u32 s27, s27, 1048576
  s_xor_b32 s37, s27, s36
  s_lshl_b32 s40, s40, 2
  s_add_u32 s28, s40, s26
  s_lshr_b32 s40, s40, 5
  s_and_b32 s40, s40, 0x4000
  s_xor_b32 s28, s28, s40
  s_xor_b32 s29, s28, 0x4000
  s_xor_b32 s40, s29, 0
  buffer_load_dword v89, v92, s[4:7], s40 offen sc1
  s_xor_b32 s40, s27, 8192
  buffer_load_dword v89, v109, s[4:7], s40 offen sc1
  s_mov_b32 s25, 2
  s_and_b32 s40, s25, 3
  s_lshl_b32 s40, s40, 16
  s_add_u32 s27, s40, s26
  s_add_u32 s27, s27, 1048576
  s_xor_b32 s37, s27, s36
  s_lshl_b32 s40, s40, 2
  s_add_u32 s28, s40, s26
  s_lshr_b32 s40, s40, 5
  s_and_b32 s40, s40, 0x4000
  s_xor_b32 s28, s28, s40
  s_xor_b32 s29, s28, 0x4000
  s_xor_b32 s40, s29, 0
  buffer_load_dword v89, v92, s[4:7], s40 offen sc1
  s_xor_b32 s40, s27, 8192
  buffer_load_dword v89, v109, s[4:7], s40 offen sc1
  s_mov_b32 s25, 3
  s_and_b32 s40, s25, 3
  s_lshl_b32 s40, s40, 16
  s_add_u32 s27, s40, s26
  s_add_u32 s27, s27, 1048576
  s_xor_b32 s37, s27, s36
  s_lshl_b32 s40, s40, 2
  s_add_u32 s28, s40, s26
  s_lshr_b32 s40, s40, 5
  s_and_b32 s40, s40, 0x4000
  s_xor_b32 s28, s28, s40
  s_xor_b32 s29, s28, 0x4000
  s_xor_b32 s40, s29, 0
  buffer_load_dword v89, v92, s[4:7], s40 offen sc1
  s_xor_b32 s40, s27, 8192
  buffer_load_dword v89, v109, s[4:7], s40 offen sc1
  buffer_load_dword v89, v90, s[4:7], 0 offen offset:2048 sc1
  s_mov_b32 s25, 0
  v_mov_b64 v[52:53], 0
  v_mov_b64 v[54:55], 0
  v_mov_b64 v[56:57], 0
  v_mov_b64 v[58:59], 0
  ds_read_b128 v[20:23], v85 offset:0
  ds_read_b128 v[24:27], v85 offset:1024
  ds_read_b128 v[28:31], v85 offset:8192
  ds_read_b128 v[32:35], v85 offset:9216
  ds_read_b128 v[36:39], v85 offset:2048
  ds_read_b128 v[40:43], v85 offset:3072
  ds_read_b128 v[44:47], v85 offset:10240
  ds_read_b128 v[48:51], v85 offset:11264
L_VO_top:
  s_and_b32 s40, s25, 3
  s_lshl_b32 s40, s40, 16
  s_add_u32 s27, s40, s26
  s_add_u32 s27, s27, 1048576
  s_xor_b32 s37, s27, s36
  s_lshl_b32 s40, s40, 2
  s_add_u32 s28, s40, s26
  s_lshr_b32 s40, s40, 5
  s_and_b32 s40, s40, 0x4000
  s_xor_b32 s28, s28, s40
  s_xor_b32 s29, s28, 0x4000
  s_sleep 4
L_VO_retry:
  buffer_load_dwordx4 v[4:7], v86, s[4:7], s37 offen offset:0 sc1
  s_nop 0
  buffer_load_dwordx4 v[8:11], v86, s[4:7], s37 offen offset:2048 sc1
  s_nop 0
  s_waitcnt vmcnt(1) lgkmcnt(0)
  buffer_load_dwordx4 v[68:71], v87, s[4:7], s27 offen offset:0 sc1
  buffer_load_dwordx4 v[72:75], v87, s[4:7], s27 offen offset:2048 sc1
  v_smfmac_f32_16x16x64_bf16 v[52:55], v[4:7], v[128:135], v88
  ds_write_b128 v1, v[4:7] offset:0
  v_max3_u32 v89, v4, v5, v6
  v_smfmac_f32_16x16x64_bf16 v[56:59], v[4:7], v[20:27], v88
  v_max3_u32 v89, v6, v7, v89
  s_waitcnt vmcnt(2)
  ds_write_b128 v1, v[8:11] offset:1024
  v_max3_u32 v89, v8, v9, v89
  v_max3_u32 v89, v10, v11, v89
  v_cmp_eq_u32_e64 vcc, -1, v89
  s_cbranch_vccnz L_VO_bad
  s_waitcnt lgkmcnt(0)
  s_barrier
  ds_read_b128 v[12:15], v2 offset:0
  ds_read_b128 v[16:19], v2 offset:1024
  v_smfmac_f32_16x16x64_bf16 v[52:55], v[8:11], v[136:143], v88
  ds_read_b128 v[4:7], v3 offset:0
  ds_read_b128 v[20:23], v85 offset:4096
  v_smfmac_f32_16x16x64_bf16 v[56:59], v[8:11], v[28:35], v88
  ds_read_b128 v[24:27], v85 offset:5120
  s_waitcnt lgkmcnt(4)
  v_smfmac_f32_16x16x64_bf16 v[52:55], v[12:15], v[144:151], v88
  ds_read_b128 v[8:11], v3 offset:1024
  ds_read_b128 v[28:31], v85 offset:12288
  v_smfmac_f32_16x16x64_bf16 v[56:59], v[12:15], v[36:43], v88
  ds_read_b128 v[32:35], v85 offset:13312
  s_waitcnt lgkmcnt(6)
  v_smfmac_f32_16x16x64_bf16 v[52:55], v[16:19], v[152:159], v88
  ds_read_b128 v[12:15], v84 offset:0
  ds_read_b128 v[36:39], v85 offset:6144
  v_smfmac_f32_16x16x64_bf16 v[56:59], v[16:19], v[44:51], v88
  ds_read_b128 v[40:43], v85 offset:7168
  s_waitcnt lgkmcnt(6)
  v_smfmac_f32_16x16x64_bf16 v[52:55], v[4:7], v[160:167], v88
  ds_read_b128 v[16:19], v84 offset:1024
  ds_read_b128 v[44:47], v85 offset:14336
  v_smfmac_f32_16x16x64_bf16 v[56:59], v[4:7], v[20:27], v88
  ds_read_b128 v[48:51], v85 offset:15360
  s_waitcnt lgkmcnt(6)
  v_smfmac_f32_16x16x64_bf16 v[52:55], v[8:11], v[168:175], v88
  ds_read_b128 v[20:23], v85 offset:16384
  v_smfmac_f32_16x16x64_bf16 v[56:59], v[8:11], v[28:35], v88
  ds_read_b128 v[24:27], v85 offset:17408
  s_waitcnt lgkmcnt(5)
  v_smfmac_f32_16x16x64_bf16 v[52:55], v[12:15], v[176:183], v88
  ds_read_b128 v[28:31], v85 offset:24576
  v_smfmac_f32_16x16x64_bf16 v[56:59], v[12:15], v[36:43], v88
  ds_read_b128 v[32:35], v85 offset:25600
  s_waitcnt lgkmcnt(4)
L_VO_rchk:
  s_waitcnt vmcnt(0)
  ds_write_b128 v1, v[68:71] offset:2048
  ds_write_b128 v1, v[72:75] offset:3072
  v_max3_u32 v89, v68, v69, v70
  v_max3_u32 v89, v70, v71, v89
  v_max3_u32 v89, v72, v73, v89
  v_max3_u32 v89, v74, v75, v89
  v_cmp_eq_u32 vcc, -1, v89
  s_cbranch_vccnz L_VO_rbad
  v_smfmac_f32_16x16x64_bf16 v[52:55], v[16:19], v[184:191], v88
  ds_read_b128 v[36:39], v85 offset:18432
  v_smfmac_f32_16x16x64_bf16 v[56:59], v[16:19], v[44:51], v88
  ds_read_b128 v[40:43], v85 offset:19456
  s_waitcnt lgkmcnt(6)
  s_waitcnt lgkmcnt(2)
  s_barrier
  v_smfmac_f32_16x16x64_bf16 v[52:55], v[68:71], v[192:199], v88
  ds_read_b128 v[12:15], v2 offset:2048
  ds_read_b128 v[16:19], v2 offset:3072
  v_smfmac_f32_16x16x64_bf16 v[56:59], v[68:71], v[20:27], v88
  ds_read_b128 v[44:47], v85 offset:26624
  ds_read_b128 v[48:51], v85 offset:27648
  v_smfmac_f32_16x16x64_bf16 v[52:55], v[72:75], v[200:207], v88
  ds_read_b128 v[4:7], v3 offset:2048
  ds_read_b128 v[20:23], v85 offset:20480
  v_smfmac_f32_16x16x64_bf16 v[56:59], v[72:75], v[28:35], v88
  ds_read_b128 v[24:27], v85 offset:21504
  s_waitcnt lgkmcnt(6)
  v_smfmac_f32_16x16x64_bf16 v[52:55], v[12:15], v[208:215], v88
  ds_read_b128 v[8:11], v3 offset:3072
  ds_read_b128 v[28:31], v85 offset:28672
  v_smfmac_f32_16x16x64_bf16 v[56:59], v[12:15], v[36:43], v88
  ds_read_b128 v[32:35], v85 offset:29696
  s_waitcnt lgkmcnt(6)
  v_smfmac_f32_16x16x64_bf16 v[52:55], v[16:19], v[216:223], v88
  ds_read_b128 v[12:15], v84 offset:2048
  ds_read_b128 v[36:39], v85 offset:22528
  v_smfmac_f32_16x16x64_bf16 v[56:59], v[16:19], v[44:51], v88
  ds_read_b128 v[40:43], v85 offset:23552
  s_waitcnt lgkmcnt(6)
  v_smfmac_f32_16x16x64_bf16 v[52:55], v[4:7], v[224:231], v88
  ds_read_b128 v[16:19], v84 offset:3072
  ds_read_b128 v[44:47], v85 offset:30720
  v_smfmac_f32_16x16x64_bf16 v[56:59], v[4:7], v[20:27], v88
  ds_read_b128 v[48:51], v85 offset:31744
  s_waitcnt lgkmcnt(6)
  v_smfmac_f32_16x16x64_bf16 v[52:55], v[8:11], v[232:239], v88
  v_smfmac_f32_16x16x64_bf16 v[56:59], v[8:11], v[28:35], v88
  s_waitcnt lgkmcnt(3)
  v_smfmac_f32_16x16x64_bf16 v[52:55], v[12:15], v[240:247], v88
  v_smfmac_f32_16x16x64_bf16 v[56:59], v[12:15], v[36:43], v88
  s_nop 0
  s_waitcnt lgkmcnt(0)
  v_smfmac_f32_16x16x64_bf16 v[52:55], v[16:19], v[248:255], v88
  v_smfmac_f32_16x16x64_bf16 v[56:59], v[16:19], v[44:51], v88
  s_nop 6
  v_pk_add_f32 v[52:53], v[52:53], v[54:55]
  v_pk_add_f32 v[56:57], v[56:57], v[58:59]
  v_cvt_pk_bf16_f32 v100, v52, v53
  v_cvt_pk_bf16_f32 v101, v56, v57
  s_cmp_eq_u32 s36, 0
  s_cbranch_scc1 Lwt_80
  buffer_store_dwordx2 v[100:101], v92, s[4:7], s29 offen
  s_branch Lwtd_81
Lwt_80:
  buffer_store_dwordx2 v[100:101], v92, s[4:7], s29 offen sc1
Lwtd_81:
  s_cmp_ge_u32 s25, 63
  s_nop 0
  s_cbranch_scc1 L_VO_end
  s_add_u32 s42, s28, s58
  s_xor_b32 s30, s42, s36
  s_xor_b32 s31, s30, 4096
  s_xor_b32 s32, s42, 131072
  s_xor_b32 s48, s32, 4096
  s_add_u32 s41, s25, 1
  v_mov_b32 v94, s41
  s_and_b32 s41, s41, 3
  s_lshl_b32 s41, s41, 16
  s_add_u32 s33, s41, s26
  s_add_u32 s33, s33, 1048576
  s_xor_b32 s49, s33, 8192
  s_xor_b32 s34, s33, 0x20000
  s_xor_b32 s35, s29, 0x84000
  buffer_store_dword v80, v109, s[4:7], s34 offen sc1
  s_xor_b32 s40, s34, 8192
  buffer_store_dword v80, v109, s[4:7], s40 offen
  s_cmp_eq_u32 s36, 0
  s_cbranch_scc1 Lwt_82
  buffer_store_dwordx2 v[80:81], v92, s[4:7], s35 offen
  s_branch Lwtd_83
Lwt_82:
  buffer_store_dwordx2 v[80:81], v92, s[4:7], s35 offen sc1
Lwtd_83:
  v_mov_b64 v[60:61], 0
  v_mov_b64 v[62:63], 0
  v_mov_b64 v[64:65], 0
  v_mov_b64 v[66:67], 0
  v_mov_b64 v[52:53], 0
  v_mov_b64 v[54:55], 0
  v_mov_b64 v[56:57], 0
  v_mov_b64 v[58:59], 0
  ds_read_b128 v[20:23], v85 offset:0
  ds_read_b128 v[24:27], v85 offset:1024
  ds_read_b128 v[28:31], v85 offset:8192
  ds_read_b128 v[32:35], v85 offset:9216
  ds_read_b128 v[36:39], v85 offset:2048
  ds_read_b128 v[40:43], v85 offset:3072
  ds_read_b128 v[44:47], v85 offset:10240
  ds_read_b128 v[48:51], v85 offset:11264
  s_cmp_eq_u32 s36, 0
  s_cbranch_scc1 Ltrigd_85
  s_mov_b64 exec, 0xffff
  s_sleep 5
  buffer_load_dword v76, v90, s[4:7], 0 offen offset:2048 sc1
  s_sleep 1
  buffer_load_dword v77, v90, s[4:7], 0 offen offset:2048 sc1
  s_sleep 1
  buffer_load_dword v78, v90, s[4:7], 0 offen offset:2048 sc1
  s_sleep 1
Ltrig_84:
  s_sub_u32 s24, s24, 1
  s_cbranch_scc1 L_FAIL
  buffer_load_dword v79, v90, s[4:7], 0 offen offset:2048 sc1
  s_waitcnt vmcnt(3)
  v_cmp_gt_i32_e64 vcc, s25, v76
  s_cbranch_vccz Ltrigd_85
  buffer_load_dword v76, v90, s[4:7], 0 offen offset:2048 sc1
  s_waitcnt vmcnt(3)
  v_cmp_gt_i32 vcc, s25, v77
  s_cbranch_vccz Ltrigd_85
  buffer_load_dword v77, v90, s[4:7], 0 offen offset:2048 sc1
  s_waitcnt vmcnt(3)
  v_cmp_gt_i32 vcc, s25, v78
  s_cbranch_vccz Ltrigd_85
  buffer_load_dword v78, v90, s[4:7], 0 offen offset:2048 sc1
  s_waitcnt vmcnt(3)
  v_cmp_gt_i32_e64 vcc, s25, v79
  s_cbranch_vccnz Ltrig_84
Ltrigd_85:
  s_mov_b64 exec, -1
L_VOO_again:
  buffer_load_dwordx4 v[4:7], v110, s[4:7], s30 offen sc1
  s_nop 0
  buffer_load_dwordx4 v[8:11], v111, s[4:7], s30 offen sc1
  s_nop 0
  buffer_load_dwordx4 v[12:15], v112, s[4:7], s30 offen sc1
  s_nop 0
  buffer_load_dwordx4 v[16:19], v113, s[4:7], s30 offen sc1
  s_nop 0
  buffer_load_dwordx4 v[68:71], v110, s[4:7], s31 offen sc1
  s_nop 0
  buffer_load_dwordx4 v[72:75], v111, s[4:7], s31 offen sc1
  s_nop 0
  s_nop 0
  s_waitcnt vmcnt(5)
  v_cmp_eq_u32_e64 vcc, -1, v4
  s_cbranch_vccnz L_VOO_g0
L_VOO_ok0:
  buffer_load_dwordx4 v[96:99], v112, s[4:7], s31 offen sc1
  v_smfmac_f32_16x16x64_bf16 v[60:63], v[4:7], a[0:7], v88
  s_waitcnt vmcnt(5)
  v_cmp_eq_u32 vcc, -1, v8
  v_smfmac_f32_16x16x64_bf16 v[64:67], v[4:7], a[8:15], v88
  s_cbranch_vccnz L_VOO_g1
L_VOO_ok1:
  buffer_load_dwordx4 v[4:7], v113, s[4:7], s31 offen sc1
  v_smfmac_f32_16x16x64_bf16 v[60:63], v[8:11], a[16:23], v88
  s_waitcnt vmcnt(5)
  v_cmp_eq_u32 vcc, -1, v12
  v_smfmac_f32_16x16x64_bf16 v[64:67], v[8:11], a[24:31], v88
  s_cbranch_vccnz L_VOO_g2
L_VOO_ok2:
  buffer_load_dwordx4 v[8:11], v110, s[4:7], s32 offen sc1
  v_smfmac_f32_16x16x64_bf16 v[60:63], v[12:15], a[32:39], v88
  s_waitcnt vmcnt(5)
  v_cmp_eq_u32 vcc, -1, v16
  v_smfmac_f32_16x16x64_bf16 v[64:67], v[12:15], a[40:47], v88
  s_cbranch_vccnz L_VOO_g3
L_VOO_ok3:
  buffer_load_dwordx4 v[12:15], v111, s[4:7], s32 offen sc1
  v_smfmac_f32_16x16x64_bf16 v[60:63], v[16:19], a[48:55], v88
  s_waitcnt vmcnt(5)
  v_cmp_eq_u32 vcc, -1, v68
  v_smfmac_f32_16x16x64_bf16 v[64:67], v[16:19], a[56:63], v88
  s_cbranch_vccnz L_VOO_g4
L_VOO_ok4:
  buffer_load_dwordx4 v[16:19], v112, s[4:7], s32 offen sc1
  v_smfmac_f32_16x16x64_bf16 v[60:63], v[68:71], a[64:71], v88
  s_waitcnt vmcnt(5)
  v_cmp_eq_u32 vcc, -1, v72
  v_smfmac_f32_16x16x64_bf16 v[64:67], v[68:71], a[72:79], v88
  s_cbranch_vccnz L_VOO_g5
L_VOO_ok5:
  buffer_load_dwordx4 v[68:71], v113, s[4:7], s32 offen sc1
  v_smfmac_f32_16x16x64_bf16 v[60:63], v[72:75], a[80:87], v88
  s_nop 0
  s_waitcnt vmcnt(5)
  v_cmp_eq_u32_e64 vcc, -1, v96
  v_smfmac_f32_16x16x64_bf16 v[64:67], v[72:75], a[88:95], v88
  s_cbranch_vccnz L_VOO_g6
L_VOO_ok6:
  buffer_load_dwordx4 v[72:75], v110, s[4:7], s48 offen sc1
  v_smfmac_f32_16x16x64_bf16 v[60:63], v[96:99], a[96:103], v88
  s_waitcnt vmcnt(5)
  v_cmp_eq_u32 vcc, -1, v4
  v_smfmac_f32_16x16x64_bf16 v[64:67], v[96:99], a[104:111], v88
  s_cbranch_vccnz L_VOO_g7
L_VOO_ok7:
  buffer_load_dwordx4 v[96:99], v111, s[4:7], s48 offen sc1
  v_smfmac_f32_16x16x64_bf16 v[60:63], v[4:7], a[112:119], v88
  s_waitcnt vmcnt(5)
  v_cmp_eq_u32 vcc, -1, v8
  v_smfmac_f32_16x16x64_bf16 v[64:67], v[4:7], a[120:127], v88
  s_cbranch_vccnz L_VOO_g8
L_VOO_ok8:
  buffer_load_dwordx4 v[4:7], v112, s[4:7], s48 offen sc1
  v_smfmac_f32_16x16x64_bf16 v[60:63], v[8:11], a[128:135], v88
  s_waitcnt vmcnt(5)
  v_cmp_eq_u32 vcc, -1, v12
  v_smfmac_f32_16x16x64_bf16 v[64:67], v[8:11], a[136:143], v88
  s_cbranch_vccnz L_VOO_g9
L_VOO_ok9:
  buffer_load_dwordx4 v[8:11], v113, s[4:7], s48 offen sc1
  v_smfmac_f32_16x16x64_bf16 v[60:63], v[12:15], a[144:151], v88
  s_waitcnt vmcnt(5)
  v_cmp_eq_u32 vcc, -1, v16
  v_smfmac_f32_16x16x64_bf16 v[64:67], v[12:15], a[152:159], v88
  s_cbranch_vccnz L_VOO_g10
L_VOO_ok10:
  v_smfmac_f32_16x16x64_bf16 v[60:63], v[16:19], a[160:167], v88
  s_waitcnt vmcnt(4)
  v_cmp_eq_u32 vcc, -1, v68
  v_smfmac_f32_16x16x64_bf16 v[64:67], v[16:19], a[168:175], v88
  s_cbranch_vccnz L_VOO_g11
L_VOO_ok11:
  v_smfmac_f32_16x16x64_bf16 v[60:63], v[68:71], a[176:183], v88
  s_waitcnt vmcnt(3)
  v_cmp_eq_u32 vcc, -1, v72
  v_smfmac_f32_16x16x64_bf16 v[64:67], v[68:71], a[184:191], v88
  s_cbranch_vccnz L_VOO_g12
L_VOO_ok12:
  v_smfmac_f32_16x16x64_bf16 v[60:63], v[72:75], a[192:199], v88
  s_waitcnt vmcnt(2)
  v_cmp_eq_u32 vcc, -1, v96
  v_smfmac_f32_16x16x64_bf16 v[64:67], v[72:75], a[200:207], v88
  s_cbranch_vccnz L_VOO_g13
L_VOO_ok13:
  v_smfmac_f32_16x16x64_bf16 v[60:63], v[96:99], a[208:215], v88
  s_waitcnt vmcnt(1)
  v_cmp_eq_u32 vcc, -1, v4
  v_smfmac_f32_16x16x64_bf16 v[64:67], v[96:99], a[216:223], v88
  s_cbranch_vccnz L_VOO_g14
L_VOO_ok14:
  v_smfmac_f32_16x16x64_bf16 v[60:63], v[4:7], a[224:231], v88
  s_waitcnt vmcnt(0)
  v_cmp_eq_u32_e64 vcc, -1, v8
  v_smfmac_f32_16x16x64_bf16 v[64:67], v[4:7], a[232:239], v88
  s_cbranch_vccnz L_VOO_g15
L_VOO_ok15:
  v_smfmac_f32_16x16x64_bf16 v[60:63], v[8:11], a[240:247], v88
  v_smfmac_f32_16x16x64_bf16 v[64:67], v[8:11], a[248:255], v88
  s_nop 6
  v_add_f32 v100, v60, v62
  v_add_f32 v102, v61, v63
  v_add_f32 v101, v64, v66
  v_add_f32 v103, v65, v67
  ds_write_b128 v95, v[100:103]
  v_cmp_u_f32 vcc, v100, v102
  s_cbranch_vccnz L_VOO_nan
L_VOO_done:
  buffer_store_dword v94, v91, s[4:7], s57 offen
  s_waitcnt lgkmcnt(0)
  s_barrier
  ds_read2st64_b64 v[100:103], v108 offset0:0 offset1:2
  ds_read2st64_b64 v[104:107], v108 offset0:4 offset1:6
  s_waitcnt lgkmcnt(1)
  v_pk_add_f32 v[100:101], v[100:101], v[102:103]
  s_waitcnt lgkmcnt(0)
  v_pk_add_f32 v[104:105], v[104:105], v[106:107]
  v_pk_add_f32 v[100:101], v[100:101], v[104:105]
  v_cvt_pk_bf16_f32 v100, v100, v101
  buffer_store_dword v100, v109, s[4:7], s49 offen
  buffer_store_dword v100, v109, s[4:7], s33 offen sc1
  s_add_u32 s25, s25, 1
  s_branch L_VO_top
L_VO_end:
  s_branch L_END
L_VO_bad:
  s_nop 7
  s_sub_u32 s24, s24, 1
  s_cbranch_scc1 L_FAIL
  s_add_u32 s60, s60, 1
  v_mov_b64 v[52:53], 0
  v_mov_b64 v[54:55], 0
  v_mov_b64 v[56:57], 0
  v_mov_b64 v[58:59], 0
  s_nop 1
  s_branch L_VO_retry
L_VO_rbad:
  s_sub_u32 s24, s24, 1
  s_cbranch_scc1 L_FAIL
  s_add_u32 s60, s60, 0x10000
  s_waitcnt lgkmcnt(0)
  buffer_load_dwordx4 v[68:71], v87, s[4:7], s27 offen offset:0 sc1
  buffer_load_dwordx4 v[72:75], v87, s[4:7], s27 offen offset:2048 sc1
  s_branch L_VO_rchk
L_VOO_nan:
  s_cmp_eq_u32 s51, s25
  s_cbranch_scc1 L_VOO_done
  s_mov_b32 s51, s25
  s_add_u32 s61, s61, 0x10000
  s_waitcnt vmcnt(0) lgkmcnt(0)
L_VOO_v0:
  s_sub_u32 s24, s24, 1
  s_cbranch_scc1 L_FAIL
  buffer_load_dwordx4 v[4:7], v110, s[4:7], s30 offen sc1
  buffer_load_dwordx4 v[8:11], v111, s[4:7], s30 offen sc1
  buffer_load_dwordx4 v[12:15], v112, s[4:7], s30 offen sc1
  buffer_load_dwordx4 v[16:19], v113, s[4:7], s30 offen sc1
  v_mov_b32 v89, 0
  s_waitcnt vmcnt(0)
  v_max3_u32 v89, v4, v5, v89
  v_max3_u32 v89, v6, v7, v89
  v_max3_u32 v89, v8, v9, v89
  v_max3_u32 v89, v10, v11, v89
  v_max3_u32 v89, v12, v13, v89
  v_max3_u32 v89, v14, v15, v89
  v_max3_u32 v89, v16, v17, v89
  v_max3_u32 v89, v18, v19, v89
  v_cmp_eq_u32 vcc, -1, v89
  s_cbranch_vccnz L_VOO_v0
L_VOO_v4:
  s_sub_u32 s24, s24, 1
  s_cbranch_scc1 L_FAIL
  buffer_load_dwordx4 v[68:71], v110, s[4:7], s31 offen sc1
  buffer_load_dwordx4 v[72:75], v111, s[4:7], s31 offen sc1
  buffer_load_dwordx4 v[96:99], v112, s[4:7], s31 offen sc1
  buffer_load_dwordx4 v[4:7], v113, s[4:7], s31 offen sc1
  v_mov_b32 v89, 0
  s_waitcnt vmcnt(0)
  v_max3_u32 v89, v68, v69, v89
  v_max3_u32 v89, v70, v71, v89
  v_max3_u32 v89, v72, v73, v89
  v_max3_u32 v89, v74, v75, v89
  v_max3_u32 v89, v96, v97, v89
  v_max3_u32 v89, v98, v99, v89
  v_max3_u32 v89, v4, v5, v89
  v_max3_u32 v89, v6, v7, v89
  v_cmp_eq_u32 vcc, -1, v89
  s_cbranch_vccnz L_VOO_v4
L_VOO_v8:
  s_sub_u32 s24, s24, 1
  s_cbranch_scc1 L_FAIL
  buffer_load_dwordx4 v[8:11], v110, s[4:7], s32 offen sc1
  buffer_load_dwordx4 v[12:15], v111, s[4:7], s32 offen sc1
  buffer_load_dwordx4 v[16:19], v112, s[4:7], s32 offen sc1
  buffer_load_dwordx4 v[68:71], v113, s[4:7], s32 offen sc1
  v_mov_b32 v89, 0
  s_waitcnt vmcnt(0)
  v_max3_u32 v89, v8, v9, v89
  v_max3_u32 v89, v10, v11, v89
  v_max3_u32 v89, v12, v13, v89
  v_max3_u32 v89, v14, v15, v89
  v_max3_u32 v89, v16, v17, v89
  v_max3_u32 v89, v18, v19, v89
  v_max3_u32 v89, v68, v69, v89
  v_max3_u32 v89, v70, v71, v89
  v_cmp_eq_u32 vcc, -1, v89
  s_cbranch_vccnz L_VOO_v8
L_VOO_v12:
  s_sub_u32 s24, s24, 1
  s_cbranch_scc1 L_FAIL
  buffer_load_dwordx4 v[72:75], v110, s[4:7], s48 offen sc1
  buffer_load_dwordx4 v[96:99], v111, s[4:7], s48 offen sc1
  buffer_load_dwordx4 v[4:7], v112, s[4:7], s48 offen sc1
  buffer_load_dwordx4 v[8:11], v113, s[4:7], s48 offen sc1
  v_mov_b32 v89, 0
  s_waitcnt vmcnt(0)
  v_max3_u32 v89, v72, v73, v89
  v_max3_u32 v89, v74, v75, v89
  v_max3_u32 v89, v96, v97, v89
  v_max3_u32 v89, v98, v99, v89
  v_max3_u32 v89, v4, v5, v89
  v_max3_u32 v89, v6, v7, v89
  v_max3_u32 v89, v8, v9, v89
  v_max3_u32 v89, v10, v11, v89
  v_cmp_eq_u32 vcc, -1, v89
  s_cbranch_vccnz L_VOO_v12
  v_mov_b64 v[60:61], 0
  v_mov_b64 v[62:63], 0
  v_mov_b64 v[64:65], 0
  v_mov_b64 v[66:67], 0
  s_nop 1
  s_branch L_VOO_again
L_VOO_g0:
  s_sub_u32 s24, s24, 1
  s_cbranch_scc1 L_FAIL
  s_add_u32 s61, s61, 1
  buffer_load_dwordx4 v[4:7], v110, s[4:7], s30 offen sc1
  s_waitcnt vmcnt(0)
  v_cmp_eq_u32 vcc, -1, v4
  s_cbranch_vccnz L_VOO_g0
  v_mov_b32 v89, 0
  v_max3_u32 v89, v8, v12, v89
  v_max3_u32 v89, v16, v68, v89
  v_max3_u32 v89, v72, v72, v89
  v_cmp_eq_u32 vcc, -1, v89
  s_cbranch_vccz L_VOO_ok0
  buffer_load_dwordx4 v[8:11], v111, s[4:7], s30 offen sc1
  s_nop 0
  buffer_load_dwordx4 v[12:15], v112, s[4:7], s30 offen sc1
  s_nop 0
  buffer_load_dwordx4 v[16:19], v113, s[4:7], s30 offen sc1
  s_nop 0
  buffer_load_dwordx4 v[68:71], v110, s[4:7], s31 offen sc1
  s_nop 0
  buffer_load_dwordx4 v[72:75], v111, s[4:7], s31 offen sc1
  s_nop 0
  s_branch L_VOO_ok0
L_VOO_g1:
  s_sub_u32 s24, s24, 1
  s_cbranch_scc1 L_FAIL
  s_add_u32 s61, s61, 1
  buffer_load_dwordx4 v[8:11], v111, s[4:7], s30 offen sc1
  s_waitcnt vmcnt(0)
  v_cmp_eq_u32 vcc, -1, v8
  s_cbranch_vccnz L_VOO_g1
  v_mov_b32 v89, 0
  v_max3_u32 v89, v12, v16, v89
  v_max3_u32 v89, v68, v72, v89
  v_max3_u32 v89, v96, v96, v89
  v_cmp_eq_u32 vcc, -1, v89
  s_cbranch_vccz L_VOO_ok1
  buffer_load_dwordx4 v[12:15], v112, s[4:7], s30 offen sc1
  s_nop 0
  buffer_load_dwordx4 v[16:19], v113, s[4:7], s30 offen sc1
  s_nop 0
  buffer_load_dwordx4 v[68:71], v110, s[4:7], s31 offen sc1
  s_nop 0
  buffer_load_dwordx4 v[72:75], v111, s[4:7], s31 offen sc1
  s_nop 0
  buffer_load_dwordx4 v[96:99], v112, s[4:7], s31 offen sc1
  s_nop 0
  s_branch L_VOO_ok1
L_VOO_g2:
  s_sub_u32 s24, s24, 1
  s_cbranch_scc1 L_FAIL
  s_add_u32 s61, s61, 1
  buffer_load_dwordx4 v[12:15], v112, s[4:7], s30 offen sc1
  s_waitcnt vmcnt(0)
  v_cmp_eq_u32 vcc, -1, v12
  s_cbranch_vccnz L_VOO_g2
  v_mov_b32 v89, 0
  v_max3_u32 v89, v16, v68, v89
  v_max3_u32 v89, v72, v96, v89
  v_max3_u32 v89, v4, v4, v89
  v_cmp_eq_u32 vcc, -1, v89
  s_cbranch_vccz L_VOO_ok2
  buffer_load_dwordx4 v[16:19], v113, s[4:7], s30 offen sc1
  s_nop 0
  buffer_load_dwordx4 v[68:71], v110, s[4:7], s31 offen sc1
  s_nop 0
  buffer_load_dwordx4 v[72:75], v111, s[4:7], s31 offen sc1
  s_nop 0
  buffer_load_dwordx4 v[96:99], v112, s[4:7], s31 offen sc1
  s_nop 0
  buffer_load_dwordx4 v[4:7], v113, s[4:7], s31 offen sc1
  s_nop 0
  s_branch L_VOO_ok2
L_VOO_g3:
  s_sub_u32 s24, s24, 1
  s_cbranch_scc1 L_FAIL
  s_add_u32 s61, s61, 1
  buffer_load_dwordx4 v[16:19], v113, s[4:7], s30 offen sc1
  s_waitcnt vmcnt(0)
  v_cmp_eq_u32 vcc, -1, v16
  s_cbranch_vccnz L_VOO_g3
  v_mov_b32 v89, 0
  v_max3_u32 v89, v68, v72, v89
  v_max3_u32 v89, v96, v4, v89
  v_max3_u32 v89, v8, v8, v89
  v_cmp_eq_u32 vcc, -1, v89
  s_cbranch_vccz L_VOO_ok3
  buffer_load_dwordx4 v[68:71], v110, s[4:7], s31 offen sc1
  s_nop 0
  buffer_load_dwordx4 v[72:75], v111, s[4:7], s31 offen sc1
  s_nop 0
  buffer_load_dwordx4 v[96:99], v112, s[4:7], s31 offen sc1
  s_nop 0
  buffer_load_dwordx4 v[4:7], v113, s[4:7], s31 offen sc1
  s_nop 0
  buffer_load_dwordx4 v[8:11], v110, s[4:7], s32 offen sc1
  s_nop 0
  s_branch L_VOO_ok3
L_VOO_g4:
  s_sub_u32 s24, s24, 1
  s_cbranch_scc1 L_FAIL
  s_add_u32 s61, s61, 1
  buffer_load_dwordx4 v[68:71], v110, s[4:7], s31 offen sc1
  s_waitcnt vmcnt(0)
  v_cmp_eq_u32 vcc, -1, v68
  s_cbranch_vccnz L_VOO_g4
  v_mov_b32 v89, 0
  v_max3_u32 v89, v72, v96, v89
  v_max3_u32 v89, v4, v8, v89
  v_max3_u32 v89, v12, v12, v89
  v_cmp_eq_u32 vcc, -1, v89
  s_cbranch_vccz L_VOO_ok4
  buffer_load_dwordx4 v[72:75], v111, s[4:7], s31 offen sc1
  s_nop 0
  buffer_load_dwordx4 v[96:99], v112, s[4:7], s31 offen sc1
  s_nop 0
  buffer_load_dwordx4 v[4:7], v113, s[4:7], s31 offen sc1
  s_nop 0
  buffer_load_dwordx4 v[8:11], v110, s[4:7], s32 offen sc1
  s_nop 0
  buffer_load_dwordx4 v[12:15], v111, s[4:7], s32 offen sc1
  s_nop 0
  s_branch L_VOO_ok4
L_VOO_g5:
  s_sub_u32 s24, s24, 1
  s_cbranch_scc1 L_FAIL
  s_add_u32 s61, s61, 1
  buffer_load_dwordx4 v[72:75], v111, s[4:7], s31 offen sc1
  s_waitcnt vmcnt(0)
  v_cmp_eq_u32 vcc, -1, v72
  s_cbranch_vccnz L_VOO_g5
  v_mov_b32 v89, 0
  v_max3_u32 v89, v96, v4, v89
  v_max3_u32 v89, v8, v12, v89
  v_max3_u32 v89, v16, v16, v89
  v_cmp_eq_u32 vcc, -1, v89
  s_cbranch_vccz L_VOO_ok5
  buffer_load_dwordx4 v[96:99], v112, s[4:7], s31 offen sc1
  s_nop 0
  buffer_load_dwordx4 v[4:7], v113, s[4:7], s31 offen sc1
  s_nop 0
  buffer_load_dwordx4 v[8:11], v110, s[4:7], s32 offen sc1
  s_nop 0
  buffer_load_dwordx4 v[12:15], v111, s[4:7], s32 offen sc1
  s_nop 0
  buffer_load_dwordx4 v[16:19], v112, s[4:7], s32 offen sc1
  s_nop 0
  s_branch L_VOO_ok5
L_VOO_g6:
  s_sub_u32 s24, s24, 1
  s_cbranch_scc1 L_FAIL
  s_add_u32 s61, s61, 1
  buffer_load_dwordx4 v[96:99], v112, s[4:7], s31 offen sc1
  s_waitcnt vmcnt(0)
  v_cmp_eq_u32 vcc, -1, v96
  s_cbranch_vccnz L_VOO_g6
  v_mov_b32 v89, 0
  v_max3_u32 v89, v4, v8, v89
  v_max3_u32 v89, v12, v16, v89
  v_max3_u32 v89, v68, v68, v89
  v_cmp_eq_u32 vcc, -1, v89
  s_cbranch_vccz L_VOO_ok6
  buffer_load_dwordx4 v[4:7], v113, s[4:7], s31 offen sc1
  s_nop 0
  buffer_load_dwordx4 v[8:11], v110, s[4:7], s32 offen sc1
  s_nop 0
  buffer_load_dwordx4 v[12:15], v111, s[4:7], s32 offen sc1
  s_nop 0
  buffer_load_dwordx4 v[16:19], v112, s[4:7], s32 offen sc1
  s_nop 0
  buffer_load_dwordx4 v[68:71], v113, s[4:7], s32 offen sc1
  s_nop 0
  s_branch L_VOO_ok6
L_VOO_g7:
  s_sub_u32 s24, s24, 1
  s_cbranch_scc1 L_FAIL
  s_add_u32 s61, s61, 1
  buffer_load_dwordx4 v[4:7], v113, s[4:7], s31 offen sc1
  s_waitcnt vmcnt(0)
  v_cmp_eq_u32 vcc, -1, v4
  s_cbranch_vccnz L_VOO_g7
  v_mov_b32 v89, 0
  v_max3_u32 v89, v8, v12, v89
  v_max3_u32 v89, v16, v68, v89
  v_max3_u32 v89, v72, v72, v89
  v_cmp_eq_u32 vcc, -1, v89
  s_cbranch_vccz L_VOO_ok7
  buffer_load_dwordx4 v[8:11], v110, s[4:7], s32 offen sc1
  s_nop 0
  buffer_load_dwordx4 v[12:15], v111, s[4:7], s32 offen sc1
  s_nop 0
  buffer_load_dwordx4 v[16:19], v112, s[4:7], s32 offen sc1
  s_nop 0
  buffer_load_dwordx4 v[68:71], v113, s[4:7], s32 offen sc1
  s_nop 0
  buffer_load_dwordx4 v[72:75], v110, s[4:7], s48 offen sc1
  s_nop 0
  s_branch L_VOO_ok7
L_VOO_g8:
  s_sub_u32 s24, s24, 1
  s_cbranch_scc1 L_FAIL
  s_add_u32 s61, s61, 256
  buffer_load_dwordx4 v[8:11], v110, s[4:7], s32 offen sc1
  s_waitcnt vmcnt(0)
  v_cmp_eq_u32 vcc, -1, v8
  s_cbranch_vccnz L_VOO_g8
  v_mov_b32 v89, 0
  v_max3_u32 v89, v12, v16, v89
  v_max3_u32 v89, v68, v72, v89
  v_max3_u32 v89, v96, v96, v89
  v_cmp_eq_u32 vcc, -1, v89
  s_cbranch_vccz L_VOO_ok8
  buffer_load_dwordx4 v[12:15], v111, s[4:7], s32 offen sc1
  s_nop 0
  buffer_load_dwordx4 v[16:19], v112, s[4:7], s32 offen sc1
  s_nop 0
  buffer_load_dwordx4 v[68:71], v113, s[4:7], s32 offen sc1
  s_nop 0
  buffer_load_dwordx4 v[72:75], v110, s[4:7], s48 offen sc1
  s_nop 0
  buffer_load_dwordx4 v[96:99], v111, s[4:7], s48 offen sc1
  s_nop 0
  s_branch L_VOO_ok8
L_VOO_g9:
  s_sub_u32 s24, s24, 1
  s_cbranch_scc1 L_FAIL
  s_add_u32 s61, s61, 256
  buffer_load_dwordx4 v[12:15], v111, s[4:7], s32 offen sc1
  s_waitcnt vmcnt(0)
  v_cmp_eq_u32 vcc, -1, v12
  s_cbranch_vccnz L_VOO_g9
  v_mov_b32 v89, 0
  v_max3_u32 v89, v16, v68, v89
  v_max3_u32 v89, v72, v96, v89
  v_max3_u32 v89, v4, v4, v89
  v_cmp_eq_u32 vcc, -1, v89
  s_cbranch_vccz L_VOO_ok9
  buffer_load_dwordx4 v[16:19], v112, s[4:7], s32 offen sc1
  s_nop 0
  buffer_load_dwordx4 v[68:71], v113, s[4:7], s32 offen sc1
  s_nop 0
  buffer_load_dwordx4 v[72:75], v110, s[4:7], s48 offen sc1
  s_nop 0
  buffer_load_dwordx4 v[96:99], v111, s[4:7], s48 offen sc1
  s_nop 0
  buffer_load_dwordx4 v[4:7], v112, s[4:7], s48 offen sc1
  s_nop 0
  s_branch L_VOO_ok9
L_VOO_g10:
  s_sub_u32 s24, s24, 1
  s_cbranch_scc1 L_FAIL
  s_add_u32 s61, s61, 256
  buffer_load_dwordx4 v[16:19], v112, s[4:7], s32 offen sc1
  s_waitcnt vmcnt(0)
  v_cmp_eq_u32 vcc, -1, v16
  s_cbranch_vccnz L_VOO_g10
  v_mov_b32 v89, 0
  v_max3_u32 v89, v68, v72, v89
  v_max3_u32 v89, v96, v4, v89
  v_max3_u32 v89, v8, v8, v89
  v_cmp_eq_u32 vcc, -1, v89
  s_cbranch_vccz L_VOO_ok10
  buffer_load_dwordx4 v[68:71], v113, s[4:7], s32 offen sc1
  s_nop 0
  buffer_load_dwordx4 v[72:75], v110, s[4:7], s48 offen sc1
  s_nop 0
  buffer_load_dwordx4 v[96:99], v111, s[4:7], s48 offen sc1
  s_nop 0
  buffer_load_dwordx4 v[4:7], v112, s[4:7], s48 offen sc1
  s_nop 0
  buffer_load_dwordx4 v[8:11], v113, s[4:7], s48 offen sc1
  s_nop 0
  s_branch L_VOO_ok10
L_VOO_g11:
  s_sub_u32 s24, s24, 1
  s_cbranch_scc1 L_FAIL
  s_add_u32 s61, s61, 256
  buffer_load_dwordx4 v[68:71], v113, s[4:7], s32 offen sc1
  s_waitcnt vmcnt(0)
  v_cmp_eq_u32 vcc, -1, v68
  s_cbranch_vccnz L_VOO_g11
  v_mov_b32 v89, 0
  v_max3_u32 v89, v72, v96, v89
  v_max3_u32 v89, v4, v8, v89
  v_cmp_eq_u32 vcc, -1, v89
  s_cbranch_vccz L_VOO_ok11
  buffer_load_dwordx4 v[72:75], v110, s[4:7], s48 offen sc1
  s_nop 0
  buffer_load_dwordx4 v[96:99], v111, s[4:7], s48 offen sc1
  s_nop 0
  buffer_load_dwordx4 v[4:7], v112, s[4:7], s48 offen sc1
  s_nop 0
  buffer_load_dwordx4 v[8:11], v113, s[4:7], s48 offen sc1
  s_nop 0
  s_branch L_VOO_ok11
L_VOO_g12:
  s_sub_u32 s24, s24, 1
  s_cbranch_scc1 L_FAIL
  s_add_u32 s61, s61, 256
  buffer_load_dwordx4 v[72:75], v110, s[4:7], s48 offen sc1
  s_waitcnt vmcnt(0)
  v_cmp_eq_u32 vcc, -1, v72
  s_cbranch_vccnz L_VOO_g12
  v_mov_b32 v89, 0
  v_max3_u32 v89, v96, v4, v89
  v_max3_u32 v89, v8, v8, v89
  v_cmp_eq_u32 vcc, -1, v89
  s_cbranch_vccz L_VOO_ok12
  buffer_load_dwordx4 v[96:99], v111, s[4:7], s48 offen sc1
  s_nop 0
  buffer_load_dwordx4 v[4:7], v112, s[4:7], s48 offen sc1
  s_nop 0
  buffer_load_dwordx4 v[8:11], v113, s[4:7], s48 offen sc1
  s_nop 0
  s_branch L_VOO_ok12
L_VOO_g13:
  s_sub_u32 s24, s24, 1
  s_cbranch_scc1 L_FAIL
  s_add_u32 s61, s61, 256
  buffer_load_dwordx4 v[96:99], v111, s[4:7], s48 offen sc1
  s_waitcnt vmcnt(0)
  v_cmp_eq_u32 vcc, -1, v96
  s_cbranch_vccnz L_VOO_g13
  v_mov_b32 v89, 0
  v_max3_u32 v89, v4, v8, v89
  v_cmp_eq_u32 vcc, -1, v89
  s_cbranch_vccz L_VOO_ok13
  buffer_load_dwordx4 v[4:7], v112, s[4:7], s48 offen sc1
  s_nop 0
  buffer_load_dwordx4 v[8:11], v113, s[4:7], s48 offen sc1
  s_nop 0
  s_branch L_VOO_ok13
L_VOO_g14:
  s_sub_u32 s24, s24, 1
  s_cbranch_scc1 L_FAIL
  s_add_u32 s61, s61, 256
  buffer_load_dwordx4 v[4:7], v112, s[4:7], s48 offen sc1
  s_waitcnt vmcnt(0)
  v_cmp_eq_u32 vcc, -1, v4
  s_cbranch_vccnz L_VOO_g14
  v_mov_b32 v89, 0
  v_max3_u32 v89, v8, v8, v89
  v_cmp_eq_u32 vcc, -1, v89
  s_cbranch_vccz L_VOO_ok14
  buffer_load_dwordx4 v[8:11], v113, s[4:7], s48 offen sc1
  s_nop 0
  s_branch L_VOO_ok14
L_VOO_g15:
  s_sub_u32 s24, s24, 1
  s_cbranch_scc1 L_FAIL
  s_add_u32 s61, s61, 256
  buffer_load_dwordx4 v[8:11], v113, s[4:7], s48 offen sc1
  s_waitcnt vmcnt(0)
  v_cmp_eq_u32 vcc, -1, v8
  s_cbranch_vccnz L_VOO_g15
  s_branch L_VOO_ok15
L_LAST:
  s_endpgm
.section .rodata,"a"
.p2align 6
.amdhsa_kernel adaLN_cond__memory_aug_recurrent_mem_tr__glu_gated_swiglu__prompt_kernel
  .amdhsa_next_free_vgpr 512
  .amdhsa_next_free_sgpr 102
  .amdhsa_accum_offset 256
  .amdhsa_group_segment_fixed_size 0
  .amdhsa_kernarg_size 128
  .amdhsa_user_sgpr_count 2
  .amdhsa_user_sgpr_kernarg_segment_ptr 1
  .amdhsa_system_sgpr_workgroup_id_x 1
  .amdhsa_float_denorm_mode_32 3
.end_amdhsa_kernel
```

```asm
; @launch grid=(256,1,1) block=(256,1,1) lds=163840
.amdgcn_target "amdgcn-amd-amdhsa--gfx950"
.text
.globl adaLN_cond__memory_aug_recurrent_mem_tr__glu_gated_swiglu__prompt_kernel
.p2align 8
.type adaLN_cond__memory_aug_recurrent_mem_tr__glu_gated_swiglu__prompt_kernel,@function
adaLN_cond__memory_aug_recurrent_mem_tr__glu_gated_swiglu__prompt_kernel:
  s_cmp_ge_u32 s2, 256
  s_cbranch_scc1 L_END
  s_load_dwordx2 s[4:5], s[0:1], 120
  s_load_dwordx2 s[12:13], s[0:1], 112
  v_lshrrev_b32 v1, 6, v0
  v_and_b32 v0, 63, v0
  v_readfirstlane_b32 s20, v1
  s_mov_b32 s6, 155222016
  s_mov_b32 s7, 0x20000
  s_mov_b32 s14, 256
  s_mov_b32 s15, 0x20000
  s_mov_b32 s24, 300000
  s_and_b32 s40, s2, 7
  s_mov_b32 s42, 0x3020100
  s_mov_b32 s43, 0x3020100
  s_cmp_eq_u32 s40, 1
  s_cselect_b32 s42, 0x1b161514, s42
  s_cselect_b32 s43, 0x1b1a1918, s43
  s_cmp_eq_u32 s40, 2
  s_cselect_b32 s42, 0xb0a0908, s42
  s_cselect_b32 s43, 0xb0a0908, s43
  s_cmp_eq_u32 s40, 3
  s_cselect_b32 s42, 0x1f1e1d1c, s42
  s_cselect_b32 s43, 0x1f1e1d1c, s43
  s_cmp_eq_u32 s40, 4
  s_cselect_b32 s42, 0x7060504, s42
  s_cselect_b32 s43, 0x7060504, s43
  s_cmp_eq_u32 s40, 5
  s_cselect_b32 s42, 0x13121110, s42
  s_cselect_b32 s43, 0x13121110, s43
  s_cmp_eq_u32 s40, 6
  s_cselect_b32 s42, 0xf0e0d0c, s42
  s_cselect_b32 s43, 0xf0e0d0c, s43
  s_cmp_eq_u32 s40, 7
  s_cselect_b32 s42, 0x1a191817, s42
  s_cselect_b32 s43, 0x17161514, s43
  s_lshr_b32 s40, s2, 6
  s_lshl_b32 s40, s40, 3
  s_lshr_b32 s42, s42, s40
  s_lshr_b32 s43, s43, s40
  s_bfe_u32 s41, s2, 0x30003
  s_and_b32 s42, s42, 31
  s_lshl_b32 s42, s42, 3
  s_add_u32 s3, s42, s41
  s_bfe_u32 s22, s43, 0x30002
  s_and_b32 s43, s43, 3
  s_lshl_b32 s43, s43, 3
  s_add_u32 s23, s43, s41
  s_waitcnt lgkmcnt(0)
  s_add_u32 s4, s4, 0x1fffff
  s_addc_u32 s5, s5, 0
  s_and_b32 s4, s4, 0xffe00000
  s_cmp_lg_u32 s20, 3
  s_cbranch_scc1 L_NOPRE
  s_getpc_b64 s[40:41]
L_PC:
  s_lshr_b32 s42, s2, 3
  v_lshlrev_b32 v1, 12, v0
  s_lshl_b32 s42, s42, 7
  v_add_u32 v1, s42, v1
  v_min_u32 v1, L_LAST-L_PC, v1
  global_load_dword v255, v1, s[40:41]
L_NOPRE:
  s_cmp_ge_u32 s22, 4
  s_cbranch_scc1 L_TRAIL
  s_lshr_b32 s40, s22, 1
  s_bitcmp1_b32 s22, 0
  s_cbranch_scc0 L_REC
  s_lshl_b32 s40, s40, 5
  s_add_u32 s21, s40, s23
  s_branch L_QKV
L_REC:
  s_lshl_b32 s40, s40, 4
  s_lshr_b32 s41, s23, 1
  s_add_u32 s21, s40, s41
  s_bitcmp1_b32 s23, 0
  s_cbranch_scc1 L_VO
  s_branch L_QK
L_TRAIL:
  s_mov_b32 s21, s23
  s_cmp_eq_u32 s22, 6
  s_cbranch_scc1 L_MOD
  s_sub_u32 s40, s22, 4
  s_lshl_b32 s40, s40, 5
  s_add_u32 s21, s40, s23
  s_cmp_lg_u32 s22, 7
  s_cbranch_scc1 L_WOF
L_INIT:
  s_lshl_b32 s40, s23, 2
  s_add_u32 s40, s40, s20
  s_lshl_b32 s40, s40, 12
  s_add_u32 s41, s40, 1048576
  s_add_u32 s42, s40, 0x80000
  v_lshlrev_b32 v1, 4, v0
  v_mov_b32 v4, -1
  v_mov_b32 v5, -1
  v_mov_b32 v6, -1
  v_mov_b32 v7, -1
  s_cmp_lt_u32 s23, 4
  s_cselect_b32 s41, 2147483392, s41
  buffer_store_dwordx4 v[4:7], v1, s[4:7], s41 offen offset:0 sc1
  buffer_store_dwordx4 v[4:7], v1, s[4:7], s41 offen offset:1024 sc1
  buffer_store_dwordx4 v[4:7], v1, s[4:7], s41 offen offset:2048 sc1
  buffer_store_dwordx4 v[4:7], v1, s[4:7], s41 offen offset:3072 sc1
  buffer_store_dwordx4 v[4:7], v1, s[4:7], s40 offen offset:0 sc1
  buffer_store_dwordx4 v[4:7], v1, s[4:7], s40 offen offset:1024 sc1
  buffer_store_dwordx4 v[4:7], v1, s[4:7], s40 offen offset:2048 sc1
  buffer_store_dwordx4 v[4:7], v1, s[4:7], s40 offen offset:3072 sc1
  buffer_store_dwordx4 v[4:7], v1, s[4:7], s42 offen offset:0 sc1
  buffer_store_dwordx4 v[4:7], v1, s[4:7], s42 offen offset:1024 sc1
  buffer_store_dwordx4 v[4:7], v1, s[4:7], s42 offen offset:2048 sc1
  buffer_store_dwordx4 v[4:7], v1, s[4:7], s42 offen offset:3072 sc1
  s_load_dwordx2 s[16:17], s[0:1], 8
  s_mov_b32 s18, 16384
  s_mov_b32 s19, 0x20000
  s_waitcnt lgkmcnt(0)
  s_and_b32 s40, s20, 1
  s_lshl_b32 s40, s40, 3
  v_bfe_u32 v8, v0, 2, 3
  v_add_u32 v8, s40, v8
  s_lshr_b32 s40, s20, 1
  s_lshl_b32 s40, s40, 3
  v_and_b32 v9, 3, v0
  v_add_u32 v9, s40, v9
  v_bfe_u32 v10, v8, 1, 1
  v_lshl_add_u32 v9, v10, 2, v9
  v_lshrrev_b32 v10, 2, v8
  v_and_b32 v11, 1, v8
  v_lshl_add_u32 v10, v10, 1, v11
  s_lshl_b32 s40, s23, 6
  v_lshl_add_u32 v10, v10, 11, s40
  v_lshl_add_u32 v10, v9, 1, v10
  buffer_load_ushort v11, v10, s[16:19], 0 offen
  buffer_load_ushort v12, v10, s[16:19], 0 offen offset:32
  s_bfe_u32 s41, s23, 0x10002
  s_mul_i32 s41, s41, 32768
  s_lshr_b32 s40, s23, 3
  s_lshl_b32 s40, s40, 11
  s_add_u32 s40, s40, s41
  s_and_b32 s41, s23, 3
  s_lshl_b32 s41, s41, 9
  s_add_u32 s40, s40, s41
  s_lshl_b32 s41, s20, 7
  s_add_u32 s40, s40, s41
  s_add_u32 s40, s40, 1048576
  s_add_u32 s41, s40, 0x4000
  v_and_b32 v8, 31, v0
  v_lshlrev_b32 v8, 2, v8
  v_lshrrev_b32 v9, 5, v0
  v_lshl_add_u32 v8, v9, 13, v8
  s_waitcnt vmcnt(0)
  v_lshl_or_b32 v11, v12, 16, v11
  v_min_u32 v11, -2, v11
  buffer_store_dword v11, v8, s[4:7], s40 offen sc1
  buffer_store_dword v11, v8, s[4:7], s41 offen sc1
  s_lshl_b32 s40, s23, 2
  s_add_u32 s40, s40, 128
  s_cmp_eq_u32 s20, 0
  s_cselect_b32 s40, s40, 2147483392
  v_mov_b32 v2, 2147483392
  s_mov_b64 exec, 1
  v_mov_b32 v2, s40
  s_mov_b64 exec, -1
  v_mov_b32 v3, 1
  s_waitcnt vmcnt(0)
  s_barrier
  buffer_store_dword v3, v2, s[12:15], 0 offen sc1
  s_branch L_LN1
L_MOD:
  s_load_dwordx2 s[16:17], s[0:1], 88
  s_mov_b32 s18, 2048
  s_mov_b32 s19, 0x20000
  s_waitcnt lgkmcnt(0)
  s_load_dwordx2 s[8:9], s[0:1], 96
  s_mov_b32 s10, 12582912
  s_mov_b32 s11, 0x20000
  s_waitcnt lgkmcnt(0)
  s_lshl_b32 s40, s20, 9
  v_lshl_add_u32 v1, v0, 3, s40
  buffer_load_dwordx2 v[8:9], v1, s[16:19], 0 offen
  v_bfe_u32 v2, v0, 5, 1
  v_mul_u32_u24 v2, 98304, v2
  v_bfe_u32 v3, v0, 4, 1
  v_mul_u32_u24 v3, 24576, v3
  v_add_u32 v2, v2, v3
  v_bfe_u32 v3, v0, 3, 1
  v_mul_u32_u24 v3, 12288, v3
  v_add_u32 v2, v2, v3
  v_lshrrev_b32 v3, 3, v0
  v_and_b32 v3, 6, v3
  v_xor_b32 v3, v3, v0
  v_and_b32 v3, 7, v3
  v_lshl_add_u32 v2, v3, 4, v2
  s_lshr_b32 s40, s20, 1
  s_mul_i32 s40, s40, 49152
  s_and_b32 s41, s20, 1
  s_mul_i32 s41, s41, 196608
  s_add_u32 s40, s40, s41
  s_lshl_b32 s41, s21, 7
  s_add_u32 s40, s40, s41
  v_add_u32 v2, s40, v2
  s_lshl_b32 s41, s20, 10
  s_add_u32 m0, s41, 0
  s_mov_b32 s42, 0
  buffer_load_dwordx4 v2, s[8:11], s42 offen nt lds
  s_add_u32 m0, s41, 4096
  s_mov_b32 s42, 393216
  buffer_load_dwordx4 v2, s[8:11], s42 offen nt lds
  s_add_u32 m0, s41, 8192
  s_mov_b32 s42, 786432
  buffer_load_dwordx4 v2, s[8:11], s42 offen nt lds
  s_add_u32 m0, s41, 12288
  s_mov_b32 s42, 1179648
  buffer_load_dwordx4 v2, s[8:11], s42 offen nt lds
  s_add_u32 m0, s41, 16384
  s_mov_b32 s42, 1572864
  buffer_load_dwordx4 v2, s[8:11], s42 offen nt lds
  s_add_u32 m0, s41, 20480
  s_mov_b32 s42, 1966080
  buffer_load_dwordx4 v2, s[8:11], s42 offen nt lds
  s_add_u32 m0, s41, 24576
  s_mov_b32 s42, 2359296
  buffer_load_dwordx4 v2, s[8:11], s42 offen nt lds
  s_add_u32 m0, s41, 28672
  s_mov_b32 s42, 2752512
  buffer_load_dwordx4 v2, s[8:11], s42 offen nt lds
  s_add_u32 m0, s41, 32768
  s_mov_b32 s42, 3145728
  buffer_load_dwordx4 v2, s[8:11], s42 offen nt lds
  s_add_u32 m0, s41, 36864
  s_mov_b32 s42, 3538944
  buffer_load_dwordx4 v2, s[8:11], s42 offen nt lds
  s_add_u32 m0, s41, 40960
  s_mov_b32 s42, 3932160
  buffer_load_dwordx4 v2, s[8:11], s42 offen nt lds
  s_add_u32 m0, s41, 45056
  s_mov_b32 s42, 4325376
  buffer_load_dwordx4 v2, s[8:11], s42 offen nt lds
  s_add_u32 m0, s41, 49152
  s_mov_b32 s42, 4718592
  buffer_load_dwordx4 v2, s[8:11], s42 offen nt lds
  s_add_u32 m0, s41, 53248
  s_mov_b32 s42, 5111808
  buffer_load_dwordx4 v2, s[8:11], s42 offen nt lds
  s_add_u32 m0, s41, 57344
  s_mov_b32 s42, 5505024
  buffer_load_dwordx4 v2, s[8:11], s42 offen nt lds
  s_add_u32 m0, s41, 61440
  s_mov_b32 s42, 5898240
  buffer_load_dwordx4 v2, s[8:11], s42 offen nt lds
  s_add_u32 m0, s41, 65536
  s_mov_b32 s42, 6291456
  buffer_load_dwordx4 v2, s[8:11], s42 offen nt lds
  s_add_u32 m0, s41, 69632
  s_mov_b32 s42, 6684672
  buffer_load_dwordx4 v2, s[8:11], s42 offen nt lds
  s_add_u32 m0, s41, 73728
  s_mov_b32 s42, 7077888
  buffer_load_dwordx4 v2, s[8:11], s42 offen nt lds
  s_add_u32 m0, s41, 77824
  s_mov_b32 s42, 7471104
  buffer_load_dwordx4 v2, s[8:11], s42 offen nt lds
  s_add_u32 m0, s41, 81920
  s_mov_b32 s42, 7864320
  buffer_load_dwordx4 v2, s[8:11], s42 offen nt lds
  s_add_u32 m0, s41, 86016
  s_mov_b32 s42, 8257536
  buffer_load_dwordx4 v2, s[8:11], s42 offen nt lds
  s_add_u32 m0, s41, 90112
  s_mov_b32 s42, 8650752
  buffer_load_dwordx4 v2, s[8:11], s42 offen nt lds
  s_add_u32 m0, s41, 94208
  s_mov_b32 s42, 9043968
  buffer_load_dwordx4 v2, s[8:11], s42 offen nt lds
  s_add_u32 m0, s41, 98304
  s_mov_b32 s42, 9437184
  buffer_load_dwordx4 v2, s[8:11], s42 offen nt lds
  s_add_u32 m0, s41, 102400
  s_mov_b32 s42, 9830400
  buffer_load_dwordx4 v2, s[8:11], s42 offen nt lds
  s_add_u32 m0, s41, 106496
  s_mov_b32 s42, 10223616
  buffer_load_dwordx4 v2, s[8:11], s42 offen nt lds
  s_add_u32 m0, s41, 110592
  s_mov_b32 s42, 10616832
  buffer_load_dwordx4 v2, s[8:11], s42 offen nt lds
  s_add_u32 m0, s41, 114688
  s_mov_b32 s42, 11010048
  buffer_load_dwordx4 v2, s[8:11], s42 offen nt lds
  s_add_u32 m0, s41, 118784
  s_mov_b32 s42, 11403264
  buffer_load_dwordx4 v2, s[8:11], s42 offen nt lds
  s_add_u32 m0, s41, 122880
  s_mov_b32 s42, 11796480
  buffer_load_dwordx4 v2, s[8:11], s42 offen nt lds
  s_add_u32 m0, s41, 126976
  s_mov_b32 s42, 12189696
  buffer_load_dwordx4 v2, s[8:11], s42 offen nt lds
  v_bfe_u32 v3, v0, 3, 2
  v_xor_b32 v3, s20, v3
  v_lshlrev_b32 v3, 5, v3
  v_lshrrev_b32 v4, 2, v0
  v_lshl_add_u32 v4, v4, 7, v3
  v_and_b32 v3, 3, v0
  v_lshl_add_u32 v4, v3, 3, v4
  v_add_u32 v5, 0x10000, v4
  v_lshrrev_b32 v6, 4, v0
  v_lshlrev_b32 v6, 4, v6
  v_add_u32 v6, 0x20000, v6
  v_add_u32 v1, 0x20000, v1
  s_mov_b32 s37, 0xbfb8aa3b
  s_waitcnt vmcnt(32)
  v_lshlrev_b32 v10, 16, v8
  v_and_b32 v11, 0xffff0000, v8
  v_lshlrev_b32 v12, 16, v9
  v_and_b32 v13, 0xffff0000, v9
  v_mul_f32 v14, s37, v10
  v_mul_f32 v15, s37, v11
  v_mul_f32 v16, s37, v12
  v_mul_f32 v17, s37, v13
  v_exp_f32 v14, v14
  v_exp_f32 v15, v15
  v_exp_f32 v16, v16
  v_exp_f32 v17, v17
  v_add_f32 v14, 1.0, v14
  v_add_f32 v15, 1.0, v15
  v_add_f32 v16, 1.0, v16
  v_add_f32 v17, 1.0, v17
  v_rcp_f32 v14, v14
  v_rcp_f32 v15, v15
  v_rcp_f32 v16, v16
  v_rcp_f32 v17, v17
  v_mul_f32 v10, v10, v14
  v_mul_f32 v11, v11, v15
  v_mul_f32 v12, v12, v16
  v_mul_f32 v13, v13, v17
  v_cvt_pk_bf16_f32 v8, v10, v11
  v_cvt_pk_bf16_f32 v9, v12, v13
  ds_write_b64 v1, v[8:9]
  s_waitcnt vmcnt(28) lgkmcnt(0)
  s_barrier
  ds_read_b64_tr_b16 v[24:25], v4 offset:0
  ds_read_b64_tr_b16 v[26:27], v4 offset:2048
  ds_read_b128 v[28:31], v6 offset:0
  ds_read_b64_tr_b16 v[32:33], v4 offset:4096
  ds_read_b64_tr_b16 v[34:35], v4 offset:6144
  ds_read_b128 v[36:39], v6 offset:64
  ds_read_b64_tr_b16 v[40:41], v4 offset:8192
  ds_read_b64_tr_b16 v[42:43], v4 offset:10240
  ds_read_b128 v[44:47], v6 offset:128
  ds_read_b64_tr_b16 v[48:49], v4 offset:12288
  ds_read_b64_tr_b16 v[50:51], v4 offset:14336
  ds_read_b128 v[52:55], v6 offset:192
  s_waitcnt lgkmcnt(9)
  v_mfma_f32_16x16x32_bf16 v[20:23], v[24:27], v[28:31], 0
  s_waitcnt lgkmcnt(6)
  v_mfma_f32_16x16x32_bf16 v[20:23], v[32:35], v[36:39], v[20:23]
  s_waitcnt lgkmcnt(3)
  v_mfma_f32_16x16x32_bf16 v[20:23], v[40:43], v[44:47], v[20:23]
  s_waitcnt lgkmcnt(0)
  v_mfma_f32_16x16x32_bf16 v[20:23], v[48:51], v[52:55], v[20:23]
  s_waitcnt vmcnt(24) lgkmcnt(0)
  s_barrier
  ds_read_b64_tr_b16 v[24:25], v4 offset:16384
  ds_read_b64_tr_b16 v[26:27], v4 offset:18432
  ds_read_b128 v[28:31], v6 offset:256
  ds_read_b64_tr_b16 v[32:33], v4 offset:20480
  ds_read_b64_tr_b16 v[34:35], v4 offset:22528
  ds_read_b128 v[36:39], v6 offset:320
  ds_read_b64_tr_b16 v[40:41], v4 offset:24576
  ds_read_b64_tr_b16 v[42:43], v4 offset:26624
  ds_read_b128 v[44:47], v6 offset:384
  ds_read_b64_tr_b16 v[48:49], v4 offset:28672
  ds_read_b64_tr_b16 v[50:51], v4 offset:30720
  ds_read_b128 v[52:55], v6 offset:448
  s_waitcnt lgkmcnt(9)
  v_mfma_f32_16x16x32_bf16 v[20:23], v[24:27], v[28:31], v[20:23]
  s_waitcnt lgkmcnt(6)
  v_mfma_f32_16x16x32_bf16 v[20:23], v[32:35], v[36:39], v[20:23]
  s_waitcnt lgkmcnt(3)
  v_mfma_f32_16x16x32_bf16 v[20:23], v[40:43], v[44:47], v[20:23]
  s_waitcnt lgkmcnt(0)
  v_mfma_f32_16x16x32_bf16 v[20:23], v[48:51], v[52:55], v[20:23]
  s_waitcnt vmcnt(20) lgkmcnt(0)
  s_barrier
  ds_read_b64_tr_b16 v[24:25], v4 offset:32768
  ds_read_b64_tr_b16 v[26:27], v4 offset:34816
  ds_read_b128 v[28:31], v6 offset:512
  ds_read_b64_tr_b16 v[32:33], v4 offset:36864
  ds_read_b64_tr_b16 v[34:35], v4 offset:38912
  ds_read_b128 v[36:39], v6 offset:576
  ds_read_b64_tr_b16 v[40:41], v4 offset:40960
  ds_read_b64_tr_b16 v[42:43], v4 offset:43008
  ds_read_b128 v[44:47], v6 offset:640
  ds_read_b64_tr_b16 v[48:49], v4 offset:45056
  ds_read_b64_tr_b16 v[50:51], v4 offset:47104
  ds_read_b128 v[52:55], v6 offset:704
  s_waitcnt lgkmcnt(9)
  v_mfma_f32_16x16x32_bf16 v[20:23], v[24:27], v[28:31], v[20:23]
  s_waitcnt lgkmcnt(6)
  v_mfma_f32_16x16x32_bf16 v[20:23], v[32:35], v[36:39], v[20:23]
  s_waitcnt lgkmcnt(3)
  v_mfma_f32_16x16x32_bf16 v[20:23], v[40:43], v[44:47], v[20:23]
  s_waitcnt lgkmcnt(0)
  v_mfma_f32_16x16x32_bf16 v[20:23], v[48:51], v[52:55], v[20:23]
  s_waitcnt vmcnt(16) lgkmcnt(0)
  s_barrier
  ds_read_b64_tr_b16 v[24:25], v4 offset:49152
  ds_read_b64_tr_b16 v[26:27], v4 offset:51200
  ds_read_b128 v[28:31], v6 offset:768
  ds_read_b64_tr_b16 v[32:33], v4 offset:53248
  ds_read_b64_tr_b16 v[34:35], v4 offset:55296
  ds_read_b128 v[36:39], v6 offset:832
  ds_read_b64_tr_b16 v[40:41], v4 offset:57344
  ds_read_b64_tr_b16 v[42:43], v4 offset:59392
  ds_read_b128 v[44:47], v6 offset:896
  ds_read_b64_tr_b16 v[48:49], v4 offset:61440
  ds_read_b64_tr_b16 v[50:51], v4 offset:63488
  ds_read_b128 v[52:55], v6 offset:960
  s_waitcnt lgkmcnt(9)
  v_mfma_f32_16x16x32_bf16 v[20:23], v[24:27], v[28:31], v[20:23]
  s_waitcnt lgkmcnt(6)
  v_mfma_f32_16x16x32_bf16 v[20:23], v[32:35], v[36:39], v[20:23]
  s_waitcnt lgkmcnt(3)
  v_mfma_f32_16x16x32_bf16 v[20:23], v[40:43], v[44:47], v[20:23]
  s_waitcnt lgkmcnt(0)
  v_mfma_f32_16x16x32_bf16 v[20:23], v[48:51], v[52:55], v[20:23]
  s_waitcnt vmcnt(12) lgkmcnt(0)
  s_barrier
  ds_read_b64_tr_b16 v[24:25], v5 offset:0
  ds_read_b64_tr_b16 v[26:27], v5 offset:2048
  ds_read_b128 v[28:31], v6 offset:1024
  ds_read_b64_tr_b16 v[32:33], v5 offset:4096
  ds_read_b64_tr_b16 v[34:35], v5 offset:6144
  ds_read_b128 v[36:39], v6 offset:1088
  ds_read_b64_tr_b16 v[40:41], v5 offset:8192
  ds_read_b64_tr_b16 v[42:43], v5 offset:10240
  ds_read_b128 v[44:47], v6 offset:1152
  ds_read_b64_tr_b16 v[48:49], v5 offset:12288
  ds_read_b64_tr_b16 v[50:51], v5 offset:14336
  ds_read_b128 v[52:55], v6 offset:1216
  s_waitcnt lgkmcnt(9)
  v_mfma_f32_16x16x32_bf16 v[20:23], v[24:27], v[28:31], v[20:23]
  s_waitcnt lgkmcnt(6)
  v_mfma_f32_16x16x32_bf16 v[20:23], v[32:35], v[36:39], v[20:23]
  s_waitcnt lgkmcnt(3)
  v_mfma_f32_16x16x32_bf16 v[20:23], v[40:43], v[44:47], v[20:23]
  s_waitcnt lgkmcnt(0)
  v_mfma_f32_16x16x32_bf16 v[20:23], v[48:51], v[52:55], v[20:23]
  s_waitcnt vmcnt(8) lgkmcnt(0)
  s_barrier
  ds_read_b64_tr_b16 v[24:25], v5 offset:16384
  ds_read_b64_tr_b16 v[26:27], v5 offset:18432
  ds_read_b128 v[28:31], v6 offset:1280
  ds_read_b64_tr_b16 v[32:33], v5 offset:20480
  ds_read_b64_tr_b16 v[34:35], v5 offset:22528
  ds_read_b128 v[36:39], v6 offset:1344
  ds_read_b64_tr_b16 v[40:41], v5 offset:24576
  ds_read_b64_tr_b16 v[42:43], v5 offset:26624
  ds_read_b128 v[44:47], v6 offset:1408
  ds_read_b64_tr_b16 v[48:49], v5 offset:28672
  ds_read_b64_tr_b16 v[50:51], v5 offset:30720
  ds_read_b128 v[52:55], v6 offset:1472
  s_waitcnt lgkmcnt(9)
  v_mfma_f32_16x16x32_bf16 v[20:23], v[24:27], v[28:31], v[20:23]
  s_waitcnt lgkmcnt(6)
  v_mfma_f32_16x16x32_bf16 v[20:23], v[32:35], v[36:39], v[20:23]
  s_waitcnt lgkmcnt(3)
  v_mfma_f32_16x16x32_bf16 v[20:23], v[40:43], v[44:47], v[20:23]
  s_waitcnt lgkmcnt(0)
  v_mfma_f32_16x16x32_bf16 v[20:23], v[48:51], v[52:55], v[20:23]
  s_waitcnt vmcnt(4) lgkmcnt(0)
  s_barrier
  ds_read_b64_tr_b16 v[24:25], v5 offset:32768
  ds_read_b64_tr_b16 v[26:27], v5 offset:34816
  ds_read_b128 v[28:31], v6 offset:1536
  ds_read_b64_tr_b16 v[32:33], v5 offset:36864
  ds_read_b64_tr_b16 v[34:35], v5 offset:38912
  ds_read_b128 v[36:39], v6 offset:1600
  ds_read_b64_tr_b16 v[40:41], v5 offset:40960
  ds_read_b64_tr_b16 v[42:43], v5 offset:43008
  ds_read_b128 v[44:47], v6 offset:1664
  ds_read_b64_tr_b16 v[48:49], v5 offset:45056
  ds_read_b64_tr_b16 v[50:51], v5 offset:47104
  ds_read_b128 v[52:55], v6 offset:1728
  s_waitcnt lgkmcnt(9)
  v_mfma_f32_16x16x32_bf16 v[20:23], v[24:27], v[28:31], v[20:23]
  s_waitcnt lgkmcnt(6)
  v_mfma_f32_16x16x32_bf16 v[20:23], v[32:35], v[36:39], v[20:23]
  s_waitcnt lgkmcnt(3)
  v_mfma_f32_16x16x32_bf16 v[20:23], v[40:43], v[44:47], v[20:23]
  s_waitcnt lgkmcnt(0)
  v_mfma_f32_16x16x32_bf16 v[20:23], v[48:51], v[52:55], v[20:23]
  s_waitcnt vmcnt(0) lgkmcnt(0)
  s_barrier
  ds_read_b64_tr_b16 v[24:25], v5 offset:49152
  ds_read_b64_tr_b16 v[26:27], v5 offset:51200
  ds_read_b128 v[28:31], v6 offset:1792
  ds_read_b64_tr_b16 v[32:33], v5 offset:53248
  ds_read_b64_tr_b16 v[34:35], v5 offset:55296
  ds_read_b128 v[36:39], v6 offset:1856
  ds_read_b64_tr_b16 v[40:41], v5 offset:57344
  ds_read_b64_tr_b16 v[42:43], v5 offset:59392
  ds_read_b128 v[44:47], v6 offset:1920
  ds_read_b64_tr_b16 v[48:49], v5 offset:61440
  ds_read_b64_tr_b16 v[50:51], v5 offset:63488
  ds_read_b128 v[52:55], v6 offset:1984
  s_waitcnt lgkmcnt(9)
  v_mfma_f32_16x16x32_bf16 v[20:23], v[24:27], v[28:31], v[20:23]
  s_waitcnt lgkmcnt(6)
  v_mfma_f32_16x16x32_bf16 v[20:23], v[32:35], v[36:39], v[20:23]
  s_waitcnt lgkmcnt(3)
  v_mfma_f32_16x16x32_bf16 v[20:23], v[40:43], v[44:47], v[20:23]
  s_waitcnt lgkmcnt(0)
  v_mfma_f32_16x16x32_bf16 v[20:23], v[48:51], v[52:55], v[20:23]
  s_lshl_b32 s40, s21, 8
  s_lshl_b32 s41, s20, 6
  s_add_u32 s40, s40, s41
  s_add_u32 s40, s40, 1572864
  v_and_b32 v2, 15, v0
  v_cmp_eq_u32 vcc, 0, v2
  v_mov_b32 v3, 2147483392
  s_nop 0
  v_cndmask_b32 v1, v3, v0, vcc
  v_cvt_pk_bf16_f32 v8, v20, v21
  v_cvt_pk_bf16_f32 v9, v22, v23
  v_lshlrev_b32 v20, 16, v8
  v_and_b32 v21, 0xffff0000, v8
  v_lshlrev_b32 v22, 16, v9
  v_and_b32 v23, 0xffff0000, v9
  buffer_store_dwordx4 v[20:23], v1, s[4:7], s40 offen sc1
  v_min_u32 v2, 31, v0
  v_lshlrev_b32 v2, 2, v2
  v_add_u32 v2, 128, v2
  s_nop 1
Lpoll_1:
  buffer_load_dword v3, v2, s[12:15], 0 offen sc1
  s_sub_u32 s24, s24, 1
  s_cbranch_scc1 L_FAIL
  s_waitcnt vmcnt(0)
  v_cmp_gt_i32 vcc, 1, v3
  s_cbranch_vccz Lpolld_2
  s_sleep 2
  s_branch Lpoll_1
Lpolld_2:
  s_lshl_b32 s40, s21, 7
  s_add_u32 s40, s40, 1376256
  v_mov_b32 v2, 2147483392
  s_mov_b64 exec, 1
  v_mov_b32 v2, s40
  s_mov_b64 exec, -1
  v_mov_b32 v3, 1
  s_barrier
  s_cmp_lg_u32 s20, 0
  s_cbranch_scc1 L_MOD_done
  buffer_store_dword v3, v2, s[4:7], 0 offen sc1
L_MOD_done:
  s_cmp_lg_u32 s22, 6
  s_cbranch_scc1 L_ROLE
L_LN1:
  s_load_dwordx2 s[16:17], s[0:1], 0
  s_mov_b32 s18, 4194304
  s_mov_b32 s19, 0x20000
  s_waitcnt lgkmcnt(0)
  s_sub_u32 s43, 7, s22
  s_lshl_b32 s43, s43, 5
  s_add_u32 s43, s43, s23
  s_lshl_b32 s43, s43, 2
  s_add_u32 s43, s43, s20
  s_lshl_b32 s44, s43, 13
  s_add_u32 s45, s44, 4096
  v_lshlrev_b32 v1, 3, v0
  v_lshlrev_b32 v2, 4, v0
  buffer_load_dwordx2 v[8:9], v1, s[16:19], s44 offen offset:0 nt
  buffer_load_dwordx2 v[10:11], v1, s[16:19], s44 offen offset:512 nt
  buffer_load_dwordx2 v[12:13], v1, s[16:19], s44 offen offset:1024 nt
  buffer_load_dwordx2 v[14:15], v1, s[16:19], s44 offen offset:1536 nt
  buffer_load_dwordx2 v[16:17], v1, s[16:19], s44 offen offset:2048 nt
  buffer_load_dwordx2 v[18:19], v1, s[16:19], s44 offen offset:2560 nt
  buffer_load_dwordx2 v[20:21], v1, s[16:19], s44 offen offset:3072 nt
  buffer_load_dwordx2 v[22:23], v1, s[16:19], s44 offen offset:3584 nt
  buffer_load_dwordx2 v[24:25], v1, s[16:19], s45 offen offset:0 nt
  buffer_load_dwordx2 v[26:27], v1, s[16:19], s45 offen offset:512 nt
  buffer_load_dwordx2 v[28:29], v1, s[16:19], s45 offen offset:1024 nt
  buffer_load_dwordx2 v[30:31], v1, s[16:19], s45 offen offset:1536 nt
  buffer_load_dwordx2 v[32:33], v1, s[16:19], s45 offen offset:2048 nt
  buffer_load_dwordx2 v[34:35], v1, s[16:19], s45 offen offset:2560 nt
  buffer_load_dwordx2 v[36:37], v1, s[16:19], s45 offen offset:3072 nt
  buffer_load_dwordx2 v[38:39], v1, s[16:19], s45 offen offset:3584 nt
  s_waitcnt vmcnt(0)
  v_lshlrev_b32 v40, 16, v8
  v_and_b32 v41, 0xffff0000, v8
  v_lshlrev_b32 v42, 16, v9
  v_and_b32 v43, 0xffff0000, v9
  v_lshlrev_b32 v44, 16, v10
  v_and_b32 v45, 0xffff0000, v10
  v_lshlrev_b32 v46, 16, v11
  v_and_b32 v47, 0xffff0000, v11
  v_lshlrev_b32 v48, 16, v12
  v_and_b32 v49, 0xffff0000, v12
  v_lshlrev_b32 v50, 16, v13
  v_and_b32 v51, 0xffff0000, v13
  v_lshlrev_b32 v52, 16, v14
  v_and_b32 v53, 0xffff0000, v14
  v_lshlrev_b32 v54, 16, v15
  v_and_b32 v55, 0xffff0000, v15
  v_lshlrev_b32 v56, 16, v16
  v_and_b32 v57, 0xffff0000, v16
  v_lshlrev_b32 v58, 16, v17
  v_and_b32 v59, 0xffff0000, v17
  v_lshlrev_b32 v60, 16, v18
  v_and_b32 v61, 0xffff0000, v18
  v_lshlrev_b32 v62, 16, v19
  v_and_b32 v63, 0xffff0000, v19
  v_lshlrev_b32 v64, 16, v20
  v_and_b32 v65, 0xffff0000, v20
  v_lshlrev_b32 v66, 16, v21
  v_and_b32 v67, 0xffff0000, v21
  v_lshlrev_b32 v68, 16, v22
  v_and_b32 v69, 0xffff0000, v22
  v_lshlrev_b32 v70, 16, v23
  v_and_b32 v71, 0xffff0000, v23
  v_lshlrev_b32 v72, 16, v24
  v_and_b32 v73, 0xffff0000, v24
  v_lshlrev_b32 v74, 16, v25
  v_and_b32 v75, 0xffff0000, v25
  v_lshlrev_b32 v76, 16, v26
  v_and_b32 v77, 0xffff0000, v26
  v_lshlrev_b32 v78, 16, v27
  v_and_b32 v79, 0xffff0000, v27
  v_lshlrev_b32 v80, 16, v28
  v_and_b32 v81, 0xffff0000, v28
  v_lshlrev_b32 v82, 16, v29
  v_and_b32 v83, 0xffff0000, v29
  v_lshlrev_b32 v84, 16, v30
  v_and_b32 v85, 0xffff0000, v30
  v_lshlrev_b32 v86, 16, v31
  v_and_b32 v87, 0xffff0000, v31
  v_lshlrev_b32 v88, 16, v32
  v_and_b32 v89, 0xffff0000, v32
  v_lshlrev_b32 v90, 16, v33
  v_and_b32 v91, 0xffff0000, v33
  v_lshlrev_b32 v92, 16, v34
  v_and_b32 v93, 0xffff0000, v34
  v_lshlrev_b32 v94, 16, v35
  v_and_b32 v95, 0xffff0000, v35
  v_lshlrev_b32 v96, 16, v36
  v_and_b32 v97, 0xffff0000, v36
  v_lshlrev_b32 v98, 16, v37
  v_and_b32 v99, 0xffff0000, v37
  v_lshlrev_b32 v100, 16, v38
  v_and_b32 v101, 0xffff0000, v38
  v_lshlrev_b32 v102, 16, v39
  v_and_b32 v103, 0xffff0000, v39
  v_pk_add_f32 v[104:105], v[40:41], v[42:43]
  v_pk_add_f32 v[108:109], v[56:57], v[58:59]
  v_pk_add_f32 v[112:113], v[72:73], v[74:75]
  v_pk_add_f32 v[116:117], v[88:89], v[90:91]
  v_pk_add_f32 v[104:105], v[104:105], v[44:45]
  v_pk_add_f32 v[108:109], v[108:109], v[60:61]
  v_pk_add_f32 v[112:113], v[112:113], v[76:77]
  v_pk_add_f32 v[116:117], v[116:117], v[92:93]
  v_pk_add_f32 v[104:105], v[104:105], v[46:47]
  v_pk_add_f32 v[108:109], v[108:109], v[62:63]
  v_pk_add_f32 v[112:113], v[112:113], v[78:79]
  v_pk_add_f32 v[116:117], v[116:117], v[94:95]
  v_pk_add_f32 v[104:105], v[104:105], v[48:49]
  v_pk_add_f32 v[108:109], v[108:109], v[64:65]
  v_pk_add_f32 v[112:113], v[112:113], v[80:81]
  v_pk_add_f32 v[116:117], v[116:117], v[96:97]
  v_pk_add_f32 v[104:105], v[104:105], v[50:51]
  v_pk_add_f32 v[108:109], v[108:109], v[66:67]
  v_pk_add_f32 v[112:113], v[112:113], v[82:83]
  v_pk_add_f32 v[116:117], v[116:117], v[98:99]
  v_pk_add_f32 v[104:105], v[104:105], v[52:53]
  v_pk_add_f32 v[108:109], v[108:109], v[68:69]
  v_pk_add_f32 v[112:113], v[112:113], v[84:85]
  v_pk_add_f32 v[116:117], v[116:117], v[100:101]
  v_pk_add_f32 v[104:105], v[104:105], v[54:55]
  v_pk_add_f32 v[108:109], v[108:109], v[70:71]
  v_pk_add_f32 v[112:113], v[112:113], v[86:87]
  v_pk_add_f32 v[116:117], v[116:117], v[102:103]
  v_add_f32 v104, v104, v105
  v_add_f32 v108, v108, v109
  v_add_f32 v112, v112, v113
  v_add_f32 v116, v116, v117
  v_add_f32_dpp v104, v104, v104 row_ror:8 row_mask:0xf bank_mask:0xf
  v_add_f32_dpp v108, v108, v108 row_ror:8 row_mask:0xf bank_mask:0xf
  v_add_f32_dpp v112, v112, v112 row_ror:8 row_mask:0xf bank_mask:0xf
  v_add_f32_dpp v116, v116, v116 row_ror:8 row_mask:0xf bank_mask:0xf
  v_add_f32_dpp v104, v104, v104 row_ror:4 row_mask:0xf bank_mask:0xf
  v_add_f32_dpp v108, v108, v108 row_ror:4 row_mask:0xf bank_mask:0xf
  v_add_f32_dpp v112, v112, v112 row_ror:4 row_mask:0xf bank_mask:0xf
  v_add_f32_dpp v116, v116, v116 row_ror:4 row_mask:0xf bank_mask:0xf
  v_add_f32_dpp v104, v104, v104 row_ror:2 row_mask:0xf bank_mask:0xf
  v_add_f32_dpp v108, v108, v108 row_ror:2 row_mask:0xf bank_mask:0xf
  v_add_f32_dpp v112, v112, v112 row_ror:2 row_mask:0xf bank_mask:0xf
  v_add_f32_dpp v116, v116, v116 row_ror:2 row_mask:0xf bank_mask:0xf
  v_add_f32_dpp v104, v104, v104 row_ror:1 row_mask:0xf bank_mask:0xf
  v_add_f32_dpp v108, v108, v108 row_ror:1 row_mask:0xf bank_mask:0xf
  v_add_f32_dpp v112, v112, v112 row_ror:1 row_mask:0xf bank_mask:0xf
  v_add_f32_dpp v116, v116, v116 row_ror:1 row_mask:0xf bank_mask:0xf
  v_mov_b32 v105, v104
  v_mov_b32 v109, v108
  v_mov_b32 v113, v112
  v_mov_b32 v117, v116
  v_permlane16_swap_b32 v105, v104
  v_permlane16_swap_b32 v109, v108
  v_permlane16_swap_b32 v113, v112
  v_permlane16_swap_b32 v117, v116
  v_add_f32 v104, v104, v105
  v_add_f32 v108, v108, v109
  v_add_f32 v112, v112, v113
  v_add_f32 v116, v116, v117
  v_mov_b32 v105, v104
  v_mov_b32 v109, v108
  v_mov_b32 v113, v112
  v_mov_b32 v117, v116
  v_permlane32_swap_b32 v105, v104
  v_permlane32_swap_b32 v109, v108
  v_permlane32_swap_b32 v113, v112
  v_permlane32_swap_b32 v117, v116
  v_add_f32 v104, v104, v105
  v_add_f32 v108, v108, v109
  v_add_f32 v112, v112, v113
  v_add_f32 v116, v116, v117
  v_mul_f32 v104, 0xba800000, v104
  v_mul_f32 v108, 0xba800000, v108
  v_mul_f32 v112, 0xba800000, v112
  v_mul_f32 v116, 0xba800000, v116
  v_pk_add_f32 v[40:41], v[40:41], v[104:105] op_sel_hi:[1,0]
  v_pk_add_f32 v[56:57], v[56:57], v[108:109] op_sel_hi:[1,0]
  v_pk_add_f32 v[72:73], v[72:73], v[112:113] op_sel_hi:[1,0]
  v_pk_add_f32 v[88:89], v[88:89], v[116:117] op_sel_hi:[1,0]
  v_pk_add_f32 v[42:43], v[42:43], v[104:105] op_sel_hi:[1,0]
  v_pk_add_f32 v[58:59], v[58:59], v[108:109] op_sel_hi:[1,0]
  v_pk_add_f32 v[74:75], v[74:75], v[112:113] op_sel_hi:[1,0]
  v_pk_add_f32 v[90:91], v[90:91], v[116:117] op_sel_hi:[1,0]
  v_pk_add_f32 v[44:45], v[44:45], v[104:105] op_sel_hi:[1,0]
  v_pk_add_f32 v[60:61], v[60:61], v[108:109] op_sel_hi:[1,0]
  v_pk_add_f32 v[76:77], v[76:77], v[112:113] op_sel_hi:[1,0]
  v_pk_add_f32 v[92:93], v[92:93], v[116:117] op_sel_hi:[1,0]
  v_pk_add_f32 v[46:47], v[46:47], v[104:105] op_sel_hi:[1,0]
  v_pk_add_f32 v[62:63], v[62:63], v[108:109] op_sel_hi:[1,0]
  v_pk_add_f32 v[78:79], v[78:79], v[112:113] op_sel_hi:[1,0]
  v_pk_add_f32 v[94:95], v[94:95], v[116:117] op_sel_hi:[1,0]
  v_pk_add_f32 v[48:49], v[48:49], v[104:105] op_sel_hi:[1,0]
  v_pk_add_f32 v[64:65], v[64:65], v[108:109] op_sel_hi:[1,0]
  v_pk_add_f32 v[80:81], v[80:81], v[112:113] op_sel_hi:[1,0]
  v_pk_add_f32 v[96:97], v[96:97], v[116:117] op_sel_hi:[1,0]
  v_pk_add_f32 v[50:51], v[50:51], v[104:105] op_sel_hi:[1,0]
  v_pk_add_f32 v[66:67], v[66:67], v[108:109] op_sel_hi:[1,0]
  v_pk_add_f32 v[82:83], v[82:83], v[112:113] op_sel_hi:[1,0]
  v_pk_add_f32 v[98:99], v[98:99], v[116:117] op_sel_hi:[1,0]
  v_pk_add_f32 v[52:53], v[52:53], v[104:105] op_sel_hi:[1,0]
  v_pk_add_f32 v[68:69], v[68:69], v[108:109] op_sel_hi:[1,0]
  v_pk_add_f32 v[84:85], v[84:85], v[112:113] op_sel_hi:[1,0]
  v_pk_add_f32 v[100:101], v[100:101], v[116:117] op_sel_hi:[1,0]
  v_pk_add_f32 v[54:55], v[54:55], v[104:105] op_sel_hi:[1,0]
  v_pk_add_f32 v[70:71], v[70:71], v[108:109] op_sel_hi:[1,0]
  v_pk_add_f32 v[86:87], v[86:87], v[112:113] op_sel_hi:[1,0]
  v_pk_add_f32 v[102:103], v[102:103], v[116:117] op_sel_hi:[1,0]
  v_pk_mul_f32 v[104:105], v[40:41], v[40:41]
  v_pk_mul_f32 v[108:109], v[56:57], v[56:57]
  v_pk_mul_f32 v[112:113], v[72:73], v[72:73]
  v_pk_mul_f32 v[116:117], v[88:89], v[88:89]
  v_pk_fma_f32 v[104:105], v[42:43], v[42:43], v[104:105]
  v_pk_fma_f32 v[108:109], v[58:59], v[58:59], v[108:109]
  v_pk_fma_f32 v[112:113], v[74:75], v[74:75], v[112:113]
  v_pk_fma_f32 v[116:117], v[90:91], v[90:91], v[116:117]
  v_pk_fma_f32 v[104:105], v[44:45], v[44:45], v[104:105]
  v_pk_fma_f32 v[108:109], v[60:61], v[60:61], v[108:109]
  v_pk_fma_f32 v[112:113], v[76:77], v[76:77], v[112:113]
  v_pk_fma_f32 v[116:117], v[92:93], v[92:93], v[116:117]
  v_pk_fma_f32 v[104:105], v[46:47], v[46:47], v[104:105]
  v_pk_fma_f32 v[108:109], v[62:63], v[62:63], v[108:109]
  v_pk_fma_f32 v[112:113], v[78:79], v[78:79], v[112:113]
  v_pk_fma_f32 v[116:117], v[94:95], v[94:95], v[116:117]
  v_pk_fma_f32 v[104:105], v[48:49], v[48:49], v[104:105]
  v_pk_fma_f32 v[108:109], v[64:65], v[64:65], v[108:109]
  v_pk_fma_f32 v[112:113], v[80:81], v[80:81], v[112:113]
  v_pk_fma_f32 v[116:117], v[96:97], v[96:97], v[116:117]
  v_pk_fma_f32 v[104:105], v[50:51], v[50:51], v[104:105]
  v_pk_fma_f32 v[108:109], v[66:67], v[66:67], v[108:109]
  v_pk_fma_f32 v[112:113], v[82:83], v[82:83], v[112:113]
  v_pk_fma_f32 v[116:117], v[98:99], v[98:99], v[116:117]
  v_pk_fma_f32 v[104:105], v[52:53], v[52:53], v[104:105]
  v_pk_fma_f32 v[108:109], v[68:69], v[68:69], v[108:109]
  v_pk_fma_f32 v[112:113], v[84:85], v[84:85], v[112:113]
  v_pk_fma_f32 v[116:117], v[100:101], v[100:101], v[116:117]
  v_pk_fma_f32 v[104:105], v[54:55], v[54:55], v[104:105]
  v_pk_fma_f32 v[108:109], v[70:71], v[70:71], v[108:109]
  v_pk_fma_f32 v[112:113], v[86:87], v[86:87], v[112:113]
  v_pk_fma_f32 v[116:117], v[102:103], v[102:103], v[116:117]
  v_add_f32 v104, v104, v105
  v_add_f32 v108, v108, v109
  v_add_f32 v112, v112, v113
  v_add_f32 v116, v116, v117
  v_add_f32_dpp v104, v104, v104 row_ror:8 row_mask:0xf bank_mask:0xf
  v_add_f32_dpp v108, v108, v108 row_ror:8 row_mask:0xf bank_mask:0xf
  v_add_f32_dpp v112, v112, v112 row_ror:8 row_mask:0xf bank_mask:0xf
  v_add_f32_dpp v116, v116, v116 row_ror:8 row_mask:0xf bank_mask:0xf
  v_add_f32_dpp v104, v104, v104 row_ror:4 row_mask:0xf bank_mask:0xf
  v_add_f32_dpp v108, v108, v108 row_ror:4 row_mask:0xf bank_mask:0xf
  v_add_f32_dpp v112, v112, v112 row_ror:4 row_mask:0xf bank_mask:0xf
  v_add_f32_dpp v116, v116, v116 row_ror:4 row_mask:0xf bank_mask:0xf
  v_add_f32_dpp v104, v104, v104 row_ror:2 row_mask:0xf bank_mask:0xf
  v_add_f32_dpp v108, v108, v108 row_ror:2 row_mask:0xf bank_mask:0xf
  v_add_f32_dpp v112, v112, v112 row_ror:2 row_mask:0xf bank_mask:0xf
  v_add_f32_dpp v116, v116, v116 row_ror:2 row_mask:0xf bank_mask:0xf
  v_add_f32_dpp v104, v104, v104 row_ror:1 row_mask:0xf bank_mask:0xf
  v_add_f32_dpp v108, v108, v108 row_ror:1 row_mask:0xf bank_mask:0xf
  v_add_f32_dpp v112, v112, v112 row_ror:1 row_mask:0xf bank_mask:0xf
  v_add_f32_dpp v116, v116, v116 row_ror:1 row_mask:0xf bank_mask:0xf
  v_mov_b32 v105, v104
  v_mov_b32 v109, v108
  v_mov_b32 v113, v112
  v_mov_b32 v117, v116
  v_permlane16_swap_b32 v105, v104
  v_permlane16_swap_b32 v109, v108
  v_permlane16_swap_b32 v113, v112
  v_permlane16_swap_b32 v117, v116
  v_add_f32 v104, v104, v105
  v_add_f32 v108, v108, v109
  v_add_f32 v112, v112, v113
  v_add_f32 v116, v116, v117
  v_mov_b32 v105, v104
  v_mov_b32 v109, v108
  v_mov_b32 v113, v112
  v_mov_b32 v117, v116
  v_permlane32_swap_b32 v105, v104
  v_permlane32_swap_b32 v109, v108
  v_permlane32_swap_b32 v113, v112
  v_permlane32_swap_b32 v117, v116
  v_add_f32 v104, v104, v105
  v_add_f32 v108, v108, v109
  v_add_f32 v112, v112, v113
  v_add_f32 v116, v116, v117
  v_mul_f32 v104, 0x3a800000, v104
  v_mul_f32 v108, 0x3a800000, v108
  v_mul_f32 v112, 0x3a800000, v112
  v_mul_f32 v116, 0x3a800000, v116
  v_add_f32 v104, 0x3727c5ac, v104
  v_add_f32 v108, 0x3727c5ac, v108
  v_add_f32 v112, 0x3727c5ac, v112
  v_add_f32 v116, 0x3727c5ac, v116
  v_rsq_f32 v104, v104
  v_rsq_f32 v108, v108
  v_rsq_f32 v112, v112
  v_rsq_f32 v116, v116
  v_pk_mul_f32 v[40:41], v[40:41], v[104:105] op_sel_hi:[1,0]
  v_pk_mul_f32 v[56:57], v[56:57], v[108:109] op_sel_hi:[1,0]
  v_pk_mul_f32 v[72:73], v[72:73], v[112:113] op_sel_hi:[1,0]
  v_pk_mul_f32 v[88:89], v[88:89], v[116:117] op_sel_hi:[1,0]
  v_pk_mul_f32 v[42:43], v[42:43], v[104:105] op_sel_hi:[1,0]
  v_pk_mul_f32 v[58:59], v[58:59], v[108:109] op_sel_hi:[1,0]
  v_pk_mul_f32 v[74:75], v[74:75], v[112:113] op_sel_hi:[1,0]
  v_pk_mul_f32 v[90:91], v[90:91], v[116:117] op_sel_hi:[1,0]
  v_pk_mul_f32 v[44:45], v[44:45], v[104:105] op_sel_hi:[1,0]
  v_pk_mul_f32 v[60:61], v[60:61], v[108:109] op_sel_hi:[1,0]
  v_pk_mul_f32 v[76:77], v[76:77], v[112:113] op_sel_hi:[1,0]
  v_pk_mul_f32 v[92:93], v[92:93], v[116:117] op_sel_hi:[1,0]
  v_pk_mul_f32 v[46:47], v[46:47], v[104:105] op_sel_hi:[1,0]
  v_pk_mul_f32 v[62:63], v[62:63], v[108:109] op_sel_hi:[1,0]
  v_pk_mul_f32 v[78:79], v[78:79], v[112:113] op_sel_hi:[1,0]
  v_pk_mul_f32 v[94:95], v[94:95], v[116:117] op_sel_hi:[1,0]
  v_pk_mul_f32 v[48:49], v[48:49], v[104:105] op_sel_hi:[1,0]
  v_pk_mul_f32 v[64:65], v[64:65], v[108:109] op_sel_hi:[1,0]
  v_pk_mul_f32 v[80:81], v[80:81], v[112:113] op_sel_hi:[1,0]
  v_pk_mul_f32 v[96:97], v[96:97], v[116:117] op_sel_hi:[1,0]
  v_pk_mul_f32 v[50:51], v[50:51], v[104:105] op_sel_hi:[1,0]
  v_pk_mul_f32 v[66:67], v[66:67], v[108:109] op_sel_hi:[1,0]
  v_pk_mul_f32 v[82:83], v[82:83], v[112:113] op_sel_hi:[1,0]
  v_pk_mul_f32 v[98:99], v[98:99], v[116:117] op_sel_hi:[1,0]
  v_pk_mul_f32 v[52:53], v[52:53], v[104:105] op_sel_hi:[1,0]
  v_pk_mul_f32 v[68:69], v[68:69], v[108:109] op_sel_hi:[1,0]
  v_pk_mul_f32 v[84:85], v[84:85], v[112:113] op_sel_hi:[1,0]
  v_pk_mul_f32 v[100:101], v[100:101], v[116:117] op_sel_hi:[1,0]
  v_pk_mul_f32 v[54:55], v[54:55], v[104:105] op_sel_hi:[1,0]
  v_pk_mul_f32 v[70:71], v[70:71], v[108:109] op_sel_hi:[1,0]
  v_pk_mul_f32 v[86:87], v[86:87], v[112:113] op_sel_hi:[1,0]
  v_pk_mul_f32 v[102:103], v[102:103], v[116:117] op_sel_hi:[1,0]
  v_min_u32 v3, 31, v0
  v_lshlrev_b32 v3, 2, v3
  v_add_u32 v3, 128, v3
  s_nop 1
Lpoll_3:
  buffer_load_dword v4, v3, s[12:15], 0 offen sc1
  s_sub_u32 s24, s24, 1
  s_cbranch_scc1 L_FAIL
  s_waitcnt vmcnt(0)
  v_cmp_gt_i32 vcc, 1, v4
  s_cbranch_vccz Lpolld_4
  s_sleep 2
  s_branch Lpoll_3
Lpolld_4:
  v_min_u32 v3, 31, v0
  v_lshlrev_b32 v3, 7, v3
  v_add_u32 v3, 1376256, v3
  s_nop 1
Lpoll_5:
  buffer_load_dword v4, v3, s[4:7], 0 offen sc1
  s_sub_u32 s24, s24, 1
  s_cbranch_scc1 L_FAIL
  s_waitcnt vmcnt(0)
  v_cmp_gt_i32 vcc, 1, v4
  s_cbranch_vccz Lpolld_6
  s_sleep 2
  s_branch Lpoll_5
Lpolld_6:
  s_mov_b32 s40, 1572864
  buffer_load_dwordx4 v[136:139], v2, s[4:7], s40 offen offset:0 sc1
  buffer_load_dwordx4 v[140:143], v2, s[4:7], s40 offen offset:1024 sc1
  buffer_load_dwordx4 v[144:147], v2, s[4:7], s40 offen offset:2048 sc1
  buffer_load_dwordx4 v[148:151], v2, s[4:7], s40 offen offset:3072 sc1
  s_mov_b32 s40, 1576960
  buffer_load_dwordx4 v[120:123], v2, s[4:7], s40 offen offset:0 sc1
  buffer_load_dwordx4 v[124:127], v2, s[4:7], s40 offen offset:1024 sc1
  buffer_load_dwordx4 v[128:131], v2, s[4:7], s40 offen offset:2048 sc1
  buffer_load_dwordx4 v[132:135], v2, s[4:7], s40 offen offset:3072 sc1
  s_waitcnt vmcnt(0)
  v_add_f32 v120, 1.0, v120
  v_add_f32 v121, 1.0, v121
  v_add_f32 v122, 1.0, v122
  v_add_f32 v123, 1.0, v123
  v_add_f32 v124, 1.0, v124
  v_add_f32 v125, 1.0, v125
  v_add_f32 v126, 1.0, v126
  v_add_f32 v127, 1.0, v127
  v_add_f32 v128, 1.0, v128
  v_add_f32 v129, 1.0, v129
  v_add_f32 v130, 1.0, v130
  v_add_f32 v131, 1.0, v131
  v_add_f32 v132, 1.0, v132
  v_add_f32 v133, 1.0, v133
  v_add_f32 v134, 1.0, v134
  v_add_f32 v135, 1.0, v135
  s_add_u32 s44, s44, 2097152
  s_add_u32 s45, s45, 2097152
  v_pk_fma_f32 v[40:41], v[40:41], v[120:121], v[136:137]
  v_pk_fma_f32 v[42:43], v[42:43], v[122:123], v[138:139]
  v_pk_fma_f32 v[44:45], v[44:45], v[124:125], v[140:141]
  v_pk_fma_f32 v[46:47], v[46:47], v[126:127], v[142:143]
  v_pk_fma_f32 v[48:49], v[48:49], v[128:129], v[144:145]
  v_pk_fma_f32 v[50:51], v[50:51], v[130:131], v[146:147]
  v_pk_fma_f32 v[52:53], v[52:53], v[132:133], v[148:149]
  v_pk_fma_f32 v[54:55], v[54:55], v[134:135], v[150:151]
  v_cvt_pk_bf16_f32 v8, v40, v41
  v_cvt_pk_bf16_f32 v9, v42, v43
  v_cvt_pk_bf16_f32 v10, v44, v45
  v_cvt_pk_bf16_f32 v11, v46, v47
  v_cvt_pk_bf16_f32 v12, v48, v49
  v_cvt_pk_bf16_f32 v13, v50, v51
  v_cvt_pk_bf16_f32 v14, v52, v53
  v_cvt_pk_bf16_f32 v15, v54, v55
  buffer_store_dwordx4 v[8:11], v2, s[4:7], s44 offen offset:0 sc1
  buffer_store_dwordx4 v[12:15], v2, s[4:7], s44 offen offset:1024 sc1
  v_pk_fma_f32 v[56:57], v[56:57], v[120:121], v[136:137]
  v_pk_fma_f32 v[58:59], v[58:59], v[122:123], v[138:139]
  v_pk_fma_f32 v[60:61], v[60:61], v[124:125], v[140:141]
  v_pk_fma_f32 v[62:63], v[62:63], v[126:127], v[142:143]
  v_pk_fma_f32 v[64:65], v[64:65], v[128:129], v[144:145]
  v_pk_fma_f32 v[66:67], v[66:67], v[130:131], v[146:147]
  v_pk_fma_f32 v[68:69], v[68:69], v[132:133], v[148:149]
  v_pk_fma_f32 v[70:71], v[70:71], v[134:135], v[150:151]
  v_cvt_pk_bf16_f32 v16, v56, v57
  v_cvt_pk_bf16_f32 v17, v58, v59
  v_cvt_pk_bf16_f32 v18, v60, v61
  v_cvt_pk_bf16_f32 v19, v62, v63
  v_cvt_pk_bf16_f32 v20, v64, v65
  v_cvt_pk_bf16_f32 v21, v66, v67
  v_cvt_pk_bf16_f32 v22, v68, v69
  v_cvt_pk_bf16_f32 v23, v70, v71
  buffer_store_dwordx4 v[16:19], v2, s[4:7], s44 offen offset:2048 sc1
  buffer_store_dwordx4 v[20:23], v2, s[4:7], s44 offen offset:3072 sc1
  v_pk_fma_f32 v[72:73], v[72:73], v[120:121], v[136:137]
  v_pk_fma_f32 v[74:75], v[74:75], v[122:123], v[138:139]
  v_pk_fma_f32 v[76:77], v[76:77], v[124:125], v[140:141]
  v_pk_fma_f32 v[78:79], v[78:79], v[126:127], v[142:143]
  v_pk_fma_f32 v[80:81], v[80:81], v[128:129], v[144:145]
  v_pk_fma_f32 v[82:83], v[82:83], v[130:131], v[146:147]
  v_pk_fma_f32 v[84:85], v[84:85], v[132:133], v[148:149]
  v_pk_fma_f32 v[86:87], v[86:87], v[134:135], v[150:151]
  v_cvt_pk_bf16_f32 v24, v72, v73
  v_cvt_pk_bf16_f32 v25, v74, v75
  v_cvt_pk_bf16_f32 v26, v76, v77
  v_cvt_pk_bf16_f32 v27, v78, v79
  v_cvt_pk_bf16_f32 v28, v80, v81
  v_cvt_pk_bf16_f32 v29, v82, v83
  v_cvt_pk_bf16_f32 v30, v84, v85
  v_cvt_pk_bf16_f32 v31, v86, v87
  buffer_store_dwordx4 v[24:27], v2, s[4:7], s45 offen offset:0 sc1
  buffer_store_dwordx4 v[28:31], v2, s[4:7], s45 offen offset:1024 sc1
  v_pk_fma_f32 v[88:89], v[88:89], v[120:121], v[136:137]
  v_pk_fma_f32 v[90:91], v[90:91], v[122:123], v[138:139]
  v_pk_fma_f32 v[92:93], v[92:93], v[124:125], v[140:141]
  v_pk_fma_f32 v[94:95], v[94:95], v[126:127], v[142:143]
  v_pk_fma_f32 v[96:97], v[96:97], v[128:129], v[144:145]
  v_pk_fma_f32 v[98:99], v[98:99], v[130:131], v[146:147]
  v_pk_fma_f32 v[100:101], v[100:101], v[132:133], v[148:149]
  v_pk_fma_f32 v[102:103], v[102:103], v[134:135], v[150:151]
  v_cvt_pk_bf16_f32 v32, v88, v89
  v_cvt_pk_bf16_f32 v33, v90, v91
  v_cvt_pk_bf16_f32 v34, v92, v93
  v_cvt_pk_bf16_f32 v35, v94, v95
  v_cvt_pk_bf16_f32 v36, v96, v97
  v_cvt_pk_bf16_f32 v37, v98, v99
  v_cvt_pk_bf16_f32 v38, v100, v101
  v_cvt_pk_bf16_f32 v39, v102, v103
  buffer_store_dwordx4 v[32:35], v2, s[4:7], s45 offen offset:2048 sc1
  buffer_store_dwordx4 v[36:39], v2, s[4:7], s45 offen offset:3072 sc1
  s_lshr_b32 s40, s43, 3
  s_lshl_b32 s40, s40, 7
  s_and_b32 s41, s43, 7
  s_lshl_b32 s41, s41, 2
  s_add_u32 s40, s40, s41
  s_add_u32 s40, s40, 1388544
  v_mov_b32 v3, 2147483392
  s_mov_b64 exec, 1
  v_mov_b32 v3, s40
  s_mov_b64 exec, -1
  v_mov_b32 v4, 1
  s_waitcnt vmcnt(0)
  buffer_store_dword v4, v3, s[4:7], 0 offen sc1
  s_cmp_lg_u32 s20, 2
  s_cbranch_scc1 Lnotlb_7
  v_lshlrev_b32 v1, 21, v0
  s_mov_b32 s40, 0x1fff80
  buffer_load_dword v2, v1, s[4:7], s40 offen sc1
  s_add_u32 s40, s40, 134217728
  buffer_load_dword v2, v1, s[4:7], s40 offen sc1
  s_waitcnt vmcnt(0)
Lnotlb_7:
  s_mov_b32 s40, 1404928
  s_cmp_lt_u32 s22, 6
  s_cselect_b32 s40, 1404928, s40
  v_mov_b32 v1, s40
  s_nop 1
Lpoll_8:
  buffer_load_dword v2, v1, s[4:7], 0 offen sc1
  s_sub_u32 s24, s24, 1
  s_cbranch_scc1 L_FAIL
  s_waitcnt vmcnt(0)
  v_cmp_gt_i32 vcc, 0, v2
  s_cbranch_vccz Lpolld_9
  s_sleep 8
  s_branch Lpoll_8
Lpolld_9:
  s_sub_u32 s40, s22, 3
  s_lshl_b32 s40, s40, 5
  s_add_u32 s21, s40, s23
  s_cmp_lt_u32 s22, 6
  s_cbranch_scc1 L_MOD
L_ROLE:
  s_sub_u32 s21, s3, 128
  s_cmp_lt_u32 s3, 160
  s_cbranch_scc1 L_WO
  s_sub_u32 s21, s3, 160
  s_cmp_lt_u32 s3, 216
  s_cbranch_scc1 L_F1
  s_sub_u32 s21, s3, 216
  s_cmp_lt_u32 s3, 224
  s_cbranch_scc1 L_LN2
  s_sub_u32 s21, s3, 224
  s_cmp_lt_u32 s3, 248
  s_cbranch_scc1 L_F2
  s_sub_u32 s21, s3, 248
  s_branch L_FIN
L_FAIL:
  s_mov_b64 exec, -1
  s_lshl_b32 s40, s2, 8
  s_add_u32 s40, s40, s25
  s_add_u32 s40, s40, 0x70000000
  v_mov_b32 v1, 60
  v_mov_b32 v2, s40
  buffer_store_dword v2, v1, s[12:15], 0 offen
L_END:
  s_endpgm
L_LN2:
  s_load_dwordx2 s[16:17], s[0:1], 0
  s_mov_b32 s18, 4194304
  s_mov_b32 s19, 0x20000
  s_waitcnt lgkmcnt(0)
  s_mov_b32 s25, 0
  s_mov_b32 s29, 1
  s_mov_b32 s26, 0
  s_cmp_eq_u32 s20, 0
  s_cselect_b32 s31, 0, 2147483392
  s_lshl_b32 s40, s21, 8
  s_lshl_b32 s41, s20, 15
  s_add_u32 s40, s40, s41
  v_and_b32 v6, 15, v0
  v_lshl_add_u32 v1, v6, 4, s40
  v_lshrrev_b32 v6, 4, v0
  v_lshl_add_u32 v1, v6, 11, v1
  v_and_b32 v6, 3, v0
  v_lshrrev_b32 v7, 5, v0
  v_lshrrev_b32 v8, 2, v0
  s_lshl_b32 s40, s20, 10
  v_lshl_add_u32 v5, v8, 4, s40
  s_lshl_b32 s40, s21, 13
  s_lshl_b32 s41, s20, 9
  s_add_u32 s40, s40, s41
  v_and_b32 v9, 31, v0
  v_lshl_add_u32 v10, v9, 4, s40
  v_lshl_add_u32 v10, v7, 11, v10
  v_min_u32 v16, 63, v0
  v_lshlrev_b32 v16, 7, v16
  v_add_u32 v16, 1424384, v16
  s_nop 1
Lpoll_10:
  buffer_load_dword v17, v16, s[4:7], 0 offen sc1
  s_sub_u32 s24, s24, 1
  s_cbranch_scc1 L_FAIL
  s_waitcnt vmcnt(0)
  v_cmp_gt_i32 vcc, 0, v17
  s_cbranch_vccz Lpolld_11
  s_sleep 1
  s_branch Lpoll_10
Lpolld_11:
  v_lshrrev_b32 v17, 8, v17
  v_and_b32 v18, 3, v0
  v_lshl_or_b32 v17, v17, 2, v18
  s_nop 1
  v_min_u32_dpp v17, v17, v17 row_ror:8 row_mask:0xf bank_mask:0xf
  s_nop 1
  v_min_u32_dpp v17, v17, v17 row_ror:4 row_mask:0xf bank_mask:0xf
  v_mov_b32 v18, v17
  s_nop 1
  v_permlane16_swap_b32 v18, v17
  v_min_u32 v17, v17, v18
  v_mov_b32 v18, v17
  s_nop 1
  v_permlane32_swap_b32 v18, v17
  v_min_u32 v17, v17, v18
  s_nop 1
  v_min_u32_dpp v17, v17, v17 row_ror:2 row_mask:0xf bank_mask:0xf
  s_nop 1
  v_min_u32_dpp v17, v17, v17 row_ror:1 row_mask:0xf bank_mask:0xf
  s_nop 0
  v_readfirstlane_b32 s27, v17
  s_and_b32 s27, s27, 3
  s_lshl_b32 s27, s27, 13
  s_and_b32 s27, s27, 0x2000
  s_xor_b32 s27, s27, 16785408
  v_min_u32 v2, 63, v0
  v_lshlrev_b32 v2, 7, v2
  v_add_u32 v2, 1380352, v2
  s_nop 1
Lpoll_12:
  buffer_load_dword v3, v2, s[4:7], 0 offen sc1
  s_sub_u32 s24, s24, 1
  s_cbranch_scc1 L_FAIL
  s_waitcnt vmcnt(0)
  v_cmp_gt_i32 vcc, 1, v3
  s_cbranch_vccz Lpolld_13
  s_sleep 2
  s_branch Lpoll_12
Lpolld_13:
  s_mov_b32 s40, 1585152
  buffer_load_dwordx4 v[64:67], v5, s[4:7], s40 offen offset:0 sc1
  buffer_load_dwordx4 v[68:71], v5, s[4:7], s40 offen offset:256 sc1
  buffer_load_dwordx4 v[72:75], v5, s[4:7], s40 offen offset:512 sc1
  buffer_load_dwordx4 v[76:79], v5, s[4:7], s40 offen offset:768 sc1
  s_mov_b32 s40, 1589248
  buffer_load_dwordx4 v[80:83], v5, s[4:7], s40 offen offset:0 sc1
  buffer_load_dwordx4 v[84:87], v5, s[4:7], s40 offen offset:256 sc1
  buffer_load_dwordx4 v[88:91], v5, s[4:7], s40 offen offset:512 sc1
  buffer_load_dwordx4 v[92:95], v5, s[4:7], s40 offen offset:768 sc1
  s_mov_b32 s40, 1581056
  buffer_load_dwordx4 v[48:51], v5, s[4:7], s40 offen offset:0 sc1
  buffer_load_dwordx4 v[52:55], v5, s[4:7], s40 offen offset:256 sc1
  buffer_load_dwordx4 v[56:59], v5, s[4:7], s40 offen offset:512 sc1
  buffer_load_dwordx4 v[60:63], v5, s[4:7], s40 offen offset:768 sc1
  s_waitcnt vmcnt(0)
  v_lshrrev_b32 v48, 16, v48
  v_lshrrev_b32 v50, 16, v50
  v_lshrrev_b32 v52, 16, v52
  v_lshrrev_b32 v54, 16, v54
  v_lshrrev_b32 v56, 16, v56
  v_lshrrev_b32 v58, 16, v58
  v_lshrrev_b32 v60, 16, v60
  v_lshrrev_b32 v62, 16, v62
  v_add_f32 v80, 1.0, v80
  v_add_f32 v81, 1.0, v81
  v_add_f32 v82, 1.0, v82
  v_add_f32 v83, 1.0, v83
  v_add_f32 v84, 1.0, v84
  v_add_f32 v85, 1.0, v85
  v_add_f32 v86, 1.0, v86
  v_add_f32 v87, 1.0, v87
  v_add_f32 v88, 1.0, v88
  v_add_f32 v89, 1.0, v89
  v_add_f32 v90, 1.0, v90
  v_add_f32 v91, 1.0, v91
  v_add_f32 v92, 1.0, v92
  v_add_f32 v93, 1.0, v93
  v_add_f32 v94, 1.0, v94
  v_add_f32 v95, 1.0, v95
  v_min_u32 v2, 31, v0
  v_lshlrev_b32 v2, 7, v2
  v_add_u32 v2, 1409024, v2
  s_lshl_b32 s62, s21, 7
  s_add_u32 s62, s62, 1413120
  s_lshl_b32 s30, s20, 11
  v_lshl_add_u32 v11, v6, 9, s30
  v_lshl_add_u32 v11, v8, 3, v11
  s_lshl_b32 s40, s20, 5
  s_add_u32 s40, s40, 8192
  v_lshl_add_u32 v12, v6, 3, s40
  v_lshlrev_b32 v13, 3, v6
  v_add_u32 v13, 8192, v13
  s_add_u32 m0, s30, 0
  s_add_u32 s40, s26, 0
  buffer_load_dwordx4 v10, s[16:19], s40 offen nt lds
  s_add_u32 m0, s30, 1024
  s_add_u32 s40, s26, 4096
  buffer_load_dwordx4 v10, s[16:19], s40 offen nt lds
  buffer_load_dword v3, v2, s[4:7], s31 offen sc1
  s_waitcnt vmcnt(1)
  ds_read_b64 v[24:25], v11 offset:0
  ds_read_b64 v[26:27], v11 offset:128
  ds_read_b64 v[28:29], v11 offset:256
  ds_read_b64 v[30:31], v11 offset:384
  s_waitcnt lgkmcnt(0)
L_LN2_top:
  v_lshlrev_b32 v96, 16, v24
  v_and_b32 v97, 0xffff0000, v24
  v_lshlrev_b32 v98, 16, v25
  v_and_b32 v99, 0xffff0000, v25
  v_lshlrev_b32 v100, 16, v26
  v_and_b32 v101, 0xffff0000, v26
  v_lshlrev_b32 v102, 16, v27
  v_and_b32 v103, 0xffff0000, v27
  v_lshlrev_b32 v104, 16, v28
  v_and_b32 v105, 0xffff0000, v28
  v_lshlrev_b32 v106, 16, v29
  v_and_b32 v107, 0xffff0000, v29
  v_lshlrev_b32 v108, 16, v30
  v_and_b32 v109, 0xffff0000, v30
  v_lshlrev_b32 v110, 16, v31
  v_and_b32 v111, 0xffff0000, v31
  s_cmp_lg_u32 s20, 0
  s_cbranch_scc1 Lgo_14
  s_waitcnt vmcnt(0)
  v_cmp_gt_i32 vcc, s29, v3
  s_cbranch_vccz Lgo_14
  s_nop 3
Lpoll_15:
  buffer_load_dword v3, v2, s[4:7], 0 offen sc1
  s_sub_u32 s24, s24, 1
  s_cbranch_scc1 L_FAIL
  s_waitcnt vmcnt(0)
  v_cmp_gt_i32 vcc, s29, v3
  s_cbranch_vccz Lpolld_16
  s_sleep 1
  s_branch Lpoll_15
Lpolld_16:
Lgo_14:
  s_barrier
  s_add_u32 s40, s27, 0
  buffer_load_dwordx4 v[112:115], v1, s[4:7], s40 offen sc1
  s_add_u32 s40, s27, 16384
  buffer_load_dwordx4 v[116:119], v1, s[4:7], s40 offen sc1
  s_add_u32 s40, s27, 131072
  buffer_load_dwordx4 v[120:123], v1, s[4:7], s40 offen sc1
  s_add_u32 s40, s27, 147456
  buffer_load_dwordx4 v[124:127], v1, s[4:7], s40 offen sc1
  s_add_u32 s40, s27, 262144
  buffer_load_dwordx4 v[128:131], v1, s[4:7], s40 offen sc1
  s_add_u32 s40, s27, 278528
  buffer_load_dwordx4 v[132:135], v1, s[4:7], s40 offen sc1
  s_add_u32 s40, s27, 393216
  buffer_load_dwordx4 v[136:139], v1, s[4:7], s40 offen sc1
  s_add_u32 s40, s27, 409600
  buffer_load_dwordx4 v[140:143], v1, s[4:7], s40 offen sc1
  s_add_u32 m0, s30, 0
  s_add_u32 s40, s26, 65536
  buffer_load_dwordx4 v10, s[16:19], s40 offen nt lds
  s_add_u32 m0, s30, 1024
  s_add_u32 s40, s26, 69632
  buffer_load_dwordx4 v10, s[16:19], s40 offen nt lds
  s_waitcnt vmcnt(9)
  v_dot2c_f32_bf16 v96, v112, v48
  v_dot2c_f32_bf16 v97, v112, v49
  v_dot2c_f32_bf16 v98, v113, v50
  v_dot2c_f32_bf16 v99, v113, v51
  v_dot2c_f32_bf16 v100, v114, v52
  v_dot2c_f32_bf16 v101, v114, v53
  v_dot2c_f32_bf16 v102, v115, v54
  v_dot2c_f32_bf16 v103, v115, v55
  s_waitcnt vmcnt(8)
  v_dot2c_f32_bf16 v104, v116, v56
  v_dot2c_f32_bf16 v105, v116, v57
  v_dot2c_f32_bf16 v106, v117, v58
  v_dot2c_f32_bf16 v107, v117, v59
  v_dot2c_f32_bf16 v108, v118, v60
  v_dot2c_f32_bf16 v109, v118, v61
  v_dot2c_f32_bf16 v110, v119, v62
  v_dot2c_f32_bf16 v111, v119, v63
  s_waitcnt vmcnt(7)
  v_dot2c_f32_bf16 v96, v120, v48
  v_dot2c_f32_bf16 v97, v120, v49
  v_dot2c_f32_bf16 v98, v121, v50
  v_dot2c_f32_bf16 v99, v121, v51
  v_dot2c_f32_bf16 v100, v122, v52
  v_dot2c_f32_bf16 v101, v122, v53
  v_dot2c_f32_bf16 v102, v123, v54
  v_dot2c_f32_bf16 v103, v123, v55
  s_waitcnt vmcnt(6)
  v_dot2c_f32_bf16 v104, v124, v56
  v_dot2c_f32_bf16 v105, v124, v57
  v_dot2c_f32_bf16 v106, v125, v58
  v_dot2c_f32_bf16 v107, v125, v59
  v_dot2c_f32_bf16 v108, v126, v60
  v_dot2c_f32_bf16 v109, v126, v61
  v_dot2c_f32_bf16 v110, v127, v62
  v_dot2c_f32_bf16 v111, v127, v63
  s_waitcnt vmcnt(5)
  v_dot2c_f32_bf16 v96, v128, v48
  v_dot2c_f32_bf16 v97, v128, v49
  v_dot2c_f32_bf16 v98, v129, v50
  v_dot2c_f32_bf16 v99, v129, v51
  v_dot2c_f32_bf16 v100, v130, v52
  v_dot2c_f32_bf16 v101, v130, v53
  v_dot2c_f32_bf16 v102, v131, v54
  v_dot2c_f32_bf16 v103, v131, v55
  s_waitcnt vmcnt(4)
  v_dot2c_f32_bf16 v104, v132, v56
  v_dot2c_f32_bf16 v105, v132, v57
  v_dot2c_f32_bf16 v106, v133, v58
  v_dot2c_f32_bf16 v107, v133, v59
  v_dot2c_f32_bf16 v108, v134, v60
  v_dot2c_f32_bf16 v109, v134, v61
  v_dot2c_f32_bf16 v110, v135, v62
  v_dot2c_f32_bf16 v111, v135, v63
  s_waitcnt vmcnt(3)
  v_dot2c_f32_bf16 v96, v136, v48
  v_dot2c_f32_bf16 v97, v136, v49
  v_dot2c_f32_bf16 v98, v137, v50
  v_dot2c_f32_bf16 v99, v137, v51
  v_dot2c_f32_bf16 v100, v138, v52
  v_dot2c_f32_bf16 v101, v138, v53
  v_dot2c_f32_bf16 v102, v139, v54
  v_dot2c_f32_bf16 v103, v139, v55
  s_waitcnt vmcnt(2)
  v_dot2c_f32_bf16 v104, v140, v56
  v_dot2c_f32_bf16 v105, v140, v57
  v_dot2c_f32_bf16 v106, v141, v58
  v_dot2c_f32_bf16 v107, v141, v59
  v_dot2c_f32_bf16 v108, v142, v60
  v_dot2c_f32_bf16 v109, v142, v61
  v_dot2c_f32_bf16 v110, v143, v62
  v_dot2c_f32_bf16 v111, v143, v63
  s_nop 2
  v_pk_add_f32 v[32:33], v[96:97], v[98:99]
  v_pk_add_f32 v[32:33], v[32:33], v[100:101]
  v_pk_add_f32 v[32:33], v[32:33], v[102:103]
  v_pk_add_f32 v[32:33], v[32:33], v[104:105]
  v_pk_add_f32 v[32:33], v[32:33], v[106:107]
  v_pk_add_f32 v[32:33], v[32:33], v[108:109]
  v_pk_add_f32 v[32:33], v[32:33], v[110:111]
  v_add_f32 v32, v32, v33
  s_nop 1
  v_add_f32_dpp v32, v32, v32 row_ror:4 row_mask:0xf bank_mask:0xf
  s_nop 1
  v_add_f32_dpp v32, v32, v32 row_ror:8 row_mask:0xf bank_mask:0xf
  v_mov_b32 v33, v32
  s_nop 1
  v_permlane16_swap_b32 v33, v32
  v_add_f32 v32, v32, v33
  v_mov_b32 v33, v32
  s_nop 1
  v_permlane32_swap_b32 v33, v32
  v_add_f32 v32, v32, v33
  v_mul_f32 v32, 0x3b800000, v32
  v_pk_add_f32 v[112:113], v[96:97], v[32:33] op_sel_hi:[1,0] neg_lo:[0,1] neg_hi:[0,1]
  v_pk_add_f32 v[114:115], v[98:99], v[32:33] op_sel_hi:[1,0] neg_lo:[0,1] neg_hi:[0,1]
  v_pk_add_f32 v[116:117], v[100:101], v[32:33] op_sel_hi:[1,0] neg_lo:[0,1] neg_hi:[0,1]
  v_pk_add_f32 v[118:119], v[102:103], v[32:33] op_sel_hi:[1,0] neg_lo:[0,1] neg_hi:[0,1]
  v_pk_add_f32 v[120:121], v[104:105], v[32:33] op_sel_hi:[1,0] neg_lo:[0,1] neg_hi:[0,1]
  v_pk_add_f32 v[122:123], v[106:107], v[32:33] op_sel_hi:[1,0] neg_lo:[0,1] neg_hi:[0,1]
  v_pk_add_f32 v[124:125], v[108:109], v[32:33] op_sel_hi:[1,0] neg_lo:[0,1] neg_hi:[0,1]
  v_pk_add_f32 v[126:127], v[110:111], v[32:33] op_sel_hi:[1,0] neg_lo:[0,1] neg_hi:[0,1]
  v_pk_mul_f32 v[34:35], v[112:113], v[112:113]
  v_pk_fma_f32 v[34:35], v[114:115], v[114:115], v[34:35]
  v_pk_fma_f32 v[34:35], v[116:117], v[116:117], v[34:35]
  v_pk_fma_f32 v[34:35], v[118:119], v[118:119], v[34:35]
  v_pk_fma_f32 v[34:35], v[120:121], v[120:121], v[34:35]
  v_pk_fma_f32 v[34:35], v[122:123], v[122:123], v[34:35]
  v_pk_fma_f32 v[34:35], v[124:125], v[124:125], v[34:35]
  v_pk_fma_f32 v[34:35], v[126:127], v[126:127], v[34:35]
  v_add_f32 v34, v34, v35
  s_nop 1
  v_add_f32_dpp v34, v34, v34 row_ror:4 row_mask:0xf bank_mask:0xf
  s_nop 1
  v_add_f32_dpp v34, v34, v34 row_ror:8 row_mask:0xf bank_mask:0xf
  v_mov_b32 v35, v34
  s_nop 1
  v_permlane16_swap_b32 v35, v34
  v_add_f32 v34, v34, v35
  v_mov_b32 v35, v34
  s_nop 1
  v_permlane32_swap_b32 v35, v34
  v_add_f32 v34, v34, v35
  v_mov_b32 v33, v34
  ds_write_b64 v12, v[32:33]
  v_cvt_pk_bf16_f32 v16, v96, v97
  v_cvt_pk_bf16_f32 v17, v98, v99
  v_cvt_pk_bf16_f32 v18, v100, v101
  v_cvt_pk_bf16_f32 v19, v102, v103
  v_cvt_pk_bf16_f32 v20, v104, v105
  v_cvt_pk_bf16_f32 v21, v106, v107
  v_cvt_pk_bf16_f32 v22, v108, v109
  v_cvt_pk_bf16_f32 v23, v110, v111
  s_waitcnt lgkmcnt(0)
  s_barrier
  ds_read2_b64 v[36:39], v13 offset0:0 offset1:4
  ds_read2_b64 v[40:43], v13 offset0:8 offset1:12
  s_add_u32 s40, s27, 1048576
  buffer_store_dwordx4 v[16:19], v1, s[4:7], s40 offen sc1
  s_add_u32 s40, s27, 1064960
  buffer_store_dwordx4 v[20:23], v1, s[4:7], s40 offen sc1
  s_waitcnt lgkmcnt(0)
  v_pk_add_f32 v[34:35], v[36:37], v[38:39]
  v_pk_add_f32 v[44:45], v[40:41], v[42:43]
  v_pk_add_f32 v[34:35], v[34:35], v[44:45]
  v_mul_f32 v34, 0x3e800000, v34
  v_mul_f32 v35, 0x3b800000, v35
  v_sub_f32 v36, v36, v34
  v_sub_f32 v38, v38, v34
  v_sub_f32 v40, v40, v34
  v_sub_f32 v42, v42, v34
  v_fmac_f32 v35, v36, v36
  v_fmac_f32 v35, v38, v38
  v_fmac_f32 v35, v40, v40
  v_fmac_f32 v35, v42, v42
  v_mul_f32 v35, 0x3e800000, v35
  v_add_f32 v35, 0x3727c5ac, v35
  v_rsq_f32 v44, v35
  v_sub_f32 v32, v32, v34
  v_mul_f32 v32, v32, v44
  v_pk_fma_f32 v[112:113], v[112:113], v[44:45], v[32:33] op_sel_hi:[1,0,0]
  v_pk_fma_f32 v[114:115], v[114:115], v[44:45], v[32:33] op_sel_hi:[1,0,0]
  v_pk_fma_f32 v[116:117], v[116:117], v[44:45], v[32:33] op_sel_hi:[1,0,0]
  v_pk_fma_f32 v[118:119], v[118:119], v[44:45], v[32:33] op_sel_hi:[1,0,0]
  v_pk_fma_f32 v[112:113], v[112:113], v[80:81], v[64:65]
  v_pk_fma_f32 v[114:115], v[114:115], v[82:83], v[66:67]
  v_pk_fma_f32 v[116:117], v[116:117], v[84:85], v[68:69]
  v_pk_fma_f32 v[118:119], v[118:119], v[86:87], v[70:71]
  v_cvt_pk_bf16_f32 v128, v112, v113
  v_cvt_pk_bf16_f32 v129, v114, v115
  v_cvt_pk_bf16_f32 v130, v116, v117
  v_cvt_pk_bf16_f32 v131, v118, v119
  s_add_u32 s40, s27, 917504
  buffer_store_dwordx4 v[128:131], v1, s[4:7], s40 offen sc1
  v_pk_fma_f32 v[120:121], v[120:121], v[44:45], v[32:33] op_sel_hi:[1,0,0]
  v_pk_fma_f32 v[122:123], v[122:123], v[44:45], v[32:33] op_sel_hi:[1,0,0]
  v_pk_fma_f32 v[124:125], v[124:125], v[44:45], v[32:33] op_sel_hi:[1,0,0]
  v_pk_fma_f32 v[126:127], v[126:127], v[44:45], v[32:33] op_sel_hi:[1,0,0]
  v_pk_fma_f32 v[120:121], v[120:121], v[88:89], v[72:73]
  v_pk_fma_f32 v[122:123], v[122:123], v[90:91], v[74:75]
  v_pk_fma_f32 v[124:125], v[124:125], v[92:93], v[76:77]
  v_pk_fma_f32 v[126:127], v[126:127], v[94:95], v[78:79]
  v_cvt_pk_bf16_f32 v132, v120, v121
  v_cvt_pk_bf16_f32 v133, v122, v123
  v_cvt_pk_bf16_f32 v134, v124, v125
  v_cvt_pk_bf16_f32 v135, v126, v127
  s_add_u32 s40, s27, 933888
  buffer_store_dwordx4 v[132:135], v1, s[4:7], s40 offen sc1
  buffer_load_dword v3, v2, s[4:7], s31 offen sc1
  s_waitcnt vmcnt(5)
  ds_read_b64 v[24:25], v11 offset:0
  ds_read_b64 v[26:27], v11 offset:128
  ds_read_b64 v[28:29], v11 offset:256
  ds_read_b64 v[30:31], v11 offset:384
  s_waitcnt vmcnt(1) lgkmcnt(0)
  s_barrier
  s_cmp_lg_u32 s20, 0
  s_cbranch_scc1 Lnosig_17
  s_mov_b32 s63, s29
  s_atomic_smax s63, s[4:5], s62 glc
Lnosig_17:
  s_add_u32 s25, s25, 1
  s_add_u32 s29, s29, 1
  s_add_u32 s26, s26, 65536
  s_add_u32 s27, s27, 2097152
  s_xor_b32 s27, s27, 0x2000
  s_cmp_lt_u32 s25, 64
  s_cbranch_scc1 L_LN2_top
  s_branch L_END
L_FIN:
  s_load_dwordx2 s[16:17], s[0:1], 104
  s_mov_b32 s18, 4194304
  s_mov_b32 s19, 0x20000
  s_waitcnt lgkmcnt(0)
  s_mov_b32 s25, 0
  s_mov_b32 s29, 1
  s_mov_b32 s26, 0
  s_cmp_eq_u32 s20, 0
  s_cselect_b32 s31, 0, 2147483392
  s_lshl_b32 s40, s21, 8
  s_lshl_b32 s41, s20, 15
  s_add_u32 s40, s40, s41
  v_and_b32 v6, 15, v0
  v_lshl_add_u32 v1, v6, 4, s40
  v_lshrrev_b32 v6, 4, v0
  v_lshl_add_u32 v1, v6, 11, v1
  v_and_b32 v6, 3, v0
  v_lshrrev_b32 v7, 5, v0
  v_lshrrev_b32 v8, 2, v0
  s_lshl_b32 s40, s20, 10
  v_lshl_add_u32 v5, v8, 4, s40
  s_lshl_b32 s40, s21, 13
  s_lshl_b32 s41, s20, 9
  s_add_u32 s40, s40, s41
  v_and_b32 v9, 31, v0
  v_lshl_add_u32 v10, v9, 4, s40
  v_lshl_add_u32 v10, v7, 11, v10
  v_min_u32 v16, 63, v0
  v_lshlrev_b32 v16, 7, v16
  v_add_u32 v16, 1424384, v16
  s_nop 1
Lpoll_18:
  buffer_load_dword v17, v16, s[4:7], 0 offen sc1
  s_sub_u32 s24, s24, 1
  s_cbranch_scc1 L_FAIL
  s_waitcnt vmcnt(0)
  v_cmp_gt_i32 vcc, 0, v17
  s_cbranch_vccz Lpolld_19
  s_sleep 1
  s_branch Lpoll_18
Lpolld_19:
  v_lshrrev_b32 v17, 8, v17
  v_and_b32 v18, 3, v0
  v_lshl_or_b32 v17, v17, 2, v18
  s_nop 1
  v_min_u32_dpp v17, v17, v17 row_ror:8 row_mask:0xf bank_mask:0xf
  s_nop 1
  v_min_u32_dpp v17, v17, v17 row_ror:4 row_mask:0xf bank_mask:0xf
  v_mov_b32 v18, v17
  s_nop 1
  v_permlane16_swap_b32 v18, v17
  v_min_u32 v17, v17, v18
  v_mov_b32 v18, v17
  s_nop 1
  v_permlane32_swap_b32 v18, v17
  v_min_u32 v17, v17, v18
  s_nop 1
  v_min_u32_dpp v17, v17, v17 row_ror:2 row_mask:0xf bank_mask:0xf
  s_nop 1
  v_min_u32_dpp v17, v17, v17 row_ror:1 row_mask:0xf bank_mask:0xf
  s_nop 0
  v_readfirstlane_b32 s27, v17
  s_and_b32 s27, s27, 3
  s_lshl_b32 s27, s27, 13
  s_and_b32 s27, s27, 0x2000
  s_xor_b32 s27, s27, 16785408
  v_min_u32 v2, 63, v0
  v_lshlrev_b32 v2, 7, v2
  v_add_u32 v2, 1380352, v2
  s_nop 1
Lpoll_20:
  buffer_load_dword v3, v2, s[4:7], 0 offen sc1
  s_sub_u32 s24, s24, 1
  s_cbranch_scc1 L_FAIL
  s_waitcnt vmcnt(0)
  v_cmp_gt_i32 vcc, 1, v3
  s_cbranch_vccz Lpolld_21
  s_sleep 2
  s_branch Lpoll_20
Lpolld_21:
  s_mov_b32 s40, 1593344
  buffer_load_dwordx4 v[48:51], v5, s[4:7], s40 offen offset:0 sc1
  buffer_load_dwordx4 v[52:55], v5, s[4:7], s40 offen offset:256 sc1
  buffer_load_dwordx4 v[56:59], v5, s[4:7], s40 offen offset:512 sc1
  buffer_load_dwordx4 v[60:63], v5, s[4:7], s40 offen offset:768 sc1
  s_waitcnt vmcnt(0)
  v_lshrrev_b32 v48, 16, v48
  v_lshrrev_b32 v50, 16, v50
  v_lshrrev_b32 v52, 16, v52
  v_lshrrev_b32 v54, 16, v54
  v_lshrrev_b32 v56, 16, v56
  v_lshrrev_b32 v58, 16, v58
  v_lshrrev_b32 v60, 16, v60
  v_lshrrev_b32 v62, 16, v62
  v_min_u32 v2, 23, v0
  v_lshlrev_b32 v2, 7, v2
  v_add_u32 v2, 1421312, v2
  s_mul_i32 s30, s20, 2176
  v_mul_u32_u24 v11, 544, v6
  v_lshl_add_u32 v11, v8, 3, v11
  v_add_u32 v11, s30, v11
  v_mul_u32_u24 v12, 544, v7
  v_lshl_add_u32 v12, v9, 4, v12
  v_add_u32 v12, s30, v12
  buffer_load_dword v3, v2, s[4:7], s31 offen sc1
  s_nop 0
L_FIN_top:
  s_cmp_lg_u32 s20, 0
  s_cbranch_scc1 Lgo_22
  s_waitcnt vmcnt(0)
  v_cmp_gt_i32 vcc, s29, v3
  s_cbranch_vccz Lgo_22
  s_nop 3
Lpoll_23:
  buffer_load_dword v3, v2, s[4:7], 0 offen sc1
  s_sub_u32 s24, s24, 1
  s_cbranch_scc1 L_FAIL
  s_waitcnt vmcnt(0)
  v_cmp_gt_i32 vcc, s29, v3
  s_cbranch_vccz Lpolld_24
  s_sleep 1
  s_branch Lpoll_23
Lpolld_24:
Lgo_22:
  s_barrier
  s_add_u32 s40, s27, 1048576
  buffer_load_dwordx4 v[16:19], v1, s[4:7], s40 offen sc1
  s_add_u32 s40, s27, 1064960
  buffer_load_dwordx4 v[20:23], v1, s[4:7], s40 offen sc1
  s_add_u32 s40, s27, 524288
  buffer_load_dwordx4 v[112:115], v1, s[4:7], s40 offen sc1
  s_add_u32 s40, s27, 540672
  buffer_load_dwordx4 v[116:119], v1, s[4:7], s40 offen sc1
  s_add_u32 s40, s27, 655360
  buffer_load_dwordx4 v[120:123], v1, s[4:7], s40 offen sc1
  s_add_u32 s40, s27, 671744
  buffer_load_dwordx4 v[124:127], v1, s[4:7], s40 offen sc1
  s_add_u32 s40, s27, 786432
  buffer_load_dwordx4 v[128:131], v1, s[4:7], s40 offen sc1
  s_add_u32 s40, s27, 802816
  buffer_load_dwordx4 v[132:135], v1, s[4:7], s40 offen sc1
  s_waitcnt vmcnt(6)
  v_lshlrev_b32 v96, 16, v16
  v_and_b32 v97, 0xffff0000, v16
  v_lshlrev_b32 v98, 16, v17
  v_and_b32 v99, 0xffff0000, v17
  v_lshlrev_b32 v100, 16, v18
  v_and_b32 v101, 0xffff0000, v18
  v_lshlrev_b32 v102, 16, v19
  v_and_b32 v103, 0xffff0000, v19
  v_lshlrev_b32 v104, 16, v20
  v_and_b32 v105, 0xffff0000, v20
  v_lshlrev_b32 v106, 16, v21
  v_and_b32 v107, 0xffff0000, v21
  v_lshlrev_b32 v108, 16, v22
  v_and_b32 v109, 0xffff0000, v22
  v_lshlrev_b32 v110, 16, v23
  v_and_b32 v111, 0xffff0000, v23
  s_waitcnt vmcnt(5)
  v_dot2c_f32_bf16 v96, v112, v48
  v_dot2c_f32_bf16 v97, v112, v49
  v_dot2c_f32_bf16 v98, v113, v50
  v_dot2c_f32_bf16 v99, v113, v51
  v_dot2c_f32_bf16 v100, v114, v52
  v_dot2c_f32_bf16 v101, v114, v53
  v_dot2c_f32_bf16 v102, v115, v54
  v_dot2c_f32_bf16 v103, v115, v55
  s_waitcnt vmcnt(4)
  v_dot2c_f32_bf16 v104, v116, v56
  v_dot2c_f32_bf16 v105, v116, v57
  v_dot2c_f32_bf16 v106, v117, v58
  v_dot2c_f32_bf16 v107, v117, v59
  v_dot2c_f32_bf16 v108, v118, v60
  v_dot2c_f32_bf16 v109, v118, v61
  v_dot2c_f32_bf16 v110, v119, v62
  v_dot2c_f32_bf16 v111, v119, v63
  s_waitcnt vmcnt(3)
  v_dot2c_f32_bf16 v96, v120, v48
  v_dot2c_f32_bf16 v97, v120, v49
  v_dot2c_f32_bf16 v98, v121, v50
  v_dot2c_f32_bf16 v99, v121, v51
  v_dot2c_f32_bf16 v100, v122, v52
  v_dot2c_f32_bf16 v101, v122, v53
  v_dot2c_f32_bf16 v102, v123, v54
  v_dot2c_f32_bf16 v103, v123, v55
  s_waitcnt vmcnt(2)
  v_dot2c_f32_bf16 v104, v124, v56
  v_dot2c_f32_bf16 v105, v124, v57
  v_dot2c_f32_bf16 v106, v125, v58
  v_dot2c_f32_bf16 v107, v125, v59
  v_dot2c_f32_bf16 v108, v126, v60
  v_dot2c_f32_bf16 v109, v126, v61
  v_dot2c_f32_bf16 v110, v127, v62
  v_dot2c_f32_bf16 v111, v127, v63
  s_waitcnt vmcnt(1)
  v_dot2c_f32_bf16 v96, v128, v48
  v_dot2c_f32_bf16 v97, v128, v49
  v_dot2c_f32_bf16 v98, v129, v50
  v_dot2c_f32_bf16 v99, v129, v51
  v_dot2c_f32_bf16 v100, v130, v52
  v_dot2c_f32_bf16 v101, v130, v53
  v_dot2c_f32_bf16 v102, v131, v54
  v_dot2c_f32_bf16 v103, v131, v55
  s_waitcnt vmcnt(0)
  v_dot2c_f32_bf16 v104, v132, v56
  v_dot2c_f32_bf16 v105, v132, v57
  v_dot2c_f32_bf16 v106, v133, v58
  v_dot2c_f32_bf16 v107, v133, v59
  v_dot2c_f32_bf16 v108, v134, v60
  v_dot2c_f32_bf16 v109, v134, v61
  v_dot2c_f32_bf16 v110, v135, v62
  v_dot2c_f32_bf16 v111, v135, v63
  s_nop 2
  buffer_load_dword v3, v2, s[4:7], s31 offen sc1
  v_cvt_pk_bf16_f32 v16, v96, v97
  v_cvt_pk_bf16_f32 v17, v98, v99
  v_cvt_pk_bf16_f32 v18, v100, v101
  v_cvt_pk_bf16_f32 v19, v102, v103
  v_cvt_pk_bf16_f32 v20, v104, v105
  v_cvt_pk_bf16_f32 v21, v106, v107
  v_cvt_pk_bf16_f32 v22, v108, v109
  v_cvt_pk_bf16_f32 v23, v110, v111
  ds_write_b64 v11, v[16:17] offset:0
  ds_write_b64 v11, v[18:19] offset:128
  ds_write_b64 v11, v[20:21] offset:256
  ds_write_b64 v11, v[22:23] offset:384
  ds_read_b128 v[112:115], v12 offset:0
  ds_read_b128 v[116:119], v12 offset:1088
  s_add_u32 s40, s26, 0
  s_waitcnt lgkmcnt(1)
  buffer_store_dwordx4 v[112:115], v10, s[16:19], s40 offen
  s_add_u32 s40, s26, 4096
  s_waitcnt lgkmcnt(0)
  buffer_store_dwordx4 v[116:119], v10, s[16:19], s40 offen
  s_add_u32 s25, s25, 1
  s_add_u32 s29, s29, 1
  s_add_u32 s26, s26, 65536
  s_add_u32 s27, s27, 2097152
  s_xor_b32 s27, s27, 0x2000
  s_cmp_lt_u32 s25, 64
  s_cbranch_scc1 L_FIN_top
  s_branch L_END
L_QKV:
  v_lshrrev_b32 v60, 3, v0
  v_and_b32 v61, 6, v60
  v_xor_b32 v61, v61, v0
  v_and_b32 v61, 7, v61
  v_lshlrev_b32 v61, 4, v61
  v_lshl_add_u32 v1, v60, 11, v61
  s_lshl_b32 s40, s20, 14
  v_add_u32 v1, s40, v1
  s_lshl_b32 s32, s20, 10
  v_and_b32 v60, 6, v0
  v_lshrrev_b32 v61, 4, v0
  v_xor_b32 v60, v60, v61
  v_lshlrev_b32 v60, 4, v60
  v_and_b32 v61, 15, v0
  v_lshl_add_u32 v77, v61, 7, v60
  v_xor_b32 v78, 64, v77
  s_and_b32 s43, s21, 1
  s_lshr_b32 s44, s21, 1
  s_lshl_b32 s44, s44, 8
  s_add_u32 s45, s44, 128
  s_lshl_b32 s46, s43, 7
  s_add_u32 s46, s46, s44
  s_load_dwordx4 s[48:51], s[0:1], 16
  s_waitcnt lgkmcnt(0)
  s_cmp_eq_u32 s43, 0
  s_cselect_b32 s8, s48, s50
  s_cselect_b32 s9, s49, s51
  s_mov_b32 s10, 8388608
  s_mov_b32 s11, 0x20000
  v_bfe_u32 v4, v0, 5, 1
  v_mul_u32_u24 v4, 32768, v4
  v_bfe_u32 v5, v0, 4, 1
  v_mul_u32_u24 v5, 16384, v5
  v_add_u32 v4, v4, v5
  v_bfe_u32 v5, v0, 3, 1
  v_mul_u32_u24 v5, 8192, v5
  v_add_u32 v4, v4, v5
  v_lshrrev_b32 v5, 3, v0
  v_and_b32 v5, 6, v5
  v_xor_b32 v5, v5, v0
  v_and_b32 v5, 7, v5
  v_lshl_add_u32 v4, v5, 4, v4
  s_lshr_b32 s40, s20, 1
  s_mul_i32 s40, s40, 2097152
  s_and_b32 s41, s20, 1
  s_mul_i32 s41, s41, 65536
  s_add_u32 s40, s40, s41
  v_add_u32 v4, s40, v4
  v_bfe_u32 v5, v0, 3, 2
  v_xor_b32 v5, s20, v5
  v_lshlrev_b32 v5, 5, v5
  v_lshrrev_b32 v6, 2, v0
  v_lshl_add_u32 v6, v6, 7, v5
  v_and_b32 v5, 3, v0
  v_lshl_add_u32 v6, v5, 3, v6
  v_add_u32 v7, 0x10000, v6
  v_add_u32 v8, s44, v4
  v_add_u32 v9, s45, v4
  v_add_u32 v10, s46, v4
  s_lshl_b32 s41, s20, 10
  s_add_u32 m0, s41, 0
  s_mov_b32 s42, 0
  buffer_load_dwordx4 v8, s[8:11], s42 offen lds
  s_add_u32 m0, s41, 4096
  s_mov_b32 s42, 0
  buffer_load_dwordx4 v9, s[8:11], s42 offen lds
  s_add_u32 m0, s41, 8192
  s_mov_b32 s42, 131072
  buffer_load_dwordx4 v8, s[8:11], s42 offen lds
  s_add_u32 m0, s41, 12288
  s_mov_b32 s42, 131072
  buffer_load_dwordx4 v9, s[8:11], s42 offen lds
  s_add_u32 m0, s41, 16384
  s_mov_b32 s42, 262144
  buffer_load_dwordx4 v8, s[8:11], s42 offen lds
  s_add_u32 m0, s41, 20480
  s_mov_b32 s42, 262144
  buffer_load_dwordx4 v9, s[8:11], s42 offen lds
  s_add_u32 m0, s41, 24576
  s_mov_b32 s42, 393216
  buffer_load_dwordx4 v8, s[8:11], s42 offen lds
  s_add_u32 m0, s41, 28672
  s_mov_b32 s42, 393216
  buffer_load_dwordx4 v9, s[8:11], s42 offen lds
  s_add_u32 m0, s41, 32768
  s_mov_b32 s42, 524288
  buffer_load_dwordx4 v8, s[8:11], s42 offen lds
  s_add_u32 m0, s41, 36864
  s_mov_b32 s42, 524288
  buffer_load_dwordx4 v9, s[8:11], s42 offen lds
  s_add_u32 m0, s41, 40960
  s_mov_b32 s42, 655360
  buffer_load_dwordx4 v8, s[8:11], s42 offen lds
  s_add_u32 m0, s41, 45056
  s_mov_b32 s42, 655360
  buffer_load_dwordx4 v9, s[8:11], s42 offen lds
  s_add_u32 m0, s41, 49152
  s_mov_b32 s42, 786432
  buffer_load_dwordx4 v8, s[8:11], s42 offen lds
  s_add_u32 m0, s41, 53248
  s_mov_b32 s42, 786432
  buffer_load_dwordx4 v9, s[8:11], s42 offen lds
  s_add_u32 m0, s41, 57344
  s_mov_b32 s42, 917504
  buffer_load_dwordx4 v8, s[8:11], s42 offen lds
  s_add_u32 m0, s41, 61440
  s_mov_b32 s42, 917504
  buffer_load_dwordx4 v9, s[8:11], s42 offen lds
  s_add_u32 m0, s41, 65536
  s_mov_b32 s42, 1048576
  buffer_load_dwordx4 v8, s[8:11], s42 offen lds
  s_add_u32 m0, s41, 69632
  s_mov_b32 s42, 1048576
  buffer_load_dwordx4 v9, s[8:11], s42 offen lds
  s_add_u32 m0, s41, 73728
  s_mov_b32 s42, 1179648
  buffer_load_dwordx4 v8, s[8:11], s42 offen lds
  s_add_u32 m0, s41, 77824
  s_mov_b32 s42, 1179648
  buffer_load_dwordx4 v9, s[8:11], s42 offen lds
  s_add_u32 m0, s41, 81920
  s_mov_b32 s42, 1310720
  buffer_load_dwordx4 v8, s[8:11], s42 offen lds
  s_add_u32 m0, s41, 86016
  s_mov_b32 s42, 1310720
  buffer_load_dwordx4 v9, s[8:11], s42 offen lds
  s_add_u32 m0, s41, 90112
  s_mov_b32 s42, 1441792
  buffer_load_dwordx4 v8, s[8:11], s42 offen lds
  s_add_u32 m0, s41, 94208
  s_mov_b32 s42, 1441792
  buffer_load_dwordx4 v9, s[8:11], s42 offen lds
  s_add_u32 m0, s41, 98304
  s_mov_b32 s42, 1572864
  buffer_load_dwordx4 v8, s[8:11], s42 offen lds
  s_add_u32 m0, s41, 102400
  s_mov_b32 s42, 1572864
  buffer_load_dwordx4 v9, s[8:11], s42 offen lds
  s_add_u32 m0, s41, 106496
  s_mov_b32 s42, 1703936
  buffer_load_dwordx4 v8, s[8:11], s42 offen lds
  s_add_u32 m0, s41, 110592
  s_mov_b32 s42, 1703936
  buffer_load_dwordx4 v9, s[8:11], s42 offen lds
  s_waitcnt vmcnt(24) lgkmcnt(0)
  s_barrier
  s_add_u32 m0, s41, 114688
  s_mov_b32 s42, 1835008
  buffer_load_dwordx4 v8, s[8:11], s42 offen lds
  s_add_u32 m0, s41, 118784
  s_mov_b32 s42, 1835008
  buffer_load_dwordx4 v9, s[8:11], s42 offen lds
  s_add_u32 m0, s41, 122880
  s_mov_b32 s42, 1966080
  buffer_load_dwordx4 v8, s[8:11], s42 offen lds
  s_add_u32 m0, s41, 126976
  s_mov_b32 s42, 1966080
  buffer_load_dwordx4 v9, s[8:11], s42 offen lds
  ds_read_b64_tr_b16 a[0:1], v6 offset:0
  ds_read_b64_tr_b16 a[2:3], v6 offset:2048
  ds_read_b64_tr_b16 a[128:129], v6 offset:4096
  ds_read_b64_tr_b16 a[130:131], v6 offset:6144
  ds_read_b64_tr_b16 a[4:5], v6 offset:8192
  ds_read_b64_tr_b16 a[6:7], v6 offset:10240
  ds_read_b64_tr_b16 a[132:133], v6 offset:12288
  ds_read_b64_tr_b16 a[134:135], v6 offset:14336
  s_waitcnt vmcnt(24) lgkmcnt(0)
  s_barrier
  s_add_u32 m0, s41, 0
  s_mov_b32 s42, 4194304
  buffer_load_dwordx4 v8, s[8:11], s42 offen lds
  s_add_u32 m0, s41, 4096
  s_mov_b32 s42, 4194304
  buffer_load_dwordx4 v9, s[8:11], s42 offen lds
  s_add_u32 m0, s41, 8192
  s_mov_b32 s42, 4325376
  buffer_load_dwordx4 v8, s[8:11], s42 offen lds
  s_add_u32 m0, s41, 12288
  s_mov_b32 s42, 4325376
  buffer_load_dwordx4 v9, s[8:11], s42 offen lds
  ds_read_b64_tr_b16 a[8:9], v6 offset:16384
  ds_read_b64_tr_b16 a[10:11], v6 offset:18432
  ds_read_b64_tr_b16 a[136:137], v6 offset:20480
  ds_read_b64_tr_b16 a[138:139], v6 offset:22528
  ds_read_b64_tr_b16 a[12:13], v6 offset:24576
  ds_read_b64_tr_b16 a[14:15], v6 offset:26624
  ds_read_b64_tr_b16 a[140:141], v6 offset:28672
  ds_read_b64_tr_b16 a[142:143], v6 offset:30720
  s_waitcnt vmcnt(24) lgkmcnt(0)
  s_barrier
  s_add_u32 m0, s41, 16384
  s_mov_b32 s42, 4456448
  buffer_load_dwordx4 v8, s[8:11], s42 offen lds
  s_add_u32 m0, s41, 20480
  s_mov_b32 s42, 4456448
  buffer_load_dwordx4 v9, s[8:11], s42 offen lds
  s_add_u32 m0, s41, 24576
  s_mov_b32 s42, 4587520
  buffer_load_dwordx4 v8, s[8:11], s42 offen lds
  s_add_u32 m0, s41, 28672
  s_mov_b32 s42, 4587520
  buffer_load_dwordx4 v9, s[8:11], s42 offen lds
  ds_read_b64_tr_b16 a[16:17], v6 offset:32768
  ds_read_b64_tr_b16 a[18:19], v6 offset:34816
  ds_read_b64_tr_b16 a[144:145], v6 offset:36864
  ds_read_b64_tr_b16 a[146:147], v6 offset:38912
  ds_read_b64_tr_b16 a[20:21], v6 offset:40960
  ds_read_b64_tr_b16 a[22:23], v6 offset:43008
  ds_read_b64_tr_b16 a[148:149], v6 offset:45056
  ds_read_b64_tr_b16 a[150:151], v6 offset:47104
  s_waitcnt vmcnt(24) lgkmcnt(0)
  s_barrier
  s_add_u32 m0, s41, 32768
  s_mov_b32 s42, 4718592
  buffer_load_dwordx4 v8, s[8:11], s42 offen lds
  s_add_u32 m0, s41, 36864
  s_mov_b32 s42, 4718592
  buffer_load_dwordx4 v9, s[8:11], s42 offen lds
  s_add_u32 m0, s41, 40960
  s_mov_b32 s42, 4849664
  buffer_load_dwordx4 v8, s[8:11], s42 offen lds
  s_add_u32 m0, s41, 45056
  s_mov_b32 s42, 4849664
  buffer_load_dwordx4 v9, s[8:11], s42 offen lds
  ds_read_b64_tr_b16 a[24:25], v6 offset:49152
  ds_read_b64_tr_b16 a[26:27], v6 offset:51200
  ds_read_b64_tr_b16 a[152:153], v6 offset:53248
  ds_read_b64_tr_b16 a[154:155], v6 offset:55296
  ds_read_b64_tr_b16 a[28:29], v6 offset:57344
  ds_read_b64_tr_b16 a[30:31], v6 offset:59392
  ds_read_b64_tr_b16 a[156:157], v6 offset:61440
  ds_read_b64_tr_b16 a[158:159], v6 offset:63488
  s_waitcnt vmcnt(24) lgkmcnt(0)
  s_barrier
  s_add_u32 m0, s41, 49152
  s_mov_b32 s42, 4980736
  buffer_load_dwordx4 v8, s[8:11], s42 offen lds
  s_add_u32 m0, s41, 53248
  s_mov_b32 s42, 4980736
  buffer_load_dwordx4 v9, s[8:11], s42 offen lds
  s_add_u32 m0, s41, 57344
  s_mov_b32 s42, 5111808
  buffer_load_dwordx4 v8, s[8:11], s42 offen lds
  s_add_u32 m0, s41, 61440
  s_mov_b32 s42, 5111808
  buffer_load_dwordx4 v9, s[8:11], s42 offen lds
  ds_read_b64_tr_b16 a[32:33], v7 offset:0
  ds_read_b64_tr_b16 a[34:35], v7 offset:2048
  ds_read_b64_tr_b16 a[160:161], v7 offset:4096
  ds_read_b64_tr_b16 a[162:163], v7 offset:6144
  ds_read_b64_tr_b16 a[36:37], v7 offset:8192
  ds_read_b64_tr_b16 a[38:39], v7 offset:10240
  ds_read_b64_tr_b16 a[164:165], v7 offset:12288
  ds_read_b64_tr_b16 a[166:167], v7 offset:14336
  s_waitcnt vmcnt(24) lgkmcnt(0)
  s_barrier
  s_add_u32 m0, s41, 65536
  s_mov_b32 s42, 5242880
  buffer_load_dwordx4 v8, s[8:11], s42 offen lds
  s_add_u32 m0, s41, 69632
  s_mov_b32 s42, 5242880
  buffer_load_dwordx4 v9, s[8:11], s42 offen lds
  s_add_u32 m0, s41, 73728
  s_mov_b32 s42, 5373952
  buffer_load_dwordx4 v8, s[8:11], s42 offen lds
  s_add_u32 m0, s41, 77824
  s_mov_b32 s42, 5373952
  buffer_load_dwordx4 v9, s[8:11], s42 offen lds
  ds_read_b64_tr_b16 a[40:41], v7 offset:16384
  ds_read_b64_tr_b16 a[42:43], v7 offset:18432
  ds_read_b64_tr_b16 a[168:169], v7 offset:20480
  ds_read_b64_tr_b16 a[170:171], v7 offset:22528
  ds_read_b64_tr_b16 a[44:45], v7 offset:24576
  ds_read_b64_tr_b16 a[46:47], v7 offset:26624
  ds_read_b64_tr_b16 a[172:173], v7 offset:28672
  ds_read_b64_tr_b16 a[174:175], v7 offset:30720
  s_waitcnt vmcnt(24) lgkmcnt(0)
  s_barrier
  s_add_u32 m0, s41, 81920
  s_mov_b32 s42, 5505024
  buffer_load_dwordx4 v8, s[8:11], s42 offen lds
  s_add_u32 m0, s41, 86016
  s_mov_b32 s42, 5505024
  buffer_load_dwordx4 v9, s[8:11], s42 offen lds
  s_add_u32 m0, s41, 90112
  s_mov_b32 s42, 5636096
  buffer_load_dwordx4 v8, s[8:11], s42 offen lds
  s_add_u32 m0, s41, 94208
  s_mov_b32 s42, 5636096
  buffer_load_dwordx4 v9, s[8:11], s42 offen lds
  ds_read_b64_tr_b16 a[48:49], v7 offset:32768
  ds_read_b64_tr_b16 a[50:51], v7 offset:34816
  ds_read_b64_tr_b16 a[176:177], v7 offset:36864
  ds_read_b64_tr_b16 a[178:179], v7 offset:38912
  ds_read_b64_tr_b16 a[52:53], v7 offset:40960
  ds_read_b64_tr_b16 a[54:55], v7 offset:43008
  ds_read_b64_tr_b16 a[180:181], v7 offset:45056
  ds_read_b64_tr_b16 a[182:183], v7 offset:47104
  s_waitcnt vmcnt(24) lgkmcnt(0)
  s_barrier
  s_add_u32 m0, s41, 98304
  s_mov_b32 s42, 5767168
  buffer_load_dwordx4 v8, s[8:11], s42 offen lds
  s_add_u32 m0, s41, 102400
  s_mov_b32 s42, 5767168
  buffer_load_dwordx4 v9, s[8:11], s42 offen lds
  s_add_u32 m0, s41, 106496
  s_mov_b32 s42, 5898240
  buffer_load_dwordx4 v8, s[8:11], s42 offen lds
  s_add_u32 m0, s41, 110592
  s_mov_b32 s42, 5898240
  buffer_load_dwordx4 v9, s[8:11], s42 offen lds
  ds_read_b64_tr_b16 a[56:57], v7 offset:49152
  ds_read_b64_tr_b16 a[58:59], v7 offset:51200
  ds_read_b64_tr_b16 a[184:185], v7 offset:53248
  ds_read_b64_tr_b16 a[186:187], v7 offset:55296
  ds_read_b64_tr_b16 a[60:61], v7 offset:57344
  ds_read_b64_tr_b16 a[62:63], v7 offset:59392
  ds_read_b64_tr_b16 a[188:189], v7 offset:61440
  ds_read_b64_tr_b16 a[190:191], v7 offset:63488
  s_waitcnt vmcnt(24) lgkmcnt(0)
  s_barrier
  s_add_u32 m0, s41, 114688
  s_mov_b32 s42, 6029312
  buffer_load_dwordx4 v8, s[8:11], s42 offen lds
  s_add_u32 m0, s41, 118784
  s_mov_b32 s42, 6029312
  buffer_load_dwordx4 v9, s[8:11], s42 offen lds
  s_add_u32 m0, s41, 122880
  s_mov_b32 s42, 6160384
  buffer_load_dwordx4 v8, s[8:11], s42 offen lds
  s_add_u32 m0, s41, 126976
  s_mov_b32 s42, 6160384
  buffer_load_dwordx4 v9, s[8:11], s42 offen lds
  ds_read_b64_tr_b16 a[64:65], v6 offset:0
  ds_read_b64_tr_b16 a[66:67], v6 offset:2048
  ds_read_b64_tr_b16 a[192:193], v6 offset:4096
  ds_read_b64_tr_b16 a[194:195], v6 offset:6144
  ds_read_b64_tr_b16 a[68:69], v6 offset:8192
  ds_read_b64_tr_b16 a[70:71], v6 offset:10240
  ds_read_b64_tr_b16 a[196:197], v6 offset:12288
  ds_read_b64_tr_b16 a[198:199], v6 offset:14336
  s_waitcnt vmcnt(24) lgkmcnt(0)
  s_barrier
  s_load_dwordx2 s[8:9], s[0:1], 32
  s_mov_b32 s10, 8388608
  s_mov_b32 s11, 0x20000
  s_waitcnt lgkmcnt(0)
  s_add_u32 m0, s41, 0
  s_mov_b32 s42, 0
  buffer_load_dwordx4 v10, s[8:11], s42 offen lds
  s_add_u32 m0, s41, 4096
  s_mov_b32 s42, 131072
  buffer_load_dwordx4 v10, s[8:11], s42 offen lds
  s_add_u32 m0, s41, 8192
  s_mov_b32 s42, 262144
  buffer_load_dwordx4 v10, s[8:11], s42 offen lds
  s_add_u32 m0, s41, 12288
  s_mov_b32 s42, 393216
  buffer_load_dwordx4 v10, s[8:11], s42 offen lds
  ds_read_b64_tr_b16 a[72:73], v6 offset:16384
  ds_read_b64_tr_b16 a[74:75], v6 offset:18432
  ds_read_b64_tr_b16 a[200:201], v6 offset:20480
  ds_read_b64_tr_b16 a[202:203], v6 offset:22528
  ds_read_b64_tr_b16 a[76:77], v6 offset:24576
  ds_read_b64_tr_b16 a[78:79], v6 offset:26624
  ds_read_b64_tr_b16 a[204:205], v6 offset:28672
  ds_read_b64_tr_b16 a[206:207], v6 offset:30720
  s_waitcnt vmcnt(24) lgkmcnt(0)
  s_barrier
  s_add_u32 m0, s41, 16384
  s_mov_b32 s42, 524288
  buffer_load_dwordx4 v10, s[8:11], s42 offen lds
  s_add_u32 m0, s41, 20480
  s_mov_b32 s42, 655360
  buffer_load_dwordx4 v10, s[8:11], s42 offen lds
  s_add_u32 m0, s41, 24576
  s_mov_b32 s42, 786432
  buffer_load_dwordx4 v10, s[8:11], s42 offen lds
  s_add_u32 m0, s41, 28672
  s_mov_b32 s42, 917504
  buffer_load_dwordx4 v10, s[8:11], s42 offen lds
  ds_read_b64_tr_b16 a[80:81], v6 offset:32768
  ds_read_b64_tr_b16 a[82:83], v6 offset:34816
  ds_read_b64_tr_b16 a[208:209], v6 offset:36864
  ds_read_b64_tr_b16 a[210:211], v6 offset:38912
  ds_read_b64_tr_b16 a[84:85], v6 offset:40960
  ds_read_b64_tr_b16 a[86:87], v6 offset:43008
  ds_read_b64_tr_b16 a[212:213], v6 offset:45056
  ds_read_b64_tr_b16 a[214:215], v6 offset:47104
  s_cmp_lg_u32 s20, 0
  s_cbranch_scc1 L_QKV_noinit
Lini_25:
  s_load_dwordx16 s[64:79], s[12:13], 128 glc
  s_load_dwordx16 s[80:95], s[12:13], 192 glc
  s_sub_u32 s24, s24, 1
  s_cbranch_scc1 L_FAIL
  s_waitcnt lgkmcnt(0)
  s_and_b64 s[64:65], s[64:65], s[66:67]
  s_and_b64 s[64:65], s[64:65], s[68:69]
  s_and_b64 s[64:65], s[64:65], s[70:71]
  s_and_b64 s[64:65], s[64:65], s[72:73]
  s_and_b64 s[64:65], s[64:65], s[74:75]
  s_and_b64 s[64:65], s[64:65], s[76:77]
  s_and_b64 s[64:65], s[64:65], s[78:79]
  s_and_b64 s[64:65], s[64:65], s[80:81]
  s_and_b64 s[64:65], s[64:65], s[82:83]
  s_and_b64 s[64:65], s[64:65], s[84:85]
  s_and_b64 s[64:65], s[64:65], s[86:87]
  s_and_b64 s[64:65], s[64:65], s[88:89]
  s_and_b64 s[64:65], s[64:65], s[90:91]
  s_and_b64 s[64:65], s[64:65], s[92:93]
  s_and_b64 s[64:65], s[64:65], s[94:95]
  s_and_b32 s64, s64, s65
  s_cbranch_scc0 Lini_25
L_QKV_noinit:
  s_waitcnt vmcnt(24) lgkmcnt(0)
  s_barrier
  s_add_u32 m0, s41, 32768
  s_mov_b32 s42, 1048576
  buffer_load_dwordx4 v10, s[8:11], s42 offen lds
  s_add_u32 m0, s41, 36864
  s_mov_b32 s42, 1179648
  buffer_load_dwordx4 v10, s[8:11], s42 offen lds
  s_add_u32 m0, s41, 40960
  s_mov_b32 s42, 1310720
  buffer_load_dwordx4 v10, s[8:11], s42 offen lds
  s_add_u32 m0, s41, 45056
  s_mov_b32 s42, 1441792
  buffer_load_dwordx4 v10, s[8:11], s42 offen lds
  ds_read_b64_tr_b16 a[88:89], v6 offset:49152
  ds_read_b64_tr_b16 a[90:91], v6 offset:51200
  ds_read_b64_tr_b16 a[216:217], v6 offset:53248
  ds_read_b64_tr_b16 a[218:219], v6 offset:55296
  ds_read_b64_tr_b16 a[92:93], v6 offset:57344
  ds_read_b64_tr_b16 a[94:95], v6 offset:59392
  ds_read_b64_tr_b16 a[220:221], v6 offset:61440
  ds_read_b64_tr_b16 a[222:223], v6 offset:63488
  s_waitcnt vmcnt(24) lgkmcnt(0)
  s_barrier
  s_add_u32 m0, s41, 49152
  s_mov_b32 s42, 1572864
  buffer_load_dwordx4 v10, s[8:11], s42 offen lds
  s_add_u32 m0, s41, 53248
  s_mov_b32 s42, 1703936
  buffer_load_dwordx4 v10, s[8:11], s42 offen lds
  s_add_u32 m0, s41, 57344
  s_mov_b32 s42, 1835008
  buffer_load_dwordx4 v10, s[8:11], s42 offen lds
  s_add_u32 m0, s41, 61440
  s_mov_b32 s42, 1966080
  buffer_load_dwordx4 v10, s[8:11], s42 offen lds
  ds_read_b64_tr_b16 a[96:97], v7 offset:0
  ds_read_b64_tr_b16 a[98:99], v7 offset:2048
  ds_read_b64_tr_b16 a[224:225], v7 offset:4096
  ds_read_b64_tr_b16 a[226:227], v7 offset:6144
  ds_read_b64_tr_b16 a[100:101], v7 offset:8192
  ds_read_b64_tr_b16 a[102:103], v7 offset:10240
  ds_read_b64_tr_b16 a[228:229], v7 offset:12288
  ds_read_b64_tr_b16 a[230:231], v7 offset:14336
  s_waitcnt vmcnt(24) lgkmcnt(0)
  s_barrier
  s_add_u32 m0, s41, 65536
  s_mov_b32 s42, 4194304
  buffer_load_dwordx4 v10, s[8:11], s42 offen lds
  s_add_u32 m0, s41, 69632
  s_mov_b32 s42, 4325376
  buffer_load_dwordx4 v10, s[8:11], s42 offen lds
  s_add_u32 m0, s41, 73728
  s_mov_b32 s42, 4456448
  buffer_load_dwordx4 v10, s[8:11], s42 offen lds
  s_add_u32 m0, s41, 77824
  s_mov_b32 s42, 4587520
  buffer_load_dwordx4 v10, s[8:11], s42 offen lds
  ds_read_b64_tr_b16 a[104:105], v7 offset:16384
  ds_read_b64_tr_b16 a[106:107], v7 offset:18432
  ds_read_b64_tr_b16 a[232:233], v7 offset:20480
  ds_read_b64_tr_b16 a[234:235], v7 offset:22528
  ds_read_b64_tr_b16 a[108:109], v7 offset:24576
  ds_read_b64_tr_b16 a[110:111], v7 offset:26624
  ds_read_b64_tr_b16 a[236:237], v7 offset:28672
  ds_read_b64_tr_b16 a[238:239], v7 offset:30720
  s_waitcnt vmcnt(24) lgkmcnt(0)
  s_barrier
  s_add_u32 m0, s41, 81920
  s_mov_b32 s42, 4718592
  buffer_load_dwordx4 v10, s[8:11], s42 offen lds
  s_add_u32 m0, s41, 86016
  s_mov_b32 s42, 4849664
  buffer_load_dwordx4 v10, s[8:11], s42 offen lds
  s_add_u32 m0, s41, 90112
  s_mov_b32 s42, 4980736
  buffer_load_dwordx4 v10, s[8:11], s42 offen lds
  s_add_u32 m0, s41, 94208
  s_mov_b32 s42, 5111808
  buffer_load_dwordx4 v10, s[8:11], s42 offen lds
  ds_read_b64_tr_b16 a[112:113], v7 offset:32768
  ds_read_b64_tr_b16 a[114:115], v7 offset:34816
  ds_read_b64_tr_b16 a[240:241], v7 offset:36864
  ds_read_b64_tr_b16 a[242:243], v7 offset:38912
  ds_read_b64_tr_b16 a[116:117], v7 offset:40960
  ds_read_b64_tr_b16 a[118:119], v7 offset:43008
  ds_read_b64_tr_b16 a[244:245], v7 offset:45056
  ds_read_b64_tr_b16 a[246:247], v7 offset:47104
  s_waitcnt vmcnt(24) lgkmcnt(0)
  s_barrier
  s_add_u32 m0, s41, 98304
  s_mov_b32 s42, 5242880
  buffer_load_dwordx4 v10, s[8:11], s42 offen lds
  s_add_u32 m0, s41, 102400
  s_mov_b32 s42, 5373952
  buffer_load_dwordx4 v10, s[8:11], s42 offen lds
  s_add_u32 m0, s41, 106496
  s_mov_b32 s42, 5505024
  buffer_load_dwordx4 v10, s[8:11], s42 offen lds
  s_add_u32 m0, s41, 110592
  s_mov_b32 s42, 5636096
  buffer_load_dwordx4 v10, s[8:11], s42 offen lds
  ds_read_b64_tr_b16 a[120:121], v7 offset:49152
  ds_read_b64_tr_b16 a[122:123], v7 offset:51200
  ds_read_b64_tr_b16 a[248:249], v7 offset:53248
  ds_read_b64_tr_b16 a[250:251], v7 offset:55296
  ds_read_b64_tr_b16 a[124:125], v7 offset:57344
  ds_read_b64_tr_b16 a[126:127], v7 offset:59392
  ds_read_b64_tr_b16 a[252:253], v7 offset:61440
  ds_read_b64_tr_b16 a[254:255], v7 offset:63488
  s_waitcnt vmcnt(24) lgkmcnt(0)
  s_barrier
  s_add_u32 m0, s41, 114688
  s_mov_b32 s42, 5767168
  buffer_load_dwordx4 v10, s[8:11], s42 offen lds
  s_add_u32 m0, s41, 118784
  s_mov_b32 s42, 5898240
  buffer_load_dwordx4 v10, s[8:11], s42 offen lds
  s_add_u32 m0, s41, 122880
  s_mov_b32 s42, 6029312
  buffer_load_dwordx4 v10, s[8:11], s42 offen lds
  s_add_u32 m0, s41, 126976
  s_mov_b32 s42, 6160384
  buffer_load_dwordx4 v10, s[8:11], s42 offen lds
  ds_read_b64_tr_b16 v[128:129], v6 offset:0
  ds_read_b64_tr_b16 v[130:131], v6 offset:2048
  ds_read_b64_tr_b16 v[132:133], v6 offset:4096
  ds_read_b64_tr_b16 v[134:135], v6 offset:6144
  ds_read_b64_tr_b16 v[136:137], v6 offset:8192
  ds_read_b64_tr_b16 v[138:139], v6 offset:10240
  ds_read_b64_tr_b16 v[140:141], v6 offset:12288
  ds_read_b64_tr_b16 v[142:143], v6 offset:14336
  s_waitcnt vmcnt(24) lgkmcnt(0)
  s_barrier
  ds_read_b64_tr_b16 v[144:145], v6 offset:16384
  ds_read_b64_tr_b16 v[146:147], v6 offset:18432
  ds_read_b64_tr_b16 v[148:149], v6 offset:20480
  ds_read_b64_tr_b16 v[150:151], v6 offset:22528
  ds_read_b64_tr_b16 v[152:153], v6 offset:24576
  ds_read_b64_tr_b16 v[154:155], v6 offset:26624
  ds_read_b64_tr_b16 v[156:157], v6 offset:28672
  ds_read_b64_tr_b16 v[158:159], v6 offset:30720
  s_waitcnt vmcnt(20) lgkmcnt(0)
  s_barrier
  ds_read_b64_tr_b16 v[160:161], v6 offset:32768
  ds_read_b64_tr_b16 v[162:163], v6 offset:34816
  ds_read_b64_tr_b16 v[164:165], v6 offset:36864
  ds_read_b64_tr_b16 v[166:167], v6 offset:38912
  ds_read_b64_tr_b16 v[168:169], v6 offset:40960
  ds_read_b64_tr_b16 v[170:171], v6 offset:43008
  ds_read_b64_tr_b16 v[172:173], v6 offset:45056
  ds_read_b64_tr_b16 v[174:175], v6 offset:47104
  s_waitcnt vmcnt(16) lgkmcnt(0)
  s_barrier
  ds_read_b64_tr_b16 v[176:177], v6 offset:49152
  ds_read_b64_tr_b16 v[178:179], v6 offset:51200
  ds_read_b64_tr_b16 v[180:181], v6 offset:53248
  ds_read_b64_tr_b16 v[182:183], v6 offset:55296
  ds_read_b64_tr_b16 v[184:185], v6 offset:57344
  ds_read_b64_tr_b16 v[186:187], v6 offset:59392
  ds_read_b64_tr_b16 v[188:189], v6 offset:61440
  ds_read_b64_tr_b16 v[190:191], v6 offset:63488
  s_waitcnt vmcnt(12) lgkmcnt(0)
  s_barrier
  ds_read_b64_tr_b16 v[192:193], v7 offset:0
  ds_read_b64_tr_b16 v[194:195], v7 offset:2048
  ds_read_b64_tr_b16 v[196:197], v7 offset:4096
  ds_read_b64_tr_b16 v[198:199], v7 offset:6144
  ds_read_b64_tr_b16 v[200:201], v7 offset:8192
  ds_read_b64_tr_b16 v[202:203], v7 offset:10240
  ds_read_b64_tr_b16 v[204:205], v7 offset:12288
  ds_read_b64_tr_b16 v[206:207], v7 offset:14336
  s_waitcnt vmcnt(8) lgkmcnt(0)
  s_barrier
  ds_read_b64_tr_b16 v[208:209], v7 offset:16384
  ds_read_b64_tr_b16 v[210:211], v7 offset:18432
  ds_read_b64_tr_b16 v[212:213], v7 offset:20480
  ds_read_b64_tr_b16 v[214:215], v7 offset:22528
  ds_read_b64_tr_b16 v[216:217], v7 offset:24576
  ds_read_b64_tr_b16 v[218:219], v7 offset:26624
  ds_read_b64_tr_b16 v[220:221], v7 offset:28672
  ds_read_b64_tr_b16 v[222:223], v7 offset:30720
  s_waitcnt vmcnt(4) lgkmcnt(0)
  s_barrier
  ds_read_b64_tr_b16 v[224:225], v7 offset:32768
  ds_read_b64_tr_b16 v[226:227], v7 offset:34816
  ds_read_b64_tr_b16 v[228:229], v7 offset:36864
  ds_read_b64_tr_b16 v[230:231], v7 offset:38912
  ds_read_b64_tr_b16 v[232:233], v7 offset:40960
  ds_read_b64_tr_b16 v[234:235], v7 offset:43008
  ds_read_b64_tr_b16 v[236:237], v7 offset:45056
  ds_read_b64_tr_b16 v[238:239], v7 offset:47104
  s_waitcnt vmcnt(0) lgkmcnt(0)
  s_barrier
  ds_read_b64_tr_b16 v[240:241], v7 offset:49152
  ds_read_b64_tr_b16 v[242:243], v7 offset:51200
  ds_read_b64_tr_b16 v[244:245], v7 offset:53248
  ds_read_b64_tr_b16 v[246:247], v7 offset:55296
  ds_read_b64_tr_b16 v[248:249], v7 offset:57344
  ds_read_b64_tr_b16 v[250:251], v7 offset:59392
  ds_read_b64_tr_b16 v[252:253], v7 offset:61440
  ds_read_b64_tr_b16 v[254:255], v7 offset:63488
  s_waitcnt lgkmcnt(0)
  s_barrier
  s_lshr_b32 s62, s21, 1
  s_lshl_b32 s62, s62, 7
  s_and_b32 s40, s21, 1
  s_lshl_b32 s40, s40, 2
  s_add_u32 s62, s62, s40
  s_add_u32 s62, s62, 1396736
  s_mov_b32 s27, 2097152
  s_lshr_b32 s40, s21, 1
  s_mul_i32 s31, s40, 65536
  s_and_b32 s41, s21, 1
  s_lshl_b32 s42, s20, 11
  s_lshl_b32 s40, s41, 14
  s_add_u32 s40, s40, s42
  v_lshl_add_u32 v76, v0, 4, s40
  s_lshl_b32 s40, s41, 10
  s_add_u32 s40, s40, s42
  s_add_u32 s40, s40, 32768
  v_lshl_add_u32 v83, v0, 4, s40
  v_lshrrev_b32 v2, 3, v0
  v_lshlrev_b32 v2, 7, v2
  v_and_b32 v3, 7, v0
  v_lshl_add_u32 v2, v3, 2, v2
  v_add_u32 v2, 1388544, v2
  s_mov_b32 s25, 0
  s_mov_b32 s37, 2147483392
  s_mov_b32 s30, 0
  s_mov_b32 s34, s32
  s_mov_b32 s35, s27
  v_mov_b32 v81, v77
  v_mov_b32 v82, v78
  s_nop 1
Lpoll_26:
  buffer_load_dword v3, v2, s[4:7], 0 offen sc1
  s_sub_u32 s24, s24, 1
  s_cbranch_scc1 L_FAIL
  s_waitcnt vmcnt(0)
  v_cmp_gt_i32 vcc, 1, v3
  s_cbranch_vccz Lpolld_27
  s_sleep 1
  s_branch Lpoll_26
Lpolld_27:
  s_add_u32 m0, s34, 0
  s_nop 0
  buffer_load_dwordx4 v1, s[4:7], s35 offen offset:0 sc1 lds
  s_add_u32 m0, s34, 3968
  s_nop 0
  buffer_load_dwordx4 v1, s[4:7], s35 offen offset:128 sc1 lds
  s_add_u32 m0, s34, 7936
  s_nop 0
  buffer_load_dwordx4 v1, s[4:7], s35 offen offset:256 sc1 lds
  s_add_u32 m0, s34, 11904
  s_nop 0
  buffer_load_dwordx4 v1, s[4:7], s35 offen offset:384 sc1 lds
  s_add_u32 m0, s34, 15872
  s_nop 0
  buffer_load_dwordx4 v1, s[4:7], s35 offen offset:512 sc1 lds
  s_add_u32 m0, s34, 19840
  s_nop 0
  buffer_load_dwordx4 v1, s[4:7], s35 offen offset:640 sc1 lds
  s_add_u32 m0, s34, 23808
  s_nop 0
  buffer_load_dwordx4 v1, s[4:7], s35 offen offset:768 sc1 lds
  s_add_u32 m0, s34, 27776
  s_nop 0
  buffer_load_dwordx4 v1, s[4:7], s35 offen offset:896 sc1 lds
  s_add_u32 m0, s34, 31744
  s_nop 0
  buffer_load_dwordx4 v1, s[4:7], s35 offen offset:1024 sc1 lds
  s_add_u32 m0, s34, 35712
  s_nop 0
  buffer_load_dwordx4 v1, s[4:7], s35 offen offset:1152 sc1 lds
  s_add_u32 m0, s34, 39680
  s_nop 0
  buffer_load_dwordx4 v1, s[4:7], s35 offen offset:1280 sc1 lds
  s_add_u32 m0, s34, 43648
  s_nop 0
  buffer_load_dwordx4 v1, s[4:7], s35 offen offset:1408 sc1 lds
  s_add_u32 m0, s34, 47616
  s_nop 0
  buffer_load_dwordx4 v1, s[4:7], s35 offen offset:1536 sc1 lds
  s_add_u32 m0, s34, 51584
  s_nop 0
  buffer_load_dwordx4 v1, s[4:7], s35 offen offset:1664 sc1 lds
  s_add_u32 m0, s34, 55552
  s_nop 0
  buffer_load_dwordx4 v1, s[4:7], s35 offen offset:1792 sc1 lds
  s_add_u32 m0, s34, 59520
  s_nop 0
  buffer_load_dwordx4 v1, s[4:7], s35 offen offset:1920 sc1 lds
  v_min_u32 v60, 63, v0
  v_lshlrev_b32 v60, 7, v60
  v_add_u32 v60, 1424384, v60
  s_nop 1
Lpoll_28:
  buffer_load_dword v61, v60, s[4:7], 0 offen sc1
  s_sub_u32 s24, s24, 1
  s_cbranch_scc1 L_FAIL
  s_waitcnt vmcnt(0)
  v_cmp_gt_i32 vcc, 0, v61
  s_cbranch_vccz Lpolld_29
  s_sleep 1
  s_branch Lpoll_28
Lpolld_29:
  v_lshrrev_b32 v61, 8, v61
  v_and_b32 v62, 3, v0
  v_lshl_or_b32 v61, v61, 2, v62
  s_nop 1
  v_min_u32_dpp v61, v61, v61 row_ror:8 row_mask:0xf bank_mask:0xf
  s_nop 1
  v_min_u32_dpp v61, v61, v61 row_ror:4 row_mask:0xf bank_mask:0xf
  v_mov_b32 v62, v61
  s_nop 1
  v_permlane16_swap_b32 v62, v61
  v_min_u32 v61, v61, v62
  v_mov_b32 v62, v61
  s_nop 1
  v_permlane32_swap_b32 v62, v61
  v_min_u32 v61, v61, v62
  s_nop 1
  v_min_u32_dpp v61, v61, v61 row_ror:2 row_mask:0xf bank_mask:0xf
  s_nop 1
  v_min_u32_dpp v61, v61, v61 row_ror:1 row_mask:0xf bank_mask:0xf
  s_nop 0
  v_readfirstlane_b32 s40, v61
  s_and_b32 s40, s40, 3
  s_lshl_b32 s40, s40, 13
  s_and_b32 s40, s40, 0x2000
  s_xor_b32 s40, s40, 16777216
  s_add_u32 s31, s31, s40
  s_barrier
  ds_read_b128 v[4:7], v81 offset:0
  ds_read_b128 v[8:11], v81 offset:2048
  ds_read_b128 v[12:15], v82 offset:0
  ds_read_b128 v[16:19], v82 offset:2048
  ds_read_b128 v[20:23], v81 offset:4096
  ds_read_b128 v[24:27], v81 offset:6144
L_QKV_top:
  s_waitcnt lgkmcnt(4)
  v_cvt_pk_bf16_f32 v60, v36, v37
  v_cvt_pk_bf16_f32 v61, v38, v39
  v_mfma_f32_16x16x32_bf16 v[36:39], a[0:3], v[4:7], 0
  v_cvt_pk_bf16_f32 v62, v44, v45
  v_cvt_pk_bf16_f32 v63, v46, v47
  v_mfma_f32_16x16x32_bf16 v[44:47], a[128:131], v[4:7], 0
  v_cvt_pk_bf16_f32 v64, v40, v41
  v_cvt_pk_bf16_f32 v65, v42, v43
  v_mfma_f32_16x16x32_bf16 v[40:43], a[0:3], v[8:11], 0
  v_cvt_pk_bf16_f32 v66, v48, v49
  v_cvt_pk_bf16_f32 v67, v50, v51
  v_mfma_f32_16x16x32_bf16 v[48:51], a[128:131], v[8:11], 0
  v_cvt_pk_bf16_f32 v68, v52, v53
  v_cvt_pk_bf16_f32 v69, v54, v55
  v_mfma_f32_16x16x32_bf16 v[52:55], v[4:7], v[128:131], 0
  ds_read_b128 v[28:31], v82 offset:4096
  v_cvt_pk_bf16_f32 v70, v56, v57
  v_cvt_pk_bf16_f32 v71, v58, v59
  v_mfma_f32_16x16x32_bf16 v[56:59], v[8:11], v[128:131], 0
  ds_read_b128 v[32:35], v82 offset:6144
  s_waitcnt lgkmcnt(4)
  v_mfma_f32_16x16x32_bf16 v[36:39], a[4:7], v[12:15], v[36:39]
  ds_read_b128 v[4:7], v81 offset:8192
  v_mfma_f32_16x16x32_bf16 v[44:47], a[132:135], v[12:15], v[44:47]
  ds_read_b128 v[8:11], v81 offset:10240
  v_mfma_f32_16x16x32_bf16 v[40:43], a[4:7], v[16:19], v[40:43]
  buffer_store_dwordx4 v[60:63], v76, s[4:7], s37 offen offset:0 sc1
  v_mfma_f32_16x16x32_bf16 v[48:51], a[132:135], v[16:19], v[48:51]
  buffer_store_dwordx4 v[64:67], v76, s[4:7], s37 offen offset:1024 sc1
  v_mfma_f32_16x16x32_bf16 v[52:55], v[12:15], v[132:135], v[52:55]
  v_mfma_f32_16x16x32_bf16 v[56:59], v[16:19], v[132:135], v[56:59]
  s_waitcnt lgkmcnt(4)
  v_mfma_f32_16x16x32_bf16 v[36:39], a[8:11], v[20:23], v[36:39]
  ds_read_b128 v[12:15], v82 offset:8192
  v_mfma_f32_16x16x32_bf16 v[44:47], a[136:139], v[20:23], v[44:47]
  ds_read_b128 v[16:19], v82 offset:10240
  v_mfma_f32_16x16x32_bf16 v[40:43], a[8:11], v[24:27], v[40:43]
  buffer_store_dwordx4 v[68:71], v83, s[4:7], s37 offen sc1
  v_mfma_f32_16x16x32_bf16 v[48:51], a[136:139], v[24:27], v[48:51]
  v_cmp_gt_i32 vcc, 1, v3
  v_mfma_f32_16x16x32_bf16 v[52:55], v[20:23], v[136:139], v[52:55]
  v_mfma_f32_16x16x32_bf16 v[56:59], v[24:27], v[136:139], v[56:59]
  s_xor_b32 s34, s34, 0x10000
  s_add_u32 s35, s35, 65536
  s_cbranch_vccz L_QKV_have
  s_nop 4
Lpoll_30:
  buffer_load_dword v3, v2, s[4:7], s30 offen sc1
  s_sub_u32 s24, s24, 1
  s_cbranch_scc1 L_FAIL
  s_waitcnt vmcnt(0)
  v_cmp_gt_i32 vcc, 1, v3
  s_cbranch_vccz Lpolld_31
  s_sleep 1
  s_branch Lpoll_30
Lpolld_31:
L_QKV_have:
  s_barrier
  s_waitcnt lgkmcnt(4)
  v_mfma_f32_16x16x32_bf16 v[36:39], a[12:15], v[28:31], v[36:39]
  ds_read_b128 v[20:23], v81 offset:12288
  v_mfma_f32_16x16x32_bf16 v[44:47], a[140:143], v[28:31], v[44:47]
  ds_read_b128 v[24:27], v81 offset:14336
  v_mfma_f32_16x16x32_bf16 v[40:43], a[12:15], v[32:35], v[40:43]
  s_add_u32 m0, s34, 0
  s_nop 0
  buffer_load_dwordx4 v1, s[4:7], s35 offen offset:0 sc1 lds
  v_mfma_f32_16x16x32_bf16 v[48:51], a[140:143], v[32:35], v[48:51]
  v_mfma_f32_16x16x32_bf16 v[52:55], v[28:31], v[140:143], v[52:55]
  v_mfma_f32_16x16x32_bf16 v[56:59], v[32:35], v[140:143], v[56:59]
  s_waitcnt lgkmcnt(4)
  v_mfma_f32_16x16x32_bf16 v[36:39], a[16:19], v[4:7], v[36:39]
  ds_read_b128 v[28:31], v82 offset:12288
  v_mfma_f32_16x16x32_bf16 v[44:47], a[144:147], v[4:7], v[44:47]
  ds_read_b128 v[32:35], v82 offset:14336
  v_mfma_f32_16x16x32_bf16 v[40:43], a[16:19], v[8:11], v[40:43]
  s_add_u32 m0, s34, 3968
  s_nop 0
  buffer_load_dwordx4 v1, s[4:7], s35 offen offset:128 sc1 lds
  v_mfma_f32_16x16x32_bf16 v[48:51], a[144:147], v[8:11], v[48:51]
  v_mfma_f32_16x16x32_bf16 v[52:55], v[4:7], v[144:147], v[52:55]
  v_mfma_f32_16x16x32_bf16 v[56:59], v[8:11], v[144:147], v[56:59]
  s_waitcnt lgkmcnt(4)
  v_mfma_f32_16x16x32_bf16 v[36:39], a[20:23], v[12:15], v[36:39]
  ds_read_b128 v[4:7], v81 offset:16384
  v_mfma_f32_16x16x32_bf16 v[44:47], a[148:151], v[12:15], v[44:47]
  ds_read_b128 v[8:11], v81 offset:18432
  v_mfma_f32_16x16x32_bf16 v[40:43], a[20:23], v[16:19], v[40:43]
  s_add_u32 m0, s34, 7936
  s_nop 0
  buffer_load_dwordx4 v1, s[4:7], s35 offen offset:256 sc1 lds
  v_mfma_f32_16x16x32_bf16 v[48:51], a[148:151], v[16:19], v[48:51]
  v_mfma_f32_16x16x32_bf16 v[52:55], v[12:15], v[148:151], v[52:55]
  v_mfma_f32_16x16x32_bf16 v[56:59], v[16:19], v[148:151], v[56:59]
  s_waitcnt lgkmcnt(4)
  v_mfma_f32_16x16x32_bf16 v[36:39], a[24:27], v[20:23], v[36:39]
  ds_read_b128 v[12:15], v82 offset:16384
  v_mfma_f32_16x16x32_bf16 v[44:47], a[152:155], v[20:23], v[44:47]
  ds_read_b128 v[16:19], v82 offset:18432
  v_mfma_f32_16x16x32_bf16 v[40:43], a[24:27], v[24:27], v[40:43]
  s_add_u32 m0, s34, 11904
  s_nop 0
  buffer_load_dwordx4 v1, s[4:7], s35 offen offset:384 sc1 lds
  v_mfma_f32_16x16x32_bf16 v[48:51], a[152:155], v[24:27], v[48:51]
  v_mfma_f32_16x16x32_bf16 v[52:55], v[20:23], v[152:155], v[52:55]
  v_mfma_f32_16x16x32_bf16 v[56:59], v[24:27], v[152:155], v[56:59]
  s_waitcnt lgkmcnt(4)
  v_mfma_f32_16x16x32_bf16 v[36:39], a[28:31], v[28:31], v[36:39]
  ds_read_b128 v[20:23], v81 offset:20480
  v_mfma_f32_16x16x32_bf16 v[44:47], a[156:159], v[28:31], v[44:47]
  ds_read_b128 v[24:27], v81 offset:22528
  v_mfma_f32_16x16x32_bf16 v[40:43], a[28:31], v[32:35], v[40:43]
  s_add_u32 m0, s34, 15872
  s_nop 0
  buffer_load_dwordx4 v1, s[4:7], s35 offen offset:512 sc1 lds
  v_mfma_f32_16x16x32_bf16 v[48:51], a[156:159], v[32:35], v[48:51]
  v_mfma_f32_16x16x32_bf16 v[52:55], v[28:31], v[156:159], v[52:55]
  v_mfma_f32_16x16x32_bf16 v[56:59], v[32:35], v[156:159], v[56:59]
  s_waitcnt lgkmcnt(4)
  v_mfma_f32_16x16x32_bf16 v[36:39], a[32:35], v[4:7], v[36:39]
  ds_read_b128 v[28:31], v82 offset:20480
  v_mfma_f32_16x16x32_bf16 v[44:47], a[160:163], v[4:7], v[44:47]
  ds_read_b128 v[32:35], v82 offset:22528
  v_mfma_f32_16x16x32_bf16 v[40:43], a[32:35], v[8:11], v[40:43]
  s_add_u32 m0, s34, 19840
  s_nop 0
  buffer_load_dwordx4 v1, s[4:7], s35 offen offset:640 sc1 lds
  v_mfma_f32_16x16x32_bf16 v[48:51], a[160:163], v[8:11], v[48:51]
  v_mfma_f32_16x16x32_bf16 v[52:55], v[4:7], v[160:163], v[52:55]
  v_mfma_f32_16x16x32_bf16 v[56:59], v[8:11], v[160:163], v[56:59]
  s_waitcnt lgkmcnt(4)
  v_mfma_f32_16x16x32_bf16 v[36:39], a[36:39], v[12:15], v[36:39]
  ds_read_b128 v[4:7], v81 offset:24576
  v_mfma_f32_16x16x32_bf16 v[44:47], a[164:167], v[12:15], v[44:47]
  ds_read_b128 v[8:11], v81 offset:26624
  v_mfma_f32_16x16x32_bf16 v[40:43], a[36:39], v[16:19], v[40:43]
  s_add_u32 m0, s34, 23808
  s_nop 0
  buffer_load_dwordx4 v1, s[4:7], s35 offen offset:768 sc1 lds
  v_mfma_f32_16x16x32_bf16 v[48:51], a[164:167], v[16:19], v[48:51]
  v_mfma_f32_16x16x32_bf16 v[52:55], v[12:15], v[164:167], v[52:55]
  v_mfma_f32_16x16x32_bf16 v[56:59], v[16:19], v[164:167], v[56:59]
  s_waitcnt lgkmcnt(4)
  v_mfma_f32_16x16x32_bf16 v[36:39], a[40:43], v[20:23], v[36:39]
  ds_read_b128 v[12:15], v82 offset:24576
  v_mfma_f32_16x16x32_bf16 v[44:47], a[168:171], v[20:23], v[44:47]
  ds_read_b128 v[16:19], v82 offset:26624
  v_mfma_f32_16x16x32_bf16 v[40:43], a[40:43], v[24:27], v[40:43]
  s_add_u32 m0, s34, 27776
  s_nop 0
  buffer_load_dwordx4 v1, s[4:7], s35 offen offset:896 sc1 lds
  v_mfma_f32_16x16x32_bf16 v[48:51], a[168:171], v[24:27], v[48:51]
  v_mfma_f32_16x16x32_bf16 v[52:55], v[20:23], v[168:171], v[52:55]
  v_mfma_f32_16x16x32_bf16 v[56:59], v[24:27], v[168:171], v[56:59]
  s_waitcnt lgkmcnt(4)
  v_mfma_f32_16x16x32_bf16 v[36:39], a[44:47], v[28:31], v[36:39]
  ds_read_b128 v[20:23], v81 offset:28672
  v_mfma_f32_16x16x32_bf16 v[44:47], a[172:175], v[28:31], v[44:47]
  ds_read_b128 v[24:27], v81 offset:30720
  v_mfma_f32_16x16x32_bf16 v[40:43], a[44:47], v[32:35], v[40:43]
  s_add_u32 m0, s34, 31744
  s_nop 0
  buffer_load_dwordx4 v1, s[4:7], s35 offen offset:1024 sc1 lds
  v_mfma_f32_16x16x32_bf16 v[48:51], a[172:175], v[32:35], v[48:51]
  v_mfma_f32_16x16x32_bf16 v[52:55], v[28:31], v[172:175], v[52:55]
  v_mfma_f32_16x16x32_bf16 v[56:59], v[32:35], v[172:175], v[56:59]
  s_waitcnt vmcnt(9)
  s_barrier
  s_cmp_lg_u32 s20, 0
  s_cbranch_scc1 Lnosig_32
  s_mov_b32 s63, s25
  s_atomic_smax s63, s[4:5], s62 glc
Lnosig_32:
  s_waitcnt lgkmcnt(4)
  v_mfma_f32_16x16x32_bf16 v[36:39], a[48:51], v[4:7], v[36:39]
  ds_read_b128 v[28:31], v82 offset:28672
  v_mfma_f32_16x16x32_bf16 v[44:47], a[176:179], v[4:7], v[44:47]
  ds_read_b128 v[32:35], v82 offset:30720
  v_mfma_f32_16x16x32_bf16 v[40:43], a[48:51], v[8:11], v[40:43]
  s_add_u32 m0, s34, 35712
  s_nop 0
  buffer_load_dwordx4 v1, s[4:7], s35 offen offset:1152 sc1 lds
  v_mfma_f32_16x16x32_bf16 v[48:51], a[176:179], v[8:11], v[48:51]
  v_mfma_f32_16x16x32_bf16 v[52:55], v[4:7], v[176:179], v[52:55]
  v_mfma_f32_16x16x32_bf16 v[56:59], v[8:11], v[176:179], v[56:59]
  s_waitcnt lgkmcnt(4)
  v_mfma_f32_16x16x32_bf16 v[36:39], a[52:55], v[12:15], v[36:39]
  ds_read_b128 v[4:7], v81 offset:32768
  v_mfma_f32_16x16x32_bf16 v[44:47], a[180:183], v[12:15], v[44:47]
  ds_read_b128 v[8:11], v81 offset:34816
  v_mfma_f32_16x16x32_bf16 v[40:43], a[52:55], v[16:19], v[40:43]
  s_add_u32 m0, s34, 39680
  s_nop 0
  buffer_load_dwordx4 v1, s[4:7], s35 offen offset:1280 sc1 lds
  v_mfma_f32_16x16x32_bf16 v[48:51], a[180:183], v[16:19], v[48:51]
  v_mfma_f32_16x16x32_bf16 v[52:55], v[12:15], v[180:183], v[52:55]
  v_mfma_f32_16x16x32_bf16 v[56:59], v[16:19], v[180:183], v[56:59]
  s_waitcnt lgkmcnt(4)
  v_mfma_f32_16x16x32_bf16 v[36:39], a[56:59], v[20:23], v[36:39]
  ds_read_b128 v[12:15], v82 offset:32768
  v_mfma_f32_16x16x32_bf16 v[44:47], a[184:187], v[20:23], v[44:47]
  ds_read_b128 v[16:19], v82 offset:34816
  v_mfma_f32_16x16x32_bf16 v[40:43], a[56:59], v[24:27], v[40:43]
  s_add_u32 m0, s34, 43648
  s_nop 0
  buffer_load_dwordx4 v1, s[4:7], s35 offen offset:1408 sc1 lds
  v_mfma_f32_16x16x32_bf16 v[48:51], a[184:187], v[24:27], v[48:51]
  v_mfma_f32_16x16x32_bf16 v[52:55], v[20:23], v[184:187], v[52:55]
  v_mfma_f32_16x16x32_bf16 v[56:59], v[24:27], v[184:187], v[56:59]
  s_waitcnt lgkmcnt(4)
  v_mfma_f32_16x16x32_bf16 v[36:39], a[60:63], v[28:31], v[36:39]
  ds_read_b128 v[20:23], v81 offset:36864
  v_mfma_f32_16x16x32_bf16 v[44:47], a[188:191], v[28:31], v[44:47]
  ds_read_b128 v[24:27], v81 offset:38912
  v_mfma_f32_16x16x32_bf16 v[40:43], a[60:63], v[32:35], v[40:43]
  s_add_u32 m0, s34, 47616
  s_nop 0
  buffer_load_dwordx4 v1, s[4:7], s35 offen offset:1536 sc1 lds
  v_mfma_f32_16x16x32_bf16 v[48:51], a[188:191], v[32:35], v[48:51]
  v_mfma_f32_16x16x32_bf16 v[52:55], v[28:31], v[188:191], v[52:55]
  v_mfma_f32_16x16x32_bf16 v[56:59], v[32:35], v[188:191], v[56:59]
  s_waitcnt lgkmcnt(4)
  v_mfma_f32_16x16x32_bf16 v[36:39], a[64:67], v[4:7], v[36:39]
  ds_read_b128 v[28:31], v82 offset:36864
  v_mfma_f32_16x16x32_bf16 v[44:47], a[192:195], v[4:7], v[44:47]
  ds_read_b128 v[32:35], v82 offset:38912
  v_mfma_f32_16x16x32_bf16 v[40:43], a[64:67], v[8:11], v[40:43]
  s_add_u32 m0, s34, 51584
  s_nop 0
  buffer_load_dwordx4 v1, s[4:7], s35 offen offset:1664 sc1 lds
  v_mfma_f32_16x16x32_bf16 v[48:51], a[192:195], v[8:11], v[48:51]
  v_mfma_f32_16x16x32_bf16 v[52:55], v[4:7], v[192:195], v[52:55]
  v_mfma_f32_16x16x32_bf16 v[56:59], v[8:11], v[192:195], v[56:59]
  s_waitcnt lgkmcnt(4)
  v_mfma_f32_16x16x32_bf16 v[36:39], a[68:71], v[12:15], v[36:39]
  ds_read_b128 v[4:7], v81 offset:40960
  v_mfma_f32_16x16x32_bf16 v[44:47], a[196:199], v[12:15], v[44:47]
  ds_read_b128 v[8:11], v81 offset:43008
  v_mfma_f32_16x16x32_bf16 v[40:43], a[68:71], v[16:19], v[40:43]
  s_add_u32 m0, s34, 55552
  s_nop 0
  buffer_load_dwordx4 v1, s[4:7], s35 offen offset:1792 sc1 lds
  v_mfma_f32_16x16x32_bf16 v[48:51], a[196:199], v[16:19], v[48:51]
  v_mfma_f32_16x16x32_bf16 v[52:55], v[12:15], v[196:199], v[52:55]
  v_mfma_f32_16x16x32_bf16 v[56:59], v[16:19], v[196:199], v[56:59]
  s_waitcnt lgkmcnt(4)
  v_mfma_f32_16x16x32_bf16 v[36:39], a[72:75], v[20:23], v[36:39]
  ds_read_b128 v[12:15], v82 offset:40960
  v_mfma_f32_16x16x32_bf16 v[44:47], a[200:203], v[20:23], v[44:47]
  ds_read_b128 v[16:19], v82 offset:43008
  v_mfma_f32_16x16x32_bf16 v[40:43], a[72:75], v[24:27], v[40:43]
  s_add_u32 m0, s34, 59520
  s_nop 0
  buffer_load_dwordx4 v1, s[4:7], s35 offen offset:1920 sc1 lds
  v_mfma_f32_16x16x32_bf16 v[48:51], a[200:203], v[24:27], v[48:51]
  v_mfma_f32_16x16x32_bf16 v[52:55], v[20:23], v[200:203], v[52:55]
  v_mfma_f32_16x16x32_bf16 v[56:59], v[24:27], v[200:203], v[56:59]
  s_waitcnt lgkmcnt(4)
  v_mfma_f32_16x16x32_bf16 v[36:39], a[76:79], v[28:31], v[36:39]
  ds_read_b128 v[20:23], v81 offset:45056
  v_mfma_f32_16x16x32_bf16 v[44:47], a[204:207], v[28:31], v[44:47]
  ds_read_b128 v[24:27], v81 offset:47104
  v_mfma_f32_16x16x32_bf16 v[40:43], a[76:79], v[32:35], v[40:43]
  v_mfma_f32_16x16x32_bf16 v[48:51], a[204:207], v[32:35], v[48:51]
  v_mfma_f32_16x16x32_bf16 v[52:55], v[28:31], v[204:207], v[52:55]
  v_mfma_f32_16x16x32_bf16 v[56:59], v[32:35], v[204:207], v[56:59]
  s_waitcnt lgkmcnt(4)
  v_mfma_f32_16x16x32_bf16 v[36:39], a[80:83], v[4:7], v[36:39]
  ds_read_b128 v[28:31], v82 offset:45056
  v_mfma_f32_16x16x32_bf16 v[44:47], a[208:211], v[4:7], v[44:47]
  ds_read_b128 v[32:35], v82 offset:47104
  v_mfma_f32_16x16x32_bf16 v[40:43], a[80:83], v[8:11], v[40:43]
  s_add_u32 s30, s25, 2
  s_and_b32 s30, s30, 56
  s_lshl_b32 s30, s30, 7
  buffer_load_dword v3, v2, s[4:7], s30 offen sc1
  v_mfma_f32_16x16x32_bf16 v[48:51], a[208:211], v[8:11], v[48:51]
  v_mfma_f32_16x16x32_bf16 v[52:55], v[4:7], v[208:211], v[52:55]
  v_mfma_f32_16x16x32_bf16 v[56:59], v[8:11], v[208:211], v[56:59]
  s_waitcnt lgkmcnt(4)
  v_mfma_f32_16x16x32_bf16 v[36:39], a[84:87], v[12:15], v[36:39]
  ds_read_b128 v[4:7], v81 offset:49152
  v_mfma_f32_16x16x32_bf16 v[44:47], a[212:215], v[12:15], v[44:47]
  ds_read_b128 v[8:11], v81 offset:51200
  v_mfma_f32_16x16x32_bf16 v[40:43], a[84:87], v[16:19], v[40:43]
  v_mfma_f32_16x16x32_bf16 v[48:51], a[212:215], v[16:19], v[48:51]
  v_mfma_f32_16x16x32_bf16 v[52:55], v[12:15], v[212:215], v[52:55]
  v_mfma_f32_16x16x32_bf16 v[56:59], v[16:19], v[212:215], v[56:59]
  s_waitcnt lgkmcnt(4)
  v_mfma_f32_16x16x32_bf16 v[36:39], a[88:91], v[20:23], v[36:39]
  ds_read_b128 v[12:15], v82 offset:49152
  v_mfma_f32_16x16x32_bf16 v[44:47], a[216:219], v[20:23], v[44:47]
  ds_read_b128 v[16:19], v82 offset:51200
  v_mfma_f32_16x16x32_bf16 v[40:43], a[88:91], v[24:27], v[40:43]
  v_mfma_f32_16x16x32_bf16 v[48:51], a[216:219], v[24:27], v[48:51]
  v_mfma_f32_16x16x32_bf16 v[52:55], v[20:23], v[216:219], v[52:55]
  v_mfma_f32_16x16x32_bf16 v[56:59], v[24:27], v[216:219], v[56:59]
  s_waitcnt lgkmcnt(4)
  v_mfma_f32_16x16x32_bf16 v[36:39], a[92:95], v[28:31], v[36:39]
  ds_read_b128 v[20:23], v81 offset:53248
  v_mfma_f32_16x16x32_bf16 v[44:47], a[220:223], v[28:31], v[44:47]
  ds_read_b128 v[24:27], v81 offset:55296
  v_mfma_f32_16x16x32_bf16 v[40:43], a[92:95], v[32:35], v[40:43]
  v_mfma_f32_16x16x32_bf16 v[48:51], a[220:223], v[32:35], v[48:51]
  v_mfma_f32_16x16x32_bf16 v[52:55], v[28:31], v[220:223], v[52:55]
  v_mfma_f32_16x16x32_bf16 v[56:59], v[32:35], v[220:223], v[56:59]
  s_waitcnt lgkmcnt(4)
  v_mfma_f32_16x16x32_bf16 v[36:39], a[96:99], v[4:7], v[36:39]
  ds_read_b128 v[28:31], v82 offset:53248
  v_mfma_f32_16x16x32_bf16 v[44:47], a[224:227], v[4:7], v[44:47]
  ds_read_b128 v[32:35], v82 offset:55296
  v_mfma_f32_16x16x32_bf16 v[40:43], a[96:99], v[8:11], v[40:43]
  v_mfma_f32_16x16x32_bf16 v[48:51], a[224:227], v[8:11], v[48:51]
  v_mfma_f32_16x16x32_bf16 v[52:55], v[4:7], v[224:227], v[52:55]
  v_mfma_f32_16x16x32_bf16 v[56:59], v[8:11], v[224:227], v[56:59]
  s_waitcnt lgkmcnt(4)
  v_mfma_f32_16x16x32_bf16 v[36:39], a[100:103], v[12:15], v[36:39]
  ds_read_b128 v[4:7], v81 offset:57344
  v_mfma_f32_16x16x32_bf16 v[44:47], a[228:231], v[12:15], v[44:47]
  ds_read_b128 v[8:11], v81 offset:59392
  v_mfma_f32_16x16x32_bf16 v[40:43], a[100:103], v[16:19], v[40:43]
  v_mfma_f32_16x16x32_bf16 v[48:51], a[228:231], v[16:19], v[48:51]
  v_mfma_f32_16x16x32_bf16 v[52:55], v[12:15], v[228:231], v[52:55]
  v_mfma_f32_16x16x32_bf16 v[56:59], v[16:19], v[228:231], v[56:59]
  s_waitcnt lgkmcnt(4)
  v_mfma_f32_16x16x32_bf16 v[36:39], a[104:107], v[20:23], v[36:39]
  ds_read_b128 v[12:15], v82 offset:57344
  v_mfma_f32_16x16x32_bf16 v[44:47], a[232:235], v[20:23], v[44:47]
  ds_read_b128 v[16:19], v82 offset:59392
  v_mfma_f32_16x16x32_bf16 v[40:43], a[104:107], v[24:27], v[40:43]
  v_mfma_f32_16x16x32_bf16 v[48:51], a[232:235], v[24:27], v[48:51]
  v_mfma_f32_16x16x32_bf16 v[52:55], v[20:23], v[232:235], v[52:55]
  v_mfma_f32_16x16x32_bf16 v[56:59], v[24:27], v[232:235], v[56:59]
  s_waitcnt lgkmcnt(4)
  v_mfma_f32_16x16x32_bf16 v[36:39], a[108:111], v[28:31], v[36:39]
  ds_read_b128 v[20:23], v81 offset:61440
  v_mfma_f32_16x16x32_bf16 v[44:47], a[236:239], v[28:31], v[44:47]
  ds_read_b128 v[24:27], v81 offset:63488
  v_mfma_f32_16x16x32_bf16 v[40:43], a[108:111], v[32:35], v[40:43]
  v_mfma_f32_16x16x32_bf16 v[48:51], a[236:239], v[32:35], v[48:51]
  v_mfma_f32_16x16x32_bf16 v[52:55], v[28:31], v[236:239], v[52:55]
  v_mfma_f32_16x16x32_bf16 v[56:59], v[32:35], v[236:239], v[56:59]
  s_waitcnt lgkmcnt(4)
  v_mfma_f32_16x16x32_bf16 v[36:39], a[112:115], v[4:7], v[36:39]
  ds_read_b128 v[28:31], v82 offset:61440
  v_mfma_f32_16x16x32_bf16 v[44:47], a[240:243], v[4:7], v[44:47]
  ds_read_b128 v[32:35], v82 offset:63488
  v_mfma_f32_16x16x32_bf16 v[40:43], a[112:115], v[8:11], v[40:43]
  v_mfma_f32_16x16x32_bf16 v[48:51], a[240:243], v[8:11], v[48:51]
  v_mfma_f32_16x16x32_bf16 v[52:55], v[4:7], v[240:243], v[52:55]
  v_mfma_f32_16x16x32_bf16 v[56:59], v[8:11], v[240:243], v[56:59]
  s_waitcnt vmcnt(0)
  s_barrier
  v_xor_b32 v81, 0x10000, v81
  v_xor_b32 v82, 0x10000, v82
  s_waitcnt lgkmcnt(4)
  v_mfma_f32_16x16x32_bf16 v[36:39], a[116:119], v[12:15], v[36:39]
  ds_read_b128 v[4:7], v81 offset:0
  v_mfma_f32_16x16x32_bf16 v[44:47], a[244:247], v[12:15], v[44:47]
  ds_read_b128 v[8:11], v81 offset:2048
  v_mfma_f32_16x16x32_bf16 v[40:43], a[116:119], v[16:19], v[40:43]
  v_mfma_f32_16x16x32_bf16 v[48:51], a[244:247], v[16:19], v[48:51]
  v_mfma_f32_16x16x32_bf16 v[52:55], v[12:15], v[244:247], v[52:55]
  v_mfma_f32_16x16x32_bf16 v[56:59], v[16:19], v[244:247], v[56:59]
  s_waitcnt lgkmcnt(4)
  v_mfma_f32_16x16x32_bf16 v[36:39], a[120:123], v[20:23], v[36:39]
  ds_read_b128 v[12:15], v82 offset:0
  v_mfma_f32_16x16x32_bf16 v[44:47], a[248:251], v[20:23], v[44:47]
  ds_read_b128 v[16:19], v82 offset:2048
  v_mfma_f32_16x16x32_bf16 v[40:43], a[120:123], v[24:27], v[40:43]
  v_mfma_f32_16x16x32_bf16 v[48:51], a[248:251], v[24:27], v[48:51]
  v_mfma_f32_16x16x32_bf16 v[52:55], v[20:23], v[248:251], v[52:55]
  v_mfma_f32_16x16x32_bf16 v[56:59], v[24:27], v[248:251], v[56:59]
  s_waitcnt lgkmcnt(4)
  v_mfma_f32_16x16x32_bf16 v[36:39], a[124:127], v[28:31], v[36:39]
  ds_read_b128 v[20:23], v81 offset:4096
  v_mfma_f32_16x16x32_bf16 v[44:47], a[252:255], v[28:31], v[44:47]
  ds_read_b128 v[24:27], v81 offset:6144
  v_mfma_f32_16x16x32_bf16 v[40:43], a[124:127], v[32:35], v[40:43]
  v_mfma_f32_16x16x32_bf16 v[48:51], a[252:255], v[32:35], v[48:51]
  v_mfma_f32_16x16x32_bf16 v[52:55], v[28:31], v[252:255], v[52:55]
  v_mfma_f32_16x16x32_bf16 v[56:59], v[32:35], v[252:255], v[56:59]
  s_mov_b32 s37, s31
  s_add_u32 s31, s31, 2097152
  s_xor_b32 s31, s31, 0x2000
  s_add_u32 s25, s25, 1
  s_cmp_lt_u32 s25, 64
  s_cbranch_scc1 L_QKV_top
  v_cvt_pk_bf16_f32 v60, v36, v37
  v_cvt_pk_bf16_f32 v61, v38, v39
  v_cvt_pk_bf16_f32 v62, v44, v45
  v_cvt_pk_bf16_f32 v63, v46, v47
  v_cvt_pk_bf16_f32 v64, v40, v41
  v_cvt_pk_bf16_f32 v65, v42, v43
  v_cvt_pk_bf16_f32 v66, v48, v49
  v_cvt_pk_bf16_f32 v67, v50, v51
  v_cvt_pk_bf16_f32 v68, v52, v53
  v_cvt_pk_bf16_f32 v69, v54, v55
  v_cvt_pk_bf16_f32 v70, v56, v57
  v_cvt_pk_bf16_f32 v71, v58, v59
  buffer_store_dwordx4 v[60:63], v76, s[4:7], s37 offen offset:0 sc1
  buffer_store_dwordx4 v[64:67], v76, s[4:7], s37 offen offset:1024 sc1
  buffer_store_dwordx4 v[68:71], v83, s[4:7], s37 offen sc1
  s_waitcnt vmcnt(0) lgkmcnt(0)
  s_barrier
  s_cmp_lg_u32 s20, 0
  s_cbranch_scc1 Lnosig_33
  s_mov_b32 s63, s25
  s_atomic_smax s63, s[4:5], s62 glc
Lnosig_33:
  s_branch L_END
L_WO:
  v_lshlrev_b32 v1, 4, v0
  s_lshl_b32 s32, s20, 12
  s_min_u32 s33, s32, 0x2000
  v_mov_b32 v69, v1
  v_add_u32 v70, 0x10000, v69
  s_load_dwordx2 s[8:9], s[0:1], 40
  s_mov_b32 s10, 8388608
  s_mov_b32 s11, 0x20000
  s_waitcnt lgkmcnt(0)
  s_lshr_b32 s44, s21, 3
  s_mul_i32 s44, s44, 2097152
  s_and_b32 s45, s21, 7
  s_lshl_b32 s45, s45, 8
  s_add_u32 s44, s44, s45
  s_add_u32 s45, s44, 128
  v_bfe_u32 v4, v0, 5, 1
  v_mul_u32_u24 v4, 8192, v4
  v_bfe_u32 v5, v0, 4, 1
  v_mul_u32_u24 v5, 4096, v5
  v_add_u32 v4, v4, v5
  v_bfe_u32 v5, v0, 3, 1
  v_mul_u32_u24 v5, 2048, v5
  v_add_u32 v4, v4, v5
  v_lshrrev_b32 v5, 3, v0
  v_and_b32 v5, 6, v5
  v_xor_b32 v5, v5, v0
  v_and_b32 v5, 7, v5
  v_lshl_add_u32 v4, v5, 4, v4
  s_lshr_b32 s40, s20, 1
  s_mul_i32 s40, s40, 131072
  s_and_b32 s41, s20, 1
  s_mul_i32 s41, s41, 16384
  s_add_u32 s40, s40, s41
  v_add_u32 v4, s40, v4
  v_bfe_u32 v5, v0, 3, 2
  v_xor_b32 v5, s20, v5
  v_lshlrev_b32 v5, 5, v5
  v_lshrrev_b32 v6, 2, v0
  v_lshl_add_u32 v6, v6, 7, v5
  v_and_b32 v5, 3, v0
  v_lshl_add_u32 v6, v5, 3, v6
  v_add_u32 v7, 0x10000, v6
  v_add_u32 v8, s44, v4
  v_add_u32 v9, s45, v4
  s_lshl_b32 s41, s20, 10
  s_add_u32 m0, s41, 0
  s_mov_b32 s42, 0
  buffer_load_dwordx4 v8, s[8:11], s42 offen nt lds
  s_add_u32 m0, s41, 4096
  s_mov_b32 s42, 0
  buffer_load_dwordx4 v9, s[8:11], s42 offen nt lds
  s_add_u32 m0, s41, 8192
  s_mov_b32 s42, 32768
  buffer_load_dwordx4 v8, s[8:11], s42 offen nt lds
  s_add_u32 m0, s41, 12288
  s_mov_b32 s42, 32768
  buffer_load_dwordx4 v9, s[8:11], s42 offen nt lds
  s_add_u32 m0, s41, 16384
  s_mov_b32 s42, 65536
  buffer_load_dwordx4 v8, s[8:11], s42 offen nt lds
  s_add_u32 m0, s41, 20480
  s_mov_b32 s42, 65536
  buffer_load_dwordx4 v9, s[8:11], s42 offen nt lds
  s_add_u32 m0, s41, 24576
  s_mov_b32 s42, 98304
  buffer_load_dwordx4 v8, s[8:11], s42 offen nt lds
  s_add_u32 m0, s41, 28672
  s_mov_b32 s42, 98304
  buffer_load_dwordx4 v9, s[8:11], s42 offen nt lds
  s_add_u32 m0, s41, 32768
  s_mov_b32 s42, 262144
  buffer_load_dwordx4 v8, s[8:11], s42 offen nt lds
  s_add_u32 m0, s41, 36864
  s_mov_b32 s42, 262144
  buffer_load_dwordx4 v9, s[8:11], s42 offen nt lds
  s_add_u32 m0, s41, 40960
  s_mov_b32 s42, 294912
  buffer_load_dwordx4 v8, s[8:11], s42 offen nt lds
  s_add_u32 m0, s41, 45056
  s_mov_b32 s42, 294912
  buffer_load_dwordx4 v9, s[8:11], s42 offen nt lds
  s_add_u32 m0, s41, 49152
  s_mov_b32 s42, 327680
  buffer_load_dwordx4 v8, s[8:11], s42 offen nt lds
  s_add_u32 m0, s41, 53248
  s_mov_b32 s42, 327680
  buffer_load_dwordx4 v9, s[8:11], s42 offen nt lds
  s_add_u32 m0, s41, 57344
  s_mov_b32 s42, 360448
  buffer_load_dwordx4 v8, s[8:11], s42 offen nt lds
  s_add_u32 m0, s41, 61440
  s_mov_b32 s42, 360448
  buffer_load_dwordx4 v9, s[8:11], s42 offen nt lds
  s_add_u32 m0, s41, 65536
  s_mov_b32 s42, 524288
  buffer_load_dwordx4 v8, s[8:11], s42 offen nt lds
  s_add_u32 m0, s41, 69632
  s_mov_b32 s42, 524288
  buffer_load_dwordx4 v9, s[8:11], s42 offen nt lds
  s_add_u32 m0, s41, 73728
  s_mov_b32 s42, 557056
  buffer_load_dwordx4 v8, s[8:11], s42 offen nt lds
  s_add_u32 m0, s41, 77824
  s_mov_b32 s42, 557056
  buffer_load_dwordx4 v9, s[8:11], s42 offen nt lds
  s_add_u32 m0, s41, 81920
  s_mov_b32 s42, 589824
  buffer_load_dwordx4 v8, s[8:11], s42 offen nt lds
  s_add_u32 m0, s41, 86016
  s_mov_b32 s42, 589824
  buffer_load_dwordx4 v9, s[8:11], s42 offen nt lds
  s_add_u32 m0, s41, 90112
  s_mov_b32 s42, 622592
  buffer_load_dwordx4 v8, s[8:11], s42 offen nt lds
  s_add_u32 m0, s41, 94208
  s_mov_b32 s42, 622592
  buffer_load_dwordx4 v9, s[8:11], s42 offen nt lds
  s_add_u32 m0, s41, 98304
  s_mov_b32 s42, 786432
  buffer_load_dwordx4 v8, s[8:11], s42 offen nt lds
  s_add_u32 m0, s41, 102400
  s_mov_b32 s42, 786432
  buffer_load_dwordx4 v9, s[8:11], s42 offen nt lds
  s_add_u32 m0, s41, 106496
  s_mov_b32 s42, 819200
  buffer_load_dwordx4 v8, s[8:11], s42 offen nt lds
  s_add_u32 m0, s41, 110592
  s_mov_b32 s42, 819200
  buffer_load_dwordx4 v9, s[8:11], s42 offen nt lds
  s_waitcnt vmcnt(24) lgkmcnt(0)
  s_barrier
  s_add_u32 m0, s41, 114688
  s_mov_b32 s42, 851968
  buffer_load_dwordx4 v8, s[8:11], s42 offen nt lds
  s_add_u32 m0, s41, 118784
  s_mov_b32 s42, 851968
  buffer_load_dwordx4 v9, s[8:11], s42 offen nt lds
  s_add_u32 m0, s41, 122880
  s_mov_b32 s42, 884736
  buffer_load_dwordx4 v8, s[8:11], s42 offen nt lds
  s_add_u32 m0, s41, 126976
  s_mov_b32 s42, 884736
  buffer_load_dwordx4 v9, s[8:11], s42 offen nt lds
  ds_read_b64_tr_b16 a[0:1], v6 offset:0
  ds_read_b64_tr_b16 a[2:3], v6 offset:2048
  ds_read_b64_tr_b16 a[128:129], v6 offset:4096
  ds_read_b64_tr_b16 a[130:131], v6 offset:6144
  ds_read_b64_tr_b16 a[4:5], v6 offset:8192
  ds_read_b64_tr_b16 a[6:7], v6 offset:10240
  ds_read_b64_tr_b16 a[132:133], v6 offset:12288
  ds_read_b64_tr_b16 a[134:135], v6 offset:14336
  s_waitcnt vmcnt(24) lgkmcnt(0)
  s_barrier
  s_add_u32 m0, s41, 0
  s_mov_b32 s42, 1048576
  buffer_load_dwordx4 v8, s[8:11], s42 offen nt lds
  s_add_u32 m0, s41, 4096
  s_mov_b32 s42, 1048576
  buffer_load_dwordx4 v9, s[8:11], s42 offen nt lds
  s_add_u32 m0, s41, 8192
  s_mov_b32 s42, 1081344
  buffer_load_dwordx4 v8, s[8:11], s42 offen nt lds
  s_add_u32 m0, s41, 12288
  s_mov_b32 s42, 1081344
  buffer_load_dwordx4 v9, s[8:11], s42 offen nt lds
  ds_read_b64_tr_b16 a[8:9], v6 offset:16384
  ds_read_b64_tr_b16 a[10:11], v6 offset:18432
  ds_read_b64_tr_b16 a[136:137], v6 offset:20480
  ds_read_b64_tr_b16 a[138:139], v6 offset:22528
  ds_read_b64_tr_b16 a[12:13], v6 offset:24576
  ds_read_b64_tr_b16 a[14:15], v6 offset:26624
  ds_read_b64_tr_b16 a[140:141], v6 offset:28672
  ds_read_b64_tr_b16 a[142:143], v6 offset:30720
  s_waitcnt vmcnt(24) lgkmcnt(0)
  s_barrier
  s_add_u32 m0, s41, 16384
  s_mov_b32 s42, 1114112
  buffer_load_dwordx4 v8, s[8:11], s42 offen nt lds
  s_add_u32 m0, s41, 20480
  s_mov_b32 s42, 1114112
  buffer_load_dwordx4 v9, s[8:11], s42 offen nt lds
  s_add_u32 m0, s41, 24576
  s_mov_b32 s42, 1146880
  buffer_load_dwordx4 v8, s[8:11], s42 offen nt lds
  s_add_u32 m0, s41, 28672
  s_mov_b32 s42, 1146880
  buffer_load_dwordx4 v9, s[8:11], s42 offen nt lds
  ds_read_b64_tr_b16 a[16:17], v6 offset:32768
  ds_read_b64_tr_b16 a[18:19], v6 offset:34816
  ds_read_b64_tr_b16 a[144:145], v6 offset:36864
  ds_read_b64_tr_b16 a[146:147], v6 offset:38912
  ds_read_b64_tr_b16 a[20:21], v6 offset:40960
  ds_read_b64_tr_b16 a[22:23], v6 offset:43008
  ds_read_b64_tr_b16 a[148:149], v6 offset:45056
  ds_read_b64_tr_b16 a[150:151], v6 offset:47104
  s_waitcnt vmcnt(24) lgkmcnt(0)
  s_barrier
  s_add_u32 m0, s41, 32768
  s_mov_b32 s42, 1310720
  buffer_load_dwordx4 v8, s[8:11], s42 offen nt lds
  s_add_u32 m0, s41, 36864
  s_mov_b32 s42, 1310720
  buffer_load_dwordx4 v9, s[8:11], s42 offen nt lds
  s_add_u32 m0, s41, 40960
  s_mov_b32 s42, 1343488
  buffer_load_dwordx4 v8, s[8:11], s42 offen nt lds
  s_add_u32 m0, s41, 45056
  s_mov_b32 s42, 1343488
  buffer_load_dwordx4 v9, s[8:11], s42 offen nt lds
  ds_read_b64_tr_b16 a[24:25], v6 offset:49152
  ds_read_b64_tr_b16 a[26:27], v6 offset:51200
  ds_read_b64_tr_b16 a[152:153], v6 offset:53248
  ds_read_b64_tr_b16 a[154:155], v6 offset:55296
  ds_read_b64_tr_b16 a[28:29], v6 offset:57344
  ds_read_b64_tr_b16 a[30:31], v6 offset:59392
  ds_read_b64_tr_b16 a[156:157], v6 offset:61440
  ds_read_b64_tr_b16 a[158:159], v6 offset:63488
  s_waitcnt vmcnt(24) lgkmcnt(0)
  s_barrier
  s_add_u32 m0, s41, 49152
  s_mov_b32 s42, 1376256
  buffer_load_dwordx4 v8, s[8:11], s42 offen nt lds
  s_add_u32 m0, s41, 53248
  s_mov_b32 s42, 1376256
  buffer_load_dwordx4 v9, s[8:11], s42 offen nt lds
  s_add_u32 m0, s41, 57344
  s_mov_b32 s42, 1409024
  buffer_load_dwordx4 v8, s[8:11], s42 offen nt lds
  s_add_u32 m0, s41, 61440
  s_mov_b32 s42, 1409024
  buffer_load_dwordx4 v9, s[8:11], s42 offen nt lds
  ds_read_b64_tr_b16 a[32:33], v7 offset:0
  ds_read_b64_tr_b16 a[34:35], v7 offset:2048
  ds_read_b64_tr_b16 a[160:161], v7 offset:4096
  ds_read_b64_tr_b16 a[162:163], v7 offset:6144
  ds_read_b64_tr_b16 a[36:37], v7 offset:8192
  ds_read_b64_tr_b16 a[38:39], v7 offset:10240
  ds_read_b64_tr_b16 a[164:165], v7 offset:12288
  ds_read_b64_tr_b16 a[166:167], v7 offset:14336
  s_waitcnt vmcnt(24) lgkmcnt(0)
  s_barrier
  s_add_u32 m0, s41, 65536
  s_mov_b32 s42, 1572864
  buffer_load_dwordx4 v8, s[8:11], s42 offen nt lds
  s_add_u32 m0, s41, 69632
  s_mov_b32 s42, 1572864
  buffer_load_dwordx4 v9, s[8:11], s42 offen nt lds
  s_add_u32 m0, s41, 73728
  s_mov_b32 s42, 1605632
  buffer_load_dwordx4 v8, s[8:11], s42 offen nt lds
  s_add_u32 m0, s41, 77824
  s_mov_b32 s42, 1605632
  buffer_load_dwordx4 v9, s[8:11], s42 offen nt lds
  ds_read_b64_tr_b16 a[40:41], v7 offset:16384
  ds_read_b64_tr_b16 a[42:43], v7 offset:18432
  ds_read_b64_tr_b16 a[168:169], v7 offset:20480
  ds_read_b64_tr_b16 a[170:171], v7 offset:22528
  ds_read_b64_tr_b16 a[44:45], v7 offset:24576
  ds_read_b64_tr_b16 a[46:47], v7 offset:26624
  ds_read_b64_tr_b16 a[172:173], v7 offset:28672
  ds_read_b64_tr_b16 a[174:175], v7 offset:30720
  s_waitcnt vmcnt(24) lgkmcnt(0)
  s_barrier
  s_add_u32 m0, s41, 81920
  s_mov_b32 s42, 1638400
  buffer_load_dwordx4 v8, s[8:11], s42 offen nt lds
  s_add_u32 m0, s41, 86016
  s_mov_b32 s42, 1638400
  buffer_load_dwordx4 v9, s[8:11], s42 offen nt lds
  s_add_u32 m0, s41, 90112
  s_mov_b32 s42, 1671168
  buffer_load_dwordx4 v8, s[8:11], s42 offen nt lds
  s_add_u32 m0, s41, 94208
  s_mov_b32 s42, 1671168
  buffer_load_dwordx4 v9, s[8:11], s42 offen nt lds
  ds_read_b64_tr_b16 a[48:49], v7 offset:32768
  ds_read_b64_tr_b16 a[50:51], v7 offset:34816
  ds_read_b64_tr_b16 a[176:177], v7 offset:36864
  ds_read_b64_tr_b16 a[178:179], v7 offset:38912
  ds_read_b64_tr_b16 a[52:53], v7 offset:40960
  ds_read_b64_tr_b16 a[54:55], v7 offset:43008
  ds_read_b64_tr_b16 a[180:181], v7 offset:45056
  ds_read_b64_tr_b16 a[182:183], v7 offset:47104
  s_waitcnt vmcnt(24) lgkmcnt(0)
  s_barrier
  s_add_u32 m0, s41, 98304
  s_mov_b32 s42, 1835008
  buffer_load_dwordx4 v8, s[8:11], s42 offen nt lds
  s_add_u32 m0, s41, 102400
  s_mov_b32 s42, 1835008
  buffer_load_dwordx4 v9, s[8:11], s42 offen nt lds
  s_add_u32 m0, s41, 106496
  s_mov_b32 s42, 1867776
  buffer_load_dwordx4 v8, s[8:11], s42 offen nt lds
  s_add_u32 m0, s41, 110592
  s_mov_b32 s42, 1867776
  buffer_load_dwordx4 v9, s[8:11], s42 offen nt lds
  ds_read_b64_tr_b16 a[56:57], v7 offset:49152
  ds_read_b64_tr_b16 a[58:59], v7 offset:51200
  ds_read_b64_tr_b16 a[184:185], v7 offset:53248
  ds_read_b64_tr_b16 a[186:187], v7 offset:55296
  ds_read_b64_tr_b16 a[60:61], v7 offset:57344
  ds_read_b64_tr_b16 a[62:63], v7 offset:59392
  ds_read_b64_tr_b16 a[188:189], v7 offset:61440
  ds_read_b64_tr_b16 a[190:191], v7 offset:63488
  s_waitcnt vmcnt(24) lgkmcnt(0)
  s_barrier
  s_add_u32 m0, s41, 114688
  s_mov_b32 s42, 1900544
  buffer_load_dwordx4 v8, s[8:11], s42 offen nt lds
  s_add_u32 m0, s41, 118784
  s_mov_b32 s42, 1900544
  buffer_load_dwordx4 v9, s[8:11], s42 offen nt lds
  s_add_u32 m0, s41, 122880
  s_mov_b32 s42, 1933312
  buffer_load_dwordx4 v8, s[8:11], s42 offen nt lds
  s_add_u32 m0, s41, 126976
  s_mov_b32 s42, 1933312
  buffer_load_dwordx4 v9, s[8:11], s42 offen nt lds
  ds_read_b64_tr_b16 a[64:65], v6 offset:0
  ds_read_b64_tr_b16 a[66:67], v6 offset:2048
  ds_read_b64_tr_b16 a[192:193], v6 offset:4096
  ds_read_b64_tr_b16 a[194:195], v6 offset:6144
  ds_read_b64_tr_b16 a[68:69], v6 offset:8192
  ds_read_b64_tr_b16 a[70:71], v6 offset:10240
  ds_read_b64_tr_b16 a[196:197], v6 offset:12288
  ds_read_b64_tr_b16 a[198:199], v6 offset:14336
  s_waitcnt vmcnt(24) lgkmcnt(0)
  s_barrier
  ds_read_b64_tr_b16 a[72:73], v6 offset:16384
  ds_read_b64_tr_b16 a[74:75], v6 offset:18432
  ds_read_b64_tr_b16 a[200:201], v6 offset:20480
  ds_read_b64_tr_b16 a[202:203], v6 offset:22528
  ds_read_b64_tr_b16 a[76:77], v6 offset:24576
  ds_read_b64_tr_b16 a[78:79], v6 offset:26624
  ds_read_b64_tr_b16 a[204:205], v6 offset:28672
  ds_read_b64_tr_b16 a[206:207], v6 offset:30720
  s_waitcnt vmcnt(20) lgkmcnt(0)
  s_barrier
  ds_read_b64_tr_b16 a[80:81], v6 offset:32768
  ds_read_b64_tr_b16 a[82:83], v6 offset:34816
  ds_read_b64_tr_b16 a[208:209], v6 offset:36864
  ds_read_b64_tr_b16 a[210:211], v6 offset:38912
  ds_read_b64_tr_b16 a[84:85], v6 offset:40960
  ds_read_b64_tr_b16 a[86:87], v6 offset:43008
  ds_read_b64_tr_b16 a[212:213], v6 offset:45056
  ds_read_b64_tr_b16 a[214:215], v6 offset:47104
  s_waitcnt vmcnt(16) lgkmcnt(0)
  s_barrier
  ds_read_b64_tr_b16 a[88:89], v6 offset:49152
  ds_read_b64_tr_b16 a[90:91], v6 offset:51200
  ds_read_b64_tr_b16 a[216:217], v6 offset:53248
  ds_read_b64_tr_b16 a[218:219], v6 offset:55296
  ds_read_b64_tr_b16 a[92:93], v6 offset:57344
  ds_read_b64_tr_b16 a[94:95], v6 offset:59392
  ds_read_b64_tr_b16 a[220:221], v6 offset:61440
  ds_read_b64_tr_b16 a[222:223], v6 offset:63488
  s_waitcnt vmcnt(12) lgkmcnt(0)
  s_barrier
  ds_read_b64_tr_b16 a[96:97], v7 offset:0
  ds_read_b64_tr_b16 a[98:99], v7 offset:2048
  ds_read_b64_tr_b16 a[224:225], v7 offset:4096
  ds_read_b64_tr_b16 a[226:227], v7 offset:6144
  ds_read_b64_tr_b16 a[100:101], v7 offset:8192
  ds_read_b64_tr_b16 a[102:103], v7 offset:10240
  ds_read_b64_tr_b16 a[228:229], v7 offset:12288
  ds_read_b64_tr_b16 a[230:231], v7 offset:14336
  s_waitcnt vmcnt(8) lgkmcnt(0)
  s_barrier
  ds_read_b64_tr_b16 a[104:105], v7 offset:16384
  ds_read_b64_tr_b16 a[106:107], v7 offset:18432
  ds_read_b64_tr_b16 a[232:233], v7 offset:20480
  ds_read_b64_tr_b16 a[234:235], v7 offset:22528
  ds_read_b64_tr_b16 a[108:109], v7 offset:24576
  ds_read_b64_tr_b16 a[110:111], v7 offset:26624
  ds_read_b64_tr_b16 a[236:237], v7 offset:28672
  ds_read_b64_tr_b16 a[238:239], v7 offset:30720
  s_waitcnt vmcnt(4) lgkmcnt(0)
  s_barrier
  ds_read_b64_tr_b16 a[112:113], v7 offset:32768
  ds_read_b64_tr_b16 a[114:115], v7 offset:34816
  ds_read_b64_tr_b16 a[240:241], v7 offset:36864
  ds_read_b64_tr_b16 a[242:243], v7 offset:38912
  ds_read_b64_tr_b16 a[116:117], v7 offset:40960
  ds_read_b64_tr_b16 a[118:119], v7 offset:43008
  ds_read_b64_tr_b16 a[244:245], v7 offset:45056
  ds_read_b64_tr_b16 a[246:247], v7 offset:47104
  s_waitcnt vmcnt(0) lgkmcnt(0)
  s_barrier
  ds_read_b64_tr_b16 a[120:121], v7 offset:49152
  ds_read_b64_tr_b16 a[122:123], v7 offset:51200
  ds_read_b64_tr_b16 a[248:249], v7 offset:53248
  ds_read_b64_tr_b16 a[250:251], v7 offset:55296
  ds_read_b64_tr_b16 a[124:125], v7 offset:57344
  ds_read_b64_tr_b16 a[126:127], v7 offset:59392
  ds_read_b64_tr_b16 a[252:253], v7 offset:61440
  ds_read_b64_tr_b16 a[254:255], v7 offset:63488
  s_waitcnt lgkmcnt(0)
  s_barrier
  s_and_b32 s43, s21, 24
  v_min_u32 v2, 7, v0
  v_add_u32 v2, s43, v2
  v_lshlrev_b32 v2, 7, v2
  v_add_u32 v2, 1404928, v2
  s_lshl_b32 s62, s21, 7
  s_add_u32 s62, s62, 1409024
  v_min_u32 v52, 63, v0
  v_lshlrev_b32 v52, 7, v52
  v_add_u32 v52, 1424384, v52
  s_nop 1
Lpoll_34:
  buffer_load_dword v53, v52, s[4:7], 0 offen sc1
  s_sub_u32 s24, s24, 1
  s_cbranch_scc1 L_FAIL
  s_waitcnt vmcnt(0)
  v_cmp_gt_i32 vcc, 0, v53
  s_cbranch_vccz Lpolld_35
  s_sleep 1
  s_branch Lpoll_34
Lpolld_35:
  v_lshrrev_b32 v53, 8, v53
  v_and_b32 v54, 3, v0
  v_lshl_or_b32 v53, v53, 2, v54
  s_nop 1
  v_min_u32_dpp v53, v53, v53 row_ror:8 row_mask:0xf bank_mask:0xf
  s_nop 1
  v_min_u32_dpp v53, v53, v53 row_ror:4 row_mask:0xf bank_mask:0xf
  v_mov_b32 v54, v53
  s_nop 1
  v_permlane16_swap_b32 v54, v53
  v_min_u32 v53, v53, v54
  v_mov_b32 v54, v53
  s_nop 1
  v_permlane32_swap_b32 v54, v53
  v_min_u32 v53, v53, v54
  s_nop 1
  v_min_u32_dpp v53, v53, v53 row_ror:2 row_mask:0xf bank_mask:0xf
  s_nop 1
  v_min_u32_dpp v53, v53, v53 row_ror:1 row_mask:0xf bank_mask:0xf
  s_nop 0
  v_readfirstlane_b32 s38, v53
  s_and_b32 s38, s38, 3
  s_lshl_b32 s38, s38, 13
  s_and_b32 s38, s38, 0x2000
  s_xor_b32 s38, s38, 16785408
  s_xor_b32 s27, s38, 0x2000
  s_lshr_b32 s40, s20, 1
  s_add_u32 s40, s40, s43
  s_mul_i32 s40, s40, 65536
  s_and_b32 s41, s20, 1
  s_lshl_b32 s41, s41, 12
  s_add_u32 s40, s40, s41
  s_add_u32 s40, s40, 49152
  s_add_u32 s27, s27, s40
  s_lshl_b32 s40, s21, 14
  s_add_u32 s40, s40, s38
  s_add_u32 s31, s40, 0
  s_lshl_b32 s40, s20, 11
  v_and_b32 v68, 3, v0
  v_lshlrev_b32 v68, 4, v68
  v_lshrrev_b32 v52, 4, v0
  v_lshl_add_u32 v68, v52, 6, v68
  v_bfe_u32 v52, v0, 2, 2
  v_lshl_add_u32 v68, v52, 8, v68
  v_add_u32 v68, s40, v68
  v_lshlrev_b32 v71, 2, v0
  v_add_u32 v71, 131072, v71
  s_mov_b32 s25, 0
  s_mov_b32 s26, 0
  s_mov_b32 s29, 1
  s_mov_b32 s30, 0
  s_mov_b32 s28, 0
L_WO_top:
  s_cmp_eq_u32 s28, 1
  s_cbranch_scc1 L_WO_go
  s_cmp_eq_u32 s28, 2
  s_cbranch_scc1 L_WO_mid
  s_cmp_lg_u32 s20, 0
  s_cbranch_scc1 L_WO_park
  buffer_load_dword v3, v2, s[4:7], s30 offen sc1
  s_waitcnt vmcnt(1)
  s_barrier
  s_mov_b32 s63, s25
  s_atomic_smax s63, s[4:5], s62 glc
Lnosig_36:
  s_cmp_ge_u32 s25, 64
  s_cbranch_scc1 L_END
  s_waitcnt vmcnt(0)
  v_cmp_gt_i32 vcc, s29, v3
  s_cbranch_vccz L_WO_issue
  s_nop 3
Lpoll_37:
  buffer_load_dword v3, v2, s[4:7], s30 offen sc1
  s_sub_u32 s24, s24, 1
  s_cbranch_scc1 L_FAIL
  s_waitcnt vmcnt(0)
  v_cmp_gt_i32 vcc, s29, v3
  s_cbranch_vccz Lpolld_38
  s_sleep 1
  s_branch Lpoll_37
Lpolld_38:
  s_branch L_WO_issue
L_WO_park:
  s_waitcnt vmcnt(0)
  s_barrier
  s_cmp_ge_u32 s25, 64
  s_cbranch_scc1 L_END
L_WO_issue:
  s_barrier
L_WO_mid:
  s_mov_b32 s34, s26
  s_mov_b32 s35, s27
  s_add_u32 s36, s32, 0
  s_add_u32 m0, s34, s36
  s_add_u32 s36, s35, 0
  buffer_load_dwordx4 v1, s[4:7], s36 offen offset:0 sc1 lds
  s_nop 0
  buffer_load_dwordx4 v1, s[4:7], s36 offen offset:1024 sc1 lds
  s_nop 0
  buffer_load_dwordx4 v1, s[4:7], s36 offen offset:2048 sc1 lds
  s_nop 0
  buffer_load_dwordx4 v1, s[4:7], s36 offen offset:3072 sc1 lds
  s_nop 0
  s_add_u32 s36, s32, 16384
  s_add_u32 m0, s34, s36
  s_add_u32 s36, s35, 131072
  buffer_load_dwordx4 v1, s[4:7], s36 offen offset:0 sc1 lds
  s_nop 0
  buffer_load_dwordx4 v1, s[4:7], s36 offen offset:1024 sc1 lds
  s_nop 0
  buffer_load_dwordx4 v1, s[4:7], s36 offen offset:2048 sc1 lds
  s_nop 0
  buffer_load_dwordx4 v1, s[4:7], s36 offen offset:3072 sc1 lds
  s_nop 0
  s_add_u32 s36, s32, 32768
  s_add_u32 m0, s34, s36
  s_add_u32 s36, s35, 262144
  buffer_load_dwordx4 v1, s[4:7], s36 offen offset:0 sc1 lds
  s_nop 0
  buffer_load_dwordx4 v1, s[4:7], s36 offen offset:1024 sc1 lds
  s_nop 0
  buffer_load_dwordx4 v1, s[4:7], s36 offen offset:2048 sc1 lds
  s_nop 0
  buffer_load_dwordx4 v1, s[4:7], s36 offen offset:3072 sc1 lds
  s_nop 0
  s_cmp_eq_u32 s28, 0
  s_cbranch_scc1 L_WO_go
  s_mov_b32 s28, 0
  s_waitcnt vmcnt(12)
  s_barrier
  s_cmp_lg_u32 s20, 0
  s_cbranch_scc1 Lnosig_39
  s_mov_b32 s63, s25
  s_atomic_smax s63, s[4:5], s62 glc
Lnosig_39:
L_WO_go:
  v_add_u32 v73, s26, v69
  v_add_u32 v74, s26, v70
  s_sub_u32 s26, 65536, s26
  s_add_u32 s27, s27, 2097152
  s_xor_b32 s27, s27, 0x2000
  s_add_u32 s29, s29, 1
  s_waitcnt vmcnt(8)
  s_barrier
  ds_read_b128 v[4:7], v73 offset:0
  ds_read_b128 v[8:11], v73 offset:1024
  ds_read_b128 v[12:15], v73 offset:2048
  ds_read_b128 v[16:19], v73 offset:3072
  ds_read_b128 v[20:23], v73 offset:4096
  ds_read_b128 v[24:27], v73 offset:5120
  s_waitcnt lgkmcnt(4)
  v_mfma_f32_16x16x32_bf16 v[36:39], a[0:3], v[4:7], 0
  ds_read_b128 v[28:31], v73 offset:6144
  v_mfma_f32_16x16x32_bf16 v[40:43], a[0:3], v[8:11], 0
  ds_read_b128 v[32:35], v73 offset:7168
  v_mfma_f32_16x16x32_bf16 v[44:47], a[128:131], v[4:7], 0
  s_add_u32 s36, s32, 49152
  s_add_u32 m0, s34, s36
  s_add_u32 s36, s35, 393216
  buffer_load_dwordx4 v1, s[4:7], s36 offen offset:0 sc1 lds
  v_mfma_f32_16x16x32_bf16 v[48:51], a[128:131], v[8:11], 0
  s_waitcnt lgkmcnt(4)
  v_mfma_f32_16x16x32_bf16 v[36:39], a[4:7], v[12:15], v[36:39]
  ds_read_b128 v[4:7], v73 offset:8192
  v_mfma_f32_16x16x32_bf16 v[40:43], a[4:7], v[16:19], v[40:43]
  ds_read_b128 v[8:11], v73 offset:9216
  v_mfma_f32_16x16x32_bf16 v[44:47], a[132:135], v[12:15], v[44:47]
  buffer_load_dwordx4 v1, s[4:7], s36 offen offset:1024 sc1 lds
  v_mfma_f32_16x16x32_bf16 v[48:51], a[132:135], v[16:19], v[48:51]
  s_waitcnt lgkmcnt(4)
  v_mfma_f32_16x16x32_bf16 v[36:39], a[8:11], v[20:23], v[36:39]
  ds_read_b128 v[12:15], v73 offset:10240
  v_mfma_f32_16x16x32_bf16 v[40:43], a[8:11], v[24:27], v[40:43]
  ds_read_b128 v[16:19], v73 offset:11264
  v_mfma_f32_16x16x32_bf16 v[44:47], a[136:139], v[20:23], v[44:47]
  buffer_load_dwordx4 v1, s[4:7], s36 offen offset:2048 sc1 lds
  v_mfma_f32_16x16x32_bf16 v[48:51], a[136:139], v[24:27], v[48:51]
  s_waitcnt lgkmcnt(4)
  v_mfma_f32_16x16x32_bf16 v[36:39], a[12:15], v[28:31], v[36:39]
  ds_read_b128 v[20:23], v73 offset:12288
  v_mfma_f32_16x16x32_bf16 v[40:43], a[12:15], v[32:35], v[40:43]
  ds_read_b128 v[24:27], v73 offset:13312
  v_mfma_f32_16x16x32_bf16 v[44:47], a[140:143], v[28:31], v[44:47]
  buffer_load_dwordx4 v1, s[4:7], s36 offen offset:3072 sc1 lds
  v_mfma_f32_16x16x32_bf16 v[48:51], a[140:143], v[32:35], v[48:51]
  s_waitcnt lgkmcnt(4)
  v_mfma_f32_16x16x32_bf16 v[36:39], a[16:19], v[4:7], v[36:39]
  ds_read_b128 v[28:31], v73 offset:14336
  v_mfma_f32_16x16x32_bf16 v[40:43], a[16:19], v[8:11], v[40:43]
  ds_read_b128 v[32:35], v73 offset:15360
  v_mfma_f32_16x16x32_bf16 v[44:47], a[144:147], v[4:7], v[44:47]
  v_mfma_f32_16x16x32_bf16 v[48:51], a[144:147], v[8:11], v[48:51]
  s_waitcnt vmcnt(8)
  s_barrier
  s_mov_b32 s34, s26
  s_mov_b32 s35, s27
  s_waitcnt lgkmcnt(4)
  v_mfma_f32_16x16x32_bf16 v[36:39], a[20:23], v[12:15], v[36:39]
  ds_read_b128 v[4:7], v73 offset:16384
  v_mfma_f32_16x16x32_bf16 v[40:43], a[20:23], v[16:19], v[40:43]
  ds_read_b128 v[8:11], v73 offset:17408
  v_mfma_f32_16x16x32_bf16 v[44:47], a[148:151], v[12:15], v[44:47]
  v_mfma_f32_16x16x32_bf16 v[48:51], a[148:151], v[16:19], v[48:51]
  s_waitcnt lgkmcnt(4)
  v_mfma_f32_16x16x32_bf16 v[36:39], a[24:27], v[20:23], v[36:39]
  ds_read_b128 v[12:15], v73 offset:18432
  v_mfma_f32_16x16x32_bf16 v[40:43], a[24:27], v[24:27], v[40:43]
  ds_read_b128 v[16:19], v73 offset:19456
  v_mfma_f32_16x16x32_bf16 v[44:47], a[152:155], v[20:23], v[44:47]
  v_mfma_f32_16x16x32_bf16 v[48:51], a[152:155], v[24:27], v[48:51]
  s_waitcnt lgkmcnt(4)
  v_mfma_f32_16x16x32_bf16 v[36:39], a[28:31], v[28:31], v[36:39]
  ds_read_b128 v[20:23], v73 offset:20480
  v_mfma_f32_16x16x32_bf16 v[40:43], a[28:31], v[32:35], v[40:43]
  ds_read_b128 v[24:27], v73 offset:21504
  v_mfma_f32_16x16x32_bf16 v[44:47], a[156:159], v[28:31], v[44:47]
  v_mfma_f32_16x16x32_bf16 v[48:51], a[156:159], v[32:35], v[48:51]
  s_waitcnt lgkmcnt(4)
  v_mfma_f32_16x16x32_bf16 v[36:39], a[32:35], v[4:7], v[36:39]
  ds_read_b128 v[28:31], v73 offset:22528
  v_mfma_f32_16x16x32_bf16 v[40:43], a[32:35], v[8:11], v[40:43]
  ds_read_b128 v[32:35], v73 offset:23552
  v_mfma_f32_16x16x32_bf16 v[44:47], a[160:163], v[4:7], v[44:47]
  v_mfma_f32_16x16x32_bf16 v[48:51], a[160:163], v[8:11], v[48:51]
  s_waitcnt lgkmcnt(4)
  v_mfma_f32_16x16x32_bf16 v[36:39], a[36:39], v[12:15], v[36:39]
  ds_read_b128 v[4:7], v73 offset:24576
  v_mfma_f32_16x16x32_bf16 v[40:43], a[36:39], v[16:19], v[40:43]
  ds_read_b128 v[8:11], v73 offset:25600
  v_mfma_f32_16x16x32_bf16 v[44:47], a[164:167], v[12:15], v[44:47]
  v_mfma_f32_16x16x32_bf16 v[48:51], a[164:167], v[16:19], v[48:51]
  s_waitcnt lgkmcnt(4)
  v_mfma_f32_16x16x32_bf16 v[36:39], a[40:43], v[20:23], v[36:39]
  ds_read_b128 v[12:15], v73 offset:26624
  v_mfma_f32_16x16x32_bf16 v[40:43], a[40:43], v[24:27], v[40:43]
  ds_read_b128 v[16:19], v73 offset:27648
  v_mfma_f32_16x16x32_bf16 v[44:47], a[168:171], v[20:23], v[44:47]
  v_mfma_f32_16x16x32_bf16 v[48:51], a[168:171], v[24:27], v[48:51]
  s_waitcnt lgkmcnt(4)
  v_mfma_f32_16x16x32_bf16 v[36:39], a[44:47], v[28:31], v[36:39]
  ds_read_b128 v[20:23], v73 offset:28672
  v_mfma_f32_16x16x32_bf16 v[40:43], a[44:47], v[32:35], v[40:43]
  ds_read_b128 v[24:27], v73 offset:29696
  v_mfma_f32_16x16x32_bf16 v[44:47], a[172:175], v[28:31], v[44:47]
  v_mfma_f32_16x16x32_bf16 v[48:51], a[172:175], v[32:35], v[48:51]
  s_lshl_b32 s40, s20, 8
  s_add_u32 m0, s40, 131072
  s_cmp_eq_u32 s20, 0
  s_cselect_b32 s40, s30, 2147483392
  buffer_load_dword v2, s[4:7], s40 offen sc1 lds
  s_waitcnt lgkmcnt(4)
  v_mfma_f32_16x16x32_bf16 v[36:39], a[48:51], v[4:7], v[36:39]
  ds_read_b128 v[28:31], v73 offset:30720
  v_mfma_f32_16x16x32_bf16 v[40:43], a[48:51], v[8:11], v[40:43]
  ds_read_b128 v[32:35], v73 offset:31744
  v_mfma_f32_16x16x32_bf16 v[44:47], a[176:179], v[4:7], v[44:47]
  v_mfma_f32_16x16x32_bf16 v[48:51], a[176:179], v[8:11], v[48:51]
  s_waitcnt vmcnt(5)
  s_barrier
  s_lshl_b32 s40, s20, 1
  s_add_u32 s40, s40, 1
  s_cmp_lg_u32 s40, s28
  s_cbranch_scc1 L_WO_s2
  s_mov_b32 s63, s25
  s_atomic_smax s63, s[4:5], s62 glc
Lnosig_40:
L_WO_s2:
  s_waitcnt lgkmcnt(4)
  v_mfma_f32_16x16x32_bf16 v[36:39], a[52:55], v[12:15], v[36:39]
  ds_read_b128 v[4:7], v73 offset:32768
  v_mfma_f32_16x16x32_bf16 v[40:43], a[52:55], v[16:19], v[40:43]
  ds_read_b128 v[8:11], v73 offset:33792
  v_mfma_f32_16x16x32_bf16 v[44:47], a[180:183], v[12:15], v[44:47]
  v_mfma_f32_16x16x32_bf16 v[48:51], a[180:183], v[16:19], v[48:51]
  s_waitcnt lgkmcnt(4)
  v_mfma_f32_16x16x32_bf16 v[36:39], a[56:59], v[20:23], v[36:39]
  ds_read_b128 v[12:15], v73 offset:34816
  v_mfma_f32_16x16x32_bf16 v[40:43], a[56:59], v[24:27], v[40:43]
  ds_read_b128 v[16:19], v73 offset:35840
  v_mfma_f32_16x16x32_bf16 v[44:47], a[184:187], v[20:23], v[44:47]
  v_mfma_f32_16x16x32_bf16 v[48:51], a[184:187], v[24:27], v[48:51]
  s_waitcnt lgkmcnt(4)
  v_mfma_f32_16x16x32_bf16 v[36:39], a[60:63], v[28:31], v[36:39]
  ds_read_b128 v[20:23], v73 offset:36864
  v_mfma_f32_16x16x32_bf16 v[40:43], a[60:63], v[32:35], v[40:43]
  ds_read_b128 v[24:27], v73 offset:37888
  v_mfma_f32_16x16x32_bf16 v[44:47], a[188:191], v[28:31], v[44:47]
  v_mfma_f32_16x16x32_bf16 v[48:51], a[188:191], v[32:35], v[48:51]
  s_waitcnt lgkmcnt(4)
  v_mfma_f32_16x16x32_bf16 v[36:39], a[64:67], v[4:7], v[36:39]
  ds_read_b128 v[28:31], v73 offset:38912
  v_mfma_f32_16x16x32_bf16 v[40:43], a[64:67], v[8:11], v[40:43]
  ds_read_b128 v[32:35], v73 offset:39936
  v_mfma_f32_16x16x32_bf16 v[44:47], a[192:195], v[4:7], v[44:47]
  v_mfma_f32_16x16x32_bf16 v[48:51], a[192:195], v[8:11], v[48:51]
  s_waitcnt lgkmcnt(4)
  v_mfma_f32_16x16x32_bf16 v[36:39], a[68:71], v[12:15], v[36:39]
  ds_read_b128 v[4:7], v73 offset:40960
  v_mfma_f32_16x16x32_bf16 v[40:43], a[68:71], v[16:19], v[40:43]
  ds_read_b128 v[8:11], v73 offset:41984
  v_mfma_f32_16x16x32_bf16 v[44:47], a[196:199], v[12:15], v[44:47]
  v_mfma_f32_16x16x32_bf16 v[48:51], a[196:199], v[16:19], v[48:51]
  s_waitcnt lgkmcnt(4)
  v_mfma_f32_16x16x32_bf16 v[36:39], a[72:75], v[20:23], v[36:39]
  ds_read_b128 v[12:15], v73 offset:43008
  v_mfma_f32_16x16x32_bf16 v[40:43], a[72:75], v[24:27], v[40:43]
  ds_read_b128 v[16:19], v73 offset:44032
  v_mfma_f32_16x16x32_bf16 v[44:47], a[200:203], v[20:23], v[44:47]
  v_mfma_f32_16x16x32_bf16 v[48:51], a[200:203], v[24:27], v[48:51]
  s_waitcnt vmcnt(0)
  s_barrier
  ds_read_b32 v3, v71
  s_waitcnt lgkmcnt(4)
  v_mfma_f32_16x16x32_bf16 v[36:39], a[76:79], v[28:31], v[36:39]
  ds_read_b128 v[20:23], v73 offset:45056
  v_mfma_f32_16x16x32_bf16 v[40:43], a[76:79], v[32:35], v[40:43]
  ds_read_b128 v[24:27], v73 offset:46080
  v_mfma_f32_16x16x32_bf16 v[44:47], a[204:207], v[28:31], v[44:47]
  v_mfma_f32_16x16x32_bf16 v[48:51], a[204:207], v[32:35], v[48:51]
  s_waitcnt lgkmcnt(4)
  v_mfma_f32_16x16x32_bf16 v[36:39], a[80:83], v[4:7], v[36:39]
  ds_read_b128 v[28:31], v73 offset:47104
  v_mfma_f32_16x16x32_bf16 v[40:43], a[80:83], v[8:11], v[40:43]
  ds_read_b128 v[32:35], v73 offset:48128
  v_mfma_f32_16x16x32_bf16 v[44:47], a[208:211], v[4:7], v[44:47]
  v_mfma_f32_16x16x32_bf16 v[48:51], a[208:211], v[8:11], v[48:51]
  s_waitcnt lgkmcnt(4)
  v_cmp_gt_i32 vcc, s29, v3
  s_mov_b32 s28, 0
  s_cbranch_vccnz L_WO_nopf
  s_cmp_ge_u32 s25, 63
  s_cbranch_scc1 L_WO_nopf
  s_mov_b32 s28, 1
  s_waitcnt lgkmcnt(4)
  v_mfma_f32_16x16x32_bf16 v[36:39], a[84:87], v[12:15], v[36:39]
  ds_read_b128 v[4:7], v73 offset:49152
  v_mfma_f32_16x16x32_bf16 v[40:43], a[84:87], v[16:19], v[40:43]
  ds_read_b128 v[8:11], v73 offset:50176
  v_mfma_f32_16x16x32_bf16 v[44:47], a[212:215], v[12:15], v[44:47]
  s_add_u32 s36, s32, 0
  s_add_u32 m0, s34, s36
  s_add_u32 s36, s35, 0
  buffer_load_dwordx4 v1, s[4:7], s36 offen offset:0 sc1 lds
  v_mfma_f32_16x16x32_bf16 v[48:51], a[212:215], v[16:19], v[48:51]
  buffer_load_dwordx4 v1, s[4:7], s36 offen offset:1024 sc1 lds
  s_waitcnt lgkmcnt(4)
  v_mfma_f32_16x16x32_bf16 v[36:39], a[88:91], v[20:23], v[36:39]
  ds_read_b128 v[12:15], v73 offset:51200
  v_mfma_f32_16x16x32_bf16 v[40:43], a[88:91], v[24:27], v[40:43]
  ds_read_b128 v[16:19], v73 offset:52224
  v_mfma_f32_16x16x32_bf16 v[44:47], a[216:219], v[20:23], v[44:47]
  buffer_load_dwordx4 v1, s[4:7], s36 offen offset:2048 sc1 lds
  v_mfma_f32_16x16x32_bf16 v[48:51], a[216:219], v[24:27], v[48:51]
  buffer_load_dwordx4 v1, s[4:7], s36 offen offset:3072 sc1 lds
  s_waitcnt lgkmcnt(4)
  v_mfma_f32_16x16x32_bf16 v[36:39], a[92:95], v[28:31], v[36:39]
  ds_read_b128 v[20:23], v73 offset:53248
  v_mfma_f32_16x16x32_bf16 v[40:43], a[92:95], v[32:35], v[40:43]
  ds_read_b128 v[24:27], v73 offset:54272
  v_mfma_f32_16x16x32_bf16 v[44:47], a[220:223], v[28:31], v[44:47]
  s_add_u32 s36, s32, 16384
  s_add_u32 m0, s34, s36
  s_add_u32 s36, s35, 131072
  buffer_load_dwordx4 v1, s[4:7], s36 offen offset:0 sc1 lds
  v_mfma_f32_16x16x32_bf16 v[48:51], a[220:223], v[32:35], v[48:51]
  buffer_load_dwordx4 v1, s[4:7], s36 offen offset:1024 sc1 lds
  s_waitcnt lgkmcnt(4)
  v_mfma_f32_16x16x32_bf16 v[36:39], a[96:99], v[4:7], v[36:39]
  ds_read_b128 v[28:31], v73 offset:55296
  v_mfma_f32_16x16x32_bf16 v[40:43], a[96:99], v[8:11], v[40:43]
  ds_read_b128 v[32:35], v73 offset:56320
  v_mfma_f32_16x16x32_bf16 v[44:47], a[224:227], v[4:7], v[44:47]
  buffer_load_dwordx4 v1, s[4:7], s36 offen offset:2048 sc1 lds
  v_mfma_f32_16x16x32_bf16 v[48:51], a[224:227], v[8:11], v[48:51]
  buffer_load_dwordx4 v1, s[4:7], s36 offen offset:3072 sc1 lds
  s_waitcnt lgkmcnt(4)
  v_mfma_f32_16x16x32_bf16 v[36:39], a[100:103], v[12:15], v[36:39]
  ds_read_b128 v[4:7], v73 offset:57344
  v_mfma_f32_16x16x32_bf16 v[40:43], a[100:103], v[16:19], v[40:43]
  ds_read_b128 v[8:11], v73 offset:58368
  v_mfma_f32_16x16x32_bf16 v[44:47], a[228:231], v[12:15], v[44:47]
  s_add_u32 s36, s32, 32768
  s_add_u32 m0, s34, s36
  s_add_u32 s36, s35, 262144
  buffer_load_dwordx4 v1, s[4:7], s36 offen offset:0 sc1 lds
  v_mfma_f32_16x16x32_bf16 v[48:51], a[228:231], v[16:19], v[48:51]
  buffer_load_dwordx4 v1, s[4:7], s36 offen offset:1024 sc1 lds
  s_waitcnt lgkmcnt(4)
  v_mfma_f32_16x16x32_bf16 v[36:39], a[104:107], v[20:23], v[36:39]
  ds_read_b128 v[12:15], v73 offset:59392
  v_mfma_f32_16x16x32_bf16 v[40:43], a[104:107], v[24:27], v[40:43]
  ds_read_b128 v[16:19], v73 offset:60416
  v_mfma_f32_16x16x32_bf16 v[44:47], a[232:235], v[20:23], v[44:47]
  buffer_load_dwordx4 v1, s[4:7], s36 offen offset:2048 sc1 lds
  v_mfma_f32_16x16x32_bf16 v[48:51], a[232:235], v[24:27], v[48:51]
  buffer_load_dwordx4 v1, s[4:7], s36 offen offset:3072 sc1 lds
  s_waitcnt lgkmcnt(4)
  v_mfma_f32_16x16x32_bf16 v[36:39], a[108:111], v[28:31], v[36:39]
  ds_read_b128 v[20:23], v73 offset:61440
  v_mfma_f32_16x16x32_bf16 v[40:43], a[108:111], v[32:35], v[40:43]
  ds_read_b128 v[24:27], v73 offset:62464
  v_mfma_f32_16x16x32_bf16 v[44:47], a[236:239], v[28:31], v[44:47]
  v_mfma_f32_16x16x32_bf16 v[48:51], a[236:239], v[32:35], v[48:51]
  s_waitcnt lgkmcnt(4)
  v_mfma_f32_16x16x32_bf16 v[36:39], a[112:115], v[4:7], v[36:39]
  ds_read_b128 v[28:31], v73 offset:63488
  v_mfma_f32_16x16x32_bf16 v[40:43], a[112:115], v[8:11], v[40:43]
  ds_read_b128 v[32:35], v73 offset:64512
  v_mfma_f32_16x16x32_bf16 v[44:47], a[240:243], v[4:7], v[44:47]
  v_mfma_f32_16x16x32_bf16 v[48:51], a[240:243], v[8:11], v[48:51]
  s_waitcnt lgkmcnt(4)
  v_mfma_f32_16x16x32_bf16 v[36:39], a[116:119], v[12:15], v[36:39]
  v_mfma_f32_16x16x32_bf16 v[40:43], a[116:119], v[16:19], v[40:43]
  v_mfma_f32_16x16x32_bf16 v[44:47], a[244:247], v[12:15], v[44:47]
  v_mfma_f32_16x16x32_bf16 v[48:51], a[244:247], v[16:19], v[48:51]
  s_waitcnt lgkmcnt(2)
  v_mfma_f32_16x16x32_bf16 v[36:39], a[120:123], v[20:23], v[36:39]
  v_mfma_f32_16x16x32_bf16 v[40:43], a[120:123], v[24:27], v[40:43]
  v_mfma_f32_16x16x32_bf16 v[44:47], a[248:251], v[20:23], v[44:47]
  v_mfma_f32_16x16x32_bf16 v[48:51], a[248:251], v[24:27], v[48:51]
  s_waitcnt lgkmcnt(0)
  v_mfma_f32_16x16x32_bf16 v[36:39], a[124:127], v[28:31], v[36:39]
  v_mfma_f32_16x16x32_bf16 v[40:43], a[124:127], v[32:35], v[40:43]
  v_mfma_f32_16x16x32_bf16 v[44:47], a[252:255], v[28:31], v[44:47]
  v_mfma_f32_16x16x32_bf16 v[48:51], a[252:255], v[32:35], v[48:51]
  s_nop 7
  s_branch L_WO_epi
L_WO_nopf:
  s_waitcnt lgkmcnt(4)
  v_mfma_f32_16x16x32_bf16 v[36:39], a[84:87], v[12:15], v[36:39]
  ds_read_b128 v[4:7], v73 offset:49152
  v_mfma_f32_16x16x32_bf16 v[40:43], a[84:87], v[16:19], v[40:43]
  ds_read_b128 v[8:11], v73 offset:50176
  v_mfma_f32_16x16x32_bf16 v[44:47], a[212:215], v[12:15], v[44:47]
  v_mfma_f32_16x16x32_bf16 v[48:51], a[212:215], v[16:19], v[48:51]
  s_waitcnt lgkmcnt(4)
  v_mfma_f32_16x16x32_bf16 v[36:39], a[88:91], v[20:23], v[36:39]
  ds_read_b128 v[12:15], v73 offset:51200
  v_mfma_f32_16x16x32_bf16 v[40:43], a[88:91], v[24:27], v[40:43]
  ds_read_b128 v[16:19], v73 offset:52224
  v_mfma_f32_16x16x32_bf16 v[44:47], a[216:219], v[20:23], v[44:47]
  v_mfma_f32_16x16x32_bf16 v[48:51], a[216:219], v[24:27], v[48:51]
  s_waitcnt lgkmcnt(4)
  v_mfma_f32_16x16x32_bf16 v[36:39], a[92:95], v[28:31], v[36:39]
  ds_read_b128 v[20:23], v73 offset:53248
  v_mfma_f32_16x16x32_bf16 v[40:43], a[92:95], v[32:35], v[40:43]
  ds_read_b128 v[24:27], v73 offset:54272
  v_mfma_f32_16x16x32_bf16 v[44:47], a[220:223], v[28:31], v[44:47]
  v_mfma_f32_16x16x32_bf16 v[48:51], a[220:223], v[32:35], v[48:51]
  s_barrier
  s_lshl_b32 s40, s20, 8
  s_add_u32 m0, s40, 131072
  s_cmp_eq_u32 s20, 0
  s_cselect_b32 s40, s30, 2147483392
  buffer_load_dword v2, s[4:7], s40 offen sc1 lds
  s_waitcnt lgkmcnt(4)
  v_mfma_f32_16x16x32_bf16 v[36:39], a[96:99], v[4:7], v[36:39]
  ds_read_b128 v[28:31], v73 offset:55296
  v_mfma_f32_16x16x32_bf16 v[40:43], a[96:99], v[8:11], v[40:43]
  ds_read_b128 v[32:35], v73 offset:56320
  v_mfma_f32_16x16x32_bf16 v[44:47], a[224:227], v[4:7], v[44:47]
  v_mfma_f32_16x16x32_bf16 v[48:51], a[224:227], v[8:11], v[48:51]
  s_waitcnt lgkmcnt(4)
  v_mfma_f32_16x16x32_bf16 v[36:39], a[100:103], v[12:15], v[36:39]
  ds_read_b128 v[4:7], v73 offset:57344
  v_mfma_f32_16x16x32_bf16 v[40:43], a[100:103], v[16:19], v[40:43]
  ds_read_b128 v[8:11], v73 offset:58368
  v_mfma_f32_16x16x32_bf16 v[44:47], a[228:231], v[12:15], v[44:47]
  v_mfma_f32_16x16x32_bf16 v[48:51], a[228:231], v[16:19], v[48:51]
  s_waitcnt lgkmcnt(4)
  v_mfma_f32_16x16x32_bf16 v[36:39], a[104:107], v[20:23], v[36:39]
  ds_read_b128 v[12:15], v73 offset:59392
  v_mfma_f32_16x16x32_bf16 v[40:43], a[104:107], v[24:27], v[40:43]
  ds_read_b128 v[16:19], v73 offset:60416
  v_mfma_f32_16x16x32_bf16 v[44:47], a[232:235], v[20:23], v[44:47]
  v_mfma_f32_16x16x32_bf16 v[48:51], a[232:235], v[24:27], v[48:51]
  s_waitcnt lgkmcnt(4)
  v_mfma_f32_16x16x32_bf16 v[36:39], a[108:111], v[28:31], v[36:39]
  ds_read_b128 v[20:23], v73 offset:61440
  v_mfma_f32_16x16x32_bf16 v[40:43], a[108:111], v[32:35], v[40:43]
  ds_read_b128 v[24:27], v73 offset:62464
  v_mfma_f32_16x16x32_bf16 v[44:47], a[236:239], v[28:31], v[44:47]
  v_mfma_f32_16x16x32_bf16 v[48:51], a[236:239], v[32:35], v[48:51]
  s_waitcnt lgkmcnt(4)
  v_mfma_f32_16x16x32_bf16 v[36:39], a[112:115], v[4:7], v[36:39]
  ds_read_b128 v[28:31], v73 offset:63488
  v_mfma_f32_16x16x32_bf16 v[40:43], a[112:115], v[8:11], v[40:43]
  ds_read_b128 v[32:35], v73 offset:64512
  v_mfma_f32_16x16x32_bf16 v[44:47], a[240:243], v[4:7], v[44:47]
  v_mfma_f32_16x16x32_bf16 v[48:51], a[240:243], v[8:11], v[48:51]
  s_waitcnt lgkmcnt(4)
  v_mfma_f32_16x16x32_bf16 v[36:39], a[116:119], v[12:15], v[36:39]
  v_mfma_f32_16x16x32_bf16 v[40:43], a[116:119], v[16:19], v[40:43]
  v_mfma_f32_16x16x32_bf16 v[44:47], a[244:247], v[12:15], v[44:47]
  v_mfma_f32_16x16x32_bf16 v[48:51], a[244:247], v[16:19], v[48:51]
  s_waitcnt vmcnt(0)
  s_barrier
  ds_read_b32 v3, v71
  s_waitcnt lgkmcnt(2)
  v_mfma_f32_16x16x32_bf16 v[36:39], a[120:123], v[20:23], v[36:39]
  v_mfma_f32_16x16x32_bf16 v[40:43], a[120:123], v[24:27], v[40:43]
  v_mfma_f32_16x16x32_bf16 v[44:47], a[248:251], v[20:23], v[44:47]
  v_mfma_f32_16x16x32_bf16 v[48:51], a[248:251], v[24:27], v[48:51]
  s_waitcnt lgkmcnt(0)
  v_mfma_f32_16x16x32_bf16 v[36:39], a[124:127], v[28:31], v[36:39]
  v_mfma_f32_16x16x32_bf16 v[40:43], a[124:127], v[32:35], v[40:43]
  v_mfma_f32_16x16x32_bf16 v[44:47], a[252:255], v[28:31], v[44:47]
  v_mfma_f32_16x16x32_bf16 v[48:51], a[252:255], v[32:35], v[48:51]
  v_cmp_gt_i32 vcc, s29, v3
  s_cmp_eq_u64 vcc, 0
  s_cselect_b32 s28, 2, 0
  s_cmp_lt_u32 s25, 63
  s_cselect_b32 s28, s28, 0
L_WO_epi:
  v_cvt_pk_bf16_f32 v52, v36, v37
  v_cvt_pk_bf16_f32 v53, v38, v39
  v_cvt_pk_bf16_f32 v54, v44, v45
  v_cvt_pk_bf16_f32 v55, v46, v47
  buffer_store_dwordx4 v[52:55], v68, s[4:7], s31 offen offset:0 sc1
  v_cvt_pk_bf16_f32 v56, v40, v41
  v_cvt_pk_bf16_f32 v57, v42, v43
  v_cvt_pk_bf16_f32 v58, v48, v49
  v_cvt_pk_bf16_f32 v59, v50, v51
  buffer_store_dwordx4 v[56:59], v68, s[4:7], s31 offen offset:1024 sc1
  s_add_u32 s25, s25, 1
  s_add_u32 s31, s31, 2097152
  s_xor_b32 s31, s31, 0x2000
  s_branch L_WO_top
L_F1:
  v_lshlrev_b32 v1, 4, v0
  s_lshl_b32 s32, s20, 12
  s_min_u32 s33, s32, 0x2000
  v_mov_b32 v69, v1
  v_add_u32 v70, 0x10000, v69
  v_and_b32 v1, 3, v0
  v_lshlrev_b32 v1, 4, v1
  v_lshrrev_b32 v52, 4, v0
  v_lshl_add_u32 v1, v52, 6, v1
  v_bfe_u32 v52, v0, 2, 2
  v_lshl_add_u32 v1, v52, 8, v1
  s_load_dwordx2 s[8:9], s[0:1], 64
  s_mov_b32 s10, 7340032
  s_mov_b32 s11, 0x20000
  s_waitcnt lgkmcnt(0)
  s_lshl_b32 s44, s21, 7
  v_bfe_u32 v4, v0, 5, 1
  v_mul_u32_u24 v4, 28672, v4
  v_bfe_u32 v5, v0, 4, 1
  v_mul_u32_u24 v5, 14336, v5
  v_add_u32 v4, v4, v5
  v_bfe_u32 v5, v0, 3, 1
  v_mul_u32_u24 v5, 7168, v5
  v_add_u32 v4, v4, v5
  v_lshrrev_b32 v5, 3, v0
  v_and_b32 v5, 6, v5
  v_xor_b32 v5, v5, v0
  v_and_b32 v5, 7, v5
  v_lshl_add_u32 v4, v5, 4, v4
  s_lshr_b32 s40, s20, 1
  s_mul_i32 s40, s40, 458752
  s_and_b32 s41, s20, 1
  s_mul_i32 s41, s41, 57344
  s_add_u32 s40, s40, s41
  v_add_u32 v4, s40, v4
  v_bfe_u32 v5, v0, 3, 2
  v_xor_b32 v5, s20, v5
  v_lshlrev_b32 v5, 5, v5
  v_lshrrev_b32 v6, 2, v0
  v_lshl_add_u32 v6, v6, 7, v5
  v_and_b32 v5, 3, v0
  v_lshl_add_u32 v6, v5, 3, v6
  v_add_u32 v7, 0x10000, v6
  v_add_u32 v8, s44, v4
  v_add_u32 v9, s44, v4
  s_lshl_b32 s41, s20, 10
  s_add_u32 m0, s41, 0
  s_mov_b32 s42, 0
  buffer_load_dwordx4 v8, s[8:11], s42 offen nt lds
  s_add_u32 m0, s41, 4096
  s_mov_b32 s42, 114688
  buffer_load_dwordx4 v8, s[8:11], s42 offen nt lds
  s_add_u32 m0, s41, 8192
  s_mov_b32 s42, 229376
  buffer_load_dwordx4 v8, s[8:11], s42 offen nt lds
  s_add_u32 m0, s41, 12288
  s_mov_b32 s42, 344064
  buffer_load_dwordx4 v8, s[8:11], s42 offen nt lds
  s_add_u32 m0, s41, 16384
  s_mov_b32 s42, 917504
  buffer_load_dwordx4 v8, s[8:11], s42 offen nt lds
  s_add_u32 m0, s41, 20480
  s_mov_b32 s42, 1032192
  buffer_load_dwordx4 v8, s[8:11], s42 offen nt lds
  s_add_u32 m0, s41, 24576
  s_mov_b32 s42, 1146880
  buffer_load_dwordx4 v8, s[8:11], s42 offen nt lds
  s_add_u32 m0, s41, 28672
  s_mov_b32 s42, 1261568
  buffer_load_dwordx4 v8, s[8:11], s42 offen nt lds
  s_add_u32 m0, s41, 32768
  s_mov_b32 s42, 1835008
  buffer_load_dwordx4 v8, s[8:11], s42 offen nt lds
  s_add_u32 m0, s41, 36864
  s_mov_b32 s42, 1949696
  buffer_load_dwordx4 v8, s[8:11], s42 offen nt lds
  s_add_u32 m0, s41, 40960
  s_mov_b32 s42, 2064384
  buffer_load_dwordx4 v8, s[8:11], s42 offen nt lds
  s_add_u32 m0, s41, 45056
  s_mov_b32 s42, 2179072
  buffer_load_dwordx4 v8, s[8:11], s42 offen nt lds
  s_add_u32 m0, s41, 49152
  s_mov_b32 s42, 2752512
  buffer_load_dwordx4 v8, s[8:11], s42 offen nt lds
  s_add_u32 m0, s41, 53248
  s_mov_b32 s42, 2867200
  buffer_load_dwordx4 v8, s[8:11], s42 offen nt lds
  s_add_u32 m0, s41, 57344
  s_mov_b32 s42, 2981888
  buffer_load_dwordx4 v8, s[8:11], s42 offen nt lds
  s_add_u32 m0, s41, 61440
  s_mov_b32 s42, 3096576
  buffer_load_dwordx4 v8, s[8:11], s42 offen nt lds
  s_add_u32 m0, s41, 65536
  s_mov_b32 s42, 3670016
  buffer_load_dwordx4 v8, s[8:11], s42 offen nt lds
  s_add_u32 m0, s41, 69632
  s_mov_b32 s42, 3784704
  buffer_load_dwordx4 v8, s[8:11], s42 offen nt lds
  s_add_u32 m0, s41, 73728
  s_mov_b32 s42, 3899392
  buffer_load_dwordx4 v8, s[8:11], s42 offen nt lds
  s_add_u32 m0, s41, 77824
  s_mov_b32 s42, 4014080
  buffer_load_dwordx4 v8, s[8:11], s42 offen nt lds
  s_add_u32 m0, s41, 81920
  s_mov_b32 s42, 4587520
  buffer_load_dwordx4 v8, s[8:11], s42 offen nt lds
  s_add_u32 m0, s41, 86016
  s_mov_b32 s42, 4702208
  buffer_load_dwordx4 v8, s[8:11], s42 offen nt lds
  s_add_u32 m0, s41, 90112
  s_mov_b32 s42, 4816896
  buffer_load_dwordx4 v8, s[8:11], s42 offen nt lds
  s_add_u32 m0, s41, 94208
  s_mov_b32 s42, 4931584
  buffer_load_dwordx4 v8, s[8:11], s42 offen nt lds
  s_add_u32 m0, s41, 98304
  s_mov_b32 s42, 5505024
  buffer_load_dwordx4 v8, s[8:11], s42 offen nt lds
  s_add_u32 m0, s41, 102400
  s_mov_b32 s42, 5619712
  buffer_load_dwordx4 v8, s[8:11], s42 offen nt lds
  s_add_u32 m0, s41, 106496
  s_mov_b32 s42, 5734400
  buffer_load_dwordx4 v8, s[8:11], s42 offen nt lds
  s_add_u32 m0, s41, 110592
  s_mov_b32 s42, 5849088
  buffer_load_dwordx4 v8, s[8:11], s42 offen nt lds
  s_waitcnt vmcnt(24) lgkmcnt(0)
  s_barrier
  s_add_u32 m0, s41, 114688
  s_mov_b32 s42, 6422528
  buffer_load_dwordx4 v8, s[8:11], s42 offen nt lds
  s_add_u32 m0, s41, 118784
  s_mov_b32 s42, 6537216
  buffer_load_dwordx4 v8, s[8:11], s42 offen nt lds
  s_add_u32 m0, s41, 122880
  s_mov_b32 s42, 6651904
  buffer_load_dwordx4 v8, s[8:11], s42 offen nt lds
  s_add_u32 m0, s41, 126976
  s_mov_b32 s42, 6766592
  buffer_load_dwordx4 v8, s[8:11], s42 offen nt lds
  ds_read_b64_tr_b16 a[0:1], v6 offset:0
  ds_read_b64_tr_b16 a[2:3], v6 offset:2048
  ds_read_b64_tr_b16 a[4:5], v6 offset:4096
  ds_read_b64_tr_b16 a[6:7], v6 offset:6144
  ds_read_b64_tr_b16 a[8:9], v6 offset:8192
  ds_read_b64_tr_b16 a[10:11], v6 offset:10240
  ds_read_b64_tr_b16 a[12:13], v6 offset:12288
  ds_read_b64_tr_b16 a[14:15], v6 offset:14336
  s_waitcnt vmcnt(24) lgkmcnt(0)
  s_barrier
  s_load_dwordx2 s[8:9], s[0:1], 72
  s_mov_b32 s10, 7340032
  s_mov_b32 s11, 0x20000
  s_waitcnt lgkmcnt(0)
  s_add_u32 m0, s41, 0
  s_mov_b32 s42, 0
  buffer_load_dwordx4 v9, s[8:11], s42 offen nt lds
  s_add_u32 m0, s41, 4096
  s_mov_b32 s42, 114688
  buffer_load_dwordx4 v9, s[8:11], s42 offen nt lds
  s_add_u32 m0, s41, 8192
  s_mov_b32 s42, 229376
  buffer_load_dwordx4 v9, s[8:11], s42 offen nt lds
  s_add_u32 m0, s41, 12288
  s_mov_b32 s42, 344064
  buffer_load_dwordx4 v9, s[8:11], s42 offen nt lds
  ds_read_b64_tr_b16 a[16:17], v6 offset:16384
  ds_read_b64_tr_b16 a[18:19], v6 offset:18432
  ds_read_b64_tr_b16 a[20:21], v6 offset:20480
  ds_read_b64_tr_b16 a[22:23], v6 offset:22528
  ds_read_b64_tr_b16 a[24:25], v6 offset:24576
  ds_read_b64_tr_b16 a[26:27], v6 offset:26624
  ds_read_b64_tr_b16 a[28:29], v6 offset:28672
  ds_read_b64_tr_b16 a[30:31], v6 offset:30720
  s_waitcnt vmcnt(24) lgkmcnt(0)
  s_barrier
  s_add_u32 m0, s41, 16384
  s_mov_b32 s42, 917504
  buffer_load_dwordx4 v9, s[8:11], s42 offen nt lds
  s_add_u32 m0, s41, 20480
  s_mov_b32 s42, 1032192
  buffer_load_dwordx4 v9, s[8:11], s42 offen nt lds
  s_add_u32 m0, s41, 24576
  s_mov_b32 s42, 1146880
  buffer_load_dwordx4 v9, s[8:11], s42 offen nt lds
  s_add_u32 m0, s41, 28672
  s_mov_b32 s42, 1261568
  buffer_load_dwordx4 v9, s[8:11], s42 offen nt lds
  ds_read_b64_tr_b16 a[32:33], v6 offset:32768
  ds_read_b64_tr_b16 a[34:35], v6 offset:34816
  ds_read_b64_tr_b16 a[36:37], v6 offset:36864
  ds_read_b64_tr_b16 a[38:39], v6 offset:38912
  ds_read_b64_tr_b16 a[40:41], v6 offset:40960
  ds_read_b64_tr_b16 a[42:43], v6 offset:43008
  ds_read_b64_tr_b16 a[44:45], v6 offset:45056
  ds_read_b64_tr_b16 a[46:47], v6 offset:47104
  s_waitcnt vmcnt(24) lgkmcnt(0)
  s_barrier
  s_add_u32 m0, s41, 32768
  s_mov_b32 s42, 1835008
  buffer_load_dwordx4 v9, s[8:11], s42 offen nt lds
  s_add_u32 m0, s41, 36864
  s_mov_b32 s42, 1949696
  buffer_load_dwordx4 v9, s[8:11], s42 offen nt lds
  s_add_u32 m0, s41, 40960
  s_mov_b32 s42, 2064384
  buffer_load_dwordx4 v9, s[8:11], s42 offen nt lds
  s_add_u32 m0, s41, 45056
  s_mov_b32 s42, 2179072
  buffer_load_dwordx4 v9, s[8:11], s42 offen nt lds
  ds_read_b64_tr_b16 a[48:49], v6 offset:49152
  ds_read_b64_tr_b16 a[50:51], v6 offset:51200
  ds_read_b64_tr_b16 a[52:53], v6 offset:53248
  ds_read_b64_tr_b16 a[54:55], v6 offset:55296
  ds_read_b64_tr_b16 a[56:57], v6 offset:57344
  ds_read_b64_tr_b16 a[58:59], v6 offset:59392
  ds_read_b64_tr_b16 a[60:61], v6 offset:61440
  ds_read_b64_tr_b16 a[62:63], v6 offset:63488
  s_waitcnt vmcnt(24) lgkmcnt(0)
  s_barrier
  s_add_u32 m0, s41, 49152
  s_mov_b32 s42, 2752512
  buffer_load_dwordx4 v9, s[8:11], s42 offen nt lds
  s_add_u32 m0, s41, 53248
  s_mov_b32 s42, 2867200
  buffer_load_dwordx4 v9, s[8:11], s42 offen nt lds
  s_add_u32 m0, s41, 57344
  s_mov_b32 s42, 2981888
  buffer_load_dwordx4 v9, s[8:11], s42 offen nt lds
  s_add_u32 m0, s41, 61440
  s_mov_b32 s42, 3096576
  buffer_load_dwordx4 v9, s[8:11], s42 offen nt lds
  ds_read_b64_tr_b16 a[64:65], v7 offset:0
  ds_read_b64_tr_b16 a[66:67], v7 offset:2048
  ds_read_b64_tr_b16 a[68:69], v7 offset:4096
  ds_read_b64_tr_b16 a[70:71], v7 offset:6144
  ds_read_b64_tr_b16 a[72:73], v7 offset:8192
  ds_read_b64_tr_b16 a[74:75], v7 offset:10240
  ds_read_b64_tr_b16 a[76:77], v7 offset:12288
  ds_read_b64_tr_b16 a[78:79], v7 offset:14336
  s_waitcnt vmcnt(24) lgkmcnt(0)
  s_barrier
  s_add_u32 m0, s41, 65536
  s_mov_b32 s42, 3670016
  buffer_load_dwordx4 v9, s[8:11], s42 offen nt lds
  s_add_u32 m0, s41, 69632
  s_mov_b32 s42, 3784704
  buffer_load_dwordx4 v9, s[8:11], s42 offen nt lds
  s_add_u32 m0, s41, 73728
  s_mov_b32 s42, 3899392
  buffer_load_dwordx4 v9, s[8:11], s42 offen nt lds
  s_add_u32 m0, s41, 77824
  s_mov_b32 s42, 4014080
  buffer_load_dwordx4 v9, s[8:11], s42 offen nt lds
  ds_read_b64_tr_b16 a[80:81], v7 offset:16384
  ds_read_b64_tr_b16 a[82:83], v7 offset:18432
  ds_read_b64_tr_b16 a[84:85], v7 offset:20480
  ds_read_b64_tr_b16 a[86:87], v7 offset:22528
  ds_read_b64_tr_b16 a[88:89], v7 offset:24576
  ds_read_b64_tr_b16 a[90:91], v7 offset:26624
  ds_read_b64_tr_b16 a[92:93], v7 offset:28672
  ds_read_b64_tr_b16 a[94:95], v7 offset:30720
  s_waitcnt vmcnt(24) lgkmcnt(0)
  s_barrier
  s_add_u32 m0, s41, 81920
  s_mov_b32 s42, 4587520
  buffer_load_dwordx4 v9, s[8:11], s42 offen nt lds
  s_add_u32 m0, s41, 86016
  s_mov_b32 s42, 4702208
  buffer_load_dwordx4 v9, s[8:11], s42 offen nt lds
  s_add_u32 m0, s41, 90112
  s_mov_b32 s42, 4816896
  buffer_load_dwordx4 v9, s[8:11], s42 offen nt lds
  s_add_u32 m0, s41, 94208
  s_mov_b32 s42, 4931584
  buffer_load_dwordx4 v9, s[8:11], s42 offen nt lds
  ds_read_b64_tr_b16 a[96:97], v7 offset:32768
  ds_read_b64_tr_b16 a[98:99], v7 offset:34816
  ds_read_b64_tr_b16 a[100:101], v7 offset:36864
  ds_read_b64_tr_b16 a[102:103], v7 offset:38912
  ds_read_b64_tr_b16 a[104:105], v7 offset:40960
  ds_read_b64_tr_b16 a[106:107], v7 offset:43008
  ds_read_b64_tr_b16 a[108:109], v7 offset:45056
  ds_read_b64_tr_b16 a[110:111], v7 offset:47104
  s_waitcnt vmcnt(24) lgkmcnt(0)
  s_barrier
  s_add_u32 m0, s41, 98304
  s_mov_b32 s42, 5505024
  buffer_load_dwordx4 v9, s[8:11], s42 offen nt lds
  s_add_u32 m0, s41, 102400
  s_mov_b32 s42, 5619712
  buffer_load_dwordx4 v9, s[8:11], s42 offen nt lds
  s_add_u32 m0, s41, 106496
  s_mov_b32 s42, 5734400
  buffer_load_dwordx4 v9, s[8:11], s42 offen nt lds
  s_add_u32 m0, s41, 110592
  s_mov_b32 s42, 5849088
  buffer_load_dwordx4 v9, s[8:11], s42 offen nt lds
  ds_read_b64_tr_b16 a[112:113], v7 offset:49152
  ds_read_b64_tr_b16 a[114:115], v7 offset:51200
  ds_read_b64_tr_b16 a[116:117], v7 offset:53248
  ds_read_b64_tr_b16 a[118:119], v7 offset:55296
  ds_read_b64_tr_b16 a[120:121], v7 offset:57344
  ds_read_b64_tr_b16 a[122:123], v7 offset:59392
  ds_read_b64_tr_b16 a[124:125], v7 offset:61440
  ds_read_b64_tr_b16 a[126:127], v7 offset:63488
  s_waitcnt vmcnt(24) lgkmcnt(0)
  s_barrier
  s_add_u32 m0, s41, 114688
  s_mov_b32 s42, 6422528
  buffer_load_dwordx4 v9, s[8:11], s42 offen nt lds
  s_add_u32 m0, s41, 118784
  s_mov_b32 s42, 6537216
  buffer_load_dwordx4 v9, s[8:11], s42 offen nt lds
  s_add_u32 m0, s41, 122880
  s_mov_b32 s42, 6651904
  buffer_load_dwordx4 v9, s[8:11], s42 offen nt lds
  s_add_u32 m0, s41, 126976
  s_mov_b32 s42, 6766592
  buffer_load_dwordx4 v9, s[8:11], s42 offen nt lds
  ds_read_b64_tr_b16 a[128:129], v6 offset:0
  ds_read_b64_tr_b16 a[130:131], v6 offset:2048
  ds_read_b64_tr_b16 a[132:133], v6 offset:4096
  ds_read_b64_tr_b16 a[134:135], v6 offset:6144
  ds_read_b64_tr_b16 a[136:137], v6 offset:8192
  ds_read_b64_tr_b16 a[138:139], v6 offset:10240
  ds_read_b64_tr_b16 a[140:141], v6 offset:12288
  ds_read_b64_tr_b16 a[142:143], v6 offset:14336
  s_waitcnt vmcnt(24) lgkmcnt(0)
  s_barrier
  ds_read_b64_tr_b16 a[144:145], v6 offset:16384
  ds_read_b64_tr_b16 a[146:147], v6 offset:18432
  ds_read_b64_tr_b16 a[148:149], v6 offset:20480
  ds_read_b64_tr_b16 a[150:151], v6 offset:22528
  ds_read_b64_tr_b16 a[152:153], v6 offset:24576
  ds_read_b64_tr_b16 a[154:155], v6 offset:26624
  ds_read_b64_tr_b16 a[156:157], v6 offset:28672
  ds_read_b64_tr_b16 a[158:159], v6 offset:30720
  s_waitcnt vmcnt(20) lgkmcnt(0)
  s_barrier
  ds_read_b64_tr_b16 a[160:161], v6 offset:32768
  ds_read_b64_tr_b16 a[162:163], v6 offset:34816
  ds_read_b64_tr_b16 a[164:165], v6 offset:36864
  ds_read_b64_tr_b16 a[166:167], v6 offset:38912
  ds_read_b64_tr_b16 a[168:169], v6 offset:40960
  ds_read_b64_tr_b16 a[170:171], v6 offset:43008
  ds_read_b64_tr_b16 a[172:173], v6 offset:45056
  ds_read_b64_tr_b16 a[174:175], v6 offset:47104
  s_waitcnt vmcnt(16) lgkmcnt(0)
  s_barrier
  ds_read_b64_tr_b16 a[176:177], v6 offset:49152
  ds_read_b64_tr_b16 a[178:179], v6 offset:51200
  ds_read_b64_tr_b16 a[180:181], v6 offset:53248
  ds_read_b64_tr_b16 a[182:183], v6 offset:55296
  ds_read_b64_tr_b16 a[184:185], v6 offset:57344
  ds_read_b64_tr_b16 a[186:187], v6 offset:59392
  ds_read_b64_tr_b16 a[188:189], v6 offset:61440
  ds_read_b64_tr_b16 a[190:191], v6 offset:63488
  s_waitcnt vmcnt(12) lgkmcnt(0)
  s_barrier
  ds_read_b64_tr_b16 a[192:193], v7 offset:0
  ds_read_b64_tr_b16 a[194:195], v7 offset:2048
  ds_read_b64_tr_b16 a[196:197], v7 offset:4096
  ds_read_b64_tr_b16 a[198:199], v7 offset:6144
  ds_read_b64_tr_b16 a[200:201], v7 offset:8192
  ds_read_b64_tr_b16 a[202:203], v7 offset:10240
  ds_read_b64_tr_b16 a[204:205], v7 offset:12288
  ds_read_b64_tr_b16 a[206:207], v7 offset:14336
  s_waitcnt vmcnt(8) lgkmcnt(0)
  s_barrier
  ds_read_b64_tr_b16 a[208:209], v7 offset:16384
  ds_read_b64_tr_b16 a[210:211], v7 offset:18432
  ds_read_b64_tr_b16 a[212:213], v7 offset:20480
  ds_read_b64_tr_b16 a[214:215], v7 offset:22528
  ds_read_b64_tr_b16 a[216:217], v7 offset:24576
  ds_read_b64_tr_b16 a[218:219], v7 offset:26624
  ds_read_b64_tr_b16 a[220:221], v7 offset:28672
  ds_read_b64_tr_b16 a[222:223], v7 offset:30720
  s_waitcnt vmcnt(4) lgkmcnt(0)
  s_barrier
  ds_read_b64_tr_b16 a[224:225], v7 offset:32768
  ds_read_b64_tr_b16 a[226:227], v7 offset:34816
  ds_read_b64_tr_b16 a[228:229], v7 offset:36864
  ds_read_b64_tr_b16 a[230:231], v7 offset:38912
  ds_read_b64_tr_b16 a[232:233], v7 offset:40960
  ds_read_b64_tr_b16 a[234:235], v7 offset:43008
  ds_read_b64_tr_b16 a[236:237], v7 offset:45056
  ds_read_b64_tr_b16 a[238:239], v7 offset:47104
  s_waitcnt vmcnt(0) lgkmcnt(0)
  s_barrier
  ds_read_b64_tr_b16 a[240:241], v7 offset:49152
  ds_read_b64_tr_b16 a[242:243], v7 offset:51200
  ds_read_b64_tr_b16 a[244:245], v7 offset:53248
  ds_read_b64_tr_b16 a[246:247], v7 offset:55296
  ds_read_b64_tr_b16 a[248:249], v7 offset:57344
  ds_read_b64_tr_b16 a[250:251], v7 offset:59392
  ds_read_b64_tr_b16 a[252:253], v7 offset:61440
  ds_read_b64_tr_b16 a[254:255], v7 offset:63488
  s_waitcnt lgkmcnt(0)
  s_barrier
  v_min_u32 v2, 7, v0
  v_lshlrev_b32 v2, 7, v2
  v_add_u32 v2, 1413120, v2
  s_lshl_b32 s62, s21, 7
  s_add_u32 s62, s62, 1414144
  v_min_u32 v52, 63, v0
  v_lshlrev_b32 v52, 7, v52
  v_add_u32 v52, 1424384, v52
  s_nop 1
Lpoll_41:
  buffer_load_dword v53, v52, s[4:7], 0 offen sc1
  s_sub_u32 s24, s24, 1
  s_cbranch_scc1 L_FAIL
  s_waitcnt vmcnt(0)
  v_cmp_gt_i32 vcc, 0, v53
  s_cbranch_vccz Lpolld_42
  s_sleep 1
  s_branch Lpoll_41
Lpolld_42:
  v_lshrrev_b32 v53, 8, v53
  v_and_b32 v54, 3, v0
  v_lshl_or_b32 v53, v53, 2, v54
  s_nop 1
  v_min_u32_dpp v53, v53, v53 row_ror:8 row_mask:0xf bank_mask:0xf
  s_nop 1
  v_min_u32_dpp v53, v53, v53 row_ror:4 row_mask:0xf bank_mask:0xf
  v_mov_b32 v54, v53
  s_nop 1
  v_permlane16_swap_b32 v54, v53
  v_min_u32 v53, v53, v54
  v_mov_b32 v54, v53
  s_nop 1
  v_permlane32_swap_b32 v54, v53
  v_min_u32 v53, v53, v54
  s_nop 1
  v_min_u32_dpp v53, v53, v53 row_ror:2 row_mask:0xf bank_mask:0xf
  s_nop 1
  v_min_u32_dpp v53, v53, v53 row_ror:1 row_mask:0xf bank_mask:0xf
  s_nop 0
  v_readfirstlane_b32 s38, v53
  s_and_b32 s38, s38, 3
  s_lshl_b32 s38, s38, 13
  s_and_b32 s38, s38, 0x2000
  s_xor_b32 s38, s38, 16785408
  s_lshr_b32 s40, s20, 1
  s_lshl_b32 s40, s40, 14
  s_and_b32 s41, s20, 1
  s_lshl_b32 s41, s41, 12
  s_add_u32 s27, s40, s41
  s_lshr_b32 s40, s21, 1
  s_lshl_b32 s40, s40, 14
  s_and_b32 s41, s21, 1
  s_lshl_b32 s41, s41, 12
  s_add_u32 s31, s40, s41
  s_add_u32 s27, s27, s38
  s_add_u32 s27, s27, 917504
  s_add_u32 s31, s31, s38
  s_add_u32 s31, s31, 1179648
  s_lshr_b32 s40, s20, 1
  s_lshl_b32 s40, s40, 11
  s_and_b32 s41, s20, 1
  s_lshl_b32 s41, s41, 9
  s_add_u32 s40, s40, s41
  v_and_b32 v52, 31, v0
  v_lshl_add_u32 v68, v52, 4, s40
  v_lshrrev_b32 v52, 5, v0
  v_lshl_add_u32 v68, v52, 10, v68
  s_mov_b32 s37, 0xbfb8aa3b
  v_lshlrev_b32 v71, 2, v0
  v_add_u32 v71, 131072, v71
  s_mov_b32 s25, 0
  s_mov_b32 s26, 0
  s_mov_b32 s29, 1
  s_mov_b32 s30, 0
  s_mov_b32 s28, 0
L_F1_top:
  s_cmp_eq_u32 s28, 1
  s_cbranch_scc1 L_F1_go
  s_cmp_eq_u32 s28, 2
  s_cbranch_scc1 L_F1_mid
  s_cmp_lg_u32 s20, 0
  s_cbranch_scc1 L_F1_park
  buffer_load_dword v3, v2, s[4:7], s30 offen sc1
  s_waitcnt vmcnt(1)
  s_barrier
  s_mov_b32 s63, s25
  s_atomic_smax s63, s[4:5], s62 glc
Lnosig_43:
  s_cmp_ge_u32 s25, 64
  s_cbranch_scc1 L_END
  s_waitcnt vmcnt(0)
  v_cmp_gt_i32 vcc, s29, v3
  s_cbranch_vccz L_F1_issue
  s_nop 3
Lpoll_44:
  buffer_load_dword v3, v2, s[4:7], s30 offen sc1
  s_sub_u32 s24, s24, 1
  s_cbranch_scc1 L_FAIL
  s_waitcnt vmcnt(0)
  v_cmp_gt_i32 vcc, s29, v3
  s_cbranch_vccz Lpolld_45
  s_sleep 1
  s_branch Lpoll_44
Lpolld_45:
  s_branch L_F1_issue
L_F1_park:
  s_waitcnt vmcnt(0)
  s_barrier
  s_cmp_ge_u32 s25, 64
  s_cbranch_scc1 L_END
L_F1_issue:
  s_barrier
L_F1_mid:
  s_mov_b32 s34, s26
  s_mov_b32 s35, s27
  s_add_u32 s36, s32, 0
  s_add_u32 m0, s34, s36
  s_add_u32 s36, s35, 0
  buffer_load_dwordx4 v1, s[4:7], s36 offen offset:0 sc1 lds
  s_nop 0
  buffer_load_dwordx4 v1, s[4:7], s36 offen offset:1024 sc1 lds
  s_nop 0
  buffer_load_dwordx4 v1, s[4:7], s36 offen offset:2048 sc1 lds
  s_nop 0
  buffer_load_dwordx4 v1, s[4:7], s36 offen offset:3072 sc1 lds
  s_nop 0
  s_add_u32 s36, s32, 16384
  s_add_u32 m0, s34, s36
  s_add_u32 s36, s35, 32768
  buffer_load_dwordx4 v1, s[4:7], s36 offen offset:0 sc1 lds
  s_nop 0
  buffer_load_dwordx4 v1, s[4:7], s36 offen offset:1024 sc1 lds
  s_nop 0
  buffer_load_dwordx4 v1, s[4:7], s36 offen offset:2048 sc1 lds
  s_nop 0
  buffer_load_dwordx4 v1, s[4:7], s36 offen offset:3072 sc1 lds
  s_nop 0
  s_add_u32 s36, s32, 32768
  s_add_u32 m0, s34, s36
  s_add_u32 s36, s35, 65536
  buffer_load_dwordx4 v1, s[4:7], s36 offen offset:0 sc1 lds
  s_nop 0
  buffer_load_dwordx4 v1, s[4:7], s36 offen offset:1024 sc1 lds
  s_nop 0
  buffer_load_dwordx4 v1, s[4:7], s36 offen offset:2048 sc1 lds
  s_nop 0
  buffer_load_dwordx4 v1, s[4:7], s36 offen offset:3072 sc1 lds
  s_nop 0
  s_cmp_eq_u32 s28, 0
  s_cbranch_scc1 L_F1_go
  s_mov_b32 s28, 0
  s_waitcnt vmcnt(12)
  s_barrier
  s_cmp_lg_u32 s20, 0
  s_cbranch_scc1 Lnosig_46
  s_mov_b32 s63, s25
  s_atomic_smax s63, s[4:5], s62 glc
Lnosig_46:
L_F1_go:
  v_add_u32 v73, s26, v69
  v_add_u32 v74, s26, v70
  s_sub_u32 s26, 65536, s26
  s_add_u32 s27, s27, 2097152
  s_xor_b32 s27, s27, 0x2000
  s_add_u32 s29, s29, 1
  s_waitcnt vmcnt(8)
  s_barrier
  ds_read_b128 v[4:7], v73 offset:0
  ds_read_b128 v[8:11], v73 offset:1024
  ds_read_b128 v[12:15], v73 offset:2048
  ds_read_b128 v[16:19], v73 offset:3072
  ds_read_b128 v[20:23], v73 offset:4096
  ds_read_b128 v[24:27], v73 offset:5120
  s_waitcnt lgkmcnt(4)
  v_mfma_f32_16x16x32_bf16 v[36:39], a[0:3], v[4:7], 0
  ds_read_b128 v[28:31], v73 offset:6144
  v_mfma_f32_16x16x32_bf16 v[40:43], a[0:3], v[8:11], 0
  ds_read_b128 v[32:35], v73 offset:7168
  v_mfma_f32_16x16x32_bf16 v[44:47], a[128:131], v[4:7], 0
  s_add_u32 s36, s32, 49152
  s_add_u32 m0, s34, s36
  s_add_u32 s36, s35, 98304
  buffer_load_dwordx4 v1, s[4:7], s36 offen offset:0 sc1 lds
  v_mfma_f32_16x16x32_bf16 v[48:51], a[128:131], v[8:11], 0
  s_waitcnt lgkmcnt(4)
  v_mfma_f32_16x16x32_bf16 v[36:39], a[4:7], v[12:15], v[36:39]
  ds_read_b128 v[4:7], v73 offset:8192
  v_mfma_f32_16x16x32_bf16 v[40:43], a[4:7], v[16:19], v[40:43]
  ds_read_b128 v[8:11], v73 offset:9216
  v_mfma_f32_16x16x32_bf16 v[44:47], a[132:135], v[12:15], v[44:47]
  buffer_load_dwordx4 v1, s[4:7], s36 offen offset:1024 sc1 lds
  v_mfma_f32_16x16x32_bf16 v[48:51], a[132:135], v[16:19], v[48:51]
  s_waitcnt lgkmcnt(4)
  v_mfma_f32_16x16x32_bf16 v[36:39], a[8:11], v[20:23], v[36:39]
  ds_read_b128 v[12:15], v73 offset:10240
  v_mfma_f32_16x16x32_bf16 v[40:43], a[8:11], v[24:27], v[40:43]
  ds_read_b128 v[16:19], v73 offset:11264
  v_mfma_f32_16x16x32_bf16 v[44:47], a[136:139], v[20:23], v[44:47]
  buffer_load_dwordx4 v1, s[4:7], s36 offen offset:2048 sc1 lds
  v_mfma_f32_16x16x32_bf16 v[48:51], a[136:139], v[24:27], v[48:51]
  s_waitcnt lgkmcnt(4)
  v_mfma_f32_16x16x32_bf16 v[36:39], a[12:15], v[28:31], v[36:39]
  ds_read_b128 v[20:23], v73 offset:12288
  v_mfma_f32_16x16x32_bf16 v[40:43], a[12:15], v[32:35], v[40:43]
  ds_read_b128 v[24:27], v73 offset:13312
  v_mfma_f32_16x16x32_bf16 v[44:47], a[140:143], v[28:31], v[44:47]
  buffer_load_dwordx4 v1, s[4:7], s36 offen offset:3072 sc1 lds
  v_mfma_f32_16x16x32_bf16 v[48:51], a[140:143], v[32:35], v[48:51]
  s_waitcnt lgkmcnt(4)
  v_mfma_f32_16x16x32_bf16 v[36:39], a[16:19], v[4:7], v[36:39]
  ds_read_b128 v[28:31], v73 offset:14336
  v_mfma_f32_16x16x32_bf16 v[40:43], a[16:19], v[8:11], v[40:43]
  ds_read_b128 v[32:35], v73 offset:15360
  v_mfma_f32_16x16x32_bf16 v[44:47], a[144:147], v[4:7], v[44:47]
  v_mfma_f32_16x16x32_bf16 v[48:51], a[144:147], v[8:11], v[48:51]
  s_waitcnt vmcnt(8)
  s_barrier
  s_mov_b32 s34, s26
  s_mov_b32 s35, s27
  s_waitcnt lgkmcnt(4)
  v_mfma_f32_16x16x32_bf16 v[36:39], a[20:23], v[12:15], v[36:39]
  ds_read_b128 v[4:7], v73 offset:16384
  v_mfma_f32_16x16x32_bf16 v[40:43], a[20:23], v[16:19], v[40:43]
  ds_read_b128 v[8:11], v73 offset:17408
  v_mfma_f32_16x16x32_bf16 v[44:47], a[148:151], v[12:15], v[44:47]
  v_mfma_f32_16x16x32_bf16 v[48:51], a[148:151], v[16:19], v[48:51]
  s_waitcnt lgkmcnt(4)
  v_mfma_f32_16x16x32_bf16 v[36:39], a[24:27], v[20:23], v[36:39]
  ds_read_b128 v[12:15], v73 offset:18432
  v_mfma_f32_16x16x32_bf16 v[40:43], a[24:27], v[24:27], v[40:43]
  ds_read_b128 v[16:19], v73 offset:19456
  v_mfma_f32_16x16x32_bf16 v[44:47], a[152:155], v[20:23], v[44:47]
  v_mfma_f32_16x16x32_bf16 v[48:51], a[152:155], v[24:27], v[48:51]
  s_waitcnt lgkmcnt(4)
  v_mfma_f32_16x16x32_bf16 v[36:39], a[28:31], v[28:31], v[36:39]
  ds_read_b128 v[20:23], v73 offset:20480
  v_mfma_f32_16x16x32_bf16 v[40:43], a[28:31], v[32:35], v[40:43]
  ds_read_b128 v[24:27], v73 offset:21504
  v_mfma_f32_16x16x32_bf16 v[44:47], a[156:159], v[28:31], v[44:47]
  v_mfma_f32_16x16x32_bf16 v[48:51], a[156:159], v[32:35], v[48:51]
  s_waitcnt lgkmcnt(4)
  v_mfma_f32_16x16x32_bf16 v[36:39], a[32:35], v[4:7], v[36:39]
  ds_read_b128 v[28:31], v73 offset:22528
  v_mfma_f32_16x16x32_bf16 v[40:43], a[32:35], v[8:11], v[40:43]
  ds_read_b128 v[32:35], v73 offset:23552
  v_mfma_f32_16x16x32_bf16 v[44:47], a[160:163], v[4:7], v[44:47]
  v_mfma_f32_16x16x32_bf16 v[48:51], a[160:163], v[8:11], v[48:51]
  s_waitcnt lgkmcnt(4)
  v_mfma_f32_16x16x32_bf16 v[36:39], a[36:39], v[12:15], v[36:39]
  ds_read_b128 v[4:7], v73 offset:24576
  v_mfma_f32_16x16x32_bf16 v[40:43], a[36:39], v[16:19], v[40:43]
  ds_read_b128 v[8:11], v73 offset:25600
  v_mfma_f32_16x16x32_bf16 v[44:47], a[164:167], v[12:15], v[44:47]
  v_mfma_f32_16x16x32_bf16 v[48:51], a[164:167], v[16:19], v[48:51]
  s_waitcnt lgkmcnt(4)
  v_mfma_f32_16x16x32_bf16 v[36:39], a[40:43], v[20:23], v[36:39]
  ds_read_b128 v[12:15], v73 offset:26624
  v_mfma_f32_16x16x32_bf16 v[40:43], a[40:43], v[24:27], v[40:43]
  ds_read_b128 v[16:19], v73 offset:27648
  v_mfma_f32_16x16x32_bf16 v[44:47], a[168:171], v[20:23], v[44:47]
  v_mfma_f32_16x16x32_bf16 v[48:51], a[168:171], v[24:27], v[48:51]
  s_waitcnt lgkmcnt(4)
  v_mfma_f32_16x16x32_bf16 v[36:39], a[44:47], v[28:31], v[36:39]
  ds_read_b128 v[20:23], v73 offset:28672
  v_mfma_f32_16x16x32_bf16 v[40:43], a[44:47], v[32:35], v[40:43]
  ds_read_b128 v[24:27], v73 offset:29696
  v_mfma_f32_16x16x32_bf16 v[44:47], a[172:175], v[28:31], v[44:47]
  v_mfma_f32_16x16x32_bf16 v[48:51], a[172:175], v[32:35], v[48:51]
  s_lshl_b32 s40, s20, 8
  s_add_u32 m0, s40, 131072
  s_cmp_eq_u32 s20, 0
  s_cselect_b32 s40, s30, 2147483392
  buffer_load_dword v2, s[4:7], s40 offen sc1 lds
  s_waitcnt lgkmcnt(4)
  v_mfma_f32_16x16x32_bf16 v[36:39], a[48:51], v[4:7], v[36:39]
  ds_read_b128 v[28:31], v73 offset:30720
  v_mfma_f32_16x16x32_bf16 v[40:43], a[48:51], v[8:11], v[40:43]
  ds_read_b128 v[32:35], v73 offset:31744
  v_mfma_f32_16x16x32_bf16 v[44:47], a[176:179], v[4:7], v[44:47]
  v_mfma_f32_16x16x32_bf16 v[48:51], a[176:179], v[8:11], v[48:51]
  s_waitcnt vmcnt(5)
  s_barrier
  s_lshl_b32 s40, s20, 1
  s_add_u32 s40, s40, 1
  s_cmp_lg_u32 s40, s28
  s_cbranch_scc1 L_F1_s2
  s_mov_b32 s63, s25
  s_atomic_smax s63, s[4:5], s62 glc
Lnosig_47:
L_F1_s2:
  s_waitcnt lgkmcnt(4)
  v_mfma_f32_16x16x32_bf16 v[36:39], a[52:55], v[12:15], v[36:39]
  ds_read_b128 v[4:7], v73 offset:32768
  v_mfma_f32_16x16x32_bf16 v[40:43], a[52:55], v[16:19], v[40:43]
  ds_read_b128 v[8:11], v73 offset:33792
  v_mfma_f32_16x16x32_bf16 v[44:47], a[180:183], v[12:15], v[44:47]
  v_mfma_f32_16x16x32_bf16 v[48:51], a[180:183], v[16:19], v[48:51]
  s_waitcnt lgkmcnt(4)
  v_mfma_f32_16x16x32_bf16 v[36:39], a[56:59], v[20:23], v[36:39]
  ds_read_b128 v[12:15], v73 offset:34816
  v_mfma_f32_16x16x32_bf16 v[40:43], a[56:59], v[24:27], v[40:43]
  ds_read_b128 v[16:19], v73 offset:35840
  v_mfma_f32_16x16x32_bf16 v[44:47], a[184:187], v[20:23], v[44:47]
  v_mfma_f32_16x16x32_bf16 v[48:51], a[184:187], v[24:27], v[48:51]
  s_waitcnt lgkmcnt(4)
  v_mfma_f32_16x16x32_bf16 v[36:39], a[60:63], v[28:31], v[36:39]
  ds_read_b128 v[20:23], v73 offset:36864
  v_mfma_f32_16x16x32_bf16 v[40:43], a[60:63], v[32:35], v[40:43]
  ds_read_b128 v[24:27], v73 offset:37888
  v_mfma_f32_16x16x32_bf16 v[44:47], a[188:191], v[28:31], v[44:47]
  v_mfma_f32_16x16x32_bf16 v[48:51], a[188:191], v[32:35], v[48:51]
  s_waitcnt lgkmcnt(4)
  v_mfma_f32_16x16x32_bf16 v[36:39], a[64:67], v[4:7], v[36:39]
  ds_read_b128 v[28:31], v73 offset:38912
  v_mfma_f32_16x16x32_bf16 v[40:43], a[64:67], v[8:11], v[40:43]
  ds_read_b128 v[32:35], v73 offset:39936
  v_mfma_f32_16x16x32_bf16 v[44:47], a[192:195], v[4:7], v[44:47]
  v_mfma_f32_16x16x32_bf16 v[48:51], a[192:195], v[8:11], v[48:51]
  s_waitcnt lgkmcnt(4)
  v_mfma_f32_16x16x32_bf16 v[36:39], a[68:71], v[12:15], v[36:39]
  ds_read_b128 v[4:7], v73 offset:40960
  v_mfma_f32_16x16x32_bf16 v[40:43], a[68:71], v[16:19], v[40:43]
  ds_read_b128 v[8:11], v73 offset:41984
  v_mfma_f32_16x16x32_bf16 v[44:47], a[196:199], v[12:15], v[44:47]
  v_mfma_f32_16x16x32_bf16 v[48:51], a[196:199], v[16:19], v[48:51]
  s_waitcnt lgkmcnt(4)
  v_mfma_f32_16x16x32_bf16 v[36:39], a[72:75], v[20:23], v[36:39]
  ds_read_b128 v[12:15], v73 offset:43008
  v_mfma_f32_16x16x32_bf16 v[40:43], a[72:75], v[24:27], v[40:43]
  ds_read_b128 v[16:19], v73 offset:44032
  v_mfma_f32_16x16x32_bf16 v[44:47], a[200:203], v[20:23], v[44:47]
  v_mfma_f32_16x16x32_bf16 v[48:51], a[200:203], v[24:27], v[48:51]
  s_waitcnt vmcnt(0)
  s_barrier
  ds_read_b32 v3, v71
  s_waitcnt lgkmcnt(4)
  v_mfma_f32_16x16x32_bf16 v[36:39], a[76:79], v[28:31], v[36:39]
  ds_read_b128 v[20:23], v73 offset:45056
  v_mfma_f32_16x16x32_bf16 v[40:43], a[76:79], v[32:35], v[40:43]
  ds_read_b128 v[24:27], v73 offset:46080
  v_mfma_f32_16x16x32_bf16 v[44:47], a[204:207], v[28:31], v[44:47]
  v_mfma_f32_16x16x32_bf16 v[48:51], a[204:207], v[32:35], v[48:51]
  s_waitcnt lgkmcnt(4)
  v_mfma_f32_16x16x32_bf16 v[36:39], a[80:83], v[4:7], v[36:39]
  ds_read_b128 v[28:31], v73 offset:47104
  v_mfma_f32_16x16x32_bf16 v[40:43], a[80:83], v[8:11], v[40:43]
  ds_read_b128 v[32:35], v73 offset:48128
  v_mfma_f32_16x16x32_bf16 v[44:47], a[208:211], v[4:7], v[44:47]
  v_mfma_f32_16x16x32_bf16 v[48:51], a[208:211], v[8:11], v[48:51]
  s_waitcnt lgkmcnt(4)
  v_cmp_gt_i32 vcc, s29, v3
  s_mov_b32 s28, 0
  s_cbranch_vccnz L_F1_nopf
  s_cmp_ge_u32 s25, 63
  s_cbranch_scc1 L_F1_nopf
  s_mov_b32 s28, 1
  s_waitcnt lgkmcnt(4)
  v_mfma_f32_16x16x32_bf16 v[36:39], a[84:87], v[12:15], v[36:39]
  ds_read_b128 v[4:7], v73 offset:49152
  v_mfma_f32_16x16x32_bf16 v[40:43], a[84:87], v[16:19], v[40:43]
  ds_read_b128 v[8:11], v73 offset:50176
  v_mfma_f32_16x16x32_bf16 v[44:47], a[212:215], v[12:15], v[44:47]
  s_add_u32 s36, s32, 0
  s_add_u32 m0, s34, s36
  s_add_u32 s36, s35, 0
  buffer_load_dwordx4 v1, s[4:7], s36 offen offset:0 sc1 lds
  v_mfma_f32_16x16x32_bf16 v[48:51], a[212:215], v[16:19], v[48:51]
  buffer_load_dwordx4 v1, s[4:7], s36 offen offset:1024 sc1 lds
  s_waitcnt lgkmcnt(4)
  v_mfma_f32_16x16x32_bf16 v[36:39], a[88:91], v[20:23], v[36:39]
  ds_read_b128 v[12:15], v73 offset:51200
  v_mfma_f32_16x16x32_bf16 v[40:43], a[88:91], v[24:27], v[40:43]
  ds_read_b128 v[16:19], v73 offset:52224
  v_mfma_f32_16x16x32_bf16 v[44:47], a[216:219], v[20:23], v[44:47]
  buffer_load_dwordx4 v1, s[4:7], s36 offen offset:2048 sc1 lds
  v_mfma_f32_16x16x32_bf16 v[48:51], a[216:219], v[24:27], v[48:51]
  buffer_load_dwordx4 v1, s[4:7], s36 offen offset:3072 sc1 lds
  s_waitcnt lgkmcnt(4)
  v_mfma_f32_16x16x32_bf16 v[36:39], a[92:95], v[28:31], v[36:39]
  ds_read_b128 v[20:23], v73 offset:53248
  v_mfma_f32_16x16x32_bf16 v[40:43], a[92:95], v[32:35], v[40:43]
  ds_read_b128 v[24:27], v73 offset:54272
  v_mfma_f32_16x16x32_bf16 v[44:47], a[220:223], v[28:31], v[44:47]
  s_add_u32 s36, s32, 16384
  s_add_u32 m0, s34, s36
  s_add_u32 s36, s35, 32768
  buffer_load_dwordx4 v1, s[4:7], s36 offen offset:0 sc1 lds
  v_mfma_f32_16x16x32_bf16 v[48:51], a[220:223], v[32:35], v[48:51]
  buffer_load_dwordx4 v1, s[4:7], s36 offen offset:1024 sc1 lds
  s_waitcnt lgkmcnt(4)
  v_mfma_f32_16x16x32_bf16 v[36:39], a[96:99], v[4:7], v[36:39]
  ds_read_b128 v[28:31], v73 offset:55296
  v_mfma_f32_16x16x32_bf16 v[40:43], a[96:99], v[8:11], v[40:43]
  ds_read_b128 v[32:35], v73 offset:56320
  v_mfma_f32_16x16x32_bf16 v[44:47], a[224:227], v[4:7], v[44:47]
  buffer_load_dwordx4 v1, s[4:7], s36 offen offset:2048 sc1 lds
  v_mfma_f32_16x16x32_bf16 v[48:51], a[224:227], v[8:11], v[48:51]
  buffer_load_dwordx4 v1, s[4:7], s36 offen offset:3072 sc1 lds
  s_waitcnt lgkmcnt(4)
  v_mfma_f32_16x16x32_bf16 v[36:39], a[100:103], v[12:15], v[36:39]
  ds_read_b128 v[4:7], v73 offset:57344
  v_mfma_f32_16x16x32_bf16 v[40:43], a[100:103], v[16:19], v[40:43]
  ds_read_b128 v[8:11], v73 offset:58368
  v_mfma_f32_16x16x32_bf16 v[44:47], a[228:231], v[12:15], v[44:47]
  s_add_u32 s36, s32, 32768
  s_add_u32 m0, s34, s36
  s_add_u32 s36, s35, 65536
  buffer_load_dwordx4 v1, s[4:7], s36 offen offset:0 sc1 lds
  v_mfma_f32_16x16x32_bf16 v[48:51], a[228:231], v[16:19], v[48:51]
  buffer_load_dwordx4 v1, s[4:7], s36 offen offset:1024 sc1 lds
  s_waitcnt lgkmcnt(4)
  v_mfma_f32_16x16x32_bf16 v[36:39], a[104:107], v[20:23], v[36:39]
  ds_read_b128 v[12:15], v73 offset:59392
  v_mfma_f32_16x16x32_bf16 v[40:43], a[104:107], v[24:27], v[40:43]
  ds_read_b128 v[16:19], v73 offset:60416
  v_mfma_f32_16x16x32_bf16 v[44:47], a[232:235], v[20:23], v[44:47]
  buffer_load_dwordx4 v1, s[4:7], s36 offen offset:2048 sc1 lds
  v_mfma_f32_16x16x32_bf16 v[48:51], a[232:235], v[24:27], v[48:51]
  buffer_load_dwordx4 v1, s[4:7], s36 offen offset:3072 sc1 lds
  s_waitcnt lgkmcnt(4)
  v_mfma_f32_16x16x32_bf16 v[36:39], a[108:111], v[28:31], v[36:39]
  ds_read_b128 v[20:23], v73 offset:61440
  v_mfma_f32_16x16x32_bf16 v[40:43], a[108:111], v[32:35], v[40:43]
  ds_read_b128 v[24:27], v73 offset:62464
  v_mfma_f32_16x16x32_bf16 v[44:47], a[236:239], v[28:31], v[44:47]
  v_mfma_f32_16x16x32_bf16 v[48:51], a[236:239], v[32:35], v[48:51]
  s_waitcnt lgkmcnt(4)
  v_mfma_f32_16x16x32_bf16 v[36:39], a[112:115], v[4:7], v[36:39]
  ds_read_b128 v[28:31], v73 offset:63488
  v_mfma_f32_16x16x32_bf16 v[40:43], a[112:115], v[8:11], v[40:43]
  ds_read_b128 v[32:35], v73 offset:64512
  v_mfma_f32_16x16x32_bf16 v[44:47], a[240:243], v[4:7], v[44:47]
  v_mfma_f32_16x16x32_bf16 v[48:51], a[240:243], v[8:11], v[48:51]
  s_waitcnt lgkmcnt(4)
  v_mfma_f32_16x16x32_bf16 v[36:39], a[116:119], v[12:15], v[36:39]
  v_mfma_f32_16x16x32_bf16 v[40:43], a[116:119], v[16:19], v[40:43]
  v_mfma_f32_16x16x32_bf16 v[44:47], a[244:247], v[12:15], v[44:47]
  v_mfma_f32_16x16x32_bf16 v[48:51], a[244:247], v[16:19], v[48:51]
  s_waitcnt lgkmcnt(2)
  v_mfma_f32_16x16x32_bf16 v[36:39], a[120:123], v[20:23], v[36:39]
  v_mfma_f32_16x16x32_bf16 v[40:43], a[120:123], v[24:27], v[40:43]
  v_mfma_f32_16x16x32_bf16 v[44:47], a[248:251], v[20:23], v[44:47]
  v_mfma_f32_16x16x32_bf16 v[48:51], a[248:251], v[24:27], v[48:51]
  s_waitcnt lgkmcnt(0)
  v_mfma_f32_16x16x32_bf16 v[36:39], a[124:127], v[28:31], v[36:39]
  v_mfma_f32_16x16x32_bf16 v[40:43], a[124:127], v[32:35], v[40:43]
  v_mfma_f32_16x16x32_bf16 v[44:47], a[252:255], v[28:31], v[44:47]
  v_mfma_f32_16x16x32_bf16 v[48:51], a[252:255], v[32:35], v[48:51]
  s_nop 7
  s_branch L_F1_epi
L_F1_nopf:
  s_waitcnt lgkmcnt(4)
  v_mfma_f32_16x16x32_bf16 v[36:39], a[84:87], v[12:15], v[36:39]
  ds_read_b128 v[4:7], v73 offset:49152
  v_mfma_f32_16x16x32_bf16 v[40:43], a[84:87], v[16:19], v[40:43]
  ds_read_b128 v[8:11], v73 offset:50176
  v_mfma_f32_16x16x32_bf16 v[44:47], a[212:215], v[12:15], v[44:47]
  v_mfma_f32_16x16x32_bf16 v[48:51], a[212:215], v[16:19], v[48:51]
  s_waitcnt lgkmcnt(4)
  v_mfma_f32_16x16x32_bf16 v[36:39], a[88:91], v[20:23], v[36:39]
  ds_read_b128 v[12:15], v73 offset:51200
  v_mfma_f32_16x16x32_bf16 v[40:43], a[88:91], v[24:27], v[40:43]
  ds_read_b128 v[16:19], v73 offset:52224
  v_mfma_f32_16x16x32_bf16 v[44:47], a[216:219], v[20:23], v[44:47]
  v_mfma_f32_16x16x32_bf16 v[48:51], a[216:219], v[24:27], v[48:51]
  s_waitcnt lgkmcnt(4)
  v_mfma_f32_16x16x32_bf16 v[36:39], a[92:95], v[28:31], v[36:39]
  ds_read_b128 v[20:23], v73 offset:53248
  v_mfma_f32_16x16x32_bf16 v[40:43], a[92:95], v[32:35], v[40:43]
  ds_read_b128 v[24:27], v73 offset:54272
  v_mfma_f32_16x16x32_bf16 v[44:47], a[220:223], v[28:31], v[44:47]
  v_mfma_f32_16x16x32_bf16 v[48:51], a[220:223], v[32:35], v[48:51]
  s_barrier
  s_lshl_b32 s40, s20, 8
  s_add_u32 m0, s40, 131072
  s_cmp_eq_u32 s20, 0
  s_cselect_b32 s40, s30, 2147483392
  buffer_load_dword v2, s[4:7], s40 offen sc1 lds
  s_waitcnt lgkmcnt(4)
  v_mfma_f32_16x16x32_bf16 v[36:39], a[96:99], v[4:7], v[36:39]
  ds_read_b128 v[28:31], v73 offset:55296
  v_mfma_f32_16x16x32_bf16 v[40:43], a[96:99], v[8:11], v[40:43]
  ds_read_b128 v[32:35], v73 offset:56320
  v_mfma_f32_16x16x32_bf16 v[44:47], a[224:227], v[4:7], v[44:47]
  v_mfma_f32_16x16x32_bf16 v[48:51], a[224:227], v[8:11], v[48:51]
  s_waitcnt lgkmcnt(4)
  v_mfma_f32_16x16x32_bf16 v[36:39], a[100:103], v[12:15], v[36:39]
  ds_read_b128 v[4:7], v73 offset:57344
  v_mfma_f32_16x16x32_bf16 v[40:43], a[100:103], v[16:19], v[40:43]
  ds_read_b128 v[8:11], v73 offset:58368
  v_mfma_f32_16x16x32_bf16 v[44:47], a[228:231], v[12:15], v[44:47]
  v_mfma_f32_16x16x32_bf16 v[48:51], a[228:231], v[16:19], v[48:51]
  s_waitcnt lgkmcnt(4)
  v_mfma_f32_16x16x32_bf16 v[36:39], a[104:107], v[20:23], v[36:39]
  ds_read_b128 v[12:15], v73 offset:59392
  v_mfma_f32_16x16x32_bf16 v[40:43], a[104:107], v[24:27], v[40:43]
  ds_read_b128 v[16:19], v73 offset:60416
  v_mfma_f32_16x16x32_bf16 v[44:47], a[232:235], v[20:23], v[44:47]
  v_mfma_f32_16x16x32_bf16 v[48:51], a[232:235], v[24:27], v[48:51]
  s_waitcnt lgkmcnt(4)
  v_mfma_f32_16x16x32_bf16 v[36:39], a[108:111], v[28:31], v[36:39]
  ds_read_b128 v[20:23], v73 offset:61440
  v_mfma_f32_16x16x32_bf16 v[40:43], a[108:111], v[32:35], v[40:43]
  ds_read_b128 v[24:27], v73 offset:62464
  v_mfma_f32_16x16x32_bf16 v[44:47], a[236:239], v[28:31], v[44:47]
  v_mfma_f32_16x16x32_bf16 v[48:51], a[236:239], v[32:35], v[48:51]
  s_waitcnt lgkmcnt(4)
  v_mfma_f32_16x16x32_bf16 v[36:39], a[112:115], v[4:7], v[36:39]
  ds_read_b128 v[28:31], v73 offset:63488
  v_mfma_f32_16x16x32_bf16 v[40:43], a[112:115], v[8:11], v[40:43]
  ds_read_b128 v[32:35], v73 offset:64512
  v_mfma_f32_16x16x32_bf16 v[44:47], a[240:243], v[4:7], v[44:47]
  v_mfma_f32_16x16x32_bf16 v[48:51], a[240:243], v[8:11], v[48:51]
  s_waitcnt lgkmcnt(4)
  v_mfma_f32_16x16x32_bf16 v[36:39], a[116:119], v[12:15], v[36:39]
  v_mfma_f32_16x16x32_bf16 v[40:43], a[116:119], v[16:19], v[40:43]
  v_mfma_f32_16x16x32_bf16 v[44:47], a[244:247], v[12:15], v[44:47]
  v_mfma_f32_16x16x32_bf16 v[48:51], a[244:247], v[16:19], v[48:51]
  s_waitcnt vmcnt(0)
  s_barrier
  ds_read_b32 v3, v71
  s_waitcnt lgkmcnt(2)
  v_mfma_f32_16x16x32_bf16 v[36:39], a[120:123], v[20:23], v[36:39]
  v_mfma_f32_16x16x32_bf16 v[40:43], a[120:123], v[24:27], v[40:43]
  v_mfma_f32_16x16x32_bf16 v[44:47], a[248:251], v[20:23], v[44:47]
  v_mfma_f32_16x16x32_bf16 v[48:51], a[248:251], v[24:27], v[48:51]
  s_waitcnt lgkmcnt(0)
  v_mfma_f32_16x16x32_bf16 v[36:39], a[124:127], v[28:31], v[36:39]
  v_mfma_f32_16x16x32_bf16 v[40:43], a[124:127], v[32:35], v[40:43]
  v_mfma_f32_16x16x32_bf16 v[44:47], a[252:255], v[28:31], v[44:47]
  v_mfma_f32_16x16x32_bf16 v[48:51], a[252:255], v[32:35], v[48:51]
  v_cmp_gt_i32 vcc, s29, v3
  s_cmp_eq_u64 vcc, 0
  s_cselect_b32 s28, 2, 0
  s_cmp_lt_u32 s25, 63
  s_cselect_b32 s28, s28, 0
L_F1_epi:
  v_mul_f32 v52, s37, v36
  v_mul_f32 v53, s37, v37
  v_mul_f32 v54, s37, v38
  v_mul_f32 v55, s37, v39
  v_mul_f32 v56, s37, v40
  v_mul_f32 v57, s37, v41
  v_mul_f32 v58, s37, v42
  v_mul_f32 v59, s37, v43
  v_exp_f32 v52, v52
  v_exp_f32 v53, v53
  v_exp_f32 v54, v54
  v_exp_f32 v55, v55
  v_exp_f32 v56, v56
  v_exp_f32 v57, v57
  v_exp_f32 v58, v58
  v_exp_f32 v59, v59
  v_pk_mul_f32 v[36:37], v[36:37], v[44:45]
  v_pk_mul_f32 v[38:39], v[38:39], v[46:47]
  v_pk_mul_f32 v[40:41], v[40:41], v[48:49]
  v_pk_mul_f32 v[42:43], v[42:43], v[50:51]
  v_add_f32 v52, 1.0, v52
  v_add_f32 v53, 1.0, v53
  v_add_f32 v54, 1.0, v54
  v_add_f32 v55, 1.0, v55
  v_add_f32 v56, 1.0, v56
  v_add_f32 v57, 1.0, v57
  v_add_f32 v58, 1.0, v58
  v_add_f32 v59, 1.0, v59
  v_rcp_f32 v52, v52
  v_rcp_f32 v53, v53
  v_rcp_f32 v54, v54
  v_rcp_f32 v55, v55
  v_rcp_f32 v56, v56
  v_rcp_f32 v57, v57
  v_rcp_f32 v58, v58
  v_rcp_f32 v59, v59
  v_pk_mul_f32 v[36:37], v[36:37], v[52:53]
  v_pk_mul_f32 v[38:39], v[38:39], v[54:55]
  v_pk_mul_f32 v[40:41], v[40:41], v[56:57]
  v_pk_mul_f32 v[42:43], v[42:43], v[58:59]
  v_cvt_pk_bf16_f32 v60, v36, v37
  v_cvt_pk_bf16_f32 v61, v38, v39
  v_cvt_pk_bf16_f32 v62, v40, v41
  v_cvt_pk_bf16_f32 v63, v42, v43
  s_nop 0
  v_permlane32_swap_b32 v60, v62
  v_permlane32_swap_b32 v61, v63
  buffer_store_dwordx4 v[60:63], v68, s[4:7], s31 offen sc1
  s_add_u32 s25, s25, 1
  s_add_u32 s31, s31, 2097152
  s_xor_b32 s31, s31, 0x2000
  s_branch L_F1_top
L_F2:
  v_lshlrev_b32 v1, 4, v0
  s_lshl_b32 s32, s20, 12
  s_min_u32 s33, s32, 0x2000
  v_mov_b32 v69, v1
  v_add_u32 v70, 0x10000, v69
  s_load_dwordx2 s[8:9], s[0:1], 80
  s_mov_b32 s10, 7340032
  s_mov_b32 s11, 0x20000
  s_waitcnt lgkmcnt(0)
  s_lshr_b32 s44, s21, 3
  s_mul_i32 s44, s44, 2490368
  s_and_b32 s45, s21, 7
  s_lshl_b32 s45, s45, 8
  s_add_u32 s44, s44, s45
  s_add_u32 s45, s44, 128
  s_cmp_ge_u32 s21, 16
  s_cselect_b32 s40, 131072, 0
  s_sub_u32 s44, s44, s40
  s_sub_u32 s45, s45, s40
  v_bfe_u32 v4, v0, 5, 1
  v_mul_u32_u24 v4, 8192, v4
  v_bfe_u32 v5, v0, 4, 1
  v_mul_u32_u24 v5, 4096, v5
  v_add_u32 v4, v4, v5
  v_bfe_u32 v5, v0, 3, 1
  v_mul_u32_u24 v5, 2048, v5
  v_add_u32 v4, v4, v5
  v_lshrrev_b32 v5, 3, v0
  v_and_b32 v5, 6, v5
  v_xor_b32 v5, v5, v0
  v_and_b32 v5, 7, v5
  v_lshl_add_u32 v4, v5, 4, v4
  s_lshr_b32 s40, s20, 1
  s_mul_i32 s40, s40, 16384
  s_and_b32 s41, s20, 1
  s_mul_i32 s41, s41, 32768
  s_add_u32 s40, s40, s41
  v_add_u32 v4, s40, v4
  v_bfe_u32 v5, v0, 3, 2
  v_xor_b32 v5, s20, v5
  v_lshlrev_b32 v5, 5, v5
  v_lshrrev_b32 v6, 2, v0
  v_lshl_add_u32 v6, v6, 7, v5
  v_and_b32 v5, 3, v0
  v_lshl_add_u32 v6, v5, 3, v6
  v_add_u32 v7, 0x10000, v6
  v_add_u32 v8, s44, v4
  v_add_u32 v9, s45, v4
  s_lshl_b32 s41, s20, 10
  s_add_u32 m0, s41, 0
  s_mov_b32 s42, 0
  buffer_load_dwordx4 v8, s[8:11], s42 offen nt lds
  s_add_u32 m0, s41, 4096
  s_mov_b32 s42, 0
  buffer_load_dwordx4 v9, s[8:11], s42 offen nt lds
  s_add_u32 m0, s41, 8192
  s_mov_b32 s42, 65536
  buffer_load_dwordx4 v8, s[8:11], s42 offen nt lds
  s_add_u32 m0, s41, 12288
  s_mov_b32 s42, 65536
  buffer_load_dwordx4 v9, s[8:11], s42 offen nt lds
  s_add_u32 m0, s41, 16384
  s_mov_b32 s42, 131072
  buffer_load_dwordx4 v8, s[8:11], s42 offen nt lds
  s_add_u32 m0, s41, 20480
  s_mov_b32 s42, 131072
  buffer_load_dwordx4 v9, s[8:11], s42 offen nt lds
  s_add_u32 m0, s41, 24576
  s_mov_b32 s42, 196608
  buffer_load_dwordx4 v8, s[8:11], s42 offen nt lds
  s_add_u32 m0, s41, 28672
  s_mov_b32 s42, 196608
  buffer_load_dwordx4 v9, s[8:11], s42 offen nt lds
  s_add_u32 m0, s41, 32768
  s_mov_b32 s42, 262144
  buffer_load_dwordx4 v8, s[8:11], s42 offen nt lds
  s_add_u32 m0, s41, 36864
  s_mov_b32 s42, 262144
  buffer_load_dwordx4 v9, s[8:11], s42 offen nt lds
  s_add_u32 m0, s41, 40960
  s_mov_b32 s42, 327680
  buffer_load_dwordx4 v8, s[8:11], s42 offen nt lds
  s_add_u32 m0, s41, 45056
  s_mov_b32 s42, 327680
  buffer_load_dwordx4 v9, s[8:11], s42 offen nt lds
  s_add_u32 m0, s41, 49152
  s_mov_b32 s42, 393216
  buffer_load_dwordx4 v8, s[8:11], s42 offen nt lds
  s_add_u32 m0, s41, 53248
  s_mov_b32 s42, 393216
  buffer_load_dwordx4 v9, s[8:11], s42 offen nt lds
  s_add_u32 m0, s41, 57344
  s_mov_b32 s42, 458752
  buffer_load_dwordx4 v8, s[8:11], s42 offen nt lds
  s_add_u32 m0, s41, 61440
  s_mov_b32 s42, 458752
  buffer_load_dwordx4 v9, s[8:11], s42 offen nt lds
  s_add_u32 m0, s41, 65536
  s_mov_b32 s42, 524288
  buffer_load_dwordx4 v8, s[8:11], s42 offen nt lds
  s_add_u32 m0, s41, 69632
  s_mov_b32 s42, 524288
  buffer_load_dwordx4 v9, s[8:11], s42 offen nt lds
  s_add_u32 m0, s41, 73728
  s_mov_b32 s42, 589824
  buffer_load_dwordx4 v8, s[8:11], s42 offen nt lds
  s_add_u32 m0, s41, 77824
  s_mov_b32 s42, 589824
  buffer_load_dwordx4 v9, s[8:11], s42 offen nt lds
  s_add_u32 m0, s41, 81920
  s_mov_b32 s42, 655360
  buffer_load_dwordx4 v8, s[8:11], s42 offen nt lds
  s_add_u32 m0, s41, 86016
  s_mov_b32 s42, 655360
  buffer_load_dwordx4 v9, s[8:11], s42 offen nt lds
  s_add_u32 m0, s41, 90112
  s_mov_b32 s42, 720896
  buffer_load_dwordx4 v8, s[8:11], s42 offen nt lds
  s_add_u32 m0, s41, 94208
  s_mov_b32 s42, 720896
  buffer_load_dwordx4 v9, s[8:11], s42 offen nt lds
  s_add_u32 m0, s41, 98304
  s_mov_b32 s42, 786432
  buffer_load_dwordx4 v8, s[8:11], s42 offen nt lds
  s_add_u32 m0, s41, 102400
  s_mov_b32 s42, 786432
  buffer_load_dwordx4 v9, s[8:11], s42 offen nt lds
  s_add_u32 m0, s41, 106496
  s_mov_b32 s42, 851968
  buffer_load_dwordx4 v8, s[8:11], s42 offen nt lds
  s_add_u32 m0, s41, 110592
  s_mov_b32 s42, 851968
  buffer_load_dwordx4 v9, s[8:11], s42 offen nt lds
  s_waitcnt vmcnt(24) lgkmcnt(0)
  s_barrier
  s_add_u32 m0, s41, 114688
  s_mov_b32 s42, 917504
  buffer_load_dwordx4 v8, s[8:11], s42 offen nt lds
  s_add_u32 m0, s41, 118784
  s_mov_b32 s42, 917504
  buffer_load_dwordx4 v9, s[8:11], s42 offen nt lds
  s_add_u32 m0, s41, 122880
  s_mov_b32 s42, 983040
  buffer_load_dwordx4 v8, s[8:11], s42 offen nt lds
  s_add_u32 m0, s41, 126976
  s_mov_b32 s42, 983040
  buffer_load_dwordx4 v9, s[8:11], s42 offen nt lds
  ds_read_b64_tr_b16 a[0:1], v6 offset:0
  ds_read_b64_tr_b16 a[2:3], v6 offset:2048
  ds_read_b64_tr_b16 a[152:153], v6 offset:4096
  ds_read_b64_tr_b16 a[154:155], v6 offset:6144
  ds_read_b64_tr_b16 a[4:5], v6 offset:8192
  ds_read_b64_tr_b16 a[6:7], v6 offset:10240
  ds_read_b64_tr_b16 a[156:157], v6 offset:12288
  ds_read_b64_tr_b16 a[158:159], v6 offset:14336
  s_waitcnt vmcnt(24) lgkmcnt(0)
  s_barrier
  s_add_u32 m0, s41, 0
  s_mov_b32 s42, 1048576
  buffer_load_dwordx4 v8, s[8:11], s42 offen nt lds
  s_add_u32 m0, s41, 4096
  s_mov_b32 s42, 1048576
  buffer_load_dwordx4 v9, s[8:11], s42 offen nt lds
  s_add_u32 m0, s41, 8192
  s_mov_b32 s42, 1114112
  buffer_load_dwordx4 v8, s[8:11], s42 offen nt lds
  s_add_u32 m0, s41, 12288
  s_mov_b32 s42, 1114112
  buffer_load_dwordx4 v9, s[8:11], s42 offen nt lds
  ds_read_b64_tr_b16 a[8:9], v6 offset:16384
  ds_read_b64_tr_b16 a[10:11], v6 offset:18432
  ds_read_b64_tr_b16 a[160:161], v6 offset:20480
  ds_read_b64_tr_b16 a[162:163], v6 offset:22528
  ds_read_b64_tr_b16 a[12:13], v6 offset:24576
  ds_read_b64_tr_b16 a[14:15], v6 offset:26624
  ds_read_b64_tr_b16 a[164:165], v6 offset:28672
  ds_read_b64_tr_b16 a[166:167], v6 offset:30720
  s_waitcnt vmcnt(24) lgkmcnt(0)
  s_barrier
  s_add_u32 m0, s41, 16384
  s_mov_b32 s42, 1179648
  buffer_load_dwordx4 v8, s[8:11], s42 offen nt lds
  s_add_u32 m0, s41, 20480
  s_mov_b32 s42, 1179648
  buffer_load_dwordx4 v9, s[8:11], s42 offen nt lds
  s_add_u32 m0, s41, 24576
  s_mov_b32 s42, 1245184
  buffer_load_dwordx4 v8, s[8:11], s42 offen nt lds
  s_add_u32 m0, s41, 28672
  s_mov_b32 s42, 1245184
  buffer_load_dwordx4 v9, s[8:11], s42 offen nt lds
  ds_read_b64_tr_b16 a[16:17], v6 offset:32768
  ds_read_b64_tr_b16 a[18:19], v6 offset:34816
  ds_read_b64_tr_b16 a[168:169], v6 offset:36864
  ds_read_b64_tr_b16 a[170:171], v6 offset:38912
  ds_read_b64_tr_b16 a[20:21], v6 offset:40960
  ds_read_b64_tr_b16 a[22:23], v6 offset:43008
  ds_read_b64_tr_b16 a[172:173], v6 offset:45056
  ds_read_b64_tr_b16 a[174:175], v6 offset:47104
  s_waitcnt vmcnt(24) lgkmcnt(0)
  s_barrier
  s_add_u32 m0, s41, 32768
  s_mov_b32 s42, 1310720
  buffer_load_dwordx4 v8, s[8:11], s42 offen nt lds
  s_add_u32 m0, s41, 36864
  s_mov_b32 s42, 1310720
  buffer_load_dwordx4 v9, s[8:11], s42 offen nt lds
  s_add_u32 m0, s41, 40960
  s_mov_b32 s42, 1376256
  buffer_load_dwordx4 v8, s[8:11], s42 offen nt lds
  s_add_u32 m0, s41, 45056
  s_mov_b32 s42, 1376256
  buffer_load_dwordx4 v9, s[8:11], s42 offen nt lds
  ds_read_b64_tr_b16 a[24:25], v6 offset:49152
  ds_read_b64_tr_b16 a[26:27], v6 offset:51200
  ds_read_b64_tr_b16 a[176:177], v6 offset:53248
  ds_read_b64_tr_b16 a[178:179], v6 offset:55296
  ds_read_b64_tr_b16 a[28:29], v6 offset:57344
  ds_read_b64_tr_b16 a[30:31], v6 offset:59392
  ds_read_b64_tr_b16 a[180:181], v6 offset:61440
  ds_read_b64_tr_b16 a[182:183], v6 offset:63488
  s_waitcnt vmcnt(24) lgkmcnt(0)
  s_barrier
  s_add_u32 m0, s41, 49152
  s_mov_b32 s42, 1441792
  buffer_load_dwordx4 v8, s[8:11], s42 offen nt lds
  s_add_u32 m0, s41, 53248
  s_mov_b32 s42, 1441792
  buffer_load_dwordx4 v9, s[8:11], s42 offen nt lds
  s_add_u32 m0, s41, 57344
  s_mov_b32 s42, 1507328
  buffer_load_dwordx4 v8, s[8:11], s42 offen nt lds
  s_add_u32 m0, s41, 61440
  s_mov_b32 s42, 1507328
  buffer_load_dwordx4 v9, s[8:11], s42 offen nt lds
  ds_read_b64_tr_b16 a[32:33], v7 offset:0
  ds_read_b64_tr_b16 a[34:35], v7 offset:2048
  ds_read_b64_tr_b16 a[184:185], v7 offset:4096
  ds_read_b64_tr_b16 a[186:187], v7 offset:6144
  ds_read_b64_tr_b16 a[36:37], v7 offset:8192
  ds_read_b64_tr_b16 a[38:39], v7 offset:10240
  ds_read_b64_tr_b16 a[188:189], v7 offset:12288
  ds_read_b64_tr_b16 a[190:191], v7 offset:14336
  s_waitcnt vmcnt(24) lgkmcnt(0)
  s_barrier
  s_add_u32 m0, s41, 65536
  s_mov_b32 s42, 1572864
  buffer_load_dwordx4 v8, s[8:11], s42 offen nt lds
  s_add_u32 m0, s41, 69632
  s_mov_b32 s42, 1572864
  buffer_load_dwordx4 v9, s[8:11], s42 offen nt lds
  s_add_u32 m0, s41, 73728
  s_mov_b32 s42, 1638400
  buffer_load_dwordx4 v8, s[8:11], s42 offen nt lds
  s_add_u32 m0, s41, 77824
  s_mov_b32 s42, 1638400
  buffer_load_dwordx4 v9, s[8:11], s42 offen nt lds
  ds_read_b64_tr_b16 a[40:41], v7 offset:16384
  ds_read_b64_tr_b16 a[42:43], v7 offset:18432
  ds_read_b64_tr_b16 a[192:193], v7 offset:20480
  ds_read_b64_tr_b16 a[194:195], v7 offset:22528
  ds_read_b64_tr_b16 a[44:45], v7 offset:24576
  ds_read_b64_tr_b16 a[46:47], v7 offset:26624
  ds_read_b64_tr_b16 a[196:197], v7 offset:28672
  ds_read_b64_tr_b16 a[198:199], v7 offset:30720
  s_waitcnt vmcnt(24) lgkmcnt(0)
  s_barrier
  s_add_u32 m0, s41, 81920
  s_mov_b32 s42, 1703936
  buffer_load_dwordx4 v8, s[8:11], s42 offen nt lds
  s_add_u32 m0, s41, 86016
  s_mov_b32 s42, 1703936
  buffer_load_dwordx4 v9, s[8:11], s42 offen nt lds
  s_add_u32 m0, s41, 90112
  s_mov_b32 s42, 1769472
  buffer_load_dwordx4 v8, s[8:11], s42 offen nt lds
  s_add_u32 m0, s41, 94208
  s_mov_b32 s42, 1769472
  buffer_load_dwordx4 v9, s[8:11], s42 offen nt lds
  ds_read_b64_tr_b16 a[48:49], v7 offset:32768
  ds_read_b64_tr_b16 a[50:51], v7 offset:34816
  ds_read_b64_tr_b16 a[200:201], v7 offset:36864
  ds_read_b64_tr_b16 a[202:203], v7 offset:38912
  ds_read_b64_tr_b16 a[52:53], v7 offset:40960
  ds_read_b64_tr_b16 a[54:55], v7 offset:43008
  ds_read_b64_tr_b16 a[204:205], v7 offset:45056
  ds_read_b64_tr_b16 a[206:207], v7 offset:47104
  s_waitcnt vmcnt(24) lgkmcnt(0)
  s_barrier
  s_add_u32 m0, s41, 98304
  s_mov_b32 s42, 1835008
  buffer_load_dwordx4 v8, s[8:11], s42 offen nt lds
  s_add_u32 m0, s41, 102400
  s_mov_b32 s42, 1835008
  buffer_load_dwordx4 v9, s[8:11], s42 offen nt lds
  s_add_u32 m0, s41, 106496
  s_mov_b32 s42, 1900544
  buffer_load_dwordx4 v8, s[8:11], s42 offen nt lds
  s_add_u32 m0, s41, 110592
  s_mov_b32 s42, 1900544
  buffer_load_dwordx4 v9, s[8:11], s42 offen nt lds
  ds_read_b64_tr_b16 a[56:57], v7 offset:49152
  ds_read_b64_tr_b16 a[58:59], v7 offset:51200
  ds_read_b64_tr_b16 a[208:209], v7 offset:53248
  ds_read_b64_tr_b16 a[210:211], v7 offset:55296
  ds_read_b64_tr_b16 a[60:61], v7 offset:57344
  ds_read_b64_tr_b16 a[62:63], v7 offset:59392
  ds_read_b64_tr_b16 a[212:213], v7 offset:61440
  ds_read_b64_tr_b16 a[214:215], v7 offset:63488
  s_waitcnt vmcnt(24) lgkmcnt(0)
  s_barrier
  s_add_u32 m0, s41, 114688
  s_mov_b32 s42, 1966080
  buffer_load_dwordx4 v8, s[8:11], s42 offen nt lds
  s_add_u32 m0, s41, 118784
  s_mov_b32 s42, 1966080
  buffer_load_dwordx4 v9, s[8:11], s42 offen nt lds
  s_add_u32 m0, s41, 122880
  s_mov_b32 s42, 2031616
  buffer_load_dwordx4 v8, s[8:11], s42 offen nt lds
  s_add_u32 m0, s41, 126976
  s_mov_b32 s42, 2031616
  buffer_load_dwordx4 v9, s[8:11], s42 offen nt lds
  ds_read_b64_tr_b16 a[64:65], v6 offset:0
  ds_read_b64_tr_b16 a[66:67], v6 offset:2048
  ds_read_b64_tr_b16 a[216:217], v6 offset:4096
  ds_read_b64_tr_b16 a[218:219], v6 offset:6144
  ds_read_b64_tr_b16 a[68:69], v6 offset:8192
  ds_read_b64_tr_b16 a[70:71], v6 offset:10240
  ds_read_b64_tr_b16 a[220:221], v6 offset:12288
  ds_read_b64_tr_b16 a[222:223], v6 offset:14336
  s_waitcnt vmcnt(24) lgkmcnt(0)
  s_barrier
  s_add_u32 m0, s41, 0
  s_mov_b32 s42, 2097152
  buffer_load_dwordx4 v8, s[8:11], s42 offen nt lds
  s_add_u32 m0, s41, 4096
  s_mov_b32 s42, 2097152
  buffer_load_dwordx4 v9, s[8:11], s42 offen nt lds
  s_add_u32 m0, s41, 8192
  s_mov_b32 s42, 2162688
  buffer_load_dwordx4 v8, s[8:11], s42 offen nt lds
  s_add_u32 m0, s41, 12288
  s_mov_b32 s42, 2162688
  buffer_load_dwordx4 v9, s[8:11], s42 offen nt lds
  ds_read_b64_tr_b16 a[72:73], v6 offset:16384
  ds_read_b64_tr_b16 a[74:75], v6 offset:18432
  ds_read_b64_tr_b16 a[224:225], v6 offset:20480
  ds_read_b64_tr_b16 a[226:227], v6 offset:22528
  ds_read_b64_tr_b16 a[76:77], v6 offset:24576
  ds_read_b64_tr_b16 a[78:79], v6 offset:26624
  ds_read_b64_tr_b16 a[228:229], v6 offset:28672
  ds_read_b64_tr_b16 a[230:231], v6 offset:30720
  s_waitcnt vmcnt(24) lgkmcnt(0)
  s_barrier
  s_add_u32 m0, s41, 16384
  s_mov_b32 s42, 2228224
  buffer_load_dwordx4 v8, s[8:11], s42 offen nt lds
  s_add_u32 m0, s41, 20480
  s_mov_b32 s42, 2228224
  buffer_load_dwordx4 v9, s[8:11], s42 offen nt lds
  s_add_u32 m0, s41, 24576
  s_mov_b32 s42, 2293760
  buffer_load_dwordx4 v8, s[8:11], s42 offen nt lds
  s_add_u32 m0, s41, 28672
  s_mov_b32 s42, 2293760
  buffer_load_dwordx4 v9, s[8:11], s42 offen nt lds
  ds_read_b64_tr_b16 a[80:81], v6 offset:32768
  ds_read_b64_tr_b16 a[82:83], v6 offset:34816
  ds_read_b64_tr_b16 a[232:233], v6 offset:36864
  ds_read_b64_tr_b16 a[234:235], v6 offset:38912
  ds_read_b64_tr_b16 a[84:85], v6 offset:40960
  ds_read_b64_tr_b16 a[86:87], v6 offset:43008
  ds_read_b64_tr_b16 a[236:237], v6 offset:45056
  ds_read_b64_tr_b16 a[238:239], v6 offset:47104
  s_waitcnt vmcnt(24) lgkmcnt(0)
  s_barrier
  s_add_u32 m0, s41, 32768
  s_mov_b32 s42, 2359296
  buffer_load_dwordx4 v8, s[8:11], s42 offen nt lds
  s_add_u32 m0, s41, 36864
  s_mov_b32 s42, 2359296
  buffer_load_dwordx4 v9, s[8:11], s42 offen nt lds
  s_add_u32 m0, s41, 40960
  s_mov_b32 s42, 2424832
  buffer_load_dwordx4 v8, s[8:11], s42 offen nt lds
  s_add_u32 m0, s41, 45056
  s_mov_b32 s42, 2424832
  buffer_load_dwordx4 v9, s[8:11], s42 offen nt lds
  ds_read_b64_tr_b16 a[88:89], v6 offset:49152
  ds_read_b64_tr_b16 a[90:91], v6 offset:51200
  ds_read_b64_tr_b16 a[240:241], v6 offset:53248
  ds_read_b64_tr_b16 a[242:243], v6 offset:55296
  ds_read_b64_tr_b16 a[92:93], v6 offset:57344
  ds_read_b64_tr_b16 a[94:95], v6 offset:59392
  ds_read_b64_tr_b16 a[244:245], v6 offset:61440
  ds_read_b64_tr_b16 a[246:247], v6 offset:63488
  s_waitcnt vmcnt(24) lgkmcnt(0)
  s_barrier
  ds_read_b64_tr_b16 a[96:97], v7 offset:0
  ds_read_b64_tr_b16 a[98:99], v7 offset:2048
  ds_read_b64_tr_b16 a[248:249], v7 offset:4096
  ds_read_b64_tr_b16 a[250:251], v7 offset:6144
  ds_read_b64_tr_b16 a[100:101], v7 offset:8192
  ds_read_b64_tr_b16 a[102:103], v7 offset:10240
  ds_read_b64_tr_b16 a[252:253], v7 offset:12288
  ds_read_b64_tr_b16 a[254:255], v7 offset:14336
  s_waitcnt vmcnt(20) lgkmcnt(0)
  s_barrier
  ds_read_b64_tr_b16 a[104:105], v7 offset:16384
  ds_read_b64_tr_b16 a[106:107], v7 offset:18432
  ds_read_b64_tr_b16 v[128:129], v7 offset:20480
  ds_read_b64_tr_b16 v[130:131], v7 offset:22528
  ds_read_b64_tr_b16 a[108:109], v7 offset:24576
  ds_read_b64_tr_b16 a[110:111], v7 offset:26624
  ds_read_b64_tr_b16 v[132:133], v7 offset:28672
  ds_read_b64_tr_b16 v[134:135], v7 offset:30720
  s_waitcnt vmcnt(16) lgkmcnt(0)
  s_barrier
  ds_read_b64_tr_b16 a[112:113], v7 offset:32768
  ds_read_b64_tr_b16 a[114:115], v7 offset:34816
  ds_read_b64_tr_b16 v[136:137], v7 offset:36864
  ds_read_b64_tr_b16 v[138:139], v7 offset:38912
  ds_read_b64_tr_b16 a[116:117], v7 offset:40960
  ds_read_b64_tr_b16 a[118:119], v7 offset:43008
  ds_read_b64_tr_b16 v[140:141], v7 offset:45056
  ds_read_b64_tr_b16 v[142:143], v7 offset:47104
  s_waitcnt vmcnt(12) lgkmcnt(0)
  s_barrier
  ds_read_b64_tr_b16 a[120:121], v7 offset:49152
  ds_read_b64_tr_b16 a[122:123], v7 offset:51200
  ds_read_b64_tr_b16 v[144:145], v7 offset:53248
  ds_read_b64_tr_b16 v[146:147], v7 offset:55296
  ds_read_b64_tr_b16 a[124:125], v7 offset:57344
  ds_read_b64_tr_b16 a[126:127], v7 offset:59392
  ds_read_b64_tr_b16 v[148:149], v7 offset:61440
  ds_read_b64_tr_b16 v[150:151], v7 offset:63488
  s_waitcnt vmcnt(8) lgkmcnt(0)
  s_barrier
  ds_read_b64_tr_b16 a[128:129], v6 offset:0
  ds_read_b64_tr_b16 a[130:131], v6 offset:2048
  ds_read_b64_tr_b16 v[152:153], v6 offset:4096
  ds_read_b64_tr_b16 v[154:155], v6 offset:6144
  ds_read_b64_tr_b16 a[132:133], v6 offset:8192
  ds_read_b64_tr_b16 a[134:135], v6 offset:10240
  ds_read_b64_tr_b16 v[156:157], v6 offset:12288
  ds_read_b64_tr_b16 v[158:159], v6 offset:14336
  s_waitcnt vmcnt(4) lgkmcnt(0)
  s_barrier
  ds_read_b64_tr_b16 a[136:137], v6 offset:16384
  ds_read_b64_tr_b16 a[138:139], v6 offset:18432
  ds_read_b64_tr_b16 v[160:161], v6 offset:20480
  ds_read_b64_tr_b16 v[162:163], v6 offset:22528
  ds_read_b64_tr_b16 a[140:141], v6 offset:24576
  ds_read_b64_tr_b16 a[142:143], v6 offset:26624
  ds_read_b64_tr_b16 v[164:165], v6 offset:28672
  ds_read_b64_tr_b16 v[166:167], v6 offset:30720
  s_waitcnt vmcnt(0) lgkmcnt(0)
  s_barrier
  ds_read_b64_tr_b16 a[144:145], v6 offset:32768
  ds_read_b64_tr_b16 a[146:147], v6 offset:34816
  ds_read_b64_tr_b16 v[168:169], v6 offset:36864
  ds_read_b64_tr_b16 v[170:171], v6 offset:38912
  ds_read_b64_tr_b16 a[148:149], v6 offset:40960
  ds_read_b64_tr_b16 a[150:151], v6 offset:43008
  ds_read_b64_tr_b16 v[172:173], v6 offset:45056
  ds_read_b64_tr_b16 v[174:175], v6 offset:47104
  s_waitcnt lgkmcnt(0)
  s_barrier
  s_cmp_lt_u32 s21, 16
  s_cbranch_scc1 L_F2_keep
  v_accvgpr_write_b32 a0, 0
  v_accvgpr_write_b32 a1, 0
  v_accvgpr_write_b32 a2, 0
  v_accvgpr_write_b32 a3, 0
  v_accvgpr_write_b32 a4, 0
  v_accvgpr_write_b32 a5, 0
  v_accvgpr_write_b32 a6, 0
  v_accvgpr_write_b32 a7, 0
  v_accvgpr_write_b32 a152, 0
  v_accvgpr_write_b32 a153, 0
  v_accvgpr_write_b32 a154, 0
  v_accvgpr_write_b32 a155, 0
  v_accvgpr_write_b32 a156, 0
  v_accvgpr_write_b32 a157, 0
  v_accvgpr_write_b32 a158, 0
  v_accvgpr_write_b32 a159, 0
  s_nop 1
L_F2_keep:
  v_min_u32 v52, 63, v0
  v_lshlrev_b32 v52, 7, v52
  v_add_u32 v52, 1424384, v52
  s_nop 1
Lpoll_48:
  buffer_load_dword v53, v52, s[4:7], 0 offen sc1
  s_sub_u32 s24, s24, 1
  s_cbranch_scc1 L_FAIL
  s_waitcnt vmcnt(0)
  v_cmp_gt_i32 vcc, 0, v53
  s_cbranch_vccz Lpolld_49
  s_sleep 1
  s_branch Lpoll_48
Lpolld_49:
  v_lshrrev_b32 v53, 8, v53
  v_and_b32 v54, 3, v0
  v_lshl_or_b32 v53, v53, 2, v54
  s_nop 1
  v_min_u32_dpp v53, v53, v53 row_ror:8 row_mask:0xf bank_mask:0xf
  s_nop 1
  v_min_u32_dpp v53, v53, v53 row_ror:4 row_mask:0xf bank_mask:0xf
  v_mov_b32 v54, v53
  s_nop 1
  v_permlane16_swap_b32 v54, v53
  v_min_u32 v53, v53, v54
  v_mov_b32 v54, v53
  s_nop 1
  v_permlane32_swap_b32 v54, v53
  v_min_u32 v53, v53, v54
  s_nop 1
  v_min_u32_dpp v53, v53, v53 row_ror:2 row_mask:0xf bank_mask:0xf
  s_nop 1
  v_min_u32_dpp v53, v53, v53 row_ror:1 row_mask:0xf bank_mask:0xf
  s_nop 0
  v_readfirstlane_b32 s38, v53
  s_and_b32 s38, s38, 3
  s_lshl_b32 s38, s38, 13
  s_and_b32 s38, s38, 0x2000
  s_xor_b32 s38, s38, 16785408
  s_lshr_b32 s43, s21, 3
  s_mul_i32 s43, s43, 19
  s_min_u32 s43, s43, 37
  v_min_u32 v2, 18, v0
  v_add_u32 v2, s43, v2
  v_lshlrev_b32 v2, 7, v2
  v_add_u32 v2, 1414144, v2
  s_add_u32 s44, s43, s20
  s_min_u32 s45, s20, 2
  s_add_u32 s45, s45, s43
  s_lshr_b32 s40, s44, 1
  s_lshl_b32 s40, s40, 14
  s_and_b32 s41, s44, 1
  s_lshl_b32 s41, s41, 12
  s_add_u32 s27, s40, s41
  s_lshr_b32 s40, s45, 1
  s_lshl_b32 s40, s40, 14
  s_and_b32 s41, s45, 1
  s_lshl_b32 s41, s41, 12
  s_add_u32 s39, s40, s41
  s_sub_u32 s39, s39, s27
  s_add_u32 s27, s27, s38
  s_add_u32 s27, s27, 1179648
  s_lshl_b32 s62, s21, 7
  s_add_u32 s62, s62, 1421312
  s_lshl_b32 s40, s21, 14
  s_add_u32 s40, s40, s38
  s_add_u32 s31, s40, 524288
  s_lshl_b32 s40, s20, 11
  v_and_b32 v68, 3, v0
  v_lshlrev_b32 v68, 4, v68
  v_lshrrev_b32 v52, 4, v0
  v_lshl_add_u32 v68, v52, 6, v68
  v_bfe_u32 v52, v0, 2, 2
  v_lshl_add_u32 v68, v52, 8, v68
  v_add_u32 v68, s40, v68
  v_lshlrev_b32 v71, 2, v0
  v_add_u32 v71, 155648, v71
  s_mov_b32 s25, 0
  s_mov_b32 s26, 0
  s_mov_b32 s29, 1
  s_mov_b32 s30, 0
  s_mov_b32 s28, 0
L_F2_top:
  s_cmp_eq_u32 s28, 1
  s_cbranch_scc1 L_F2_go
  s_cmp_eq_u32 s28, 2
  s_cbranch_scc1 L_F2_mid
  s_cmp_lg_u32 s20, 0
  s_cbranch_scc1 L_F2_park
  buffer_load_dword v3, v2, s[4:7], s30 offen sc1
  s_waitcnt vmcnt(1)
  s_barrier
  s_mov_b32 s63, s25
  s_atomic_smax s63, s[4:5], s62 glc
Lnosig_50:
  s_cmp_ge_u32 s25, 64
  s_cbranch_scc1 L_END
  s_waitcnt vmcnt(0)
  v_cmp_gt_i32 vcc, s29, v3
  s_cbranch_vccz L_F2_issue
  s_nop 3
Lpoll_51:
  buffer_load_dword v3, v2, s[4:7], s30 offen sc1
  s_sub_u32 s24, s24, 1
  s_cbranch_scc1 L_FAIL
  s_waitcnt vmcnt(0)
  v_cmp_gt_i32 vcc, s29, v3
  s_cbranch_vccz Lpolld_52
  s_sleep 1
  s_branch Lpoll_51
Lpolld_52:
  s_branch L_F2_issue
L_F2_park:
  s_waitcnt vmcnt(0)
  s_barrier
  s_cmp_ge_u32 s25, 64
  s_cbranch_scc1 L_END
L_F2_issue:
  s_barrier
L_F2_mid:
  s_mov_b32 s34, s26
  s_mov_b32 s35, s27
  s_add_u32 s36, s32, 0
  s_add_u32 m0, s34, s36
  s_add_u32 s36, s35, 0
  buffer_load_dwordx4 v1, s[4:7], s36 offen offset:0 sc1 lds
  s_nop 0
  buffer_load_dwordx4 v1, s[4:7], s36 offen offset:1024 sc1 lds
  s_nop 0
  buffer_load_dwordx4 v1, s[4:7], s36 offen offset:2048 sc1 lds
  s_nop 0
  buffer_load_dwordx4 v1, s[4:7], s36 offen offset:3072 sc1 lds
  s_nop 0
  s_add_u32 s36, s32, 16384
  s_add_u32 m0, s34, s36
  s_add_u32 s36, s35, 32768
  buffer_load_dwordx4 v1, s[4:7], s36 offen offset:0 sc1 lds
  s_nop 0
  buffer_load_dwordx4 v1, s[4:7], s36 offen offset:1024 sc1 lds
  s_nop 0
  buffer_load_dwordx4 v1, s[4:7], s36 offen offset:2048 sc1 lds
  s_nop 0
  buffer_load_dwordx4 v1, s[4:7], s36 offen offset:3072 sc1 lds
  s_nop 0
  s_add_u32 s36, s32, 32768
  s_add_u32 m0, s34, s36
  s_add_u32 s36, s35, 65536
  buffer_load_dwordx4 v1, s[4:7], s36 offen offset:0 sc1 lds
  s_nop 0
  buffer_load_dwordx4 v1, s[4:7], s36 offen offset:1024 sc1 lds
  s_nop 0
  buffer_load_dwordx4 v1, s[4:7], s36 offen offset:2048 sc1 lds
  s_nop 0
  buffer_load_dwordx4 v1, s[4:7], s36 offen offset:3072 sc1 lds
  s_nop 0
  s_cmp_eq_u32 s28, 0
  s_cbranch_scc1 L_F2_go
  s_mov_b32 s28, 0
  s_waitcnt vmcnt(12)
  s_barrier
  s_cmp_lg_u32 s20, 0
  s_cbranch_scc1 Lnosig_53
  s_mov_b32 s63, s25
  s_atomic_smax s63, s[4:5], s62 glc
Lnosig_53:
L_F2_go:
  v_add_u32 v73, s26, v69
  v_add_u32 v74, s26, v70
  s_sub_u32 s26, 77824, s26
  s_add_u32 s27, s27, 2097152
  s_xor_b32 s27, s27, 0x2000
  s_add_u32 s29, s29, 1
  s_waitcnt vmcnt(8)
  s_barrier
  ds_read_b128 v[4:7], v73 offset:0
  ds_read_b128 v[8:11], v73 offset:1024
  ds_read_b128 v[12:15], v73 offset:2048
  ds_read_b128 v[16:19], v73 offset:3072
  ds_read_b128 v[20:23], v73 offset:4096
  ds_read_b128 v[24:27], v73 offset:5120
  s_waitcnt lgkmcnt(4)
  v_mfma_f32_16x16x32_bf16 v[36:39], a[0:3], v[4:7], 0
  ds_read_b128 v[28:31], v73 offset:6144
  v_mfma_f32_16x16x32_bf16 v[40:43], a[0:3], v[8:11], 0
  ds_read_b128 v[32:35], v73 offset:7168
  v_mfma_f32_16x16x32_bf16 v[44:47], a[152:155], v[4:7], 0
  s_add_u32 s36, s32, 49152
  s_add_u32 m0, s34, s36
  s_add_u32 s36, s35, 98304
  buffer_load_dwordx4 v1, s[4:7], s36 offen offset:0 sc1 lds
  v_mfma_f32_16x16x32_bf16 v[48:51], a[152:155], v[8:11], 0
  buffer_load_dwordx4 v1, s[4:7], s36 offen offset:1024 sc1 lds
  s_waitcnt lgkmcnt(4)
  v_mfma_f32_16x16x32_bf16 v[36:39], a[4:7], v[12:15], v[36:39]
  ds_read_b128 v[4:7], v73 offset:8192
  v_mfma_f32_16x16x32_bf16 v[40:43], a[4:7], v[16:19], v[40:43]
  ds_read_b128 v[8:11], v73 offset:9216
  v_mfma_f32_16x16x32_bf16 v[44:47], a[156:159], v[12:15], v[44:47]
  buffer_load_dwordx4 v1, s[4:7], s36 offen offset:2048 sc1 lds
  v_mfma_f32_16x16x32_bf16 v[48:51], a[156:159], v[16:19], v[48:51]
  buffer_load_dwordx4 v1, s[4:7], s36 offen offset:3072 sc1 lds
  s_waitcnt lgkmcnt(4)
  v_mfma_f32_16x16x32_bf16 v[36:39], a[8:11], v[20:23], v[36:39]
  ds_read_b128 v[12:15], v73 offset:10240
  v_mfma_f32_16x16x32_bf16 v[40:43], a[8:11], v[24:27], v[40:43]
  ds_read_b128 v[16:19], v73 offset:11264
  v_mfma_f32_16x16x32_bf16 v[44:47], a[160:163], v[20:23], v[44:47]
  s_add_u32 s36, s33, 65536
  s_add_u32 m0, s34, s36
  s_add_u32 s36, s35, 131072
  s_add_u32 s36, s36, s39
  buffer_load_dwordx4 v1, s[4:7], s36 offen offset:0 sc1 lds
  v_mfma_f32_16x16x32_bf16 v[48:51], a[160:163], v[24:27], v[48:51]
  buffer_load_dwordx4 v1, s[4:7], s36 offen offset:1024 sc1 lds
  s_waitcnt lgkmcnt(4)
  v_mfma_f32_16x16x32_bf16 v[36:39], a[12:15], v[28:31], v[36:39]
  ds_read_b128 v[20:23], v73 offset:12288
  v_mfma_f32_16x16x32_bf16 v[40:43], a[12:15], v[32:35], v[40:43]
  ds_read_b128 v[24:27], v73 offset:13312
  v_mfma_f32_16x16x32_bf16 v[44:47], a[164:167], v[28:31], v[44:47]
  buffer_load_dwordx4 v1, s[4:7], s36 offen offset:2048 sc1 lds
  v_mfma_f32_16x16x32_bf16 v[48:51], a[164:167], v[32:35], v[48:51]
  buffer_load_dwordx4 v1, s[4:7], s36 offen offset:3072 sc1 lds
  s_waitcnt lgkmcnt(4)
  v_mfma_f32_16x16x32_bf16 v[36:39], a[16:19], v[4:7], v[36:39]
  ds_read_b128 v[28:31], v73 offset:14336
  v_mfma_f32_16x16x32_bf16 v[40:43], a[16:19], v[8:11], v[40:43]
  ds_read_b128 v[32:35], v73 offset:15360
  v_mfma_f32_16x16x32_bf16 v[44:47], a[168:171], v[4:7], v[44:47]
  v_mfma_f32_16x16x32_bf16 v[48:51], a[168:171], v[8:11], v[48:51]
  s_waitcnt vmcnt(12)
  s_barrier
  s_mov_b32 s34, s26
  s_mov_b32 s35, s27
  s_waitcnt lgkmcnt(4)
  v_mfma_f32_16x16x32_bf16 v[36:39], a[20:23], v[12:15], v[36:39]
  ds_read_b128 v[4:7], v73 offset:16384
  v_mfma_f32_16x16x32_bf16 v[40:43], a[20:23], v[16:19], v[40:43]
  ds_read_b128 v[8:11], v73 offset:17408
  v_mfma_f32_16x16x32_bf16 v[44:47], a[172:175], v[12:15], v[44:47]
  v_mfma_f32_16x16x32_bf16 v[48:51], a[172:175], v[16:19], v[48:51]
  s_waitcnt lgkmcnt(4)
  v_mfma_f32_16x16x32_bf16 v[36:39], a[24:27], v[20:23], v[36:39]
  ds_read_b128 v[12:15], v73 offset:18432
  v_mfma_f32_16x16x32_bf16 v[40:43], a[24:27], v[24:27], v[40:43]
  ds_read_b128 v[16:19], v73 offset:19456
  v_mfma_f32_16x16x32_bf16 v[44:47], a[176:179], v[20:23], v[44:47]
  v_mfma_f32_16x16x32_bf16 v[48:51], a[176:179], v[24:27], v[48:51]
  s_waitcnt lgkmcnt(4)
  v_mfma_f32_16x16x32_bf16 v[36:39], a[28:31], v[28:31], v[36:39]
  ds_read_b128 v[20:23], v73 offset:20480
  v_mfma_f32_16x16x32_bf16 v[40:43], a[28:31], v[32:35], v[40:43]
  ds_read_b128 v[24:27], v73 offset:21504
  v_mfma_f32_16x16x32_bf16 v[44:47], a[180:183], v[28:31], v[44:47]
  v_mfma_f32_16x16x32_bf16 v[48:51], a[180:183], v[32:35], v[48:51]
  s_waitcnt lgkmcnt(4)
  v_mfma_f32_16x16x32_bf16 v[36:39], a[32:35], v[4:7], v[36:39]
  ds_read_b128 v[28:31], v73 offset:22528
  v_mfma_f32_16x16x32_bf16 v[40:43], a[32:35], v[8:11], v[40:43]
  ds_read_b128 v[32:35], v73 offset:23552
  v_mfma_f32_16x16x32_bf16 v[44:47], a[184:187], v[4:7], v[44:47]
  v_mfma_f32_16x16x32_bf16 v[48:51], a[184:187], v[8:11], v[48:51]
  s_waitcnt lgkmcnt(4)
  v_mfma_f32_16x16x32_bf16 v[36:39], a[36:39], v[12:15], v[36:39]
  ds_read_b128 v[4:7], v73 offset:24576
  v_mfma_f32_16x16x32_bf16 v[40:43], a[36:39], v[16:19], v[40:43]
  ds_read_b128 v[8:11], v73 offset:25600
  v_mfma_f32_16x16x32_bf16 v[44:47], a[188:191], v[12:15], v[44:47]
  v_mfma_f32_16x16x32_bf16 v[48:51], a[188:191], v[16:19], v[48:51]
  s_waitcnt lgkmcnt(4)
  v_mfma_f32_16x16x32_bf16 v[36:39], a[40:43], v[20:23], v[36:39]
  ds_read_b128 v[12:15], v73 offset:26624
  v_mfma_f32_16x16x32_bf16 v[40:43], a[40:43], v[24:27], v[40:43]
  ds_read_b128 v[16:19], v73 offset:27648
  v_mfma_f32_16x16x32_bf16 v[44:47], a[192:195], v[20:23], v[44:47]
  v_mfma_f32_16x16x32_bf16 v[48:51], a[192:195], v[24:27], v[48:51]
  s_waitcnt lgkmcnt(4)
  v_mfma_f32_16x16x32_bf16 v[36:39], a[44:47], v[28:31], v[36:39]
  ds_read_b128 v[20:23], v73 offset:28672
  v_mfma_f32_16x16x32_bf16 v[40:43], a[44:47], v[32:35], v[40:43]
  ds_read_b128 v[24:27], v73 offset:29696
  v_mfma_f32_16x16x32_bf16 v[44:47], a[196:199], v[28:31], v[44:47]
  v_mfma_f32_16x16x32_bf16 v[48:51], a[196:199], v[32:35], v[48:51]
  s_lshl_b32 s40, s20, 8
  s_add_u32 m0, s40, 155648
  s_cmp_eq_u32 s20, 0
  s_cselect_b32 s40, s30, 2147483392
  buffer_load_dword v2, s[4:7], s40 offen sc1 lds
  s_waitcnt lgkmcnt(4)
  v_mfma_f32_16x16x32_bf16 v[36:39], a[48:51], v[4:7], v[36:39]
  ds_read_b128 v[28:31], v73 offset:30720
  v_mfma_f32_16x16x32_bf16 v[40:43], a[48:51], v[8:11], v[40:43]
  ds_read_b128 v[32:35], v73 offset:31744
  v_mfma_f32_16x16x32_bf16 v[44:47], a[200:203], v[4:7], v[44:47]
  v_mfma_f32_16x16x32_bf16 v[48:51], a[200:203], v[8:11], v[48:51]
  s_waitcnt vmcnt(9)
  s_barrier
  s_lshl_b32 s40, s20, 1
  s_add_u32 s40, s40, 1
  s_cmp_lg_u32 s40, s28
  s_cbranch_scc1 L_F2_s2
  s_mov_b32 s63, s25
  s_atomic_smax s63, s[4:5], s62 glc
Lnosig_54:
L_F2_s2:
  s_waitcnt lgkmcnt(4)
  v_mfma_f32_16x16x32_bf16 v[36:39], a[52:55], v[12:15], v[36:39]
  ds_read_b128 v[4:7], v73 offset:32768
  v_mfma_f32_16x16x32_bf16 v[40:43], a[52:55], v[16:19], v[40:43]
  ds_read_b128 v[8:11], v73 offset:33792
  v_mfma_f32_16x16x32_bf16 v[44:47], a[204:207], v[12:15], v[44:47]
  v_mfma_f32_16x16x32_bf16 v[48:51], a[204:207], v[16:19], v[48:51]
  s_waitcnt lgkmcnt(4)
  v_mfma_f32_16x16x32_bf16 v[36:39], a[56:59], v[20:23], v[36:39]
  ds_read_b128 v[12:15], v73 offset:34816
  v_mfma_f32_16x16x32_bf16 v[40:43], a[56:59], v[24:27], v[40:43]
  ds_read_b128 v[16:19], v73 offset:35840
  v_mfma_f32_16x16x32_bf16 v[44:47], a[208:211], v[20:23], v[44:47]
  v_mfma_f32_16x16x32_bf16 v[48:51], a[208:211], v[24:27], v[48:51]
  s_waitcnt lgkmcnt(4)
  v_mfma_f32_16x16x32_bf16 v[36:39], a[60:63], v[28:31], v[36:39]
  ds_read_b128 v[20:23], v73 offset:36864
  v_mfma_f32_16x16x32_bf16 v[40:43], a[60:63], v[32:35], v[40:43]
  ds_read_b128 v[24:27], v73 offset:37888
  v_mfma_f32_16x16x32_bf16 v[44:47], a[212:215], v[28:31], v[44:47]
  v_mfma_f32_16x16x32_bf16 v[48:51], a[212:215], v[32:35], v[48:51]
  s_waitcnt lgkmcnt(4)
  v_mfma_f32_16x16x32_bf16 v[36:39], a[64:67], v[4:7], v[36:39]
  ds_read_b128 v[28:31], v73 offset:38912
  v_mfma_f32_16x16x32_bf16 v[40:43], a[64:67], v[8:11], v[40:43]
  ds_read_b128 v[32:35], v73 offset:39936
  v_mfma_f32_16x16x32_bf16 v[44:47], a[216:219], v[4:7], v[44:47]
  v_mfma_f32_16x16x32_bf16 v[48:51], a[216:219], v[8:11], v[48:51]
  s_waitcnt lgkmcnt(4)
  v_mfma_f32_16x16x32_bf16 v[36:39], a[68:71], v[12:15], v[36:39]
  ds_read_b128 v[4:7], v73 offset:40960
  v_mfma_f32_16x16x32_bf16 v[40:43], a[68:71], v[16:19], v[40:43]
  ds_read_b128 v[8:11], v73 offset:41984
  v_mfma_f32_16x16x32_bf16 v[44:47], a[220:223], v[12:15], v[44:47]
  v_mfma_f32_16x16x32_bf16 v[48:51], a[220:223], v[16:19], v[48:51]
  s_waitcnt lgkmcnt(4)
  v_mfma_f32_16x16x32_bf16 v[36:39], a[72:75], v[20:23], v[36:39]
  ds_read_b128 v[12:15], v73 offset:43008
  v_mfma_f32_16x16x32_bf16 v[40:43], a[72:75], v[24:27], v[40:43]
  ds_read_b128 v[16:19], v73 offset:44032
  v_mfma_f32_16x16x32_bf16 v[44:47], a[224:227], v[20:23], v[44:47]
  v_mfma_f32_16x16x32_bf16 v[48:51], a[224:227], v[24:27], v[48:51]
  s_waitcnt vmcnt(0)
  s_barrier
  ds_read_b32 v3, v71
  s_waitcnt lgkmcnt(4)
  v_mfma_f32_16x16x32_bf16 v[36:39], a[76:79], v[28:31], v[36:39]
  ds_read_b128 v[20:23], v73 offset:45056
  v_mfma_f32_16x16x32_bf16 v[40:43], a[76:79], v[32:35], v[40:43]
  ds_read_b128 v[24:27], v73 offset:46080
  v_mfma_f32_16x16x32_bf16 v[44:47], a[228:231], v[28:31], v[44:47]
  v_mfma_f32_16x16x32_bf16 v[48:51], a[228:231], v[32:35], v[48:51]
  s_waitcnt lgkmcnt(4)
  v_mfma_f32_16x16x32_bf16 v[36:39], a[80:83], v[4:7], v[36:39]
  ds_read_b128 v[28:31], v73 offset:47104
  v_mfma_f32_16x16x32_bf16 v[40:43], a[80:83], v[8:11], v[40:43]
  ds_read_b128 v[32:35], v73 offset:48128
  v_mfma_f32_16x16x32_bf16 v[44:47], a[232:235], v[4:7], v[44:47]
  v_mfma_f32_16x16x32_bf16 v[48:51], a[232:235], v[8:11], v[48:51]
  s_waitcnt lgkmcnt(4)
  v_cmp_gt_i32 vcc, s29, v3
  s_mov_b32 s28, 0
  s_cbranch_vccnz L_F2_nopf
  s_cmp_ge_u32 s25, 63
  s_cbranch_scc1 L_F2_nopf
  s_mov_b32 s28, 1
  s_waitcnt lgkmcnt(4)
  v_mfma_f32_16x16x32_bf16 v[36:39], a[84:87], v[12:15], v[36:39]
  ds_read_b128 v[4:7], v73 offset:49152
  v_mfma_f32_16x16x32_bf16 v[40:43], a[84:87], v[16:19], v[40:43]
  ds_read_b128 v[8:11], v73 offset:50176
  v_mfma_f32_16x16x32_bf16 v[44:47], a[236:239], v[12:15], v[44:47]
  s_add_u32 s36, s32, 0
  s_add_u32 m0, s34, s36
  s_add_u32 s36, s35, 0
  buffer_load_dwordx4 v1, s[4:7], s36 offen offset:0 sc1 lds
  v_mfma_f32_16x16x32_bf16 v[48:51], a[236:239], v[16:19], v[48:51]
  s_waitcnt lgkmcnt(4)
  v_mfma_f32_16x16x32_bf16 v[36:39], a[88:91], v[20:23], v[36:39]
  ds_read_b128 v[12:15], v73 offset:51200
  v_mfma_f32_16x16x32_bf16 v[40:43], a[88:91], v[24:27], v[40:43]
  ds_read_b128 v[16:19], v73 offset:52224
  v_mfma_f32_16x16x32_bf16 v[44:47], a[240:243], v[20:23], v[44:47]
  buffer_load_dwordx4 v1, s[4:7], s36 offen offset:1024 sc1 lds
  v_mfma_f32_16x16x32_bf16 v[48:51], a[240:243], v[24:27], v[48:51]
  s_waitcnt lgkmcnt(4)
  v_mfma_f32_16x16x32_bf16 v[36:39], a[92:95], v[28:31], v[36:39]
  ds_read_b128 v[20:23], v73 offset:53248
  v_mfma_f32_16x16x32_bf16 v[40:43], a[92:95], v[32:35], v[40:43]
  ds_read_b128 v[24:27], v73 offset:54272
  v_mfma_f32_16x16x32_bf16 v[44:47], a[244:247], v[28:31], v[44:47]
  buffer_load_dwordx4 v1, s[4:7], s36 offen offset:2048 sc1 lds
  v_mfma_f32_16x16x32_bf16 v[48:51], a[244:247], v[32:35], v[48:51]
  s_waitcnt lgkmcnt(4)
  v_mfma_f32_16x16x32_bf16 v[36:39], a[96:99], v[4:7], v[36:39]
  ds_read_b128 v[28:31], v73 offset:55296
  v_mfma_f32_16x16x32_bf16 v[40:43], a[96:99], v[8:11], v[40:43]
  ds_read_b128 v[32:35], v73 offset:56320
  v_mfma_f32_16x16x32_bf16 v[44:47], a[248:251], v[4:7], v[44:47]
  buffer_load_dwordx4 v1, s[4:7], s36 offen offset:3072 sc1 lds
  v_mfma_f32_16x16x32_bf16 v[48:51], a[248:251], v[8:11], v[48:51]
  s_waitcnt lgkmcnt(4)
  v_mfma_f32_16x16x32_bf16 v[36:39], a[100:103], v[12:15], v[36:39]
  ds_read_b128 v[4:7], v73 offset:57344
  v_mfma_f32_16x16x32_bf16 v[40:43], a[100:103], v[16:19], v[40:43]
  ds_read_b128 v[8:11], v73 offset:58368
  v_mfma_f32_16x16x32_bf16 v[44:47], a[252:255], v[12:15], v[44:47]
  s_add_u32 s36, s32, 16384
  s_add_u32 m0, s34, s36
  s_add_u32 s36, s35, 32768
  buffer_load_dwordx4 v1, s[4:7], s36 offen offset:0 sc1 lds
  v_mfma_f32_16x16x32_bf16 v[48:51], a[252:255], v[16:19], v[48:51]
  s_waitcnt lgkmcnt(4)
  v_mfma_f32_16x16x32_bf16 v[36:39], a[104:107], v[20:23], v[36:39]
  ds_read_b128 v[12:15], v73 offset:59392
  v_mfma_f32_16x16x32_bf16 v[40:43], a[104:107], v[24:27], v[40:43]
  ds_read_b128 v[16:19], v73 offset:60416
  v_mfma_f32_16x16x32_bf16 v[44:47], v[128:131], v[20:23], v[44:47]
  buffer_load_dwordx4 v1, s[4:7], s36 offen offset:1024 sc1 lds
  v_mfma_f32_16x16x32_bf16 v[48:51], v[128:131], v[24:27], v[48:51]
  s_waitcnt lgkmcnt(4)
  v_mfma_f32_16x16x32_bf16 v[36:39], a[108:111], v[28:31], v[36:39]
  ds_read_b128 v[20:23], v73 offset:61440
  v_mfma_f32_16x16x32_bf16 v[40:43], a[108:111], v[32:35], v[40:43]
  ds_read_b128 v[24:27], v73 offset:62464
  v_mfma_f32_16x16x32_bf16 v[44:47], v[132:135], v[28:31], v[44:47]
  buffer_load_dwordx4 v1, s[4:7], s36 offen offset:2048 sc1 lds
  v_mfma_f32_16x16x32_bf16 v[48:51], v[132:135], v[32:35], v[48:51]
  s_waitcnt lgkmcnt(4)
  v_mfma_f32_16x16x32_bf16 v[36:39], a[112:115], v[4:7], v[36:39]
  ds_read_b128 v[28:31], v73 offset:63488
  v_mfma_f32_16x16x32_bf16 v[40:43], a[112:115], v[8:11], v[40:43]
  ds_read_b128 v[32:35], v73 offset:64512
  v_mfma_f32_16x16x32_bf16 v[44:47], v[136:139], v[4:7], v[44:47]
  buffer_load_dwordx4 v1, s[4:7], s36 offen offset:3072 sc1 lds
  v_mfma_f32_16x16x32_bf16 v[48:51], v[136:139], v[8:11], v[48:51]
  s_waitcnt lgkmcnt(4)
  v_mfma_f32_16x16x32_bf16 v[36:39], a[116:119], v[12:15], v[36:39]
  ds_read_b128 v[4:7], v74 offset:0
  v_mfma_f32_16x16x32_bf16 v[40:43], a[116:119], v[16:19], v[40:43]
  ds_read_b128 v[8:11], v74 offset:1024
  v_mfma_f32_16x16x32_bf16 v[44:47], v[140:143], v[12:15], v[44:47]
  s_add_u32 s36, s32, 32768
  s_add_u32 m0, s34, s36
  s_add_u32 s36, s35, 65536
  buffer_load_dwordx4 v1, s[4:7], s36 offen offset:0 sc1 lds
  v_mfma_f32_16x16x32_bf16 v[48:51], v[140:143], v[16:19], v[48:51]
  s_waitcnt lgkmcnt(4)
  v_mfma_f32_16x16x32_bf16 v[36:39], a[120:123], v[20:23], v[36:39]
  ds_read_b128 v[12:15], v74 offset:2048
  v_mfma_f32_16x16x32_bf16 v[40:43], a[120:123], v[24:27], v[40:43]
  ds_read_b128 v[16:19], v74 offset:3072
  v_mfma_f32_16x16x32_bf16 v[44:47], v[144:147], v[20:23], v[44:47]
  buffer_load_dwordx4 v1, s[4:7], s36 offen offset:1024 sc1 lds
  v_mfma_f32_16x16x32_bf16 v[48:51], v[144:147], v[24:27], v[48:51]
  s_waitcnt lgkmcnt(4)
  v_mfma_f32_16x16x32_bf16 v[36:39], a[124:127], v[28:31], v[36:39]
  ds_read_b128 v[20:23], v74 offset:4096
  v_mfma_f32_16x16x32_bf16 v[40:43], a[124:127], v[32:35], v[40:43]
  ds_read_b128 v[24:27], v74 offset:5120
  v_mfma_f32_16x16x32_bf16 v[44:47], v[148:151], v[28:31], v[44:47]
  buffer_load_dwordx4 v1, s[4:7], s36 offen offset:2048 sc1 lds
  v_mfma_f32_16x16x32_bf16 v[48:51], v[148:151], v[32:35], v[48:51]
  s_waitcnt lgkmcnt(4)
  v_mfma_f32_16x16x32_bf16 v[36:39], a[128:131], v[4:7], v[36:39]
  ds_read_b128 v[28:31], v74 offset:6144
  v_mfma_f32_16x16x32_bf16 v[40:43], a[128:131], v[8:11], v[40:43]
  ds_read_b128 v[32:35], v74 offset:7168
  v_mfma_f32_16x16x32_bf16 v[44:47], v[152:155], v[4:7], v[44:47]
  buffer_load_dwordx4 v1, s[4:7], s36 offen offset:3072 sc1 lds
  v_mfma_f32_16x16x32_bf16 v[48:51], v[152:155], v[8:11], v[48:51]
  s_waitcnt lgkmcnt(4)
  v_mfma_f32_16x16x32_bf16 v[36:39], a[132:135], v[12:15], v[36:39]
  ds_read_b128 v[4:7], v74 offset:8192
  v_mfma_f32_16x16x32_bf16 v[40:43], a[132:135], v[16:19], v[40:43]
  ds_read_b128 v[8:11], v74 offset:9216
  v_mfma_f32_16x16x32_bf16 v[44:47], v[156:159], v[12:15], v[44:47]
  v_mfma_f32_16x16x32_bf16 v[48:51], v[156:159], v[16:19], v[48:51]
  s_waitcnt lgkmcnt(4)
  v_mfma_f32_16x16x32_bf16 v[36:39], a[136:139], v[20:23], v[36:39]
  ds_read_b128 v[12:15], v74 offset:10240
  v_mfma_f32_16x16x32_bf16 v[40:43], a[136:139], v[24:27], v[40:43]
  ds_read_b128 v[16:19], v74 offset:11264
  v_mfma_f32_16x16x32_bf16 v[44:47], v[160:163], v[20:23], v[44:47]
  v_mfma_f32_16x16x32_bf16 v[48:51], v[160:163], v[24:27], v[48:51]
  s_waitcnt lgkmcnt(4)
  v_mfma_f32_16x16x32_bf16 v[36:39], a[140:143], v[28:31], v[36:39]
  v_mfma_f32_16x16x32_bf16 v[40:43], a[140:143], v[32:35], v[40:43]
  v_mfma_f32_16x16x32_bf16 v[44:47], v[164:167], v[28:31], v[44:47]
  v_mfma_f32_16x16x32_bf16 v[48:51], v[164:167], v[32:35], v[48:51]
  s_waitcnt lgkmcnt(2)
  v_mfma_f32_16x16x32_bf16 v[36:39], a[144:147], v[4:7], v[36:39]
  v_mfma_f32_16x16x32_bf16 v[40:43], a[144:147], v[8:11], v[40:43]
  v_mfma_f32_16x16x32_bf16 v[44:47], v[168:171], v[4:7], v[44:47]
  v_mfma_f32_16x16x32_bf16 v[48:51], v[168:171], v[8:11], v[48:51]
  s_waitcnt lgkmcnt(0)
  v_mfma_f32_16x16x32_bf16 v[36:39], a[148:151], v[12:15], v[36:39]
  v_mfma_f32_16x16x32_bf16 v[40:43], a[148:151], v[16:19], v[40:43]
  v_mfma_f32_16x16x32_bf16 v[44:47], v[172:175], v[12:15], v[44:47]
  v_mfma_f32_16x16x32_bf16 v[48:51], v[172:175], v[16:19], v[48:51]
  s_nop 7
  s_branch L_F2_epi
L_F2_nopf:
  s_waitcnt lgkmcnt(4)
  v_mfma_f32_16x16x32_bf16 v[36:39], a[84:87], v[12:15], v[36:39]
  ds_read_b128 v[4:7], v73 offset:49152
  v_mfma_f32_16x16x32_bf16 v[40:43], a[84:87], v[16:19], v[40:43]
  ds_read_b128 v[8:11], v73 offset:50176
  v_mfma_f32_16x16x32_bf16 v[44:47], a[236:239], v[12:15], v[44:47]
  v_mfma_f32_16x16x32_bf16 v[48:51], a[236:239], v[16:19], v[48:51]
  s_waitcnt lgkmcnt(4)
  v_mfma_f32_16x16x32_bf16 v[36:39], a[88:91], v[20:23], v[36:39]
  ds_read_b128 v[12:15], v73 offset:51200
  v_mfma_f32_16x16x32_bf16 v[40:43], a[88:91], v[24:27], v[40:43]
  ds_read_b128 v[16:19], v73 offset:52224
  v_mfma_f32_16x16x32_bf16 v[44:47], a[240:243], v[20:23], v[44:47]
  v_mfma_f32_16x16x32_bf16 v[48:51], a[240:243], v[24:27], v[48:51]
  s_waitcnt lgkmcnt(4)
  v_mfma_f32_16x16x32_bf16 v[36:39], a[92:95], v[28:31], v[36:39]
  ds_read_b128 v[20:23], v73 offset:53248
  v_mfma_f32_16x16x32_bf16 v[40:43], a[92:95], v[32:35], v[40:43]
  ds_read_b128 v[24:27], v73 offset:54272
  v_mfma_f32_16x16x32_bf16 v[44:47], a[244:247], v[28:31], v[44:47]
  v_mfma_f32_16x16x32_bf16 v[48:51], a[244:247], v[32:35], v[48:51]
  s_waitcnt lgkmcnt(4)
  v_mfma_f32_16x16x32_bf16 v[36:39], a[96:99], v[4:7], v[36:39]
  ds_read_b128 v[28:31], v73 offset:55296
  v_mfma_f32_16x16x32_bf16 v[40:43], a[96:99], v[8:11], v[40:43]
  ds_read_b128 v[32:35], v73 offset:56320
  v_mfma_f32_16x16x32_bf16 v[44:47], a[248:251], v[4:7], v[44:47]
  v_mfma_f32_16x16x32_bf16 v[48:51], a[248:251], v[8:11], v[48:51]
  s_waitcnt lgkmcnt(4)
  v_mfma_f32_16x16x32_bf16 v[36:39], a[100:103], v[12:15], v[36:39]
  ds_read_b128 v[4:7], v73 offset:57344
  v_mfma_f32_16x16x32_bf16 v[40:43], a[100:103], v[16:19], v[40:43]
  ds_read_b128 v[8:11], v73 offset:58368
  v_mfma_f32_16x16x32_bf16 v[44:47], a[252:255], v[12:15], v[44:47]
  v_mfma_f32_16x16x32_bf16 v[48:51], a[252:255], v[16:19], v[48:51]
  s_waitcnt lgkmcnt(4)
  v_mfma_f32_16x16x32_bf16 v[36:39], a[104:107], v[20:23], v[36:39]
  ds_read_b128 v[12:15], v73 offset:59392
  v_mfma_f32_16x16x32_bf16 v[40:43], a[104:107], v[24:27], v[40:43]
  ds_read_b128 v[16:19], v73 offset:60416
  v_mfma_f32_16x16x32_bf16 v[44:47], v[128:131], v[20:23], v[44:47]
  v_mfma_f32_16x16x32_bf16 v[48:51], v[128:131], v[24:27], v[48:51]
  s_waitcnt lgkmcnt(4)
  v_mfma_f32_16x16x32_bf16 v[36:39], a[108:111], v[28:31], v[36:39]
  ds_read_b128 v[20:23], v73 offset:61440
  v_mfma_f32_16x16x32_bf16 v[40:43], a[108:111], v[32:35], v[40:43]
  ds_read_b128 v[24:27], v73 offset:62464
  v_mfma_f32_16x16x32_bf16 v[44:47], v[132:135], v[28:31], v[44:47]
  v_mfma_f32_16x16x32_bf16 v[48:51], v[132:135], v[32:35], v[48:51]
  s_waitcnt lgkmcnt(4)
  v_mfma_f32_16x16x32_bf16 v[36:39], a[112:115], v[4:7], v[36:39]
  ds_read_b128 v[28:31], v73 offset:63488
  v_mfma_f32_16x16x32_bf16 v[40:43], a[112:115], v[8:11], v[40:43]
  ds_read_b128 v[32:35], v73 offset:64512
  v_mfma_f32_16x16x32_bf16 v[44:47], v[136:139], v[4:7], v[44:47]
  v_mfma_f32_16x16x32_bf16 v[48:51], v[136:139], v[8:11], v[48:51]
  s_waitcnt lgkmcnt(4)
  v_mfma_f32_16x16x32_bf16 v[36:39], a[116:119], v[12:15], v[36:39]
  ds_read_b128 v[4:7], v74 offset:0
  v_mfma_f32_16x16x32_bf16 v[40:43], a[116:119], v[16:19], v[40:43]
  ds_read_b128 v[8:11], v74 offset:1024
  v_mfma_f32_16x16x32_bf16 v[44:47], v[140:143], v[12:15], v[44:47]
  v_mfma_f32_16x16x32_bf16 v[48:51], v[140:143], v[16:19], v[48:51]
  s_barrier
  s_lshl_b32 s40, s20, 8
  s_add_u32 m0, s40, 155648
  s_cmp_eq_u32 s20, 0
  s_cselect_b32 s40, s30, 2147483392
  buffer_load_dword v2, s[4:7], s40 offen sc1 lds
  s_waitcnt lgkmcnt(4)
  v_mfma_f32_16x16x32_bf16 v[36:39], a[120:123], v[20:23], v[36:39]
  ds_read_b128 v[12:15], v74 offset:2048
  v_mfma_f32_16x16x32_bf16 v[40:43], a[120:123], v[24:27], v[40:43]
  ds_read_b128 v[16:19], v74 offset:3072
  v_mfma_f32_16x16x32_bf16 v[44:47], v[144:147], v[20:23], v[44:47]
  v_mfma_f32_16x16x32_bf16 v[48:51], v[144:147], v[24:27], v[48:51]
  s_waitcnt lgkmcnt(4)
  v_mfma_f32_16x16x32_bf16 v[36:39], a[124:127], v[28:31], v[36:39]
  ds_read_b128 v[20:23], v74 offset:4096
  v_mfma_f32_16x16x32_bf16 v[40:43], a[124:127], v[32:35], v[40:43]
  ds_read_b128 v[24:27], v74 offset:5120
  v_mfma_f32_16x16x32_bf16 v[44:47], v[148:151], v[28:31], v[44:47]
  v_mfma_f32_16x16x32_bf16 v[48:51], v[148:151], v[32:35], v[48:51]
  s_waitcnt lgkmcnt(4)
  v_mfma_f32_16x16x32_bf16 v[36:39], a[128:131], v[4:7], v[36:39]
  ds_read_b128 v[28:31], v74 offset:6144
  v_mfma_f32_16x16x32_bf16 v[40:43], a[128:131], v[8:11], v[40:43]
  ds_read_b128 v[32:35], v74 offset:7168
  v_mfma_f32_16x16x32_bf16 v[44:47], v[152:155], v[4:7], v[44:47]
  v_mfma_f32_16x16x32_bf16 v[48:51], v[152:155], v[8:11], v[48:51]
  s_waitcnt lgkmcnt(4)
  v_mfma_f32_16x16x32_bf16 v[36:39], a[132:135], v[12:15], v[36:39]
  ds_read_b128 v[4:7], v74 offset:8192
  v_mfma_f32_16x16x32_bf16 v[40:43], a[132:135], v[16:19], v[40:43]
  ds_read_b128 v[8:11], v74 offset:9216
  v_mfma_f32_16x16x32_bf16 v[44:47], v[156:159], v[12:15], v[44:47]
  v_mfma_f32_16x16x32_bf16 v[48:51], v[156:159], v[16:19], v[48:51]
  s_waitcnt lgkmcnt(4)
  v_mfma_f32_16x16x32_bf16 v[36:39], a[136:139], v[20:23], v[36:39]
  ds_read_b128 v[12:15], v74 offset:10240
  v_mfma_f32_16x16x32_bf16 v[40:43], a[136:139], v[24:27], v[40:43]
  ds_read_b128 v[16:19], v74 offset:11264
  v_mfma_f32_16x16x32_bf16 v[44:47], v[160:163], v[20:23], v[44:47]
  v_mfma_f32_16x16x32_bf16 v[48:51], v[160:163], v[24:27], v[48:51]
  s_waitcnt lgkmcnt(4)
  v_mfma_f32_16x16x32_bf16 v[36:39], a[140:143], v[28:31], v[36:39]
  v_mfma_f32_16x16x32_bf16 v[40:43], a[140:143], v[32:35], v[40:43]
  v_mfma_f32_16x16x32_bf16 v[44:47], v[164:167], v[28:31], v[44:47]
  v_mfma_f32_16x16x32_bf16 v[48:51], v[164:167], v[32:35], v[48:51]
  s_waitcnt vmcnt(0)
  s_barrier
  ds_read_b32 v3, v71
  s_waitcnt lgkmcnt(2)
  v_mfma_f32_16x16x32_bf16 v[36:39], a[144:147], v[4:7], v[36:39]
  v_mfma_f32_16x16x32_bf16 v[40:43], a[144:147], v[8:11], v[40:43]
  v_mfma_f32_16x16x32_bf16 v[44:47], v[168:171], v[4:7], v[44:47]
  v_mfma_f32_16x16x32_bf16 v[48:51], v[168:171], v[8:11], v[48:51]
  s_waitcnt lgkmcnt(0)
  v_mfma_f32_16x16x32_bf16 v[36:39], a[148:151], v[12:15], v[36:39]
  v_mfma_f32_16x16x32_bf16 v[40:43], a[148:151], v[16:19], v[40:43]
  v_mfma_f32_16x16x32_bf16 v[44:47], v[172:175], v[12:15], v[44:47]
  v_mfma_f32_16x16x32_bf16 v[48:51], v[172:175], v[16:19], v[48:51]
  v_cmp_gt_i32 vcc, s29, v3
  s_cmp_eq_u64 vcc, 0
  s_cselect_b32 s28, 2, 0
  s_cmp_lt_u32 s25, 63
  s_cselect_b32 s28, s28, 0
L_F2_epi:
  v_cvt_pk_bf16_f32 v52, v36, v37
  v_cvt_pk_bf16_f32 v53, v38, v39
  v_cvt_pk_bf16_f32 v54, v44, v45
  v_cvt_pk_bf16_f32 v55, v46, v47
  buffer_store_dwordx4 v[52:55], v68, s[4:7], s31 offen offset:0 sc1
  v_cvt_pk_bf16_f32 v56, v40, v41
  v_cvt_pk_bf16_f32 v57, v42, v43
  v_cvt_pk_bf16_f32 v58, v48, v49
  v_cvt_pk_bf16_f32 v59, v50, v51
  buffer_store_dwordx4 v[56:59], v68, s[4:7], s31 offen offset:1024 sc1
  s_add_u32 s25, s25, 1
  s_add_u32 s31, s31, 2097152
  s_xor_b32 s31, s31, 0x2000
  s_branch L_F2_top
L_WOF:
  s_load_dwordx2 s[8:9], s[0:1], 40
  s_mov_b32 s10, 8388608
  s_mov_b32 s11, 0x20000
  s_waitcnt lgkmcnt(0)
  v_bfe_u32 v1, v0, 5, 1
  v_mul_u32_u24 v1, 131072, v1
  v_bfe_u32 v2, v0, 4, 1
  v_mul_u32_u24 v2, 8192, v2
  v_add_u32 v1, v1, v2
  v_bfe_u32 v2, v0, 3, 1
  v_mul_u32_u24 v2, 2048, v2
  v_add_u32 v1, v1, v2
  v_lshrrev_b32 v2, 3, v0
  v_and_b32 v2, 6, v2
  v_xor_b32 v2, v2, v0
  v_and_b32 v2, 7, v2
  v_lshl_add_u32 v1, v2, 4, v1
  v_bfe_u32 v2, v0, 3, 2
  v_xor_b32 v2, 0, v2
  v_lshlrev_b32 v2, 5, v2
  v_lshrrev_b32 v4, 2, v0
  v_lshl_add_u32 v4, v4, 7, v2
  v_and_b32 v2, 3, v0
  v_lshl_add_u32 v4, v2, 3, v4
  s_and_b32 s43, s21, 3
  s_lshl_b32 s43, s43, 2
  s_add_u32 s43, s43, s20
  s_lshr_b32 s44, s21, 2
  s_lshl_b32 s40, s43, 19
  s_lshl_b32 s41, s44, 7
  s_add_u32 s40, s40, s41
  v_add_u32 v1, s40, v1
  s_lshl_b32 s41, s20, 15
  v_add_u32 v4, s41, v4
  s_lshl_b32 s40, s44, 19
  s_lshl_b32 s45, s43, 14
  s_add_u32 s40, s40, s45
  v_lshl_add_u32 v3, v0, 4, s40
  v_xor_b32 v5, 32, v4
  v_xor_b32 v6, 64, v4
  v_xor_b32 v7, 96, v4
  s_add_u32 m0, s41, 0
  s_mov_b32 s42, 0
  buffer_load_dwordx4 v1, s[8:11], s42 offen nt lds
  s_add_u32 m0, s41, 1024
  s_mov_b32 s42, 16384
  buffer_load_dwordx4 v1, s[8:11], s42 offen nt lds
  s_add_u32 m0, s41, 2048
  s_mov_b32 s42, 4096
  buffer_load_dwordx4 v1, s[8:11], s42 offen nt lds
  s_add_u32 m0, s41, 3072
  s_mov_b32 s42, 20480
  buffer_load_dwordx4 v1, s[8:11], s42 offen nt lds
  s_add_u32 m0, s41, 4096
  s_mov_b32 s42, 32768
  buffer_load_dwordx4 v1, s[8:11], s42 offen nt lds
  s_add_u32 m0, s41, 5120
  s_mov_b32 s42, 49152
  buffer_load_dwordx4 v1, s[8:11], s42 offen nt lds
  s_add_u32 m0, s41, 6144
  s_mov_b32 s42, 36864
  buffer_load_dwordx4 v1, s[8:11], s42 offen nt lds
  s_add_u32 m0, s41, 7168
  s_mov_b32 s42, 53248
  buffer_load_dwordx4 v1, s[8:11], s42 offen nt lds
  s_add_u32 m0, s41, 8192
  s_mov_b32 s42, 65536
  buffer_load_dwordx4 v1, s[8:11], s42 offen nt lds
  s_add_u32 m0, s41, 9216
  s_mov_b32 s42, 81920
  buffer_load_dwordx4 v1, s[8:11], s42 offen nt lds
  s_add_u32 m0, s41, 10240
  s_mov_b32 s42, 69632
  buffer_load_dwordx4 v1, s[8:11], s42 offen nt lds
  s_add_u32 m0, s41, 11264
  s_mov_b32 s42, 86016
  buffer_load_dwordx4 v1, s[8:11], s42 offen nt lds
  s_add_u32 m0, s41, 12288
  s_mov_b32 s42, 98304
  buffer_load_dwordx4 v1, s[8:11], s42 offen nt lds
  s_add_u32 m0, s41, 13312
  s_mov_b32 s42, 114688
  buffer_load_dwordx4 v1, s[8:11], s42 offen nt lds
  s_add_u32 m0, s41, 14336
  s_mov_b32 s42, 102400
  buffer_load_dwordx4 v1, s[8:11], s42 offen nt lds
  s_add_u32 m0, s41, 15360
  s_mov_b32 s42, 118784
  buffer_load_dwordx4 v1, s[8:11], s42 offen nt lds
  s_add_u32 m0, s41, 16384
  s_mov_b32 s42, 262144
  buffer_load_dwordx4 v1, s[8:11], s42 offen nt lds
  s_add_u32 m0, s41, 17408
  s_mov_b32 s42, 278528
  buffer_load_dwordx4 v1, s[8:11], s42 offen nt lds
  s_add_u32 m0, s41, 18432
  s_mov_b32 s42, 266240
  buffer_load_dwordx4 v1, s[8:11], s42 offen nt lds
  s_add_u32 m0, s41, 19456
  s_mov_b32 s42, 282624
  buffer_load_dwordx4 v1, s[8:11], s42 offen nt lds
  s_add_u32 m0, s41, 20480
  s_mov_b32 s42, 294912
  buffer_load_dwordx4 v1, s[8:11], s42 offen nt lds
  s_add_u32 m0, s41, 21504
  s_mov_b32 s42, 311296
  buffer_load_dwordx4 v1, s[8:11], s42 offen nt lds
  s_add_u32 m0, s41, 22528
  s_mov_b32 s42, 299008
  buffer_load_dwordx4 v1, s[8:11], s42 offen nt lds
  s_add_u32 m0, s41, 23552
  s_mov_b32 s42, 315392
  buffer_load_dwordx4 v1, s[8:11], s42 offen nt lds
  s_add_u32 m0, s41, 24576
  s_mov_b32 s42, 327680
  buffer_load_dwordx4 v1, s[8:11], s42 offen nt lds
  s_add_u32 m0, s41, 25600
  s_mov_b32 s42, 344064
  buffer_load_dwordx4 v1, s[8:11], s42 offen nt lds
  s_add_u32 m0, s41, 26624
  s_mov_b32 s42, 331776
  buffer_load_dwordx4 v1, s[8:11], s42 offen nt lds
  s_add_u32 m0, s41, 27648
  s_mov_b32 s42, 348160
  buffer_load_dwordx4 v1, s[8:11], s42 offen nt lds
  s_add_u32 m0, s41, 28672
  s_mov_b32 s42, 360448
  buffer_load_dwordx4 v1, s[8:11], s42 offen nt lds
  s_add_u32 m0, s41, 29696
  s_mov_b32 s42, 376832
  buffer_load_dwordx4 v1, s[8:11], s42 offen nt lds
  s_add_u32 m0, s41, 30720
  s_mov_b32 s42, 364544
  buffer_load_dwordx4 v1, s[8:11], s42 offen nt lds
  s_add_u32 m0, s41, 31744
  s_mov_b32 s42, 380928
  buffer_load_dwordx4 v1, s[8:11], s42 offen nt lds
  s_waitcnt vmcnt(24)
  ds_read_b64_tr_b16 v[8:9], v4 offset:0
  ds_read_b64_tr_b16 v[10:11], v4 offset:2048
  ds_read_b64_tr_b16 v[12:13], v4 offset:4096
  ds_read_b64_tr_b16 v[14:15], v4 offset:6144
  ds_read_b64_tr_b16 v[16:17], v5 offset:0
  ds_read_b64_tr_b16 v[18:19], v5 offset:2048
  ds_read_b64_tr_b16 v[20:21], v5 offset:4096
  ds_read_b64_tr_b16 v[22:23], v5 offset:6144
  ds_read_b64_tr_b16 v[24:25], v6 offset:0
  ds_read_b64_tr_b16 v[26:27], v6 offset:2048
  ds_read_b64_tr_b16 v[28:29], v6 offset:4096
  ds_read_b64_tr_b16 v[30:31], v6 offset:6144
  ds_read_b64_tr_b16 v[32:33], v7 offset:0
  ds_read_b64_tr_b16 v[34:35], v7 offset:2048
  ds_read_b64_tr_b16 v[36:37], v7 offset:4096
  ds_read_b64_tr_b16 v[38:39], v7 offset:6144
  s_mov_b32 s42, 6291456
  s_waitcnt lgkmcnt(12)
  buffer_store_dwordx4 v[8:11], v3, s[4:7], s42 offen offset:0 sc1
  buffer_store_dwordx4 v[12:15], v3, s[4:7], s42 offen offset:1024 sc1
  s_mov_b32 s42, 6291456
  s_waitcnt lgkmcnt(8)
  buffer_store_dwordx4 v[16:19], v3, s[4:7], s42 offen offset:2048 sc1
  buffer_store_dwordx4 v[20:23], v3, s[4:7], s42 offen offset:3072 sc1
  s_mov_b32 s42, 6553600
  s_waitcnt lgkmcnt(4)
  buffer_store_dwordx4 v[24:27], v3, s[4:7], s42 offen offset:0 sc1
  buffer_store_dwordx4 v[28:31], v3, s[4:7], s42 offen offset:1024 sc1
  s_mov_b32 s42, 6553600
  s_waitcnt lgkmcnt(0)
  buffer_store_dwordx4 v[32:35], v3, s[4:7], s42 offen offset:2048 sc1
  buffer_store_dwordx4 v[36:39], v3, s[4:7], s42 offen offset:3072 sc1
  s_waitcnt vmcnt(24)
  ds_read_b64_tr_b16 v[40:41], v4 offset:8192
  ds_read_b64_tr_b16 v[42:43], v4 offset:10240
  ds_read_b64_tr_b16 v[44:45], v4 offset:12288
  ds_read_b64_tr_b16 v[46:47], v4 offset:14336
  ds_read_b64_tr_b16 v[48:49], v5 offset:8192
  ds_read_b64_tr_b16 v[50:51], v5 offset:10240
  ds_read_b64_tr_b16 v[52:53], v5 offset:12288
  ds_read_b64_tr_b16 v[54:55], v5 offset:14336
  ds_read_b64_tr_b16 v[56:57], v6 offset:8192
  ds_read_b64_tr_b16 v[58:59], v6 offset:10240
  ds_read_b64_tr_b16 v[60:61], v6 offset:12288
  ds_read_b64_tr_b16 v[62:63], v6 offset:14336
  ds_read_b64_tr_b16 v[64:65], v7 offset:8192
  ds_read_b64_tr_b16 v[66:67], v7 offset:10240
  ds_read_b64_tr_b16 v[68:69], v7 offset:12288
  ds_read_b64_tr_b16 v[70:71], v7 offset:14336
  s_mov_b32 s42, 6295552
  s_waitcnt lgkmcnt(12)
  buffer_store_dwordx4 v[40:43], v3, s[4:7], s42 offen offset:0 sc1
  buffer_store_dwordx4 v[44:47], v3, s[4:7], s42 offen offset:1024 sc1
  s_mov_b32 s42, 6295552
  s_waitcnt lgkmcnt(8)
  buffer_store_dwordx4 v[48:51], v3, s[4:7], s42 offen offset:2048 sc1
  buffer_store_dwordx4 v[52:55], v3, s[4:7], s42 offen offset:3072 sc1
  s_mov_b32 s42, 6557696
  s_waitcnt lgkmcnt(4)
  buffer_store_dwordx4 v[56:59], v3, s[4:7], s42 offen offset:0 sc1
  buffer_store_dwordx4 v[60:63], v3, s[4:7], s42 offen offset:1024 sc1
  s_mov_b32 s42, 6557696
  s_waitcnt lgkmcnt(0)
  buffer_store_dwordx4 v[64:67], v3, s[4:7], s42 offen offset:2048 sc1
  buffer_store_dwordx4 v[68:71], v3, s[4:7], s42 offen offset:3072 sc1
  s_waitcnt vmcnt(24)
  ds_read_b64_tr_b16 v[72:73], v4 offset:16384
  ds_read_b64_tr_b16 v[74:75], v4 offset:18432
  ds_read_b64_tr_b16 v[76:77], v4 offset:20480
  ds_read_b64_tr_b16 v[78:79], v4 offset:22528
  ds_read_b64_tr_b16 v[80:81], v5 offset:16384
  ds_read_b64_tr_b16 v[82:83], v5 offset:18432
  ds_read_b64_tr_b16 v[84:85], v5 offset:20480
  ds_read_b64_tr_b16 v[86:87], v5 offset:22528
  ds_read_b64_tr_b16 v[88:89], v6 offset:16384
  ds_read_b64_tr_b16 v[90:91], v6 offset:18432
  ds_read_b64_tr_b16 v[92:93], v6 offset:20480
  ds_read_b64_tr_b16 v[94:95], v6 offset:22528
  ds_read_b64_tr_b16 v[96:97], v7 offset:16384
  ds_read_b64_tr_b16 v[98:99], v7 offset:18432
  ds_read_b64_tr_b16 v[100:101], v7 offset:20480
  ds_read_b64_tr_b16 v[102:103], v7 offset:22528
  s_mov_b32 s42, 6299648
  s_waitcnt lgkmcnt(12)
  buffer_store_dwordx4 v[72:75], v3, s[4:7], s42 offen offset:0 sc1
  buffer_store_dwordx4 v[76:79], v3, s[4:7], s42 offen offset:1024 sc1
  s_mov_b32 s42, 6299648
  s_waitcnt lgkmcnt(8)
  buffer_store_dwordx4 v[80:83], v3, s[4:7], s42 offen offset:2048 sc1
  buffer_store_dwordx4 v[84:87], v3, s[4:7], s42 offen offset:3072 sc1
  s_mov_b32 s42, 6561792
  s_waitcnt lgkmcnt(4)
  buffer_store_dwordx4 v[88:91], v3, s[4:7], s42 offen offset:0 sc1
  buffer_store_dwordx4 v[92:95], v3, s[4:7], s42 offen offset:1024 sc1
  s_mov_b32 s42, 6561792
  s_waitcnt lgkmcnt(0)
  buffer_store_dwordx4 v[96:99], v3, s[4:7], s42 offen offset:2048 sc1
  buffer_store_dwordx4 v[100:103], v3, s[4:7], s42 offen offset:3072 sc1
  s_waitcnt vmcnt(24)
  ds_read_b64_tr_b16 v[104:105], v4 offset:24576
  ds_read_b64_tr_b16 v[106:107], v4 offset:26624
  ds_read_b64_tr_b16 v[108:109], v4 offset:28672
  ds_read_b64_tr_b16 v[110:111], v4 offset:30720
  ds_read_b64_tr_b16 v[112:113], v5 offset:24576
  ds_read_b64_tr_b16 v[114:115], v5 offset:26624
  ds_read_b64_tr_b16 v[116:117], v5 offset:28672
  ds_read_b64_tr_b16 v[118:119], v5 offset:30720
  ds_read_b64_tr_b16 v[120:121], v6 offset:24576
  ds_read_b64_tr_b16 v[122:123], v6 offset:26624
  ds_read_b64_tr_b16 v[124:125], v6 offset:28672
  ds_read_b64_tr_b16 v[126:127], v6 offset:30720
  ds_read_b64_tr_b16 v[128:129], v7 offset:24576
  ds_read_b64_tr_b16 v[130:131], v7 offset:26624
  ds_read_b64_tr_b16 v[132:133], v7 offset:28672
  ds_read_b64_tr_b16 v[134:135], v7 offset:30720
  s_mov_b32 s42, 6303744
  s_waitcnt lgkmcnt(12)
  buffer_store_dwordx4 v[104:107], v3, s[4:7], s42 offen offset:0 sc1
  buffer_store_dwordx4 v[108:111], v3, s[4:7], s42 offen offset:1024 sc1
  s_mov_b32 s42, 6303744
  s_waitcnt lgkmcnt(8)
  buffer_store_dwordx4 v[112:115], v3, s[4:7], s42 offen offset:2048 sc1
  buffer_store_dwordx4 v[116:119], v3, s[4:7], s42 offen offset:3072 sc1
  s_mov_b32 s42, 6565888
  s_waitcnt lgkmcnt(4)
  buffer_store_dwordx4 v[120:123], v3, s[4:7], s42 offen offset:0 sc1
  buffer_store_dwordx4 v[124:127], v3, s[4:7], s42 offen offset:1024 sc1
  s_mov_b32 s42, 6565888
  s_waitcnt lgkmcnt(0)
  buffer_store_dwordx4 v[128:131], v3, s[4:7], s42 offen offset:2048 sc1
  buffer_store_dwordx4 v[132:135], v3, s[4:7], s42 offen offset:3072 sc1
  v_min_u32 v1, 31, v0
  v_lshlrev_b32 v1, 2, v1
  v_add_u32 v1, 128, v1
  s_nop 1
Lpoll_55:
  buffer_load_dword v2, v1, s[12:15], 0 offen sc1
  s_sub_u32 s24, s24, 1
  s_cbranch_scc1 L_FAIL
  s_waitcnt vmcnt(0)
  v_cmp_gt_i32 vcc, 1, v2
  s_cbranch_vccz Lpolld_56
  s_sleep 2
  s_branch Lpoll_55
Lpolld_56:
  s_barrier
  s_lshl_b32 s40, s21, 7
  s_add_u32 s40, s40, 1432576
  s_cmp_lg_u32 s20, 0
  s_cbranch_scc1 Lnosig_57
  s_mov_b32 s63, 1
  s_atomic_smax s63, s[4:5], s40 glc
Lnosig_57:
  s_branch L_LN1
L_QK:
  v_bfe_u32 v76, v0, 3, 2
  v_xor_b32 v76, s20, v76
  v_lshlrev_b32 v76, 5, v76
  v_lshrrev_b32 v4, 2, v0
  v_lshl_add_u32 v4, v4, 7, v76
  v_and_b32 v76, 3, v0
  v_lshl_add_u32 v4, v76, 3, v4
  s_lshl_b32 s40, s20, 15
  v_add_u32 v4, s40, v4
  v_lshl_add_u32 v85, v0, 4, s40
  s_lshl_b32 s40, s20, 12
  s_add_u32 s40, s40, 131072
  v_lshl_add_u32 v1, v0, 4, s40
  s_lshr_b32 s54, s21, 4
  s_lshl_b32 s52, s54, 22
  s_sub_u32 s53, 0, s52
  v_xor_b32 v5, 32768, v4
  v_xor_b32 v2, 4096, v1
  v_xor_b32 v6, 65536, v4
  v_xor_b32 v3, 8192, v1
  v_xor_b32 v7, 98304, v4
  v_xor_b32 v84, 12288, v1
  v_bfe_u32 v8, v0, 5, 1
  v_mul_u32_u24 v8, 16384, v8
  v_bfe_u32 v76, v0, 4, 1
  v_mul_u32_u24 v76, 32768, v76
  v_add_u32 v8, v8, v76
  v_bfe_u32 v76, v0, 3, 1
  v_mul_u32_u24 v76, 131072, v76
  v_add_u32 v8, v8, v76
  v_lshrrev_b32 v76, 3, v0
  v_and_b32 v76, 6, v76
  v_xor_b32 v76, v76, v0
  v_and_b32 v76, 7, v76
  v_lshl_add_u32 v8, v76, 4, v8
  s_lshl_b32 s40, s20, 19
  v_add_u32 v8, s40, v8
  s_lshl_b32 s44, s21, 8
  s_add_u32 s45, s44, 128
  s_load_dwordx2 s[8:9], s[0:1], 16
  s_mov_b32 s10, 8388608
  s_mov_b32 s11, 0x20000
  s_waitcnt lgkmcnt(0)
  v_add_u32 v9, s44, v8
  v_add_u32 v10, s45, v8
  v_add_u32 v11, s44, v8
  v_add_u32 v12, s45, v8
  s_lshl_b32 s41, s20, 15
  s_add_u32 m0, s41, 0
  s_add_u32 s42, s52, 0
  buffer_load_dwordx4 v9, s[8:11], s42 offen lds
  s_add_u32 m0, s41, 1024
  s_add_u32 s42, s52, 65536
  buffer_load_dwordx4 v9, s[8:11], s42 offen lds
  s_add_u32 m0, s41, 2048
  s_add_u32 s42, s52, 8192
  buffer_load_dwordx4 v9, s[8:11], s42 offen lds
  s_add_u32 m0, s41, 3072
  s_add_u32 s42, s52, 73728
  buffer_load_dwordx4 v9, s[8:11], s42 offen lds
  s_add_u32 m0, s41, 4096
  s_add_u32 s42, s52, 262144
  buffer_load_dwordx4 v9, s[8:11], s42 offen lds
  s_add_u32 m0, s41, 5120
  s_add_u32 s42, s52, 327680
  buffer_load_dwordx4 v9, s[8:11], s42 offen lds
  s_add_u32 m0, s41, 6144
  s_add_u32 s42, s52, 270336
  buffer_load_dwordx4 v9, s[8:11], s42 offen lds
  s_add_u32 m0, s41, 7168
  s_add_u32 s42, s52, 335872
  buffer_load_dwordx4 v9, s[8:11], s42 offen lds
  s_add_u32 m0, s41, 8192
  s_add_u32 s42, s52, 2097152
  buffer_load_dwordx4 v9, s[8:11], s42 offen lds
  s_add_u32 m0, s41, 9216
  s_add_u32 s42, s52, 2162688
  buffer_load_dwordx4 v9, s[8:11], s42 offen lds
  s_add_u32 m0, s41, 10240
  s_add_u32 s42, s52, 2105344
  buffer_load_dwordx4 v9, s[8:11], s42 offen lds
  s_add_u32 m0, s41, 11264
  s_add_u32 s42, s52, 2170880
  buffer_load_dwordx4 v9, s[8:11], s42 offen lds
  s_add_u32 m0, s41, 12288
  s_add_u32 s42, s52, 2359296
  buffer_load_dwordx4 v9, s[8:11], s42 offen lds
  s_add_u32 m0, s41, 13312
  s_add_u32 s42, s52, 2424832
  buffer_load_dwordx4 v9, s[8:11], s42 offen lds
  s_add_u32 m0, s41, 14336
  s_add_u32 s42, s52, 2367488
  buffer_load_dwordx4 v9, s[8:11], s42 offen lds
  s_add_u32 m0, s41, 15360
  s_add_u32 s42, s52, 2433024
  buffer_load_dwordx4 v9, s[8:11], s42 offen lds
  s_add_u32 m0, s41, 16384
  s_add_u32 s42, s53, 4194304
  buffer_load_dwordx4 v9, s[8:11], s42 offen lds
  s_add_u32 m0, s41, 17408
  s_add_u32 s42, s53, 4259840
  buffer_load_dwordx4 v9, s[8:11], s42 offen lds
  s_add_u32 m0, s41, 18432
  s_add_u32 s42, s53, 4202496
  buffer_load_dwordx4 v9, s[8:11], s42 offen lds
  s_add_u32 m0, s41, 19456
  s_add_u32 s42, s53, 4268032
  buffer_load_dwordx4 v9, s[8:11], s42 offen lds
  s_add_u32 m0, s41, 20480
  s_add_u32 s42, s53, 4456448
  buffer_load_dwordx4 v9, s[8:11], s42 offen lds
  s_add_u32 m0, s41, 21504
  s_add_u32 s42, s53, 4521984
  buffer_load_dwordx4 v9, s[8:11], s42 offen lds
  s_add_u32 m0, s41, 22528
  s_add_u32 s42, s53, 4464640
  buffer_load_dwordx4 v9, s[8:11], s42 offen lds
  s_add_u32 m0, s41, 23552
  s_add_u32 s42, s53, 4530176
  buffer_load_dwordx4 v9, s[8:11], s42 offen lds
  s_waitcnt vmcnt(16) lgkmcnt(0)
  s_barrier
  s_add_u32 m0, s41, 24576
  s_add_u32 s42, s53, 6291456
  buffer_load_dwordx4 v9, s[8:11], s42 offen lds
  s_add_u32 m0, s41, 25600
  s_add_u32 s42, s53, 6356992
  buffer_load_dwordx4 v9, s[8:11], s42 offen lds
  s_add_u32 m0, s41, 26624
  s_add_u32 s42, s53, 6299648
  buffer_load_dwordx4 v9, s[8:11], s42 offen lds
  s_add_u32 m0, s41, 27648
  s_add_u32 s42, s53, 6365184
  buffer_load_dwordx4 v9, s[8:11], s42 offen lds
  s_add_u32 m0, s41, 28672
  s_add_u32 s42, s53, 6553600
  buffer_load_dwordx4 v9, s[8:11], s42 offen lds
  s_add_u32 m0, s41, 29696
  s_add_u32 s42, s53, 6619136
  buffer_load_dwordx4 v9, s[8:11], s42 offen lds
  s_add_u32 m0, s41, 30720
  s_add_u32 s42, s53, 6561792
  buffer_load_dwordx4 v9, s[8:11], s42 offen lds
  s_add_u32 m0, s41, 31744
  s_add_u32 s42, s53, 6627328
  buffer_load_dwordx4 v9, s[8:11], s42 offen lds
  ds_read_b64_tr_b16 a[0:1], v4 offset:0
  ds_read_b64_tr_b16 a[2:3], v4 offset:2048
  ds_read_b64_tr_b16 a[4:5], v4 offset:4096
  ds_read_b64_tr_b16 a[6:7], v4 offset:6144
  ds_read_b64_tr_b16 a[16:17], v5 offset:0
  ds_read_b64_tr_b16 a[18:19], v5 offset:2048
  ds_read_b64_tr_b16 a[20:21], v5 offset:4096
  ds_read_b64_tr_b16 a[22:23], v5 offset:6144
  ds_read_b64_tr_b16 a[32:33], v6 offset:0
  ds_read_b64_tr_b16 a[34:35], v6 offset:2048
  ds_read_b64_tr_b16 a[36:37], v6 offset:4096
  ds_read_b64_tr_b16 a[38:39], v6 offset:6144
  ds_read_b64_tr_b16 a[48:49], v7 offset:0
  ds_read_b64_tr_b16 a[50:51], v7 offset:2048
  ds_read_b64_tr_b16 a[52:53], v7 offset:4096
  ds_read_b64_tr_b16 a[54:55], v7 offset:6144
  s_waitcnt vmcnt(16) lgkmcnt(0)
  s_barrier
  s_add_u32 m0, s41, 0
  s_add_u32 s42, s52, 0
  buffer_load_dwordx4 v10, s[8:11], s42 offen lds
  s_add_u32 m0, s41, 1024
  s_add_u32 s42, s52, 65536
  buffer_load_dwordx4 v10, s[8:11], s42 offen lds
  s_add_u32 m0, s41, 2048
  s_add_u32 s42, s52, 8192
  buffer_load_dwordx4 v10, s[8:11], s42 offen lds
  s_add_u32 m0, s41, 3072
  s_add_u32 s42, s52, 73728
  buffer_load_dwordx4 v10, s[8:11], s42 offen lds
  s_add_u32 m0, s41, 4096
  s_add_u32 s42, s52, 262144
  buffer_load_dwordx4 v10, s[8:11], s42 offen lds
  s_add_u32 m0, s41, 5120
  s_add_u32 s42, s52, 327680
  buffer_load_dwordx4 v10, s[8:11], s42 offen lds
  s_add_u32 m0, s41, 6144
  s_add_u32 s42, s52, 270336
  buffer_load_dwordx4 v10, s[8:11], s42 offen lds
  s_add_u32 m0, s41, 7168
  s_add_u32 s42, s52, 335872
  buffer_load_dwordx4 v10, s[8:11], s42 offen lds
  ds_read_b64_tr_b16 a[8:9], v4 offset:8192
  ds_read_b64_tr_b16 a[10:11], v4 offset:10240
  ds_read_b64_tr_b16 a[12:13], v4 offset:12288
  ds_read_b64_tr_b16 a[14:15], v4 offset:14336
  ds_read_b64_tr_b16 a[24:25], v5 offset:8192
  ds_read_b64_tr_b16 a[26:27], v5 offset:10240
  ds_read_b64_tr_b16 a[28:29], v5 offset:12288
  ds_read_b64_tr_b16 a[30:31], v5 offset:14336
  ds_read_b64_tr_b16 a[40:41], v6 offset:8192
  ds_read_b64_tr_b16 a[42:43], v6 offset:10240
  ds_read_b64_tr_b16 a[44:45], v6 offset:12288
  ds_read_b64_tr_b16 a[46:47], v6 offset:14336
  ds_read_b64_tr_b16 a[56:57], v7 offset:8192
  ds_read_b64_tr_b16 a[58:59], v7 offset:10240
  ds_read_b64_tr_b16 a[60:61], v7 offset:12288
  ds_read_b64_tr_b16 a[62:63], v7 offset:14336
  s_waitcnt vmcnt(16) lgkmcnt(0)
  s_barrier
  s_add_u32 m0, s41, 8192
  s_add_u32 s42, s52, 2097152
  buffer_load_dwordx4 v10, s[8:11], s42 offen lds
  s_add_u32 m0, s41, 9216
  s_add_u32 s42, s52, 2162688
  buffer_load_dwordx4 v10, s[8:11], s42 offen lds
  s_add_u32 m0, s41, 10240
  s_add_u32 s42, s52, 2105344
  buffer_load_dwordx4 v10, s[8:11], s42 offen lds
  s_add_u32 m0, s41, 11264
  s_add_u32 s42, s52, 2170880
  buffer_load_dwordx4 v10, s[8:11], s42 offen lds
  s_add_u32 m0, s41, 12288
  s_add_u32 s42, s52, 2359296
  buffer_load_dwordx4 v10, s[8:11], s42 offen lds
  s_add_u32 m0, s41, 13312
  s_add_u32 s42, s52, 2424832
  buffer_load_dwordx4 v10, s[8:11], s42 offen lds
  s_add_u32 m0, s41, 14336
  s_add_u32 s42, s52, 2367488
  buffer_load_dwordx4 v10, s[8:11], s42 offen lds
  s_add_u32 m0, s41, 15360
  s_add_u32 s42, s52, 2433024
  buffer_load_dwordx4 v10, s[8:11], s42 offen lds
  ds_read_b64_tr_b16 a[64:65], v4 offset:16384
  ds_read_b64_tr_b16 a[66:67], v4 offset:18432
  ds_read_b64_tr_b16 a[68:69], v4 offset:20480
  ds_read_b64_tr_b16 a[70:71], v4 offset:22528
  ds_read_b64_tr_b16 a[80:81], v5 offset:16384
  ds_read_b64_tr_b16 a[82:83], v5 offset:18432
  ds_read_b64_tr_b16 a[84:85], v5 offset:20480
  ds_read_b64_tr_b16 a[86:87], v5 offset:22528
  ds_read_b64_tr_b16 a[96:97], v6 offset:16384
  ds_read_b64_tr_b16 a[98:99], v6 offset:18432
  ds_read_b64_tr_b16 a[100:101], v6 offset:20480
  ds_read_b64_tr_b16 a[102:103], v6 offset:22528
  ds_read_b64_tr_b16 a[112:113], v7 offset:16384
  ds_read_b64_tr_b16 a[114:115], v7 offset:18432
  ds_read_b64_tr_b16 a[116:117], v7 offset:20480
  ds_read_b64_tr_b16 a[118:119], v7 offset:22528
  s_waitcnt vmcnt(16) lgkmcnt(0)
  s_barrier
  s_add_u32 m0, s41, 16384
  s_add_u32 s42, s53, 4194304
  buffer_load_dwordx4 v10, s[8:11], s42 offen lds
  s_add_u32 m0, s41, 17408
  s_add_u32 s42, s53, 4259840
  buffer_load_dwordx4 v10, s[8:11], s42 offen lds
  s_add_u32 m0, s41, 18432
  s_add_u32 s42, s53, 4202496
  buffer_load_dwordx4 v10, s[8:11], s42 offen lds
  s_add_u32 m0, s41, 19456
  s_add_u32 s42, s53, 4268032
  buffer_load_dwordx4 v10, s[8:11], s42 offen lds
  s_add_u32 m0, s41, 20480
  s_add_u32 s42, s53, 4456448
  buffer_load_dwordx4 v10, s[8:11], s42 offen lds
  s_add_u32 m0, s41, 21504
  s_add_u32 s42, s53, 4521984
  buffer_load_dwordx4 v10, s[8:11], s42 offen lds
  s_add_u32 m0, s41, 22528
  s_add_u32 s42, s53, 4464640
  buffer_load_dwordx4 v10, s[8:11], s42 offen lds
  s_add_u32 m0, s41, 23552
  s_add_u32 s42, s53, 4530176
  buffer_load_dwordx4 v10, s[8:11], s42 offen lds
  ds_read_b64_tr_b16 a[72:73], v4 offset:24576
  ds_read_b64_tr_b16 a[74:75], v4 offset:26624
  ds_read_b64_tr_b16 a[76:77], v4 offset:28672
  ds_read_b64_tr_b16 a[78:79], v4 offset:30720
  ds_read_b64_tr_b16 a[88:89], v5 offset:24576
  ds_read_b64_tr_b16 a[90:91], v5 offset:26624
  ds_read_b64_tr_b16 a[92:93], v5 offset:28672
  ds_read_b64_tr_b16 a[94:95], v5 offset:30720
  ds_read_b64_tr_b16 a[104:105], v6 offset:24576
  ds_read_b64_tr_b16 a[106:107], v6 offset:26624
  ds_read_b64_tr_b16 a[108:109], v6 offset:28672
  ds_read_b64_tr_b16 a[110:111], v6 offset:30720
  ds_read_b64_tr_b16 a[120:121], v7 offset:24576
  ds_read_b64_tr_b16 a[122:123], v7 offset:26624
  ds_read_b64_tr_b16 a[124:125], v7 offset:28672
  ds_read_b64_tr_b16 a[126:127], v7 offset:30720
  s_waitcnt vmcnt(16) lgkmcnt(0)
  s_barrier
  s_add_u32 m0, s41, 24576
  s_add_u32 s42, s53, 6291456
  buffer_load_dwordx4 v10, s[8:11], s42 offen lds
  s_add_u32 m0, s41, 25600
  s_add_u32 s42, s53, 6356992
  buffer_load_dwordx4 v10, s[8:11], s42 offen lds
  s_add_u32 m0, s41, 26624
  s_add_u32 s42, s53, 6299648
  buffer_load_dwordx4 v10, s[8:11], s42 offen lds
  s_add_u32 m0, s41, 27648
  s_add_u32 s42, s53, 6365184
  buffer_load_dwordx4 v10, s[8:11], s42 offen lds
  s_add_u32 m0, s41, 28672
  s_add_u32 s42, s53, 6553600
  buffer_load_dwordx4 v10, s[8:11], s42 offen lds
  s_add_u32 m0, s41, 29696
  s_add_u32 s42, s53, 6619136
  buffer_load_dwordx4 v10, s[8:11], s42 offen lds
  s_add_u32 m0, s41, 30720
  s_add_u32 s42, s53, 6561792
  buffer_load_dwordx4 v10, s[8:11], s42 offen lds
  s_add_u32 m0, s41, 31744
  s_add_u32 s42, s53, 6627328
  buffer_load_dwordx4 v10, s[8:11], s42 offen lds
  ds_read_b64_tr_b16 a[128:129], v4 offset:0
  ds_read_b64_tr_b16 a[130:131], v4 offset:2048
  ds_read_b64_tr_b16 a[132:133], v4 offset:4096
  ds_read_b64_tr_b16 a[134:135], v4 offset:6144
  ds_read_b64_tr_b16 a[144:145], v5 offset:0
  ds_read_b64_tr_b16 a[146:147], v5 offset:2048
  ds_read_b64_tr_b16 a[148:149], v5 offset:4096
  ds_read_b64_tr_b16 a[150:151], v5 offset:6144
  ds_read_b64_tr_b16 a[160:161], v6 offset:0
  ds_read_b64_tr_b16 a[162:163], v6 offset:2048
  ds_read_b64_tr_b16 a[164:165], v6 offset:4096
  ds_read_b64_tr_b16 a[166:167], v6 offset:6144
  ds_read_b64_tr_b16 a[176:177], v7 offset:0
  ds_read_b64_tr_b16 a[178:179], v7 offset:2048
  ds_read_b64_tr_b16 a[180:181], v7 offset:4096
  ds_read_b64_tr_b16 a[182:183], v7 offset:6144
  s_waitcnt vmcnt(16) lgkmcnt(0)
  s_barrier
  s_load_dwordx2 s[8:9], s[0:1], 24
  s_mov_b32 s10, 8388608
  s_mov_b32 s11, 0x20000
  s_waitcnt lgkmcnt(0)
  s_add_u32 m0, s41, 0
  s_add_u32 s42, s52, 0
  buffer_load_dwordx4 v11, s[8:11], s42 offen lds
  s_add_u32 m0, s41, 1024
  s_add_u32 s42, s52, 65536
  buffer_load_dwordx4 v11, s[8:11], s42 offen lds
  s_add_u32 m0, s41, 2048
  s_add_u32 s42, s52, 8192
  buffer_load_dwordx4 v11, s[8:11], s42 offen lds
  s_add_u32 m0, s41, 3072
  s_add_u32 s42, s52, 73728
  buffer_load_dwordx4 v11, s[8:11], s42 offen lds
  s_add_u32 m0, s41, 4096
  s_add_u32 s42, s52, 262144
  buffer_load_dwordx4 v11, s[8:11], s42 offen lds
  s_add_u32 m0, s41, 5120
  s_add_u32 s42, s52, 327680
  buffer_load_dwordx4 v11, s[8:11], s42 offen lds
  s_add_u32 m0, s41, 6144
  s_add_u32 s42, s52, 270336
  buffer_load_dwordx4 v11, s[8:11], s42 offen lds
  s_add_u32 m0, s41, 7168
  s_add_u32 s42, s52, 335872
  buffer_load_dwordx4 v11, s[8:11], s42 offen lds
  ds_read_b64_tr_b16 a[136:137], v4 offset:8192
  ds_read_b64_tr_b16 a[138:139], v4 offset:10240
  ds_read_b64_tr_b16 a[140:141], v4 offset:12288
  ds_read_b64_tr_b16 a[142:143], v4 offset:14336
  ds_read_b64_tr_b16 a[152:153], v5 offset:8192
  ds_read_b64_tr_b16 a[154:155], v5 offset:10240
  ds_read_b64_tr_b16 a[156:157], v5 offset:12288
  ds_read_b64_tr_b16 a[158:159], v5 offset:14336
  ds_read_b64_tr_b16 a[168:169], v6 offset:8192
  ds_read_b64_tr_b16 a[170:171], v6 offset:10240
  ds_read_b64_tr_b16 a[172:173], v6 offset:12288
  ds_read_b64_tr_b16 a[174:175], v6 offset:14336
  ds_read_b64_tr_b16 a[184:185], v7 offset:8192
  ds_read_b64_tr_b16 a[186:187], v7 offset:10240
  ds_read_b64_tr_b16 a[188:189], v7 offset:12288
  ds_read_b64_tr_b16 a[190:191], v7 offset:14336
  s_waitcnt vmcnt(16) lgkmcnt(0)
  s_barrier
  s_add_u32 m0, s41, 8192
  s_add_u32 s42, s52, 2097152
  buffer_load_dwordx4 v11, s[8:11], s42 offen lds
  s_add_u32 m0, s41, 9216
  s_add_u32 s42, s52, 2162688
  buffer_load_dwordx4 v11, s[8:11], s42 offen lds
  s_add_u32 m0, s41, 10240
  s_add_u32 s42, s52, 2105344
  buffer_load_dwordx4 v11, s[8:11], s42 offen lds
  s_add_u32 m0, s41, 11264
  s_add_u32 s42, s52, 2170880
  buffer_load_dwordx4 v11, s[8:11], s42 offen lds
  s_add_u32 m0, s41, 12288
  s_add_u32 s42, s52, 2359296
  buffer_load_dwordx4 v11, s[8:11], s42 offen lds
  s_add_u32 m0, s41, 13312
  s_add_u32 s42, s52, 2424832
  buffer_load_dwordx4 v11, s[8:11], s42 offen lds
  s_add_u32 m0, s41, 14336
  s_add_u32 s42, s52, 2367488
  buffer_load_dwordx4 v11, s[8:11], s42 offen lds
  s_add_u32 m0, s41, 15360
  s_add_u32 s42, s52, 2433024
  buffer_load_dwordx4 v11, s[8:11], s42 offen lds
  ds_read_b64_tr_b16 a[192:193], v4 offset:16384
  ds_read_b64_tr_b16 a[194:195], v4 offset:18432
  ds_read_b64_tr_b16 a[196:197], v4 offset:20480
  ds_read_b64_tr_b16 a[198:199], v4 offset:22528
  ds_read_b64_tr_b16 a[208:209], v5 offset:16384
  ds_read_b64_tr_b16 a[210:211], v5 offset:18432
  ds_read_b64_tr_b16 a[212:213], v5 offset:20480
  ds_read_b64_tr_b16 a[214:215], v5 offset:22528
  ds_read_b64_tr_b16 a[224:225], v6 offset:16384
  ds_read_b64_tr_b16 a[226:227], v6 offset:18432
  ds_read_b64_tr_b16 a[228:229], v6 offset:20480
  ds_read_b64_tr_b16 a[230:231], v6 offset:22528
  ds_read_b64_tr_b16 a[240:241], v7 offset:16384
  ds_read_b64_tr_b16 a[242:243], v7 offset:18432
  ds_read_b64_tr_b16 a[244:245], v7 offset:20480
  ds_read_b64_tr_b16 a[246:247], v7 offset:22528
  s_waitcnt vmcnt(16) lgkmcnt(0)
  s_barrier
  s_add_u32 m0, s41, 16384
  s_add_u32 s42, s53, 4194304
  buffer_load_dwordx4 v11, s[8:11], s42 offen lds
  s_add_u32 m0, s41, 17408
  s_add_u32 s42, s53, 4259840
  buffer_load_dwordx4 v11, s[8:11], s42 offen lds
  s_add_u32 m0, s41, 18432
  s_add_u32 s42, s53, 4202496
  buffer_load_dwordx4 v11, s[8:11], s42 offen lds
  s_add_u32 m0, s41, 19456
  s_add_u32 s42, s53, 4268032
  buffer_load_dwordx4 v11, s[8:11], s42 offen lds
  s_add_u32 m0, s41, 20480
  s_add_u32 s42, s53, 4456448
  buffer_load_dwordx4 v11, s[8:11], s42 offen lds
  s_add_u32 m0, s41, 21504
  s_add_u32 s42, s53, 4521984
  buffer_load_dwordx4 v11, s[8:11], s42 offen lds
  s_add_u32 m0, s41, 22528
  s_add_u32 s42, s53, 4464640
  buffer_load_dwordx4 v11, s[8:11], s42 offen lds
  s_add_u32 m0, s41, 23552
  s_add_u32 s42, s53, 4530176
  buffer_load_dwordx4 v11, s[8:11], s42 offen lds
  ds_read_b64_tr_b16 a[200:201], v4 offset:24576
  ds_read_b64_tr_b16 a[202:203], v4 offset:26624
  ds_read_b64_tr_b16 a[204:205], v4 offset:28672
  ds_read_b64_tr_b16 a[206:207], v4 offset:30720
  ds_read_b64_tr_b16 a[216:217], v5 offset:24576
  ds_read_b64_tr_b16 a[218:219], v5 offset:26624
  ds_read_b64_tr_b16 a[220:221], v5 offset:28672
  ds_read_b64_tr_b16 a[222:223], v5 offset:30720
  ds_read_b64_tr_b16 a[232:233], v6 offset:24576
  ds_read_b64_tr_b16 a[234:235], v6 offset:26624
  ds_read_b64_tr_b16 a[236:237], v6 offset:28672
  ds_read_b64_tr_b16 a[238:239], v6 offset:30720
  ds_read_b64_tr_b16 a[248:249], v7 offset:24576
  ds_read_b64_tr_b16 a[250:251], v7 offset:26624
  ds_read_b64_tr_b16 a[252:253], v7 offset:28672
  ds_read_b64_tr_b16 a[254:255], v7 offset:30720
  s_waitcnt vmcnt(16) lgkmcnt(0)
  s_barrier
  s_add_u32 m0, s41, 24576
  s_add_u32 s42, s53, 6291456
  buffer_load_dwordx4 v11, s[8:11], s42 offen lds
  s_add_u32 m0, s41, 25600
  s_add_u32 s42, s53, 6356992
  buffer_load_dwordx4 v11, s[8:11], s42 offen lds
  s_add_u32 m0, s41, 26624
  s_add_u32 s42, s53, 6299648
  buffer_load_dwordx4 v11, s[8:11], s42 offen lds
  s_add_u32 m0, s41, 27648
  s_add_u32 s42, s53, 6365184
  buffer_load_dwordx4 v11, s[8:11], s42 offen lds
  s_add_u32 m0, s41, 28672
  s_add_u32 s42, s53, 6553600
  buffer_load_dwordx4 v11, s[8:11], s42 offen lds
  s_add_u32 m0, s41, 29696
  s_add_u32 s42, s53, 6619136
  buffer_load_dwordx4 v11, s[8:11], s42 offen lds
  s_add_u32 m0, s41, 30720
  s_add_u32 s42, s53, 6561792
  buffer_load_dwordx4 v11, s[8:11], s42 offen lds
  s_add_u32 m0, s41, 31744
  s_add_u32 s42, s53, 6627328
  buffer_load_dwordx4 v11, s[8:11], s42 offen lds
  ds_read_b64_tr_b16 v[128:129], v4 offset:0
  ds_read_b64_tr_b16 v[130:131], v4 offset:2048
  ds_read_b64_tr_b16 v[132:133], v4 offset:4096
  ds_read_b64_tr_b16 v[134:135], v4 offset:6144
  ds_read_b64_tr_b16 v[144:145], v5 offset:0
  ds_read_b64_tr_b16 v[146:147], v5 offset:2048
  ds_read_b64_tr_b16 v[148:149], v5 offset:4096
  ds_read_b64_tr_b16 v[150:151], v5 offset:6144
  ds_read_b64_tr_b16 v[160:161], v6 offset:0
  ds_read_b64_tr_b16 v[162:163], v6 offset:2048
  ds_read_b64_tr_b16 v[164:165], v6 offset:4096
  ds_read_b64_tr_b16 v[166:167], v6 offset:6144
  ds_read_b64_tr_b16 v[176:177], v7 offset:0
  ds_read_b64_tr_b16 v[178:179], v7 offset:2048
  ds_read_b64_tr_b16 v[180:181], v7 offset:4096
  ds_read_b64_tr_b16 v[182:183], v7 offset:6144
  s_waitcnt vmcnt(16) lgkmcnt(0)
  s_barrier
  s_add_u32 m0, s41, 0
  s_add_u32 s42, s52, 0
  buffer_load_dwordx4 v12, s[8:11], s42 offen lds
  s_add_u32 m0, s41, 1024
  s_add_u32 s42, s52, 65536
  buffer_load_dwordx4 v12, s[8:11], s42 offen lds
  s_add_u32 m0, s41, 2048
  s_add_u32 s42, s52, 8192
  buffer_load_dwordx4 v12, s[8:11], s42 offen lds
  s_add_u32 m0, s41, 3072
  s_add_u32 s42, s52, 73728
  buffer_load_dwordx4 v12, s[8:11], s42 offen lds
  s_add_u32 m0, s41, 4096
  s_add_u32 s42, s52, 262144
  buffer_load_dwordx4 v12, s[8:11], s42 offen lds
  s_add_u32 m0, s41, 5120
  s_add_u32 s42, s52, 327680
  buffer_load_dwordx4 v12, s[8:11], s42 offen lds
  s_add_u32 m0, s41, 6144
  s_add_u32 s42, s52, 270336
  buffer_load_dwordx4 v12, s[8:11], s42 offen lds
  s_add_u32 m0, s41, 7168
  s_add_u32 s42, s52, 335872
  buffer_load_dwordx4 v12, s[8:11], s42 offen lds
  ds_read_b64_tr_b16 v[136:137], v4 offset:8192
  ds_read_b64_tr_b16 v[138:139], v4 offset:10240
  ds_read_b64_tr_b16 v[140:141], v4 offset:12288
  ds_read_b64_tr_b16 v[142:143], v4 offset:14336
  ds_read_b64_tr_b16 v[152:153], v5 offset:8192
  ds_read_b64_tr_b16 v[154:155], v5 offset:10240
  ds_read_b64_tr_b16 v[156:157], v5 offset:12288
  ds_read_b64_tr_b16 v[158:159], v5 offset:14336
  ds_read_b64_tr_b16 v[168:169], v6 offset:8192
  ds_read_b64_tr_b16 v[170:171], v6 offset:10240
  ds_read_b64_tr_b16 v[172:173], v6 offset:12288
  ds_read_b64_tr_b16 v[174:175], v6 offset:14336
  ds_read_b64_tr_b16 v[184:185], v7 offset:8192
  ds_read_b64_tr_b16 v[186:187], v7 offset:10240
  ds_read_b64_tr_b16 v[188:189], v7 offset:12288
  ds_read_b64_tr_b16 v[190:191], v7 offset:14336
  s_cmp_lg_u32 s20, 0
  s_cbranch_scc1 Lchore_58
Lini_59:
  s_load_dwordx16 s[64:79], s[12:13], 128 glc
  s_load_dwordx16 s[80:95], s[12:13], 192 glc
  s_sub_u32 s24, s24, 1
  s_cbranch_scc1 L_FAIL
  s_waitcnt lgkmcnt(0)
  s_and_b64 s[64:65], s[64:65], s[66:67]
  s_and_b64 s[64:65], s[64:65], s[68:69]
  s_and_b64 s[64:65], s[64:65], s[70:71]
  s_and_b64 s[64:65], s[64:65], s[72:73]
  s_and_b64 s[64:65], s[64:65], s[74:75]
  s_and_b64 s[64:65], s[64:65], s[76:77]
  s_and_b64 s[64:65], s[64:65], s[78:79]
  s_and_b64 s[64:65], s[64:65], s[80:81]
  s_and_b64 s[64:65], s[64:65], s[82:83]
  s_and_b64 s[64:65], s[64:65], s[84:85]
  s_and_b64 s[64:65], s[64:65], s[86:87]
  s_and_b64 s[64:65], s[64:65], s[88:89]
  s_and_b64 s[64:65], s[64:65], s[90:91]
  s_and_b64 s[64:65], s[64:65], s[92:93]
  s_and_b64 s[64:65], s[64:65], s[94:95]
  s_and_b32 s64, s64, s65
  s_cbranch_scc0 Lini_59
  s_mov_b32 s46, 0xffff
  s_and_b32 s40, s21, 3
  s_lshl_b32 s40, s40, 13
  s_lshr_b32 s43, s21, 2
  s_lshl_b32 s43, s43, 10
  s_add_u32 s43, s43, s40
  s_add_u32 s43, s43, 1343488
  s_waitcnt lgkmcnt(0)
  s_memtime s[64:65]
  s_waitcnt lgkmcnt(0)
  s_load_dword s68, s[4:5], s43 glc
  s_waitcnt lgkmcnt(0)
  s_memtime s[66:67]
  s_waitcnt lgkmcnt(0)
  s_sub_u32 s64, s66, s64
  s_min_u32 s46, s46, s64
Lchore_58:
  s_waitcnt vmcnt(16) lgkmcnt(0)
  s_barrier
  s_add_u32 m0, s41, 8192
  s_add_u32 s42, s52, 2097152
  buffer_load_dwordx4 v12, s[8:11], s42 offen lds
  s_add_u32 m0, s41, 9216
  s_add_u32 s42, s52, 2162688
  buffer_load_dwordx4 v12, s[8:11], s42 offen lds
  s_add_u32 m0, s41, 10240
  s_add_u32 s42, s52, 2105344
  buffer_load_dwordx4 v12, s[8:11], s42 offen lds
  s_add_u32 m0, s41, 11264
  s_add_u32 s42, s52, 2170880
  buffer_load_dwordx4 v12, s[8:11], s42 offen lds
  s_add_u32 m0, s41, 12288
  s_add_u32 s42, s52, 2359296
  buffer_load_dwordx4 v12, s[8:11], s42 offen lds
  s_add_u32 m0, s41, 13312
  s_add_u32 s42, s52, 2424832
  buffer_load_dwordx4 v12, s[8:11], s42 offen lds
  s_add_u32 m0, s41, 14336
  s_add_u32 s42, s52, 2367488
  buffer_load_dwordx4 v12, s[8:11], s42 offen lds
  s_add_u32 m0, s41, 15360
  s_add_u32 s42, s52, 2433024
  buffer_load_dwordx4 v12, s[8:11], s42 offen lds
  ds_read_b64_tr_b16 v[192:193], v4 offset:16384
  ds_read_b64_tr_b16 v[194:195], v4 offset:18432
  ds_read_b64_tr_b16 v[196:197], v4 offset:20480
  ds_read_b64_tr_b16 v[198:199], v4 offset:22528
  ds_read_b64_tr_b16 v[208:209], v5 offset:16384
  ds_read_b64_tr_b16 v[210:211], v5 offset:18432
  ds_read_b64_tr_b16 v[212:213], v5 offset:20480
  ds_read_b64_tr_b16 v[214:215], v5 offset:22528
  ds_read_b64_tr_b16 v[224:225], v6 offset:16384
  ds_read_b64_tr_b16 v[226:227], v6 offset:18432
  ds_read_b64_tr_b16 v[228:229], v6 offset:20480
  ds_read_b64_tr_b16 v[230:231], v6 offset:22528
  ds_read_b64_tr_b16 v[240:241], v7 offset:16384
  ds_read_b64_tr_b16 v[242:243], v7 offset:18432
  ds_read_b64_tr_b16 v[244:245], v7 offset:20480
  ds_read_b64_tr_b16 v[246:247], v7 offset:22528
  s_cmp_lg_u32 s20, 0
  s_cbranch_scc1 Lchore_60
  s_waitcnt lgkmcnt(0)
  s_memtime s[64:65]
  s_waitcnt lgkmcnt(0)
  s_load_dword s68, s[4:5], s43 glc
  s_waitcnt lgkmcnt(0)
  s_memtime s[66:67]
  s_waitcnt lgkmcnt(0)
  s_sub_u32 s64, s66, s64
  s_min_u32 s46, s46, s64
  s_getreg_b32 s55, hwreg(HW_REG_XCC_ID)
  s_and_b32 s55, s55, 15
  s_lshl_b32 s46, s46, 8
  s_or_b32 s46, s46, s55
  s_add_u32 s40, s21, 0
  s_lshl_b32 s40, s40, 7
  s_add_u32 s40, s40, 1424384
  s_mov_b32 s63, s46
  s_atomic_smax s63, s[4:5], s40 glc
Lnosig_61:
Lchore_60:
  s_waitcnt vmcnt(16) lgkmcnt(0)
  s_barrier
  s_add_u32 m0, s41, 16384
  s_add_u32 s42, s53, 4194304
  buffer_load_dwordx4 v12, s[8:11], s42 offen lds
  s_add_u32 m0, s41, 17408
  s_add_u32 s42, s53, 4259840
  buffer_load_dwordx4 v12, s[8:11], s42 offen lds
  s_add_u32 m0, s41, 18432
  s_add_u32 s42, s53, 4202496
  buffer_load_dwordx4 v12, s[8:11], s42 offen lds
  s_add_u32 m0, s41, 19456
  s_add_u32 s42, s53, 4268032
  buffer_load_dwordx4 v12, s[8:11], s42 offen lds
  s_add_u32 m0, s41, 20480
  s_add_u32 s42, s53, 4456448
  buffer_load_dwordx4 v12, s[8:11], s42 offen lds
  s_add_u32 m0, s41, 21504
  s_add_u32 s42, s53, 4521984
  buffer_load_dwordx4 v12, s[8:11], s42 offen lds
  s_add_u32 m0, s41, 22528
  s_add_u32 s42, s53, 4464640
  buffer_load_dwordx4 v12, s[8:11], s42 offen lds
  s_add_u32 m0, s41, 23552
  s_add_u32 s42, s53, 4530176
  buffer_load_dwordx4 v12, s[8:11], s42 offen lds
  ds_read_b64_tr_b16 v[200:201], v4 offset:24576
  ds_read_b64_tr_b16 v[202:203], v4 offset:26624
  ds_read_b64_tr_b16 v[204:205], v4 offset:28672
  ds_read_b64_tr_b16 v[206:207], v4 offset:30720
  ds_read_b64_tr_b16 v[216:217], v5 offset:24576
  ds_read_b64_tr_b16 v[218:219], v5 offset:26624
  ds_read_b64_tr_b16 v[220:221], v5 offset:28672
  ds_read_b64_tr_b16 v[222:223], v5 offset:30720
  ds_read_b64_tr_b16 v[232:233], v6 offset:24576
  ds_read_b64_tr_b16 v[234:235], v6 offset:26624
  ds_read_b64_tr_b16 v[236:237], v6 offset:28672
  ds_read_b64_tr_b16 v[238:239], v6 offset:30720
  ds_read_b64_tr_b16 v[248:249], v7 offset:24576
  ds_read_b64_tr_b16 v[250:251], v7 offset:26624
  ds_read_b64_tr_b16 v[252:253], v7 offset:28672
  ds_read_b64_tr_b16 v[254:255], v7 offset:30720
  s_waitcnt vmcnt(16) lgkmcnt(0)
  s_barrier
  s_add_u32 m0, s41, 24576
  s_add_u32 s42, s53, 6291456
  buffer_load_dwordx4 v12, s[8:11], s42 offen lds
  s_add_u32 m0, s41, 25600
  s_add_u32 s42, s53, 6356992
  buffer_load_dwordx4 v12, s[8:11], s42 offen lds
  s_add_u32 m0, s41, 26624
  s_add_u32 s42, s53, 6299648
  buffer_load_dwordx4 v12, s[8:11], s42 offen lds
  s_add_u32 m0, s41, 27648
  s_add_u32 s42, s53, 6365184
  buffer_load_dwordx4 v12, s[8:11], s42 offen lds
  s_add_u32 m0, s41, 28672
  s_add_u32 s42, s53, 6553600
  buffer_load_dwordx4 v12, s[8:11], s42 offen lds
  s_add_u32 m0, s41, 29696
  s_add_u32 s42, s53, 6619136
  buffer_load_dwordx4 v12, s[8:11], s42 offen lds
  s_add_u32 m0, s41, 30720
  s_add_u32 s42, s53, 6561792
  buffer_load_dwordx4 v12, s[8:11], s42 offen lds
  s_add_u32 m0, s41, 31744
  s_add_u32 s42, s53, 6627328
  buffer_load_dwordx4 v12, s[8:11], s42 offen lds
  ds_read_b64_tr_b16 v[20:21], v4 offset:0
  ds_read_b64_tr_b16 v[22:23], v4 offset:2048
  ds_read_b64_tr_b16 v[24:25], v4 offset:4096
  ds_read_b64_tr_b16 v[26:27], v4 offset:6144
  ds_read_b64_tr_b16 v[28:29], v5 offset:0
  ds_read_b64_tr_b16 v[30:31], v5 offset:2048
  ds_read_b64_tr_b16 v[32:33], v5 offset:4096
  ds_read_b64_tr_b16 v[34:35], v5 offset:6144
  ds_read_b64_tr_b16 v[36:37], v6 offset:0
  ds_read_b64_tr_b16 v[38:39], v6 offset:2048
  ds_read_b64_tr_b16 v[40:41], v6 offset:4096
  ds_read_b64_tr_b16 v[42:43], v6 offset:6144
  ds_read_b64_tr_b16 v[44:45], v7 offset:0
  ds_read_b64_tr_b16 v[46:47], v7 offset:2048
  ds_read_b64_tr_b16 v[48:49], v7 offset:4096
  ds_read_b64_tr_b16 v[50:51], v7 offset:6144
  s_waitcnt lgkmcnt(0)
  s_barrier
  ds_write_b128 v85, v[20:23] offset:0
  ds_write_b128 v85, v[24:27] offset:1024
  ds_write_b128 v85, v[28:31] offset:2048
  ds_write_b128 v85, v[32:35] offset:3072
  ds_write_b128 v85, v[36:39] offset:4096
  ds_write_b128 v85, v[40:43] offset:5120
  ds_write_b128 v85, v[44:47] offset:6144
  ds_write_b128 v85, v[48:51] offset:7168
  s_waitcnt vmcnt(16) lgkmcnt(0)
  s_barrier
  ds_read_b64_tr_b16 v[20:21], v4 offset:8192
  ds_read_b64_tr_b16 v[22:23], v4 offset:10240
  ds_read_b64_tr_b16 v[24:25], v4 offset:12288
  ds_read_b64_tr_b16 v[26:27], v4 offset:14336
  ds_read_b64_tr_b16 v[28:29], v5 offset:8192
  ds_read_b64_tr_b16 v[30:31], v5 offset:10240
  ds_read_b64_tr_b16 v[32:33], v5 offset:12288
  ds_read_b64_tr_b16 v[34:35], v5 offset:14336
  ds_read_b64_tr_b16 v[36:37], v6 offset:8192
  ds_read_b64_tr_b16 v[38:39], v6 offset:10240
  ds_read_b64_tr_b16 v[40:41], v6 offset:12288
  ds_read_b64_tr_b16 v[42:43], v6 offset:14336
  ds_read_b64_tr_b16 v[44:45], v7 offset:8192
  ds_read_b64_tr_b16 v[46:47], v7 offset:10240
  ds_read_b64_tr_b16 v[48:49], v7 offset:12288
  ds_read_b64_tr_b16 v[50:51], v7 offset:14336
  s_waitcnt lgkmcnt(0)
  s_barrier
  ds_write_b128 v85, v[20:23] offset:8192
  ds_write_b128 v85, v[24:27] offset:9216
  ds_write_b128 v85, v[28:31] offset:10240
  ds_write_b128 v85, v[32:35] offset:11264
  ds_write_b128 v85, v[36:39] offset:12288
  ds_write_b128 v85, v[40:43] offset:13312
  ds_write_b128 v85, v[44:47] offset:14336
  ds_write_b128 v85, v[48:51] offset:15360
  s_waitcnt vmcnt(8) lgkmcnt(0)
  s_barrier
  ds_read_b64_tr_b16 v[20:21], v4 offset:16384
  ds_read_b64_tr_b16 v[22:23], v4 offset:18432
  ds_read_b64_tr_b16 v[24:25], v4 offset:20480
  ds_read_b64_tr_b16 v[26:27], v4 offset:22528
  ds_read_b64_tr_b16 v[28:29], v5 offset:16384
  ds_read_b64_tr_b16 v[30:31], v5 offset:18432
  ds_read_b64_tr_b16 v[32:33], v5 offset:20480
  ds_read_b64_tr_b16 v[34:35], v5 offset:22528
  ds_read_b64_tr_b16 v[36:37], v6 offset:16384
  ds_read_b64_tr_b16 v[38:39], v6 offset:18432
  ds_read_b64_tr_b16 v[40:41], v6 offset:20480
  ds_read_b64_tr_b16 v[42:43], v6 offset:22528
  ds_read_b64_tr_b16 v[44:45], v7 offset:16384
  ds_read_b64_tr_b16 v[46:47], v7 offset:18432
  ds_read_b64_tr_b16 v[48:49], v7 offset:20480
  ds_read_b64_tr_b16 v[50:51], v7 offset:22528
  s_waitcnt lgkmcnt(0)
  s_barrier
  ds_write_b128 v85, v[20:23] offset:16384
  ds_write_b128 v85, v[24:27] offset:17408
  ds_write_b128 v85, v[28:31] offset:18432
  ds_write_b128 v85, v[32:35] offset:19456
  ds_write_b128 v85, v[36:39] offset:20480
  ds_write_b128 v85, v[40:43] offset:21504
  ds_write_b128 v85, v[44:47] offset:22528
  ds_write_b128 v85, v[48:51] offset:23552
  s_waitcnt vmcnt(0) lgkmcnt(0)
  s_barrier
  ds_read_b64_tr_b16 v[20:21], v4 offset:24576
  ds_read_b64_tr_b16 v[22:23], v4 offset:26624
  ds_read_b64_tr_b16 v[24:25], v4 offset:28672
  ds_read_b64_tr_b16 v[26:27], v4 offset:30720
  ds_read_b64_tr_b16 v[28:29], v5 offset:24576
  ds_read_b64_tr_b16 v[30:31], v5 offset:26624
  ds_read_b64_tr_b16 v[32:33], v5 offset:28672
  ds_read_b64_tr_b16 v[34:35], v5 offset:30720
  ds_read_b64_tr_b16 v[36:37], v6 offset:24576
  ds_read_b64_tr_b16 v[38:39], v6 offset:26624
  ds_read_b64_tr_b16 v[40:41], v6 offset:28672
  ds_read_b64_tr_b16 v[42:43], v6 offset:30720
  ds_read_b64_tr_b16 v[44:45], v7 offset:24576
  ds_read_b64_tr_b16 v[46:47], v7 offset:26624
  ds_read_b64_tr_b16 v[48:49], v7 offset:28672
  ds_read_b64_tr_b16 v[50:51], v7 offset:30720
  s_waitcnt lgkmcnt(0)
  s_barrier
  ds_write_b128 v85, v[20:23] offset:24576
  ds_write_b128 v85, v[24:27] offset:25600
  ds_write_b128 v85, v[28:31] offset:26624
  ds_write_b128 v85, v[32:35] offset:27648
  ds_write_b128 v85, v[36:39] offset:28672
  ds_write_b128 v85, v[40:43] offset:29696
  ds_write_b128 v85, v[44:47] offset:30720
  ds_write_b128 v85, v[48:51] offset:31744
  s_waitcnt lgkmcnt(0)
  s_getreg_b32 s55, hwreg(HW_REG_XCC_ID)
  s_and_b32 s55, s55, 15
  v_min_u32 v76, 63, v0
  v_lshlrev_b32 v76, 7, v76
  v_add_u32 v76, 1424384, v76
  s_nop 1
Lpoll_62:
  buffer_load_dword v77, v76, s[4:7], 0 offen sc1
  s_sub_u32 s24, s24, 1
  s_cbranch_scc1 L_FAIL
  s_waitcnt vmcnt(0)
  v_cmp_gt_i32 vcc, 0, v77
  s_cbranch_vccz Lpolld_63
  s_sleep 1
  s_branch Lpoll_62
Lpolld_63:
  v_and_b32 v78, 15, v77
  v_cmp_ne_u32 vcc, s55, v78
  s_lshl_b32 s40, s54, 4
  s_lshl_b32 s40, 0xffff, s40
  s_or_b32 s41, vcc_lo, vcc_hi
  s_and_b32 s40, s40, s41
  s_cselect_b32 s36, 0, 8192
  v_lshrrev_b32 v77, 8, v77
  v_and_b32 v78, 3, v0
  v_lshl_or_b32 v77, v77, 2, v78
  s_nop 1
  v_min_u32_dpp v77, v77, v77 row_ror:8 row_mask:0xf bank_mask:0xf
  s_nop 1
  v_min_u32_dpp v77, v77, v77 row_ror:4 row_mask:0xf bank_mask:0xf
  v_mov_b32 v78, v77
  s_nop 1
  v_permlane16_swap_b32 v78, v77
  v_min_u32 v77, v77, v78
  v_mov_b32 v78, v77
  s_nop 1
  v_permlane32_swap_b32 v78, v77
  v_min_u32 v77, v77, v78
  s_nop 1
  v_min_u32_dpp v77, v77, v77 row_ror:2 row_mask:0xf bank_mask:0xf
  s_nop 1
  v_min_u32_dpp v77, v77, v77 row_ror:1 row_mask:0xf bank_mask:0xf
  s_nop 0
  v_readfirstlane_b32 s26, v77
  s_and_b32 s26, s26, 3
  s_lshl_b32 s26, s26, 13
  s_lshr_b32 s40, s20, 1
  s_mul_i32 s40, s40, 32768
  s_and_b32 s41, s20, 1
  s_lshl_b32 s41, s41, 10
  s_add_u32 s40, s40, s41
  s_lshl_b32 s41, s54, 12
  s_add_u32 s40, s40, s41
  v_lshl_add_u32 v86, v0, 4, s40
  v_xor_b32 v87, 0x1000, v86
  v_and_b32 v76, 2, v0
  v_cmp_eq_u32 vcc, 0, v76
  v_mov_b32 v76, 0xeeee
  v_mov_b32 v77, 0x4444
  v_cndmask_b32 v88, v76, v77, vcc
  s_lshr_b32 s40, s21, 2
  s_mul_i32 s40, s40, 32768
  s_and_b32 s41, s21, 3
  s_lshl_b32 s41, s41, 11
  s_add_u32 s47, s40, s41
  s_lshl_b32 s41, s20, 9
  s_add_u32 s47, s47, s41
  v_lshl_add_u32 v92, v0, 3, s47
  s_lshl_b32 s41, s54, 12
  s_add_u32 s40, s41, 1310720
  s_add_u32 s40, s40, s26
  v_lshrrev_b32 v76, 2, v0
  v_lshl_add_u32 v76, v76, 7, s40
  v_and_b32 v77, 3, v0
  v_lshl_add_u32 v90, v77, 2, v76
  s_mov_b32 s57, s40
  s_cmp_eq_u32 s36, 0
  s_cselect_b32 s56, 1, s20
  s_and_b32 s41, s21, 15
  s_lshl_b32 s41, s41, 7
  s_lshl_b32 s40, s20, 2
  s_add_u32 s40, s40, s41
  s_add_u32 s40, s40, 2048
  s_mov_b32 s25, 0
  s_mov_b32 s60, 0
  s_mov_b32 s61, 0
  s_mov_b32 s51, -1
  v_mov_b32 v91, 2147483392
  s_mov_b64 exec, 1
  v_mov_b32 v91, s40
  s_mov_b64 exec, -1
  v_mov_b32 v80, -1
  v_mov_b32 v81, -1
  v_mov_b32 v82, -1
  v_mov_b32 v83, -1
  v_mov_b32 v112, 0
  v_mov_b32 v113, 0
  v_mov_b32 v114, 0
  v_mov_b32 v115, 0
  v_mov_b32 v116, 0
  v_mov_b32 v117, 0
  v_mov_b32 v118, 0
  v_mov_b32 v119, 0
  v_mov_b32 v120, 0
  v_mov_b32 v121, 0
  v_mov_b32 v108, 0x3f803f80
  v_mov_b32 v109, 0x3f803f80
  v_mov_b32 v110, 0x3f803f80
  v_mov_b32 v111, 0x3f803f80
  v_lshlrev_b32 v95, 4, v0
  s_lshl_b32 s58, s20, 12
  s_add_u32 s40, s58, 149504
  s_add_u32 s58, s58, 131072
  v_lshrrev_b32 v76, 4, v0
  v_bfe_u32 v77, v0, 1, 2
  v_xor_b32 v76, v76, v77
  v_lshl_add_u32 v76, v76, 4, s40
  v_and_b32 v77, 15, v0
  v_lshl_add_u32 v123, v77, 6, v76
  v_bfe_u32 v76, v0, 3, 2
  v_xor_b32 v76, v76, v0
  v_lshl_add_u32 v124, v76, 4, s40
  v_bfe_u32 v76, v0, 4, 1
  v_lshlrev_b32 v76, 1, v76
  v_and_b32 v77, 13, v0
  v_or_b32 v76, v76, v77
  v_lshl_add_u32 v122, v76, 4, s47
  v_lshrrev_b32 v76, 5, v0
  v_lshl_add_u32 v122, v76, 8, v122
  v_and_b32 v76, 2, v0
  v_cmp_eq_u32 vcc, 0, v76
  v_mov_b32 v77, 2147483392
  s_nop 0
  v_cndmask_b32 v122, v122, v77, vcc
  s_lshl_b32 s43, s21, 2
  s_add_u32 s43, s43, s20
  s_and_b32 s46, s20, 1
  s_lshl_b32 s46, s46, 10
  s_mul_i32 s32, s21, 65536
  s_lshl_b32 s40, s20, 11
  s_add_u32 s32, s32, s40
  s_and_b32 s40, s26, 0x2000
  s_xor_b32 s40, s40, 16777216
  s_add_u32 s32, s32, s40
  s_add_u32 s30, s32, s46
  s_add_u32 s30, s30, 49152
  s_lshl_b32 s59, s21, 7
  s_add_u32 s59, s59, 1396736
  s_lshl_b32 s62, s21, 7
  s_add_u32 s62, s62, 1404928
  s_mov_b32 s38, 0x3e0293ee
  s_mov_b32 s39, s38
  v_xor_b32 v125, 4096, v124
  v_xor_b32 v126, 8192, v124
  v_xor_b32 v127, 12288, v124
  v_readfirstlane_b32 s88, v86
  s_xor_b32 s41, s47, 131072
  v_min_u32 v76, 3, v0
  v_lshl_add_u32 v87, v76, 7, s41
  v_lshrrev_b32 v76, 4, v0
  v_lshlrev_b32 v76, 2, v76
  v_and_b32 v77, 15, v0
  v_sub_u32 v76, v77, v76
  s_lshr_b32 s41, s46, 6
  v_add_u32 v76, s41, v76
  v_and_b32 v92, 0xfffffdff, v92
  v_mov_b32 v86, 0xd028965f
  v_cmp_le_i32 s[8:9], 0, v76
  v_cmp_le_i32 s[10:11], 1, v76
  v_cmp_le_i32 s[16:17], 2, v76
  v_cmp_le_i32 s[18:19], 3, v76
  v_cmp_le_i32 s[42:43], 16, v76
  v_cmp_le_i32 s[44:45], 17, v76
  v_cmp_le_i32 s[52:53], 18, v76
  v_cmp_le_i32 s[54:55], 19, v76
  s_xor_b32 s89, s88, 1024
  s_xor_b32 s90, s88, 32768
  s_xor_b32 s91, s88, 33792
  v_lshrrev_b32 v76, 4, v0
  v_lshl_add_u32 v76, v76, 7, s57
  v_and_b32 v77, 15, v0
  v_lshl_add_u32 v90, v77, 2, v76
  s_mov_b32 s25, 0
  s_and_b32 s40, s25, 3
  s_lshl_b32 s40, s40, 16
  s_add_u32 s27, s40, s26
  s_add_u32 s27, s27, 1048576
  s_xor_b32 s37, s27, s36
  s_lshl_b32 s40, s40, 2
  s_add_u32 s28, s40, s26
  s_lshr_b32 s40, s40, 5
  s_and_b32 s40, s40, 0x4000
  s_xor_b32 s28, s28, s40
  s_xor_b32 s29, s28, 0x4000
  s_xor_b32 s40, s28, 8192
  buffer_load_dword v89, v122, s[4:7], s40 offen sc1
  s_mov_b32 s25, 1
  s_and_b32 s40, s25, 3
  s_lshl_b32 s40, s40, 16
  s_add_u32 s27, s40, s26
  s_add_u32 s27, s27, 1048576
  s_xor_b32 s37, s27, s36
  s_lshl_b32 s40, s40, 2
  s_add_u32 s28, s40, s26
  s_lshr_b32 s40, s40, 5
  s_and_b32 s40, s40, 0x4000
  s_xor_b32 s28, s28, s40
  s_xor_b32 s29, s28, 0x4000
  s_xor_b32 s40, s28, 8192
  buffer_load_dword v89, v122, s[4:7], s40 offen sc1
  s_mov_b32 s25, 2
  s_and_b32 s40, s25, 3
  s_lshl_b32 s40, s40, 16
  s_add_u32 s27, s40, s26
  s_add_u32 s27, s27, 1048576
  s_xor_b32 s37, s27, s36
  s_lshl_b32 s40, s40, 2
  s_add_u32 s28, s40, s26
  s_lshr_b32 s40, s40, 5
  s_and_b32 s40, s40, 0x4000
  s_xor_b32 s28, s28, s40
  s_xor_b32 s29, s28, 0x4000
  s_xor_b32 s40, s28, 8192
  buffer_load_dword v89, v122, s[4:7], s40 offen sc1
  s_mov_b32 s25, 3
  s_and_b32 s40, s25, 3
  s_lshl_b32 s40, s40, 16
  s_add_u32 s27, s40, s26
  s_add_u32 s27, s27, 1048576
  s_xor_b32 s37, s27, s36
  s_lshl_b32 s40, s40, 2
  s_add_u32 s28, s40, s26
  s_lshr_b32 s40, s40, 5
  s_and_b32 s40, s40, 0x4000
  s_xor_b32 s28, s28, s40
  s_xor_b32 s29, s28, 0x4000
  s_xor_b32 s40, s28, 8192
  buffer_load_dword v89, v122, s[4:7], s40 offen sc1
  buffer_load_dword v89, v90, s[4:7], 0 offen offset:0 sc1
  s_mov_b32 s25, 0
  s_mov_b32 s33, 1
  s_mov_b64 s[100:101], 0
  s_cmp_lg_u32 s20, 1
  s_cbranch_scc1 Lskip_66
Lask_64:
  s_min_i32 s47, s100, s101
  s_cmp_ge_i32 s47, s33
  s_cbranch_scc1 Lhave_65
  s_load_dwordx2 s[100:101], s[4:5], s59 glc
  s_sub_u32 s24, s24, 1
  s_cbranch_scc1 L_FAIL
  s_waitcnt lgkmcnt(0)
  s_branch Lask_64
Lhave_65:
  s_add_u32 s33, s33, 2
  s_min_u32 s33, s33, 64
  s_cmp_ge_i32 s47, s33
  s_cbranch_scc1 Lskip_66
  s_load_dwordx2 s[100:101], s[4:5], s59 glc
Lskip_66:
  s_barrier
  s_add_u32 m0, s58, 16384
  s_add_u32 s31, s32, 16384
  buffer_load_dwordx4 v95, s[4:7], s31 offen offset:0 sc1 lds
  buffer_load_dwordx4 v95, s[4:7], s31 offen offset:1024 sc1 lds
  s_add_u32 m0, s58, 2048
  s_add_u32 s31, s32, 32768
  buffer_load_dwordx4 v95, s[4:7], s31 offen offset:0 sc1 lds
  buffer_load_dwordx4 v95, s[4:7], s31 offen offset:1024 sc1 lds
  s_mov_b32 m0, s58
  s_add_u32 s31, s32, s46
  buffer_load_dwordx4 v95, s[4:7], s31 offen offset:0 sc1 lds
  s_sub_u32 s31, s32, s46
  buffer_load_dwordx4 v95, s[4:7], s31 offen offset:1024 sc1 lds
  s_and_b32 s40, s25, 3
  s_lshl_b32 s40, s40, 16
  s_add_u32 s27, s40, s26
  s_add_u32 s27, s27, 1048576
  s_xor_b32 s37, s27, s36
  s_lshl_b32 s40, s40, 2
  s_add_u32 s28, s40, s26
  s_lshr_b32 s40, s40, 5
  s_and_b32 s40, s40, 0x4000
  s_xor_b32 s28, s28, s40
  s_xor_b32 s29, s28, 0x4000
  s_xor_b32 s34, s28, 0x84000
  s_xor_b32 s48, s28, 8192
  s_lshr_b32 s40, s46, 1
  s_add_u32 s29, s29, s40
  s_xor_b32 s35, s29, 512
  s_add_u32 s92, s37, s88
  s_add_u32 s96, s27, s88
  s_xor_b32 s96, s96, 0x1000
  s_add_u32 s93, s37, s89
  s_add_u32 s97, s27, s89
  s_xor_b32 s97, s97, 0x1000
  s_add_u32 s94, s37, s90
  s_add_u32 s98, s27, s90
  s_xor_b32 s98, s98, 0x1000
  s_add_u32 s95, s37, s91
  s_add_u32 s99, s27, s91
  s_xor_b32 s99, s99, 0x1000
L_QK_top:
  v_mov_b32 v94, s25
  v_mov_b64 v[52:53], 0
  v_mov_b64 v[54:55], 0
  v_mov_b64 v[56:57], 0
  v_mov_b64 v[58:59], 0
  v_mov_b64 v[60:61], 0
  v_mov_b64 v[62:63], 0
  v_mov_b64 v[64:65], 0
  v_mov_b64 v[66:67], 0
  ds_read_b128 v[20:23], v85 offset:0
  ds_read_b128 v[24:27], v85 offset:1024
  ds_read_b128 v[28:31], v85 offset:8192
  ds_read_b128 v[32:35], v85 offset:9216
  ds_read_b128 v[36:39], v85 offset:2048
  ds_read_b128 v[40:43], v85 offset:3072
  ds_read_b128 v[44:47], v85 offset:10240
  ds_read_b128 v[48:51], v85 offset:11264
  s_waitcnt lgkmcnt(0)
  s_and_b32 s40, s25, 63
  s_cselect_b32 s40, s56, 1
  s_cmp_lg_u32 s40, 0
  s_cbranch_scc1 L_QK_park
  v_mov_b32 v76, -1
  s_sleep 4
  s_nop 0
  s_nop 0
L_QK_spin:
  s_sub_u32 s24, s24, 1
  s_nop 0
  s_nop 0
  s_cbranch_scc1 L_FAIL
  s_nop 0
  s_waitcnt vmcnt(40)
  buffer_load_dword v76, v90, s[4:7], 0 offen sc1
  s_nop 3
  v_cmp_gt_i32_e64 vcc, s25, v76
  s_cbranch_vccz L_QK_rel
  buffer_load_dword v76, v90, s[4:7], 0 offen sc1
  s_nop 3
  v_cmp_gt_i32 vcc, s25, v76
  s_cbranch_vccz L_QK_rel
  buffer_load_dword v76, v90, s[4:7], 0 offen sc1
  s_nop 3
  v_cmp_gt_i32 vcc, s25, v76
  s_cbranch_vccz L_QK_rel
  buffer_load_dword v76, v90, s[4:7], 0 offen sc1
  s_nop 3
  v_cmp_gt_i32_e64 vcc, s25, v76
  s_cbranch_vccnz L_QK_spin
L_QK_rel:
  s_barrier
  s_mov_b64 exec, -1
L_QK_go:
L_QKM_again:
  buffer_load_dwordx4 v[96:99], v95, s[4:7], s92 offen offset:0 sc1
  s_nop 0
  buffer_load_dwordx4 v[100:103], v95, s[4:7], s92 offen offset:2048 sc1
  s_nop 0
  buffer_load_dwordx4 v[68:71], v95, s[4:7], s93 offen offset:0 sc1
  s_nop 0
  buffer_load_dwordx4 v[72:75], v95, s[4:7], s93 offen offset:2048 sc1
  s_nop 0
  buffer_load_dwordx4 v[4:7], v95, s[4:7], s94 offen offset:0 sc1
  s_nop 0
  buffer_load_dwordx4 v[8:11], v95, s[4:7], s94 offen offset:2048 sc1
  s_nop 0
  s_waitcnt vmcnt(5)
  v_cmp_eq_u32_e64 vcc, -1, v96
  s_cbranch_vccnz L_QKM_g0
L_QKM_ok0:
  v_smfmac_f32_16x16x64_bf16 v[52:55], v[96:99], a[0:7], v88
  buffer_load_dwordx4 v[12:15], v95, s[4:7], s95 offen offset:0 sc1
  buffer_load_dwordx4 v[16:19], v95, s[4:7], s95 offen offset:2048 sc1
  s_cmp_eq_u32 s20, 0
  s_cbranch_scc1 L_QK_sig
L_QK_sigd:
  v_smfmac_f32_16x16x64_bf16 v[60:63], v[96:99], v[128:135], v88
  s_waitcnt vmcnt(6)
  v_cmp_eq_u32 vcc, -1, v100
  v_smfmac_f32_16x16x64_bf16 v[56:59], v[96:99], a[128:135], v88
  v_smfmac_f32_16x16x64_bf16 v[64:67], v[96:99], v[20:27], v88
  s_cbranch_vccnz L_QKM_g1
L_QKM_ok1:
  v_smfmac_f32_16x16x64_bf16 v[52:55], v[100:103], a[8:15], v88
  buffer_load_dwordx4 v[96:99], v95, s[4:7], s96 offen offset:0 sc1
  ds_read_b128 v[20:23], v85 offset:4096
  v_smfmac_f32_16x16x64_bf16 v[60:63], v[100:103], v[136:143], v88
  s_waitcnt vmcnt(6)
  v_cmp_eq_u32 vcc, -1, v68
  v_smfmac_f32_16x16x64_bf16 v[56:59], v[100:103], a[136:143], v88
  ds_read_b128 v[24:27], v85 offset:5120
  v_smfmac_f32_16x16x64_bf16 v[64:67], v[100:103], v[28:35], v88
  s_cbranch_vccnz L_QKM_g2
L_QKM_ok2:
  v_smfmac_f32_16x16x64_bf16 v[52:55], v[68:71], a[16:23], v88
  buffer_load_dwordx4 v[100:103], v95, s[4:7], s96 offen offset:2048 sc1
  ds_read_b128 v[28:31], v85 offset:12288
  v_smfmac_f32_16x16x64_bf16 v[60:63], v[68:71], v[144:151], v88
  s_waitcnt vmcnt(6)
  v_cmp_eq_u32 vcc, -1, v72
  v_smfmac_f32_16x16x64_bf16 v[56:59], v[68:71], a[144:151], v88
  ds_read_b128 v[32:35], v85 offset:13312
  v_smfmac_f32_16x16x64_bf16 v[64:67], v[68:71], v[36:43], v88
  s_cbranch_vccnz L_QKM_g3
L_QKM_ok3:
  v_smfmac_f32_16x16x64_bf16 v[52:55], v[72:75], a[24:31], v88
  buffer_load_dwordx4 v[68:71], v95, s[4:7], s97 offen offset:0 sc1
  ds_read_b128 v[36:39], v85 offset:6144
  v_smfmac_f32_16x16x64_bf16 v[60:63], v[72:75], v[152:159], v88
  s_waitcnt vmcnt(6)
  v_cmp_eq_u32 vcc, -1, v4
  v_smfmac_f32_16x16x64_bf16 v[56:59], v[72:75], a[152:159], v88
  ds_read_b128 v[40:43], v85 offset:7168
  v_smfmac_f32_16x16x64_bf16 v[64:67], v[72:75], v[44:51], v88
  s_cbranch_vccnz L_QKM_g4
L_QKM_ok4:
  v_smfmac_f32_16x16x64_bf16 v[52:55], v[4:7], a[32:39], v88
  buffer_load_dwordx4 v[72:75], v95, s[4:7], s97 offen offset:2048 sc1
  ds_read_b128 v[44:47], v85 offset:14336
  v_smfmac_f32_16x16x64_bf16 v[60:63], v[4:7], v[160:167], v88
  s_waitcnt vmcnt(6)
  v_cmp_eq_u32_e64 vcc, -1, v8
  v_smfmac_f32_16x16x64_bf16 v[56:59], v[4:7], a[160:167], v88
  ds_read_b128 v[48:51], v85 offset:15360
  s_nop 0
  s_waitcnt lgkmcnt(6)
  v_smfmac_f32_16x16x64_bf16 v[64:67], v[4:7], v[20:27], v88
  s_cbranch_vccnz L_QKM_g5
L_QKM_ok5:
  v_smfmac_f32_16x16x64_bf16 v[52:55], v[8:11], a[40:47], v88
  buffer_load_dwordx4 v[4:7], v95, s[4:7], s98 offen offset:0 sc1
  ds_read_b128 v[20:23], v85 offset:16384
  v_smfmac_f32_16x16x64_bf16 v[60:63], v[8:11], v[168:175], v88
  s_waitcnt vmcnt(6)
  v_cmp_eq_u32 vcc, -1, v12
  v_smfmac_f32_16x16x64_bf16 v[56:59], v[8:11], a[168:175], v88
  ds_read_b128 v[24:27], v85 offset:17408
  s_waitcnt lgkmcnt(6)
  v_smfmac_f32_16x16x64_bf16 v[64:67], v[8:11], v[28:35], v88
  s_cbranch_vccnz L_QKM_g6
L_QKM_ok6:
  v_smfmac_f32_16x16x64_bf16 v[52:55], v[12:15], a[48:55], v88
  buffer_load_dwordx4 v[8:11], v95, s[4:7], s98 offen offset:2048 sc1
  ds_read_b128 v[28:31], v85 offset:24576
  v_smfmac_f32_16x16x64_bf16 v[60:63], v[12:15], v[176:183], v88
  s_waitcnt vmcnt(6)
  v_cmp_eq_u32 vcc, -1, v16
  v_smfmac_f32_16x16x64_bf16 v[56:59], v[12:15], a[176:183], v88
  ds_read_b128 v[32:35], v85 offset:25600
  s_waitcnt lgkmcnt(6)
  v_smfmac_f32_16x16x64_bf16 v[64:67], v[12:15], v[36:43], v88
  s_cbranch_vccnz L_QKM_g7
L_QKM_ok7:
  v_smfmac_f32_16x16x64_bf16 v[52:55], v[16:19], a[56:63], v88
  buffer_load_dwordx4 v[12:15], v95, s[4:7], s99 offen offset:0 sc1
  ds_read_b128 v[36:39], v85 offset:18432
  v_smfmac_f32_16x16x64_bf16 v[60:63], v[16:19], v[184:191], v88
  s_waitcnt vmcnt(6)
  v_cmp_eq_u32_e64 vcc, -1, v96
  v_smfmac_f32_16x16x64_bf16 v[56:59], v[16:19], a[184:191], v88
  ds_read_b128 v[40:43], v85 offset:19456
  s_nop 0
  s_waitcnt lgkmcnt(6)
  v_smfmac_f32_16x16x64_bf16 v[64:67], v[16:19], v[44:51], v88
  s_cbranch_vccnz L_QKM_g8
L_QKM_ok8:
  v_smfmac_f32_16x16x64_bf16 v[52:55], v[96:99], a[64:71], v88
  buffer_load_dwordx4 v[16:19], v95, s[4:7], s99 offen offset:2048 sc1
  ds_read_b128 v[44:47], v85 offset:26624
  v_smfmac_f32_16x16x64_bf16 v[60:63], v[96:99], v[192:199], v88
  s_waitcnt vmcnt(6)
  v_cmp_eq_u32 vcc, -1, v100
  v_smfmac_f32_16x16x64_bf16 v[56:59], v[96:99], a[192:199], v88
  ds_read_b128 v[48:51], v85 offset:27648
  s_waitcnt lgkmcnt(6)
  v_smfmac_f32_16x16x64_bf16 v[64:67], v[96:99], v[20:27], v88
  s_cbranch_vccnz L_QKM_g9
L_QKM_ok9:
  v_smfmac_f32_16x16x64_bf16 v[52:55], v[100:103], a[72:79], v88
  ds_read_b128 v[20:23], v85 offset:20480
  v_smfmac_f32_16x16x64_bf16 v[60:63], v[100:103], v[200:207], v88
  s_waitcnt vmcnt(5)
  v_cmp_eq_u32 vcc, -1, v68
  v_smfmac_f32_16x16x64_bf16 v[56:59], v[100:103], a[200:207], v88
  ds_read_b128 v[24:27], v85 offset:21504
  s_waitcnt lgkmcnt(6)
  v_smfmac_f32_16x16x64_bf16 v[64:67], v[100:103], v[28:35], v88
  s_cbranch_vccnz L_QKM_g10
L_QKM_ok10:
  v_smfmac_f32_16x16x64_bf16 v[52:55], v[68:71], a[80:87], v88
  ds_read_b128 v[28:31], v85 offset:28672
  v_smfmac_f32_16x16x64_bf16 v[60:63], v[68:71], v[208:215], v88
  s_waitcnt vmcnt(4)
  v_cmp_eq_u32 vcc, -1, v72
  v_smfmac_f32_16x16x64_bf16 v[56:59], v[68:71], a[208:215], v88
  ds_read_b128 v[32:35], v85 offset:29696
  s_waitcnt lgkmcnt(6)
  v_smfmac_f32_16x16x64_bf16 v[64:67], v[68:71], v[36:43], v88
  s_cbranch_vccnz L_QKM_g11
L_QKM_ok11:
  v_smfmac_f32_16x16x64_bf16 v[52:55], v[72:75], a[88:95], v88
  ds_read_b128 v[36:39], v85 offset:22528
  ds_read_b128 v[40:43], v85 offset:23552
  v_smfmac_f32_16x16x64_bf16 v[60:63], v[72:75], v[216:223], v88
  s_waitcnt vmcnt(3)
  v_cmp_eq_u32 vcc, -1, v4
  v_smfmac_f32_16x16x64_bf16 v[56:59], v[72:75], a[216:223], v88
  ds_read_b128 v[96:99], v1 offset:2048
  s_waitcnt lgkmcnt(7)
  v_smfmac_f32_16x16x64_bf16 v[64:67], v[72:75], v[44:51], v88
  s_cbranch_vccnz L_QKM_g12
L_QKM_ok12:
  v_smfmac_f32_16x16x64_bf16 v[52:55], v[4:7], a[96:103], v88
  ds_read_b128 v[44:47], v85 offset:30720
  ds_read_b128 v[48:51], v85 offset:31744
  v_smfmac_f32_16x16x64_bf16 v[60:63], v[4:7], v[224:231], v88
  s_waitcnt vmcnt(2)
  v_cmp_eq_u32_e64 vcc, -1, v8
  v_smfmac_f32_16x16x64_bf16 v[56:59], v[4:7], a[224:231], v88
  ds_read_b128 v[100:103], v1 offset:3072
  s_nop 0
  s_waitcnt lgkmcnt(8)
  v_smfmac_f32_16x16x64_bf16 v[64:67], v[4:7], v[20:27], v88
  s_cbranch_vccnz L_QKM_g13
L_QKM_ok13:
  v_smfmac_f32_16x16x64_bf16 v[52:55], v[8:11], a[104:111], v88
  ds_read_b128 v[68:71], v84 offset:16384
  ds_read_b128 v[72:75], v84 offset:17408
  v_smfmac_f32_16x16x64_bf16 v[60:63], v[8:11], v[232:239], v88
  s_waitcnt vmcnt(1)
  v_cmp_eq_u32 vcc, -1, v12
  v_smfmac_f32_16x16x64_bf16 v[56:59], v[8:11], a[232:239], v88
  ds_read_b128 v[20:23], v1 offset:16384
  s_waitcnt lgkmcnt(9)
  v_smfmac_f32_16x16x64_bf16 v[64:67], v[8:11], v[28:35], v88
  s_cbranch_vccnz L_QKM_g14
L_QKM_ok14:
  v_smfmac_f32_16x16x64_bf16 v[52:55], v[12:15], a[112:119], v88
  ds_read_b128 v[24:27], v1 offset:17408
  ds_read_b128 v[28:31], v2 offset:16384
  v_smfmac_f32_16x16x64_bf16 v[60:63], v[12:15], v[240:247], v88
  s_waitcnt vmcnt(0)
  v_cmp_eq_u32 vcc, -1, v16
  v_smfmac_f32_16x16x64_bf16 v[56:59], v[12:15], a[240:247], v88
  ds_read_b128 v[32:35], v2 offset:17408
  s_waitcnt lgkmcnt(10)
  v_smfmac_f32_16x16x64_bf16 v[64:67], v[12:15], v[36:43], v88
  s_cbranch_vccnz L_QKM_g15
L_QKM_ok15:
  v_smfmac_f32_16x16x64_bf16 v[52:55], v[16:19], a[120:127], v88
  ds_read_b128 v[36:39], v3 offset:16384
  v_smfmac_f32_16x16x64_bf16 v[60:63], v[16:19], v[248:255], v88
  ds_read_b128 v[40:43], v3 offset:17408
  v_smfmac_f32_16x16x64_bf16 v[56:59], v[16:19], a[248:255], v88
  s_waitcnt lgkmcnt(9)
  v_smfmac_f32_16x16x64_bf16 v[64:67], v[16:19], v[44:51], v88
  s_nop 1
  v_pk_add_f32 v[52:53], v[52:53], v[54:55]
  s_nop 0
  v_pk_add_f32 v[60:61], v[60:61], v[62:63]
  v_cmp_u_f32 vcc, v52, v53
  v_cvt_pk_bf16_f32 v77, v52, v53
  v_cvt_pk_bf16_f32 v76, v60, v61
  v_pk_add_f32 v[56:57], v[56:57], v[58:59]
  v_pk_add_f32 v[64:65], v[64:65], v[66:67]
  v_cvt_pk_bf16_f32 v79, v56, v57
  v_cvt_pk_bf16_f32 v78, v64, v65
  ds_write_b128 v123, v[76:79]
  ds_read_b64_tr_b16 v[4:5], v124 offset:0
  ds_read_b64_tr_b16 v[6:7], v124 offset:8
  s_cbranch_vccnz L_QKM_nan
L_QKM_done:
  s_waitcnt lgkmcnt(2)
  s_barrier
  ds_read_b64_tr_b16 v[8:9], v125 offset:0
  ds_read_b64_tr_b16 v[10:11], v125 offset:8
  ds_read_b64_tr_b16 v[12:13], v126 offset:0
  ds_read_b64_tr_b16 v[14:15], v126 offset:8
  ds_read_b64_tr_b16 v[16:17], v127 offset:0
  ds_read_b64_tr_b16 v[18:19], v127 offset:8
  s_waitcnt lgkmcnt(6)
  v_mfma_f32_16x16x32_bf16 v[52:55], v[20:23], v[4:7], 0
  v_mfma_f32_16x16x32_bf16 v[56:59], v[24:27], v[4:7], 0
  v_mfma_f32_16x16x32_bf16 v[60:63], v[4:7], v[4:7], 0
  s_waitcnt lgkmcnt(4)
  v_mfma_f32_16x16x32_bf16 v[52:55], v[28:31], v[8:11], v[52:55]
  v_mfma_f32_16x16x32_bf16 v[56:59], v[32:35], v[8:11], v[56:59]
  v_mfma_f32_16x16x32_bf16 v[60:63], v[8:11], v[8:11], v[60:63]
  buffer_load_dwordx2 v[104:105], v92, s[4:7], s29 offen sc1
  buffer_load_dwordx2 v[106:107], v92, s[4:7], s35 offen sc1
  s_waitcnt lgkmcnt(2)
  v_mfma_f32_16x16x32_bf16 v[52:55], v[36:39], v[12:15], v[52:55]
  v_mfma_f32_16x16x32_bf16 v[56:59], v[40:43], v[12:15], v[56:59]
  v_mfma_f32_16x16x32_bf16 v[60:63], v[12:15], v[12:15], v[60:63]
  s_waitcnt lgkmcnt(0)
  v_mfma_f32_16x16x32_bf16 v[52:55], v[68:71], v[16:19], v[52:55]
  v_mfma_f32_16x16x32_bf16 v[56:59], v[72:75], v[16:19], v[56:59]
  v_mfma_f32_16x16x32_bf16 v[60:63], v[16:19], v[16:19], v[60:63]
  s_mov_b32 vcc_lo, 0xcccccccc
  s_mov_b32 vcc_hi, 0xcccccccc
  v_mov_b32 v79, s38
  s_nop 2
  v_max3_f32 v64, v52, v53, v54
  v_max3_f32 v65, v55, v56, v57
  v_max3_f32 v64, v64, v58, v59
  v_max3_f32 v65, v65, v60, v61
  v_max_f32 v66, v64, v65
  v_max_f32 v67, v64, v65
  v_cndmask_b32_dpp v60, v61, v60, vcc quad_perm:[2,3,2,3] row_mask:0xf bank_mask:0xf
  v_cndmask_b32_dpp v52, v56, v52, vcc quad_perm:[2,3,2,3] row_mask:0xf bank_mask:0xf
  v_permlane16_swap_b32 v66, v67
  v_max_f32 v64, v66, v67
  v_max_f32 v65, v66, v67
  v_cndmask_b32_dpp v53, v57, v53, vcc quad_perm:[2,3,2,3] row_mask:0xf bank_mask:0xf
  v_cndmask_b32_dpp v54, v58, v54, vcc quad_perm:[2,3,2,3] row_mask:0xf bank_mask:0xf
  v_permlane32_swap_b32 v64, v65
  v_max_f32 v64, v64, v65
  v_cndmask_b32_dpp v55, v59, v55, vcc quad_perm:[2,3,2,3] row_mask:0xf bank_mask:0xf
  s_nop 0
  v_mul_f32_dpp v64, v64, v79 quad_perm:[2,3,2,3] row_mask:0xf bank_mask:0xf
  v_pk_fma_f32 v[52:53], v[52:53], s[38:39], v[64:65] op_sel_hi:[1,1,0] neg_lo:[0,0,1] neg_hi:[0,0,1]
  v_pk_fma_f32 v[54:55], v[54:55], s[38:39], v[64:65] op_sel_hi:[1,1,0] neg_lo:[0,0,1] neg_hi:[0,0,1]
  v_exp_f32 v52, v52
  v_exp_f32 v53, v53
  v_exp_f32 v54, v54
  v_cvt_pk_bf16_f32 v76, v52, v53
  v_exp_f32 v55, v55
  v_fma_f32 v60, v60, s38, -v64
  v_cvt_pk_bf16_f32 v77, v54, v55
  v_mov_b32_dpp v78, v76 quad_perm:[0,1,0,1] row_mask:0xf bank_mask:0xf
  v_exp_f32 v60, v60
  v_mov_b32_dpp v79, v77 quad_perm:[0,1,0,1] row_mask:0xf bank_mask:0xf
  s_nop 0
  v_mov_b32_dpp v61, v60 quad_perm:[0,1,0,1] row_mask:0xf bank_mask:0xf
  v_mfma_f32_16x16x32_bf16 v[64:67], v[108:111], v[76:79], 0
  v_cvt_pk_bf16_f32 v114, v60, v61
  v_cvt_pk_bf16_f32 v119, v60, v61
  s_waitcnt vmcnt(0)
  v_mfma_f32_16x16x32_bf16 v[44:47], v[96:99], v[76:79], 0
  v_max3_u32 v89, v104, v105, v106
  v_max_u32 v89, v89, v107
  v_mfma_f32_16x16x32_bf16 v[64:67], v[108:111], v[114:117], v[64:67]
  v_cmp_eq_u32 vcc, -1, v89
  v_mfma_f32_16x16x32_bf16 v[48:51], v[100:103], v[76:79], 0
  s_cbranch_vccnz L_QK_vbad
L_QK_vok:
  buffer_store_dword v94, v91, s[4:7], s57 offen
  v_mfma_f32_16x16x32_bf16 v[44:47], v[104:107], v[114:117], v[44:47]
  v_mfma_f32_16x16x32_bf16 v[48:51], v[104:107], v[118:121], v[48:51]
  s_nop 1
  v_rcp_f32_e64 v64, v64
  s_nop 3
  v_pk_mul_f32 v[44:45], v[44:45], v[64:65] op_sel_hi:[1,0]
  v_pk_mul_f32 v[46:47], v[46:47], v[64:65] op_sel_hi:[1,0]
  v_pk_mul_f32 v[48:49], v[48:49], v[64:65] op_sel_hi:[1,0]
  v_pk_mul_f32 v[50:51], v[50:51], v[64:65] op_sel_hi:[1,0]
  v_cvt_pk_bf16_f32 v52, v44, v45
  v_cvt_pk_bf16_f32 v53, v46, v47
  v_cvt_pk_bf16_f32 v54, v48, v49
  v_cvt_pk_bf16_f32 v55, v50, v51
  buffer_store_dwordx4 v[52:55], v122, s[4:7], s48 offen
  ds_read_b128 v[44:47], v1 offset:0
  ds_read_b128 v[48:51], v2 offset:1024
  s_add_u32 s32, s32, 2097152
  s_xor_b32 s32, s32, 0x2000
  s_add_u32 s33, s25, 2
  s_min_u32 s33, s33, 64
  s_waitcnt lgkmcnt(0)
  buffer_store_dwordx4 v[52:55], v122, s[4:7], s28 offen sc1
  v_mfma_f32_16x16x32_bf16 v[56:59], v[20:23], v[44:47], 0
  v_mfma_f32_16x16x32_bf16 v[60:63], v[24:27], v[44:47], 0
  v_mfma_f32_16x16x32_bf16 v[64:67], v[4:7], v[44:47], 0
  ds_read_b128 v[20:23], v3 offset:0
  ds_read_b128 v[24:27], v2 offset:2048
  v_mfma_f32_16x16x32_bf16 v[56:59], v[28:31], v[48:51], v[56:59]
  v_mfma_f32_16x16x32_bf16 v[60:63], v[32:35], v[48:51], v[60:63]
  v_mfma_f32_16x16x32_bf16 v[64:67], v[8:11], v[48:51], v[64:67]
  ds_read_b128 v[28:31], v84 offset:1024
  ds_read_b128 v[32:35], v2 offset:3072
  s_waitcnt lgkmcnt(3)
  v_mfma_f32_16x16x32_bf16 v[56:59], v[36:39], v[20:23], v[56:59]
  v_mfma_f32_16x16x32_bf16 v[60:63], v[40:43], v[20:23], v[60:63]
  v_mfma_f32_16x16x32_bf16 v[64:67], v[12:15], v[20:23], v[64:67]
  s_waitcnt lgkmcnt(0)
  v_mfma_f32_16x16x32_bf16 v[56:59], v[68:71], v[28:31], v[56:59]
  v_mfma_f32_16x16x32_bf16 v[60:63], v[72:75], v[28:31], v[60:63]
  v_mfma_f32_16x16x32_bf16 v[64:67], v[16:19], v[28:31], v[64:67]
  s_cmp_lg_u32 s20, 1
  s_cbranch_scc1 Lskip_69
Lask_67:
  s_min_i32 s47, s100, s101
  s_cmp_ge_i32 s47, s33
  s_cbranch_scc1 Lhave_68
  s_load_dwordx2 s[100:101], s[4:5], s59 glc
  s_sub_u32 s24, s24, 1
  s_nop 0
  s_cbranch_scc1 L_FAIL
  s_waitcnt lgkmcnt(0)
  s_branch Lask_67
Lhave_68:
  s_add_u32 s33, s33, 2
  s_min_u32 s33, s33, 64
  s_cmp_ge_i32 s47, s33
  s_nop 0
  s_nop 0
  s_cbranch_scc1 Lskip_69
  s_load_dwordx2 s[100:101], s[4:5], s59 glc
Lskip_69:
  s_barrier
  v_cndmask_b32 v56, v86, v56, s[8:9]
  v_cndmask_b32 v57, v86, v57, s[10:11]
  v_cndmask_b32 v58, v86, v58, s[16:17]
  v_cndmask_b32 v59, v86, v59, s[18:19]
  v_cndmask_b32 v60, v86, v60, s[42:43]
  v_cndmask_b32 v61, v86, v61, s[44:45]
  v_cndmask_b32 v62, v86, v62, s[52:53]
  v_cndmask_b32 v63, v86, v63, s[54:55]
  v_max3_f32 v72, v56, v57, v58
  v_max3_f32 v73, v59, v60, v61
  buffer_load_dword v89, v87, s[4:7], s28 offen sc1
  v_max3_f32 v72, v72, v62, v63
  v_max3_f32 v73, v73, v64, v65
  s_add_u32 m0, s58, 16384
  s_add_u32 s31, s32, 16384
  buffer_load_dwordx4 v95, s[4:7], s31 offen offset:0 sc1 lds
  v_max_f32 v74, v72, v73
  v_max_f32 v75, v72, v73
  buffer_load_dwordx4 v95, s[4:7], s31 offen offset:1024 sc1 lds
  s_nop 0
  v_permlane16_swap_b32 v74, v75
  v_max_f32 v72, v74, v75
  s_add_u32 m0, s58, 2048
  s_add_u32 s31, s32, 32768
  buffer_load_dwordx4 v95, s[4:7], s31 offen offset:0 sc1 lds
  v_max_f32 v73, v74, v75
  s_nop 1
  v_permlane32_swap_b32 v72, v73
  buffer_load_dwordx4 v95, s[4:7], s31 offen offset:1024 sc1 lds
  v_max_f32 v72, v72, v73
  v_mul_f32 v72, s38, v72
  s_mov_b32 m0, s58
  s_add_u32 s31, s32, s46
  buffer_load_dwordx4 v95, s[4:7], s31 offen offset:0 sc1 lds
  v_pk_fma_f32 v[56:57], v[56:57], s[38:39], v[72:73] op_sel_hi:[1,1,0] neg_lo:[0,0,1] neg_hi:[0,0,1]
  v_pk_fma_f32 v[58:59], v[58:59], s[38:39], v[72:73] op_sel_hi:[1,1,0] neg_lo:[0,0,1] neg_hi:[0,0,1]
  s_sub_u32 s31, s32, s46
  buffer_load_dwordx4 v95, s[4:7], s31 offen offset:1024 sc1 lds
  v_pk_fma_f32 v[60:61], v[60:61], s[38:39], v[72:73] op_sel_hi:[1,1,0] neg_lo:[0,0,1] neg_hi:[0,0,1]
  v_pk_fma_f32 v[62:63], v[62:63], s[38:39], v[72:73] op_sel_hi:[1,1,0] neg_lo:[0,0,1] neg_hi:[0,0,1]
  buffer_store_dwordx4 v[80:83], v122, s[4:7], s34 offen sc1
  v_pk_fma_f32 v[64:65], v[64:65], s[38:39], v[72:73] op_sel_hi:[1,1,0] neg_lo:[0,0,1] neg_hi:[0,0,1]
  v_exp_f32 v56, v56
  s_xor_b32 s40, s34, 8192
  buffer_store_dwordx4 v[80:83], v122, s[4:7], s40 offen
  v_exp_f32 v57, v57
  v_exp_f32 v58, v58
  v_exp_f32 v59, v59
  v_exp_f32 v60, v60
  v_exp_f32 v61, v61
  v_exp_f32 v62, v62
  v_exp_f32 v63, v63
  v_exp_f32 v64, v64
  v_exp_f32 v65, v65
  v_cvt_pk_bf16_f32 v36, v56, v57
  v_cvt_pk_bf16_f32 v37, v58, v59
  v_cvt_pk_bf16_f32 v38, v60, v61
  v_cvt_pk_bf16_f32 v39, v62, v63
  v_cvt_pk_bf16_f32 v114, v64, v65
  v_cvt_pk_bf16_f32 v119, v64, v65
  s_add_u32 s25, s25, 1
  s_xor_b32 s41, s30, 2048
  v_mfma_f32_16x16x32_bf16 v[40:43], v[108:111], v[36:39], 0
  s_and_b32 s40, s25, 3
  s_lshl_b32 s40, s40, 16
  s_add_u32 s27, s40, s26
  v_mfma_f32_16x16x32_bf16 v[52:55], v[96:99], v[36:39], 0
  s_add_u32 s27, s27, 1048576
  s_xor_b32 s37, s27, s36
  s_lshl_b32 s40, s40, 2
  v_mfma_f32_16x16x32_bf16 v[56:59], v[100:103], v[36:39], 0
  s_add_u32 s28, s40, s26
  s_lshr_b32 s40, s40, 5
  s_and_b32 s40, s40, 0x4000
  v_mfma_f32_16x16x32_bf16 v[60:63], v[24:27], v[36:39], 0
  s_xor_b32 s28, s28, s40
  s_xor_b32 s29, s28, 0x4000
  s_xor_b32 s34, s28, 0x84000
  v_mfma_f32_16x16x32_bf16 v[64:67], v[32:35], v[36:39], 0
  s_xor_b32 s48, s28, 8192
  s_lshr_b32 s40, s46, 1
  s_add_u32 s29, s29, s40
  v_mfma_f32_16x16x32_bf16 v[40:43], v[108:111], v[114:117], v[40:43]
  s_xor_b32 s35, s29, 512
  s_add_u32 s92, s37, s88
  s_add_u32 s96, s27, s88
  v_mfma_f32_16x16x32_bf16 v[52:55], v[104:107], v[114:117], v[52:55]
  s_xor_b32 s96, s96, 0x1000
  s_add_u32 s93, s37, s89
  s_add_u32 s97, s27, s89
  v_mfma_f32_16x16x32_bf16 v[56:59], v[104:107], v[118:121], v[56:59]
  s_xor_b32 s97, s97, 0x1000
  s_add_u32 s94, s37, s90
  s_add_u32 s98, s27, s90
  v_mfma_f32_16x16x32_bf16 v[60:63], v[104:107], v[112:115], v[60:63]
  s_xor_b32 s98, s98, 0x1000
  s_add_u32 s95, s37, s91
  s_add_u32 s99, s27, s91
  v_mfma_f32_16x16x32_bf16 v[64:67], v[104:107], v[116:119], v[64:67]
  s_xor_b32 s99, s99, 0x1000
  v_rcp_f32 v40, v40
  s_nop 0
  v_pk_mul_f32 v[52:53], v[52:53], v[40:41] op_sel_hi:[1,0]
  v_pk_mul_f32 v[54:55], v[54:55], v[40:41] op_sel_hi:[1,0]
  v_pk_mul_f32 v[56:57], v[56:57], v[40:41] op_sel_hi:[1,0]
  v_pk_mul_f32 v[58:59], v[58:59], v[40:41] op_sel_hi:[1,0]
  v_cvt_pk_bf16_f32 v4, v52, v53
  v_cvt_pk_bf16_f32 v5, v54, v55
  v_cvt_pk_bf16_f32 v6, v56, v57
  v_cvt_pk_bf16_f32 v7, v58, v59
  buffer_store_dwordx4 v[4:7], v95, s[4:7], s30 offen sc1
  v_pk_mul_f32 v[60:61], v[60:61], v[40:41] op_sel_hi:[1,0]
  v_pk_mul_f32 v[62:63], v[62:63], v[40:41] op_sel_hi:[1,0]
  v_pk_mul_f32 v[64:65], v[64:65], v[40:41] op_sel_hi:[1,0]
  v_pk_mul_f32 v[66:67], v[66:67], v[40:41] op_sel_hi:[1,0]
  v_cvt_pk_bf16_f32 v8, v60, v61
  v_cvt_pk_bf16_f32 v9, v62, v63
  v_cvt_pk_bf16_f32 v10, v64, v65
  v_cvt_pk_bf16_f32 v11, v66, v67
  buffer_store_dwordx4 v[8:11], v95, s[4:7], s41 offen sc1
  s_add_u32 s30, s30, 2097152
  s_xor_b32 s30, s30, 0x2000
  s_branch L_QK_top
L_QK_park:
  s_waitcnt vmcnt(0)
  s_cmp_lt_u32 s25, 64
  s_cbranch_scc1 L_QK_rel
  s_barrier
  s_cmp_lg_u32 s20, 0
  s_cbranch_scc1 Lnosig_70
  s_mov_b32 s63, s25
  s_atomic_smax s63, s[4:5], s62 glc
Lnosig_70:
  s_branch L_END
L_QKM_nan:
  s_cmp_eq_u32 s51, s25
  s_cbranch_scc1 L_QKM_done
  s_mov_b32 s51, s25
  s_add_u32 s60, s60, 0x10000
  s_waitcnt vmcnt(0) lgkmcnt(0)
L_QKM_v0:
  s_sub_u32 s24, s24, 1
  s_cbranch_scc1 L_FAIL
  buffer_load_dwordx4 v[96:99], v95, s[4:7], s92 offen offset:0 sc1
  buffer_load_dwordx4 v[100:103], v95, s[4:7], s92 offen offset:2048 sc1
  buffer_load_dwordx4 v[68:71], v95, s[4:7], s93 offen offset:0 sc1
  buffer_load_dwordx4 v[72:75], v95, s[4:7], s93 offen offset:2048 sc1
  v_mov_b32 v89, 0
  s_waitcnt vmcnt(0)
  v_max3_u32 v89, v96, v97, v89
  v_max3_u32 v89, v98, v99, v89
  v_max3_u32 v89, v100, v101, v89
  v_max3_u32 v89, v102, v103, v89
  v_max3_u32 v89, v68, v69, v89
  v_max3_u32 v89, v70, v71, v89
  v_max3_u32 v89, v72, v73, v89
  v_max3_u32 v89, v74, v75, v89
  v_cmp_eq_u32 vcc, -1, v89
  s_cbranch_vccnz L_QKM_v0
L_QKM_v4:
  s_sub_u32 s24, s24, 1
  s_cbranch_scc1 L_FAIL
  buffer_load_dwordx4 v[4:7], v95, s[4:7], s94 offen offset:0 sc1
  buffer_load_dwordx4 v[8:11], v95, s[4:7], s94 offen offset:2048 sc1
  buffer_load_dwordx4 v[12:15], v95, s[4:7], s95 offen offset:0 sc1
  buffer_load_dwordx4 v[16:19], v95, s[4:7], s95 offen offset:2048 sc1
  v_mov_b32 v89, 0
  s_waitcnt vmcnt(0)
  v_max3_u32 v89, v4, v5, v89
  v_max3_u32 v89, v6, v7, v89
  v_max3_u32 v89, v8, v9, v89
  v_max3_u32 v89, v10, v11, v89
  v_max3_u32 v89, v12, v13, v89
  v_max3_u32 v89, v14, v15, v89
  v_max3_u32 v89, v16, v17, v89
  v_max3_u32 v89, v18, v19, v89
  v_cmp_eq_u32 vcc, -1, v89
  s_cbranch_vccnz L_QKM_v4
L_QKM_v8:
  s_sub_u32 s24, s24, 1
  s_cbranch_scc1 L_FAIL
  buffer_load_dwordx4 v[96:99], v95, s[4:7], s96 offen offset:0 sc1
  buffer_load_dwordx4 v[100:103], v95, s[4:7], s96 offen offset:2048 sc1
  buffer_load_dwordx4 v[68:71], v95, s[4:7], s97 offen offset:0 sc1
  buffer_load_dwordx4 v[72:75], v95, s[4:7], s97 offen offset:2048 sc1
  v_mov_b32 v89, 0
  s_waitcnt vmcnt(0)
  v_max3_u32 v89, v96, v97, v89
  v_max3_u32 v89, v98, v99, v89
  v_max3_u32 v89, v100, v101, v89
  v_max3_u32 v89, v102, v103, v89
  v_max3_u32 v89, v68, v69, v89
  v_max3_u32 v89, v70, v71, v89
  v_max3_u32 v89, v72, v73, v89
  v_max3_u32 v89, v74, v75, v89
  v_cmp_eq_u32 vcc, -1, v89
  s_cbranch_vccnz L_QKM_v8
L_QKM_v12:
  s_sub_u32 s24, s24, 1
  s_cbranch_scc1 L_FAIL
  buffer_load_dwordx4 v[4:7], v95, s[4:7], s98 offen offset:0 sc1
  buffer_load_dwordx4 v[8:11], v95, s[4:7], s98 offen offset:2048 sc1
  buffer_load_dwordx4 v[12:15], v95, s[4:7], s99 offen offset:0 sc1
  buffer_load_dwordx4 v[16:19], v95, s[4:7], s99 offen offset:2048 sc1
  v_mov_b32 v89, 0
  s_waitcnt vmcnt(0)
  v_max3_u32 v89, v4, v5, v89
  v_max3_u32 v89, v6, v7, v89
  v_max3_u32 v89, v8, v9, v89
  v_max3_u32 v89, v10, v11, v89
  v_max3_u32 v89, v12, v13, v89
  v_max3_u32 v89, v14, v15, v89
  v_max3_u32 v89, v16, v17, v89
  v_max3_u32 v89, v18, v19, v89
  v_cmp_eq_u32 vcc, -1, v89
  s_cbranch_vccnz L_QKM_v12
  v_mov_b64 v[52:53], 0
  v_mov_b64 v[54:55], 0
  v_mov_b64 v[56:57], 0
  v_mov_b64 v[58:59], 0
  v_mov_b64 v[60:61], 0
  v_mov_b64 v[62:63], 0
  v_mov_b64 v[64:65], 0
  v_mov_b64 v[66:67], 0
  ds_read_b128 v[20:23], v85 offset:0
  ds_read_b128 v[24:27], v85 offset:1024
  ds_read_b128 v[28:31], v85 offset:8192
  ds_read_b128 v[32:35], v85 offset:9216
  ds_read_b128 v[36:39], v85 offset:2048
  ds_read_b128 v[40:43], v85 offset:3072
  ds_read_b128 v[44:47], v85 offset:10240
  ds_read_b128 v[48:51], v85 offset:11264
  s_waitcnt lgkmcnt(0)
  s_branch L_QKM_again
L_QKM_g0:
  s_sub_u32 s24, s24, 1
  s_cbranch_scc1 L_FAIL
  s_add_u32 s60, s60, 1
  buffer_load_dwordx4 v[96:99], v95, s[4:7], s92 offen offset:0 sc1
  s_waitcnt vmcnt(0)
  v_cmp_eq_u32 vcc, -1, v96
  s_cbranch_vccnz L_QKM_g0
  v_mov_b32 v89, 0
  v_max3_u32 v89, v100, v68, v89
  v_max3_u32 v89, v72, v4, v89
  v_max3_u32 v89, v8, v8, v89
  v_cmp_eq_u32 vcc, -1, v89
  s_cbranch_vccz L_QKM_ok0
  buffer_load_dwordx4 v[100:103], v95, s[4:7], s92 offen offset:2048 sc1
  s_nop 0
  buffer_load_dwordx4 v[68:71], v95, s[4:7], s93 offen offset:0 sc1
  s_nop 0
  buffer_load_dwordx4 v[72:75], v95, s[4:7], s93 offen offset:2048 sc1
  s_nop 0
  buffer_load_dwordx4 v[4:7], v95, s[4:7], s94 offen offset:0 sc1
  s_nop 0
  buffer_load_dwordx4 v[8:11], v95, s[4:7], s94 offen offset:2048 sc1
  s_nop 0
  s_branch L_QKM_ok0
L_QKM_g1:
  s_sub_u32 s24, s24, 1
  s_cbranch_scc1 L_FAIL
  s_add_u32 s60, s60, 1
  buffer_load_dwordx4 v[100:103], v95, s[4:7], s92 offen offset:2048 sc1
  s_waitcnt vmcnt(0)
  v_cmp_eq_u32 vcc, -1, v100
  s_cbranch_vccnz L_QKM_g1
  v_mov_b32 v89, 0
  v_max3_u32 v89, v68, v72, v89
  v_max3_u32 v89, v4, v8, v89
  v_max3_u32 v89, v12, v16, v89
  v_cmp_eq_u32 vcc, -1, v89
  s_cbranch_vccz L_QKM_ok1
  buffer_load_dwordx4 v[68:71], v95, s[4:7], s93 offen offset:0 sc1
  s_nop 0
  buffer_load_dwordx4 v[72:75], v95, s[4:7], s93 offen offset:2048 sc1
  s_nop 0
  buffer_load_dwordx4 v[4:7], v95, s[4:7], s94 offen offset:0 sc1
  s_nop 0
  buffer_load_dwordx4 v[8:11], v95, s[4:7], s94 offen offset:2048 sc1
  s_nop 0
  buffer_load_dwordx4 v[12:15], v95, s[4:7], s95 offen offset:0 sc1
  s_nop 0
  buffer_load_dwordx4 v[16:19], v95, s[4:7], s95 offen offset:2048 sc1
  s_nop 0
  s_branch L_QKM_ok1
L_QKM_g2:
  s_sub_u32 s24, s24, 1
  s_cbranch_scc1 L_FAIL
  s_add_u32 s60, s60, 1
  buffer_load_dwordx4 v[68:71], v95, s[4:7], s93 offen offset:0 sc1
  s_waitcnt vmcnt(0)
  v_cmp_eq_u32 vcc, -1, v68
  s_cbranch_vccnz L_QKM_g2
  v_mov_b32 v89, 0
  v_max3_u32 v89, v72, v4, v89
  v_max3_u32 v89, v8, v12, v89
  v_max3_u32 v89, v16, v96, v89
  v_cmp_eq_u32 vcc, -1, v89
  s_cbranch_vccz L_QKM_ok2
  buffer_load_dwordx4 v[72:75], v95, s[4:7], s93 offen offset:2048 sc1
  s_nop 0
  buffer_load_dwordx4 v[4:7], v95, s[4:7], s94 offen offset:0 sc1
  s_nop 0
  buffer_load_dwordx4 v[8:11], v95, s[4:7], s94 offen offset:2048 sc1
  s_nop 0
  buffer_load_dwordx4 v[12:15], v95, s[4:7], s95 offen offset:0 sc1
  s_nop 0
  buffer_load_dwordx4 v[16:19], v95, s[4:7], s95 offen offset:2048 sc1
  s_nop 0
  buffer_load_dwordx4 v[96:99], v95, s[4:7], s96 offen offset:0 sc1
  s_nop 0
  s_branch L_QKM_ok2
L_QKM_g3:
  s_sub_u32 s24, s24, 1
  s_cbranch_scc1 L_FAIL
  s_add_u32 s60, s60, 1
  buffer_load_dwordx4 v[72:75], v95, s[4:7], s93 offen offset:2048 sc1
  s_waitcnt vmcnt(0)
  v_cmp_eq_u32 vcc, -1, v72
  s_cbranch_vccnz L_QKM_g3
  v_mov_b32 v89, 0
  v_max3_u32 v89, v4, v8, v89
  v_max3_u32 v89, v12, v16, v89
  v_max3_u32 v89, v96, v100, v89
  v_cmp_eq_u32 vcc, -1, v89
  s_cbranch_vccz L_QKM_ok3
  buffer_load_dwordx4 v[4:7], v95, s[4:7], s94 offen offset:0 sc1
  s_nop 0
  buffer_load_dwordx4 v[8:11], v95, s[4:7], s94 offen offset:2048 sc1
  s_nop 0
  buffer_load_dwordx4 v[12:15], v95, s[4:7], s95 offen offset:0 sc1
  s_nop 0
  buffer_load_dwordx4 v[16:19], v95, s[4:7], s95 offen offset:2048 sc1
  s_nop 0
  buffer_load_dwordx4 v[96:99], v95, s[4:7], s96 offen offset:0 sc1
  s_nop 0
  buffer_load_dwordx4 v[100:103], v95, s[4:7], s96 offen offset:2048 sc1
  s_nop 0
  s_branch L_QKM_ok3
L_QKM_g4:
  s_sub_u32 s24, s24, 1
  s_cbranch_scc1 L_FAIL
  s_add_u32 s60, s60, 1
  buffer_load_dwordx4 v[4:7], v95, s[4:7], s94 offen offset:0 sc1
  s_waitcnt vmcnt(0)
  v_cmp_eq_u32 vcc, -1, v4
  s_cbranch_vccnz L_QKM_g4
  v_mov_b32 v89, 0
  v_max3_u32 v89, v8, v12, v89
  v_max3_u32 v89, v16, v96, v89
  v_max3_u32 v89, v100, v68, v89
  v_cmp_eq_u32 vcc, -1, v89
  s_cbranch_vccz L_QKM_ok4
  buffer_load_dwordx4 v[8:11], v95, s[4:7], s94 offen offset:2048 sc1
  s_nop 0
  buffer_load_dwordx4 v[12:15], v95, s[4:7], s95 offen offset:0 sc1
  s_nop 0
  buffer_load_dwordx4 v[16:19], v95, s[4:7], s95 offen offset:2048 sc1
  s_nop 0
  buffer_load_dwordx4 v[96:99], v95, s[4:7], s96 offen offset:0 sc1
  s_nop 0
  buffer_load_dwordx4 v[100:103], v95, s[4:7], s96 offen offset:2048 sc1
  s_nop 0
  buffer_load_dwordx4 v[68:71], v95, s[4:7], s97 offen offset:0 sc1
  s_nop 0
  s_branch L_QKM_ok4
L_QKM_g5:
  s_sub_u32 s24, s24, 1
  s_cbranch_scc1 L_FAIL
  s_add_u32 s60, s60, 1
  buffer_load_dwordx4 v[8:11], v95, s[4:7], s94 offen offset:2048 sc1
  s_waitcnt vmcnt(0)
  v_cmp_eq_u32 vcc, -1, v8
  s_cbranch_vccnz L_QKM_g5
  v_mov_b32 v89, 0
  v_max3_u32 v89, v12, v16, v89
  v_max3_u32 v89, v96, v100, v89
  v_max3_u32 v89, v68, v72, v89
  v_cmp_eq_u32 vcc, -1, v89
  s_cbranch_vccz L_QKM_ok5
  buffer_load_dwordx4 v[12:15], v95, s[4:7], s95 offen offset:0 sc1
  s_nop 0
  buffer_load_dwordx4 v[16:19], v95, s[4:7], s95 offen offset:2048 sc1
  s_nop 0
  buffer_load_dwordx4 v[96:99], v95, s[4:7], s96 offen offset:0 sc1
  s_nop 0
  buffer_load_dwordx4 v[100:103], v95, s[4:7], s96 offen offset:2048 sc1
  s_nop 0
  buffer_load_dwordx4 v[68:71], v95, s[4:7], s97 offen offset:0 sc1
  s_nop 0
  buffer_load_dwordx4 v[72:75], v95, s[4:7], s97 offen offset:2048 sc1
  s_nop 0
  s_branch L_QKM_ok5
L_QKM_g6:
  s_sub_u32 s24, s24, 1
  s_cbranch_scc1 L_FAIL
  s_add_u32 s60, s60, 1
  buffer_load_dwordx4 v[12:15], v95, s[4:7], s95 offen offset:0 sc1
  s_waitcnt vmcnt(0)
  v_cmp_eq_u32 vcc, -1, v12
  s_cbranch_vccnz L_QKM_g6
  v_mov_b32 v89, 0
  v_max3_u32 v89, v16, v96, v89
  v_max3_u32 v89, v100, v68, v89
  v_max3_u32 v89, v72, v4, v89
  v_cmp_eq_u32 vcc, -1, v89
  s_cbranch_vccz L_QKM_ok6
  buffer_load_dwordx4 v[16:19], v95, s[4:7], s95 offen offset:2048 sc1
  s_nop 0
  buffer_load_dwordx4 v[96:99], v95, s[4:7], s96 offen offset:0 sc1
  s_nop 0
  buffer_load_dwordx4 v[100:103], v95, s[4:7], s96 offen offset:2048 sc1
  s_nop 0
  buffer_load_dwordx4 v[68:71], v95, s[4:7], s97 offen offset:0 sc1
  s_nop 0
  buffer_load_dwordx4 v[72:75], v95, s[4:7], s97 offen offset:2048 sc1
  s_nop 0
  buffer_load_dwordx4 v[4:7], v95, s[4:7], s98 offen offset:0 sc1
  s_nop 0
  s_branch L_QKM_ok6
L_QKM_g7:
  s_sub_u32 s24, s24, 1
  s_cbranch_scc1 L_FAIL
  s_add_u32 s60, s60, 1
  buffer_load_dwordx4 v[16:19], v95, s[4:7], s95 offen offset:2048 sc1
  s_waitcnt vmcnt(0)
  v_cmp_eq_u32 vcc, -1, v16
  s_cbranch_vccnz L_QKM_g7
  v_mov_b32 v89, 0
  v_max3_u32 v89, v96, v100, v89
  v_max3_u32 v89, v68, v72, v89
  v_max3_u32 v89, v4, v8, v89
  v_cmp_eq_u32 vcc, -1, v89
  s_cbranch_vccz L_QKM_ok7
  buffer_load_dwordx4 v[96:99], v95, s[4:7], s96 offen offset:0 sc1
  s_nop 0
  buffer_load_dwordx4 v[100:103], v95, s[4:7], s96 offen offset:2048 sc1
  s_nop 0
  buffer_load_dwordx4 v[68:71], v95, s[4:7], s97 offen offset:0 sc1
  s_nop 0
  buffer_load_dwordx4 v[72:75], v95, s[4:7], s97 offen offset:2048 sc1
  s_nop 0
  buffer_load_dwordx4 v[4:7], v95, s[4:7], s98 offen offset:0 sc1
  s_nop 0
  buffer_load_dwordx4 v[8:11], v95, s[4:7], s98 offen offset:2048 sc1
  s_nop 0
  s_branch L_QKM_ok7
L_QKM_g8:
  s_sub_u32 s24, s24, 1
  s_cbranch_scc1 L_FAIL
  s_add_u32 s60, s60, 256
  buffer_load_dwordx4 v[96:99], v95, s[4:7], s96 offen offset:0 sc1
  s_waitcnt vmcnt(0)
  v_cmp_eq_u32 vcc, -1, v96
  s_cbranch_vccnz L_QKM_g8
  v_mov_b32 v89, 0
  v_max3_u32 v89, v100, v68, v89
  v_max3_u32 v89, v72, v4, v89
  v_max3_u32 v89, v8, v12, v89
  v_cmp_eq_u32 vcc, -1, v89
  s_cbranch_vccz L_QKM_ok8
  buffer_load_dwordx4 v[100:103], v95, s[4:7], s96 offen offset:2048 sc1
  s_nop 0
  buffer_load_dwordx4 v[68:71], v95, s[4:7], s97 offen offset:0 sc1
  s_nop 0
  buffer_load_dwordx4 v[72:75], v95, s[4:7], s97 offen offset:2048 sc1
  s_nop 0
  buffer_load_dwordx4 v[4:7], v95, s[4:7], s98 offen offset:0 sc1
  s_nop 0
  buffer_load_dwordx4 v[8:11], v95, s[4:7], s98 offen offset:2048 sc1
  s_nop 0
  buffer_load_dwordx4 v[12:15], v95, s[4:7], s99 offen offset:0 sc1
  s_nop 0
  s_branch L_QKM_ok8
L_QKM_g9:
  s_sub_u32 s24, s24, 1
  s_cbranch_scc1 L_FAIL
  s_add_u32 s60, s60, 256
  buffer_load_dwordx4 v[100:103], v95, s[4:7], s96 offen offset:2048 sc1
  s_waitcnt vmcnt(0)
  v_cmp_eq_u32 vcc, -1, v100
  s_cbranch_vccnz L_QKM_g9
  v_mov_b32 v89, 0
  v_max3_u32 v89, v68, v72, v89
  v_max3_u32 v89, v4, v8, v89
  v_max3_u32 v89, v12, v16, v89
  v_cmp_eq_u32 vcc, -1, v89
  s_cbranch_vccz L_QKM_ok9
  buffer_load_dwordx4 v[68:71], v95, s[4:7], s97 offen offset:0 sc1
  s_nop 0
  buffer_load_dwordx4 v[72:75], v95, s[4:7], s97 offen offset:2048 sc1
  s_nop 0
  buffer_load_dwordx4 v[4:7], v95, s[4:7], s98 offen offset:0 sc1
  s_nop 0
  buffer_load_dwordx4 v[8:11], v95, s[4:7], s98 offen offset:2048 sc1
  s_nop 0
  buffer_load_dwordx4 v[12:15], v95, s[4:7], s99 offen offset:0 sc1
  s_nop 0
  buffer_load_dwordx4 v[16:19], v95, s[4:7], s99 offen offset:2048 sc1
  s_nop 0
  s_branch L_QKM_ok9
L_QKM_g10:
  s_sub_u32 s24, s24, 1
  s_cbranch_scc1 L_FAIL
  s_add_u32 s60, s60, 256
  buffer_load_dwordx4 v[68:71], v95, s[4:7], s97 offen offset:0 sc1
  s_waitcnt vmcnt(0)
  v_cmp_eq_u32 vcc, -1, v68
  s_cbranch_vccnz L_QKM_g10
  v_mov_b32 v89, 0
  v_max3_u32 v89, v72, v4, v89
  v_max3_u32 v89, v8, v12, v89
  v_max3_u32 v89, v16, v16, v89
  v_cmp_eq_u32 vcc, -1, v89
  s_cbranch_vccz L_QKM_ok10
  buffer_load_dwordx4 v[72:75], v95, s[4:7], s97 offen offset:2048 sc1
  s_nop 0
  buffer_load_dwordx4 v[4:7], v95, s[4:7], s98 offen offset:0 sc1
  s_nop 0
  buffer_load_dwordx4 v[8:11], v95, s[4:7], s98 offen offset:2048 sc1
  s_nop 0
  buffer_load_dwordx4 v[12:15], v95, s[4:7], s99 offen offset:0 sc1
  s_nop 0
  buffer_load_dwordx4 v[16:19], v95, s[4:7], s99 offen offset:2048 sc1
  s_nop 0
  s_branch L_QKM_ok10
L_QKM_g11:
  s_sub_u32 s24, s24, 1
  s_cbranch_scc1 L_FAIL
  s_add_u32 s60, s60, 256
  buffer_load_dwordx4 v[72:75], v95, s[4:7], s97 offen offset:2048 sc1
  s_waitcnt vmcnt(0)
  v_cmp_eq_u32 vcc, -1, v72
  s_cbranch_vccnz L_QKM_g11
  v_mov_b32 v89, 0
  v_max3_u32 v89, v4, v8, v89
  v_max3_u32 v89, v12, v16, v89
  v_cmp_eq_u32 vcc, -1, v89
  s_cbranch_vccz L_QKM_ok11
  buffer_load_dwordx4 v[4:7], v95, s[4:7], s98 offen offset:0 sc1
  s_nop 0
  buffer_load_dwordx4 v[8:11], v95, s[4:7], s98 offen offset:2048 sc1
  s_nop 0
  buffer_load_dwordx4 v[12:15], v95, s[4:7], s99 offen offset:0 sc1
  s_nop 0
  buffer_load_dwordx4 v[16:19], v95, s[4:7], s99 offen offset:2048 sc1
  s_nop 0
  s_branch L_QKM_ok11
L_QKM_g12:
  s_sub_u32 s24, s24, 1
  s_cbranch_scc1 L_FAIL
  s_add_u32 s60, s60, 256
  buffer_load_dwordx4 v[4:7], v95, s[4:7], s98 offen offset:0 sc1
  s_waitcnt vmcnt(0)
  v_cmp_eq_u32 vcc, -1, v4
  s_cbranch_vccnz L_QKM_g12
  v_mov_b32 v89, 0
  v_max3_u32 v89, v8, v12, v89
  v_max3_u32 v89, v16, v16, v89
  v_cmp_eq_u32 vcc, -1, v89
  s_cbranch_vccz L_QKM_ok12
  buffer_load_dwordx4 v[8:11], v95, s[4:7], s98 offen offset:2048 sc1
  s_nop 0
  buffer_load_dwordx4 v[12:15], v95, s[4:7], s99 offen offset:0 sc1
  s_nop 0
  buffer_load_dwordx4 v[16:19], v95, s[4:7], s99 offen offset:2048 sc1
  s_nop 0
  s_branch L_QKM_ok12
L_QKM_g13:
  s_sub_u32 s24, s24, 1
  s_cbranch_scc1 L_FAIL
  s_add_u32 s60, s60, 256
  buffer_load_dwordx4 v[8:11], v95, s[4:7], s98 offen offset:2048 sc1
  s_waitcnt vmcnt(0)
  v_cmp_eq_u32 vcc, -1, v8
  s_cbranch_vccnz L_QKM_g13
  v_mov_b32 v89, 0
  v_max3_u32 v89, v12, v16, v89
  v_cmp_eq_u32 vcc, -1, v89
  s_cbranch_vccz L_QKM_ok13
  buffer_load_dwordx4 v[12:15], v95, s[4:7], s99 offen offset:0 sc1
  s_nop 0
  buffer_load_dwordx4 v[16:19], v95, s[4:7], s99 offen offset:2048 sc1
  s_nop 0
  s_branch L_QKM_ok13
L_QKM_g14:
  s_sub_u32 s24, s24, 1
  s_cbranch_scc1 L_FAIL
  s_add_u32 s60, s60, 256
  buffer_load_dwordx4 v[12:15], v95, s[4:7], s99 offen offset:0 sc1
  s_waitcnt vmcnt(0)
  v_cmp_eq_u32 vcc, -1, v12
  s_cbranch_vccnz L_QKM_g14
  v_mov_b32 v89, 0
  v_max3_u32 v89, v16, v16, v89
  v_cmp_eq_u32 vcc, -1, v89
  s_cbranch_vccz L_QKM_ok14
  buffer_load_dwordx4 v[16:19], v95, s[4:7], s99 offen offset:2048 sc1
  s_nop 0
  s_branch L_QKM_ok14
L_QKM_g15:
  s_sub_u32 s24, s24, 1
  s_cbranch_scc1 L_FAIL
  s_add_u32 s60, s60, 256
  buffer_load_dwordx4 v[16:19], v95, s[4:7], s99 offen offset:2048 sc1
  s_waitcnt vmcnt(0)
  v_cmp_eq_u32 vcc, -1, v16
  s_cbranch_vccnz L_QKM_g15
  s_branch L_QKM_ok15
L_QK_sig:
  s_mov_b32 s63, s25
  s_atomic_smax s63, s[4:5], s62 glc
Lnosig_71:
  s_branch L_QK_sigd
L_QK_vbad:
  s_sub_u32 s24, s24, 1
  s_cbranch_scc1 L_FAIL
  s_add_u32 s61, s61, 1
  buffer_load_dwordx2 v[104:105], v92, s[4:7], s29 offen sc1
  buffer_load_dwordx2 v[106:107], v92, s[4:7], s35 offen sc1
  s_waitcnt vmcnt(0)
  v_max3_u32 v89, v104, v105, v106
  v_max_u32 v89, v89, v107
  v_cmp_eq_u32 vcc, -1, v89
  s_cbranch_vccnz L_QK_vbad
  s_branch L_QK_vok
L_VO:
  v_bfe_u32 v76, v0, 3, 2
  v_xor_b32 v76, s20, v76
  v_lshlrev_b32 v76, 5, v76
  v_lshrrev_b32 v4, 2, v0
  v_lshl_add_u32 v4, v4, 7, v76
  v_and_b32 v76, 3, v0
  v_lshl_add_u32 v4, v76, 3, v4
  s_lshl_b32 s40, s20, 15
  v_add_u32 v4, s40, v4
  v_lshl_add_u32 v85, v0, 4, s40
  s_lshl_b32 s40, s20, 12
  s_add_u32 s40, s40, 131072
  v_lshl_add_u32 v1, v0, 4, s40
  s_lshr_b32 s54, s21, 4
  s_lshl_b32 s52, s54, 22
  s_sub_u32 s53, 0, s52
  v_xor_b32 v5, 32768, v4
  v_xor_b32 v2, 4096, v1
  v_xor_b32 v6, 65536, v4
  v_xor_b32 v3, 8192, v1
  v_xor_b32 v7, 98304, v4
  v_xor_b32 v84, 12288, v1
  v_bfe_u32 v8, v0, 5, 1
  v_mul_u32_u24 v8, 16384, v8
  v_bfe_u32 v76, v0, 4, 1
  v_mul_u32_u24 v76, 32768, v76
  v_add_u32 v8, v8, v76
  v_bfe_u32 v76, v0, 3, 1
  v_mul_u32_u24 v76, 131072, v76
  v_add_u32 v8, v8, v76
  v_lshrrev_b32 v76, 3, v0
  v_and_b32 v76, 6, v76
  v_xor_b32 v76, v76, v0
  v_and_b32 v76, 7, v76
  v_lshl_add_u32 v8, v76, 4, v8
  s_lshl_b32 s40, s20, 19
  v_add_u32 v8, s40, v8
  s_lshl_b32 s44, s21, 8
  s_add_u32 s45, s44, 128
  s_load_dwordx2 s[8:9], s[0:1], 32
  s_mov_b32 s10, 8388608
  s_mov_b32 s11, 0x20000
  s_waitcnt lgkmcnt(0)
  v_add_u32 v9, s44, v8
  v_add_u32 v10, s45, v8
  s_lshl_b32 s41, s20, 15
  s_add_u32 m0, s41, 0
  s_add_u32 s42, s52, 0
  buffer_load_dwordx4 v9, s[8:11], s42 offen lds
  s_add_u32 m0, s41, 1024
  s_add_u32 s42, s52, 65536
  buffer_load_dwordx4 v9, s[8:11], s42 offen lds
  s_add_u32 m0, s41, 2048
  s_add_u32 s42, s52, 8192
  buffer_load_dwordx4 v9, s[8:11], s42 offen lds
  s_add_u32 m0, s41, 3072
  s_add_u32 s42, s52, 73728
  buffer_load_dwordx4 v9, s[8:11], s42 offen lds
  s_add_u32 m0, s41, 4096
  s_add_u32 s42, s52, 262144
  buffer_load_dwordx4 v9, s[8:11], s42 offen lds
  s_add_u32 m0, s41, 5120
  s_add_u32 s42, s52, 327680
  buffer_load_dwordx4 v9, s[8:11], s42 offen lds
  s_add_u32 m0, s41, 6144
  s_add_u32 s42, s52, 270336
  buffer_load_dwordx4 v9, s[8:11], s42 offen lds
  s_add_u32 m0, s41, 7168
  s_add_u32 s42, s52, 335872
  buffer_load_dwordx4 v9, s[8:11], s42 offen lds
  s_add_u32 m0, s41, 8192
  s_add_u32 s42, s52, 2097152
  buffer_load_dwordx4 v9, s[8:11], s42 offen lds
  s_add_u32 m0, s41, 9216
  s_add_u32 s42, s52, 2162688
  buffer_load_dwordx4 v9, s[8:11], s42 offen lds
  s_add_u32 m0, s41, 10240
  s_add_u32 s42, s52, 2105344
  buffer_load_dwordx4 v9, s[8:11], s42 offen lds
  s_add_u32 m0, s41, 11264
  s_add_u32 s42, s52, 2170880
  buffer_load_dwordx4 v9, s[8:11], s42 offen lds
  s_add_u32 m0, s41, 12288
  s_add_u32 s42, s52, 2359296
  buffer_load_dwordx4 v9, s[8:11], s42 offen lds
  s_add_u32 m0, s41, 13312
  s_add_u32 s42, s52, 2424832
  buffer_load_dwordx4 v9, s[8:11], s42 offen lds
  s_add_u32 m0, s41, 14336
  s_add_u32 s42, s52, 2367488
  buffer_load_dwordx4 v9, s[8:11], s42 offen lds
  s_add_u32 m0, s41, 15360
  s_add_u32 s42, s52, 2433024
  buffer_load_dwordx4 v9, s[8:11], s42 offen lds
  s_add_u32 m0, s41, 16384
  s_add_u32 s42, s53, 4194304
  buffer_load_dwordx4 v9, s[8:11], s42 offen lds
  s_add_u32 m0, s41, 17408
  s_add_u32 s42, s53, 4259840
  buffer_load_dwordx4 v9, s[8:11], s42 offen lds
  s_add_u32 m0, s41, 18432
  s_add_u32 s42, s53, 4202496
  buffer_load_dwordx4 v9, s[8:11], s42 offen lds
  s_add_u32 m0, s41, 19456
  s_add_u32 s42, s53, 4268032
  buffer_load_dwordx4 v9, s[8:11], s42 offen lds
  s_add_u32 m0, s41, 20480
  s_add_u32 s42, s53, 4456448
  buffer_load_dwordx4 v9, s[8:11], s42 offen lds
  s_add_u32 m0, s41, 21504
  s_add_u32 s42, s53, 4521984
  buffer_load_dwordx4 v9, s[8:11], s42 offen lds
  s_add_u32 m0, s41, 22528
  s_add_u32 s42, s53, 4464640
  buffer_load_dwordx4 v9, s[8:11], s42 offen lds
  s_add_u32 m0, s41, 23552
  s_add_u32 s42, s53, 4530176
  buffer_load_dwordx4 v9, s[8:11], s42 offen lds
  s_waitcnt vmcnt(16) lgkmcnt(0)
  s_barrier
  s_add_u32 m0, s41, 24576
  s_add_u32 s42, s53, 6291456
  buffer_load_dwordx4 v9, s[8:11], s42 offen lds
  s_add_u32 m0, s41, 25600
  s_add_u32 s42, s53, 6356992
  buffer_load_dwordx4 v9, s[8:11], s42 offen lds
  s_add_u32 m0, s41, 26624
  s_add_u32 s42, s53, 6299648
  buffer_load_dwordx4 v9, s[8:11], s42 offen lds
  s_add_u32 m0, s41, 27648
  s_add_u32 s42, s53, 6365184
  buffer_load_dwordx4 v9, s[8:11], s42 offen lds
  s_add_u32 m0, s41, 28672
  s_add_u32 s42, s53, 6553600
  buffer_load_dwordx4 v9, s[8:11], s42 offen lds
  s_add_u32 m0, s41, 29696
  s_add_u32 s42, s53, 6619136
  buffer_load_dwordx4 v9, s[8:11], s42 offen lds
  s_add_u32 m0, s41, 30720
  s_add_u32 s42, s53, 6561792
  buffer_load_dwordx4 v9, s[8:11], s42 offen lds
  s_add_u32 m0, s41, 31744
  s_add_u32 s42, s53, 6627328
  buffer_load_dwordx4 v9, s[8:11], s42 offen lds
  ds_read_b64_tr_b16 v[128:129], v4 offset:0
  ds_read_b64_tr_b16 v[130:131], v4 offset:2048
  ds_read_b64_tr_b16 v[132:133], v4 offset:4096
  ds_read_b64_tr_b16 v[134:135], v4 offset:6144
  ds_read_b64_tr_b16 v[144:145], v5 offset:0
  ds_read_b64_tr_b16 v[146:147], v5 offset:2048
  ds_read_b64_tr_b16 v[148:149], v5 offset:4096
  ds_read_b64_tr_b16 v[150:151], v5 offset:6144
  ds_read_b64_tr_b16 v[160:161], v6 offset:0
  ds_read_b64_tr_b16 v[162:163], v6 offset:2048
  ds_read_b64_tr_b16 v[164:165], v6 offset:4096
  ds_read_b64_tr_b16 v[166:167], v6 offset:6144
  ds_read_b64_tr_b16 v[176:177], v7 offset:0
  ds_read_b64_tr_b16 v[178:179], v7 offset:2048
  ds_read_b64_tr_b16 v[180:181], v7 offset:4096
  ds_read_b64_tr_b16 v[182:183], v7 offset:6144
  s_waitcnt vmcnt(16) lgkmcnt(0)
  s_barrier
  s_add_u32 m0, s41, 0
  s_add_u32 s42, s52, 0
  buffer_load_dwordx4 v10, s[8:11], s42 offen lds
  s_add_u32 m0, s41, 1024
  s_add_u32 s42, s52, 65536
  buffer_load_dwordx4 v10, s[8:11], s42 offen lds
  s_add_u32 m0, s41, 2048
  s_add_u32 s42, s52, 8192
  buffer_load_dwordx4 v10, s[8:11], s42 offen lds
  s_add_u32 m0, s41, 3072
  s_add_u32 s42, s52, 73728
  buffer_load_dwordx4 v10, s[8:11], s42 offen lds
  s_add_u32 m0, s41, 4096
  s_add_u32 s42, s52, 262144
  buffer_load_dwordx4 v10, s[8:11], s42 offen lds
  s_add_u32 m0, s41, 5120
  s_add_u32 s42, s52, 327680
  buffer_load_dwordx4 v10, s[8:11], s42 offen lds
  s_add_u32 m0, s41, 6144
  s_add_u32 s42, s52, 270336
  buffer_load_dwordx4 v10, s[8:11], s42 offen lds
  s_add_u32 m0, s41, 7168
  s_add_u32 s42, s52, 335872
  buffer_load_dwordx4 v10, s[8:11], s42 offen lds
  ds_read_b64_tr_b16 v[136:137], v4 offset:8192
  ds_read_b64_tr_b16 v[138:139], v4 offset:10240
  ds_read_b64_tr_b16 v[140:141], v4 offset:12288
  ds_read_b64_tr_b16 v[142:143], v4 offset:14336
  ds_read_b64_tr_b16 v[152:153], v5 offset:8192
  ds_read_b64_tr_b16 v[154:155], v5 offset:10240
  ds_read_b64_tr_b16 v[156:157], v5 offset:12288
  ds_read_b64_tr_b16 v[158:159], v5 offset:14336
  ds_read_b64_tr_b16 v[168:169], v6 offset:8192
  ds_read_b64_tr_b16 v[170:171], v6 offset:10240
  ds_read_b64_tr_b16 v[172:173], v6 offset:12288
  ds_read_b64_tr_b16 v[174:175], v6 offset:14336
  ds_read_b64_tr_b16 v[184:185], v7 offset:8192
  ds_read_b64_tr_b16 v[186:187], v7 offset:10240
  ds_read_b64_tr_b16 v[188:189], v7 offset:12288
  ds_read_b64_tr_b16 v[190:191], v7 offset:14336
  s_waitcnt vmcnt(16) lgkmcnt(0)
  s_barrier
  s_add_u32 m0, s41, 8192
  s_add_u32 s42, s52, 2097152
  buffer_load_dwordx4 v10, s[8:11], s42 offen lds
  s_add_u32 m0, s41, 9216
  s_add_u32 s42, s52, 2162688
  buffer_load_dwordx4 v10, s[8:11], s42 offen lds
  s_add_u32 m0, s41, 10240
  s_add_u32 s42, s52, 2105344
  buffer_load_dwordx4 v10, s[8:11], s42 offen lds
  s_add_u32 m0, s41, 11264
  s_add_u32 s42, s52, 2170880
  buffer_load_dwordx4 v10, s[8:11], s42 offen lds
  s_add_u32 m0, s41, 12288
  s_add_u32 s42, s52, 2359296
  buffer_load_dwordx4 v10, s[8:11], s42 offen lds
  s_add_u32 m0, s41, 13312
  s_add_u32 s42, s52, 2424832
  buffer_load_dwordx4 v10, s[8:11], s42 offen lds
  s_add_u32 m0, s41, 14336
  s_add_u32 s42, s52, 2367488
  buffer_load_dwordx4 v10, s[8:11], s42 offen lds
  s_add_u32 m0, s41, 15360
  s_add_u32 s42, s52, 2433024
  buffer_load_dwordx4 v10, s[8:11], s42 offen lds
  ds_read_b64_tr_b16 v[192:193], v4 offset:16384
  ds_read_b64_tr_b16 v[194:195], v4 offset:18432
  ds_read_b64_tr_b16 v[196:197], v4 offset:20480
  ds_read_b64_tr_b16 v[198:199], v4 offset:22528
  ds_read_b64_tr_b16 v[208:209], v5 offset:16384
  ds_read_b64_tr_b16 v[210:211], v5 offset:18432
  ds_read_b64_tr_b16 v[212:213], v5 offset:20480
  ds_read_b64_tr_b16 v[214:215], v5 offset:22528
  ds_read_b64_tr_b16 v[224:225], v6 offset:16384
  ds_read_b64_tr_b16 v[226:227], v6 offset:18432
  ds_read_b64_tr_b16 v[228:229], v6 offset:20480
  ds_read_b64_tr_b16 v[230:231], v6 offset:22528
  ds_read_b64_tr_b16 v[240:241], v7 offset:16384
  ds_read_b64_tr_b16 v[242:243], v7 offset:18432
  ds_read_b64_tr_b16 v[244:245], v7 offset:20480
  ds_read_b64_tr_b16 v[246:247], v7 offset:22528
  s_waitcnt vmcnt(16) lgkmcnt(0)
  s_barrier
  s_add_u32 m0, s41, 16384
  s_add_u32 s42, s53, 4194304
  buffer_load_dwordx4 v10, s[8:11], s42 offen lds
  s_add_u32 m0, s41, 17408
  s_add_u32 s42, s53, 4259840
  buffer_load_dwordx4 v10, s[8:11], s42 offen lds
  s_add_u32 m0, s41, 18432
  s_add_u32 s42, s53, 4202496
  buffer_load_dwordx4 v10, s[8:11], s42 offen lds
  s_add_u32 m0, s41, 19456
  s_add_u32 s42, s53, 4268032
  buffer_load_dwordx4 v10, s[8:11], s42 offen lds
  s_add_u32 m0, s41, 20480
  s_add_u32 s42, s53, 4456448
  buffer_load_dwordx4 v10, s[8:11], s42 offen lds
  s_add_u32 m0, s41, 21504
  s_add_u32 s42, s53, 4521984
  buffer_load_dwordx4 v10, s[8:11], s42 offen lds
  s_add_u32 m0, s41, 22528
  s_add_u32 s42, s53, 4464640
  buffer_load_dwordx4 v10, s[8:11], s42 offen lds
  s_add_u32 m0, s41, 23552
  s_add_u32 s42, s53, 4530176
  buffer_load_dwordx4 v10, s[8:11], s42 offen lds
  ds_read_b64_tr_b16 v[200:201], v4 offset:24576
  ds_read_b64_tr_b16 v[202:203], v4 offset:26624
  ds_read_b64_tr_b16 v[204:205], v4 offset:28672
  ds_read_b64_tr_b16 v[206:207], v4 offset:30720
  ds_read_b64_tr_b16 v[216:217], v5 offset:24576
  ds_read_b64_tr_b16 v[218:219], v5 offset:26624
  ds_read_b64_tr_b16 v[220:221], v5 offset:28672
  ds_read_b64_tr_b16 v[222:223], v5 offset:30720
  ds_read_b64_tr_b16 v[232:233], v6 offset:24576
  ds_read_b64_tr_b16 v[234:235], v6 offset:26624
  ds_read_b64_tr_b16 v[236:237], v6 offset:28672
  ds_read_b64_tr_b16 v[238:239], v6 offset:30720
  ds_read_b64_tr_b16 v[248:249], v7 offset:24576
  ds_read_b64_tr_b16 v[250:251], v7 offset:26624
  ds_read_b64_tr_b16 v[252:253], v7 offset:28672
  ds_read_b64_tr_b16 v[254:255], v7 offset:30720
  s_cmp_lg_u32 s20, 0
  s_cbranch_scc1 Lchore_72
Lini_73:
  s_load_dwordx16 s[64:79], s[12:13], 128 glc
  s_load_dwordx16 s[80:95], s[12:13], 192 glc
  s_sub_u32 s24, s24, 1
  s_cbranch_scc1 L_FAIL
  s_waitcnt lgkmcnt(0)
  s_and_b64 s[64:65], s[64:65], s[66:67]
  s_and_b64 s[64:65], s[64:65], s[68:69]
  s_and_b64 s[64:65], s[64:65], s[70:71]
  s_and_b64 s[64:65], s[64:65], s[72:73]
  s_and_b64 s[64:65], s[64:65], s[74:75]
  s_and_b64 s[64:65], s[64:65], s[76:77]
  s_and_b64 s[64:65], s[64:65], s[78:79]
  s_and_b64 s[64:65], s[64:65], s[80:81]
  s_and_b64 s[64:65], s[64:65], s[82:83]
  s_and_b64 s[64:65], s[64:65], s[84:85]
  s_and_b64 s[64:65], s[64:65], s[86:87]
  s_and_b64 s[64:65], s[64:65], s[88:89]
  s_and_b64 s[64:65], s[64:65], s[90:91]
  s_and_b64 s[64:65], s[64:65], s[92:93]
  s_and_b64 s[64:65], s[64:65], s[94:95]
  s_and_b32 s64, s64, s65
  s_cbranch_scc0 Lini_73
  s_mov_b32 s46, 0xffff
  s_and_b32 s40, s21, 3
  s_lshl_b32 s40, s40, 13
  s_lshr_b32 s43, s21, 2
  s_lshl_b32 s43, s43, 10
  s_add_u32 s43, s43, s40
  s_add_u32 s43, s43, 1344000
  s_waitcnt lgkmcnt(0)
  s_memtime s[64:65]
  s_waitcnt lgkmcnt(0)
  s_load_dword s68, s[4:5], s43 glc
  s_waitcnt lgkmcnt(0)
  s_memtime s[66:67]
  s_waitcnt lgkmcnt(0)
  s_sub_u32 s64, s66, s64
  s_min_u32 s46, s46, s64
  s_getreg_b32 s55, hwreg(HW_REG_XCC_ID)
  s_and_b32 s55, s55, 15
  s_lshl_b32 s46, s46, 8
  s_or_b32 s46, s46, s55
  s_add_u32 s40, s21, 32
  s_lshl_b32 s40, s40, 7
  s_add_u32 s40, s40, 1424384
  s_mov_b32 s63, s46
  s_atomic_smax s63, s[4:5], s40 glc
Lnosig_74:
Lchore_72:
  s_waitcnt vmcnt(16) lgkmcnt(0)
  s_barrier
  s_add_u32 m0, s41, 24576
  s_add_u32 s42, s53, 6291456
  buffer_load_dwordx4 v10, s[8:11], s42 offen lds
  s_add_u32 m0, s41, 25600
  s_add_u32 s42, s53, 6356992
  buffer_load_dwordx4 v10, s[8:11], s42 offen lds
  s_add_u32 m0, s41, 26624
  s_add_u32 s42, s53, 6299648
  buffer_load_dwordx4 v10, s[8:11], s42 offen lds
  s_add_u32 m0, s41, 27648
  s_add_u32 s42, s53, 6365184
  buffer_load_dwordx4 v10, s[8:11], s42 offen lds
  s_add_u32 m0, s41, 28672
  s_add_u32 s42, s53, 6553600
  buffer_load_dwordx4 v10, s[8:11], s42 offen lds
  s_add_u32 m0, s41, 29696
  s_add_u32 s42, s53, 6619136
  buffer_load_dwordx4 v10, s[8:11], s42 offen lds
  s_add_u32 m0, s41, 30720
  s_add_u32 s42, s53, 6561792
  buffer_load_dwordx4 v10, s[8:11], s42 offen lds
  s_add_u32 m0, s41, 31744
  s_add_u32 s42, s53, 6627328
  buffer_load_dwordx4 v10, s[8:11], s42 offen lds
  ds_read_b64_tr_b16 v[20:21], v4 offset:0
  ds_read_b64_tr_b16 v[22:23], v4 offset:2048
  ds_read_b64_tr_b16 v[24:25], v4 offset:4096
  ds_read_b64_tr_b16 v[26:27], v4 offset:6144
  ds_read_b64_tr_b16 v[28:29], v5 offset:0
  ds_read_b64_tr_b16 v[30:31], v5 offset:2048
  ds_read_b64_tr_b16 v[32:33], v5 offset:4096
  ds_read_b64_tr_b16 v[34:35], v5 offset:6144
  ds_read_b64_tr_b16 v[36:37], v6 offset:0
  ds_read_b64_tr_b16 v[38:39], v6 offset:2048
  ds_read_b64_tr_b16 v[40:41], v6 offset:4096
  ds_read_b64_tr_b16 v[42:43], v6 offset:6144
  ds_read_b64_tr_b16 v[44:45], v7 offset:0
  ds_read_b64_tr_b16 v[46:47], v7 offset:2048
  ds_read_b64_tr_b16 v[48:49], v7 offset:4096
  ds_read_b64_tr_b16 v[50:51], v7 offset:6144
  s_waitcnt lgkmcnt(0)
  s_barrier
  ds_write_b128 v85, v[20:23] offset:0
  ds_write_b128 v85, v[24:27] offset:1024
  ds_write_b128 v85, v[28:31] offset:2048
  ds_write_b128 v85, v[32:35] offset:3072
  ds_write_b128 v85, v[36:39] offset:4096
  ds_write_b128 v85, v[40:43] offset:5120
  ds_write_b128 v85, v[44:47] offset:6144
  ds_write_b128 v85, v[48:51] offset:7168
  s_waitcnt vmcnt(16) lgkmcnt(0)
  s_barrier
  ds_read_b64_tr_b16 v[20:21], v4 offset:8192
  ds_read_b64_tr_b16 v[22:23], v4 offset:10240
  ds_read_b64_tr_b16 v[24:25], v4 offset:12288
  ds_read_b64_tr_b16 v[26:27], v4 offset:14336
  ds_read_b64_tr_b16 v[28:29], v5 offset:8192
  ds_read_b64_tr_b16 v[30:31], v5 offset:10240
  ds_read_b64_tr_b16 v[32:33], v5 offset:12288
  ds_read_b64_tr_b16 v[34:35], v5 offset:14336
  ds_read_b64_tr_b16 v[36:37], v6 offset:8192
  ds_read_b64_tr_b16 v[38:39], v6 offset:10240
  ds_read_b64_tr_b16 v[40:41], v6 offset:12288
  ds_read_b64_tr_b16 v[42:43], v6 offset:14336
  ds_read_b64_tr_b16 v[44:45], v7 offset:8192
  ds_read_b64_tr_b16 v[46:47], v7 offset:10240
  ds_read_b64_tr_b16 v[48:49], v7 offset:12288
  ds_read_b64_tr_b16 v[50:51], v7 offset:14336
  s_waitcnt lgkmcnt(0)
  s_barrier
  ds_write_b128 v85, v[20:23] offset:8192
  ds_write_b128 v85, v[24:27] offset:9216
  ds_write_b128 v85, v[28:31] offset:10240
  ds_write_b128 v85, v[32:35] offset:11264
  ds_write_b128 v85, v[36:39] offset:12288
  ds_write_b128 v85, v[40:43] offset:13312
  ds_write_b128 v85, v[44:47] offset:14336
  ds_write_b128 v85, v[48:51] offset:15360
  s_waitcnt vmcnt(8) lgkmcnt(0)
  s_barrier
  ds_read_b64_tr_b16 v[20:21], v4 offset:16384
  ds_read_b64_tr_b16 v[22:23], v4 offset:18432
  ds_read_b64_tr_b16 v[24:25], v4 offset:20480
  ds_read_b64_tr_b16 v[26:27], v4 offset:22528
  ds_read_b64_tr_b16 v[28:29], v5 offset:16384
  ds_read_b64_tr_b16 v[30:31], v5 offset:18432
  ds_read_b64_tr_b16 v[32:33], v5 offset:20480
  ds_read_b64_tr_b16 v[34:35], v5 offset:22528
  ds_read_b64_tr_b16 v[36:37], v6 offset:16384
  ds_read_b64_tr_b16 v[38:39], v6 offset:18432
  ds_read_b64_tr_b16 v[40:41], v6 offset:20480
  ds_read_b64_tr_b16 v[42:43], v6 offset:22528
  ds_read_b64_tr_b16 v[44:45], v7 offset:16384
  ds_read_b64_tr_b16 v[46:47], v7 offset:18432
  ds_read_b64_tr_b16 v[48:49], v7 offset:20480
  ds_read_b64_tr_b16 v[50:51], v7 offset:22528
  s_waitcnt lgkmcnt(0)
  s_barrier
  ds_write_b128 v85, v[20:23] offset:16384
  ds_write_b128 v85, v[24:27] offset:17408
  ds_write_b128 v85, v[28:31] offset:18432
  ds_write_b128 v85, v[32:35] offset:19456
  ds_write_b128 v85, v[36:39] offset:20480
  ds_write_b128 v85, v[40:43] offset:21504
  ds_write_b128 v85, v[44:47] offset:22528
  ds_write_b128 v85, v[48:51] offset:23552
  s_waitcnt vmcnt(0) lgkmcnt(0)
  s_barrier
  ds_read_b64_tr_b16 v[20:21], v4 offset:24576
  ds_read_b64_tr_b16 v[22:23], v4 offset:26624
  ds_read_b64_tr_b16 v[24:25], v4 offset:28672
  ds_read_b64_tr_b16 v[26:27], v4 offset:30720
  ds_read_b64_tr_b16 v[28:29], v5 offset:24576
  ds_read_b64_tr_b16 v[30:31], v5 offset:26624
  ds_read_b64_tr_b16 v[32:33], v5 offset:28672
  ds_read_b64_tr_b16 v[34:35], v5 offset:30720
  ds_read_b64_tr_b16 v[36:37], v6 offset:24576
  ds_read_b64_tr_b16 v[38:39], v6 offset:26624
  ds_read_b64_tr_b16 v[40:41], v6 offset:28672
  ds_read_b64_tr_b16 v[42:43], v6 offset:30720
  ds_read_b64_tr_b16 v[44:45], v7 offset:24576
  ds_read_b64_tr_b16 v[46:47], v7 offset:26624
  ds_read_b64_tr_b16 v[48:49], v7 offset:28672
  ds_read_b64_tr_b16 v[50:51], v7 offset:30720
  s_waitcnt lgkmcnt(0)
  s_barrier
  ds_write_b128 v85, v[20:23] offset:24576
  ds_write_b128 v85, v[24:27] offset:25600
  ds_write_b128 v85, v[28:31] offset:26624
  ds_write_b128 v85, v[32:35] offset:27648
  ds_write_b128 v85, v[36:39] offset:28672
  ds_write_b128 v85, v[40:43] offset:29696
  ds_write_b128 v85, v[44:47] offset:30720
  ds_write_b128 v85, v[48:51] offset:31744
  s_waitcnt lgkmcnt(0)
  s_lshr_b32 s40, s21, 1
  s_lshl_b32 s40, s40, 2
  v_min_u32 v76, 3, v0
  v_add_u32 v76, s40, v76
  v_lshlrev_b32 v76, 7, v76
  v_add_u32 v76, 1432576, v76
  s_nop 1
Lpoll_75:
  buffer_load_dword v77, v76, s[4:7], 0 offen sc1
  s_sub_u32 s24, s24, 1
  s_cbranch_scc1 L_FAIL
  s_waitcnt vmcnt(0)
  v_cmp_gt_i32 vcc, 1, v77
  s_cbranch_vccz Lpolld_76
  s_sleep 1
  s_branch Lpoll_75
Lpolld_76:
  s_lshl_b32 s40, s21, 18
  s_lshl_b32 s41, s20, 15
  s_add_u32 s40, s40, s41
  v_lshl_add_u32 v76, v0, 4, s40
  s_add_u32 s50, s21, s20
  s_and_b32 s50, s50, 3
  s_lshl_b32 s41, s54, 5
  s_add_u32 s41, s41, s50
  s_lshl_b32 s41, s41, 12
  s_xor_b32 s40, s41, 0
  s_add_u32 s40, s40, 6291456
  buffer_load_dwordx4 a[0:3], v76, s[4:7], s40 offen offset:0 sc1
  buffer_load_dwordx4 a[4:7], v76, s[4:7], s40 offen offset:1024 sc1
  buffer_load_dwordx4 a[8:11], v76, s[4:7], s40 offen offset:2048 sc1
  buffer_load_dwordx4 a[12:15], v76, s[4:7], s40 offen offset:3072 sc1
  s_xor_b32 s40, s41, 4096
  s_add_u32 s40, s40, 6291456
  buffer_load_dwordx4 a[16:19], v76, s[4:7], s40 offen offset:0 sc1
  buffer_load_dwordx4 a[20:23], v76, s[4:7], s40 offen offset:1024 sc1
  buffer_load_dwordx4 a[24:27], v76, s[4:7], s40 offen offset:2048 sc1
  buffer_load_dwordx4 a[28:31], v76, s[4:7], s40 offen offset:3072 sc1
  s_xor_b32 s40, s41, 8192
  s_add_u32 s40, s40, 6291456
  buffer_load_dwordx4 a[32:35], v76, s[4:7], s40 offen offset:0 sc1
  buffer_load_dwordx4 a[36:39], v76, s[4:7], s40 offen offset:1024 sc1
  buffer_load_dwordx4 a[40:43], v76, s[4:7], s40 offen offset:2048 sc1
  buffer_load_dwordx4 a[44:47], v76, s[4:7], s40 offen offset:3072 sc1
  s_xor_b32 s40, s41, 12288
  s_add_u32 s40, s40, 6291456
  buffer_load_dwordx4 a[48:51], v76, s[4:7], s40 offen offset:0 sc1
  buffer_load_dwordx4 a[52:55], v76, s[4:7], s40 offen offset:1024 sc1
  buffer_load_dwordx4 a[56:59], v76, s[4:7], s40 offen offset:2048 sc1
  buffer_load_dwordx4 a[60:63], v76, s[4:7], s40 offen offset:3072 sc1
  s_xor_b32 s40, s41, 16384
  s_add_u32 s40, s40, 6291456
  buffer_load_dwordx4 a[64:67], v76, s[4:7], s40 offen offset:0 sc1
  buffer_load_dwordx4 a[68:71], v76, s[4:7], s40 offen offset:1024 sc1
  buffer_load_dwordx4 a[72:75], v76, s[4:7], s40 offen offset:2048 sc1
  buffer_load_dwordx4 a[76:79], v76, s[4:7], s40 offen offset:3072 sc1
  s_xor_b32 s40, s41, 20480
  s_add_u32 s40, s40, 6291456
  buffer_load_dwordx4 a[80:83], v76, s[4:7], s40 offen offset:0 sc1
  buffer_load_dwordx4 a[84:87], v76, s[4:7], s40 offen offset:1024 sc1
  buffer_load_dwordx4 a[88:91], v76, s[4:7], s40 offen offset:2048 sc1
  buffer_load_dwordx4 a[92:95], v76, s[4:7], s40 offen offset:3072 sc1
  s_xor_b32 s40, s41, 24576
  s_add_u32 s40, s40, 6291456
  buffer_load_dwordx4 a[96:99], v76, s[4:7], s40 offen offset:0 sc1
  buffer_load_dwordx4 a[100:103], v76, s[4:7], s40 offen offset:1024 sc1
  buffer_load_dwordx4 a[104:107], v76, s[4:7], s40 offen offset:2048 sc1
  buffer_load_dwordx4 a[108:111], v76, s[4:7], s40 offen offset:3072 sc1
  s_xor_b32 s40, s41, 28672
  s_add_u32 s40, s40, 6291456
  buffer_load_dwordx4 a[112:115], v76, s[4:7], s40 offen offset:0 sc1
  buffer_load_dwordx4 a[116:119], v76, s[4:7], s40 offen offset:1024 sc1
  buffer_load_dwordx4 a[120:123], v76, s[4:7], s40 offen offset:2048 sc1
  buffer_load_dwordx4 a[124:127], v76, s[4:7], s40 offen offset:3072 sc1
  s_xor_b32 s40, s41, 131072
  s_add_u32 s40, s40, 6291456
  buffer_load_dwordx4 a[128:131], v76, s[4:7], s40 offen offset:0 sc1
  buffer_load_dwordx4 a[132:135], v76, s[4:7], s40 offen offset:1024 sc1
  buffer_load_dwordx4 a[136:139], v76, s[4:7], s40 offen offset:2048 sc1
  buffer_load_dwordx4 a[140:143], v76, s[4:7], s40 offen offset:3072 sc1
  s_waitcnt vmcnt(32)
  s_xor_b32 s40, s41, 135168
  s_add_u32 s40, s40, 6291456
  buffer_load_dwordx4 a[144:147], v76, s[4:7], s40 offen offset:0 sc1
  buffer_load_dwordx4 a[148:151], v76, s[4:7], s40 offen offset:1024 sc1
  buffer_load_dwordx4 a[152:155], v76, s[4:7], s40 offen offset:2048 sc1
  buffer_load_dwordx4 a[156:159], v76, s[4:7], s40 offen offset:3072 sc1
  s_waitcnt vmcnt(32)
  s_xor_b32 s40, s41, 139264
  s_add_u32 s40, s40, 6291456
  buffer_load_dwordx4 a[160:163], v76, s[4:7], s40 offen offset:0 sc1
  buffer_load_dwordx4 a[164:167], v76, s[4:7], s40 offen offset:1024 sc1
  buffer_load_dwordx4 a[168:171], v76, s[4:7], s40 offen offset:2048 sc1
  buffer_load_dwordx4 a[172:175], v76, s[4:7], s40 offen offset:3072 sc1
  s_waitcnt vmcnt(32)
  s_xor_b32 s40, s41, 143360
  s_add_u32 s40, s40, 6291456
  buffer_load_dwordx4 a[176:179], v76, s[4:7], s40 offen offset:0 sc1
  buffer_load_dwordx4 a[180:183], v76, s[4:7], s40 offen offset:1024 sc1
  buffer_load_dwordx4 a[184:187], v76, s[4:7], s40 offen offset:2048 sc1
  buffer_load_dwordx4 a[188:191], v76, s[4:7], s40 offen offset:3072 sc1
  s_waitcnt vmcnt(32)
  s_xor_b32 s40, s41, 147456
  s_add_u32 s40, s40, 6291456
  buffer_load_dwordx4 a[192:195], v76, s[4:7], s40 offen offset:0 sc1
  buffer_load_dwordx4 a[196:199], v76, s[4:7], s40 offen offset:1024 sc1
  buffer_load_dwordx4 a[200:203], v76, s[4:7], s40 offen offset:2048 sc1
  buffer_load_dwordx4 a[204:207], v76, s[4:7], s40 offen offset:3072 sc1
  s_waitcnt vmcnt(32)
  s_xor_b32 s40, s41, 151552
  s_add_u32 s40, s40, 6291456
  buffer_load_dwordx4 a[208:211], v76, s[4:7], s40 offen offset:0 sc1
  buffer_load_dwordx4 a[212:215], v76, s[4:7], s40 offen offset:1024 sc1
  buffer_load_dwordx4 a[216:219], v76, s[4:7], s40 offen offset:2048 sc1
  buffer_load_dwordx4 a[220:223], v76, s[4:7], s40 offen offset:3072 sc1
  s_waitcnt vmcnt(32)
  s_xor_b32 s40, s41, 155648
  s_add_u32 s40, s40, 6291456
  buffer_load_dwordx4 a[224:227], v76, s[4:7], s40 offen offset:0 sc1
  buffer_load_dwordx4 a[228:231], v76, s[4:7], s40 offen offset:1024 sc1
  buffer_load_dwordx4 a[232:235], v76, s[4:7], s40 offen offset:2048 sc1
  buffer_load_dwordx4 a[236:239], v76, s[4:7], s40 offen offset:3072 sc1
  s_waitcnt vmcnt(32)
  s_xor_b32 s40, s41, 159744
  s_add_u32 s40, s40, 6291456
  buffer_load_dwordx4 a[240:243], v76, s[4:7], s40 offen offset:0 sc1
  buffer_load_dwordx4 a[244:247], v76, s[4:7], s40 offen offset:1024 sc1
  buffer_load_dwordx4 a[248:251], v76, s[4:7], s40 offen offset:2048 sc1
  buffer_load_dwordx4 a[252:255], v76, s[4:7], s40 offen offset:3072 sc1
  s_waitcnt vmcnt(32)
  s_cmp_lg_u32 s20, 2
  s_cbranch_scc1 Lnotlb_77
  v_lshlrev_b32 v77, 21, v0
  s_mov_b32 s40, 0x1fff80
  buffer_load_dword v78, v77, s[4:7], s40 offen sc1
  s_add_u32 s40, s40, 134217728
  buffer_load_dword v78, v77, s[4:7], s40 offen sc1
  s_waitcnt vmcnt(0)
Lnotlb_77:
  s_getreg_b32 s55, hwreg(HW_REG_XCC_ID)
  s_and_b32 s55, s55, 15
  v_min_u32 v76, 63, v0
  v_lshlrev_b32 v76, 7, v76
  v_add_u32 v76, 1424384, v76
  s_nop 1
Lpoll_78:
  buffer_load_dword v77, v76, s[4:7], 0 offen sc1
  s_sub_u32 s24, s24, 1
  s_cbranch_scc1 L_FAIL
  s_waitcnt vmcnt(0)
  v_cmp_gt_i32 vcc, 0, v77
  s_cbranch_vccz Lpolld_79
  s_sleep 1
  s_branch Lpoll_78
Lpolld_79:
  v_and_b32 v78, 15, v77
  v_cmp_ne_u32 vcc, s55, v78
  s_lshl_b32 s40, s54, 4
  s_lshl_b32 s40, 0xffff, s40
  s_or_b32 s41, vcc_lo, vcc_hi
  s_and_b32 s40, s40, s41
  s_cselect_b32 s36, 0, 8192
  v_lshrrev_b32 v77, 8, v77
  v_and_b32 v78, 3, v0
  v_lshl_or_b32 v77, v77, 2, v78
  s_nop 1
  v_min_u32_dpp v77, v77, v77 row_ror:8 row_mask:0xf bank_mask:0xf
  s_nop 1
  v_min_u32_dpp v77, v77, v77 row_ror:4 row_mask:0xf bank_mask:0xf
  v_mov_b32 v78, v77
  s_nop 1
  v_permlane16_swap_b32 v78, v77
  v_min_u32 v77, v77, v78
  v_mov_b32 v78, v77
  s_nop 1
  v_permlane32_swap_b32 v78, v77
  v_min_u32 v77, v77, v78
  s_nop 1
  v_min_u32_dpp v77, v77, v77 row_ror:2 row_mask:0xf bank_mask:0xf
  s_nop 1
  v_min_u32_dpp v77, v77, v77 row_ror:1 row_mask:0xf bank_mask:0xf
  s_nop 0
  v_readfirstlane_b32 s26, v77
  s_and_b32 s26, s26, 3
  s_lshl_b32 s26, s26, 13
  s_lshr_b32 s40, s20, 1
  s_mul_i32 s40, s40, 32768
  s_and_b32 s41, s20, 1
  s_lshl_b32 s41, s41, 10
  s_add_u32 s40, s40, s41
  s_lshl_b32 s41, s54, 12
  s_add_u32 s40, s40, s41
  v_lshl_add_u32 v86, v0, 4, s40
  v_xor_b32 v87, 0x1000, v86
  v_and_b32 v76, 2, v0
  v_cmp_eq_u32 vcc, 0, v76
  v_mov_b32 v76, 0xeeee
  v_mov_b32 v77, 0x4444
  v_cndmask_b32 v88, v76, v77, vcc
  s_lshr_b32 s40, s21, 2
  s_mul_i32 s40, s40, 32768
  s_and_b32 s41, s21, 3
  s_lshl_b32 s41, s41, 11
  s_add_u32 s47, s40, s41
  s_lshl_b32 s41, s20, 9
  s_add_u32 s47, s47, s41
  v_lshl_add_u32 v92, v0, 3, s47
  s_lshl_b32 s41, s54, 12
  s_add_u32 s40, s41, 1310720
  s_add_u32 s40, s40, s26
  v_lshrrev_b32 v76, 2, v0
  v_lshl_add_u32 v76, v76, 7, s40
  v_and_b32 v77, 3, v0
  v_lshl_add_u32 v90, v77, 2, v76
  s_mov_b32 s57, s40
  s_cmp_eq_u32 s36, 0
  s_cselect_b32 s56, 1, s20
  s_and_b32 s41, s21, 15
  s_lshl_b32 s41, s41, 7
  s_lshl_b32 s40, s20, 2
  s_add_u32 s40, s40, s41
  s_add_u32 s40, s40, 0
  s_mov_b32 s25, 0
  s_mov_b32 s60, 0
  s_mov_b32 s61, 0
  s_mov_b32 s51, -1
  v_mov_b32 v91, 2147483392
  s_mov_b64 exec, 1
  v_mov_b32 v91, s40
  s_mov_b64 exec, -1
  v_mov_b32 v80, -1
  v_mov_b32 v81, -1
  v_mov_b32 v82, -1
  v_mov_b32 v83, -1
  s_mul_i32 s40, s20, 32768
  s_and_b32 s41, s50, 3
  s_lshl_b32 s41, s41, 10
  s_add_u32 s40, s40, s41
  v_lshl_add_u32 v110, v0, 4, s40
  v_xor_b32 v111, 0x400, v110
  v_xor_b32 v112, 0x800, v110
  v_xor_b32 v113, 0xc00, v110
  s_mul_i32 s58, s54, 131072
  s_and_b32 s41, s50, 4
  s_lshl_b32 s41, s41, 10
  s_add_u32 s58, s58, s41
  s_bfe_u32 s40, s21, 0x20002
  s_lshl_b32 s40, s40, 7
  s_and_b32 s41, s21, 3
  s_lshl_b32 s41, s41, 4
  s_add_u32 s40, s40, s41
  s_lshl_b32 s41, s20, 2
  s_add_u32 s41, s41, s40
  s_cmp_eq_u32 s20, 0
  s_cselect_b32 s40, s40, s41
  s_mov_b64 exec, 1
  v_mov_b32 v91, s40
  s_mov_b64 exec, -1
  s_mul_i32 s40, s20, 512
  v_add_u32 v90, s40, v90
  s_lshl_b32 s40, s20, 10
  s_add_u32 s40, s40, 147456
  v_lshl_add_u32 v95, v0, 4, s40
  s_and_b32 s40, s20, 1
  s_lshl_b32 s40, s40, 3
  v_bfe_u32 v4, v0, 2, 3
  v_add_u32 v4, s40, v4
  s_lshr_b32 s40, s20, 1
  s_lshl_b32 s40, s40, 3
  v_and_b32 v5, 3, v0
  v_add_u32 v5, s40, v5
  v_bfe_u32 v76, v4, 1, 1
  v_lshl_add_u32 v5, v76, 2, v5
  v_lshrrev_b32 v76, 2, v4
  v_and_b32 v77, 1, v4
  v_lshl_add_u32 v78, v76, 4, v5
  v_lshlrev_b32 v78, 4, v78
  v_lshl_add_u32 v78, v77, 3, v78
  v_add_u32 v108, 147456, v78
  s_bfe_u32 s41, s21, 0x10002
  s_mul_i32 s41, s41, 32768
  s_lshr_b32 s40, s21, 3
  s_lshl_b32 s40, s40, 11
  s_add_u32 s40, s40, s41
  s_and_b32 s41, s21, 3
  s_lshl_b32 s41, s41, 9
  s_add_u32 s40, s40, s41
  s_lshl_b32 s41, s20, 7
  s_add_u32 s40, s40, s41
  v_lshl_add_u32 v109, v0, 2, s40
  s_mov_b32 exec_lo, 0
  v_mov_b32 v109, 2147483392
  s_mov_b64 exec, -1
  ds_read_b128 v[116:119], v85 offset:20480
  ds_read_b128 v[120:123], v85 offset:21504
  s_mov_b32 s25, 0
  s_and_b32 s40, s25, 3
  s_lshl_b32 s40, s40, 16
  s_add_u32 s27, s40, s26
  s_add_u32 s27, s27, 1048576
  s_xor_b32 s37, s27, s36
  s_lshl_b32 s40, s40, 2
  s_add_u32 s28, s40, s26
  s_lshr_b32 s40, s40, 5
  s_and_b32 s40, s40, 0x4000
  s_xor_b32 s28, s28, s40
  s_xor_b32 s29, s28, 0x4000
  s_xor_b32 s40, s29, 0
  buffer_load_dword v89, v92, s[4:7], s40 offen sc1
  s_xor_b32 s40, s27, 8192
  buffer_load_dword v89, v109, s[4:7], s40 offen sc1
  s_mov_b32 s25, 1
  s_and_b32 s40, s25, 3
  s_lshl_b32 s40, s40, 16
  s_add_u32 s27, s40, s26
  s_add_u32 s27, s27, 1048576
  s_xor_b32 s37, s27, s36
  s_lshl_b32 s40, s40, 2
  s_add_u32 s28, s40, s26
  s_lshr_b32 s40, s40, 5
  s_and_b32 s40, s40, 0x4000
  s_xor_b32 s28, s28, s40
  s_xor_b32 s29, s28, 0x4000
  s_xor_b32 s40, s29, 0
  buffer_load_dword v89, v92, s[4:7], s40 offen sc1
  s_xor_b32 s40, s27, 8192
  buffer_load_dword v89, v109, s[4:7], s40 offen sc1
  s_mov_b32 s25, 2
  s_and_b32 s40, s25, 3
  s_lshl_b32 s40, s40, 16
  s_add_u32 s27, s40, s26
  s_add_u32 s27, s27, 1048576
  s_xor_b32 s37, s27, s36
  s_lshl_b32 s40, s40, 2
  s_add_u32 s28, s40, s26
  s_lshr_b32 s40, s40, 5
  s_and_b32 s40, s40, 0x4000
  s_xor_b32 s28, s28, s40
  s_xor_b32 s29, s28, 0x4000
  s_xor_b32 s40, s29, 0
  buffer_load_dword v89, v92, s[4:7], s40 offen sc1
  s_xor_b32 s40, s27, 8192
  buffer_load_dword v89, v109, s[4:7], s40 offen sc1
  s_mov_b32 s25, 3
  s_and_b32 s40, s25, 3
  s_lshl_b32 s40, s40, 16
  s_add_u32 s27, s40, s26
  s_add_u32 s27, s27, 1048576
  s_xor_b32 s37, s27, s36
  s_lshl_b32 s40, s40, 2
  s_add_u32 s28, s40, s26
  s_lshr_b32 s40, s40, 5
  s_and_b32 s40, s40, 0x4000
  s_xor_b32 s28, s28, s40
  s_xor_b32 s29, s28, 0x4000
  s_xor_b32 s40, s29, 0
  buffer_load_dword v89, v92, s[4:7], s40 offen sc1
  s_xor_b32 s40, s27, 8192
  buffer_load_dword v89, v109, s[4:7], s40 offen sc1
  buffer_load_dword v89, v90, s[4:7], 0 offen offset:2048 sc1
  s_mov_b32 s25, 0
  v_mov_b64 v[52:53], 0
  v_mov_b64 v[54:55], 0
  v_mov_b64 v[56:57], 0
  v_mov_b64 v[58:59], 0
  ds_read_b128 v[20:23], v85 offset:0
  ds_read_b128 v[24:27], v85 offset:1024
  ds_read_b128 v[28:31], v85 offset:8192
  ds_read_b128 v[32:35], v85 offset:9216
  ds_read_b128 v[36:39], v85 offset:2048
  ds_read_b128 v[40:43], v85 offset:3072
  ds_read_b128 v[44:47], v85 offset:10240
  ds_read_b128 v[48:51], v85 offset:11264
L_VO_top:
  s_and_b32 s40, s25, 3
  s_lshl_b32 s40, s40, 16
  s_add_u32 s27, s40, s26
  s_add_u32 s27, s27, 1048576
  s_xor_b32 s37, s27, s36
  s_lshl_b32 s40, s40, 2
  s_add_u32 s28, s40, s26
  s_lshr_b32 s40, s40, 5
  s_and_b32 s40, s40, 0x4000
  s_xor_b32 s28, s28, s40
  s_xor_b32 s29, s28, 0x4000
  s_sleep 4
L_VO_retry:
  buffer_load_dwordx4 v[4:7], v86, s[4:7], s37 offen offset:0 sc1
  s_nop 0
  buffer_load_dwordx4 v[8:11], v86, s[4:7], s37 offen offset:2048 sc1
  s_nop 0
  s_waitcnt vmcnt(1) lgkmcnt(0)
  buffer_load_dwordx4 v[68:71], v87, s[4:7], s27 offen offset:0 sc1
  buffer_load_dwordx4 v[72:75], v87, s[4:7], s27 offen offset:2048 sc1
  v_smfmac_f32_16x16x64_bf16 v[52:55], v[4:7], v[128:135], v88
  ds_write_b128 v1, v[4:7] offset:0
  v_max3_u32 v89, v4, v5, v6
  v_smfmac_f32_16x16x64_bf16 v[56:59], v[4:7], v[20:27], v88
  v_max3_u32 v89, v6, v7, v89
  s_waitcnt vmcnt(2)
  ds_write_b128 v1, v[8:11] offset:1024
  v_max3_u32 v89, v8, v9, v89
  v_max3_u32 v89, v10, v11, v89
  v_cmp_eq_u32 vcc, -1, v89
  s_cbranch_vccnz L_VO_bad
  s_waitcnt lgkmcnt(0)
  s_barrier
  ds_read_b128 v[12:15], v2 offset:0
  ds_read_b128 v[16:19], v2 offset:1024
  v_smfmac_f32_16x16x64_bf16 v[52:55], v[8:11], v[136:143], v88
  ds_read_b128 v[4:7], v3 offset:0
  ds_read_b128 v[20:23], v85 offset:4096
  v_smfmac_f32_16x16x64_bf16 v[56:59], v[8:11], v[28:35], v88
  ds_read_b128 v[24:27], v85 offset:5120
  s_waitcnt lgkmcnt(4)
  v_smfmac_f32_16x16x64_bf16 v[52:55], v[12:15], v[144:151], v88
  ds_read_b128 v[8:11], v3 offset:1024
  ds_read_b128 v[28:31], v85 offset:12288
  v_smfmac_f32_16x16x64_bf16 v[56:59], v[12:15], v[36:43], v88
  ds_read_b128 v[32:35], v85 offset:13312
  s_waitcnt lgkmcnt(6)
  v_smfmac_f32_16x16x64_bf16 v[52:55], v[16:19], v[152:159], v88
  ds_read_b128 v[12:15], v84 offset:0
  ds_read_b128 v[36:39], v85 offset:6144
  v_smfmac_f32_16x16x64_bf16 v[56:59], v[16:19], v[44:51], v88
  ds_read_b128 v[40:43], v85 offset:7168
  s_waitcnt lgkmcnt(6)
  v_smfmac_f32_16x16x64_bf16 v[52:55], v[4:7], v[160:167], v88
  ds_read_b128 v[16:19], v84 offset:1024
  ds_read_b128 v[44:47], v85 offset:14336
  v_smfmac_f32_16x16x64_bf16 v[56:59], v[4:7], v[20:27], v88
  ds_read_b128 v[48:51], v85 offset:15360
  s_waitcnt lgkmcnt(6)
  v_smfmac_f32_16x16x64_bf16 v[52:55], v[8:11], v[168:175], v88
  ds_read_b128 v[20:23], v85 offset:16384
  v_smfmac_f32_16x16x64_bf16 v[56:59], v[8:11], v[28:35], v88
  ds_read_b128 v[24:27], v85 offset:17408
  s_waitcnt lgkmcnt(5)
  v_smfmac_f32_16x16x64_bf16 v[52:55], v[12:15], v[176:183], v88
  ds_read_b128 v[28:31], v85 offset:24576
  v_smfmac_f32_16x16x64_bf16 v[56:59], v[12:15], v[36:43], v88
  ds_read_b128 v[32:35], v85 offset:25600
  s_waitcnt lgkmcnt(4)
  s_nop 0
  s_waitcnt vmcnt(0)
  ds_write_b128 v1, v[68:71] offset:2048
  v_smfmac_f32_16x16x64_bf16 v[52:55], v[16:19], v[184:191], v88
  ds_write_b128 v1, v[72:75] offset:3072
  v_max3_u32 v89, v68, v69, v70
  v_max3_u32 v89, v70, v71, v89
  v_max3_u32 v89, v72, v73, v89
  v_smfmac_f32_16x16x64_bf16 v[56:59], v[16:19], v[44:51], v88
  v_max3_u32 v89, v74, v75, v89
  v_cmp_eq_u32_e64 vcc, -1, v89
  ds_read_b128 v[36:39], v85 offset:18432
  ds_read_b128 v[40:43], v85 offset:19456
  s_cbranch_vccnz L_VO_rbad
L_VO_rok:
  s_waitcnt lgkmcnt(6)
  s_waitcnt lgkmcnt(2)
  s_barrier
  v_smfmac_f32_16x16x64_bf16 v[52:55], v[68:71], v[192:199], v88
  ds_read_b128 v[12:15], v2 offset:2048
  ds_read_b128 v[16:19], v2 offset:3072
  v_smfmac_f32_16x16x64_bf16 v[56:59], v[68:71], v[20:27], v88
  ds_read_b128 v[44:47], v85 offset:26624
  ds_read_b128 v[48:51], v85 offset:27648
  v_smfmac_f32_16x16x64_bf16 v[52:55], v[72:75], v[200:207], v88
  ds_read_b128 v[4:7], v3 offset:2048
  v_smfmac_f32_16x16x64_bf16 v[56:59], v[72:75], v[28:35], v88
  s_waitcnt lgkmcnt(4)
  v_smfmac_f32_16x16x64_bf16 v[52:55], v[12:15], v[208:215], v88
  ds_read_b128 v[8:11], v3 offset:3072
  ds_read_b128 v[28:31], v85 offset:28672
  v_smfmac_f32_16x16x64_bf16 v[56:59], v[12:15], v[36:43], v88
  ds_read_b128 v[32:35], v85 offset:29696
  s_waitcnt lgkmcnt(4)
  v_smfmac_f32_16x16x64_bf16 v[52:55], v[16:19], v[216:223], v88
  ds_read_b128 v[12:15], v84 offset:2048
  ds_read_b128 v[36:39], v85 offset:22528
  v_smfmac_f32_16x16x64_bf16 v[56:59], v[16:19], v[44:51], v88
  ds_read_b128 v[40:43], v85 offset:23552
  s_waitcnt lgkmcnt(6)
  v_smfmac_f32_16x16x64_bf16 v[52:55], v[4:7], v[224:231], v88
  ds_read_b128 v[16:19], v84 offset:3072
  ds_read_b128 v[44:47], v85 offset:30720
  v_smfmac_f32_16x16x64_bf16 v[56:59], v[4:7], v[116:123], v88
  ds_read_b128 v[48:51], v85 offset:31744
  s_waitcnt lgkmcnt(6)
  v_smfmac_f32_16x16x64_bf16 v[52:55], v[8:11], v[232:239], v88
  v_smfmac_f32_16x16x64_bf16 v[56:59], v[8:11], v[28:35], v88
  s_waitcnt lgkmcnt(3)
  v_smfmac_f32_16x16x64_bf16 v[52:55], v[12:15], v[240:247], v88
  v_smfmac_f32_16x16x64_bf16 v[56:59], v[12:15], v[36:43], v88
  s_waitcnt lgkmcnt(0)
  v_smfmac_f32_16x16x64_bf16 v[52:55], v[16:19], v[248:255], v88
  v_smfmac_f32_16x16x64_bf16 v[56:59], v[16:19], v[44:51], v88
  s_nop 6
  v_pk_add_f32 v[52:53], v[52:53], v[54:55]
  v_pk_add_f32 v[56:57], v[56:57], v[58:59]
  v_cvt_pk_bf16_f32 v100, v52, v53
  v_cvt_pk_bf16_f32 v101, v56, v57
  s_cmp_eq_u32 s36, 0
  s_cbranch_scc1 Lwt_80
  buffer_store_dwordx2 v[100:101], v92, s[4:7], s29 offen
  s_branch Lwtd_81
Lwt_80:
  buffer_store_dwordx2 v[100:101], v92, s[4:7], s29 offen sc1
Lwtd_81:
  s_cmp_ge_u32 s25, 63
  s_nop 0
  s_cbranch_scc1 L_VO_end
  s_add_u32 s42, s28, s58
  s_xor_b32 s30, s42, s36
  s_xor_b32 s31, s30, 4096
  s_xor_b32 s32, s42, 131072
  s_xor_b32 s48, s32, 4096
  s_add_u32 s41, s25, 1
  v_mov_b32 v94, s41
  s_and_b32 s41, s41, 3
  s_lshl_b32 s41, s41, 16
  s_add_u32 s33, s41, s26
  s_add_u32 s33, s33, 1048576
  s_xor_b32 s49, s33, 8192
  s_xor_b32 s34, s33, 0x20000
  s_xor_b32 s35, s29, 0x84000
  buffer_store_dword v80, v109, s[4:7], s34 offen sc1
  s_xor_b32 s40, s34, 8192
  buffer_store_dword v80, v109, s[4:7], s40 offen
  s_cmp_eq_u32 s36, 0
  s_cbranch_scc1 Lwt_82
  buffer_store_dwordx2 v[80:81], v92, s[4:7], s35 offen
  s_branch Lwtd_83
Lwt_82:
  buffer_store_dwordx2 v[80:81], v92, s[4:7], s35 offen sc1
Lwtd_83:
  v_mov_b64 v[60:61], 0
  v_mov_b64 v[62:63], 0
  v_mov_b64 v[64:65], 0
  v_mov_b64 v[66:67], 0
  v_mov_b64 v[52:53], 0
  v_mov_b64 v[54:55], 0
  v_mov_b64 v[56:57], 0
  v_mov_b64 v[58:59], 0
  ds_read_b128 v[20:23], v85 offset:0
  ds_read_b128 v[24:27], v85 offset:1024
  ds_read_b128 v[28:31], v85 offset:8192
  ds_read_b128 v[32:35], v85 offset:9216
  ds_read_b128 v[36:39], v85 offset:2048
  ds_read_b128 v[40:43], v85 offset:3072
  ds_read_b128 v[44:47], v85 offset:10240
  ds_read_b128 v[48:51], v85 offset:11264
  s_cmp_eq_u32 s36, 0
  s_cbranch_scc1 Ltrigd_85
  s_mov_b64 exec, 0xffff
  s_sleep 5
  buffer_load_dword v76, v90, s[4:7], 0 offen offset:2048 sc1
  s_sleep 1
  buffer_load_dword v77, v90, s[4:7], 0 offen offset:2048 sc1
  s_sleep 1
  buffer_load_dword v78, v90, s[4:7], 0 offen offset:2048 sc1
  s_sleep 1
Ltrig_84:
  s_sub_u32 s24, s24, 1
  s_cbranch_scc1 L_FAIL
  buffer_load_dword v79, v90, s[4:7], 0 offen offset:2048 sc1
  s_waitcnt vmcnt(3)
  v_cmp_gt_i32_e64 vcc, s25, v76
  s_cbranch_vccz Ltrigd_85
  buffer_load_dword v76, v90, s[4:7], 0 offen offset:2048 sc1
  s_waitcnt vmcnt(3)
  v_cmp_gt_i32 vcc, s25, v77
  s_cbranch_vccz Ltrigd_85
  buffer_load_dword v77, v90, s[4:7], 0 offen offset:2048 sc1
  s_waitcnt vmcnt(3)
  v_cmp_gt_i32 vcc, s25, v78
  s_cbranch_vccz Ltrigd_85
  buffer_load_dword v78, v90, s[4:7], 0 offen offset:2048 sc1
  s_waitcnt vmcnt(3)
  v_cmp_gt_i32_e64 vcc, s25, v79
  s_cbranch_vccnz Ltrig_84
Ltrigd_85:
  s_mov_b64 exec, -1
L_VOO_again:
  buffer_load_dwordx4 v[4:7], v110, s[4:7], s30 offen sc1
  s_nop 0
  buffer_load_dwordx4 v[8:11], v111, s[4:7], s30 offen sc1
  s_nop 0
  buffer_load_dwordx4 v[12:15], v112, s[4:7], s30 offen sc1
  s_nop 0
  buffer_load_dwordx4 v[16:19], v113, s[4:7], s30 offen sc1
  s_nop 0
  buffer_load_dwordx4 v[68:71], v110, s[4:7], s31 offen sc1
  s_nop 0
  buffer_load_dwordx4 v[72:75], v111, s[4:7], s31 offen sc1
  s_nop 0
  s_nop 0
  s_waitcnt vmcnt(5)
  v_cmp_eq_u32_e64 vcc, -1, v4
  s_cbranch_vccnz L_VOO_g0
L_VOO_ok0:
  buffer_load_dwordx4 v[96:99], v112, s[4:7], s31 offen sc1
  v_smfmac_f32_16x16x64_bf16 v[60:63], v[4:7], a[0:7], v88
  s_waitcnt vmcnt(5)
  v_cmp_eq_u32 vcc, -1, v8
  v_smfmac_f32_16x16x64_bf16 v[64:67], v[4:7], a[8:15], v88
  s_cbranch_vccnz L_VOO_g1
L_VOO_ok1:
  buffer_load_dwordx4 v[4:7], v113, s[4:7], s31 offen sc1
  v_smfmac_f32_16x16x64_bf16 v[60:63], v[8:11], a[16:23], v88
  s_waitcnt vmcnt(5)
  v_cmp_eq_u32 vcc, -1, v12
  v_smfmac_f32_16x16x64_bf16 v[64:67], v[8:11], a[24:31], v88
  s_cbranch_vccnz L_VOO_g2
L_VOO_ok2:
  buffer_load_dwordx4 v[8:11], v110, s[4:7], s32 offen sc1
  v_smfmac_f32_16x16x64_bf16 v[60:63], v[12:15], a[32:39], v88
  s_waitcnt vmcnt(5)
  v_cmp_eq_u32 vcc, -1, v16
  v_smfmac_f32_16x16x64_bf16 v[64:67], v[12:15], a[40:47], v88
  s_cbranch_vccnz L_VOO_g3
L_VOO_ok3:
  buffer_load_dwordx4 v[12:15], v111, s[4:7], s32 offen sc1
  v_smfmac_f32_16x16x64_bf16 v[60:63], v[16:19], a[48:55], v88
  s_waitcnt vmcnt(5)
  v_cmp_eq_u32 vcc, -1, v68
  v_smfmac_f32_16x16x64_bf16 v[64:67], v[16:19], a[56:63], v88
  s_cbranch_vccnz L_VOO_g4
L_VOO_ok4:
  buffer_load_dwordx4 v[16:19], v112, s[4:7], s32 offen sc1
  v_smfmac_f32_16x16x64_bf16 v[60:63], v[68:71], a[64:71], v88
  s_waitcnt vmcnt(5)
  v_cmp_eq_u32 vcc, -1, v72
  v_smfmac_f32_16x16x64_bf16 v[64:67], v[68:71], a[72:79], v88
  s_cbranch_vccnz L_VOO_g5
L_VOO_ok5:
  buffer_load_dwordx4 v[68:71], v113, s[4:7], s32 offen sc1
  v_smfmac_f32_16x16x64_bf16 v[60:63], v[72:75], a[80:87], v88
  s_nop 0
  s_waitcnt vmcnt(5)
  v_cmp_eq_u32_e64 vcc, -1, v96
  v_smfmac_f32_16x16x64_bf16 v[64:67], v[72:75], a[88:95], v88
  s_cbranch_vccnz L_VOO_g6
L_VOO_ok6:
  buffer_load_dwordx4 v[72:75], v110, s[4:7], s48 offen sc1
  v_smfmac_f32_16x16x64_bf16 v[60:63], v[96:99], a[96:103], v88
  s_waitcnt vmcnt(5)
  v_cmp_eq_u32 vcc, -1, v4
  v_smfmac_f32_16x16x64_bf16 v[64:67], v[96:99], a[104:111], v88
  s_cbranch_vccnz L_VOO_g7
L_VOO_ok7:
  buffer_load_dwordx4 v[96:99], v111, s[4:7], s48 offen sc1
  v_smfmac_f32_16x16x64_bf16 v[60:63], v[4:7], a[112:119], v88
  s_waitcnt vmcnt(5)
  v_cmp_eq_u32 vcc, -1, v8
  v_smfmac_f32_16x16x64_bf16 v[64:67], v[4:7], a[120:127], v88
  s_cbranch_vccnz L_VOO_g8
L_VOO_ok8:
  buffer_load_dwordx4 v[4:7], v112, s[4:7], s48 offen sc1
  v_smfmac_f32_16x16x64_bf16 v[60:63], v[8:11], a[128:135], v88
  s_waitcnt vmcnt(5)
  v_cmp_eq_u32 vcc, -1, v12
  v_smfmac_f32_16x16x64_bf16 v[64:67], v[8:11], a[136:143], v88
  s_cbranch_vccnz L_VOO_g9
L_VOO_ok9:
  buffer_load_dwordx4 v[8:11], v113, s[4:7], s48 offen sc1
  v_smfmac_f32_16x16x64_bf16 v[60:63], v[12:15], a[144:151], v88
  s_waitcnt vmcnt(5)
  v_cmp_eq_u32 vcc, -1, v16
  v_smfmac_f32_16x16x64_bf16 v[64:67], v[12:15], a[152:159], v88
  s_cbranch_vccnz L_VOO_g10
L_VOO_ok10:
  v_smfmac_f32_16x16x64_bf16 v[60:63], v[16:19], a[160:167], v88
  s_waitcnt vmcnt(4)
  v_cmp_eq_u32 vcc, -1, v68
  v_smfmac_f32_16x16x64_bf16 v[64:67], v[16:19], a[168:175], v88
  s_cbranch_vccnz L_VOO_g11
L_VOO_ok11:
  v_smfmac_f32_16x16x64_bf16 v[60:63], v[68:71], a[176:183], v88
  s_waitcnt vmcnt(3)
  v_cmp_eq_u32 vcc, -1, v72
  v_smfmac_f32_16x16x64_bf16 v[64:67], v[68:71], a[184:191], v88
  s_cbranch_vccnz L_VOO_g12
L_VOO_ok12:
  v_smfmac_f32_16x16x64_bf16 v[60:63], v[72:75], a[192:199], v88
  s_waitcnt vmcnt(2)
  v_cmp_eq_u32 vcc, -1, v96
  v_smfmac_f32_16x16x64_bf16 v[64:67], v[72:75], a[200:207], v88
  s_cbranch_vccnz L_VOO_g13
L_VOO_ok13:
  v_smfmac_f32_16x16x64_bf16 v[60:63], v[96:99], a[208:215], v88
  s_waitcnt vmcnt(1)
  v_cmp_eq_u32 vcc, -1, v4
  v_smfmac_f32_16x16x64_bf16 v[64:67], v[96:99], a[216:223], v88
  s_cbranch_vccnz L_VOO_g14
L_VOO_ok14:
  v_smfmac_f32_16x16x64_bf16 v[60:63], v[4:7], a[224:231], v88
  s_waitcnt vmcnt(0)
  v_cmp_eq_u32_e64 vcc, -1, v8
  v_smfmac_f32_16x16x64_bf16 v[64:67], v[4:7], a[232:239], v88
  s_cbranch_vccnz L_VOO_g15
L_VOO_ok15:
  v_smfmac_f32_16x16x64_bf16 v[60:63], v[8:11], a[240:247], v88
  v_smfmac_f32_16x16x64_bf16 v[64:67], v[8:11], a[248:255], v88
  s_nop 6
  v_add_f32 v100, v60, v62
  v_add_f32 v102, v61, v63
  v_add_f32 v101, v64, v66
  v_add_f32 v103, v65, v67
  ds_write_b128 v95, v[100:103]
  v_cmp_u_f32 vcc, v100, v102
  s_cbranch_vccnz L_VOO_nan
L_VOO_done:
  buffer_store_dword v94, v91, s[4:7], s57 offen
  s_waitcnt lgkmcnt(0)
  s_barrier
  ds_read2st64_b64 v[100:103], v108 offset0:0 offset1:2
  ds_read2st64_b64 v[104:107], v108 offset0:4 offset1:6
  s_waitcnt lgkmcnt(1)
  v_pk_add_f32 v[100:101], v[100:101], v[102:103]
  s_waitcnt lgkmcnt(0)
  v_pk_add_f32 v[104:105], v[104:105], v[106:107]
  v_pk_add_f32 v[100:101], v[100:101], v[104:105]
  v_cvt_pk_bf16_f32 v100, v100, v101
  buffer_store_dword v100, v109, s[4:7], s49 offen
  buffer_store_dword v100, v109, s[4:7], s33 offen sc1
  s_add_u32 s25, s25, 1
  s_branch L_VO_top
L_VO_end:
  s_branch L_END
L_VO_bad:
  s_nop 7
  s_sub_u32 s24, s24, 1
  s_cbranch_scc1 L_FAIL
  s_add_u32 s60, s60, 1
  v_mov_b64 v[52:53], 0
  v_mov_b64 v[54:55], 0
  v_mov_b64 v[56:57], 0
  v_mov_b64 v[58:59], 0
  s_nop 1
  s_branch L_VO_retry
L_VO_rbad:
  s_sub_u32 s24, s24, 1
  s_cbranch_scc1 L_FAIL
  s_add_u32 s60, s60, 0x10000
  s_waitcnt lgkmcnt(0)
  buffer_load_dwordx4 v[68:71], v87, s[4:7], s27 offen offset:0 sc1
  buffer_load_dwordx4 v[72:75], v87, s[4:7], s27 offen offset:2048 sc1
  s_waitcnt vmcnt(0)
  ds_write_b128 v1, v[68:71] offset:2048
  ds_write_b128 v1, v[72:75] offset:3072
  v_max3_u32 v89, v68, v69, v70
  v_max3_u32 v89, v70, v71, v89
  v_max3_u32 v89, v72, v73, v89
  v_max3_u32 v89, v74, v75, v89
  v_cmp_eq_u32 vcc, -1, v89
  s_waitcnt lgkmcnt(0)
  s_cbranch_vccnz L_VO_rbad
  s_branch L_VO_rok
L_VOO_nan:
  s_cmp_eq_u32 s51, s25
  s_cbranch_scc1 L_VOO_done
  s_mov_b32 s51, s25
  s_add_u32 s61, s61, 0x10000
  s_waitcnt vmcnt(0) lgkmcnt(0)
L_VOO_v0:
  s_sub_u32 s24, s24, 1
  s_cbranch_scc1 L_FAIL
  buffer_load_dwordx4 v[4:7], v110, s[4:7], s30 offen sc1
  buffer_load_dwordx4 v[8:11], v111, s[4:7], s30 offen sc1
  buffer_load_dwordx4 v[12:15], v112, s[4:7], s30 offen sc1
  buffer_load_dwordx4 v[16:19], v113, s[4:7], s30 offen sc1
  v_mov_b32 v89, 0
  s_waitcnt vmcnt(0)
  v_max3_u32 v89, v4, v5, v89
  v_max3_u32 v89, v6, v7, v89
  v_max3_u32 v89, v8, v9, v89
  v_max3_u32 v89, v10, v11, v89
  v_max3_u32 v89, v12, v13, v89
  v_max3_u32 v89, v14, v15, v89
  v_max3_u32 v89, v16, v17, v89
  v_max3_u32 v89, v18, v19, v89
  v_cmp_eq_u32 vcc, -1, v89
  s_cbranch_vccnz L_VOO_v0
L_VOO_v4:
  s_sub_u32 s24, s24, 1
  s_cbranch_scc1 L_FAIL
  buffer_load_dwordx4 v[68:71], v110, s[4:7], s31 offen sc1
  buffer_load_dwordx4 v[72:75], v111, s[4:7], s31 offen sc1
  buffer_load_dwordx4 v[96:99], v112, s[4:7], s31 offen sc1
  buffer_load_dwordx4 v[4:7], v113, s[4:7], s31 offen sc1
  v_mov_b32 v89, 0
  s_waitcnt vmcnt(0)
  v_max3_u32 v89, v68, v69, v89
  v_max3_u32 v89, v70, v71, v89
  v_max3_u32 v89, v72, v73, v89
  v_max3_u32 v89, v74, v75, v89
  v_max3_u32 v89, v96, v97, v89
  v_max3_u32 v89, v98, v99, v89
  v_max3_u32 v89, v4, v5, v89
  v_max3_u32 v89, v6, v7, v89
  v_cmp_eq_u32 vcc, -1, v89
  s_cbranch_vccnz L_VOO_v4
L_VOO_v8:
  s_sub_u32 s24, s24, 1
  s_cbranch_scc1 L_FAIL
  buffer_load_dwordx4 v[8:11], v110, s[4:7], s32 offen sc1
  buffer_load_dwordx4 v[12:15], v111, s[4:7], s32 offen sc1
  buffer_load_dwordx4 v[16:19], v112, s[4:7], s32 offen sc1
  buffer_load_dwordx4 v[68:71], v113, s[4:7], s32 offen sc1
  v_mov_b32 v89, 0
  s_waitcnt vmcnt(0)
  v_max3_u32 v89, v8, v9, v89
  v_max3_u32 v89, v10, v11, v89
  v_max3_u32 v89, v12, v13, v89
  v_max3_u32 v89, v14, v15, v89
  v_max3_u32 v89, v16, v17, v89
  v_max3_u32 v89, v18, v19, v89
  v_max3_u32 v89, v68, v69, v89
  v_max3_u32 v89, v70, v71, v89
  v_cmp_eq_u32 vcc, -1, v89
  s_cbranch_vccnz L_VOO_v8
L_VOO_v12:
  s_sub_u32 s24, s24, 1
  s_cbranch_scc1 L_FAIL
  buffer_load_dwordx4 v[72:75], v110, s[4:7], s48 offen sc1
  buffer_load_dwordx4 v[96:99], v111, s[4:7], s48 offen sc1
  buffer_load_dwordx4 v[4:7], v112, s[4:7], s48 offen sc1
  buffer_load_dwordx4 v[8:11], v113, s[4:7], s48 offen sc1
  v_mov_b32 v89, 0
  s_waitcnt vmcnt(0)
  v_max3_u32 v89, v72, v73, v89
  v_max3_u32 v89, v74, v75, v89
  v_max3_u32 v89, v96, v97, v89
  v_max3_u32 v89, v98, v99, v89
  v_max3_u32 v89, v4, v5, v89
  v_max3_u32 v89, v6, v7, v89
  v_max3_u32 v89, v8, v9, v89
  v_max3_u32 v89, v10, v11, v89
  v_cmp_eq_u32 vcc, -1, v89
  s_cbranch_vccnz L_VOO_v12
  v_mov_b64 v[60:61], 0
  v_mov_b64 v[62:63], 0
  v_mov_b64 v[64:65], 0
  v_mov_b64 v[66:67], 0
  s_nop 1
  s_branch L_VOO_again
L_VOO_g0:
  s_sub_u32 s24, s24, 1
  s_cbranch_scc1 L_FAIL
  s_add_u32 s61, s61, 1
  buffer_load_dwordx4 v[4:7], v110, s[4:7], s30 offen sc1
  s_waitcnt vmcnt(0)
  v_cmp_eq_u32 vcc, -1, v4
  s_cbranch_vccnz L_VOO_g0
  v_mov_b32 v89, 0
  v_max3_u32 v89, v8, v12, v89
  v_max3_u32 v89, v16, v68, v89
  v_max3_u32 v89, v72, v72, v89
  v_cmp_eq_u32 vcc, -1, v89
  s_cbranch_vccz L_VOO_ok0
  buffer_load_dwordx4 v[8:11], v111, s[4:7], s30 offen sc1
  s_nop 0
  buffer_load_dwordx4 v[12:15], v112, s[4:7], s30 offen sc1
  s_nop 0
  buffer_load_dwordx4 v[16:19], v113, s[4:7], s30 offen sc1
  s_nop 0
  buffer_load_dwordx4 v[68:71], v110, s[4:7], s31 offen sc1
  s_nop 0
  buffer_load_dwordx4 v[72:75], v111, s[4:7], s31 offen sc1
  s_nop 0
  s_branch L_VOO_ok0
L_VOO_g1:
  s_sub_u32 s24, s24, 1
  s_cbranch_scc1 L_FAIL
  s_add_u32 s61, s61, 1
  buffer_load_dwordx4 v[8:11], v111, s[4:7], s30 offen sc1
  s_waitcnt vmcnt(0)
  v_cmp_eq_u32 vcc, -1, v8
  s_cbranch_vccnz L_VOO_g1
  v_mov_b32 v89, 0
  v_max3_u32 v89, v12, v16, v89
  v_max3_u32 v89, v68, v72, v89
  v_max3_u32 v89, v96, v96, v89
  v_cmp_eq_u32 vcc, -1, v89
  s_cbranch_vccz L_VOO_ok1
  buffer_load_dwordx4 v[12:15], v112, s[4:7], s30 offen sc1
  s_nop 0
  buffer_load_dwordx4 v[16:19], v113, s[4:7], s30 offen sc1
  s_nop 0
  buffer_load_dwordx4 v[68:71], v110, s[4:7], s31 offen sc1
  s_nop 0
  buffer_load_dwordx4 v[72:75], v111, s[4:7], s31 offen sc1
  s_nop 0
  buffer_load_dwordx4 v[96:99], v112, s[4:7], s31 offen sc1
  s_nop 0
  s_branch L_VOO_ok1
L_VOO_g2:
  s_sub_u32 s24, s24, 1
  s_cbranch_scc1 L_FAIL
  s_add_u32 s61, s61, 1
  buffer_load_dwordx4 v[12:15], v112, s[4:7], s30 offen sc1
  s_waitcnt vmcnt(0)
  v_cmp_eq_u32 vcc, -1, v12
  s_cbranch_vccnz L_VOO_g2
  v_mov_b32 v89, 0
  v_max3_u32 v89, v16, v68, v89
  v_max3_u32 v89, v72, v96, v89
  v_max3_u32 v89, v4, v4, v89
  v_cmp_eq_u32 vcc, -1, v89
  s_cbranch_vccz L_VOO_ok2
  buffer_load_dwordx4 v[16:19], v113, s[4:7], s30 offen sc1
  s_nop 0
  buffer_load_dwordx4 v[68:71], v110, s[4:7], s31 offen sc1
  s_nop 0
  buffer_load_dwordx4 v[72:75], v111, s[4:7], s31 offen sc1
  s_nop 0
  buffer_load_dwordx4 v[96:99], v112, s[4:7], s31 offen sc1
  s_nop 0
  buffer_load_dwordx4 v[4:7], v113, s[4:7], s31 offen sc1
  s_nop 0
  s_branch L_VOO_ok2
L_VOO_g3:
  s_sub_u32 s24, s24, 1
  s_cbranch_scc1 L_FAIL
  s_add_u32 s61, s61, 1
  buffer_load_dwordx4 v[16:19], v113, s[4:7], s30 offen sc1
  s_waitcnt vmcnt(0)
  v_cmp_eq_u32 vcc, -1, v16
  s_cbranch_vccnz L_VOO_g3
  v_mov_b32 v89, 0
  v_max3_u32 v89, v68, v72, v89
  v_max3_u32 v89, v96, v4, v89
  v_max3_u32 v89, v8, v8, v89
  v_cmp_eq_u32 vcc, -1, v89
  s_cbranch_vccz L_VOO_ok3
  buffer_load_dwordx4 v[68:71], v110, s[4:7], s31 offen sc1
  s_nop 0
  buffer_load_dwordx4 v[72:75], v111, s[4:7], s31 offen sc1
  s_nop 0
  buffer_load_dwordx4 v[96:99], v112, s[4:7], s31 offen sc1
  s_nop 0
  buffer_load_dwordx4 v[4:7], v113, s[4:7], s31 offen sc1
  s_nop 0
  buffer_load_dwordx4 v[8:11], v110, s[4:7], s32 offen sc1
  s_nop 0
  s_branch L_VOO_ok3
L_VOO_g4:
  s_sub_u32 s24, s24, 1
  s_cbranch_scc1 L_FAIL
  s_add_u32 s61, s61, 1
  buffer_load_dwordx4 v[68:71], v110, s[4:7], s31 offen sc1
  s_waitcnt vmcnt(0)
  v_cmp_eq_u32 vcc, -1, v68
  s_cbranch_vccnz L_VOO_g4
  v_mov_b32 v89, 0
  v_max3_u32 v89, v72, v96, v89
  v_max3_u32 v89, v4, v8, v89
  v_max3_u32 v89, v12, v12, v89
  v_cmp_eq_u32 vcc, -1, v89
  s_cbranch_vccz L_VOO_ok4
  buffer_load_dwordx4 v[72:75], v111, s[4:7], s31 offen sc1
  s_nop 0
  buffer_load_dwordx4 v[96:99], v112, s[4:7], s31 offen sc1
  s_nop 0
  buffer_load_dwordx4 v[4:7], v113, s[4:7], s31 offen sc1
  s_nop 0
  buffer_load_dwordx4 v[8:11], v110, s[4:7], s32 offen sc1
  s_nop 0
  buffer_load_dwordx4 v[12:15], v111, s[4:7], s32 offen sc1
  s_nop 0
  s_branch L_VOO_ok4
L_VOO_g5:
  s_sub_u32 s24, s24, 1
  s_cbranch_scc1 L_FAIL
  s_add_u32 s61, s61, 1
  buffer_load_dwordx4 v[72:75], v111, s[4:7], s31 offen sc1
  s_waitcnt vmcnt(0)
  v_cmp_eq_u32 vcc, -1, v72
  s_cbranch_vccnz L_VOO_g5
  v_mov_b32 v89, 0
  v_max3_u32 v89, v96, v4, v89
  v_max3_u32 v89, v8, v12, v89
  v_max3_u32 v89, v16, v16, v89
  v_cmp_eq_u32 vcc, -1, v89
  s_cbranch_vccz L_VOO_ok5
  buffer_load_dwordx4 v[96:99], v112, s[4:7], s31 offen sc1
  s_nop 0
  buffer_load_dwordx4 v[4:7], v113, s[4:7], s31 offen sc1
  s_nop 0
  buffer_load_dwordx4 v[8:11], v110, s[4:7], s32 offen sc1
  s_nop 0
  buffer_load_dwordx4 v[12:15], v111, s[4:7], s32 offen sc1
  s_nop 0
  buffer_load_dwordx4 v[16:19], v112, s[4:7], s32 offen sc1
  s_nop 0
  s_branch L_VOO_ok5
L_VOO_g6:
  s_sub_u32 s24, s24, 1
  s_cbranch_scc1 L_FAIL
  s_add_u32 s61, s61, 1
  buffer_load_dwordx4 v[96:99], v112, s[4:7], s31 offen sc1
  s_waitcnt vmcnt(0)
  v_cmp_eq_u32 vcc, -1, v96
  s_cbranch_vccnz L_VOO_g6
  v_mov_b32 v89, 0
  v_max3_u32 v89, v4, v8, v89
  v_max3_u32 v89, v12, v16, v89
  v_max3_u32 v89, v68, v68, v89
  v_cmp_eq_u32 vcc, -1, v89
  s_cbranch_vccz L_VOO_ok6
  buffer_load_dwordx4 v[4:7], v113, s[4:7], s31 offen sc1
  s_nop 0
  buffer_load_dwordx4 v[8:11], v110, s[4:7], s32 offen sc1
  s_nop 0
  buffer_load_dwordx4 v[12:15], v111, s[4:7], s32 offen sc1
  s_nop 0
  buffer_load_dwordx4 v[16:19], v112, s[4:7], s32 offen sc1
  s_nop 0
  buffer_load_dwordx4 v[68:71], v113, s[4:7], s32 offen sc1
  s_nop 0
  s_branch L_VOO_ok6
L_VOO_g7:
  s_sub_u32 s24, s24, 1
  s_cbranch_scc1 L_FAIL
  s_add_u32 s61, s61, 1
  buffer_load_dwordx4 v[4:7], v113, s[4:7], s31 offen sc1
  s_waitcnt vmcnt(0)
  v_cmp_eq_u32 vcc, -1, v4
  s_cbranch_vccnz L_VOO_g7
  v_mov_b32 v89, 0
  v_max3_u32 v89, v8, v12, v89
  v_max3_u32 v89, v16, v68, v89
  v_max3_u32 v89, v72, v72, v89
  v_cmp_eq_u32 vcc, -1, v89
  s_cbranch_vccz L_VOO_ok7
  buffer_load_dwordx4 v[8:11], v110, s[4:7], s32 offen sc1
  s_nop 0
  buffer_load_dwordx4 v[12:15], v111, s[4:7], s32 offen sc1
  s_nop 0
  buffer_load_dwordx4 v[16:19], v112, s[4:7], s32 offen sc1
  s_nop 0
  buffer_load_dwordx4 v[68:71], v113, s[4:7], s32 offen sc1
  s_nop 0
  buffer_load_dwordx4 v[72:75], v110, s[4:7], s48 offen sc1
  s_nop 0
  s_branch L_VOO_ok7
L_VOO_g8:
  s_sub_u32 s24, s24, 1
  s_cbranch_scc1 L_FAIL
  s_add_u32 s61, s61, 256
  buffer_load_dwordx4 v[8:11], v110, s[4:7], s32 offen sc1
  s_waitcnt vmcnt(0)
  v_cmp_eq_u32 vcc, -1, v8
  s_cbranch_vccnz L_VOO_g8
  v_mov_b32 v89, 0
  v_max3_u32 v89, v12, v16, v89
  v_max3_u32 v89, v68, v72, v89
  v_max3_u32 v89, v96, v96, v89
  v_cmp_eq_u32 vcc, -1, v89
  s_cbranch_vccz L_VOO_ok8
  buffer_load_dwordx4 v[12:15], v111, s[4:7], s32 offen sc1
  s_nop 0
  buffer_load_dwordx4 v[16:19], v112, s[4:7], s32 offen sc1
  s_nop 0
  buffer_load_dwordx4 v[68:71], v113, s[4:7], s32 offen sc1
  s_nop 0
  buffer_load_dwordx4 v[72:75], v110, s[4:7], s48 offen sc1
  s_nop 0
  buffer_load_dwordx4 v[96:99], v111, s[4:7], s48 offen sc1
  s_nop 0
  s_branch L_VOO_ok8
L_VOO_g9:
  s_sub_u32 s24, s24, 1
  s_cbranch_scc1 L_FAIL
  s_add_u32 s61, s61, 256
  buffer_load_dwordx4 v[12:15], v111, s[4:7], s32 offen sc1
  s_waitcnt vmcnt(0)
  v_cmp_eq_u32 vcc, -1, v12
  s_cbranch_vccnz L_VOO_g9
  v_mov_b32 v89, 0
  v_max3_u32 v89, v16, v68, v89
  v_max3_u32 v89, v72, v96, v89
  v_max3_u32 v89, v4, v4, v89
  v_cmp_eq_u32 vcc, -1, v89
  s_cbranch_vccz L_VOO_ok9
  buffer_load_dwordx4 v[16:19], v112, s[4:7], s32 offen sc1
  s_nop 0
  buffer_load_dwordx4 v[68:71], v113, s[4:7], s32 offen sc1
  s_nop 0
  buffer_load_dwordx4 v[72:75], v110, s[4:7], s48 offen sc1
  s_nop 0
  buffer_load_dwordx4 v[96:99], v111, s[4:7], s48 offen sc1
  s_nop 0
  buffer_load_dwordx4 v[4:7], v112, s[4:7], s48 offen sc1
  s_nop 0
  s_branch L_VOO_ok9
L_VOO_g10:
  s_sub_u32 s24, s24, 1
  s_cbranch_scc1 L_FAIL
  s_add_u32 s61, s61, 256
  buffer_load_dwordx4 v[16:19], v112, s[4:7], s32 offen sc1
  s_waitcnt vmcnt(0)
  v_cmp_eq_u32 vcc, -1, v16
  s_cbranch_vccnz L_VOO_g10
  v_mov_b32 v89, 0
  v_max3_u32 v89, v68, v72, v89
  v_max3_u32 v89, v96, v4, v89
  v_max3_u32 v89, v8, v8, v89
  v_cmp_eq_u32 vcc, -1, v89
  s_cbranch_vccz L_VOO_ok10
  buffer_load_dwordx4 v[68:71], v113, s[4:7], s32 offen sc1
  s_nop 0
  buffer_load_dwordx4 v[72:75], v110, s[4:7], s48 offen sc1
  s_nop 0
  buffer_load_dwordx4 v[96:99], v111, s[4:7], s48 offen sc1
  s_nop 0
  buffer_load_dwordx4 v[4:7], v112, s[4:7], s48 offen sc1
  s_nop 0
  buffer_load_dwordx4 v[8:11], v113, s[4:7], s48 offen sc1
  s_nop 0
  s_branch L_VOO_ok10
L_VOO_g11:
  s_sub_u32 s24, s24, 1
  s_cbranch_scc1 L_FAIL
  s_add_u32 s61, s61, 256
  buffer_load_dwordx4 v[68:71], v113, s[4:7], s32 offen sc1
  s_waitcnt vmcnt(0)
  v_cmp_eq_u32 vcc, -1, v68
  s_cbranch_vccnz L_VOO_g11
  v_mov_b32 v89, 0
  v_max3_u32 v89, v72, v96, v89
  v_max3_u32 v89, v4, v8, v89
  v_cmp_eq_u32 vcc, -1, v89
  s_cbranch_vccz L_VOO_ok11
  buffer_load_dwordx4 v[72:75], v110, s[4:7], s48 offen sc1
  s_nop 0
  buffer_load_dwordx4 v[96:99], v111, s[4:7], s48 offen sc1
  s_nop 0
  buffer_load_dwordx4 v[4:7], v112, s[4:7], s48 offen sc1
  s_nop 0
  buffer_load_dwordx4 v[8:11], v113, s[4:7], s48 offen sc1
  s_nop 0
  s_branch L_VOO_ok11
L_VOO_g12:
  s_sub_u32 s24, s24, 1
  s_cbranch_scc1 L_FAIL
  s_add_u32 s61, s61, 256
  buffer_load_dwordx4 v[72:75], v110, s[4:7], s48 offen sc1
  s_waitcnt vmcnt(0)
  v_cmp_eq_u32 vcc, -1, v72
  s_cbranch_vccnz L_VOO_g12
  v_mov_b32 v89, 0
  v_max3_u32 v89, v96, v4, v89
  v_max3_u32 v89, v8, v8, v89
  v_cmp_eq_u32 vcc, -1, v89
  s_cbranch_vccz L_VOO_ok12
  buffer_load_dwordx4 v[96:99], v111, s[4:7], s48 offen sc1
  s_nop 0
  buffer_load_dwordx4 v[4:7], v112, s[4:7], s48 offen sc1
  s_nop 0
  buffer_load_dwordx4 v[8:11], v113, s[4:7], s48 offen sc1
  s_nop 0
  s_branch L_VOO_ok12
L_VOO_g13:
  s_sub_u32 s24, s24, 1
  s_cbranch_scc1 L_FAIL
  s_add_u32 s61, s61, 256
  buffer_load_dwordx4 v[96:99], v111, s[4:7], s48 offen sc1
  s_waitcnt vmcnt(0)
  v_cmp_eq_u32 vcc, -1, v96
  s_cbranch_vccnz L_VOO_g13
  v_mov_b32 v89, 0
  v_max3_u32 v89, v4, v8, v89
  v_cmp_eq_u32 vcc, -1, v89
  s_cbranch_vccz L_VOO_ok13
  buffer_load_dwordx4 v[4:7], v112, s[4:7], s48 offen sc1
  s_nop 0
  buffer_load_dwordx4 v[8:11], v113, s[4:7], s48 offen sc1
  s_nop 0
  s_branch L_VOO_ok13
L_VOO_g14:
  s_sub_u32 s24, s24, 1
  s_cbranch_scc1 L_FAIL
  s_add_u32 s61, s61, 256
  buffer_load_dwordx4 v[4:7], v112, s[4:7], s48 offen sc1
  s_waitcnt vmcnt(0)
  v_cmp_eq_u32 vcc, -1, v4
  s_cbranch_vccnz L_VOO_g14
  v_mov_b32 v89, 0
  v_max3_u32 v89, v8, v8, v89
  v_cmp_eq_u32 vcc, -1, v89
  s_cbranch_vccz L_VOO_ok14
  buffer_load_dwordx4 v[8:11], v113, s[4:7], s48 offen sc1
  s_nop 0
  s_branch L_VOO_ok14
L_VOO_g15:
  s_sub_u32 s24, s24, 1
  s_cbranch_scc1 L_FAIL
  s_add_u32 s61, s61, 256
  buffer_load_dwordx4 v[8:11], v113, s[4:7], s48 offen sc1
  s_waitcnt vmcnt(0)
  v_cmp_eq_u32 vcc, -1, v8
  s_cbranch_vccnz L_VOO_g15
  s_branch L_VOO_ok15
L_LAST:
  s_endpgm
.section .rodata,"a"
.p2align 6
.amdhsa_kernel adaLN_cond__memory_aug_recurrent_mem_tr__glu_gated_swiglu__prompt_kernel
  .amdhsa_next_free_vgpr 512
  .amdhsa_next_free_sgpr 102
  .amdhsa_accum_offset 256
  .amdhsa_group_segment_fixed_size 0
  .amdhsa_kernarg_size 128
  .amdhsa_user_sgpr_count 2
  .amdhsa_user_sgpr_kernarg_segment_ptr 1
  .amdhsa_system_sgpr_workgroup_id_x 1
  .amdhsa_float_denorm_mode_32 3
.end_amdhsa_kernel
```

```asm
; @launch grid=(256,1,1) block=(256,1,1) lds=163840
.amdgcn_target "amdgcn-amd-amdhsa--gfx950"
.text
.globl adaLN_cond__memory_aug_recurrent_mem_tr__glu_gated_swiglu__prompt_kernel
.p2align 8
.type adaLN_cond__memory_aug_recurrent_mem_tr__glu_gated_swiglu__prompt_kernel,@function
adaLN_cond__memory_aug_recurrent_mem_tr__glu_gated_swiglu__prompt_kernel:
  s_cmp_ge_u32 s2, 256
  s_cbranch_scc1 L_END
  s_load_dwordx2 s[4:5], s[0:1], 120
  s_load_dwordx2 s[12:13], s[0:1], 112
  v_lshrrev_b32 v1, 6, v0
  v_and_b32 v0, 63, v0
  v_readfirstlane_b32 s20, v1
  s_mov_b32 s6, 155222016
  s_mov_b32 s7, 0x20000
  s_mov_b32 s14, 256
  s_mov_b32 s15, 0x20000
  s_mov_b32 s24, 300000
  s_and_b32 s40, s2, 7
  s_mov_b32 s42, 0x3020100
  s_mov_b32 s43, 0x3020100
  s_cmp_eq_u32 s40, 1
  s_cselect_b32 s42, 0x1b161514, s42
  s_cselect_b32 s43, 0x1b1a1918, s43
  s_cmp_eq_u32 s40, 2
  s_cselect_b32 s42, 0xb0a0908, s42
  s_cselect_b32 s43, 0xb0a0908, s43
  s_cmp_eq_u32 s40, 3
  s_cselect_b32 s42, 0x1f1e1d1c, s42
  s_cselect_b32 s43, 0x1f1e1d1c, s43
  s_cmp_eq_u32 s40, 4
  s_cselect_b32 s42, 0x7060504, s42
  s_cselect_b32 s43, 0x7060504, s43
  s_cmp_eq_u32 s40, 5
  s_cselect_b32 s42, 0x13121110, s42
  s_cselect_b32 s43, 0x13121110, s43
  s_cmp_eq_u32 s40, 6
  s_cselect_b32 s42, 0xf0e0d0c, s42
  s_cselect_b32 s43, 0xf0e0d0c, s43
  s_cmp_eq_u32 s40, 7
  s_cselect_b32 s42, 0x1a191817, s42
  s_cselect_b32 s43, 0x17161514, s43
  s_lshr_b32 s40, s2, 6
  s_lshl_b32 s40, s40, 3
  s_lshr_b32 s42, s42, s40
  s_lshr_b32 s43, s43, s40
  s_bfe_u32 s41, s2, 0x30003
  s_and_b32 s42, s42, 31
  s_lshl_b32 s42, s42, 3
  s_add_u32 s3, s42, s41
  s_bfe_u32 s22, s43, 0x30002
  s_and_b32 s43, s43, 3
  s_lshl_b32 s43, s43, 3
  s_add_u32 s23, s43, s41
  s_waitcnt lgkmcnt(0)
  s_add_u32 s4, s4, 0x1fffff
  s_addc_u32 s5, s5, 0
  s_and_b32 s4, s4, 0xffe00000
  s_cmp_lg_u32 s20, 3
  s_cbranch_scc1 L_NOPRE
  s_getpc_b64 s[40:41]
L_PC:
  s_lshr_b32 s42, s2, 3
  v_lshlrev_b32 v1, 12, v0
  s_lshl_b32 s42, s42, 7
  v_add_u32 v1, s42, v1
  v_min_u32 v1, L_LAST-L_PC, v1
  global_load_dword v255, v1, s[40:41]
L_NOPRE:
  s_cmp_ge_u32 s22, 4
  s_cbranch_scc1 L_TRAIL
  s_lshr_b32 s40, s22, 1
  s_bitcmp1_b32 s22, 0
  s_cbranch_scc0 L_REC
  s_lshl_b32 s40, s40, 5
  s_add_u32 s21, s40, s23
  s_branch L_QKV
L_REC:
  s_lshl_b32 s40, s40, 4
  s_lshr_b32 s41, s23, 1
  s_add_u32 s21, s40, s41
  s_bitcmp1_b32 s23, 0
  s_cbranch_scc1 L_VO
  s_branch L_QK
L_TRAIL:
  s_mov_b32 s21, s23
  s_cmp_eq_u32 s22, 6
  s_cbranch_scc1 L_MOD
  s_sub_u32 s40, s22, 4
  s_lshl_b32 s40, s40, 5
  s_add_u32 s21, s40, s23
  s_cmp_lg_u32 s22, 7
  s_cbranch_scc1 L_WOF
L_INIT:
  s_lshl_b32 s40, s23, 2
  s_add_u32 s40, s40, s20
  s_lshl_b32 s40, s40, 12
  s_add_u32 s41, s40, 1048576
  s_add_u32 s42, s40, 0x80000
  v_lshlrev_b32 v1, 4, v0
  v_mov_b32 v4, -1
  v_mov_b32 v5, -1
  v_mov_b32 v6, -1
  v_mov_b32 v7, -1
  s_cmp_lt_u32 s23, 4
  s_cselect_b32 s41, 2147483392, s41
  buffer_store_dwordx4 v[4:7], v1, s[4:7], s41 offen offset:0 sc1
  buffer_store_dwordx4 v[4:7], v1, s[4:7], s41 offen offset:1024 sc1
  buffer_store_dwordx4 v[4:7], v1, s[4:7], s41 offen offset:2048 sc1
  buffer_store_dwordx4 v[4:7], v1, s[4:7], s41 offen offset:3072 sc1
  buffer_store_dwordx4 v[4:7], v1, s[4:7], s40 offen offset:0 sc1
  buffer_store_dwordx4 v[4:7], v1, s[4:7], s40 offen offset:1024 sc1
  buffer_store_dwordx4 v[4:7], v1, s[4:7], s40 offen offset:2048 sc1
  buffer_store_dwordx4 v[4:7], v1, s[4:7], s40 offen offset:3072 sc1
  buffer_store_dwordx4 v[4:7], v1, s[4:7], s42 offen offset:0 sc1
  buffer_store_dwordx4 v[4:7], v1, s[4:7], s42 offen offset:1024 sc1
  buffer_store_dwordx4 v[4:7], v1, s[4:7], s42 offen offset:2048 sc1
  buffer_store_dwordx4 v[4:7], v1, s[4:7], s42 offen offset:3072 sc1
  s_load_dwordx2 s[16:17], s[0:1], 8
  s_mov_b32 s18, 16384
  s_mov_b32 s19, 0x20000
  s_waitcnt lgkmcnt(0)
  s_and_b32 s40, s20, 1
  s_lshl_b32 s40, s40, 3
  v_bfe_u32 v8, v0, 2, 3
  v_add_u32 v8, s40, v8
  s_lshr_b32 s40, s20, 1
  s_lshl_b32 s40, s40, 3
  v_and_b32 v9, 3, v0
  v_add_u32 v9, s40, v9
  v_bfe_u32 v10, v8, 1, 1
  v_lshl_add_u32 v9, v10, 2, v9
  v_lshrrev_b32 v10, 2, v8
  v_and_b32 v11, 1, v8
  v_lshl_add_u32 v10, v10, 1, v11
  s_lshl_b32 s40, s23, 6
  v_lshl_add_u32 v10, v10, 11, s40
  v_lshl_add_u32 v10, v9, 1, v10
  buffer_load_ushort v11, v10, s[16:19], 0 offen
  buffer_load_ushort v12, v10, s[16:19], 0 offen offset:32
  s_bfe_u32 s41, s23, 0x10002
  s_mul_i32 s41, s41, 32768
  s_lshr_b32 s40, s23, 3
  s_lshl_b32 s40, s40, 11
  s_add_u32 s40, s40, s41
  s_and_b32 s41, s23, 3
  s_lshl_b32 s41, s41, 9
  s_add_u32 s40, s40, s41
  s_lshl_b32 s41, s20, 7
  s_add_u32 s40, s40, s41
  s_add_u32 s40, s40, 1048576
  s_add_u32 s41, s40, 0x4000
  v_and_b32 v8, 31, v0
  v_lshlrev_b32 v8, 2, v8
  v_lshrrev_b32 v9, 5, v0
  v_lshl_add_u32 v8, v9, 13, v8
  s_waitcnt vmcnt(0)
  v_lshl_or_b32 v11, v12, 16, v11
  v_min_u32 v11, -2, v11
  buffer_store_dword v11, v8, s[4:7], s40 offen sc1
  buffer_store_dword v11, v8, s[4:7], s41 offen sc1
  s_lshl_b32 s40, s23, 2
  s_add_u32 s40, s40, 128
  s_cmp_eq_u32 s20, 0
  s_cselect_b32 s40, s40, 2147483392
  v_mov_b32 v2, 2147483392
  s_mov_b64 exec, 1
  v_mov_b32 v2, s40
  s_mov_b64 exec, -1
  v_mov_b32 v3, 1
  s_waitcnt vmcnt(0)
  s_barrier
  buffer_store_dword v3, v2, s[12:15], 0 offen sc1
  s_branch L_LN1
L_MOD:
  s_load_dwordx2 s[16:17], s[0:1], 88
  s_mov_b32 s18, 2048
  s_mov_b32 s19, 0x20000
  s_waitcnt lgkmcnt(0)
  s_load_dwordx2 s[8:9], s[0:1], 96
  s_mov_b32 s10, 12582912
  s_mov_b32 s11, 0x20000
  s_waitcnt lgkmcnt(0)
  s_lshl_b32 s40, s20, 9
  v_lshl_add_u32 v1, v0, 3, s40
  buffer_load_dwordx2 v[8:9], v1, s[16:19], 0 offen
  v_bfe_u32 v2, v0, 5, 1
  v_mul_u32_u24 v2, 98304, v2
  v_bfe_u32 v3, v0, 4, 1
  v_mul_u32_u24 v3, 24576, v3
  v_add_u32 v2, v2, v3
  v_bfe_u32 v3, v0, 3, 1
  v_mul_u32_u24 v3, 12288, v3
  v_add_u32 v2, v2, v3
  v_lshrrev_b32 v3, 3, v0
  v_and_b32 v3, 6, v3
  v_xor_b32 v3, v3, v0
  v_and_b32 v3, 7, v3
  v_lshl_add_u32 v2, v3, 4, v2
  s_lshr_b32 s40, s20, 1
  s_mul_i32 s40, s40, 49152
  s_and_b32 s41, s20, 1
  s_mul_i32 s41, s41, 196608
  s_add_u32 s40, s40, s41
  s_lshl_b32 s41, s21, 7
  s_add_u32 s40, s40, s41
  v_add_u32 v2, s40, v2
  s_lshl_b32 s41, s20, 10
  s_add_u32 m0, s41, 0
  s_mov_b32 s42, 0
  buffer_load_dwordx4 v2, s[8:11], s42 offen nt lds
  s_add_u32 m0, s41, 4096
  s_mov_b32 s42, 393216
  buffer_load_dwordx4 v2, s[8:11], s42 offen nt lds
  s_add_u32 m0, s41, 8192
  s_mov_b32 s42, 786432
  buffer_load_dwordx4 v2, s[8:11], s42 offen nt lds
  s_add_u32 m0, s41, 12288
  s_mov_b32 s42, 1179648
  buffer_load_dwordx4 v2, s[8:11], s42 offen nt lds
  s_add_u32 m0, s41, 16384
  s_mov_b32 s42, 1572864
  buffer_load_dwordx4 v2, s[8:11], s42 offen nt lds
  s_add_u32 m0, s41, 20480
  s_mov_b32 s42, 1966080
  buffer_load_dwordx4 v2, s[8:11], s42 offen nt lds
  s_add_u32 m0, s41, 24576
  s_mov_b32 s42, 2359296
  buffer_load_dwordx4 v2, s[8:11], s42 offen nt lds
  s_add_u32 m0, s41, 28672
  s_mov_b32 s42, 2752512
  buffer_load_dwordx4 v2, s[8:11], s42 offen nt lds
  s_add_u32 m0, s41, 32768
  s_mov_b32 s42, 3145728
  buffer_load_dwordx4 v2, s[8:11], s42 offen nt lds
  s_add_u32 m0, s41, 36864
  s_mov_b32 s42, 3538944
  buffer_load_dwordx4 v2, s[8:11], s42 offen nt lds
  s_add_u32 m0, s41, 40960
  s_mov_b32 s42, 3932160
  buffer_load_dwordx4 v2, s[8:11], s42 offen nt lds
  s_add_u32 m0, s41, 45056
  s_mov_b32 s42, 4325376
  buffer_load_dwordx4 v2, s[8:11], s42 offen nt lds
  s_add_u32 m0, s41, 49152
  s_mov_b32 s42, 4718592
  buffer_load_dwordx4 v2, s[8:11], s42 offen nt lds
  s_add_u32 m0, s41, 53248
  s_mov_b32 s42, 5111808
  buffer_load_dwordx4 v2, s[8:11], s42 offen nt lds
  s_add_u32 m0, s41, 57344
  s_mov_b32 s42, 5505024
  buffer_load_dwordx4 v2, s[8:11], s42 offen nt lds
  s_add_u32 m0, s41, 61440
  s_mov_b32 s42, 5898240
  buffer_load_dwordx4 v2, s[8:11], s42 offen nt lds
  s_add_u32 m0, s41, 65536
  s_mov_b32 s42, 6291456
  buffer_load_dwordx4 v2, s[8:11], s42 offen nt lds
  s_add_u32 m0, s41, 69632
  s_mov_b32 s42, 6684672
  buffer_load_dwordx4 v2, s[8:11], s42 offen nt lds
  s_add_u32 m0, s41, 73728
  s_mov_b32 s42, 7077888
  buffer_load_dwordx4 v2, s[8:11], s42 offen nt lds
  s_add_u32 m0, s41, 77824
  s_mov_b32 s42, 7471104
  buffer_load_dwordx4 v2, s[8:11], s42 offen nt lds
  s_add_u32 m0, s41, 81920
  s_mov_b32 s42, 7864320
  buffer_load_dwordx4 v2, s[8:11], s42 offen nt lds
  s_add_u32 m0, s41, 86016
  s_mov_b32 s42, 8257536
  buffer_load_dwordx4 v2, s[8:11], s42 offen nt lds
  s_add_u32 m0, s41, 90112
  s_mov_b32 s42, 8650752
  buffer_load_dwordx4 v2, s[8:11], s42 offen nt lds
  s_add_u32 m0, s41, 94208
  s_mov_b32 s42, 9043968
  buffer_load_dwordx4 v2, s[8:11], s42 offen nt lds
  s_add_u32 m0, s41, 98304
  s_mov_b32 s42, 9437184
  buffer_load_dwordx4 v2, s[8:11], s42 offen nt lds
  s_add_u32 m0, s41, 102400
  s_mov_b32 s42, 9830400
  buffer_load_dwordx4 v2, s[8:11], s42 offen nt lds
  s_add_u32 m0, s41, 106496
  s_mov_b32 s42, 10223616
  buffer_load_dwordx4 v2, s[8:11], s42 offen nt lds
  s_add_u32 m0, s41, 110592
  s_mov_b32 s42, 10616832
  buffer_load_dwordx4 v2, s[8:11], s42 offen nt lds
  s_add_u32 m0, s41, 114688
  s_mov_b32 s42, 11010048
  buffer_load_dwordx4 v2, s[8:11], s42 offen nt lds
  s_add_u32 m0, s41, 118784
  s_mov_b32 s42, 11403264
  buffer_load_dwordx4 v2, s[8:11], s42 offen nt lds
  s_add_u32 m0, s41, 122880
  s_mov_b32 s42, 11796480
  buffer_load_dwordx4 v2, s[8:11], s42 offen nt lds
  s_add_u32 m0, s41, 126976
  s_mov_b32 s42, 12189696
  buffer_load_dwordx4 v2, s[8:11], s42 offen nt lds
  v_bfe_u32 v3, v0, 3, 2
  v_xor_b32 v3, s20, v3
  v_lshlrev_b32 v3, 5, v3
  v_lshrrev_b32 v4, 2, v0
  v_lshl_add_u32 v4, v4, 7, v3
  v_and_b32 v3, 3, v0
  v_lshl_add_u32 v4, v3, 3, v4
  v_add_u32 v5, 0x10000, v4
  v_lshrrev_b32 v6, 4, v0
  v_lshlrev_b32 v6, 4, v6
  v_add_u32 v6, 0x20000, v6
  v_add_u32 v1, 0x20000, v1
  s_mov_b32 s37, 0xbfb8aa3b
  s_waitcnt vmcnt(32)
  v_lshlrev_b32 v10, 16, v8
  v_and_b32 v11, 0xffff0000, v8
  v_lshlrev_b32 v12, 16, v9
  v_and_b32 v13, 0xffff0000, v9
  v_mul_f32 v14, s37, v10
  v_mul_f32 v15, s37, v11
  v_mul_f32 v16, s37, v12
  v_mul_f32 v17, s37, v13
  v_exp_f32 v14, v14
  v_exp_f32 v15, v15
  v_exp_f32 v16, v16
  v_exp_f32 v17, v17
  v_add_f32 v14, 1.0, v14
  v_add_f32 v15, 1.0, v15
  v_add_f32 v16, 1.0, v16
  v_add_f32 v17, 1.0, v17
  v_rcp_f32 v14, v14
  v_rcp_f32 v15, v15
  v_rcp_f32 v16, v16
  v_rcp_f32 v17, v17
  v_mul_f32 v10, v10, v14
  v_mul_f32 v11, v11, v15
  v_mul_f32 v12, v12, v16
  v_mul_f32 v13, v13, v17
  v_cvt_pk_bf16_f32 v8, v10, v11
  v_cvt_pk_bf16_f32 v9, v12, v13
  ds_write_b64 v1, v[8:9]
  s_waitcnt vmcnt(28) lgkmcnt(0)
  s_barrier
  ds_read_b64_tr_b16 v[24:25], v4 offset:0
  ds_read_b64_tr_b16 v[26:27], v4 offset:2048
  ds_read_b128 v[28:31], v6 offset:0
  ds_read_b64_tr_b16 v[32:33], v4 offset:4096
  ds_read_b64_tr_b16 v[34:35], v4 offset:6144
  ds_read_b128 v[36:39], v6 offset:64
  ds_read_b64_tr_b16 v[40:41], v4 offset:8192
  ds_read_b64_tr_b16 v[42:43], v4 offset:10240
  ds_read_b128 v[44:47], v6 offset:128
  ds_read_b64_tr_b16 v[48:49], v4 offset:12288
  ds_read_b64_tr_b16 v[50:51], v4 offset:14336
  ds_read_b128 v[52:55], v6 offset:192
  s_waitcnt lgkmcnt(9)
  v_mfma_f32_16x16x32_bf16 v[20:23], v[24:27], v[28:31], 0
  s_waitcnt lgkmcnt(6)
  v_mfma_f32_16x16x32_bf16 v[20:23], v[32:35], v[36:39], v[20:23]
  s_waitcnt lgkmcnt(3)
  v_mfma_f32_16x16x32_bf16 v[20:23], v[40:43], v[44:47], v[20:23]
  s_waitcnt lgkmcnt(0)
  v_mfma_f32_16x16x32_bf16 v[20:23], v[48:51], v[52:55], v[20:23]
  s_waitcnt vmcnt(24) lgkmcnt(0)
  s_barrier
  ds_read_b64_tr_b16 v[24:25], v4 offset:16384
  ds_read_b64_tr_b16 v[26:27], v4 offset:18432
  ds_read_b128 v[28:31], v6 offset:256
  ds_read_b64_tr_b16 v[32:33], v4 offset:20480
  ds_read_b64_tr_b16 v[34:35], v4 offset:22528
  ds_read_b128 v[36:39], v6 offset:320
  ds_read_b64_tr_b16 v[40:41], v4 offset:24576
  ds_read_b64_tr_b16 v[42:43], v4 offset:26624
  ds_read_b128 v[44:47], v6 offset:384
  ds_read_b64_tr_b16 v[48:49], v4 offset:28672
  ds_read_b64_tr_b16 v[50:51], v4 offset:30720
  ds_read_b128 v[52:55], v6 offset:448
  s_waitcnt lgkmcnt(9)
  v_mfma_f32_16x16x32_bf16 v[20:23], v[24:27], v[28:31], v[20:23]
  s_waitcnt lgkmcnt(6)
  v_mfma_f32_16x16x32_bf16 v[20:23], v[32:35], v[36:39], v[20:23]
  s_waitcnt lgkmcnt(3)
  v_mfma_f32_16x16x32_bf16 v[20:23], v[40:43], v[44:47], v[20:23]
  s_waitcnt lgkmcnt(0)
  v_mfma_f32_16x16x32_bf16 v[20:23], v[48:51], v[52:55], v[20:23]
  s_waitcnt vmcnt(20) lgkmcnt(0)
  s_barrier
  ds_read_b64_tr_b16 v[24:25], v4 offset:32768
  ds_read_b64_tr_b16 v[26:27], v4 offset:34816
  ds_read_b128 v[28:31], v6 offset:512
  ds_read_b64_tr_b16 v[32:33], v4 offset:36864
  ds_read_b64_tr_b16 v[34:35], v4 offset:38912
  ds_read_b128 v[36:39], v6 offset:576
  ds_read_b64_tr_b16 v[40:41], v4 offset:40960
  ds_read_b64_tr_b16 v[42:43], v4 offset:43008
  ds_read_b128 v[44:47], v6 offset:640
  ds_read_b64_tr_b16 v[48:49], v4 offset:45056
  ds_read_b64_tr_b16 v[50:51], v4 offset:47104
  ds_read_b128 v[52:55], v6 offset:704
  s_waitcnt lgkmcnt(9)
  v_mfma_f32_16x16x32_bf16 v[20:23], v[24:27], v[28:31], v[20:23]
  s_waitcnt lgkmcnt(6)
  v_mfma_f32_16x16x32_bf16 v[20:23], v[32:35], v[36:39], v[20:23]
  s_waitcnt lgkmcnt(3)
  v_mfma_f32_16x16x32_bf16 v[20:23], v[40:43], v[44:47], v[20:23]
  s_waitcnt lgkmcnt(0)
  v_mfma_f32_16x16x32_bf16 v[20:23], v[48:51], v[52:55], v[20:23]
  s_waitcnt vmcnt(16) lgkmcnt(0)
  s_barrier
  ds_read_b64_tr_b16 v[24:25], v4 offset:49152
  ds_read_b64_tr_b16 v[26:27], v4 offset:51200
  ds_read_b128 v[28:31], v6 offset:768
  ds_read_b64_tr_b16 v[32:33], v4 offset:53248
  ds_read_b64_tr_b16 v[34:35], v4 offset:55296
  ds_read_b128 v[36:39], v6 offset:832
  ds_read_b64_tr_b16 v[40:41], v4 offset:57344
  ds_read_b64_tr_b16 v[42:43], v4 offset:59392
  ds_read_b128 v[44:47], v6 offset:896
  ds_read_b64_tr_b16 v[48:49], v4 offset:61440
  ds_read_b64_tr_b16 v[50:51], v4 offset:63488
  ds_read_b128 v[52:55], v6 offset:960
  s_waitcnt lgkmcnt(9)
  v_mfma_f32_16x16x32_bf16 v[20:23], v[24:27], v[28:31], v[20:23]
  s_waitcnt lgkmcnt(6)
  v_mfma_f32_16x16x32_bf16 v[20:23], v[32:35], v[36:39], v[20:23]
  s_waitcnt lgkmcnt(3)
  v_mfma_f32_16x16x32_bf16 v[20:23], v[40:43], v[44:47], v[20:23]
  s_waitcnt lgkmcnt(0)
  v_mfma_f32_16x16x32_bf16 v[20:23], v[48:51], v[52:55], v[20:23]
  s_waitcnt vmcnt(12) lgkmcnt(0)
  s_barrier
  ds_read_b64_tr_b16 v[24:25], v5 offset:0
  ds_read_b64_tr_b16 v[26:27], v5 offset:2048
  ds_read_b128 v[28:31], v6 offset:1024
  ds_read_b64_tr_b16 v[32:33], v5 offset:4096
  ds_read_b64_tr_b16 v[34:35], v5 offset:6144
  ds_read_b128 v[36:39], v6 offset:1088
  ds_read_b64_tr_b16 v[40:41], v5 offset:8192
  ds_read_b64_tr_b16 v[42:43], v5 offset:10240
  ds_read_b128 v[44:47], v6 offset:1152
  ds_read_b64_tr_b16 v[48:49], v5 offset:12288
  ds_read_b64_tr_b16 v[50:51], v5 offset:14336
  ds_read_b128 v[52:55], v6 offset:1216
  s_waitcnt lgkmcnt(9)
  v_mfma_f32_16x16x32_bf16 v[20:23], v[24:27], v[28:31], v[20:23]
  s_waitcnt lgkmcnt(6)
  v_mfma_f32_16x16x32_bf16 v[20:23], v[32:35], v[36:39], v[20:23]
  s_waitcnt lgkmcnt(3)
  v_mfma_f32_16x16x32_bf16 v[20:23], v[40:43], v[44:47], v[20:23]
  s_waitcnt lgkmcnt(0)
  v_mfma_f32_16x16x32_bf16 v[20:23], v[48:51], v[52:55], v[20:23]
  s_waitcnt vmcnt(8) lgkmcnt(0)
  s_barrier
  ds_read_b64_tr_b16 v[24:25], v5 offset:16384
  ds_read_b64_tr_b16 v[26:27], v5 offset:18432
  ds_read_b128 v[28:31], v6 offset:1280
  ds_read_b64_tr_b16 v[32:33], v5 offset:20480
  ds_read_b64_tr_b16 v[34:35], v5 offset:22528
  ds_read_b128 v[36:39], v6 offset:1344
  ds_read_b64_tr_b16 v[40:41], v5 offset:24576
  ds_read_b64_tr_b16 v[42:43], v5 offset:26624
  ds_read_b128 v[44:47], v6 offset:1408
  ds_read_b64_tr_b16 v[48:49], v5 offset:28672
  ds_read_b64_tr_b16 v[50:51], v5 offset:30720
  ds_read_b128 v[52:55], v6 offset:1472
  s_waitcnt lgkmcnt(9)
  v_mfma_f32_16x16x32_bf16 v[20:23], v[24:27], v[28:31], v[20:23]
  s_waitcnt lgkmcnt(6)
  v_mfma_f32_16x16x32_bf16 v[20:23], v[32:35], v[36:39], v[20:23]
  s_waitcnt lgkmcnt(3)
  v_mfma_f32_16x16x32_bf16 v[20:23], v[40:43], v[44:47], v[20:23]
  s_waitcnt lgkmcnt(0)
  v_mfma_f32_16x16x32_bf16 v[20:23], v[48:51], v[52:55], v[20:23]
  s_waitcnt vmcnt(4) lgkmcnt(0)
  s_barrier
  ds_read_b64_tr_b16 v[24:25], v5 offset:32768
  ds_read_b64_tr_b16 v[26:27], v5 offset:34816
  ds_read_b128 v[28:31], v6 offset:1536
  ds_read_b64_tr_b16 v[32:33], v5 offset:36864
  ds_read_b64_tr_b16 v[34:35], v5 offset:38912
  ds_read_b128 v[36:39], v6 offset:1600
  ds_read_b64_tr_b16 v[40:41], v5 offset:40960
  ds_read_b64_tr_b16 v[42:43], v5 offset:43008
  ds_read_b128 v[44:47], v6 offset:1664
  ds_read_b64_tr_b16 v[48:49], v5 offset:45056
  ds_read_b64_tr_b16 v[50:51], v5 offset:47104
  ds_read_b128 v[52:55], v6 offset:1728
  s_waitcnt lgkmcnt(9)
  v_mfma_f32_16x16x32_bf16 v[20:23], v[24:27], v[28:31], v[20:23]
  s_waitcnt lgkmcnt(6)
  v_mfma_f32_16x16x32_bf16 v[20:23], v[32:35], v[36:39], v[20:23]
  s_waitcnt lgkmcnt(3)
  v_mfma_f32_16x16x32_bf16 v[20:23], v[40:43], v[44:47], v[20:23]
  s_waitcnt lgkmcnt(0)
  v_mfma_f32_16x16x32_bf16 v[20:23], v[48:51], v[52:55], v[20:23]
  s_waitcnt vmcnt(0) lgkmcnt(0)
  s_barrier
  ds_read_b64_tr_b16 v[24:25], v5 offset:49152
  ds_read_b64_tr_b16 v[26:27], v5 offset:51200
  ds_read_b128 v[28:31], v6 offset:1792
  ds_read_b64_tr_b16 v[32:33], v5 offset:53248
  ds_read_b64_tr_b16 v[34:35], v5 offset:55296
  ds_read_b128 v[36:39], v6 offset:1856
  ds_read_b64_tr_b16 v[40:41], v5 offset:57344
  ds_read_b64_tr_b16 v[42:43], v5 offset:59392
  ds_read_b128 v[44:47], v6 offset:1920
  ds_read_b64_tr_b16 v[48:49], v5 offset:61440
  ds_read_b64_tr_b16 v[50:51], v5 offset:63488
  ds_read_b128 v[52:55], v6 offset:1984
  s_waitcnt lgkmcnt(9)
  v_mfma_f32_16x16x32_bf16 v[20:23], v[24:27], v[28:31], v[20:23]
  s_waitcnt lgkmcnt(6)
  v_mfma_f32_16x16x32_bf16 v[20:23], v[32:35], v[36:39], v[20:23]
  s_waitcnt lgkmcnt(3)
  v_mfma_f32_16x16x32_bf16 v[20:23], v[40:43], v[44:47], v[20:23]
  s_waitcnt lgkmcnt(0)
  v_mfma_f32_16x16x32_bf16 v[20:23], v[48:51], v[52:55], v[20:23]
  s_lshl_b32 s40, s21, 8
  s_lshl_b32 s41, s20, 6
  s_add_u32 s40, s40, s41
  s_add_u32 s40, s40, 1572864
  v_and_b32 v2, 15, v0
  v_cmp_eq_u32 vcc, 0, v2
  v_mov_b32 v3, 2147483392
  s_nop 0
  v_cndmask_b32 v1, v3, v0, vcc
  v_cvt_pk_bf16_f32 v8, v20, v21
  v_cvt_pk_bf16_f32 v9, v22, v23
  v_lshlrev_b32 v20, 16, v8
  v_and_b32 v21, 0xffff0000, v8
  v_lshlrev_b32 v22, 16, v9
  v_and_b32 v23, 0xffff0000, v9
  buffer_store_dwordx4 v[20:23], v1, s[4:7], s40 offen sc1
  v_min_u32 v2, 31, v0
  v_lshlrev_b32 v2, 2, v2
  v_add_u32 v2, 128, v2
  s_nop 1
Lpoll_1:
  buffer_load_dword v3, v2, s[12:15], 0 offen sc1
  s_sub_u32 s24, s24, 1
  s_cbranch_scc1 L_FAIL
  s_waitcnt vmcnt(0)
  v_cmp_gt_i32 vcc, 1, v3
  s_cbranch_vccz Lpolld_2
  s_sleep 2
  s_branch Lpoll_1
Lpolld_2:
  s_lshl_b32 s40, s21, 7
  s_add_u32 s40, s40, 1376256
  v_mov_b32 v2, 2147483392
  s_mov_b64 exec, 1
  v_mov_b32 v2, s40
  s_mov_b64 exec, -1
  v_mov_b32 v3, 1
  s_barrier
  s_cmp_lg_u32 s20, 0
  s_cbranch_scc1 L_MOD_done
  buffer_store_dword v3, v2, s[4:7], 0 offen sc1
L_MOD_done:
  s_cmp_lg_u32 s22, 6
  s_cbranch_scc1 L_ROLE
L_LN1:
  s_load_dwordx2 s[16:17], s[0:1], 0
  s_mov_b32 s18, 4194304
  s_mov_b32 s19, 0x20000
  s_waitcnt lgkmcnt(0)
  s_sub_u32 s43, 7, s22
  s_lshl_b32 s43, s43, 5
  s_add_u32 s43, s43, s23
  s_lshl_b32 s43, s43, 2
  s_add_u32 s43, s43, s20
  s_lshl_b32 s44, s43, 13
  s_add_u32 s45, s44, 4096
  v_lshlrev_b32 v1, 3, v0
  v_lshlrev_b32 v2, 4, v0
  buffer_load_dwordx2 v[8:9], v1, s[16:19], s44 offen offset:0 nt
  buffer_load_dwordx2 v[10:11], v1, s[16:19], s44 offen offset:512 nt
  buffer_load_dwordx2 v[12:13], v1, s[16:19], s44 offen offset:1024 nt
  buffer_load_dwordx2 v[14:15], v1, s[16:19], s44 offen offset:1536 nt
  buffer_load_dwordx2 v[16:17], v1, s[16:19], s44 offen offset:2048 nt
  buffer_load_dwordx2 v[18:19], v1, s[16:19], s44 offen offset:2560 nt
  buffer_load_dwordx2 v[20:21], v1, s[16:19], s44 offen offset:3072 nt
  buffer_load_dwordx2 v[22:23], v1, s[16:19], s44 offen offset:3584 nt
  buffer_load_dwordx2 v[24:25], v1, s[16:19], s45 offen offset:0 nt
  buffer_load_dwordx2 v[26:27], v1, s[16:19], s45 offen offset:512 nt
  buffer_load_dwordx2 v[28:29], v1, s[16:19], s45 offen offset:1024 nt
  buffer_load_dwordx2 v[30:31], v1, s[16:19], s45 offen offset:1536 nt
  buffer_load_dwordx2 v[32:33], v1, s[16:19], s45 offen offset:2048 nt
  buffer_load_dwordx2 v[34:35], v1, s[16:19], s45 offen offset:2560 nt
  buffer_load_dwordx2 v[36:37], v1, s[16:19], s45 offen offset:3072 nt
  buffer_load_dwordx2 v[38:39], v1, s[16:19], s45 offen offset:3584 nt
  s_waitcnt vmcnt(0)
  v_lshlrev_b32 v40, 16, v8
  v_and_b32 v41, 0xffff0000, v8
  v_lshlrev_b32 v42, 16, v9
  v_and_b32 v43, 0xffff0000, v9
  v_lshlrev_b32 v44, 16, v10
  v_and_b32 v45, 0xffff0000, v10
  v_lshlrev_b32 v46, 16, v11
  v_and_b32 v47, 0xffff0000, v11
  v_lshlrev_b32 v48, 16, v12
  v_and_b32 v49, 0xffff0000, v12
  v_lshlrev_b32 v50, 16, v13
  v_and_b32 v51, 0xffff0000, v13
  v_lshlrev_b32 v52, 16, v14
  v_and_b32 v53, 0xffff0000, v14
  v_lshlrev_b32 v54, 16, v15
  v_and_b32 v55, 0xffff0000, v15
  v_lshlrev_b32 v56, 16, v16
  v_and_b32 v57, 0xffff0000, v16
  v_lshlrev_b32 v58, 16, v17
  v_and_b32 v59, 0xffff0000, v17
  v_lshlrev_b32 v60, 16, v18
  v_and_b32 v61, 0xffff0000, v18
  v_lshlrev_b32 v62, 16, v19
  v_and_b32 v63, 0xffff0000, v19
  v_lshlrev_b32 v64, 16, v20
  v_and_b32 v65, 0xffff0000, v20
  v_lshlrev_b32 v66, 16, v21
  v_and_b32 v67, 0xffff0000, v21
  v_lshlrev_b32 v68, 16, v22
  v_and_b32 v69, 0xffff0000, v22
  v_lshlrev_b32 v70, 16, v23
  v_and_b32 v71, 0xffff0000, v23
  v_lshlrev_b32 v72, 16, v24
  v_and_b32 v73, 0xffff0000, v24
  v_lshlrev_b32 v74, 16, v25
  v_and_b32 v75, 0xffff0000, v25
  v_lshlrev_b32 v76, 16, v26
  v_and_b32 v77, 0xffff0000, v26
  v_lshlrev_b32 v78, 16, v27
  v_and_b32 v79, 0xffff0000, v27
  v_lshlrev_b32 v80, 16, v28
  v_and_b32 v81, 0xffff0000, v28
  v_lshlrev_b32 v82, 16, v29
  v_and_b32 v83, 0xffff0000, v29
  v_lshlrev_b32 v84, 16, v30
  v_and_b32 v85, 0xffff0000, v30
  v_lshlrev_b32 v86, 16, v31
  v_and_b32 v87, 0xffff0000, v31
  v_lshlrev_b32 v88, 16, v32
  v_and_b32 v89, 0xffff0000, v32
  v_lshlrev_b32 v90, 16, v33
  v_and_b32 v91, 0xffff0000, v33
  v_lshlrev_b32 v92, 16, v34
  v_and_b32 v93, 0xffff0000, v34
  v_lshlrev_b32 v94, 16, v35
  v_and_b32 v95, 0xffff0000, v35
  v_lshlrev_b32 v96, 16, v36
  v_and_b32 v97, 0xffff0000, v36
  v_lshlrev_b32 v98, 16, v37
  v_and_b32 v99, 0xffff0000, v37
  v_lshlrev_b32 v100, 16, v38
  v_and_b32 v101, 0xffff0000, v38
  v_lshlrev_b32 v102, 16, v39
  v_and_b32 v103, 0xffff0000, v39
  v_pk_add_f32 v[104:105], v[40:41], v[42:43]
  v_pk_add_f32 v[108:109], v[56:57], v[58:59]
  v_pk_add_f32 v[112:113], v[72:73], v[74:75]
  v_pk_add_f32 v[116:117], v[88:89], v[90:91]
  v_pk_add_f32 v[104:105], v[104:105], v[44:45]
  v_pk_add_f32 v[108:109], v[108:109], v[60:61]
  v_pk_add_f32 v[112:113], v[112:113], v[76:77]
  v_pk_add_f32 v[116:117], v[116:117], v[92:93]
  v_pk_add_f32 v[104:105], v[104:105], v[46:47]
  v_pk_add_f32 v[108:109], v[108:109], v[62:63]
  v_pk_add_f32 v[112:113], v[112:113], v[78:79]
  v_pk_add_f32 v[116:117], v[116:117], v[94:95]
  v_pk_add_f32 v[104:105], v[104:105], v[48:49]
  v_pk_add_f32 v[108:109], v[108:109], v[64:65]
  v_pk_add_f32 v[112:113], v[112:113], v[80:81]
  v_pk_add_f32 v[116:117], v[116:117], v[96:97]
  v_pk_add_f32 v[104:105], v[104:105], v[50:51]
  v_pk_add_f32 v[108:109], v[108:109], v[66:67]
  v_pk_add_f32 v[112:113], v[112:113], v[82:83]
  v_pk_add_f32 v[116:117], v[116:117], v[98:99]
  v_pk_add_f32 v[104:105], v[104:105], v[52:53]
  v_pk_add_f32 v[108:109], v[108:109], v[68:69]
  v_pk_add_f32 v[112:113], v[112:113], v[84:85]
  v_pk_add_f32 v[116:117], v[116:117], v[100:101]
  v_pk_add_f32 v[104:105], v[104:105], v[54:55]
  v_pk_add_f32 v[108:109], v[108:109], v[70:71]
  v_pk_add_f32 v[112:113], v[112:113], v[86:87]
  v_pk_add_f32 v[116:117], v[116:117], v[102:103]
  v_add_f32 v104, v104, v105
  v_add_f32 v108, v108, v109
  v_add_f32 v112, v112, v113
  v_add_f32 v116, v116, v117
  v_add_f32_dpp v104, v104, v104 row_ror:8 row_mask:0xf bank_mask:0xf
  v_add_f32_dpp v108, v108, v108 row_ror:8 row_mask:0xf bank_mask:0xf
  v_add_f32_dpp v112, v112, v112 row_ror:8 row_mask:0xf bank_mask:0xf
  v_add_f32_dpp v116, v116, v116 row_ror:8 row_mask:0xf bank_mask:0xf
  v_add_f32_dpp v104, v104, v104 row_ror:4 row_mask:0xf bank_mask:0xf
  v_add_f32_dpp v108, v108, v108 row_ror:4 row_mask:0xf bank_mask:0xf
  v_add_f32_dpp v112, v112, v112 row_ror:4 row_mask:0xf bank_mask:0xf
  v_add_f32_dpp v116, v116, v116 row_ror:4 row_mask:0xf bank_mask:0xf
  v_add_f32_dpp v104, v104, v104 row_ror:2 row_mask:0xf bank_mask:0xf
  v_add_f32_dpp v108, v108, v108 row_ror:2 row_mask:0xf bank_mask:0xf
  v_add_f32_dpp v112, v112, v112 row_ror:2 row_mask:0xf bank_mask:0xf
  v_add_f32_dpp v116, v116, v116 row_ror:2 row_mask:0xf bank_mask:0xf
  v_add_f32_dpp v104, v104, v104 row_ror:1 row_mask:0xf bank_mask:0xf
  v_add_f32_dpp v108, v108, v108 row_ror:1 row_mask:0xf bank_mask:0xf
  v_add_f32_dpp v112, v112, v112 row_ror:1 row_mask:0xf bank_mask:0xf
  v_add_f32_dpp v116, v116, v116 row_ror:1 row_mask:0xf bank_mask:0xf
  v_mov_b32 v105, v104
  v_mov_b32 v109, v108
  v_mov_b32 v113, v112
  v_mov_b32 v117, v116
  v_permlane16_swap_b32 v105, v104
  v_permlane16_swap_b32 v109, v108
  v_permlane16_swap_b32 v113, v112
  v_permlane16_swap_b32 v117, v116
  v_add_f32 v104, v104, v105
  v_add_f32 v108, v108, v109
  v_add_f32 v112, v112, v113
  v_add_f32 v116, v116, v117
  v_mov_b32 v105, v104
  v_mov_b32 v109, v108
  v_mov_b32 v113, v112
  v_mov_b32 v117, v116
  v_permlane32_swap_b32 v105, v104
  v_permlane32_swap_b32 v109, v108
  v_permlane32_swap_b32 v113, v112
  v_permlane32_swap_b32 v117, v116
  v_add_f32 v104, v104, v105
  v_add_f32 v108, v108, v109
  v_add_f32 v112, v112, v113
  v_add_f32 v116, v116, v117
  v_mul_f32 v104, 0xba800000, v104
  v_mul_f32 v108, 0xba800000, v108
  v_mul_f32 v112, 0xba800000, v112
  v_mul_f32 v116, 0xba800000, v116
  v_pk_add_f32 v[40:41], v[40:41], v[104:105] op_sel_hi:[1,0]
  v_pk_add_f32 v[56:57], v[56:57], v[108:109] op_sel_hi:[1,0]
  v_pk_add_f32 v[72:73], v[72:73], v[112:113] op_sel_hi:[1,0]
  v_pk_add_f32 v[88:89], v[88:89], v[116:117] op_sel_hi:[1,0]
  v_pk_add_f32 v[42:43], v[42:43], v[104:105] op_sel_hi:[1,0]
  v_pk_add_f32 v[58:59], v[58:59], v[108:109] op_sel_hi:[1,0]
  v_pk_add_f32 v[74:75], v[74:75], v[112:113] op_sel_hi:[1,0]
  v_pk_add_f32 v[90:91], v[90:91], v[116:117] op_sel_hi:[1,0]
  v_pk_add_f32 v[44:45], v[44:45], v[104:105] op_sel_hi:[1,0]
  v_pk_add_f32 v[60:61], v[60:61], v[108:109] op_sel_hi:[1,0]
  v_pk_add_f32 v[76:77], v[76:77], v[112:113] op_sel_hi:[1,0]
  v_pk_add_f32 v[92:93], v[92:93], v[116:117] op_sel_hi:[1,0]
  v_pk_add_f32 v[46:47], v[46:47], v[104:105] op_sel_hi:[1,0]
  v_pk_add_f32 v[62:63], v[62:63], v[108:109] op_sel_hi:[1,0]
  v_pk_add_f32 v[78:79], v[78:79], v[112:113] op_sel_hi:[1,0]
  v_pk_add_f32 v[94:95], v[94:95], v[116:117] op_sel_hi:[1,0]
  v_pk_add_f32 v[48:49], v[48:49], v[104:105] op_sel_hi:[1,0]
  v_pk_add_f32 v[64:65], v[64:65], v[108:109] op_sel_hi:[1,0]
  v_pk_add_f32 v[80:81], v[80:81], v[112:113] op_sel_hi:[1,0]
  v_pk_add_f32 v[96:97], v[96:97], v[116:117] op_sel_hi:[1,0]
  v_pk_add_f32 v[50:51], v[50:51], v[104:105] op_sel_hi:[1,0]
  v_pk_add_f32 v[66:67], v[66:67], v[108:109] op_sel_hi:[1,0]
  v_pk_add_f32 v[82:83], v[82:83], v[112:113] op_sel_hi:[1,0]
  v_pk_add_f32 v[98:99], v[98:99], v[116:117] op_sel_hi:[1,0]
  v_pk_add_f32 v[52:53], v[52:53], v[104:105] op_sel_hi:[1,0]
  v_pk_add_f32 v[68:69], v[68:69], v[108:109] op_sel_hi:[1,0]
  v_pk_add_f32 v[84:85], v[84:85], v[112:113] op_sel_hi:[1,0]
  v_pk_add_f32 v[100:101], v[100:101], v[116:117] op_sel_hi:[1,0]
  v_pk_add_f32 v[54:55], v[54:55], v[104:105] op_sel_hi:[1,0]
  v_pk_add_f32 v[70:71], v[70:71], v[108:109] op_sel_hi:[1,0]
  v_pk_add_f32 v[86:87], v[86:87], v[112:113] op_sel_hi:[1,0]
  v_pk_add_f32 v[102:103], v[102:103], v[116:117] op_sel_hi:[1,0]
  v_pk_mul_f32 v[104:105], v[40:41], v[40:41]
  v_pk_mul_f32 v[108:109], v[56:57], v[56:57]
  v_pk_mul_f32 v[112:113], v[72:73], v[72:73]
  v_pk_mul_f32 v[116:117], v[88:89], v[88:89]
  v_pk_fma_f32 v[104:105], v[42:43], v[42:43], v[104:105]
  v_pk_fma_f32 v[108:109], v[58:59], v[58:59], v[108:109]
  v_pk_fma_f32 v[112:113], v[74:75], v[74:75], v[112:113]
  v_pk_fma_f32 v[116:117], v[90:91], v[90:91], v[116:117]
  v_pk_fma_f32 v[104:105], v[44:45], v[44:45], v[104:105]
  v_pk_fma_f32 v[108:109], v[60:61], v[60:61], v[108:109]
  v_pk_fma_f32 v[112:113], v[76:77], v[76:77], v[112:113]
  v_pk_fma_f32 v[116:117], v[92:93], v[92:93], v[116:117]
  v_pk_fma_f32 v[104:105], v[46:47], v[46:47], v[104:105]
  v_pk_fma_f32 v[108:109], v[62:63], v[62:63], v[108:109]
  v_pk_fma_f32 v[112:113], v[78:79], v[78:79], v[112:113]
  v_pk_fma_f32 v[116:117], v[94:95], v[94:95], v[116:117]
  v_pk_fma_f32 v[104:105], v[48:49], v[48:49], v[104:105]
  v_pk_fma_f32 v[108:109], v[64:65], v[64:65], v[108:109]
  v_pk_fma_f32 v[112:113], v[80:81], v[80:81], v[112:113]
  v_pk_fma_f32 v[116:117], v[96:97], v[96:97], v[116:117]
  v_pk_fma_f32 v[104:105], v[50:51], v[50:51], v[104:105]
  v_pk_fma_f32 v[108:109], v[66:67], v[66:67], v[108:109]
  v_pk_fma_f32 v[112:113], v[82:83], v[82:83], v[112:113]
  v_pk_fma_f32 v[116:117], v[98:99], v[98:99], v[116:117]
  v_pk_fma_f32 v[104:105], v[52:53], v[52:53], v[104:105]
  v_pk_fma_f32 v[108:109], v[68:69], v[68:69], v[108:109]
  v_pk_fma_f32 v[112:113], v[84:85], v[84:85], v[112:113]
  v_pk_fma_f32 v[116:117], v[100:101], v[100:101], v[116:117]
  v_pk_fma_f32 v[104:105], v[54:55], v[54:55], v[104:105]
  v_pk_fma_f32 v[108:109], v[70:71], v[70:71], v[108:109]
  v_pk_fma_f32 v[112:113], v[86:87], v[86:87], v[112:113]
  v_pk_fma_f32 v[116:117], v[102:103], v[102:103], v[116:117]
  v_add_f32 v104, v104, v105
  v_add_f32 v108, v108, v109
  v_add_f32 v112, v112, v113
  v_add_f32 v116, v116, v117
  v_add_f32_dpp v104, v104, v104 row_ror:8 row_mask:0xf bank_mask:0xf
  v_add_f32_dpp v108, v108, v108 row_ror:8 row_mask:0xf bank_mask:0xf
  v_add_f32_dpp v112, v112, v112 row_ror:8 row_mask:0xf bank_mask:0xf
  v_add_f32_dpp v116, v116, v116 row_ror:8 row_mask:0xf bank_mask:0xf
  v_add_f32_dpp v104, v104, v104 row_ror:4 row_mask:0xf bank_mask:0xf
  v_add_f32_dpp v108, v108, v108 row_ror:4 row_mask:0xf bank_mask:0xf
  v_add_f32_dpp v112, v112, v112 row_ror:4 row_mask:0xf bank_mask:0xf
  v_add_f32_dpp v116, v116, v116 row_ror:4 row_mask:0xf bank_mask:0xf
  v_add_f32_dpp v104, v104, v104 row_ror:2 row_mask:0xf bank_mask:0xf
  v_add_f32_dpp v108, v108, v108 row_ror:2 row_mask:0xf bank_mask:0xf
  v_add_f32_dpp v112, v112, v112 row_ror:2 row_mask:0xf bank_mask:0xf
  v_add_f32_dpp v116, v116, v116 row_ror:2 row_mask:0xf bank_mask:0xf
  v_add_f32_dpp v104, v104, v104 row_ror:1 row_mask:0xf bank_mask:0xf
  v_add_f32_dpp v108, v108, v108 row_ror:1 row_mask:0xf bank_mask:0xf
  v_add_f32_dpp v112, v112, v112 row_ror:1 row_mask:0xf bank_mask:0xf
  v_add_f32_dpp v116, v116, v116 row_ror:1 row_mask:0xf bank_mask:0xf
  v_mov_b32 v105, v104
  v_mov_b32 v109, v108
  v_mov_b32 v113, v112
  v_mov_b32 v117, v116
  v_permlane16_swap_b32 v105, v104
  v_permlane16_swap_b32 v109, v108
  v_permlane16_swap_b32 v113, v112
  v_permlane16_swap_b32 v117, v116
  v_add_f32 v104, v104, v105
  v_add_f32 v108, v108, v109
  v_add_f32 v112, v112, v113
  v_add_f32 v116, v116, v117
  v_mov_b32 v105, v104
  v_mov_b32 v109, v108
  v_mov_b32 v113, v112
  v_mov_b32 v117, v116
  v_permlane32_swap_b32 v105, v104
  v_permlane32_swap_b32 v109, v108
  v_permlane32_swap_b32 v113, v112
  v_permlane32_swap_b32 v117, v116
  v_add_f32 v104, v104, v105
  v_add_f32 v108, v108, v109
  v_add_f32 v112, v112, v113
  v_add_f32 v116, v116, v117
  v_mul_f32 v104, 0x3a800000, v104
  v_mul_f32 v108, 0x3a800000, v108
  v_mul_f32 v112, 0x3a800000, v112
  v_mul_f32 v116, 0x3a800000, v116
  v_add_f32 v104, 0x3727c5ac, v104
  v_add_f32 v108, 0x3727c5ac, v108
  v_add_f32 v112, 0x3727c5ac, v112
  v_add_f32 v116, 0x3727c5ac, v116
  v_rsq_f32 v104, v104
  v_rsq_f32 v108, v108
  v_rsq_f32 v112, v112
  v_rsq_f32 v116, v116
  v_pk_mul_f32 v[40:41], v[40:41], v[104:105] op_sel_hi:[1,0]
  v_pk_mul_f32 v[56:57], v[56:57], v[108:109] op_sel_hi:[1,0]
  v_pk_mul_f32 v[72:73], v[72:73], v[112:113] op_sel_hi:[1,0]
  v_pk_mul_f32 v[88:89], v[88:89], v[116:117] op_sel_hi:[1,0]
  v_pk_mul_f32 v[42:43], v[42:43], v[104:105] op_sel_hi:[1,0]
  v_pk_mul_f32 v[58:59], v[58:59], v[108:109] op_sel_hi:[1,0]
  v_pk_mul_f32 v[74:75], v[74:75], v[112:113] op_sel_hi:[1,0]
  v_pk_mul_f32 v[90:91], v[90:91], v[116:117] op_sel_hi:[1,0]
  v_pk_mul_f32 v[44:45], v[44:45], v[104:105] op_sel_hi:[1,0]
  v_pk_mul_f32 v[60:61], v[60:61], v[108:109] op_sel_hi:[1,0]
  v_pk_mul_f32 v[76:77], v[76:77], v[112:113] op_sel_hi:[1,0]
  v_pk_mul_f32 v[92:93], v[92:93], v[116:117] op_sel_hi:[1,0]
  v_pk_mul_f32 v[46:47], v[46:47], v[104:105] op_sel_hi:[1,0]
  v_pk_mul_f32 v[62:63], v[62:63], v[108:109] op_sel_hi:[1,0]
  v_pk_mul_f32 v[78:79], v[78:79], v[112:113] op_sel_hi:[1,0]
  v_pk_mul_f32 v[94:95], v[94:95], v[116:117] op_sel_hi:[1,0]
  v_pk_mul_f32 v[48:49], v[48:49], v[104:105] op_sel_hi:[1,0]
  v_pk_mul_f32 v[64:65], v[64:65], v[108:109] op_sel_hi:[1,0]
  v_pk_mul_f32 v[80:81], v[80:81], v[112:113] op_sel_hi:[1,0]
  v_pk_mul_f32 v[96:97], v[96:97], v[116:117] op_sel_hi:[1,0]
  v_pk_mul_f32 v[50:51], v[50:51], v[104:105] op_sel_hi:[1,0]
  v_pk_mul_f32 v[66:67], v[66:67], v[108:109] op_sel_hi:[1,0]
  v_pk_mul_f32 v[82:83], v[82:83], v[112:113] op_sel_hi:[1,0]
  v_pk_mul_f32 v[98:99], v[98:99], v[116:117] op_sel_hi:[1,0]
  v_pk_mul_f32 v[52:53], v[52:53], v[104:105] op_sel_hi:[1,0]
  v_pk_mul_f32 v[68:69], v[68:69], v[108:109] op_sel_hi:[1,0]
  v_pk_mul_f32 v[84:85], v[84:85], v[112:113] op_sel_hi:[1,0]
  v_pk_mul_f32 v[100:101], v[100:101], v[116:117] op_sel_hi:[1,0]
  v_pk_mul_f32 v[54:55], v[54:55], v[104:105] op_sel_hi:[1,0]
  v_pk_mul_f32 v[70:71], v[70:71], v[108:109] op_sel_hi:[1,0]
  v_pk_mul_f32 v[86:87], v[86:87], v[112:113] op_sel_hi:[1,0]
  v_pk_mul_f32 v[102:103], v[102:103], v[116:117] op_sel_hi:[1,0]
  v_min_u32 v3, 31, v0
  v_lshlrev_b32 v3, 2, v3
  v_add_u32 v3, 128, v3
  s_nop 1
Lpoll_3:
  buffer_load_dword v4, v3, s[12:15], 0 offen sc1
  s_sub_u32 s24, s24, 1
  s_cbranch_scc1 L_FAIL
  s_waitcnt vmcnt(0)
  v_cmp_gt_i32 vcc, 1, v4
  s_cbranch_vccz Lpolld_4
  s_sleep 2
  s_branch Lpoll_3
Lpolld_4:
  v_min_u32 v3, 31, v0
  v_lshlrev_b32 v3, 7, v3
  v_add_u32 v3, 1376256, v3
  s_nop 1
Lpoll_5:
  buffer_load_dword v4, v3, s[4:7], 0 offen sc1
  s_sub_u32 s24, s24, 1
  s_cbranch_scc1 L_FAIL
  s_waitcnt vmcnt(0)
  v_cmp_gt_i32 vcc, 1, v4
  s_cbranch_vccz Lpolld_6
  s_sleep 2
  s_branch Lpoll_5
Lpolld_6:
  s_mov_b32 s40, 1572864
  buffer_load_dwordx4 v[136:139], v2, s[4:7], s40 offen offset:0 sc1
  buffer_load_dwordx4 v[140:143], v2, s[4:7], s40 offen offset:1024 sc1
  buffer_load_dwordx4 v[144:147], v2, s[4:7], s40 offen offset:2048 sc1
  buffer_load_dwordx4 v[148:151], v2, s[4:7], s40 offen offset:3072 sc1
  s_mov_b32 s40, 1576960
  buffer_load_dwordx4 v[120:123], v2, s[4:7], s40 offen offset:0 sc1
  buffer_load_dwordx4 v[124:127], v2, s[4:7], s40 offen offset:1024 sc1
  buffer_load_dwordx4 v[128:131], v2, s[4:7], s40 offen offset:2048 sc1
  buffer_load_dwordx4 v[132:135], v2, s[4:7], s40 offen offset:3072 sc1
  s_waitcnt vmcnt(0)
  v_add_f32 v120, 1.0, v120
  v_add_f32 v121, 1.0, v121
  v_add_f32 v122, 1.0, v122
  v_add_f32 v123, 1.0, v123
  v_add_f32 v124, 1.0, v124
  v_add_f32 v125, 1.0, v125
  v_add_f32 v126, 1.0, v126
  v_add_f32 v127, 1.0, v127
  v_add_f32 v128, 1.0, v128
  v_add_f32 v129, 1.0, v129
  v_add_f32 v130, 1.0, v130
  v_add_f32 v131, 1.0, v131
  v_add_f32 v132, 1.0, v132
  v_add_f32 v133, 1.0, v133
  v_add_f32 v134, 1.0, v134
  v_add_f32 v135, 1.0, v135
  s_add_u32 s44, s44, 2097152
  s_add_u32 s45, s45, 2097152
  v_pk_fma_f32 v[40:41], v[40:41], v[120:121], v[136:137]
  v_pk_fma_f32 v[42:43], v[42:43], v[122:123], v[138:139]
  v_pk_fma_f32 v[44:45], v[44:45], v[124:125], v[140:141]
  v_pk_fma_f32 v[46:47], v[46:47], v[126:127], v[142:143]
  v_pk_fma_f32 v[48:49], v[48:49], v[128:129], v[144:145]
  v_pk_fma_f32 v[50:51], v[50:51], v[130:131], v[146:147]
  v_pk_fma_f32 v[52:53], v[52:53], v[132:133], v[148:149]
  v_pk_fma_f32 v[54:55], v[54:55], v[134:135], v[150:151]
  v_cvt_pk_bf16_f32 v8, v40, v41
  v_cvt_pk_bf16_f32 v9, v42, v43
  v_cvt_pk_bf16_f32 v10, v44, v45
  v_cvt_pk_bf16_f32 v11, v46, v47
  v_cvt_pk_bf16_f32 v12, v48, v49
  v_cvt_pk_bf16_f32 v13, v50, v51
  v_cvt_pk_bf16_f32 v14, v52, v53
  v_cvt_pk_bf16_f32 v15, v54, v55
  buffer_store_dwordx4 v[8:11], v2, s[4:7], s44 offen offset:0 sc1
  buffer_store_dwordx4 v[12:15], v2, s[4:7], s44 offen offset:1024 sc1
  v_pk_fma_f32 v[56:57], v[56:57], v[120:121], v[136:137]
  v_pk_fma_f32 v[58:59], v[58:59], v[122:123], v[138:139]
  v_pk_fma_f32 v[60:61], v[60:61], v[124:125], v[140:141]
  v_pk_fma_f32 v[62:63], v[62:63], v[126:127], v[142:143]
  v_pk_fma_f32 v[64:65], v[64:65], v[128:129], v[144:145]
  v_pk_fma_f32 v[66:67], v[66:67], v[130:131], v[146:147]
  v_pk_fma_f32 v[68:69], v[68:69], v[132:133], v[148:149]
  v_pk_fma_f32 v[70:71], v[70:71], v[134:135], v[150:151]
  v_cvt_pk_bf16_f32 v16, v56, v57
  v_cvt_pk_bf16_f32 v17, v58, v59
  v_cvt_pk_bf16_f32 v18, v60, v61
  v_cvt_pk_bf16_f32 v19, v62, v63
  v_cvt_pk_bf16_f32 v20, v64, v65
  v_cvt_pk_bf16_f32 v21, v66, v67
  v_cvt_pk_bf16_f32 v22, v68, v69
  v_cvt_pk_bf16_f32 v23, v70, v71
  buffer_store_dwordx4 v[16:19], v2, s[4:7], s44 offen offset:2048 sc1
  buffer_store_dwordx4 v[20:23], v2, s[4:7], s44 offen offset:3072 sc1
  v_pk_fma_f32 v[72:73], v[72:73], v[120:121], v[136:137]
  v_pk_fma_f32 v[74:75], v[74:75], v[122:123], v[138:139]
  v_pk_fma_f32 v[76:77], v[76:77], v[124:125], v[140:141]
  v_pk_fma_f32 v[78:79], v[78:79], v[126:127], v[142:143]
  v_pk_fma_f32 v[80:81], v[80:81], v[128:129], v[144:145]
  v_pk_fma_f32 v[82:83], v[82:83], v[130:131], v[146:147]
  v_pk_fma_f32 v[84:85], v[84:85], v[132:133], v[148:149]
  v_pk_fma_f32 v[86:87], v[86:87], v[134:135], v[150:151]
  v_cvt_pk_bf16_f32 v24, v72, v73
  v_cvt_pk_bf16_f32 v25, v74, v75
  v_cvt_pk_bf16_f32 v26, v76, v77
  v_cvt_pk_bf16_f32 v27, v78, v79
  v_cvt_pk_bf16_f32 v28, v80, v81
  v_cvt_pk_bf16_f32 v29, v82, v83
  v_cvt_pk_bf16_f32 v30, v84, v85
  v_cvt_pk_bf16_f32 v31, v86, v87
  buffer_store_dwordx4 v[24:27], v2, s[4:7], s45 offen offset:0 sc1
  buffer_store_dwordx4 v[28:31], v2, s[4:7], s45 offen offset:1024 sc1
  v_pk_fma_f32 v[88:89], v[88:89], v[120:121], v[136:137]
  v_pk_fma_f32 v[90:91], v[90:91], v[122:123], v[138:139]
  v_pk_fma_f32 v[92:93], v[92:93], v[124:125], v[140:141]
  v_pk_fma_f32 v[94:95], v[94:95], v[126:127], v[142:143]
  v_pk_fma_f32 v[96:97], v[96:97], v[128:129], v[144:145]
  v_pk_fma_f32 v[98:99], v[98:99], v[130:131], v[146:147]
  v_pk_fma_f32 v[100:101], v[100:101], v[132:133], v[148:149]
  v_pk_fma_f32 v[102:103], v[102:103], v[134:135], v[150:151]
  v_cvt_pk_bf16_f32 v32, v88, v89
  v_cvt_pk_bf16_f32 v33, v90, v91
  v_cvt_pk_bf16_f32 v34, v92, v93
  v_cvt_pk_bf16_f32 v35, v94, v95
  v_cvt_pk_bf16_f32 v36, v96, v97
  v_cvt_pk_bf16_f32 v37, v98, v99
  v_cvt_pk_bf16_f32 v38, v100, v101
  v_cvt_pk_bf16_f32 v39, v102, v103
  buffer_store_dwordx4 v[32:35], v2, s[4:7], s45 offen offset:2048 sc1
  buffer_store_dwordx4 v[36:39], v2, s[4:7], s45 offen offset:3072 sc1
  s_lshr_b32 s40, s43, 3
  s_lshl_b32 s40, s40, 7
  s_and_b32 s41, s43, 7
  s_lshl_b32 s41, s41, 2
  s_add_u32 s40, s40, s41
  s_add_u32 s40, s40, 1388544
  v_mov_b32 v3, 2147483392
  s_mov_b64 exec, 1
  v_mov_b32 v3, s40
  s_mov_b64 exec, -1
  v_mov_b32 v4, 1
  s_waitcnt vmcnt(0)
  buffer_store_dword v4, v3, s[4:7], 0 offen sc1
  s_cmp_lg_u32 s20, 2
  s_cbranch_scc1 Lnotlb_7
  v_lshlrev_b32 v1, 21, v0
  s_mov_b32 s40, 0x1fff80
  buffer_load_dword v2, v1, s[4:7], s40 offen sc1
  s_add_u32 s40, s40, 134217728
  buffer_load_dword v2, v1, s[4:7], s40 offen sc1
  s_waitcnt vmcnt(0)
Lnotlb_7:
  s_mov_b32 s40, 1404928
  s_cmp_lt_u32 s22, 6
  s_cselect_b32 s40, 1404928, s40
  v_mov_b32 v1, s40
  s_nop 1
Lpoll_8:
  buffer_load_dword v2, v1, s[4:7], 0 offen sc1
  s_sub_u32 s24, s24, 1
  s_cbranch_scc1 L_FAIL
  s_waitcnt vmcnt(0)
  v_cmp_gt_i32 vcc, 0, v2
  s_cbranch_vccz Lpolld_9
  s_sleep 8
  s_branch Lpoll_8
Lpolld_9:
  s_sub_u32 s40, s22, 3
  s_lshl_b32 s40, s40, 5
  s_add_u32 s21, s40, s23
  s_cmp_lt_u32 s22, 6
  s_cbranch_scc1 L_MOD
L_ROLE:
  s_sub_u32 s21, s3, 128
  s_cmp_lt_u32 s3, 160
  s_cbranch_scc1 L_WO
  s_sub_u32 s21, s3, 160
  s_cmp_lt_u32 s3, 216
  s_cbranch_scc1 L_F1
  s_sub_u32 s21, s3, 216
  s_cmp_lt_u32 s3, 224
  s_cbranch_scc1 L_LN2
  s_sub_u32 s21, s3, 224
  s_cmp_lt_u32 s3, 248
  s_cbranch_scc1 L_F2
  s_sub_u32 s21, s3, 248
  s_branch L_FIN
L_FAIL:
  s_mov_b64 exec, -1
  s_lshl_b32 s40, s2, 8
  s_add_u32 s40, s40, s25
  s_add_u32 s40, s40, 0x70000000
  v_mov_b32 v1, 60
  v_mov_b32 v2, s40
  buffer_store_dword v2, v1, s[12:15], 0 offen
L_END:
  s_endpgm
L_LN2:
  s_load_dwordx2 s[16:17], s[0:1], 0
  s_mov_b32 s18, 4194304
  s_mov_b32 s19, 0x20000
  s_waitcnt lgkmcnt(0)
  s_mov_b32 s25, 0
  s_mov_b32 s29, 1
  s_mov_b32 s26, 0
  s_cmp_eq_u32 s20, 0
  s_cselect_b32 s31, 0, 2147483392
  s_lshl_b32 s40, s21, 8
  s_lshl_b32 s41, s20, 15
  s_add_u32 s40, s40, s41
  v_and_b32 v6, 15, v0
  v_lshl_add_u32 v1, v6, 4, s40
  v_lshrrev_b32 v6, 4, v0
  v_lshl_add_u32 v1, v6, 11, v1
  v_and_b32 v6, 3, v0
  v_lshrrev_b32 v7, 5, v0
  v_lshrrev_b32 v8, 2, v0
  s_lshl_b32 s40, s20, 10
  v_lshl_add_u32 v5, v8, 4, s40
  s_lshl_b32 s40, s21, 13
  s_lshl_b32 s41, s20, 9
  s_add_u32 s40, s40, s41
  v_and_b32 v9, 31, v0
  v_lshl_add_u32 v10, v9, 4, s40
  v_lshl_add_u32 v10, v7, 11, v10
  v_min_u32 v16, 63, v0
  v_lshlrev_b32 v16, 7, v16
  v_add_u32 v16, 1424384, v16
  s_nop 1
Lpoll_10:
  buffer_load_dword v17, v16, s[4:7], 0 offen sc1
  s_sub_u32 s24, s24, 1
  s_cbranch_scc1 L_FAIL
  s_waitcnt vmcnt(0)
  v_cmp_gt_i32 vcc, 0, v17
  s_cbranch_vccz Lpolld_11
  s_sleep 1
  s_branch Lpoll_10
Lpolld_11:
  v_lshrrev_b32 v17, 8, v17
  v_and_b32 v18, 3, v0
  v_lshl_or_b32 v17, v17, 2, v18
  s_nop 1
  v_min_u32_dpp v17, v17, v17 row_ror:8 row_mask:0xf bank_mask:0xf
  s_nop 1
  v_min_u32_dpp v17, v17, v17 row_ror:4 row_mask:0xf bank_mask:0xf
  v_mov_b32 v18, v17
  s_nop 1
  v_permlane16_swap_b32 v18, v17
  v_min_u32 v17, v17, v18
  v_mov_b32 v18, v17
  s_nop 1
  v_permlane32_swap_b32 v18, v17
  v_min_u32 v17, v17, v18
  s_nop 1
  v_min_u32_dpp v17, v17, v17 row_ror:2 row_mask:0xf bank_mask:0xf
  s_nop 1
  v_min_u32_dpp v17, v17, v17 row_ror:1 row_mask:0xf bank_mask:0xf
  s_nop 0
  v_readfirstlane_b32 s27, v17
  s_and_b32 s27, s27, 3
  s_lshl_b32 s27, s27, 13
  s_and_b32 s27, s27, 0x2000
  s_xor_b32 s27, s27, 16785408
  v_min_u32 v2, 63, v0
  v_lshlrev_b32 v2, 7, v2
  v_add_u32 v2, 1380352, v2
  s_nop 1
Lpoll_12:
  buffer_load_dword v3, v2, s[4:7], 0 offen sc1
  s_sub_u32 s24, s24, 1
  s_cbranch_scc1 L_FAIL
  s_waitcnt vmcnt(0)
  v_cmp_gt_i32 vcc, 1, v3
  s_cbranch_vccz Lpolld_13
  s_sleep 2
  s_branch Lpoll_12
Lpolld_13:
  s_mov_b32 s40, 1585152
  buffer_load_dwordx4 v[64:67], v5, s[4:7], s40 offen offset:0 sc1
  buffer_load_dwordx4 v[68:71], v5, s[4:7], s40 offen offset:256 sc1
  buffer_load_dwordx4 v[72:75], v5, s[4:7], s40 offen offset:512 sc1
  buffer_load_dwordx4 v[76:79], v5, s[4:7], s40 offen offset:768 sc1
  s_mov_b32 s40, 1589248
  buffer_load_dwordx4 v[80:83], v5, s[4:7], s40 offen offset:0 sc1
  buffer_load_dwordx4 v[84:87], v5, s[4:7], s40 offen offset:256 sc1
  buffer_load_dwordx4 v[88:91], v5, s[4:7], s40 offen offset:512 sc1
  buffer_load_dwordx4 v[92:95], v5, s[4:7], s40 offen offset:768 sc1
  s_mov_b32 s40, 1581056
  buffer_load_dwordx4 v[48:51], v5, s[4:7], s40 offen offset:0 sc1
  buffer_load_dwordx4 v[52:55], v5, s[4:7], s40 offen offset:256 sc1
  buffer_load_dwordx4 v[56:59], v5, s[4:7], s40 offen offset:512 sc1
  buffer_load_dwordx4 v[60:63], v5, s[4:7], s40 offen offset:768 sc1
  s_waitcnt vmcnt(0)
  v_lshrrev_b32 v48, 16, v48
  v_lshrrev_b32 v50, 16, v50
  v_lshrrev_b32 v52, 16, v52
  v_lshrrev_b32 v54, 16, v54
  v_lshrrev_b32 v56, 16, v56
  v_lshrrev_b32 v58, 16, v58
  v_lshrrev_b32 v60, 16, v60
  v_lshrrev_b32 v62, 16, v62
  v_add_f32 v80, 1.0, v80
  v_add_f32 v81, 1.0, v81
  v_add_f32 v82, 1.0, v82
  v_add_f32 v83, 1.0, v83
  v_add_f32 v84, 1.0, v84
  v_add_f32 v85, 1.0, v85
  v_add_f32 v86, 1.0, v86
  v_add_f32 v87, 1.0, v87
  v_add_f32 v88, 1.0, v88
  v_add_f32 v89, 1.0, v89
  v_add_f32 v90, 1.0, v90
  v_add_f32 v91, 1.0, v91
  v_add_f32 v92, 1.0, v92
  v_add_f32 v93, 1.0, v93
  v_add_f32 v94, 1.0, v94
  v_add_f32 v95, 1.0, v95
  v_min_u32 v2, 31, v0
  v_lshlrev_b32 v2, 7, v2
  v_add_u32 v2, 1409024, v2
  s_lshl_b32 s62, s21, 7
  s_add_u32 s62, s62, 1413120
  s_lshl_b32 s30, s20, 11
  v_lshl_add_u32 v11, v6, 9, s30
  v_lshl_add_u32 v11, v8, 3, v11
  s_lshl_b32 s40, s20, 5
  s_add_u32 s40, s40, 8192
  v_lshl_add_u32 v12, v6, 3, s40
  v_lshlrev_b32 v13, 3, v6
  v_add_u32 v13, 8192, v13
  s_add_u32 m0, s30, 0
  s_add_u32 s40, s26, 0
  buffer_load_dwordx4 v10, s[16:19], s40 offen nt lds
  s_add_u32 m0, s30, 1024
  s_add_u32 s40, s26, 4096
  buffer_load_dwordx4 v10, s[16:19], s40 offen nt lds
  buffer_load_dword v3, v2, s[4:7], s31 offen sc1
  s_waitcnt vmcnt(1)
  ds_read_b64 v[24:25], v11 offset:0
  ds_read_b64 v[26:27], v11 offset:128
  ds_read_b64 v[28:29], v11 offset:256
  ds_read_b64 v[30:31], v11 offset:384
  s_waitcnt lgkmcnt(0)
L_LN2_top:
  v_lshlrev_b32 v96, 16, v24
  v_and_b32 v97, 0xffff0000, v24
  v_lshlrev_b32 v98, 16, v25
  v_and_b32 v99, 0xffff0000, v25
  v_lshlrev_b32 v100, 16, v26
  v_and_b32 v101, 0xffff0000, v26
  v_lshlrev_b32 v102, 16, v27
  v_and_b32 v103, 0xffff0000, v27
  v_lshlrev_b32 v104, 16, v28
  v_and_b32 v105, 0xffff0000, v28
  v_lshlrev_b32 v106, 16, v29
  v_and_b32 v107, 0xffff0000, v29
  v_lshlrev_b32 v108, 16, v30
  v_and_b32 v109, 0xffff0000, v30
  v_lshlrev_b32 v110, 16, v31
  v_and_b32 v111, 0xffff0000, v31
  s_cmp_lg_u32 s20, 0
  s_cbranch_scc1 Lgo_14
  s_waitcnt vmcnt(0)
  v_cmp_gt_i32 vcc, s29, v3
  s_cbranch_vccz Lgo_14
  s_nop 3
Lpoll_15:
  buffer_load_dword v3, v2, s[4:7], 0 offen sc1
  s_sub_u32 s24, s24, 1
  s_cbranch_scc1 L_FAIL
  s_waitcnt vmcnt(0)
  v_cmp_gt_i32 vcc, s29, v3
  s_cbranch_vccz Lpolld_16
  s_sleep 1
  s_branch Lpoll_15
Lpolld_16:
Lgo_14:
  s_barrier
  s_add_u32 s40, s27, 0
  buffer_load_dwordx4 v[112:115], v1, s[4:7], s40 offen sc1
  s_add_u32 s40, s27, 16384
  buffer_load_dwordx4 v[116:119], v1, s[4:7], s40 offen sc1
  s_add_u32 s40, s27, 131072
  buffer_load_dwordx4 v[120:123], v1, s[4:7], s40 offen sc1
  s_add_u32 s40, s27, 147456
  buffer_load_dwordx4 v[124:127], v1, s[4:7], s40 offen sc1
  s_add_u32 s40, s27, 262144
  buffer_load_dwordx4 v[128:131], v1, s[4:7], s40 offen sc1
  s_add_u32 s40, s27, 278528
  buffer_load_dwordx4 v[132:135], v1, s[4:7], s40 offen sc1
  s_add_u32 s40, s27, 393216
  buffer_load_dwordx4 v[136:139], v1, s[4:7], s40 offen sc1
  s_add_u32 s40, s27, 409600
  buffer_load_dwordx4 v[140:143], v1, s[4:7], s40 offen sc1
  s_add_u32 m0, s30, 0
  s_add_u32 s40, s26, 65536
  buffer_load_dwordx4 v10, s[16:19], s40 offen nt lds
  s_add_u32 m0, s30, 1024
  s_add_u32 s40, s26, 69632
  buffer_load_dwordx4 v10, s[16:19], s40 offen nt lds
  s_waitcnt vmcnt(9)
  v_dot2c_f32_bf16 v96, v112, v48
  v_dot2c_f32_bf16 v97, v112, v49
  v_dot2c_f32_bf16 v98, v113, v50
  v_dot2c_f32_bf16 v99, v113, v51
  v_dot2c_f32_bf16 v100, v114, v52
  v_dot2c_f32_bf16 v101, v114, v53
  v_dot2c_f32_bf16 v102, v115, v54
  v_dot2c_f32_bf16 v103, v115, v55
  s_waitcnt vmcnt(8)
  v_dot2c_f32_bf16 v104, v116, v56
  v_dot2c_f32_bf16 v105, v116, v57
  v_dot2c_f32_bf16 v106, v117, v58
  v_dot2c_f32_bf16 v107, v117, v59
  v_dot2c_f32_bf16 v108, v118, v60
  v_dot2c_f32_bf16 v109, v118, v61
  v_dot2c_f32_bf16 v110, v119, v62
  v_dot2c_f32_bf16 v111, v119, v63
  s_waitcnt vmcnt(7)
  v_dot2c_f32_bf16 v96, v120, v48
  v_dot2c_f32_bf16 v97, v120, v49
  v_dot2c_f32_bf16 v98, v121, v50
  v_dot2c_f32_bf16 v99, v121, v51
  v_dot2c_f32_bf16 v100, v122, v52
  v_dot2c_f32_bf16 v101, v122, v53
  v_dot2c_f32_bf16 v102, v123, v54
  v_dot2c_f32_bf16 v103, v123, v55
  s_waitcnt vmcnt(6)
  v_dot2c_f32_bf16 v104, v124, v56
  v_dot2c_f32_bf16 v105, v124, v57
  v_dot2c_f32_bf16 v106, v125, v58
  v_dot2c_f32_bf16 v107, v125, v59
  v_dot2c_f32_bf16 v108, v126, v60
  v_dot2c_f32_bf16 v109, v126, v61
  v_dot2c_f32_bf16 v110, v127, v62
  v_dot2c_f32_bf16 v111, v127, v63
  s_waitcnt vmcnt(5)
  v_dot2c_f32_bf16 v96, v128, v48
  v_dot2c_f32_bf16 v97, v128, v49
  v_dot2c_f32_bf16 v98, v129, v50
  v_dot2c_f32_bf16 v99, v129, v51
  v_dot2c_f32_bf16 v100, v130, v52
  v_dot2c_f32_bf16 v101, v130, v53
  v_dot2c_f32_bf16 v102, v131, v54
  v_dot2c_f32_bf16 v103, v131, v55
  s_waitcnt vmcnt(4)
  v_dot2c_f32_bf16 v104, v132, v56
  v_dot2c_f32_bf16 v105, v132, v57
  v_dot2c_f32_bf16 v106, v133, v58
  v_dot2c_f32_bf16 v107, v133, v59
  v_dot2c_f32_bf16 v108, v134, v60
  v_dot2c_f32_bf16 v109, v134, v61
  v_dot2c_f32_bf16 v110, v135, v62
  v_dot2c_f32_bf16 v111, v135, v63
  s_waitcnt vmcnt(3)
  v_dot2c_f32_bf16 v96, v136, v48
  v_dot2c_f32_bf16 v97, v136, v49
  v_dot2c_f32_bf16 v98, v137, v50
  v_dot2c_f32_bf16 v99, v137, v51
  v_dot2c_f32_bf16 v100, v138, v52
  v_dot2c_f32_bf16 v101, v138, v53
  v_dot2c_f32_bf16 v102, v139, v54
  v_dot2c_f32_bf16 v103, v139, v55
  s_waitcnt vmcnt(2)
  v_dot2c_f32_bf16 v104, v140, v56
  v_dot2c_f32_bf16 v105, v140, v57
  v_dot2c_f32_bf16 v106, v141, v58
  v_dot2c_f32_bf16 v107, v141, v59
  v_dot2c_f32_bf16 v108, v142, v60
  v_dot2c_f32_bf16 v109, v142, v61
  v_dot2c_f32_bf16 v110, v143, v62
  v_dot2c_f32_bf16 v111, v143, v63
  s_nop 2
  v_pk_add_f32 v[32:33], v[96:97], v[98:99]
  v_pk_add_f32 v[32:33], v[32:33], v[100:101]
  v_pk_add_f32 v[32:33], v[32:33], v[102:103]
  v_pk_add_f32 v[32:33], v[32:33], v[104:105]
  v_pk_add_f32 v[32:33], v[32:33], v[106:107]
  v_pk_add_f32 v[32:33], v[32:33], v[108:109]
  v_pk_add_f32 v[32:33], v[32:33], v[110:111]
  v_add_f32 v32, v32, v33
  s_nop 1
  v_add_f32_dpp v32, v32, v32 row_ror:4 row_mask:0xf bank_mask:0xf
  s_nop 1
  v_add_f32_dpp v32, v32, v32 row_ror:8 row_mask:0xf bank_mask:0xf
  v_mov_b32 v33, v32
  s_nop 1
  v_permlane16_swap_b32 v33, v32
  v_add_f32 v32, v32, v33
  v_mov_b32 v33, v32
  s_nop 1
  v_permlane32_swap_b32 v33, v32
  v_add_f32 v32, v32, v33
  v_mul_f32 v32, 0x3b800000, v32
  v_pk_add_f32 v[112:113], v[96:97], v[32:33] op_sel_hi:[1,0] neg_lo:[0,1] neg_hi:[0,1]
  v_pk_add_f32 v[114:115], v[98:99], v[32:33] op_sel_hi:[1,0] neg_lo:[0,1] neg_hi:[0,1]
  v_pk_add_f32 v[116:117], v[100:101], v[32:33] op_sel_hi:[1,0] neg_lo:[0,1] neg_hi:[0,1]
  v_pk_add_f32 v[118:119], v[102:103], v[32:33] op_sel_hi:[1,0] neg_lo:[0,1] neg_hi:[0,1]
  v_pk_add_f32 v[120:121], v[104:105], v[32:33] op_sel_hi:[1,0] neg_lo:[0,1] neg_hi:[0,1]
  v_pk_add_f32 v[122:123], v[106:107], v[32:33] op_sel_hi:[1,0] neg_lo:[0,1] neg_hi:[0,1]
  v_pk_add_f32 v[124:125], v[108:109], v[32:33] op_sel_hi:[1,0] neg_lo:[0,1] neg_hi:[0,1]
  v_pk_add_f32 v[126:127], v[110:111], v[32:33] op_sel_hi:[1,0] neg_lo:[0,1] neg_hi:[0,1]
  v_pk_mul_f32 v[34:35], v[112:113], v[112:113]
  v_pk_fma_f32 v[34:35], v[114:115], v[114:115], v[34:35]
  v_pk_fma_f32 v[34:35], v[116:117], v[116:117], v[34:35]
  v_pk_fma_f32 v[34:35], v[118:119], v[118:119], v[34:35]
  v_pk_fma_f32 v[34:35], v[120:121], v[120:121], v[34:35]
  v_pk_fma_f32 v[34:35], v[122:123], v[122:123], v[34:35]
  v_pk_fma_f32 v[34:35], v[124:125], v[124:125], v[34:35]
  v_pk_fma_f32 v[34:35], v[126:127], v[126:127], v[34:35]
  v_add_f32 v34, v34, v35
  s_nop 1
  v_add_f32_dpp v34, v34, v34 row_ror:4 row_mask:0xf bank_mask:0xf
  s_nop 1
  v_add_f32_dpp v34, v34, v34 row_ror:8 row_mask:0xf bank_mask:0xf
  v_mov_b32 v35, v34
  s_nop 1
  v_permlane16_swap_b32 v35, v34
  v_add_f32 v34, v34, v35
  v_mov_b32 v35, v34
  s_nop 1
  v_permlane32_swap_b32 v35, v34
  v_add_f32 v34, v34, v35
  v_mov_b32 v33, v34
  ds_write_b64 v12, v[32:33]
  v_cvt_pk_bf16_f32 v16, v96, v97
  v_cvt_pk_bf16_f32 v17, v98, v99
  v_cvt_pk_bf16_f32 v18, v100, v101
  v_cvt_pk_bf16_f32 v19, v102, v103
  v_cvt_pk_bf16_f32 v20, v104, v105
  v_cvt_pk_bf16_f32 v21, v106, v107
  v_cvt_pk_bf16_f32 v22, v108, v109
  v_cvt_pk_bf16_f32 v23, v110, v111
  s_waitcnt lgkmcnt(0)
  s_barrier
  ds_read2_b64 v[36:39], v13 offset0:0 offset1:4
  ds_read2_b64 v[40:43], v13 offset0:8 offset1:12
  s_add_u32 s40, s27, 1048576
  buffer_store_dwordx4 v[16:19], v1, s[4:7], s40 offen sc1
  s_add_u32 s40, s27, 1064960
  buffer_store_dwordx4 v[20:23], v1, s[4:7], s40 offen sc1
  s_waitcnt lgkmcnt(0)
  v_pk_add_f32 v[34:35], v[36:37], v[38:39]
  v_pk_add_f32 v[44:45], v[40:41], v[42:43]
  v_pk_add_f32 v[34:35], v[34:35], v[44:45]
  v_mul_f32 v34, 0x3e800000, v34
  v_mul_f32 v35, 0x3b800000, v35
  v_sub_f32 v36, v36, v34
  v_sub_f32 v38, v38, v34
  v_sub_f32 v40, v40, v34
  v_sub_f32 v42, v42, v34
  v_fmac_f32 v35, v36, v36
  v_fmac_f32 v35, v38, v38
  v_fmac_f32 v35, v40, v40
  v_fmac_f32 v35, v42, v42
  v_mul_f32 v35, 0x3e800000, v35
  v_add_f32 v35, 0x3727c5ac, v35
  v_rsq_f32 v44, v35
  v_sub_f32 v32, v32, v34
  v_mul_f32 v32, v32, v44
  v_pk_fma_f32 v[112:113], v[112:113], v[44:45], v[32:33] op_sel_hi:[1,0,0]
  v_pk_fma_f32 v[114:115], v[114:115], v[44:45], v[32:33] op_sel_hi:[1,0,0]
  v_pk_fma_f32 v[116:117], v[116:117], v[44:45], v[32:33] op_sel_hi:[1,0,0]
  v_pk_fma_f32 v[118:119], v[118:119], v[44:45], v[32:33] op_sel_hi:[1,0,0]
  v_pk_fma_f32 v[112:113], v[112:113], v[80:81], v[64:65]
  v_pk_fma_f32 v[114:115], v[114:115], v[82:83], v[66:67]
  v_pk_fma_f32 v[116:117], v[116:117], v[84:85], v[68:69]
  v_pk_fma_f32 v[118:119], v[118:119], v[86:87], v[70:71]
  v_cvt_pk_bf16_f32 v128, v112, v113
  v_cvt_pk_bf16_f32 v129, v114, v115
  v_cvt_pk_bf16_f32 v130, v116, v117
  v_cvt_pk_bf16_f32 v131, v118, v119
  s_add_u32 s40, s27, 917504
  buffer_store_dwordx4 v[128:131], v1, s[4:7], s40 offen sc1
  v_pk_fma_f32 v[120:121], v[120:121], v[44:45], v[32:33] op_sel_hi:[1,0,0]
  v_pk_fma_f32 v[122:123], v[122:123], v[44:45], v[32:33] op_sel_hi:[1,0,0]
  v_pk_fma_f32 v[124:125], v[124:125], v[44:45], v[32:33] op_sel_hi:[1,0,0]
  v_pk_fma_f32 v[126:127], v[126:127], v[44:45], v[32:33] op_sel_hi:[1,0,0]
  v_pk_fma_f32 v[120:121], v[120:121], v[88:89], v[72:73]
  v_pk_fma_f32 v[122:123], v[122:123], v[90:91], v[74:75]
  v_pk_fma_f32 v[124:125], v[124:125], v[92:93], v[76:77]
  v_pk_fma_f32 v[126:127], v[126:127], v[94:95], v[78:79]
  v_cvt_pk_bf16_f32 v132, v120, v121
  v_cvt_pk_bf16_f32 v133, v122, v123
  v_cvt_pk_bf16_f32 v134, v124, v125
  v_cvt_pk_bf16_f32 v135, v126, v127
  s_add_u32 s40, s27, 933888
  buffer_store_dwordx4 v[132:135], v1, s[4:7], s40 offen sc1
  buffer_load_dword v3, v2, s[4:7], s31 offen sc1
  s_waitcnt vmcnt(5)
  ds_read_b64 v[24:25], v11 offset:0
  ds_read_b64 v[26:27], v11 offset:128
  ds_read_b64 v[28:29], v11 offset:256
  ds_read_b64 v[30:31], v11 offset:384
  s_waitcnt vmcnt(1) lgkmcnt(0)
  s_barrier
  s_cmp_lg_u32 s20, 0
  s_cbranch_scc1 Lnosig_17
  s_mov_b32 s63, s29
  s_atomic_smax s63, s[4:5], s62 glc
Lnosig_17:
  s_add_u32 s25, s25, 1
  s_add_u32 s29, s29, 1
  s_add_u32 s26, s26, 65536
  s_add_u32 s27, s27, 2097152
  s_xor_b32 s27, s27, 0x2000
  s_cmp_lt_u32 s25, 64
  s_cbranch_scc1 L_LN2_top
  s_branch L_END
L_FIN:
  s_load_dwordx2 s[16:17], s[0:1], 104
  s_mov_b32 s18, 4194304
  s_mov_b32 s19, 0x20000
  s_waitcnt lgkmcnt(0)
  s_mov_b32 s25, 0
  s_mov_b32 s29, 1
  s_mov_b32 s26, 0
  s_cmp_eq_u32 s20, 0
  s_cselect_b32 s31, 0, 2147483392
  s_lshl_b32 s40, s21, 8
  s_lshl_b32 s41, s20, 15
  s_add_u32 s40, s40, s41
  v_and_b32 v6, 15, v0
  v_lshl_add_u32 v1, v6, 4, s40
  v_lshrrev_b32 v6, 4, v0
  v_lshl_add_u32 v1, v6, 11, v1
  v_and_b32 v6, 3, v0
  v_lshrrev_b32 v7, 5, v0
  v_lshrrev_b32 v8, 2, v0
  s_lshl_b32 s40, s20, 10
  v_lshl_add_u32 v5, v8, 4, s40
  s_lshl_b32 s40, s21, 13
  s_lshl_b32 s41, s20, 9
  s_add_u32 s40, s40, s41
  v_and_b32 v9, 31, v0
  v_lshl_add_u32 v10, v9, 4, s40
  v_lshl_add_u32 v10, v7, 11, v10
  v_min_u32 v16, 63, v0
  v_lshlrev_b32 v16, 7, v16
  v_add_u32 v16, 1424384, v16
  s_nop 1
Lpoll_18:
  buffer_load_dword v17, v16, s[4:7], 0 offen sc1
  s_sub_u32 s24, s24, 1
  s_cbranch_scc1 L_FAIL
  s_waitcnt vmcnt(0)
  v_cmp_gt_i32 vcc, 0, v17
  s_cbranch_vccz Lpolld_19
  s_sleep 1
  s_branch Lpoll_18
Lpolld_19:
  v_lshrrev_b32 v17, 8, v17
  v_and_b32 v18, 3, v0
  v_lshl_or_b32 v17, v17, 2, v18
  s_nop 1
  v_min_u32_dpp v17, v17, v17 row_ror:8 row_mask:0xf bank_mask:0xf
  s_nop 1
  v_min_u32_dpp v17, v17, v17 row_ror:4 row_mask:0xf bank_mask:0xf
  v_mov_b32 v18, v17
  s_nop 1
  v_permlane16_swap_b32 v18, v17
  v_min_u32 v17, v17, v18
  v_mov_b32 v18, v17
  s_nop 1
  v_permlane32_swap_b32 v18, v17
  v_min_u32 v17, v17, v18
  s_nop 1
  v_min_u32_dpp v17, v17, v17 row_ror:2 row_mask:0xf bank_mask:0xf
  s_nop 1
  v_min_u32_dpp v17, v17, v17 row_ror:1 row_mask:0xf bank_mask:0xf
  s_nop 0
  v_readfirstlane_b32 s27, v17
  s_and_b32 s27, s27, 3
  s_lshl_b32 s27, s27, 13
  s_and_b32 s27, s27, 0x2000
  s_xor_b32 s27, s27, 16785408
  v_min_u32 v2, 63, v0
  v_lshlrev_b32 v2, 7, v2
  v_add_u32 v2, 1380352, v2
  s_nop 1
Lpoll_20:
  buffer_load_dword v3, v2, s[4:7], 0 offen sc1
  s_sub_u32 s24, s24, 1
  s_cbranch_scc1 L_FAIL
  s_waitcnt vmcnt(0)
  v_cmp_gt_i32 vcc, 1, v3
  s_cbranch_vccz Lpolld_21
  s_sleep 2
  s_branch Lpoll_20
Lpolld_21:
  s_mov_b32 s40, 1593344
  buffer_load_dwordx4 v[48:51], v5, s[4:7], s40 offen offset:0 sc1
  buffer_load_dwordx4 v[52:55], v5, s[4:7], s40 offen offset:256 sc1
  buffer_load_dwordx4 v[56:59], v5, s[4:7], s40 offen offset:512 sc1
  buffer_load_dwordx4 v[60:63], v5, s[4:7], s40 offen offset:768 sc1
  s_waitcnt vmcnt(0)
  v_lshrrev_b32 v48, 16, v48
  v_lshrrev_b32 v50, 16, v50
  v_lshrrev_b32 v52, 16, v52
  v_lshrrev_b32 v54, 16, v54
  v_lshrrev_b32 v56, 16, v56
  v_lshrrev_b32 v58, 16, v58
  v_lshrrev_b32 v60, 16, v60
  v_lshrrev_b32 v62, 16, v62
  v_min_u32 v2, 23, v0
  v_lshlrev_b32 v2, 7, v2
  v_add_u32 v2, 1421312, v2
  s_mul_i32 s30, s20, 2176
  v_mul_u32_u24 v11, 544, v6
  v_lshl_add_u32 v11, v8, 3, v11
  v_add_u32 v11, s30, v11
  v_mul_u32_u24 v12, 544, v7
  v_lshl_add_u32 v12, v9, 4, v12
  v_add_u32 v12, s30, v12
  buffer_load_dword v3, v2, s[4:7], s31 offen sc1
  s_nop 0
L_FIN_top:
  s_cmp_lg_u32 s20, 0
  s_cbranch_scc1 Lgo_22
  s_waitcnt vmcnt(0)
  v_cmp_gt_i32 vcc, s29, v3
  s_cbranch_vccz Lgo_22
  s_nop 3
Lpoll_23:
  buffer_load_dword v3, v2, s[4:7], 0 offen sc1
  s_sub_u32 s24, s24, 1
  s_cbranch_scc1 L_FAIL
  s_waitcnt vmcnt(0)
  v_cmp_gt_i32 vcc, s29, v3
  s_cbranch_vccz Lpolld_24
  s_sleep 1
  s_branch Lpoll_23
Lpolld_24:
Lgo_22:
  s_barrier
  s_add_u32 s40, s27, 1048576
  buffer_load_dwordx4 v[16:19], v1, s[4:7], s40 offen sc1
  s_add_u32 s40, s27, 1064960
  buffer_load_dwordx4 v[20:23], v1, s[4:7], s40 offen sc1
  s_add_u32 s40, s27, 524288
  buffer_load_dwordx4 v[112:115], v1, s[4:7], s40 offen sc1
  s_add_u32 s40, s27, 540672
  buffer_load_dwordx4 v[116:119], v1, s[4:7], s40 offen sc1
  s_add_u32 s40, s27, 655360
  buffer_load_dwordx4 v[120:123], v1, s[4:7], s40 offen sc1
  s_add_u32 s40, s27, 671744
  buffer_load_dwordx4 v[124:127], v1, s[4:7], s40 offen sc1
  s_add_u32 s40, s27, 786432
  buffer_load_dwordx4 v[128:131], v1, s[4:7], s40 offen sc1
  s_add_u32 s40, s27, 802816
  buffer_load_dwordx4 v[132:135], v1, s[4:7], s40 offen sc1
  s_waitcnt vmcnt(6)
  v_lshlrev_b32 v96, 16, v16
  v_and_b32 v97, 0xffff0000, v16
  v_lshlrev_b32 v98, 16, v17
  v_and_b32 v99, 0xffff0000, v17
  v_lshlrev_b32 v100, 16, v18
  v_and_b32 v101, 0xffff0000, v18
  v_lshlrev_b32 v102, 16, v19
  v_and_b32 v103, 0xffff0000, v19
  v_lshlrev_b32 v104, 16, v20
  v_and_b32 v105, 0xffff0000, v20
  v_lshlrev_b32 v106, 16, v21
  v_and_b32 v107, 0xffff0000, v21
  v_lshlrev_b32 v108, 16, v22
  v_and_b32 v109, 0xffff0000, v22
  v_lshlrev_b32 v110, 16, v23
  v_and_b32 v111, 0xffff0000, v23
  s_waitcnt vmcnt(5)
  v_dot2c_f32_bf16 v96, v112, v48
  v_dot2c_f32_bf16 v97, v112, v49
  v_dot2c_f32_bf16 v98, v113, v50
  v_dot2c_f32_bf16 v99, v113, v51
  v_dot2c_f32_bf16 v100, v114, v52
  v_dot2c_f32_bf16 v101, v114, v53
  v_dot2c_f32_bf16 v102, v115, v54
  v_dot2c_f32_bf16 v103, v115, v55
  s_waitcnt vmcnt(4)
  v_dot2c_f32_bf16 v104, v116, v56
  v_dot2c_f32_bf16 v105, v116, v57
  v_dot2c_f32_bf16 v106, v117, v58
  v_dot2c_f32_bf16 v107, v117, v59
  v_dot2c_f32_bf16 v108, v118, v60
  v_dot2c_f32_bf16 v109, v118, v61
  v_dot2c_f32_bf16 v110, v119, v62
  v_dot2c_f32_bf16 v111, v119, v63
  s_waitcnt vmcnt(3)
  v_dot2c_f32_bf16 v96, v120, v48
  v_dot2c_f32_bf16 v97, v120, v49
  v_dot2c_f32_bf16 v98, v121, v50
  v_dot2c_f32_bf16 v99, v121, v51
  v_dot2c_f32_bf16 v100, v122, v52
  v_dot2c_f32_bf16 v101, v122, v53
  v_dot2c_f32_bf16 v102, v123, v54
  v_dot2c_f32_bf16 v103, v123, v55
  s_waitcnt vmcnt(2)
  v_dot2c_f32_bf16 v104, v124, v56
  v_dot2c_f32_bf16 v105, v124, v57
  v_dot2c_f32_bf16 v106, v125, v58
  v_dot2c_f32_bf16 v107, v125, v59
  v_dot2c_f32_bf16 v108, v126, v60
  v_dot2c_f32_bf16 v109, v126, v61
  v_dot2c_f32_bf16 v110, v127, v62
  v_dot2c_f32_bf16 v111, v127, v63
  s_waitcnt vmcnt(1)
  v_dot2c_f32_bf16 v96, v128, v48
  v_dot2c_f32_bf16 v97, v128, v49
  v_dot2c_f32_bf16 v98, v129, v50
  v_dot2c_f32_bf16 v99, v129, v51
  v_dot2c_f32_bf16 v100, v130, v52
  v_dot2c_f32_bf16 v101, v130, v53
  v_dot2c_f32_bf16 v102, v131, v54
  v_dot2c_f32_bf16 v103, v131, v55
  s_waitcnt vmcnt(0)
  v_dot2c_f32_bf16 v104, v132, v56
  v_dot2c_f32_bf16 v105, v132, v57
  v_dot2c_f32_bf16 v106, v133, v58
  v_dot2c_f32_bf16 v107, v133, v59
  v_dot2c_f32_bf16 v108, v134, v60
  v_dot2c_f32_bf16 v109, v134, v61
  v_dot2c_f32_bf16 v110, v135, v62
  v_dot2c_f32_bf16 v111, v135, v63
  s_nop 2
  buffer_load_dword v3, v2, s[4:7], s31 offen sc1
  v_cvt_pk_bf16_f32 v16, v96, v97
  v_cvt_pk_bf16_f32 v17, v98, v99
  v_cvt_pk_bf16_f32 v18, v100, v101
  v_cvt_pk_bf16_f32 v19, v102, v103
  v_cvt_pk_bf16_f32 v20, v104, v105
  v_cvt_pk_bf16_f32 v21, v106, v107
  v_cvt_pk_bf16_f32 v22, v108, v109
  v_cvt_pk_bf16_f32 v23, v110, v111
  ds_write_b64 v11, v[16:17] offset:0
  ds_write_b64 v11, v[18:19] offset:128
  ds_write_b64 v11, v[20:21] offset:256
  ds_write_b64 v11, v[22:23] offset:384
  ds_read_b128 v[112:115], v12 offset:0
  ds_read_b128 v[116:119], v12 offset:1088
  s_add_u32 s40, s26, 0
  s_waitcnt lgkmcnt(1)
  buffer_store_dwordx4 v[112:115], v10, s[16:19], s40 offen
  s_add_u32 s40, s26, 4096
  s_waitcnt lgkmcnt(0)
  buffer_store_dwordx4 v[116:119], v10, s[16:19], s40 offen
  s_add_u32 s25, s25, 1
  s_add_u32 s29, s29, 1
  s_add_u32 s26, s26, 65536
  s_add_u32 s27, s27, 2097152
  s_xor_b32 s27, s27, 0x2000
  s_cmp_lt_u32 s25, 64
  s_cbranch_scc1 L_FIN_top
  s_branch L_END
L_QKV:
  v_lshrrev_b32 v60, 3, v0
  v_and_b32 v61, 6, v60
  v_xor_b32 v61, v61, v0
  v_and_b32 v61, 7, v61
  v_lshlrev_b32 v61, 4, v61
  v_lshl_add_u32 v1, v60, 11, v61
  s_lshl_b32 s40, s20, 14
  v_add_u32 v1, s40, v1
  s_lshl_b32 s32, s20, 10
  v_and_b32 v60, 6, v0
  v_lshrrev_b32 v61, 4, v0
  v_xor_b32 v60, v60, v61
  v_lshlrev_b32 v60, 4, v60
  v_and_b32 v61, 15, v0
  v_lshl_add_u32 v77, v61, 7, v60
  v_xor_b32 v78, 64, v77
  s_and_b32 s43, s21, 1
  s_lshr_b32 s44, s21, 1
  s_lshl_b32 s44, s44, 8
  s_add_u32 s45, s44, 128
  s_lshl_b32 s46, s43, 7
  s_add_u32 s46, s46, s44
  s_load_dwordx4 s[48:51], s[0:1], 16
  s_waitcnt lgkmcnt(0)
  s_cmp_eq_u32 s43, 0
  s_cselect_b32 s8, s48, s50
  s_cselect_b32 s9, s49, s51
  s_mov_b32 s10, 8388608
  s_mov_b32 s11, 0x20000
  v_bfe_u32 v4, v0, 5, 1
  v_mul_u32_u24 v4, 32768, v4
  v_bfe_u32 v5, v0, 4, 1
  v_mul_u32_u24 v5, 16384, v5
  v_add_u32 v4, v4, v5
  v_bfe_u32 v5, v0, 3, 1
  v_mul_u32_u24 v5, 8192, v5
  v_add_u32 v4, v4, v5
  v_lshrrev_b32 v5, 3, v0
  v_and_b32 v5, 6, v5
  v_xor_b32 v5, v5, v0
  v_and_b32 v5, 7, v5
  v_lshl_add_u32 v4, v5, 4, v4
  s_lshr_b32 s40, s20, 1
  s_mul_i32 s40, s40, 2097152
  s_and_b32 s41, s20, 1
  s_mul_i32 s41, s41, 65536
  s_add_u32 s40, s40, s41
  v_add_u32 v4, s40, v4
  v_bfe_u32 v5, v0, 3, 2
  v_xor_b32 v5, s20, v5
  v_lshlrev_b32 v5, 5, v5
  v_lshrrev_b32 v6, 2, v0
  v_lshl_add_u32 v6, v6, 7, v5
  v_and_b32 v5, 3, v0
  v_lshl_add_u32 v6, v5, 3, v6
  v_add_u32 v7, 0x10000, v6
  v_add_u32 v8, s44, v4
  v_add_u32 v9, s45, v4
  v_add_u32 v10, s46, v4
  s_lshl_b32 s41, s20, 10
  s_add_u32 m0, s41, 0
  s_mov_b32 s42, 0
  buffer_load_dwordx4 v8, s[8:11], s42 offen lds
  s_add_u32 m0, s41, 4096
  s_mov_b32 s42, 0
  buffer_load_dwordx4 v9, s[8:11], s42 offen lds
  s_add_u32 m0, s41, 8192
  s_mov_b32 s42, 131072
  buffer_load_dwordx4 v8, s[8:11], s42 offen lds
  s_add_u32 m0, s41, 12288
  s_mov_b32 s42, 131072
  buffer_load_dwordx4 v9, s[8:11], s42 offen lds
  s_add_u32 m0, s41, 16384
  s_mov_b32 s42, 262144
  buffer_load_dwordx4 v8, s[8:11], s42 offen lds
  s_add_u32 m0, s41, 20480
  s_mov_b32 s42, 262144
  buffer_load_dwordx4 v9, s[8:11], s42 offen lds
  s_add_u32 m0, s41, 24576
  s_mov_b32 s42, 393216
  buffer_load_dwordx4 v8, s[8:11], s42 offen lds
  s_add_u32 m0, s41, 28672
  s_mov_b32 s42, 393216
  buffer_load_dwordx4 v9, s[8:11], s42 offen lds
  s_add_u32 m0, s41, 32768
  s_mov_b32 s42, 524288
  buffer_load_dwordx4 v8, s[8:11], s42 offen lds
  s_add_u32 m0, s41, 36864
  s_mov_b32 s42, 524288
  buffer_load_dwordx4 v9, s[8:11], s42 offen lds
  s_add_u32 m0, s41, 40960
  s_mov_b32 s42, 655360
  buffer_load_dwordx4 v8, s[8:11], s42 offen lds
  s_add_u32 m0, s41, 45056
  s_mov_b32 s42, 655360
  buffer_load_dwordx4 v9, s[8:11], s42 offen lds
  s_add_u32 m0, s41, 49152
  s_mov_b32 s42, 786432
  buffer_load_dwordx4 v8, s[8:11], s42 offen lds
  s_add_u32 m0, s41, 53248
  s_mov_b32 s42, 786432
  buffer_load_dwordx4 v9, s[8:11], s42 offen lds
  s_add_u32 m0, s41, 57344
  s_mov_b32 s42, 917504
  buffer_load_dwordx4 v8, s[8:11], s42 offen lds
  s_add_u32 m0, s41, 61440
  s_mov_b32 s42, 917504
  buffer_load_dwordx4 v9, s[8:11], s42 offen lds
  s_add_u32 m0, s41, 65536
  s_mov_b32 s42, 1048576
  buffer_load_dwordx4 v8, s[8:11], s42 offen lds
  s_add_u32 m0, s41, 69632
  s_mov_b32 s42, 1048576
  buffer_load_dwordx4 v9, s[8:11], s42 offen lds
  s_add_u32 m0, s41, 73728
  s_mov_b32 s42, 1179648
  buffer_load_dwordx4 v8, s[8:11], s42 offen lds
  s_add_u32 m0, s41, 77824
  s_mov_b32 s42, 1179648
  buffer_load_dwordx4 v9, s[8:11], s42 offen lds
  s_add_u32 m0, s41, 81920
  s_mov_b32 s42, 1310720
  buffer_load_dwordx4 v8, s[8:11], s42 offen lds
  s_add_u32 m0, s41, 86016
  s_mov_b32 s42, 1310720
  buffer_load_dwordx4 v9, s[8:11], s42 offen lds
  s_add_u32 m0, s41, 90112
  s_mov_b32 s42, 1441792
  buffer_load_dwordx4 v8, s[8:11], s42 offen lds
  s_add_u32 m0, s41, 94208
  s_mov_b32 s42, 1441792
  buffer_load_dwordx4 v9, s[8:11], s42 offen lds
  s_add_u32 m0, s41, 98304
  s_mov_b32 s42, 1572864
  buffer_load_dwordx4 v8, s[8:11], s42 offen lds
  s_add_u32 m0, s41, 102400
  s_mov_b32 s42, 1572864
  buffer_load_dwordx4 v9, s[8:11], s42 offen lds
  s_add_u32 m0, s41, 106496
  s_mov_b32 s42, 1703936
  buffer_load_dwordx4 v8, s[8:11], s42 offen lds
  s_add_u32 m0, s41, 110592
  s_mov_b32 s42, 1703936
  buffer_load_dwordx4 v9, s[8:11], s42 offen lds
  s_waitcnt vmcnt(24) lgkmcnt(0)
  s_barrier
  s_add_u32 m0, s41, 114688
  s_mov_b32 s42, 1835008
  buffer_load_dwordx4 v8, s[8:11], s42 offen lds
  s_add_u32 m0, s41, 118784
  s_mov_b32 s42, 1835008
  buffer_load_dwordx4 v9, s[8:11], s42 offen lds
  s_add_u32 m0, s41, 122880
  s_mov_b32 s42, 1966080
  buffer_load_dwordx4 v8, s[8:11], s42 offen lds
  s_add_u32 m0, s41, 126976
  s_mov_b32 s42, 1966080
  buffer_load_dwordx4 v9, s[8:11], s42 offen lds
  ds_read_b64_tr_b16 a[0:1], v6 offset:0
  ds_read_b64_tr_b16 a[2:3], v6 offset:2048
  ds_read_b64_tr_b16 a[128:129], v6 offset:4096
  ds_read_b64_tr_b16 a[130:131], v6 offset:6144
  ds_read_b64_tr_b16 a[4:5], v6 offset:8192
  ds_read_b64_tr_b16 a[6:7], v6 offset:10240
  ds_read_b64_tr_b16 a[132:133], v6 offset:12288
  ds_read_b64_tr_b16 a[134:135], v6 offset:14336
  s_waitcnt vmcnt(24) lgkmcnt(0)
  s_barrier
  s_add_u32 m0, s41, 0
  s_mov_b32 s42, 4194304
  buffer_load_dwordx4 v8, s[8:11], s42 offen lds
  s_add_u32 m0, s41, 4096
  s_mov_b32 s42, 4194304
  buffer_load_dwordx4 v9, s[8:11], s42 offen lds
  s_add_u32 m0, s41, 8192
  s_mov_b32 s42, 4325376
  buffer_load_dwordx4 v8, s[8:11], s42 offen lds
  s_add_u32 m0, s41, 12288
  s_mov_b32 s42, 4325376
  buffer_load_dwordx4 v9, s[8:11], s42 offen lds
  ds_read_b64_tr_b16 a[8:9], v6 offset:16384
  ds_read_b64_tr_b16 a[10:11], v6 offset:18432
  ds_read_b64_tr_b16 a[136:137], v6 offset:20480
  ds_read_b64_tr_b16 a[138:139], v6 offset:22528
  ds_read_b64_tr_b16 a[12:13], v6 offset:24576
  ds_read_b64_tr_b16 a[14:15], v6 offset:26624
  ds_read_b64_tr_b16 a[140:141], v6 offset:28672
  ds_read_b64_tr_b16 a[142:143], v6 offset:30720
  s_waitcnt vmcnt(24) lgkmcnt(0)
  s_barrier
  s_add_u32 m0, s41, 16384
  s_mov_b32 s42, 4456448
  buffer_load_dwordx4 v8, s[8:11], s42 offen lds
  s_add_u32 m0, s41, 20480
  s_mov_b32 s42, 4456448
  buffer_load_dwordx4 v9, s[8:11], s42 offen lds
  s_add_u32 m0, s41, 24576
  s_mov_b32 s42, 4587520
  buffer_load_dwordx4 v8, s[8:11], s42 offen lds
  s_add_u32 m0, s41, 28672
  s_mov_b32 s42, 4587520
  buffer_load_dwordx4 v9, s[8:11], s42 offen lds
  ds_read_b64_tr_b16 a[16:17], v6 offset:32768
  ds_read_b64_tr_b16 a[18:19], v6 offset:34816
  ds_read_b64_tr_b16 a[144:145], v6 offset:36864
  ds_read_b64_tr_b16 a[146:147], v6 offset:38912
  ds_read_b64_tr_b16 a[20:21], v6 offset:40960
  ds_read_b64_tr_b16 a[22:23], v6 offset:43008
  ds_read_b64_tr_b16 a[148:149], v6 offset:45056
  ds_read_b64_tr_b16 a[150:151], v6 offset:47104
  s_waitcnt vmcnt(24) lgkmcnt(0)
  s_barrier
  s_add_u32 m0, s41, 32768
  s_mov_b32 s42, 4718592
  buffer_load_dwordx4 v8, s[8:11], s42 offen lds
  s_add_u32 m0, s41, 36864
  s_mov_b32 s42, 4718592
  buffer_load_dwordx4 v9, s[8:11], s42 offen lds
  s_add_u32 m0, s41, 40960
  s_mov_b32 s42, 4849664
  buffer_load_dwordx4 v8, s[8:11], s42 offen lds
  s_add_u32 m0, s41, 45056
  s_mov_b32 s42, 4849664
  buffer_load_dwordx4 v9, s[8:11], s42 offen lds
  ds_read_b64_tr_b16 a[24:25], v6 offset:49152
  ds_read_b64_tr_b16 a[26:27], v6 offset:51200
  ds_read_b64_tr_b16 a[152:153], v6 offset:53248
  ds_read_b64_tr_b16 a[154:155], v6 offset:55296
  ds_read_b64_tr_b16 a[28:29], v6 offset:57344
  ds_read_b64_tr_b16 a[30:31], v6 offset:59392
  ds_read_b64_tr_b16 a[156:157], v6 offset:61440
  ds_read_b64_tr_b16 a[158:159], v6 offset:63488
  s_waitcnt vmcnt(24) lgkmcnt(0)
  s_barrier
  s_add_u32 m0, s41, 49152
  s_mov_b32 s42, 4980736
  buffer_load_dwordx4 v8, s[8:11], s42 offen lds
  s_add_u32 m0, s41, 53248
  s_mov_b32 s42, 4980736
  buffer_load_dwordx4 v9, s[8:11], s42 offen lds
  s_add_u32 m0, s41, 57344
  s_mov_b32 s42, 5111808
  buffer_load_dwordx4 v8, s[8:11], s42 offen lds
  s_add_u32 m0, s41, 61440
  s_mov_b32 s42, 5111808
  buffer_load_dwordx4 v9, s[8:11], s42 offen lds
  ds_read_b64_tr_b16 a[32:33], v7 offset:0
  ds_read_b64_tr_b16 a[34:35], v7 offset:2048
  ds_read_b64_tr_b16 a[160:161], v7 offset:4096
  ds_read_b64_tr_b16 a[162:163], v7 offset:6144
  ds_read_b64_tr_b16 a[36:37], v7 offset:8192
  ds_read_b64_tr_b16 a[38:39], v7 offset:10240
  ds_read_b64_tr_b16 a[164:165], v7 offset:12288
  ds_read_b64_tr_b16 a[166:167], v7 offset:14336
  s_waitcnt vmcnt(24) lgkmcnt(0)
  s_barrier
  s_add_u32 m0, s41, 65536
  s_mov_b32 s42, 5242880
  buffer_load_dwordx4 v8, s[8:11], s42 offen lds
  s_add_u32 m0, s41, 69632
  s_mov_b32 s42, 5242880
  buffer_load_dwordx4 v9, s[8:11], s42 offen lds
  s_add_u32 m0, s41, 73728
  s_mov_b32 s42, 5373952
  buffer_load_dwordx4 v8, s[8:11], s42 offen lds
  s_add_u32 m0, s41, 77824
  s_mov_b32 s42, 5373952
  buffer_load_dwordx4 v9, s[8:11], s42 offen lds
  ds_read_b64_tr_b16 a[40:41], v7 offset:16384
  ds_read_b64_tr_b16 a[42:43], v7 offset:18432
  ds_read_b64_tr_b16 a[168:169], v7 offset:20480
  ds_read_b64_tr_b16 a[170:171], v7 offset:22528
  ds_read_b64_tr_b16 a[44:45], v7 offset:24576
  ds_read_b64_tr_b16 a[46:47], v7 offset:26624
  ds_read_b64_tr_b16 a[172:173], v7 offset:28672
  ds_read_b64_tr_b16 a[174:175], v7 offset:30720
  s_waitcnt vmcnt(24) lgkmcnt(0)
  s_barrier
  s_add_u32 m0, s41, 81920
  s_mov_b32 s42, 5505024
  buffer_load_dwordx4 v8, s[8:11], s42 offen lds
  s_add_u32 m0, s41, 86016
  s_mov_b32 s42, 5505024
  buffer_load_dwordx4 v9, s[8:11], s42 offen lds
  s_add_u32 m0, s41, 90112
  s_mov_b32 s42, 5636096
  buffer_load_dwordx4 v8, s[8:11], s42 offen lds
  s_add_u32 m0, s41, 94208
  s_mov_b32 s42, 5636096
  buffer_load_dwordx4 v9, s[8:11], s42 offen lds
  ds_read_b64_tr_b16 a[48:49], v7 offset:32768
  ds_read_b64_tr_b16 a[50:51], v7 offset:34816
  ds_read_b64_tr_b16 a[176:177], v7 offset:36864
  ds_read_b64_tr_b16 a[178:179], v7 offset:38912
  ds_read_b64_tr_b16 a[52:53], v7 offset:40960
  ds_read_b64_tr_b16 a[54:55], v7 offset:43008
  ds_read_b64_tr_b16 a[180:181], v7 offset:45056
  ds_read_b64_tr_b16 a[182:183], v7 offset:47104
  s_waitcnt vmcnt(24) lgkmcnt(0)
  s_barrier
  s_add_u32 m0, s41, 98304
  s_mov_b32 s42, 5767168
  buffer_load_dwordx4 v8, s[8:11], s42 offen lds
  s_add_u32 m0, s41, 102400
  s_mov_b32 s42, 5767168
  buffer_load_dwordx4 v9, s[8:11], s42 offen lds
  s_add_u32 m0, s41, 106496
  s_mov_b32 s42, 5898240
  buffer_load_dwordx4 v8, s[8:11], s42 offen lds
  s_add_u32 m0, s41, 110592
  s_mov_b32 s42, 5898240
  buffer_load_dwordx4 v9, s[8:11], s42 offen lds
  ds_read_b64_tr_b16 a[56:57], v7 offset:49152
  ds_read_b64_tr_b16 a[58:59], v7 offset:51200
  ds_read_b64_tr_b16 a[184:185], v7 offset:53248
  ds_read_b64_tr_b16 a[186:187], v7 offset:55296
  ds_read_b64_tr_b16 a[60:61], v7 offset:57344
  ds_read_b64_tr_b16 a[62:63], v7 offset:59392
  ds_read_b64_tr_b16 a[188:189], v7 offset:61440
  ds_read_b64_tr_b16 a[190:191], v7 offset:63488
  s_waitcnt vmcnt(24) lgkmcnt(0)
  s_barrier
  s_add_u32 m0, s41, 114688
  s_mov_b32 s42, 6029312
  buffer_load_dwordx4 v8, s[8:11], s42 offen lds
  s_add_u32 m0, s41, 118784
  s_mov_b32 s42, 6029312
  buffer_load_dwordx4 v9, s[8:11], s42 offen lds
  s_add_u32 m0, s41, 122880
  s_mov_b32 s42, 6160384
  buffer_load_dwordx4 v8, s[8:11], s42 offen lds
  s_add_u32 m0, s41, 126976
  s_mov_b32 s42, 6160384
  buffer_load_dwordx4 v9, s[8:11], s42 offen lds
  ds_read_b64_tr_b16 a[64:65], v6 offset:0
  ds_read_b64_tr_b16 a[66:67], v6 offset:2048
  ds_read_b64_tr_b16 a[192:193], v6 offset:4096
  ds_read_b64_tr_b16 a[194:195], v6 offset:6144
  ds_read_b64_tr_b16 a[68:69], v6 offset:8192
  ds_read_b64_tr_b16 a[70:71], v6 offset:10240
  ds_read_b64_tr_b16 a[196:197], v6 offset:12288
  ds_read_b64_tr_b16 a[198:199], v6 offset:14336
  s_waitcnt vmcnt(24) lgkmcnt(0)
  s_barrier
  s_load_dwordx2 s[8:9], s[0:1], 32
  s_mov_b32 s10, 8388608
  s_mov_b32 s11, 0x20000
  s_waitcnt lgkmcnt(0)
  s_add_u32 m0, s41, 0
  s_mov_b32 s42, 0
  buffer_load_dwordx4 v10, s[8:11], s42 offen lds
  s_add_u32 m0, s41, 4096
  s_mov_b32 s42, 131072
  buffer_load_dwordx4 v10, s[8:11], s42 offen lds
  s_add_u32 m0, s41, 8192
  s_mov_b32 s42, 262144
  buffer_load_dwordx4 v10, s[8:11], s42 offen lds
  s_add_u32 m0, s41, 12288
  s_mov_b32 s42, 393216
  buffer_load_dwordx4 v10, s[8:11], s42 offen lds
  ds_read_b64_tr_b16 a[72:73], v6 offset:16384
  ds_read_b64_tr_b16 a[74:75], v6 offset:18432
  ds_read_b64_tr_b16 a[200:201], v6 offset:20480
  ds_read_b64_tr_b16 a[202:203], v6 offset:22528
  ds_read_b64_tr_b16 a[76:77], v6 offset:24576
  ds_read_b64_tr_b16 a[78:79], v6 offset:26624
  ds_read_b64_tr_b16 a[204:205], v6 offset:28672
  ds_read_b64_tr_b16 a[206:207], v6 offset:30720
  s_waitcnt vmcnt(24) lgkmcnt(0)
  s_barrier
  s_add_u32 m0, s41, 16384
  s_mov_b32 s42, 524288
  buffer_load_dwordx4 v10, s[8:11], s42 offen lds
  s_add_u32 m0, s41, 20480
  s_mov_b32 s42, 655360
  buffer_load_dwordx4 v10, s[8:11], s42 offen lds
  s_add_u32 m0, s41, 24576
  s_mov_b32 s42, 786432
  buffer_load_dwordx4 v10, s[8:11], s42 offen lds
  s_add_u32 m0, s41, 28672
  s_mov_b32 s42, 917504
  buffer_load_dwordx4 v10, s[8:11], s42 offen lds
  ds_read_b64_tr_b16 a[80:81], v6 offset:32768
  ds_read_b64_tr_b16 a[82:83], v6 offset:34816
  ds_read_b64_tr_b16 a[208:209], v6 offset:36864
  ds_read_b64_tr_b16 a[210:211], v6 offset:38912
  ds_read_b64_tr_b16 a[84:85], v6 offset:40960
  ds_read_b64_tr_b16 a[86:87], v6 offset:43008
  ds_read_b64_tr_b16 a[212:213], v6 offset:45056
  ds_read_b64_tr_b16 a[214:215], v6 offset:47104
  s_cmp_lg_u32 s20, 0
  s_cbranch_scc1 L_QKV_noinit
Lini_25:
  s_load_dwordx16 s[64:79], s[12:13], 128 glc
  s_load_dwordx16 s[80:95], s[12:13], 192 glc
  s_sub_u32 s24, s24, 1
  s_cbranch_scc1 L_FAIL
  s_waitcnt lgkmcnt(0)
  s_and_b64 s[64:65], s[64:65], s[66:67]
  s_and_b64 s[64:65], s[64:65], s[68:69]
  s_and_b64 s[64:65], s[64:65], s[70:71]
  s_and_b64 s[64:65], s[64:65], s[72:73]
  s_and_b64 s[64:65], s[64:65], s[74:75]
  s_and_b64 s[64:65], s[64:65], s[76:77]
  s_and_b64 s[64:65], s[64:65], s[78:79]
  s_and_b64 s[64:65], s[64:65], s[80:81]
  s_and_b64 s[64:65], s[64:65], s[82:83]
  s_and_b64 s[64:65], s[64:65], s[84:85]
  s_and_b64 s[64:65], s[64:65], s[86:87]
  s_and_b64 s[64:65], s[64:65], s[88:89]
  s_and_b64 s[64:65], s[64:65], s[90:91]
  s_and_b64 s[64:65], s[64:65], s[92:93]
  s_and_b64 s[64:65], s[64:65], s[94:95]
  s_and_b32 s64, s64, s65
  s_cbranch_scc0 Lini_25
L_QKV_noinit:
  s_waitcnt vmcnt(24) lgkmcnt(0)
  s_barrier
  s_add_u32 m0, s41, 32768
  s_mov_b32 s42, 1048576
  buffer_load_dwordx4 v10, s[8:11], s42 offen lds
  s_add_u32 m0, s41, 36864
  s_mov_b32 s42, 1179648
  buffer_load_dwordx4 v10, s[8:11], s42 offen lds
  s_add_u32 m0, s41, 40960
  s_mov_b32 s42, 1310720
  buffer_load_dwordx4 v10, s[8:11], s42 offen lds
  s_add_u32 m0, s41, 45056
  s_mov_b32 s42, 1441792
  buffer_load_dwordx4 v10, s[8:11], s42 offen lds
  ds_read_b64_tr_b16 a[88:89], v6 offset:49152
  ds_read_b64_tr_b16 a[90:91], v6 offset:51200
  ds_read_b64_tr_b16 a[216:217], v6 offset:53248
  ds_read_b64_tr_b16 a[218:219], v6 offset:55296
  ds_read_b64_tr_b16 a[92:93], v6 offset:57344
  ds_read_b64_tr_b16 a[94:95], v6 offset:59392
  ds_read_b64_tr_b16 a[220:221], v6 offset:61440
  ds_read_b64_tr_b16 a[222:223], v6 offset:63488
  s_waitcnt vmcnt(24) lgkmcnt(0)
  s_barrier
  s_add_u32 m0, s41, 49152
  s_mov_b32 s42, 1572864
  buffer_load_dwordx4 v10, s[8:11], s42 offen lds
  s_add_u32 m0, s41, 53248
  s_mov_b32 s42, 1703936
  buffer_load_dwordx4 v10, s[8:11], s42 offen lds
  s_add_u32 m0, s41, 57344
  s_mov_b32 s42, 1835008
  buffer_load_dwordx4 v10, s[8:11], s42 offen lds
  s_add_u32 m0, s41, 61440
  s_mov_b32 s42, 1966080
  buffer_load_dwordx4 v10, s[8:11], s42 offen lds
  ds_read_b64_tr_b16 a[96:97], v7 offset:0
  ds_read_b64_tr_b16 a[98:99], v7 offset:2048
  ds_read_b64_tr_b16 a[224:225], v7 offset:4096
  ds_read_b64_tr_b16 a[226:227], v7 offset:6144
  ds_read_b64_tr_b16 a[100:101], v7 offset:8192
  ds_read_b64_tr_b16 a[102:103], v7 offset:10240
  ds_read_b64_tr_b16 a[228:229], v7 offset:12288
  ds_read_b64_tr_b16 a[230:231], v7 offset:14336
  s_waitcnt vmcnt(24) lgkmcnt(0)
  s_barrier
  s_add_u32 m0, s41, 65536
  s_mov_b32 s42, 4194304
  buffer_load_dwordx4 v10, s[8:11], s42 offen lds
  s_add_u32 m0, s41, 69632
  s_mov_b32 s42, 4325376
  buffer_load_dwordx4 v10, s[8:11], s42 offen lds
  s_add_u32 m0, s41, 73728
  s_mov_b32 s42, 4456448
  buffer_load_dwordx4 v10, s[8:11], s42 offen lds
  s_add_u32 m0, s41, 77824
  s_mov_b32 s42, 4587520
  buffer_load_dwordx4 v10, s[8:11], s42 offen lds
  ds_read_b64_tr_b16 a[104:105], v7 offset:16384
  ds_read_b64_tr_b16 a[106:107], v7 offset:18432
  ds_read_b64_tr_b16 a[232:233], v7 offset:20480
  ds_read_b64_tr_b16 a[234:235], v7 offset:22528
  ds_read_b64_tr_b16 a[108:109], v7 offset:24576
  ds_read_b64_tr_b16 a[110:111], v7 offset:26624
  ds_read_b64_tr_b16 a[236:237], v7 offset:28672
  ds_read_b64_tr_b16 a[238:239], v7 offset:30720
  s_waitcnt vmcnt(24) lgkmcnt(0)
  s_barrier
  s_add_u32 m0, s41, 81920
  s_mov_b32 s42, 4718592
  buffer_load_dwordx4 v10, s[8:11], s42 offen lds
  s_add_u32 m0, s41, 86016
  s_mov_b32 s42, 4849664
  buffer_load_dwordx4 v10, s[8:11], s42 offen lds
  s_add_u32 m0, s41, 90112
  s_mov_b32 s42, 4980736
  buffer_load_dwordx4 v10, s[8:11], s42 offen lds
  s_add_u32 m0, s41, 94208
  s_mov_b32 s42, 5111808
  buffer_load_dwordx4 v10, s[8:11], s42 offen lds
  ds_read_b64_tr_b16 a[112:113], v7 offset:32768
  ds_read_b64_tr_b16 a[114:115], v7 offset:34816
  ds_read_b64_tr_b16 a[240:241], v7 offset:36864
  ds_read_b64_tr_b16 a[242:243], v7 offset:38912
  ds_read_b64_tr_b16 a[116:117], v7 offset:40960
  ds_read_b64_tr_b16 a[118:119], v7 offset:43008
  ds_read_b64_tr_b16 a[244:245], v7 offset:45056
  ds_read_b64_tr_b16 a[246:247], v7 offset:47104
  s_waitcnt vmcnt(24) lgkmcnt(0)
  s_barrier
  s_add_u32 m0, s41, 98304
  s_mov_b32 s42, 5242880
  buffer_load_dwordx4 v10, s[8:11], s42 offen lds
  s_add_u32 m0, s41, 102400
  s_mov_b32 s42, 5373952
  buffer_load_dwordx4 v10, s[8:11], s42 offen lds
  s_add_u32 m0, s41, 106496
  s_mov_b32 s42, 5505024
  buffer_load_dwordx4 v10, s[8:11], s42 offen lds
  s_add_u32 m0, s41, 110592
  s_mov_b32 s42, 5636096
  buffer_load_dwordx4 v10, s[8:11], s42 offen lds
  ds_read_b64_tr_b16 a[120:121], v7 offset:49152
  ds_read_b64_tr_b16 a[122:123], v7 offset:51200
  ds_read_b64_tr_b16 a[248:249], v7 offset:53248
  ds_read_b64_tr_b16 a[250:251], v7 offset:55296
  ds_read_b64_tr_b16 a[124:125], v7 offset:57344
  ds_read_b64_tr_b16 a[126:127], v7 offset:59392
  ds_read_b64_tr_b16 a[252:253], v7 offset:61440
  ds_read_b64_tr_b16 a[254:255], v7 offset:63488
  s_waitcnt vmcnt(24) lgkmcnt(0)
  s_barrier
  s_add_u32 m0, s41, 114688
  s_mov_b32 s42, 5767168
  buffer_load_dwordx4 v10, s[8:11], s42 offen lds
  s_add_u32 m0, s41, 118784
  s_mov_b32 s42, 5898240
  buffer_load_dwordx4 v10, s[8:11], s42 offen lds
  s_add_u32 m0, s41, 122880
  s_mov_b32 s42, 6029312
  buffer_load_dwordx4 v10, s[8:11], s42 offen lds
  s_add_u32 m0, s41, 126976
  s_mov_b32 s42, 6160384
  buffer_load_dwordx4 v10, s[8:11], s42 offen lds
  ds_read_b64_tr_b16 v[128:129], v6 offset:0
  ds_read_b64_tr_b16 v[130:131], v6 offset:2048
  ds_read_b64_tr_b16 v[132:133], v6 offset:4096
  ds_read_b64_tr_b16 v[134:135], v6 offset:6144
  ds_read_b64_tr_b16 v[136:137], v6 offset:8192
  ds_read_b64_tr_b16 v[138:139], v6 offset:10240
  ds_read_b64_tr_b16 v[140:141], v6 offset:12288
  ds_read_b64_tr_b16 v[142:143], v6 offset:14336
  s_waitcnt vmcnt(24) lgkmcnt(0)
  s_barrier
  ds_read_b64_tr_b16 v[144:145], v6 offset:16384
  ds_read_b64_tr_b16 v[146:147], v6 offset:18432
  ds_read_b64_tr_b16 v[148:149], v6 offset:20480
  ds_read_b64_tr_b16 v[150:151], v6 offset:22528
  ds_read_b64_tr_b16 v[152:153], v6 offset:24576
  ds_read_b64_tr_b16 v[154:155], v6 offset:26624
  ds_read_b64_tr_b16 v[156:157], v6 offset:28672
  ds_read_b64_tr_b16 v[158:159], v6 offset:30720
  s_waitcnt vmcnt(20) lgkmcnt(0)
  s_barrier
  ds_read_b64_tr_b16 v[160:161], v6 offset:32768
  ds_read_b64_tr_b16 v[162:163], v6 offset:34816
  ds_read_b64_tr_b16 v[164:165], v6 offset:36864
  ds_read_b64_tr_b16 v[166:167], v6 offset:38912
  ds_read_b64_tr_b16 v[168:169], v6 offset:40960
  ds_read_b64_tr_b16 v[170:171], v6 offset:43008
  ds_read_b64_tr_b16 v[172:173], v6 offset:45056
  ds_read_b64_tr_b16 v[174:175], v6 offset:47104
  s_waitcnt vmcnt(16) lgkmcnt(0)
  s_barrier
  ds_read_b64_tr_b16 v[176:177], v6 offset:49152
  ds_read_b64_tr_b16 v[178:179], v6 offset:51200
  ds_read_b64_tr_b16 v[180:181], v6 offset:53248
  ds_read_b64_tr_b16 v[182:183], v6 offset:55296
  ds_read_b64_tr_b16 v[184:185], v6 offset:57344
  ds_read_b64_tr_b16 v[186:187], v6 offset:59392
  ds_read_b64_tr_b16 v[188:189], v6 offset:61440
  ds_read_b64_tr_b16 v[190:191], v6 offset:63488
  s_waitcnt vmcnt(12) lgkmcnt(0)
  s_barrier
  ds_read_b64_tr_b16 v[192:193], v7 offset:0
  ds_read_b64_tr_b16 v[194:195], v7 offset:2048
  ds_read_b64_tr_b16 v[196:197], v7 offset:4096
  ds_read_b64_tr_b16 v[198:199], v7 offset:6144
  ds_read_b64_tr_b16 v[200:201], v7 offset:8192
  ds_read_b64_tr_b16 v[202:203], v7 offset:10240
  ds_read_b64_tr_b16 v[204:205], v7 offset:12288
  ds_read_b64_tr_b16 v[206:207], v7 offset:14336
  s_waitcnt vmcnt(8) lgkmcnt(0)
  s_barrier
  ds_read_b64_tr_b16 v[208:209], v7 offset:16384
  ds_read_b64_tr_b16 v[210:211], v7 offset:18432
  ds_read_b64_tr_b16 v[212:213], v7 offset:20480
  ds_read_b64_tr_b16 v[214:215], v7 offset:22528
  ds_read_b64_tr_b16 v[216:217], v7 offset:24576
  ds_read_b64_tr_b16 v[218:219], v7 offset:26624
  ds_read_b64_tr_b16 v[220:221], v7 offset:28672
  ds_read_b64_tr_b16 v[222:223], v7 offset:30720
  s_waitcnt vmcnt(4) lgkmcnt(0)
  s_barrier
  ds_read_b64_tr_b16 v[224:225], v7 offset:32768
  ds_read_b64_tr_b16 v[226:227], v7 offset:34816
  ds_read_b64_tr_b16 v[228:229], v7 offset:36864
  ds_read_b64_tr_b16 v[230:231], v7 offset:38912
  ds_read_b64_tr_b16 v[232:233], v7 offset:40960
  ds_read_b64_tr_b16 v[234:235], v7 offset:43008
  ds_read_b64_tr_b16 v[236:237], v7 offset:45056
  ds_read_b64_tr_b16 v[238:239], v7 offset:47104
  s_waitcnt vmcnt(0) lgkmcnt(0)
  s_barrier
  ds_read_b64_tr_b16 v[240:241], v7 offset:49152
  ds_read_b64_tr_b16 v[242:243], v7 offset:51200
  ds_read_b64_tr_b16 v[244:245], v7 offset:53248
  ds_read_b64_tr_b16 v[246:247], v7 offset:55296
  ds_read_b64_tr_b16 v[248:249], v7 offset:57344
  ds_read_b64_tr_b16 v[250:251], v7 offset:59392
  ds_read_b64_tr_b16 v[252:253], v7 offset:61440
  ds_read_b64_tr_b16 v[254:255], v7 offset:63488
  s_waitcnt lgkmcnt(0)
  s_barrier
  s_lshr_b32 s62, s21, 1
  s_lshl_b32 s62, s62, 7
  s_and_b32 s40, s21, 1
  s_lshl_b32 s40, s40, 2
  s_add_u32 s62, s62, s40
  s_add_u32 s62, s62, 1396736
  s_mov_b32 s27, 2097152
  s_lshr_b32 s40, s21, 1
  s_mul_i32 s31, s40, 65536
  s_and_b32 s41, s21, 1
  s_lshl_b32 s42, s20, 11
  s_lshl_b32 s40, s41, 14
  s_add_u32 s40, s40, s42
  v_lshl_add_u32 v76, v0, 4, s40
  s_lshl_b32 s40, s41, 10
  s_add_u32 s40, s40, s42
  s_add_u32 s40, s40, 32768
  v_lshl_add_u32 v83, v0, 4, s40
  v_lshrrev_b32 v2, 3, v0
  v_lshlrev_b32 v2, 7, v2
  v_and_b32 v3, 7, v0
  v_lshl_add_u32 v2, v3, 2, v2
  v_add_u32 v2, 1388544, v2
  s_mov_b32 s25, 0
  s_mov_b32 s37, 2147483392
  s_mov_b32 s30, 0
  s_mov_b32 s34, s32
  s_mov_b32 s35, s27
  v_mov_b32 v81, v77
  v_mov_b32 v82, v78
  s_nop 1
Lpoll_26:
  buffer_load_dword v3, v2, s[4:7], 0 offen sc1
  s_sub_u32 s24, s24, 1
  s_cbranch_scc1 L_FAIL
  s_waitcnt vmcnt(0)
  v_cmp_gt_i32 vcc, 1, v3
  s_cbranch_vccz Lpolld_27
  s_sleep 1
  s_branch Lpoll_26
Lpolld_27:
  s_add_u32 m0, s34, 0
  s_nop 0
  buffer_load_dwordx4 v1, s[4:7], s35 offen offset:0 sc1 lds
  s_add_u32 m0, s34, 3968
  s_nop 0
  buffer_load_dwordx4 v1, s[4:7], s35 offen offset:128 sc1 lds
  s_add_u32 m0, s34, 7936
  s_nop 0
  buffer_load_dwordx4 v1, s[4:7], s35 offen offset:256 sc1 lds
  s_add_u32 m0, s34, 11904
  s_nop 0
  buffer_load_dwordx4 v1, s[4:7], s35 offen offset:384 sc1 lds
  s_add_u32 m0, s34, 15872
  s_nop 0
  buffer_load_dwordx4 v1, s[4:7], s35 offen offset:512 sc1 lds
  s_add_u32 m0, s34, 19840
  s_nop 0
  buffer_load_dwordx4 v1, s[4:7], s35 offen offset:640 sc1 lds
  s_add_u32 m0, s34, 23808
  s_nop 0
  buffer_load_dwordx4 v1, s[4:7], s35 offen offset:768 sc1 lds
  s_add_u32 m0, s34, 27776
  s_nop 0
  buffer_load_dwordx4 v1, s[4:7], s35 offen offset:896 sc1 lds
  s_add_u32 m0, s34, 31744
  s_nop 0
  buffer_load_dwordx4 v1, s[4:7], s35 offen offset:1024 sc1 lds
  s_add_u32 m0, s34, 35712
  s_nop 0
  buffer_load_dwordx4 v1, s[4:7], s35 offen offset:1152 sc1 lds
  s_add_u32 m0, s34, 39680
  s_nop 0
  buffer_load_dwordx4 v1, s[4:7], s35 offen offset:1280 sc1 lds
  s_add_u32 m0, s34, 43648
  s_nop 0
  buffer_load_dwordx4 v1, s[4:7], s35 offen offset:1408 sc1 lds
  s_add_u32 m0, s34, 47616
  s_nop 0
  buffer_load_dwordx4 v1, s[4:7], s35 offen offset:1536 sc1 lds
  s_add_u32 m0, s34, 51584
  s_nop 0
  buffer_load_dwordx4 v1, s[4:7], s35 offen offset:1664 sc1 lds
  s_add_u32 m0, s34, 55552
  s_nop 0
  buffer_load_dwordx4 v1, s[4:7], s35 offen offset:1792 sc1 lds
  s_add_u32 m0, s34, 59520
  s_nop 0
  buffer_load_dwordx4 v1, s[4:7], s35 offen offset:1920 sc1 lds
  v_min_u32 v60, 63, v0
  v_lshlrev_b32 v60, 7, v60
  v_add_u32 v60, 1424384, v60
  s_nop 1
Lpoll_28:
  buffer_load_dword v61, v60, s[4:7], 0 offen sc1
  s_sub_u32 s24, s24, 1
  s_cbranch_scc1 L_FAIL
  s_waitcnt vmcnt(0)
  v_cmp_gt_i32 vcc, 0, v61
  s_cbranch_vccz Lpolld_29
  s_sleep 1
  s_branch Lpoll_28
Lpolld_29:
  v_lshrrev_b32 v61, 8, v61
  v_and_b32 v62, 3, v0
  v_lshl_or_b32 v61, v61, 2, v62
  s_nop 1
  v_min_u32_dpp v61, v61, v61 row_ror:8 row_mask:0xf bank_mask:0xf
  s_nop 1
  v_min_u32_dpp v61, v61, v61 row_ror:4 row_mask:0xf bank_mask:0xf
  v_mov_b32 v62, v61
  s_nop 1
  v_permlane16_swap_b32 v62, v61
  v_min_u32 v61, v61, v62
  v_mov_b32 v62, v61
  s_nop 1
  v_permlane32_swap_b32 v62, v61
  v_min_u32 v61, v61, v62
  s_nop 1
  v_min_u32_dpp v61, v61, v61 row_ror:2 row_mask:0xf bank_mask:0xf
  s_nop 1
  v_min_u32_dpp v61, v61, v61 row_ror:1 row_mask:0xf bank_mask:0xf
  s_nop 0
  v_readfirstlane_b32 s40, v61
  s_and_b32 s40, s40, 3
  s_lshl_b32 s40, s40, 13
  s_and_b32 s40, s40, 0x2000
  s_xor_b32 s40, s40, 16777216
  s_add_u32 s31, s31, s40
  s_barrier
  ds_read_b128 v[4:7], v81 offset:0
  ds_read_b128 v[8:11], v81 offset:2048
  ds_read_b128 v[12:15], v82 offset:0
  ds_read_b128 v[16:19], v82 offset:2048
  ds_read_b128 v[20:23], v81 offset:4096
  ds_read_b128 v[24:27], v81 offset:6144
L_QKV_top:
  s_waitcnt lgkmcnt(4)
  v_cvt_pk_bf16_f32 v60, v36, v37
  v_cvt_pk_bf16_f32 v61, v38, v39
  v_mfma_f32_16x16x32_bf16 v[36:39], a[0:3], v[4:7], 0
  v_cvt_pk_bf16_f32 v62, v44, v45
  v_cvt_pk_bf16_f32 v63, v46, v47
  v_mfma_f32_16x16x32_bf16 v[44:47], a[128:131], v[4:7], 0
  v_cvt_pk_bf16_f32 v64, v40, v41
  v_cvt_pk_bf16_f32 v65, v42, v43
  v_mfma_f32_16x16x32_bf16 v[40:43], a[0:3], v[8:11], 0
  v_cvt_pk_bf16_f32 v66, v48, v49
  v_cvt_pk_bf16_f32 v67, v50, v51
  v_mfma_f32_16x16x32_bf16 v[48:51], a[128:131], v[8:11], 0
  v_cvt_pk_bf16_f32 v68, v52, v53
  v_cvt_pk_bf16_f32 v69, v54, v55
  v_mfma_f32_16x16x32_bf16 v[52:55], v[4:7], v[128:131], 0
  ds_read_b128 v[28:31], v82 offset:4096
  v_cvt_pk_bf16_f32 v70, v56, v57
  v_cvt_pk_bf16_f32 v71, v58, v59
  v_mfma_f32_16x16x32_bf16 v[56:59], v[8:11], v[128:131], 0
  ds_read_b128 v[32:35], v82 offset:6144
  s_waitcnt lgkmcnt(4)
  v_mfma_f32_16x16x32_bf16 v[36:39], a[4:7], v[12:15], v[36:39]
  ds_read_b128 v[4:7], v81 offset:8192
  v_mfma_f32_16x16x32_bf16 v[44:47], a[132:135], v[12:15], v[44:47]
  ds_read_b128 v[8:11], v81 offset:10240
  v_mfma_f32_16x16x32_bf16 v[40:43], a[4:7], v[16:19], v[40:43]
  buffer_store_dwordx4 v[60:63], v76, s[4:7], s37 offen offset:0 sc1
  v_mfma_f32_16x16x32_bf16 v[48:51], a[132:135], v[16:19], v[48:51]
  buffer_store_dwordx4 v[64:67], v76, s[4:7], s37 offen offset:1024 sc1
  v_mfma_f32_16x16x32_bf16 v[52:55], v[12:15], v[132:135], v[52:55]
  v_mfma_f32_16x16x32_bf16 v[56:59], v[16:19], v[132:135], v[56:59]
  s_waitcnt lgkmcnt(4)
  v_mfma_f32_16x16x32_bf16 v[36:39], a[8:11], v[20:23], v[36:39]
  ds_read_b128 v[12:15], v82 offset:8192
  v_mfma_f32_16x16x32_bf16 v[44:47], a[136:139], v[20:23], v[44:47]
  ds_read_b128 v[16:19], v82 offset:10240
  v_mfma_f32_16x16x32_bf16 v[40:43], a[8:11], v[24:27], v[40:43]
  buffer_store_dwordx4 v[68:71], v83, s[4:7], s37 offen sc1
  v_mfma_f32_16x16x32_bf16 v[48:51], a[136:139], v[24:27], v[48:51]
  v_cmp_gt_i32 vcc, 1, v3
  v_mfma_f32_16x16x32_bf16 v[52:55], v[20:23], v[136:139], v[52:55]
  v_mfma_f32_16x16x32_bf16 v[56:59], v[24:27], v[136:139], v[56:59]
  s_xor_b32 s34, s34, 0x10000
  s_add_u32 s35, s35, 65536
  s_cbranch_vccz L_QKV_have
  s_nop 4
Lpoll_30:
  buffer_load_dword v3, v2, s[4:7], s30 offen sc1
  s_sub_u32 s24, s24, 1
  s_cbranch_scc1 L_FAIL
  s_waitcnt vmcnt(0)
  v_cmp_gt_i32 vcc, 1, v3
  s_cbranch_vccz Lpolld_31
  s_sleep 1
  s_branch Lpoll_30
Lpolld_31:
L_QKV_have:
  s_barrier
  s_waitcnt lgkmcnt(4)
  v_mfma_f32_16x16x32_bf16 v[36:39], a[12:15], v[28:31], v[36:39]
  ds_read_b128 v[20:23], v81 offset:12288
  v_mfma_f32_16x16x32_bf16 v[44:47], a[140:143], v[28:31], v[44:47]
  ds_read_b128 v[24:27], v81 offset:14336
  v_mfma_f32_16x16x32_bf16 v[40:43], a[12:15], v[32:35], v[40:43]
  s_add_u32 m0, s34, 0
  s_nop 0
  buffer_load_dwordx4 v1, s[4:7], s35 offen offset:0 sc1 lds
  v_mfma_f32_16x16x32_bf16 v[48:51], a[140:143], v[32:35], v[48:51]
  v_mfma_f32_16x16x32_bf16 v[52:55], v[28:31], v[140:143], v[52:55]
  v_mfma_f32_16x16x32_bf16 v[56:59], v[32:35], v[140:143], v[56:59]
  s_waitcnt lgkmcnt(4)
  v_mfma_f32_16x16x32_bf16 v[36:39], a[16:19], v[4:7], v[36:39]
  ds_read_b128 v[28:31], v82 offset:12288
  v_mfma_f32_16x16x32_bf16 v[44:47], a[144:147], v[4:7], v[44:47]
  ds_read_b128 v[32:35], v82 offset:14336
  v_mfma_f32_16x16x32_bf16 v[40:43], a[16:19], v[8:11], v[40:43]
  s_add_u32 m0, s34, 3968
  s_nop 0
  buffer_load_dwordx4 v1, s[4:7], s35 offen offset:128 sc1 lds
  v_mfma_f32_16x16x32_bf16 v[48:51], a[144:147], v[8:11], v[48:51]
  v_mfma_f32_16x16x32_bf16 v[52:55], v[4:7], v[144:147], v[52:55]
  v_mfma_f32_16x16x32_bf16 v[56:59], v[8:11], v[144:147], v[56:59]
  s_waitcnt lgkmcnt(4)
  v_mfma_f32_16x16x32_bf16 v[36:39], a[20:23], v[12:15], v[36:39]
  ds_read_b128 v[4:7], v81 offset:16384
  v_mfma_f32_16x16x32_bf16 v[44:47], a[148:151], v[12:15], v[44:47]
  ds_read_b128 v[8:11], v81 offset:18432
  v_mfma_f32_16x16x32_bf16 v[40:43], a[20:23], v[16:19], v[40:43]
  s_add_u32 m0, s34, 7936
  s_nop 0
  buffer_load_dwordx4 v1, s[4:7], s35 offen offset:256 sc1 lds
  v_mfma_f32_16x16x32_bf16 v[48:51], a[148:151], v[16:19], v[48:51]
  v_mfma_f32_16x16x32_bf16 v[52:55], v[12:15], v[148:151], v[52:55]
  v_mfma_f32_16x16x32_bf16 v[56:59], v[16:19], v[148:151], v[56:59]
  s_waitcnt lgkmcnt(4)
  v_mfma_f32_16x16x32_bf16 v[36:39], a[24:27], v[20:23], v[36:39]
  ds_read_b128 v[12:15], v82 offset:16384
  v_mfma_f32_16x16x32_bf16 v[44:47], a[152:155], v[20:23], v[44:47]
  ds_read_b128 v[16:19], v82 offset:18432
  v_mfma_f32_16x16x32_bf16 v[40:43], a[24:27], v[24:27], v[40:43]
  s_add_u32 m0, s34, 11904
  s_nop 0
  buffer_load_dwordx4 v1, s[4:7], s35 offen offset:384 sc1 lds
  v_mfma_f32_16x16x32_bf16 v[48:51], a[152:155], v[24:27], v[48:51]
  v_mfma_f32_16x16x32_bf16 v[52:55], v[20:23], v[152:155], v[52:55]
  v_mfma_f32_16x16x32_bf16 v[56:59], v[24:27], v[152:155], v[56:59]
  s_waitcnt lgkmcnt(4)
  v_mfma_f32_16x16x32_bf16 v[36:39], a[28:31], v[28:31], v[36:39]
  ds_read_b128 v[20:23], v81 offset:20480
  v_mfma_f32_16x16x32_bf16 v[44:47], a[156:159], v[28:31], v[44:47]
  ds_read_b128 v[24:27], v81 offset:22528
  v_mfma_f32_16x16x32_bf16 v[40:43], a[28:31], v[32:35], v[40:43]
  s_add_u32 m0, s34, 15872
  s_nop 0
  buffer_load_dwordx4 v1, s[4:7], s35 offen offset:512 sc1 lds
  v_mfma_f32_16x16x32_bf16 v[48:51], a[156:159], v[32:35], v[48:51]
  v_mfma_f32_16x16x32_bf16 v[52:55], v[28:31], v[156:159], v[52:55]
  v_mfma_f32_16x16x32_bf16 v[56:59], v[32:35], v[156:159], v[56:59]
  s_waitcnt lgkmcnt(4)
  v_mfma_f32_16x16x32_bf16 v[36:39], a[32:35], v[4:7], v[36:39]
  ds_read_b128 v[28:31], v82 offset:20480
  v_mfma_f32_16x16x32_bf16 v[44:47], a[160:163], v[4:7], v[44:47]
  ds_read_b128 v[32:35], v82 offset:22528
  v_mfma_f32_16x16x32_bf16 v[40:43], a[32:35], v[8:11], v[40:43]
  s_add_u32 m0, s34, 19840
  s_nop 0
  buffer_load_dwordx4 v1, s[4:7], s35 offen offset:640 sc1 lds
  v_mfma_f32_16x16x32_bf16 v[48:51], a[160:163], v[8:11], v[48:51]
  v_mfma_f32_16x16x32_bf16 v[52:55], v[4:7], v[160:163], v[52:55]
  v_mfma_f32_16x16x32_bf16 v[56:59], v[8:11], v[160:163], v[56:59]
  s_waitcnt lgkmcnt(4)
  v_mfma_f32_16x16x32_bf16 v[36:39], a[36:39], v[12:15], v[36:39]
  ds_read_b128 v[4:7], v81 offset:24576
  v_mfma_f32_16x16x32_bf16 v[44:47], a[164:167], v[12:15], v[44:47]
  ds_read_b128 v[8:11], v81 offset:26624
  v_mfma_f32_16x16x32_bf16 v[40:43], a[36:39], v[16:19], v[40:43]
  s_add_u32 m0, s34, 23808
  s_nop 0
  buffer_load_dwordx4 v1, s[4:7], s35 offen offset:768 sc1 lds
  v_mfma_f32_16x16x32_bf16 v[48:51], a[164:167], v[16:19], v[48:51]
  v_mfma_f32_16x16x32_bf16 v[52:55], v[12:15], v[164:167], v[52:55]
  v_mfma_f32_16x16x32_bf16 v[56:59], v[16:19], v[164:167], v[56:59]
  s_waitcnt lgkmcnt(4)
  v_mfma_f32_16x16x32_bf16 v[36:39], a[40:43], v[20:23], v[36:39]
  ds_read_b128 v[12:15], v82 offset:24576
  v_mfma_f32_16x16x32_bf16 v[44:47], a[168:171], v[20:23], v[44:47]
  ds_read_b128 v[16:19], v82 offset:26624
  v_mfma_f32_16x16x32_bf16 v[40:43], a[40:43], v[24:27], v[40:43]
  s_add_u32 m0, s34, 27776
  s_nop 0
  buffer_load_dwordx4 v1, s[4:7], s35 offen offset:896 sc1 lds
  v_mfma_f32_16x16x32_bf16 v[48:51], a[168:171], v[24:27], v[48:51]
  v_mfma_f32_16x16x32_bf16 v[52:55], v[20:23], v[168:171], v[52:55]
  v_mfma_f32_16x16x32_bf16 v[56:59], v[24:27], v[168:171], v[56:59]
  s_waitcnt lgkmcnt(4)
  v_mfma_f32_16x16x32_bf16 v[36:39], a[44:47], v[28:31], v[36:39]
  ds_read_b128 v[20:23], v81 offset:28672
  v_mfma_f32_16x16x32_bf16 v[44:47], a[172:175], v[28:31], v[44:47]
  ds_read_b128 v[24:27], v81 offset:30720
  v_mfma_f32_16x16x32_bf16 v[40:43], a[44:47], v[32:35], v[40:43]
  s_add_u32 m0, s34, 31744
  s_nop 0
  buffer_load_dwordx4 v1, s[4:7], s35 offen offset:1024 sc1 lds
  v_mfma_f32_16x16x32_bf16 v[48:51], a[172:175], v[32:35], v[48:51]
  v_mfma_f32_16x16x32_bf16 v[52:55], v[28:31], v[172:175], v[52:55]
  v_mfma_f32_16x16x32_bf16 v[56:59], v[32:35], v[172:175], v[56:59]
  s_waitcnt vmcnt(9)
  s_barrier
  s_cmp_lg_u32 s20, 0
  s_cbranch_scc1 Lnosig_32
  s_mov_b32 s63, s25
  s_atomic_smax s63, s[4:5], s62 glc
Lnosig_32:
  s_waitcnt lgkmcnt(4)
  v_mfma_f32_16x16x32_bf16 v[36:39], a[48:51], v[4:7], v[36:39]
  ds_read_b128 v[28:31], v82 offset:28672
  v_mfma_f32_16x16x32_bf16 v[44:47], a[176:179], v[4:7], v[44:47]
  ds_read_b128 v[32:35], v82 offset:30720
  v_mfma_f32_16x16x32_bf16 v[40:43], a[48:51], v[8:11], v[40:43]
  s_add_u32 m0, s34, 35712
  s_nop 0
  buffer_load_dwordx4 v1, s[4:7], s35 offen offset:1152 sc1 lds
  v_mfma_f32_16x16x32_bf16 v[48:51], a[176:179], v[8:11], v[48:51]
  v_mfma_f32_16x16x32_bf16 v[52:55], v[4:7], v[176:179], v[52:55]
  v_mfma_f32_16x16x32_bf16 v[56:59], v[8:11], v[176:179], v[56:59]
  s_waitcnt lgkmcnt(4)
  v_mfma_f32_16x16x32_bf16 v[36:39], a[52:55], v[12:15], v[36:39]
  ds_read_b128 v[4:7], v81 offset:32768
  v_mfma_f32_16x16x32_bf16 v[44:47], a[180:183], v[12:15], v[44:47]
  ds_read_b128 v[8:11], v81 offset:34816
  v_mfma_f32_16x16x32_bf16 v[40:43], a[52:55], v[16:19], v[40:43]
  s_add_u32 m0, s34, 39680
  s_nop 0
  buffer_load_dwordx4 v1, s[4:7], s35 offen offset:1280 sc1 lds
  v_mfma_f32_16x16x32_bf16 v[48:51], a[180:183], v[16:19], v[48:51]
  v_mfma_f32_16x16x32_bf16 v[52:55], v[12:15], v[180:183], v[52:55]
  v_mfma_f32_16x16x32_bf16 v[56:59], v[16:19], v[180:183], v[56:59]
  s_waitcnt lgkmcnt(4)
  v_mfma_f32_16x16x32_bf16 v[36:39], a[56:59], v[20:23], v[36:39]
  ds_read_b128 v[12:15], v82 offset:32768
  v_mfma_f32_16x16x32_bf16 v[44:47], a[184:187], v[20:23], v[44:47]
  ds_read_b128 v[16:19], v82 offset:34816
  v_mfma_f32_16x16x32_bf16 v[40:43], a[56:59], v[24:27], v[40:43]
  s_add_u32 m0, s34, 43648
  s_nop 0
  buffer_load_dwordx4 v1, s[4:7], s35 offen offset:1408 sc1 lds
  v_mfma_f32_16x16x32_bf16 v[48:51], a[184:187], v[24:27], v[48:51]
  v_mfma_f32_16x16x32_bf16 v[52:55], v[20:23], v[184:187], v[52:55]
  v_mfma_f32_16x16x32_bf16 v[56:59], v[24:27], v[184:187], v[56:59]
  s_waitcnt lgkmcnt(4)
  v_mfma_f32_16x16x32_bf16 v[36:39], a[60:63], v[28:31], v[36:39]
  ds_read_b128 v[20:23], v81 offset:36864
  v_mfma_f32_16x16x32_bf16 v[44:47], a[188:191], v[28:31], v[44:47]
  ds_read_b128 v[24:27], v81 offset:38912
  v_mfma_f32_16x16x32_bf16 v[40:43], a[60:63], v[32:35], v[40:43]
  s_add_u32 m0, s34, 47616
  s_nop 0
  buffer_load_dwordx4 v1, s[4:7], s35 offen offset:1536 sc1 lds
  v_mfma_f32_16x16x32_bf16 v[48:51], a[188:191], v[32:35], v[48:51]
  v_mfma_f32_16x16x32_bf16 v[52:55], v[28:31], v[188:191], v[52:55]
  v_mfma_f32_16x16x32_bf16 v[56:59], v[32:35], v[188:191], v[56:59]
  s_waitcnt lgkmcnt(4)
  v_mfma_f32_16x16x32_bf16 v[36:39], a[64:67], v[4:7], v[36:39]
  ds_read_b128 v[28:31], v82 offset:36864
  v_mfma_f32_16x16x32_bf16 v[44:47], a[192:195], v[4:7], v[44:47]
  ds_read_b128 v[32:35], v82 offset:38912
  v_mfma_f32_16x16x32_bf16 v[40:43], a[64:67], v[8:11], v[40:43]
  s_add_u32 m0, s34, 51584
  s_nop 0
  buffer_load_dwordx4 v1, s[4:7], s35 offen offset:1664 sc1 lds
  v_mfma_f32_16x16x32_bf16 v[48:51], a[192:195], v[8:11], v[48:51]
  v_mfma_f32_16x16x32_bf16 v[52:55], v[4:7], v[192:195], v[52:55]
  v_mfma_f32_16x16x32_bf16 v[56:59], v[8:11], v[192:195], v[56:59]
  s_waitcnt lgkmcnt(4)
  v_mfma_f32_16x16x32_bf16 v[36:39], a[68:71], v[12:15], v[36:39]
  ds_read_b128 v[4:7], v81 offset:40960
  v_mfma_f32_16x16x32_bf16 v[44:47], a[196:199], v[12:15], v[44:47]
  ds_read_b128 v[8:11], v81 offset:43008
  v_mfma_f32_16x16x32_bf16 v[40:43], a[68:71], v[16:19], v[40:43]
  s_add_u32 m0, s34, 55552
  s_nop 0
  buffer_load_dwordx4 v1, s[4:7], s35 offen offset:1792 sc1 lds
  v_mfma_f32_16x16x32_bf16 v[48:51], a[196:199], v[16:19], v[48:51]
  v_mfma_f32_16x16x32_bf16 v[52:55], v[12:15], v[196:199], v[52:55]
  v_mfma_f32_16x16x32_bf16 v[56:59], v[16:19], v[196:199], v[56:59]
  s_waitcnt lgkmcnt(4)
  v_mfma_f32_16x16x32_bf16 v[36:39], a[72:75], v[20:23], v[36:39]
  ds_read_b128 v[12:15], v82 offset:40960
  v_mfma_f32_16x16x32_bf16 v[44:47], a[200:203], v[20:23], v[44:47]
  ds_read_b128 v[16:19], v82 offset:43008
  v_mfma_f32_16x16x32_bf16 v[40:43], a[72:75], v[24:27], v[40:43]
  s_add_u32 m0, s34, 59520
  s_nop 0
  buffer_load_dwordx4 v1, s[4:7], s35 offen offset:1920 sc1 lds
  v_mfma_f32_16x16x32_bf16 v[48:51], a[200:203], v[24:27], v[48:51]
  v_mfma_f32_16x16x32_bf16 v[52:55], v[20:23], v[200:203], v[52:55]
  v_mfma_f32_16x16x32_bf16 v[56:59], v[24:27], v[200:203], v[56:59]
  s_waitcnt lgkmcnt(4)
  v_mfma_f32_16x16x32_bf16 v[36:39], a[76:79], v[28:31], v[36:39]
  ds_read_b128 v[20:23], v81 offset:45056
  v_mfma_f32_16x16x32_bf16 v[44:47], a[204:207], v[28:31], v[44:47]
  ds_read_b128 v[24:27], v81 offset:47104
  v_mfma_f32_16x16x32_bf16 v[40:43], a[76:79], v[32:35], v[40:43]
  v_mfma_f32_16x16x32_bf16 v[48:51], a[204:207], v[32:35], v[48:51]
  v_mfma_f32_16x16x32_bf16 v[52:55], v[28:31], v[204:207], v[52:55]
  v_mfma_f32_16x16x32_bf16 v[56:59], v[32:35], v[204:207], v[56:59]
  s_waitcnt lgkmcnt(4)
  v_mfma_f32_16x16x32_bf16 v[36:39], a[80:83], v[4:7], v[36:39]
  ds_read_b128 v[28:31], v82 offset:45056
  v_mfma_f32_16x16x32_bf16 v[44:47], a[208:211], v[4:7], v[44:47]
  ds_read_b128 v[32:35], v82 offset:47104
  v_mfma_f32_16x16x32_bf16 v[40:43], a[80:83], v[8:11], v[40:43]
  s_add_u32 s30, s25, 2
  s_and_b32 s30, s30, 56
  s_lshl_b32 s30, s30, 7
  buffer_load_dword v3, v2, s[4:7], s30 offen sc1
  v_mfma_f32_16x16x32_bf16 v[48:51], a[208:211], v[8:11], v[48:51]
  v_mfma_f32_16x16x32_bf16 v[52:55], v[4:7], v[208:211], v[52:55]
  v_mfma_f32_16x16x32_bf16 v[56:59], v[8:11], v[208:211], v[56:59]
  s_waitcnt lgkmcnt(4)
  v_mfma_f32_16x16x32_bf16 v[36:39], a[84:87], v[12:15], v[36:39]
  ds_read_b128 v[4:7], v81 offset:49152
  v_mfma_f32_16x16x32_bf16 v[44:47], a[212:215], v[12:15], v[44:47]
  ds_read_b128 v[8:11], v81 offset:51200
  v_mfma_f32_16x16x32_bf16 v[40:43], a[84:87], v[16:19], v[40:43]
  v_mfma_f32_16x16x32_bf16 v[48:51], a[212:215], v[16:19], v[48:51]
  v_mfma_f32_16x16x32_bf16 v[52:55], v[12:15], v[212:215], v[52:55]
  v_mfma_f32_16x16x32_bf16 v[56:59], v[16:19], v[212:215], v[56:59]
  s_waitcnt lgkmcnt(4)
  v_mfma_f32_16x16x32_bf16 v[36:39], a[88:91], v[20:23], v[36:39]
  ds_read_b128 v[12:15], v82 offset:49152
  v_mfma_f32_16x16x32_bf16 v[44:47], a[216:219], v[20:23], v[44:47]
  ds_read_b128 v[16:19], v82 offset:51200
  v_mfma_f32_16x16x32_bf16 v[40:43], a[88:91], v[24:27], v[40:43]
  v_mfma_f32_16x16x32_bf16 v[48:51], a[216:219], v[24:27], v[48:51]
  v_mfma_f32_16x16x32_bf16 v[52:55], v[20:23], v[216:219], v[52:55]
  v_mfma_f32_16x16x32_bf16 v[56:59], v[24:27], v[216:219], v[56:59]
  s_waitcnt lgkmcnt(4)
  v_mfma_f32_16x16x32_bf16 v[36:39], a[92:95], v[28:31], v[36:39]
  ds_read_b128 v[20:23], v81 offset:53248
  v_mfma_f32_16x16x32_bf16 v[44:47], a[220:223], v[28:31], v[44:47]
  ds_read_b128 v[24:27], v81 offset:55296
  v_mfma_f32_16x16x32_bf16 v[40:43], a[92:95], v[32:35], v[40:43]
  v_mfma_f32_16x16x32_bf16 v[48:51], a[220:223], v[32:35], v[48:51]
  v_mfma_f32_16x16x32_bf16 v[52:55], v[28:31], v[220:223], v[52:55]
  v_mfma_f32_16x16x32_bf16 v[56:59], v[32:35], v[220:223], v[56:59]
  s_waitcnt lgkmcnt(4)
  v_mfma_f32_16x16x32_bf16 v[36:39], a[96:99], v[4:7], v[36:39]
  ds_read_b128 v[28:31], v82 offset:53248
  v_mfma_f32_16x16x32_bf16 v[44:47], a[224:227], v[4:7], v[44:47]
  ds_read_b128 v[32:35], v82 offset:55296
  v_mfma_f32_16x16x32_bf16 v[40:43], a[96:99], v[8:11], v[40:43]
  v_mfma_f32_16x16x32_bf16 v[48:51], a[224:227], v[8:11], v[48:51]
  v_mfma_f32_16x16x32_bf16 v[52:55], v[4:7], v[224:227], v[52:55]
  v_mfma_f32_16x16x32_bf16 v[56:59], v[8:11], v[224:227], v[56:59]
  s_waitcnt lgkmcnt(4)
  v_mfma_f32_16x16x32_bf16 v[36:39], a[100:103], v[12:15], v[36:39]
  ds_read_b128 v[4:7], v81 offset:57344
  v_mfma_f32_16x16x32_bf16 v[44:47], a[228:231], v[12:15], v[44:47]
  ds_read_b128 v[8:11], v81 offset:59392
  v_mfma_f32_16x16x32_bf16 v[40:43], a[100:103], v[16:19], v[40:43]
  v_mfma_f32_16x16x32_bf16 v[48:51], a[228:231], v[16:19], v[48:51]
  v_mfma_f32_16x16x32_bf16 v[52:55], v[12:15], v[228:231], v[52:55]
  v_mfma_f32_16x16x32_bf16 v[56:59], v[16:19], v[228:231], v[56:59]
  s_waitcnt lgkmcnt(4)
  v_mfma_f32_16x16x32_bf16 v[36:39], a[104:107], v[20:23], v[36:39]
  ds_read_b128 v[12:15], v82 offset:57344
  v_mfma_f32_16x16x32_bf16 v[44:47], a[232:235], v[20:23], v[44:47]
  ds_read_b128 v[16:19], v82 offset:59392
  v_mfma_f32_16x16x32_bf16 v[40:43], a[104:107], v[24:27], v[40:43]
  v_mfma_f32_16x16x32_bf16 v[48:51], a[232:235], v[24:27], v[48:51]
  v_mfma_f32_16x16x32_bf16 v[52:55], v[20:23], v[232:235], v[52:55]
  v_mfma_f32_16x16x32_bf16 v[56:59], v[24:27], v[232:235], v[56:59]
  s_waitcnt lgkmcnt(4)
  v_mfma_f32_16x16x32_bf16 v[36:39], a[108:111], v[28:31], v[36:39]
  ds_read_b128 v[20:23], v81 offset:61440
  v_mfma_f32_16x16x32_bf16 v[44:47], a[236:239], v[28:31], v[44:47]
  ds_read_b128 v[24:27], v81 offset:63488
  v_mfma_f32_16x16x32_bf16 v[40:43], a[108:111], v[32:35], v[40:43]
  v_mfma_f32_16x16x32_bf16 v[48:51], a[236:239], v[32:35], v[48:51]
  v_mfma_f32_16x16x32_bf16 v[52:55], v[28:31], v[236:239], v[52:55]
  v_mfma_f32_16x16x32_bf16 v[56:59], v[32:35], v[236:239], v[56:59]
  s_waitcnt lgkmcnt(4)
  v_mfma_f32_16x16x32_bf16 v[36:39], a[112:115], v[4:7], v[36:39]
  ds_read_b128 v[28:31], v82 offset:61440
  v_mfma_f32_16x16x32_bf16 v[44:47], a[240:243], v[4:7], v[44:47]
  ds_read_b128 v[32:35], v82 offset:63488
  v_mfma_f32_16x16x32_bf16 v[40:43], a[112:115], v[8:11], v[40:43]
  v_mfma_f32_16x16x32_bf16 v[48:51], a[240:243], v[8:11], v[48:51]
  v_mfma_f32_16x16x32_bf16 v[52:55], v[4:7], v[240:243], v[52:55]
  v_mfma_f32_16x16x32_bf16 v[56:59], v[8:11], v[240:243], v[56:59]
  s_waitcnt vmcnt(0)
  s_barrier
  v_xor_b32 v81, 0x10000, v81
  v_xor_b32 v82, 0x10000, v82
  s_waitcnt lgkmcnt(4)
  v_mfma_f32_16x16x32_bf16 v[36:39], a[116:119], v[12:15], v[36:39]
  ds_read_b128 v[4:7], v81 offset:0
  v_mfma_f32_16x16x32_bf16 v[44:47], a[244:247], v[12:15], v[44:47]
  ds_read_b128 v[8:11], v81 offset:2048
  v_mfma_f32_16x16x32_bf16 v[40:43], a[116:119], v[16:19], v[40:43]
  v_mfma_f32_16x16x32_bf16 v[48:51], a[244:247], v[16:19], v[48:51]
  v_mfma_f32_16x16x32_bf16 v[52:55], v[12:15], v[244:247], v[52:55]
  v_mfma_f32_16x16x32_bf16 v[56:59], v[16:19], v[244:247], v[56:59]
  s_waitcnt lgkmcnt(4)
  v_mfma_f32_16x16x32_bf16 v[36:39], a[120:123], v[20:23], v[36:39]
  ds_read_b128 v[12:15], v82 offset:0
  v_mfma_f32_16x16x32_bf16 v[44:47], a[248:251], v[20:23], v[44:47]
  ds_read_b128 v[16:19], v82 offset:2048
  v_mfma_f32_16x16x32_bf16 v[40:43], a[120:123], v[24:27], v[40:43]
  v_mfma_f32_16x16x32_bf16 v[48:51], a[248:251], v[24:27], v[48:51]
  v_mfma_f32_16x16x32_bf16 v[52:55], v[20:23], v[248:251], v[52:55]
  v_mfma_f32_16x16x32_bf16 v[56:59], v[24:27], v[248:251], v[56:59]
  s_waitcnt lgkmcnt(4)
  v_mfma_f32_16x16x32_bf16 v[36:39], a[124:127], v[28:31], v[36:39]
  ds_read_b128 v[20:23], v81 offset:4096
  v_mfma_f32_16x16x32_bf16 v[44:47], a[252:255], v[28:31], v[44:47]
  ds_read_b128 v[24:27], v81 offset:6144
  v_mfma_f32_16x16x32_bf16 v[40:43], a[124:127], v[32:35], v[40:43]
  v_mfma_f32_16x16x32_bf16 v[48:51], a[252:255], v[32:35], v[48:51]
  v_mfma_f32_16x16x32_bf16 v[52:55], v[28:31], v[252:255], v[52:55]
  v_mfma_f32_16x16x32_bf16 v[56:59], v[32:35], v[252:255], v[56:59]
  s_mov_b32 s37, s31
  s_add_u32 s31, s31, 2097152
  s_xor_b32 s31, s31, 0x2000
  s_add_u32 s25, s25, 1
  s_cmp_lt_u32 s25, 64
  s_cbranch_scc1 L_QKV_top
  v_cvt_pk_bf16_f32 v60, v36, v37
  v_cvt_pk_bf16_f32 v61, v38, v39
  v_cvt_pk_bf16_f32 v62, v44, v45
  v_cvt_pk_bf16_f32 v63, v46, v47
  v_cvt_pk_bf16_f32 v64, v40, v41
  v_cvt_pk_bf16_f32 v65, v42, v43
  v_cvt_pk_bf16_f32 v66, v48, v49
  v_cvt_pk_bf16_f32 v67, v50, v51
  v_cvt_pk_bf16_f32 v68, v52, v53
  v_cvt_pk_bf16_f32 v69, v54, v55
  v_cvt_pk_bf16_f32 v70, v56, v57
  v_cvt_pk_bf16_f32 v71, v58, v59
  buffer_store_dwordx4 v[60:63], v76, s[4:7], s37 offen offset:0 sc1
  buffer_store_dwordx4 v[64:67], v76, s[4:7], s37 offen offset:1024 sc1
  buffer_store_dwordx4 v[68:71], v83, s[4:7], s37 offen sc1
  s_waitcnt vmcnt(0) lgkmcnt(0)
  s_barrier
  s_cmp_lg_u32 s20, 0
  s_cbranch_scc1 Lnosig_33
  s_mov_b32 s63, s25
  s_atomic_smax s63, s[4:5], s62 glc
Lnosig_33:
  s_branch L_END
L_WO:
  v_lshlrev_b32 v1, 4, v0
  s_lshl_b32 s32, s20, 12
  s_min_u32 s33, s32, 0x2000
  v_mov_b32 v69, v1
  v_add_u32 v70, 0x10000, v69
  s_load_dwordx2 s[8:9], s[0:1], 40
  s_mov_b32 s10, 8388608
  s_mov_b32 s11, 0x20000
  s_waitcnt lgkmcnt(0)
  s_lshr_b32 s44, s21, 3
  s_mul_i32 s44, s44, 2097152
  s_and_b32 s45, s21, 7
  s_lshl_b32 s45, s45, 8
  s_add_u32 s44, s44, s45
  s_add_u32 s45, s44, 128
  v_bfe_u32 v4, v0, 5, 1
  v_mul_u32_u24 v4, 8192, v4
  v_bfe_u32 v5, v0, 4, 1
  v_mul_u32_u24 v5, 4096, v5
  v_add_u32 v4, v4, v5
  v_bfe_u32 v5, v0, 3, 1
  v_mul_u32_u24 v5, 2048, v5
  v_add_u32 v4, v4, v5
  v_lshrrev_b32 v5, 3, v0
  v_and_b32 v5, 6, v5
  v_xor_b32 v5, v5, v0
  v_and_b32 v5, 7, v5
  v_lshl_add_u32 v4, v5, 4, v4
  s_lshr_b32 s40, s20, 1
  s_mul_i32 s40, s40, 131072
  s_and_b32 s41, s20, 1
  s_mul_i32 s41, s41, 16384
  s_add_u32 s40, s40, s41
  v_add_u32 v4, s40, v4
  v_bfe_u32 v5, v0, 3, 2
  v_xor_b32 v5, s20, v5
  v_lshlrev_b32 v5, 5, v5
  v_lshrrev_b32 v6, 2, v0
  v_lshl_add_u32 v6, v6, 7, v5
  v_and_b32 v5, 3, v0
  v_lshl_add_u32 v6, v5, 3, v6
  v_add_u32 v7, 0x10000, v6
  v_add_u32 v8, s44, v4
  v_add_u32 v9, s45, v4
  s_lshl_b32 s41, s20, 10
  s_add_u32 m0, s41, 0
  s_mov_b32 s42, 0
  buffer_load_dwordx4 v8, s[8:11], s42 offen nt lds
  s_add_u32 m0, s41, 4096
  s_mov_b32 s42, 0
  buffer_load_dwordx4 v9, s[8:11], s42 offen nt lds
  s_add_u32 m0, s41, 8192
  s_mov_b32 s42, 32768
  buffer_load_dwordx4 v8, s[8:11], s42 offen nt lds
  s_add_u32 m0, s41, 12288
  s_mov_b32 s42, 32768
  buffer_load_dwordx4 v9, s[8:11], s42 offen nt lds
  s_add_u32 m0, s41, 16384
  s_mov_b32 s42, 65536
  buffer_load_dwordx4 v8, s[8:11], s42 offen nt lds
  s_add_u32 m0, s41, 20480
  s_mov_b32 s42, 65536
  buffer_load_dwordx4 v9, s[8:11], s42 offen nt lds
  s_add_u32 m0, s41, 24576
  s_mov_b32 s42, 98304
  buffer_load_dwordx4 v8, s[8:11], s42 offen nt lds
  s_add_u32 m0, s41, 28672
  s_mov_b32 s42, 98304
  buffer_load_dwordx4 v9, s[8:11], s42 offen nt lds
  s_add_u32 m0, s41, 32768
  s_mov_b32 s42, 262144
  buffer_load_dwordx4 v8, s[8:11], s42 offen nt lds
  s_add_u32 m0, s41, 36864
  s_mov_b32 s42, 262144
  buffer_load_dwordx4 v9, s[8:11], s42 offen nt lds
  s_add_u32 m0, s41, 40960
  s_mov_b32 s42, 294912
  buffer_load_dwordx4 v8, s[8:11], s42 offen nt lds
  s_add_u32 m0, s41, 45056
  s_mov_b32 s42, 294912
  buffer_load_dwordx4 v9, s[8:11], s42 offen nt lds
  s_add_u32 m0, s41, 49152
  s_mov_b32 s42, 327680
  buffer_load_dwordx4 v8, s[8:11], s42 offen nt lds
  s_add_u32 m0, s41, 53248
  s_mov_b32 s42, 327680
  buffer_load_dwordx4 v9, s[8:11], s42 offen nt lds
  s_add_u32 m0, s41, 57344
  s_mov_b32 s42, 360448
  buffer_load_dwordx4 v8, s[8:11], s42 offen nt lds
  s_add_u32 m0, s41, 61440
  s_mov_b32 s42, 360448
  buffer_load_dwordx4 v9, s[8:11], s42 offen nt lds
  s_add_u32 m0, s41, 65536
  s_mov_b32 s42, 524288
  buffer_load_dwordx4 v8, s[8:11], s42 offen nt lds
  s_add_u32 m0, s41, 69632
  s_mov_b32 s42, 524288
  buffer_load_dwordx4 v9, s[8:11], s42 offen nt lds
  s_add_u32 m0, s41, 73728
  s_mov_b32 s42, 557056
  buffer_load_dwordx4 v8, s[8:11], s42 offen nt lds
  s_add_u32 m0, s41, 77824
  s_mov_b32 s42, 557056
  buffer_load_dwordx4 v9, s[8:11], s42 offen nt lds
  s_add_u32 m0, s41, 81920
  s_mov_b32 s42, 589824
  buffer_load_dwordx4 v8, s[8:11], s42 offen nt lds
  s_add_u32 m0, s41, 86016
  s_mov_b32 s42, 589824
  buffer_load_dwordx4 v9, s[8:11], s42 offen nt lds
  s_add_u32 m0, s41, 90112
  s_mov_b32 s42, 622592
  buffer_load_dwordx4 v8, s[8:11], s42 offen nt lds
  s_add_u32 m0, s41, 94208
  s_mov_b32 s42, 622592
  buffer_load_dwordx4 v9, s[8:11], s42 offen nt lds
  s_add_u32 m0, s41, 98304
  s_mov_b32 s42, 786432
  buffer_load_dwordx4 v8, s[8:11], s42 offen nt lds
  s_add_u32 m0, s41, 102400
  s_mov_b32 s42, 786432
  buffer_load_dwordx4 v9, s[8:11], s42 offen nt lds
  s_add_u32 m0, s41, 106496
  s_mov_b32 s42, 819200
  buffer_load_dwordx4 v8, s[8:11], s42 offen nt lds
  s_add_u32 m0, s41, 110592
  s_mov_b32 s42, 819200
  buffer_load_dwordx4 v9, s[8:11], s42 offen nt lds
  s_waitcnt vmcnt(24) lgkmcnt(0)
  s_barrier
  s_add_u32 m0, s41, 114688
  s_mov_b32 s42, 851968
  buffer_load_dwordx4 v8, s[8:11], s42 offen nt lds
  s_add_u32 m0, s41, 118784
  s_mov_b32 s42, 851968
  buffer_load_dwordx4 v9, s[8:11], s42 offen nt lds
  s_add_u32 m0, s41, 122880
  s_mov_b32 s42, 884736
  buffer_load_dwordx4 v8, s[8:11], s42 offen nt lds
  s_add_u32 m0, s41, 126976
  s_mov_b32 s42, 884736
  buffer_load_dwordx4 v9, s[8:11], s42 offen nt lds
  ds_read_b64_tr_b16 a[0:1], v6 offset:0
  ds_read_b64_tr_b16 a[2:3], v6 offset:2048
  ds_read_b64_tr_b16 a[128:129], v6 offset:4096
  ds_read_b64_tr_b16 a[130:131], v6 offset:6144
  ds_read_b64_tr_b16 a[4:5], v6 offset:8192
  ds_read_b64_tr_b16 a[6:7], v6 offset:10240
  ds_read_b64_tr_b16 a[132:133], v6 offset:12288
  ds_read_b64_tr_b16 a[134:135], v6 offset:14336
  s_waitcnt vmcnt(24) lgkmcnt(0)
  s_barrier
  s_add_u32 m0, s41, 0
  s_mov_b32 s42, 1048576
  buffer_load_dwordx4 v8, s[8:11], s42 offen nt lds
  s_add_u32 m0, s41, 4096
  s_mov_b32 s42, 1048576
  buffer_load_dwordx4 v9, s[8:11], s42 offen nt lds
  s_add_u32 m0, s41, 8192
  s_mov_b32 s42, 1081344
  buffer_load_dwordx4 v8, s[8:11], s42 offen nt lds
  s_add_u32 m0, s41, 12288
  s_mov_b32 s42, 1081344
  buffer_load_dwordx4 v9, s[8:11], s42 offen nt lds
  ds_read_b64_tr_b16 a[8:9], v6 offset:16384
  ds_read_b64_tr_b16 a[10:11], v6 offset:18432
  ds_read_b64_tr_b16 a[136:137], v6 offset:20480
  ds_read_b64_tr_b16 a[138:139], v6 offset:22528
  ds_read_b64_tr_b16 a[12:13], v6 offset:24576
  ds_read_b64_tr_b16 a[14:15], v6 offset:26624
  ds_read_b64_tr_b16 a[140:141], v6 offset:28672
  ds_read_b64_tr_b16 a[142:143], v6 offset:30720
  s_waitcnt vmcnt(24) lgkmcnt(0)
  s_barrier
  s_add_u32 m0, s41, 16384
  s_mov_b32 s42, 1114112
  buffer_load_dwordx4 v8, s[8:11], s42 offen nt lds
  s_add_u32 m0, s41, 20480
  s_mov_b32 s42, 1114112
  buffer_load_dwordx4 v9, s[8:11], s42 offen nt lds
  s_add_u32 m0, s41, 24576
  s_mov_b32 s42, 1146880
  buffer_load_dwordx4 v8, s[8:11], s42 offen nt lds
  s_add_u32 m0, s41, 28672
  s_mov_b32 s42, 1146880
  buffer_load_dwordx4 v9, s[8:11], s42 offen nt lds
  ds_read_b64_tr_b16 a[16:17], v6 offset:32768
  ds_read_b64_tr_b16 a[18:19], v6 offset:34816
  ds_read_b64_tr_b16 a[144:145], v6 offset:36864
  ds_read_b64_tr_b16 a[146:147], v6 offset:38912
  ds_read_b64_tr_b16 a[20:21], v6 offset:40960
  ds_read_b64_tr_b16 a[22:23], v6 offset:43008
  ds_read_b64_tr_b16 a[148:149], v6 offset:45056
  ds_read_b64_tr_b16 a[150:151], v6 offset:47104
  s_waitcnt vmcnt(24) lgkmcnt(0)
  s_barrier
  s_add_u32 m0, s41, 32768
  s_mov_b32 s42, 1310720
  buffer_load_dwordx4 v8, s[8:11], s42 offen nt lds
  s_add_u32 m0, s41, 36864
  s_mov_b32 s42, 1310720
  buffer_load_dwordx4 v9, s[8:11], s42 offen nt lds
  s_add_u32 m0, s41, 40960
  s_mov_b32 s42, 1343488
  buffer_load_dwordx4 v8, s[8:11], s42 offen nt lds
  s_add_u32 m0, s41, 45056
  s_mov_b32 s42, 1343488
  buffer_load_dwordx4 v9, s[8:11], s42 offen nt lds
  ds_read_b64_tr_b16 a[24:25], v6 offset:49152
  ds_read_b64_tr_b16 a[26:27], v6 offset:51200
  ds_read_b64_tr_b16 a[152:153], v6 offset:53248
  ds_read_b64_tr_b16 a[154:155], v6 offset:55296
  ds_read_b64_tr_b16 a[28:29], v6 offset:57344
  ds_read_b64_tr_b16 a[30:31], v6 offset:59392
  ds_read_b64_tr_b16 a[156:157], v6 offset:61440
  ds_read_b64_tr_b16 a[158:159], v6 offset:63488
  s_waitcnt vmcnt(24) lgkmcnt(0)
  s_barrier
  s_add_u32 m0, s41, 49152
  s_mov_b32 s42, 1376256
  buffer_load_dwordx4 v8, s[8:11], s42 offen nt lds
  s_add_u32 m0, s41, 53248
  s_mov_b32 s42, 1376256
  buffer_load_dwordx4 v9, s[8:11], s42 offen nt lds
  s_add_u32 m0, s41, 57344
  s_mov_b32 s42, 1409024
  buffer_load_dwordx4 v8, s[8:11], s42 offen nt lds
  s_add_u32 m0, s41, 61440
  s_mov_b32 s42, 1409024
  buffer_load_dwordx4 v9, s[8:11], s42 offen nt lds
  ds_read_b64_tr_b16 a[32:33], v7 offset:0
  ds_read_b64_tr_b16 a[34:35], v7 offset:2048
  ds_read_b64_tr_b16 a[160:161], v7 offset:4096
  ds_read_b64_tr_b16 a[162:163], v7 offset:6144
  ds_read_b64_tr_b16 a[36:37], v7 offset:8192
  ds_read_b64_tr_b16 a[38:39], v7 offset:10240
  ds_read_b64_tr_b16 a[164:165], v7 offset:12288
  ds_read_b64_tr_b16 a[166:167], v7 offset:14336
  s_waitcnt vmcnt(24) lgkmcnt(0)
  s_barrier
  s_add_u32 m0, s41, 65536
  s_mov_b32 s42, 1572864
  buffer_load_dwordx4 v8, s[8:11], s42 offen nt lds
  s_add_u32 m0, s41, 69632
  s_mov_b32 s42, 1572864
  buffer_load_dwordx4 v9, s[8:11], s42 offen nt lds
  s_add_u32 m0, s41, 73728
  s_mov_b32 s42, 1605632
  buffer_load_dwordx4 v8, s[8:11], s42 offen nt lds
  s_add_u32 m0, s41, 77824
  s_mov_b32 s42, 1605632
  buffer_load_dwordx4 v9, s[8:11], s42 offen nt lds
  ds_read_b64_tr_b16 a[40:41], v7 offset:16384
  ds_read_b64_tr_b16 a[42:43], v7 offset:18432
  ds_read_b64_tr_b16 a[168:169], v7 offset:20480
  ds_read_b64_tr_b16 a[170:171], v7 offset:22528
  ds_read_b64_tr_b16 a[44:45], v7 offset:24576
  ds_read_b64_tr_b16 a[46:47], v7 offset:26624
  ds_read_b64_tr_b16 a[172:173], v7 offset:28672
  ds_read_b64_tr_b16 a[174:175], v7 offset:30720
  s_waitcnt vmcnt(24) lgkmcnt(0)
  s_barrier
  s_add_u32 m0, s41, 81920
  s_mov_b32 s42, 1638400
  buffer_load_dwordx4 v8, s[8:11], s42 offen nt lds
  s_add_u32 m0, s41, 86016
  s_mov_b32 s42, 1638400
  buffer_load_dwordx4 v9, s[8:11], s42 offen nt lds
  s_add_u32 m0, s41, 90112
  s_mov_b32 s42, 1671168
  buffer_load_dwordx4 v8, s[8:11], s42 offen nt lds
  s_add_u32 m0, s41, 94208
  s_mov_b32 s42, 1671168
  buffer_load_dwordx4 v9, s[8:11], s42 offen nt lds
  ds_read_b64_tr_b16 a[48:49], v7 offset:32768
  ds_read_b64_tr_b16 a[50:51], v7 offset:34816
  ds_read_b64_tr_b16 a[176:177], v7 offset:36864
  ds_read_b64_tr_b16 a[178:179], v7 offset:38912
  ds_read_b64_tr_b16 a[52:53], v7 offset:40960
  ds_read_b64_tr_b16 a[54:55], v7 offset:43008
  ds_read_b64_tr_b16 a[180:181], v7 offset:45056
  ds_read_b64_tr_b16 a[182:183], v7 offset:47104
  s_waitcnt vmcnt(24) lgkmcnt(0)
  s_barrier
  s_add_u32 m0, s41, 98304
  s_mov_b32 s42, 1835008
  buffer_load_dwordx4 v8, s[8:11], s42 offen nt lds
  s_add_u32 m0, s41, 102400
  s_mov_b32 s42, 1835008
  buffer_load_dwordx4 v9, s[8:11], s42 offen nt lds
  s_add_u32 m0, s41, 106496
  s_mov_b32 s42, 1867776
  buffer_load_dwordx4 v8, s[8:11], s42 offen nt lds
  s_add_u32 m0, s41, 110592
  s_mov_b32 s42, 1867776
  buffer_load_dwordx4 v9, s[8:11], s42 offen nt lds
  ds_read_b64_tr_b16 a[56:57], v7 offset:49152
  ds_read_b64_tr_b16 a[58:59], v7 offset:51200
  ds_read_b64_tr_b16 a[184:185], v7 offset:53248
  ds_read_b64_tr_b16 a[186:187], v7 offset:55296
  ds_read_b64_tr_b16 a[60:61], v7 offset:57344
  ds_read_b64_tr_b16 a[62:63], v7 offset:59392
  ds_read_b64_tr_b16 a[188:189], v7 offset:61440
  ds_read_b64_tr_b16 a[190:191], v7 offset:63488
  s_waitcnt vmcnt(24) lgkmcnt(0)
  s_barrier
  s_add_u32 m0, s41, 114688
  s_mov_b32 s42, 1900544
  buffer_load_dwordx4 v8, s[8:11], s42 offen nt lds
  s_add_u32 m0, s41, 118784
  s_mov_b32 s42, 1900544
  buffer_load_dwordx4 v9, s[8:11], s42 offen nt lds
  s_add_u32 m0, s41, 122880
  s_mov_b32 s42, 1933312
  buffer_load_dwordx4 v8, s[8:11], s42 offen nt lds
  s_add_u32 m0, s41, 126976
  s_mov_b32 s42, 1933312
  buffer_load_dwordx4 v9, s[8:11], s42 offen nt lds
  ds_read_b64_tr_b16 a[64:65], v6 offset:0
  ds_read_b64_tr_b16 a[66:67], v6 offset:2048
  ds_read_b64_tr_b16 a[192:193], v6 offset:4096
  ds_read_b64_tr_b16 a[194:195], v6 offset:6144
  ds_read_b64_tr_b16 a[68:69], v6 offset:8192
  ds_read_b64_tr_b16 a[70:71], v6 offset:10240
  ds_read_b64_tr_b16 a[196:197], v6 offset:12288
  ds_read_b64_tr_b16 a[198:199], v6 offset:14336
  s_waitcnt vmcnt(24) lgkmcnt(0)
  s_barrier
  ds_read_b64_tr_b16 a[72:73], v6 offset:16384
  ds_read_b64_tr_b16 a[74:75], v6 offset:18432
  ds_read_b64_tr_b16 a[200:201], v6 offset:20480
  ds_read_b64_tr_b16 a[202:203], v6 offset:22528
  ds_read_b64_tr_b16 a[76:77], v6 offset:24576
  ds_read_b64_tr_b16 a[78:79], v6 offset:26624
  ds_read_b64_tr_b16 a[204:205], v6 offset:28672
  ds_read_b64_tr_b16 a[206:207], v6 offset:30720
  s_waitcnt vmcnt(20) lgkmcnt(0)
  s_barrier
  ds_read_b64_tr_b16 a[80:81], v6 offset:32768
  ds_read_b64_tr_b16 a[82:83], v6 offset:34816
  ds_read_b64_tr_b16 a[208:209], v6 offset:36864
  ds_read_b64_tr_b16 a[210:211], v6 offset:38912
  ds_read_b64_tr_b16 a[84:85], v6 offset:40960
  ds_read_b64_tr_b16 a[86:87], v6 offset:43008
  ds_read_b64_tr_b16 a[212:213], v6 offset:45056
  ds_read_b64_tr_b16 a[214:215], v6 offset:47104
  s_waitcnt vmcnt(16) lgkmcnt(0)
  s_barrier
  ds_read_b64_tr_b16 a[88:89], v6 offset:49152
  ds_read_b64_tr_b16 a[90:91], v6 offset:51200
  ds_read_b64_tr_b16 a[216:217], v6 offset:53248
  ds_read_b64_tr_b16 a[218:219], v6 offset:55296
  ds_read_b64_tr_b16 a[92:93], v6 offset:57344
  ds_read_b64_tr_b16 a[94:95], v6 offset:59392
  ds_read_b64_tr_b16 a[220:221], v6 offset:61440
  ds_read_b64_tr_b16 a[222:223], v6 offset:63488
  s_waitcnt vmcnt(12) lgkmcnt(0)
  s_barrier
  ds_read_b64_tr_b16 a[96:97], v7 offset:0
  ds_read_b64_tr_b16 a[98:99], v7 offset:2048
  ds_read_b64_tr_b16 a[224:225], v7 offset:4096
  ds_read_b64_tr_b16 a[226:227], v7 offset:6144
  ds_read_b64_tr_b16 a[100:101], v7 offset:8192
  ds_read_b64_tr_b16 a[102:103], v7 offset:10240
  ds_read_b64_tr_b16 a[228:229], v7 offset:12288
  ds_read_b64_tr_b16 a[230:231], v7 offset:14336
  s_waitcnt vmcnt(8) lgkmcnt(0)
  s_barrier
  ds_read_b64_tr_b16 a[104:105], v7 offset:16384
  ds_read_b64_tr_b16 a[106:107], v7 offset:18432
  ds_read_b64_tr_b16 a[232:233], v7 offset:20480
  ds_read_b64_tr_b16 a[234:235], v7 offset:22528
  ds_read_b64_tr_b16 a[108:109], v7 offset:24576
  ds_read_b64_tr_b16 a[110:111], v7 offset:26624
  ds_read_b64_tr_b16 a[236:237], v7 offset:28672
  ds_read_b64_tr_b16 a[238:239], v7 offset:30720
  s_waitcnt vmcnt(4) lgkmcnt(0)
  s_barrier
  ds_read_b64_tr_b16 a[112:113], v7 offset:32768
  ds_read_b64_tr_b16 a[114:115], v7 offset:34816
  ds_read_b64_tr_b16 a[240:241], v7 offset:36864
  ds_read_b64_tr_b16 a[242:243], v7 offset:38912
  ds_read_b64_tr_b16 a[116:117], v7 offset:40960
  ds_read_b64_tr_b16 a[118:119], v7 offset:43008
  ds_read_b64_tr_b16 a[244:245], v7 offset:45056
  ds_read_b64_tr_b16 a[246:247], v7 offset:47104
  s_waitcnt vmcnt(0) lgkmcnt(0)
  s_barrier
  ds_read_b64_tr_b16 a[120:121], v7 offset:49152
  ds_read_b64_tr_b16 a[122:123], v7 offset:51200
  ds_read_b64_tr_b16 a[248:249], v7 offset:53248
  ds_read_b64_tr_b16 a[250:251], v7 offset:55296
  ds_read_b64_tr_b16 a[124:125], v7 offset:57344
  ds_read_b64_tr_b16 a[126:127], v7 offset:59392
  ds_read_b64_tr_b16 a[252:253], v7 offset:61440
  ds_read_b64_tr_b16 a[254:255], v7 offset:63488
  s_waitcnt lgkmcnt(0)
  s_barrier
  s_and_b32 s43, s21, 24
  v_min_u32 v2, 7, v0
  v_add_u32 v2, s43, v2
  v_lshlrev_b32 v2, 7, v2
  v_add_u32 v2, 1404928, v2
  s_lshl_b32 s62, s21, 7
  s_add_u32 s62, s62, 1409024
  v_min_u32 v52, 63, v0
  v_lshlrev_b32 v52, 7, v52
  v_add_u32 v52, 1424384, v52
  s_nop 1
Lpoll_34:
  buffer_load_dword v53, v52, s[4:7], 0 offen sc1
  s_sub_u32 s24, s24, 1
  s_cbranch_scc1 L_FAIL
  s_waitcnt vmcnt(0)
  v_cmp_gt_i32 vcc, 0, v53
  s_cbranch_vccz Lpolld_35
  s_sleep 1
  s_branch Lpoll_34
Lpolld_35:
  v_lshrrev_b32 v53, 8, v53
  v_and_b32 v54, 3, v0
  v_lshl_or_b32 v53, v53, 2, v54
  s_nop 1
  v_min_u32_dpp v53, v53, v53 row_ror:8 row_mask:0xf bank_mask:0xf
  s_nop 1
  v_min_u32_dpp v53, v53, v53 row_ror:4 row_mask:0xf bank_mask:0xf
  v_mov_b32 v54, v53
  s_nop 1
  v_permlane16_swap_b32 v54, v53
  v_min_u32 v53, v53, v54
  v_mov_b32 v54, v53
  s_nop 1
  v_permlane32_swap_b32 v54, v53
  v_min_u32 v53, v53, v54
  s_nop 1
  v_min_u32_dpp v53, v53, v53 row_ror:2 row_mask:0xf bank_mask:0xf
  s_nop 1
  v_min_u32_dpp v53, v53, v53 row_ror:1 row_mask:0xf bank_mask:0xf
  s_nop 0
  v_readfirstlane_b32 s38, v53
  s_and_b32 s38, s38, 3
  s_lshl_b32 s38, s38, 13
  s_and_b32 s38, s38, 0x2000
  s_xor_b32 s38, s38, 16785408
  s_xor_b32 s27, s38, 0x2000
  s_lshr_b32 s40, s20, 1
  s_add_u32 s40, s40, s43
  s_mul_i32 s40, s40, 65536
  s_and_b32 s41, s20, 1
  s_lshl_b32 s41, s41, 12
  s_add_u32 s40, s40, s41
  s_add_u32 s40, s40, 49152
  s_add_u32 s27, s27, s40
  s_lshl_b32 s40, s21, 14
  s_add_u32 s40, s40, s38
  s_add_u32 s31, s40, 0
  s_lshl_b32 s40, s20, 11
  v_and_b32 v68, 3, v0
  v_lshlrev_b32 v68, 4, v68
  v_lshrrev_b32 v52, 4, v0
  v_lshl_add_u32 v68, v52, 6, v68
  v_bfe_u32 v52, v0, 2, 2
  v_lshl_add_u32 v68, v52, 8, v68
  v_add_u32 v68, s40, v68
  v_lshlrev_b32 v71, 2, v0
  v_add_u32 v71, 131072, v71
  s_mov_b32 s25, 0
  s_mov_b32 s26, 0
  s_mov_b32 s29, 1
  s_mov_b32 s30, 0
  s_mov_b32 s28, 0
L_WO_top:
  s_cmp_eq_u32 s28, 1
  s_cbranch_scc1 L_WO_go
  s_cmp_eq_u32 s28, 2
  s_cbranch_scc1 L_WO_mid
  s_cmp_lg_u32 s20, 0
  s_cbranch_scc1 L_WO_park
  buffer_load_dword v3, v2, s[4:7], s30 offen sc1
  s_waitcnt vmcnt(1)
  s_barrier
  s_mov_b32 s63, s25
  s_atomic_smax s63, s[4:5], s62 glc
Lnosig_36:
  s_cmp_ge_u32 s25, 64
  s_cbranch_scc1 L_END
  s_waitcnt vmcnt(0)
  v_cmp_gt_i32 vcc, s29, v3
  s_cbranch_vccz L_WO_issue
  s_nop 3
Lpoll_37:
  buffer_load_dword v3, v2, s[4:7], s30 offen sc1
  s_sub_u32 s24, s24, 1
  s_cbranch_scc1 L_FAIL
  s_waitcnt vmcnt(0)
  v_cmp_gt_i32 vcc, s29, v3
  s_cbranch_vccz Lpolld_38
  s_sleep 1
  s_branch Lpoll_37
Lpolld_38:
  s_branch L_WO_issue
L_WO_park:
  s_waitcnt vmcnt(0)
  s_barrier
  s_cmp_ge_u32 s25, 64
  s_cbranch_scc1 L_END
L_WO_issue:
  s_barrier
L_WO_mid:
  s_mov_b32 s34, s26
  s_mov_b32 s35, s27
  s_add_u32 s36, s32, 0
  s_add_u32 m0, s34, s36
  s_add_u32 s36, s35, 0
  buffer_load_dwordx4 v1, s[4:7], s36 offen offset:0 sc1 lds
  s_nop 0
  buffer_load_dwordx4 v1, s[4:7], s36 offen offset:1024 sc1 lds
  s_nop 0
  buffer_load_dwordx4 v1, s[4:7], s36 offen offset:2048 sc1 lds
  s_nop 0
  buffer_load_dwordx4 v1, s[4:7], s36 offen offset:3072 sc1 lds
  s_nop 0
  s_add_u32 s36, s32, 16384
  s_add_u32 m0, s34, s36
  s_add_u32 s36, s35, 131072
  buffer_load_dwordx4 v1, s[4:7], s36 offen offset:0 sc1 lds
  s_nop 0
  buffer_load_dwordx4 v1, s[4:7], s36 offen offset:1024 sc1 lds
  s_nop 0
  buffer_load_dwordx4 v1, s[4:7], s36 offen offset:2048 sc1 lds
  s_nop 0
  buffer_load_dwordx4 v1, s[4:7], s36 offen offset:3072 sc1 lds
  s_nop 0
  s_add_u32 s36, s32, 32768
  s_add_u32 m0, s34, s36
  s_add_u32 s36, s35, 262144
  buffer_load_dwordx4 v1, s[4:7], s36 offen offset:0 sc1 lds
  s_nop 0
  buffer_load_dwordx4 v1, s[4:7], s36 offen offset:1024 sc1 lds
  s_nop 0
  buffer_load_dwordx4 v1, s[4:7], s36 offen offset:2048 sc1 lds
  s_nop 0
  buffer_load_dwordx4 v1, s[4:7], s36 offen offset:3072 sc1 lds
  s_nop 0
  s_cmp_eq_u32 s28, 0
  s_cbranch_scc1 L_WO_go
  s_mov_b32 s28, 0
  s_waitcnt vmcnt(12)
  s_barrier
  s_cmp_lg_u32 s20, 0
  s_cbranch_scc1 Lnosig_39
  s_mov_b32 s63, s25
  s_atomic_smax s63, s[4:5], s62 glc
Lnosig_39:
L_WO_go:
  v_add_u32 v73, s26, v69
  v_add_u32 v74, s26, v70
  s_sub_u32 s26, 65536, s26
  s_add_u32 s27, s27, 2097152
  s_xor_b32 s27, s27, 0x2000
  s_add_u32 s29, s29, 1
  s_waitcnt vmcnt(8)
  s_barrier
  ds_read_b128 v[4:7], v73 offset:0
  ds_read_b128 v[8:11], v73 offset:1024
  ds_read_b128 v[12:15], v73 offset:2048
  ds_read_b128 v[16:19], v73 offset:3072
  ds_read_b128 v[20:23], v73 offset:4096
  ds_read_b128 v[24:27], v73 offset:5120
  s_waitcnt lgkmcnt(4)
  v_mfma_f32_16x16x32_bf16 v[36:39], a[0:3], v[4:7], 0
  ds_read_b128 v[28:31], v73 offset:6144
  v_mfma_f32_16x16x32_bf16 v[40:43], a[0:3], v[8:11], 0
  ds_read_b128 v[32:35], v73 offset:7168
  v_mfma_f32_16x16x32_bf16 v[44:47], a[128:131], v[4:7], 0
  s_add_u32 s36, s32, 49152
  s_add_u32 m0, s34, s36
  s_add_u32 s36, s35, 393216
  buffer_load_dwordx4 v1, s[4:7], s36 offen offset:0 sc1 lds
  v_mfma_f32_16x16x32_bf16 v[48:51], a[128:131], v[8:11], 0
  s_waitcnt lgkmcnt(4)
  v_mfma_f32_16x16x32_bf16 v[36:39], a[4:7], v[12:15], v[36:39]
  ds_read_b128 v[4:7], v73 offset:8192
  v_mfma_f32_16x16x32_bf16 v[40:43], a[4:7], v[16:19], v[40:43]
  ds_read_b128 v[8:11], v73 offset:9216
  v_mfma_f32_16x16x32_bf16 v[44:47], a[132:135], v[12:15], v[44:47]
  buffer_load_dwordx4 v1, s[4:7], s36 offen offset:1024 sc1 lds
  v_mfma_f32_16x16x32_bf16 v[48:51], a[132:135], v[16:19], v[48:51]
  s_waitcnt lgkmcnt(4)
  v_mfma_f32_16x16x32_bf16 v[36:39], a[8:11], v[20:23], v[36:39]
  ds_read_b128 v[12:15], v73 offset:10240
  v_mfma_f32_16x16x32_bf16 v[40:43], a[8:11], v[24:27], v[40:43]
  ds_read_b128 v[16:19], v73 offset:11264
  v_mfma_f32_16x16x32_bf16 v[44:47], a[136:139], v[20:23], v[44:47]
  buffer_load_dwordx4 v1, s[4:7], s36 offen offset:2048 sc1 lds
  v_mfma_f32_16x16x32_bf16 v[48:51], a[136:139], v[24:27], v[48:51]
  s_waitcnt lgkmcnt(4)
  v_mfma_f32_16x16x32_bf16 v[36:39], a[12:15], v[28:31], v[36:39]
  ds_read_b128 v[20:23], v73 offset:12288
  v_mfma_f32_16x16x32_bf16 v[40:43], a[12:15], v[32:35], v[40:43]
  ds_read_b128 v[24:27], v73 offset:13312
  v_mfma_f32_16x16x32_bf16 v[44:47], a[140:143], v[28:31], v[44:47]
  buffer_load_dwordx4 v1, s[4:7], s36 offen offset:3072 sc1 lds
  v_mfma_f32_16x16x32_bf16 v[48:51], a[140:143], v[32:35], v[48:51]
  s_waitcnt lgkmcnt(4)
  v_mfma_f32_16x16x32_bf16 v[36:39], a[16:19], v[4:7], v[36:39]
  ds_read_b128 v[28:31], v73 offset:14336
  v_mfma_f32_16x16x32_bf16 v[40:43], a[16:19], v[8:11], v[40:43]
  ds_read_b128 v[32:35], v73 offset:15360
  v_mfma_f32_16x16x32_bf16 v[44:47], a[144:147], v[4:7], v[44:47]
  v_mfma_f32_16x16x32_bf16 v[48:51], a[144:147], v[8:11], v[48:51]
  s_waitcnt vmcnt(8)
  s_barrier
  s_mov_b32 s34, s26
  s_mov_b32 s35, s27
  s_waitcnt lgkmcnt(4)
  v_mfma_f32_16x16x32_bf16 v[36:39], a[20:23], v[12:15], v[36:39]
  ds_read_b128 v[4:7], v73 offset:16384
  v_mfma_f32_16x16x32_bf16 v[40:43], a[20:23], v[16:19], v[40:43]
  ds_read_b128 v[8:11], v73 offset:17408
  v_mfma_f32_16x16x32_bf16 v[44:47], a[148:151], v[12:15], v[44:47]
  v_mfma_f32_16x16x32_bf16 v[48:51], a[148:151], v[16:19], v[48:51]
  s_waitcnt lgkmcnt(4)
  v_mfma_f32_16x16x32_bf16 v[36:39], a[24:27], v[20:23], v[36:39]
  ds_read_b128 v[12:15], v73 offset:18432
  v_mfma_f32_16x16x32_bf16 v[40:43], a[24:27], v[24:27], v[40:43]
  ds_read_b128 v[16:19], v73 offset:19456
  v_mfma_f32_16x16x32_bf16 v[44:47], a[152:155], v[20:23], v[44:47]
  v_mfma_f32_16x16x32_bf16 v[48:51], a[152:155], v[24:27], v[48:51]
  s_waitcnt lgkmcnt(4)
  v_mfma_f32_16x16x32_bf16 v[36:39], a[28:31], v[28:31], v[36:39]
  ds_read_b128 v[20:23], v73 offset:20480
  v_mfma_f32_16x16x32_bf16 v[40:43], a[28:31], v[32:35], v[40:43]
  ds_read_b128 v[24:27], v73 offset:21504
  v_mfma_f32_16x16x32_bf16 v[44:47], a[156:159], v[28:31], v[44:47]
  v_mfma_f32_16x16x32_bf16 v[48:51], a[156:159], v[32:35], v[48:51]
  s_waitcnt lgkmcnt(4)
  v_mfma_f32_16x16x32_bf16 v[36:39], a[32:35], v[4:7], v[36:39]
  ds_read_b128 v[28:31], v73 offset:22528
  v_mfma_f32_16x16x32_bf16 v[40:43], a[32:35], v[8:11], v[40:43]
  ds_read_b128 v[32:35], v73 offset:23552
  v_mfma_f32_16x16x32_bf16 v[44:47], a[160:163], v[4:7], v[44:47]
  v_mfma_f32_16x16x32_bf16 v[48:51], a[160:163], v[8:11], v[48:51]
  s_waitcnt lgkmcnt(4)
  v_mfma_f32_16x16x32_bf16 v[36:39], a[36:39], v[12:15], v[36:39]
  ds_read_b128 v[4:7], v73 offset:24576
  v_mfma_f32_16x16x32_bf16 v[40:43], a[36:39], v[16:19], v[40:43]
  ds_read_b128 v[8:11], v73 offset:25600
  v_mfma_f32_16x16x32_bf16 v[44:47], a[164:167], v[12:15], v[44:47]
  v_mfma_f32_16x16x32_bf16 v[48:51], a[164:167], v[16:19], v[48:51]
  s_waitcnt lgkmcnt(4)
  v_mfma_f32_16x16x32_bf16 v[36:39], a[40:43], v[20:23], v[36:39]
  ds_read_b128 v[12:15], v73 offset:26624
  v_mfma_f32_16x16x32_bf16 v[40:43], a[40:43], v[24:27], v[40:43]
  ds_read_b128 v[16:19], v73 offset:27648
  v_mfma_f32_16x16x32_bf16 v[44:47], a[168:171], v[20:23], v[44:47]
  v_mfma_f32_16x16x32_bf16 v[48:51], a[168:171], v[24:27], v[48:51]
  s_waitcnt lgkmcnt(4)
  v_mfma_f32_16x16x32_bf16 v[36:39], a[44:47], v[28:31], v[36:39]
  ds_read_b128 v[20:23], v73 offset:28672
  v_mfma_f32_16x16x32_bf16 v[40:43], a[44:47], v[32:35], v[40:43]
  ds_read_b128 v[24:27], v73 offset:29696
  v_mfma_f32_16x16x32_bf16 v[44:47], a[172:175], v[28:31], v[44:47]
  v_mfma_f32_16x16x32_bf16 v[48:51], a[172:175], v[32:35], v[48:51]
  s_lshl_b32 s40, s20, 8
  s_add_u32 m0, s40, 131072
  s_cmp_eq_u32 s20, 0
  s_cselect_b32 s40, s30, 2147483392
  buffer_load_dword v2, s[4:7], s40 offen sc1 lds
  s_waitcnt lgkmcnt(4)
  v_mfma_f32_16x16x32_bf16 v[36:39], a[48:51], v[4:7], v[36:39]
  ds_read_b128 v[28:31], v73 offset:30720
  v_mfma_f32_16x16x32_bf16 v[40:43], a[48:51], v[8:11], v[40:43]
  ds_read_b128 v[32:35], v73 offset:31744
  v_mfma_f32_16x16x32_bf16 v[44:47], a[176:179], v[4:7], v[44:47]
  v_mfma_f32_16x16x32_bf16 v[48:51], a[176:179], v[8:11], v[48:51]
  s_waitcnt vmcnt(5)
  s_barrier
  s_lshl_b32 s40, s20, 1
  s_add_u32 s40, s40, 1
  s_cmp_lg_u32 s40, s28
  s_cbranch_scc1 L_WO_s2
  s_mov_b32 s63, s25
  s_atomic_smax s63, s[4:5], s62 glc
Lnosig_40:
L_WO_s2:
  s_waitcnt lgkmcnt(4)
  v_mfma_f32_16x16x32_bf16 v[36:39], a[52:55], v[12:15], v[36:39]
  ds_read_b128 v[4:7], v73 offset:32768
  v_mfma_f32_16x16x32_bf16 v[40:43], a[52:55], v[16:19], v[40:43]
  ds_read_b128 v[8:11], v73 offset:33792
  v_mfma_f32_16x16x32_bf16 v[44:47], a[180:183], v[12:15], v[44:47]
  v_mfma_f32_16x16x32_bf16 v[48:51], a[180:183], v[16:19], v[48:51]
  s_waitcnt lgkmcnt(4)
  v_mfma_f32_16x16x32_bf16 v[36:39], a[56:59], v[20:23], v[36:39]
  ds_read_b128 v[12:15], v73 offset:34816
  v_mfma_f32_16x16x32_bf16 v[40:43], a[56:59], v[24:27], v[40:43]
  ds_read_b128 v[16:19], v73 offset:35840
  v_mfma_f32_16x16x32_bf16 v[44:47], a[184:187], v[20:23], v[44:47]
  v_mfma_f32_16x16x32_bf16 v[48:51], a[184:187], v[24:27], v[48:51]
  s_waitcnt lgkmcnt(4)
  v_mfma_f32_16x16x32_bf16 v[36:39], a[60:63], v[28:31], v[36:39]
  ds_read_b128 v[20:23], v73 offset:36864
  v_mfma_f32_16x16x32_bf16 v[40:43], a[60:63], v[32:35], v[40:43]
  ds_read_b128 v[24:27], v73 offset:37888
  v_mfma_f32_16x16x32_bf16 v[44:47], a[188:191], v[28:31], v[44:47]
  v_mfma_f32_16x16x32_bf16 v[48:51], a[188:191], v[32:35], v[48:51]
  s_waitcnt lgkmcnt(4)
  v_mfma_f32_16x16x32_bf16 v[36:39], a[64:67], v[4:7], v[36:39]
  ds_read_b128 v[28:31], v73 offset:38912
  v_mfma_f32_16x16x32_bf16 v[40:43], a[64:67], v[8:11], v[40:43]
  ds_read_b128 v[32:35], v73 offset:39936
  v_mfma_f32_16x16x32_bf16 v[44:47], a[192:195], v[4:7], v[44:47]
  v_mfma_f32_16x16x32_bf16 v[48:51], a[192:195], v[8:11], v[48:51]
  s_waitcnt lgkmcnt(4)
  v_mfma_f32_16x16x32_bf16 v[36:39], a[68:71], v[12:15], v[36:39]
  ds_read_b128 v[4:7], v73 offset:40960
  v_mfma_f32_16x16x32_bf16 v[40:43], a[68:71], v[16:19], v[40:43]
  ds_read_b128 v[8:11], v73 offset:41984
  v_mfma_f32_16x16x32_bf16 v[44:47], a[196:199], v[12:15], v[44:47]
  v_mfma_f32_16x16x32_bf16 v[48:51], a[196:199], v[16:19], v[48:51]
  s_waitcnt lgkmcnt(4)
  v_mfma_f32_16x16x32_bf16 v[36:39], a[72:75], v[20:23], v[36:39]
  ds_read_b128 v[12:15], v73 offset:43008
  v_mfma_f32_16x16x32_bf16 v[40:43], a[72:75], v[24:27], v[40:43]
  ds_read_b128 v[16:19], v73 offset:44032
  v_mfma_f32_16x16x32_bf16 v[44:47], a[200:203], v[20:23], v[44:47]
  v_mfma_f32_16x16x32_bf16 v[48:51], a[200:203], v[24:27], v[48:51]
  s_waitcnt vmcnt(0)
  s_barrier
  ds_read_b32 v3, v71
  s_waitcnt lgkmcnt(4)
  v_mfma_f32_16x16x32_bf16 v[36:39], a[76:79], v[28:31], v[36:39]
  ds_read_b128 v[20:23], v73 offset:45056
  v_mfma_f32_16x16x32_bf16 v[40:43], a[76:79], v[32:35], v[40:43]
  ds_read_b128 v[24:27], v73 offset:46080
  v_mfma_f32_16x16x32_bf16 v[44:47], a[204:207], v[28:31], v[44:47]
  v_mfma_f32_16x16x32_bf16 v[48:51], a[204:207], v[32:35], v[48:51]
  s_waitcnt lgkmcnt(4)
  v_mfma_f32_16x16x32_bf16 v[36:39], a[80:83], v[4:7], v[36:39]
  ds_read_b128 v[28:31], v73 offset:47104
  v_mfma_f32_16x16x32_bf16 v[40:43], a[80:83], v[8:11], v[40:43]
  ds_read_b128 v[32:35], v73 offset:48128
  v_mfma_f32_16x16x32_bf16 v[44:47], a[208:211], v[4:7], v[44:47]
  v_mfma_f32_16x16x32_bf16 v[48:51], a[208:211], v[8:11], v[48:51]
  s_waitcnt lgkmcnt(4)
  v_cmp_gt_i32 vcc, s29, v3
  s_mov_b32 s28, 0
  s_cbranch_vccnz L_WO_nopf
  s_cmp_ge_u32 s25, 63
  s_cbranch_scc1 L_WO_nopf
  s_mov_b32 s28, 1
  s_waitcnt lgkmcnt(4)
  v_mfma_f32_16x16x32_bf16 v[36:39], a[84:87], v[12:15], v[36:39]
  ds_read_b128 v[4:7], v73 offset:49152
  v_mfma_f32_16x16x32_bf16 v[40:43], a[84:87], v[16:19], v[40:43]
  ds_read_b128 v[8:11], v73 offset:50176
  v_mfma_f32_16x16x32_bf16 v[44:47], a[212:215], v[12:15], v[44:47]
  s_add_u32 s36, s32, 0
  s_add_u32 m0, s34, s36
  s_add_u32 s36, s35, 0
  buffer_load_dwordx4 v1, s[4:7], s36 offen offset:0 sc1 lds
  v_mfma_f32_16x16x32_bf16 v[48:51], a[212:215], v[16:19], v[48:51]
  buffer_load_dwordx4 v1, s[4:7], s36 offen offset:1024 sc1 lds
  s_waitcnt lgkmcnt(4)
  v_mfma_f32_16x16x32_bf16 v[36:39], a[88:91], v[20:23], v[36:39]
  ds_read_b128 v[12:15], v73 offset:51200
  v_mfma_f32_16x16x32_bf16 v[40:43], a[88:91], v[24:27], v[40:43]
  ds_read_b128 v[16:19], v73 offset:52224
  v_mfma_f32_16x16x32_bf16 v[44:47], a[216:219], v[20:23], v[44:47]
  buffer_load_dwordx4 v1, s[4:7], s36 offen offset:2048 sc1 lds
  v_mfma_f32_16x16x32_bf16 v[48:51], a[216:219], v[24:27], v[48:51]
  buffer_load_dwordx4 v1, s[4:7], s36 offen offset:3072 sc1 lds
  s_waitcnt lgkmcnt(4)
  v_mfma_f32_16x16x32_bf16 v[36:39], a[92:95], v[28:31], v[36:39]
  ds_read_b128 v[20:23], v73 offset:53248
  v_mfma_f32_16x16x32_bf16 v[40:43], a[92:95], v[32:35], v[40:43]
  ds_read_b128 v[24:27], v73 offset:54272
  v_mfma_f32_16x16x32_bf16 v[44:47], a[220:223], v[28:31], v[44:47]
  s_add_u32 s36, s32, 16384
  s_add_u32 m0, s34, s36
  s_add_u32 s36, s35, 131072
  buffer_load_dwordx4 v1, s[4:7], s36 offen offset:0 sc1 lds
  v_mfma_f32_16x16x32_bf16 v[48:51], a[220:223], v[32:35], v[48:51]
  buffer_load_dwordx4 v1, s[4:7], s36 offen offset:1024 sc1 lds
  s_waitcnt lgkmcnt(4)
  v_mfma_f32_16x16x32_bf16 v[36:39], a[96:99], v[4:7], v[36:39]
  ds_read_b128 v[28:31], v73 offset:55296
  v_mfma_f32_16x16x32_bf16 v[40:43], a[96:99], v[8:11], v[40:43]
  ds_read_b128 v[32:35], v73 offset:56320
  v_mfma_f32_16x16x32_bf16 v[44:47], a[224:227], v[4:7], v[44:47]
  buffer_load_dwordx4 v1, s[4:7], s36 offen offset:2048 sc1 lds
  v_mfma_f32_16x16x32_bf16 v[48:51], a[224:227], v[8:11], v[48:51]
  buffer_load_dwordx4 v1, s[4:7], s36 offen offset:3072 sc1 lds
  s_waitcnt lgkmcnt(4)
  v_mfma_f32_16x16x32_bf16 v[36:39], a[100:103], v[12:15], v[36:39]
  ds_read_b128 v[4:7], v73 offset:57344
  v_mfma_f32_16x16x32_bf16 v[40:43], a[100:103], v[16:19], v[40:43]
  ds_read_b128 v[8:11], v73 offset:58368
  v_mfma_f32_16x16x32_bf16 v[44:47], a[228:231], v[12:15], v[44:47]
  s_add_u32 s36, s32, 32768
  s_add_u32 m0, s34, s36
  s_add_u32 s36, s35, 262144
  buffer_load_dwordx4 v1, s[4:7], s36 offen offset:0 sc1 lds
  v_mfma_f32_16x16x32_bf16 v[48:51], a[228:231], v[16:19], v[48:51]
  buffer_load_dwordx4 v1, s[4:7], s36 offen offset:1024 sc1 lds
  s_waitcnt lgkmcnt(4)
  v_mfma_f32_16x16x32_bf16 v[36:39], a[104:107], v[20:23], v[36:39]
  ds_read_b128 v[12:15], v73 offset:59392
  v_mfma_f32_16x16x32_bf16 v[40:43], a[104:107], v[24:27], v[40:43]
  ds_read_b128 v[16:19], v73 offset:60416
  v_mfma_f32_16x16x32_bf16 v[44:47], a[232:235], v[20:23], v[44:47]
  buffer_load_dwordx4 v1, s[4:7], s36 offen offset:2048 sc1 lds
  v_mfma_f32_16x16x32_bf16 v[48:51], a[232:235], v[24:27], v[48:51]
  buffer_load_dwordx4 v1, s[4:7], s36 offen offset:3072 sc1 lds
  s_waitcnt lgkmcnt(4)
  v_mfma_f32_16x16x32_bf16 v[36:39], a[108:111], v[28:31], v[36:39]
  ds_read_b128 v[20:23], v73 offset:61440
  v_mfma_f32_16x16x32_bf16 v[40:43], a[108:111], v[32:35], v[40:43]
  ds_read_b128 v[24:27], v73 offset:62464
  v_mfma_f32_16x16x32_bf16 v[44:47], a[236:239], v[28:31], v[44:47]
  v_mfma_f32_16x16x32_bf16 v[48:51], a[236:239], v[32:35], v[48:51]
  s_waitcnt lgkmcnt(4)
  v_mfma_f32_16x16x32_bf16 v[36:39], a[112:115], v[4:7], v[36:39]
  ds_read_b128 v[28:31], v73 offset:63488
  v_mfma_f32_16x16x32_bf16 v[40:43], a[112:115], v[8:11], v[40:43]
  ds_read_b128 v[32:35], v73 offset:64512
  v_mfma_f32_16x16x32_bf16 v[44:47], a[240:243], v[4:7], v[44:47]
  v_mfma_f32_16x16x32_bf16 v[48:51], a[240:243], v[8:11], v[48:51]
  s_waitcnt lgkmcnt(4)
  v_mfma_f32_16x16x32_bf16 v[36:39], a[116:119], v[12:15], v[36:39]
  v_mfma_f32_16x16x32_bf16 v[40:43], a[116:119], v[16:19], v[40:43]
  v_mfma_f32_16x16x32_bf16 v[44:47], a[244:247], v[12:15], v[44:47]
  v_mfma_f32_16x16x32_bf16 v[48:51], a[244:247], v[16:19], v[48:51]
  s_waitcnt lgkmcnt(2)
  v_mfma_f32_16x16x32_bf16 v[36:39], a[120:123], v[20:23], v[36:39]
  v_mfma_f32_16x16x32_bf16 v[40:43], a[120:123], v[24:27], v[40:43]
  v_mfma_f32_16x16x32_bf16 v[44:47], a[248:251], v[20:23], v[44:47]
  v_mfma_f32_16x16x32_bf16 v[48:51], a[248:251], v[24:27], v[48:51]
  s_waitcnt lgkmcnt(0)
  v_mfma_f32_16x16x32_bf16 v[36:39], a[124:127], v[28:31], v[36:39]
  v_mfma_f32_16x16x32_bf16 v[40:43], a[124:127], v[32:35], v[40:43]
  v_mfma_f32_16x16x32_bf16 v[44:47], a[252:255], v[28:31], v[44:47]
  v_mfma_f32_16x16x32_bf16 v[48:51], a[252:255], v[32:35], v[48:51]
  s_nop 7
  s_branch L_WO_epi
L_WO_nopf:
  s_waitcnt lgkmcnt(4)
  v_mfma_f32_16x16x32_bf16 v[36:39], a[84:87], v[12:15], v[36:39]
  ds_read_b128 v[4:7], v73 offset:49152
  v_mfma_f32_16x16x32_bf16 v[40:43], a[84:87], v[16:19], v[40:43]
  ds_read_b128 v[8:11], v73 offset:50176
  v_mfma_f32_16x16x32_bf16 v[44:47], a[212:215], v[12:15], v[44:47]
  v_mfma_f32_16x16x32_bf16 v[48:51], a[212:215], v[16:19], v[48:51]
  s_waitcnt lgkmcnt(4)
  v_mfma_f32_16x16x32_bf16 v[36:39], a[88:91], v[20:23], v[36:39]
  ds_read_b128 v[12:15], v73 offset:51200
  v_mfma_f32_16x16x32_bf16 v[40:43], a[88:91], v[24:27], v[40:43]
  ds_read_b128 v[16:19], v73 offset:52224
  v_mfma_f32_16x16x32_bf16 v[44:47], a[216:219], v[20:23], v[44:47]
  v_mfma_f32_16x16x32_bf16 v[48:51], a[216:219], v[24:27], v[48:51]
  s_waitcnt lgkmcnt(4)
  v_mfma_f32_16x16x32_bf16 v[36:39], a[92:95], v[28:31], v[36:39]
  ds_read_b128 v[20:23], v73 offset:53248
  v_mfma_f32_16x16x32_bf16 v[40:43], a[92:95], v[32:35], v[40:43]
  ds_read_b128 v[24:27], v73 offset:54272
  v_mfma_f32_16x16x32_bf16 v[44:47], a[220:223], v[28:31], v[44:47]
  v_mfma_f32_16x16x32_bf16 v[48:51], a[220:223], v[32:35], v[48:51]
  s_barrier
  s_lshl_b32 s40, s20, 8
  s_add_u32 m0, s40, 131072
  s_cmp_eq_u32 s20, 0
  s_cselect_b32 s40, s30, 2147483392
  buffer_load_dword v2, s[4:7], s40 offen sc1 lds
  s_waitcnt lgkmcnt(4)
  v_mfma_f32_16x16x32_bf16 v[36:39], a[96:99], v[4:7], v[36:39]
  ds_read_b128 v[28:31], v73 offset:55296
  v_mfma_f32_16x16x32_bf16 v[40:43], a[96:99], v[8:11], v[40:43]
  ds_read_b128 v[32:35], v73 offset:56320
  v_mfma_f32_16x16x32_bf16 v[44:47], a[224:227], v[4:7], v[44:47]
  v_mfma_f32_16x16x32_bf16 v[48:51], a[224:227], v[8:11], v[48:51]
  s_waitcnt lgkmcnt(4)
  v_mfma_f32_16x16x32_bf16 v[36:39], a[100:103], v[12:15], v[36:39]
  ds_read_b128 v[4:7], v73 offset:57344
  v_mfma_f32_16x16x32_bf16 v[40:43], a[100:103], v[16:19], v[40:43]
  ds_read_b128 v[8:11], v73 offset:58368
  v_mfma_f32_16x16x32_bf16 v[44:47], a[228:231], v[12:15], v[44:47]
  v_mfma_f32_16x16x32_bf16 v[48:51], a[228:231], v[16:19], v[48:51]
  s_waitcnt lgkmcnt(4)
  v_mfma_f32_16x16x32_bf16 v[36:39], a[104:107], v[20:23], v[36:39]
  ds_read_b128 v[12:15], v73 offset:59392
  v_mfma_f32_16x16x32_bf16 v[40:43], a[104:107], v[24:27], v[40:43]
  ds_read_b128 v[16:19], v73 offset:60416
  v_mfma_f32_16x16x32_bf16 v[44:47], a[232:235], v[20:23], v[44:47]
  v_mfma_f32_16x16x32_bf16 v[48:51], a[232:235], v[24:27], v[48:51]
  s_waitcnt lgkmcnt(4)
  v_mfma_f32_16x16x32_bf16 v[36:39], a[108:111], v[28:31], v[36:39]
  ds_read_b128 v[20:23], v73 offset:61440
  v_mfma_f32_16x16x32_bf16 v[40:43], a[108:111], v[32:35], v[40:43]
  ds_read_b128 v[24:27], v73 offset:62464
  v_mfma_f32_16x16x32_bf16 v[44:47], a[236:239], v[28:31], v[44:47]
  v_mfma_f32_16x16x32_bf16 v[48:51], a[236:239], v[32:35], v[48:51]
  s_waitcnt lgkmcnt(4)
  v_mfma_f32_16x16x32_bf16 v[36:39], a[112:115], v[4:7], v[36:39]
  ds_read_b128 v[28:31], v73 offset:63488
  v_mfma_f32_16x16x32_bf16 v[40:43], a[112:115], v[8:11], v[40:43]
  ds_read_b128 v[32:35], v73 offset:64512
  v_mfma_f32_16x16x32_bf16 v[44:47], a[240:243], v[4:7], v[44:47]
  v_mfma_f32_16x16x32_bf16 v[48:51], a[240:243], v[8:11], v[48:51]
  s_waitcnt lgkmcnt(4)
  v_mfma_f32_16x16x32_bf16 v[36:39], a[116:119], v[12:15], v[36:39]
  v_mfma_f32_16x16x32_bf16 v[40:43], a[116:119], v[16:19], v[40:43]
  v_mfma_f32_16x16x32_bf16 v[44:47], a[244:247], v[12:15], v[44:47]
  v_mfma_f32_16x16x32_bf16 v[48:51], a[244:247], v[16:19], v[48:51]
  s_waitcnt vmcnt(0)
  s_barrier
  ds_read_b32 v3, v71
  s_waitcnt lgkmcnt(2)
  v_mfma_f32_16x16x32_bf16 v[36:39], a[120:123], v[20:23], v[36:39]
  v_mfma_f32_16x16x32_bf16 v[40:43], a[120:123], v[24:27], v[40:43]
  v_mfma_f32_16x16x32_bf16 v[44:47], a[248:251], v[20:23], v[44:47]
  v_mfma_f32_16x16x32_bf16 v[48:51], a[248:251], v[24:27], v[48:51]
  s_waitcnt lgkmcnt(0)
  v_mfma_f32_16x16x32_bf16 v[36:39], a[124:127], v[28:31], v[36:39]
  v_mfma_f32_16x16x32_bf16 v[40:43], a[124:127], v[32:35], v[40:43]
  v_mfma_f32_16x16x32_bf16 v[44:47], a[252:255], v[28:31], v[44:47]
  v_mfma_f32_16x16x32_bf16 v[48:51], a[252:255], v[32:35], v[48:51]
  v_cmp_gt_i32 vcc, s29, v3
  s_cmp_eq_u64 vcc, 0
  s_cselect_b32 s28, 2, 0
  s_cmp_lt_u32 s25, 63
  s_cselect_b32 s28, s28, 0
L_WO_epi:
  v_cvt_pk_bf16_f32 v52, v36, v37
  v_cvt_pk_bf16_f32 v53, v38, v39
  v_cvt_pk_bf16_f32 v54, v44, v45
  v_cvt_pk_bf16_f32 v55, v46, v47
  buffer_store_dwordx4 v[52:55], v68, s[4:7], s31 offen offset:0 sc1
  v_cvt_pk_bf16_f32 v56, v40, v41
  v_cvt_pk_bf16_f32 v57, v42, v43
  v_cvt_pk_bf16_f32 v58, v48, v49
  v_cvt_pk_bf16_f32 v59, v50, v51
  buffer_store_dwordx4 v[56:59], v68, s[4:7], s31 offen offset:1024 sc1
  s_add_u32 s25, s25, 1
  s_add_u32 s31, s31, 2097152
  s_xor_b32 s31, s31, 0x2000
  s_branch L_WO_top
L_F1:
  v_lshlrev_b32 v1, 4, v0
  s_lshl_b32 s32, s20, 12
  s_min_u32 s33, s32, 0x2000
  v_mov_b32 v69, v1
  v_add_u32 v70, 0x10000, v69
  v_and_b32 v1, 3, v0
  v_lshlrev_b32 v1, 4, v1
  v_lshrrev_b32 v52, 4, v0
  v_lshl_add_u32 v1, v52, 6, v1
  v_bfe_u32 v52, v0, 2, 2
  v_lshl_add_u32 v1, v52, 8, v1
  s_load_dwordx2 s[8:9], s[0:1], 64
  s_mov_b32 s10, 7340032
  s_mov_b32 s11, 0x20000
  s_waitcnt lgkmcnt(0)
  s_lshl_b32 s44, s21, 7
  v_bfe_u32 v4, v0, 5, 1
  v_mul_u32_u24 v4, 28672, v4
  v_bfe_u32 v5, v0, 4, 1
  v_mul_u32_u24 v5, 14336, v5
  v_add_u32 v4, v4, v5
  v_bfe_u32 v5, v0, 3, 1
  v_mul_u32_u24 v5, 7168, v5
  v_add_u32 v4, v4, v5
  v_lshrrev_b32 v5, 3, v0
  v_and_b32 v5, 6, v5
  v_xor_b32 v5, v5, v0
  v_and_b32 v5, 7, v5
  v_lshl_add_u32 v4, v5, 4, v4
  s_lshr_b32 s40, s20, 1
  s_mul_i32 s40, s40, 458752
  s_and_b32 s41, s20, 1
  s_mul_i32 s41, s41, 57344
  s_add_u32 s40, s40, s41
  v_add_u32 v4, s40, v4
  v_bfe_u32 v5, v0, 3, 2
  v_xor_b32 v5, s20, v5
  v_lshlrev_b32 v5, 5, v5
  v_lshrrev_b32 v6, 2, v0
  v_lshl_add_u32 v6, v6, 7, v5
  v_and_b32 v5, 3, v0
  v_lshl_add_u32 v6, v5, 3, v6
  v_add_u32 v7, 0x10000, v6
  v_add_u32 v8, s44, v4
  v_add_u32 v9, s44, v4
  s_lshl_b32 s41, s20, 10
  s_add_u32 m0, s41, 0
  s_mov_b32 s42, 0
  buffer_load_dwordx4 v8, s[8:11], s42 offen nt lds
  s_add_u32 m0, s41, 4096
  s_mov_b32 s42, 114688
  buffer_load_dwordx4 v8, s[8:11], s42 offen nt lds
  s_add_u32 m0, s41, 8192
  s_mov_b32 s42, 229376
  buffer_load_dwordx4 v8, s[8:11], s42 offen nt lds
  s_add_u32 m0, s41, 12288
  s_mov_b32 s42, 344064
  buffer_load_dwordx4 v8, s[8:11], s42 offen nt lds
  s_add_u32 m0, s41, 16384
  s_mov_b32 s42, 917504
  buffer_load_dwordx4 v8, s[8:11], s42 offen nt lds
  s_add_u32 m0, s41, 20480
  s_mov_b32 s42, 1032192
  buffer_load_dwordx4 v8, s[8:11], s42 offen nt lds
  s_add_u32 m0, s41, 24576
  s_mov_b32 s42, 1146880
  buffer_load_dwordx4 v8, s[8:11], s42 offen nt lds
  s_add_u32 m0, s41, 28672
  s_mov_b32 s42, 1261568
  buffer_load_dwordx4 v8, s[8:11], s42 offen nt lds
  s_add_u32 m0, s41, 32768
  s_mov_b32 s42, 1835008
  buffer_load_dwordx4 v8, s[8:11], s42 offen nt lds
  s_add_u32 m0, s41, 36864
  s_mov_b32 s42, 1949696
  buffer_load_dwordx4 v8, s[8:11], s42 offen nt lds
  s_add_u32 m0, s41, 40960
  s_mov_b32 s42, 2064384
  buffer_load_dwordx4 v8, s[8:11], s42 offen nt lds
  s_add_u32 m0, s41, 45056
  s_mov_b32 s42, 2179072
  buffer_load_dwordx4 v8, s[8:11], s42 offen nt lds
  s_add_u32 m0, s41, 49152
  s_mov_b32 s42, 2752512
  buffer_load_dwordx4 v8, s[8:11], s42 offen nt lds
  s_add_u32 m0, s41, 53248
  s_mov_b32 s42, 2867200
  buffer_load_dwordx4 v8, s[8:11], s42 offen nt lds
  s_add_u32 m0, s41, 57344
  s_mov_b32 s42, 2981888
  buffer_load_dwordx4 v8, s[8:11], s42 offen nt lds
  s_add_u32 m0, s41, 61440
  s_mov_b32 s42, 3096576
  buffer_load_dwordx4 v8, s[8:11], s42 offen nt lds
  s_add_u32 m0, s41, 65536
  s_mov_b32 s42, 3670016
  buffer_load_dwordx4 v8, s[8:11], s42 offen nt lds
  s_add_u32 m0, s41, 69632
  s_mov_b32 s42, 3784704
  buffer_load_dwordx4 v8, s[8:11], s42 offen nt lds
  s_add_u32 m0, s41, 73728
  s_mov_b32 s42, 3899392
  buffer_load_dwordx4 v8, s[8:11], s42 offen nt lds
  s_add_u32 m0, s41, 77824
  s_mov_b32 s42, 4014080
  buffer_load_dwordx4 v8, s[8:11], s42 offen nt lds
  s_add_u32 m0, s41, 81920
  s_mov_b32 s42, 4587520
  buffer_load_dwordx4 v8, s[8:11], s42 offen nt lds
  s_add_u32 m0, s41, 86016
  s_mov_b32 s42, 4702208
  buffer_load_dwordx4 v8, s[8:11], s42 offen nt lds
  s_add_u32 m0, s41, 90112
  s_mov_b32 s42, 4816896
  buffer_load_dwordx4 v8, s[8:11], s42 offen nt lds
  s_add_u32 m0, s41, 94208
  s_mov_b32 s42, 4931584
  buffer_load_dwordx4 v8, s[8:11], s42 offen nt lds
  s_add_u32 m0, s41, 98304
  s_mov_b32 s42, 5505024
  buffer_load_dwordx4 v8, s[8:11], s42 offen nt lds
  s_add_u32 m0, s41, 102400
  s_mov_b32 s42, 5619712
  buffer_load_dwordx4 v8, s[8:11], s42 offen nt lds
  s_add_u32 m0, s41, 106496
  s_mov_b32 s42, 5734400
  buffer_load_dwordx4 v8, s[8:11], s42 offen nt lds
  s_add_u32 m0, s41, 110592
  s_mov_b32 s42, 5849088
  buffer_load_dwordx4 v8, s[8:11], s42 offen nt lds
  s_waitcnt vmcnt(24) lgkmcnt(0)
  s_barrier
  s_add_u32 m0, s41, 114688
  s_mov_b32 s42, 6422528
  buffer_load_dwordx4 v8, s[8:11], s42 offen nt lds
  s_add_u32 m0, s41, 118784
  s_mov_b32 s42, 6537216
  buffer_load_dwordx4 v8, s[8:11], s42 offen nt lds
  s_add_u32 m0, s41, 122880
  s_mov_b32 s42, 6651904
  buffer_load_dwordx4 v8, s[8:11], s42 offen nt lds
  s_add_u32 m0, s41, 126976
  s_mov_b32 s42, 6766592
  buffer_load_dwordx4 v8, s[8:11], s42 offen nt lds
  ds_read_b64_tr_b16 a[0:1], v6 offset:0
  ds_read_b64_tr_b16 a[2:3], v6 offset:2048
  ds_read_b64_tr_b16 a[4:5], v6 offset:4096
  ds_read_b64_tr_b16 a[6:7], v6 offset:6144
  ds_read_b64_tr_b16 a[8:9], v6 offset:8192
  ds_read_b64_tr_b16 a[10:11], v6 offset:10240
  ds_read_b64_tr_b16 a[12:13], v6 offset:12288
  ds_read_b64_tr_b16 a[14:15], v6 offset:14336
  s_waitcnt vmcnt(24) lgkmcnt(0)
  s_barrier
  s_load_dwordx2 s[8:9], s[0:1], 72
  s_mov_b32 s10, 7340032
  s_mov_b32 s11, 0x20000
  s_waitcnt lgkmcnt(0)
  s_add_u32 m0, s41, 0
  s_mov_b32 s42, 0
  buffer_load_dwordx4 v9, s[8:11], s42 offen nt lds
  s_add_u32 m0, s41, 4096
  s_mov_b32 s42, 114688
  buffer_load_dwordx4 v9, s[8:11], s42 offen nt lds
  s_add_u32 m0, s41, 8192
  s_mov_b32 s42, 229376
  buffer_load_dwordx4 v9, s[8:11], s42 offen nt lds
  s_add_u32 m0, s41, 12288
  s_mov_b32 s42, 344064
  buffer_load_dwordx4 v9, s[8:11], s42 offen nt lds
  ds_read_b64_tr_b16 a[16:17], v6 offset:16384
  ds_read_b64_tr_b16 a[18:19], v6 offset:18432
  ds_read_b64_tr_b16 a[20:21], v6 offset:20480
  ds_read_b64_tr_b16 a[22:23], v6 offset:22528
  ds_read_b64_tr_b16 a[24:25], v6 offset:24576
  ds_read_b64_tr_b16 a[26:27], v6 offset:26624
  ds_read_b64_tr_b16 a[28:29], v6 offset:28672
  ds_read_b64_tr_b16 a[30:31], v6 offset:30720
  s_waitcnt vmcnt(24) lgkmcnt(0)
  s_barrier
  s_add_u32 m0, s41, 16384
  s_mov_b32 s42, 917504
  buffer_load_dwordx4 v9, s[8:11], s42 offen nt lds
  s_add_u32 m0, s41, 20480
  s_mov_b32 s42, 1032192
  buffer_load_dwordx4 v9, s[8:11], s42 offen nt lds
  s_add_u32 m0, s41, 24576
  s_mov_b32 s42, 1146880
  buffer_load_dwordx4 v9, s[8:11], s42 offen nt lds
  s_add_u32 m0, s41, 28672
  s_mov_b32 s42, 1261568
  buffer_load_dwordx4 v9, s[8:11], s42 offen nt lds
  ds_read_b64_tr_b16 a[32:33], v6 offset:32768
  ds_read_b64_tr_b16 a[34:35], v6 offset:34816
  ds_read_b64_tr_b16 a[36:37], v6 offset:36864
  ds_read_b64_tr_b16 a[38:39], v6 offset:38912
  ds_read_b64_tr_b16 a[40:41], v6 offset:40960
  ds_read_b64_tr_b16 a[42:43], v6 offset:43008
  ds_read_b64_tr_b16 a[44:45], v6 offset:45056
  ds_read_b64_tr_b16 a[46:47], v6 offset:47104
  s_waitcnt vmcnt(24) lgkmcnt(0)
  s_barrier
  s_add_u32 m0, s41, 32768
  s_mov_b32 s42, 1835008
  buffer_load_dwordx4 v9, s[8:11], s42 offen nt lds
  s_add_u32 m0, s41, 36864
  s_mov_b32 s42, 1949696
  buffer_load_dwordx4 v9, s[8:11], s42 offen nt lds
  s_add_u32 m0, s41, 40960
  s_mov_b32 s42, 2064384
  buffer_load_dwordx4 v9, s[8:11], s42 offen nt lds
  s_add_u32 m0, s41, 45056
  s_mov_b32 s42, 2179072
  buffer_load_dwordx4 v9, s[8:11], s42 offen nt lds
  ds_read_b64_tr_b16 a[48:49], v6 offset:49152
  ds_read_b64_tr_b16 a[50:51], v6 offset:51200
  ds_read_b64_tr_b16 a[52:53], v6 offset:53248
  ds_read_b64_tr_b16 a[54:55], v6 offset:55296
  ds_read_b64_tr_b16 a[56:57], v6 offset:57344
  ds_read_b64_tr_b16 a[58:59], v6 offset:59392
  ds_read_b64_tr_b16 a[60:61], v6 offset:61440
  ds_read_b64_tr_b16 a[62:63], v6 offset:63488
  s_waitcnt vmcnt(24) lgkmcnt(0)
  s_barrier
  s_add_u32 m0, s41, 49152
  s_mov_b32 s42, 2752512
  buffer_load_dwordx4 v9, s[8:11], s42 offen nt lds
  s_add_u32 m0, s41, 53248
  s_mov_b32 s42, 2867200
  buffer_load_dwordx4 v9, s[8:11], s42 offen nt lds
  s_add_u32 m0, s41, 57344
  s_mov_b32 s42, 2981888
  buffer_load_dwordx4 v9, s[8:11], s42 offen nt lds
  s_add_u32 m0, s41, 61440
  s_mov_b32 s42, 3096576
  buffer_load_dwordx4 v9, s[8:11], s42 offen nt lds
  ds_read_b64_tr_b16 a[64:65], v7 offset:0
  ds_read_b64_tr_b16 a[66:67], v7 offset:2048
  ds_read_b64_tr_b16 a[68:69], v7 offset:4096
  ds_read_b64_tr_b16 a[70:71], v7 offset:6144
  ds_read_b64_tr_b16 a[72:73], v7 offset:8192
  ds_read_b64_tr_b16 a[74:75], v7 offset:10240
  ds_read_b64_tr_b16 a[76:77], v7 offset:12288
  ds_read_b64_tr_b16 a[78:79], v7 offset:14336
  s_waitcnt vmcnt(24) lgkmcnt(0)
  s_barrier
  s_add_u32 m0, s41, 65536
  s_mov_b32 s42, 3670016
  buffer_load_dwordx4 v9, s[8:11], s42 offen nt lds
  s_add_u32 m0, s41, 69632
  s_mov_b32 s42, 3784704
  buffer_load_dwordx4 v9, s[8:11], s42 offen nt lds
  s_add_u32 m0, s41, 73728
  s_mov_b32 s42, 3899392
  buffer_load_dwordx4 v9, s[8:11], s42 offen nt lds
  s_add_u32 m0, s41, 77824
  s_mov_b32 s42, 4014080
  buffer_load_dwordx4 v9, s[8:11], s42 offen nt lds
  ds_read_b64_tr_b16 a[80:81], v7 offset:16384
  ds_read_b64_tr_b16 a[82:83], v7 offset:18432
  ds_read_b64_tr_b16 a[84:85], v7 offset:20480
  ds_read_b64_tr_b16 a[86:87], v7 offset:22528
  ds_read_b64_tr_b16 a[88:89], v7 offset:24576
  ds_read_b64_tr_b16 a[90:91], v7 offset:26624
  ds_read_b64_tr_b16 a[92:93], v7 offset:28672
  ds_read_b64_tr_b16 a[94:95], v7 offset:30720
  s_waitcnt vmcnt(24) lgkmcnt(0)
  s_barrier
  s_add_u32 m0, s41, 81920
  s_mov_b32 s42, 4587520
  buffer_load_dwordx4 v9, s[8:11], s42 offen nt lds
  s_add_u32 m0, s41, 86016
  s_mov_b32 s42, 4702208
  buffer_load_dwordx4 v9, s[8:11], s42 offen nt lds
  s_add_u32 m0, s41, 90112
  s_mov_b32 s42, 4816896
  buffer_load_dwordx4 v9, s[8:11], s42 offen nt lds
  s_add_u32 m0, s41, 94208
  s_mov_b32 s42, 4931584
  buffer_load_dwordx4 v9, s[8:11], s42 offen nt lds
  ds_read_b64_tr_b16 a[96:97], v7 offset:32768
  ds_read_b64_tr_b16 a[98:99], v7 offset:34816
  ds_read_b64_tr_b16 a[100:101], v7 offset:36864
  ds_read_b64_tr_b16 a[102:103], v7 offset:38912
  ds_read_b64_tr_b16 a[104:105], v7 offset:40960
  ds_read_b64_tr_b16 a[106:107], v7 offset:43008
  ds_read_b64_tr_b16 a[108:109], v7 offset:45056
  ds_read_b64_tr_b16 a[110:111], v7 offset:47104
  s_waitcnt vmcnt(24) lgkmcnt(0)
  s_barrier
  s_add_u32 m0, s41, 98304
  s_mov_b32 s42, 5505024
  buffer_load_dwordx4 v9, s[8:11], s42 offen nt lds
  s_add_u32 m0, s41, 102400
  s_mov_b32 s42, 5619712
  buffer_load_dwordx4 v9, s[8:11], s42 offen nt lds
  s_add_u32 m0, s41, 106496
  s_mov_b32 s42, 5734400
  buffer_load_dwordx4 v9, s[8:11], s42 offen nt lds
  s_add_u32 m0, s41, 110592
  s_mov_b32 s42, 5849088
  buffer_load_dwordx4 v9, s[8:11], s42 offen nt lds
  ds_read_b64_tr_b16 a[112:113], v7 offset:49152
  ds_read_b64_tr_b16 a[114:115], v7 offset:51200
  ds_read_b64_tr_b16 a[116:117], v7 offset:53248
  ds_read_b64_tr_b16 a[118:119], v7 offset:55296
  ds_read_b64_tr_b16 a[120:121], v7 offset:57344
  ds_read_b64_tr_b16 a[122:123], v7 offset:59392
  ds_read_b64_tr_b16 a[124:125], v7 offset:61440
  ds_read_b64_tr_b16 a[126:127], v7 offset:63488
  s_waitcnt vmcnt(24) lgkmcnt(0)
  s_barrier
  s_add_u32 m0, s41, 114688
  s_mov_b32 s42, 6422528
  buffer_load_dwordx4 v9, s[8:11], s42 offen nt lds
  s_add_u32 m0, s41, 118784
  s_mov_b32 s42, 6537216
  buffer_load_dwordx4 v9, s[8:11], s42 offen nt lds
  s_add_u32 m0, s41, 122880
  s_mov_b32 s42, 6651904
  buffer_load_dwordx4 v9, s[8:11], s42 offen nt lds
  s_add_u32 m0, s41, 126976
  s_mov_b32 s42, 6766592
  buffer_load_dwordx4 v9, s[8:11], s42 offen nt lds
  ds_read_b64_tr_b16 a[128:129], v6 offset:0
  ds_read_b64_tr_b16 a[130:131], v6 offset:2048
  ds_read_b64_tr_b16 a[132:133], v6 offset:4096
  ds_read_b64_tr_b16 a[134:135], v6 offset:6144
  ds_read_b64_tr_b16 a[136:137], v6 offset:8192
  ds_read_b64_tr_b16 a[138:139], v6 offset:10240
  ds_read_b64_tr_b16 a[140:141], v6 offset:12288
  ds_read_b64_tr_b16 a[142:143], v6 offset:14336
  s_waitcnt vmcnt(24) lgkmcnt(0)
  s_barrier
  ds_read_b64_tr_b16 a[144:145], v6 offset:16384
  ds_read_b64_tr_b16 a[146:147], v6 offset:18432
  ds_read_b64_tr_b16 a[148:149], v6 offset:20480
  ds_read_b64_tr_b16 a[150:151], v6 offset:22528
  ds_read_b64_tr_b16 a[152:153], v6 offset:24576
  ds_read_b64_tr_b16 a[154:155], v6 offset:26624
  ds_read_b64_tr_b16 a[156:157], v6 offset:28672
  ds_read_b64_tr_b16 a[158:159], v6 offset:30720
  s_waitcnt vmcnt(20) lgkmcnt(0)
  s_barrier
  ds_read_b64_tr_b16 a[160:161], v6 offset:32768
  ds_read_b64_tr_b16 a[162:163], v6 offset:34816
  ds_read_b64_tr_b16 a[164:165], v6 offset:36864
  ds_read_b64_tr_b16 a[166:167], v6 offset:38912
  ds_read_b64_tr_b16 a[168:169], v6 offset:40960
  ds_read_b64_tr_b16 a[170:171], v6 offset:43008
  ds_read_b64_tr_b16 a[172:173], v6 offset:45056
  ds_read_b64_tr_b16 a[174:175], v6 offset:47104
  s_waitcnt vmcnt(16) lgkmcnt(0)
  s_barrier
  ds_read_b64_tr_b16 a[176:177], v6 offset:49152
  ds_read_b64_tr_b16 a[178:179], v6 offset:51200
  ds_read_b64_tr_b16 a[180:181], v6 offset:53248
  ds_read_b64_tr_b16 a[182:183], v6 offset:55296
  ds_read_b64_tr_b16 a[184:185], v6 offset:57344
  ds_read_b64_tr_b16 a[186:187], v6 offset:59392
  ds_read_b64_tr_b16 a[188:189], v6 offset:61440
  ds_read_b64_tr_b16 a[190:191], v6 offset:63488
  s_waitcnt vmcnt(12) lgkmcnt(0)
  s_barrier
  ds_read_b64_tr_b16 a[192:193], v7 offset:0
  ds_read_b64_tr_b16 a[194:195], v7 offset:2048
  ds_read_b64_tr_b16 a[196:197], v7 offset:4096
  ds_read_b64_tr_b16 a[198:199], v7 offset:6144
  ds_read_b64_tr_b16 a[200:201], v7 offset:8192
  ds_read_b64_tr_b16 a[202:203], v7 offset:10240
  ds_read_b64_tr_b16 a[204:205], v7 offset:12288
  ds_read_b64_tr_b16 a[206:207], v7 offset:14336
  s_waitcnt vmcnt(8) lgkmcnt(0)
  s_barrier
  ds_read_b64_tr_b16 a[208:209], v7 offset:16384
  ds_read_b64_tr_b16 a[210:211], v7 offset:18432
  ds_read_b64_tr_b16 a[212:213], v7 offset:20480
  ds_read_b64_tr_b16 a[214:215], v7 offset:22528
  ds_read_b64_tr_b16 a[216:217], v7 offset:24576
  ds_read_b64_tr_b16 a[218:219], v7 offset:26624
  ds_read_b64_tr_b16 a[220:221], v7 offset:28672
  ds_read_b64_tr_b16 a[222:223], v7 offset:30720
  s_waitcnt vmcnt(4) lgkmcnt(0)
  s_barrier
  ds_read_b64_tr_b16 a[224:225], v7 offset:32768
  ds_read_b64_tr_b16 a[226:227], v7 offset:34816
  ds_read_b64_tr_b16 a[228:229], v7 offset:36864
  ds_read_b64_tr_b16 a[230:231], v7 offset:38912
  ds_read_b64_tr_b16 a[232:233], v7 offset:40960
  ds_read_b64_tr_b16 a[234:235], v7 offset:43008
  ds_read_b64_tr_b16 a[236:237], v7 offset:45056
  ds_read_b64_tr_b16 a[238:239], v7 offset:47104
  s_waitcnt vmcnt(0) lgkmcnt(0)
  s_barrier
  ds_read_b64_tr_b16 a[240:241], v7 offset:49152
  ds_read_b64_tr_b16 a[242:243], v7 offset:51200
  ds_read_b64_tr_b16 a[244:245], v7 offset:53248
  ds_read_b64_tr_b16 a[246:247], v7 offset:55296
  ds_read_b64_tr_b16 a[248:249], v7 offset:57344
  ds_read_b64_tr_b16 a[250:251], v7 offset:59392
  ds_read_b64_tr_b16 a[252:253], v7 offset:61440
  ds_read_b64_tr_b16 a[254:255], v7 offset:63488
  s_waitcnt lgkmcnt(0)
  s_barrier
  v_min_u32 v2, 7, v0
  v_lshlrev_b32 v2, 7, v2
  v_add_u32 v2, 1413120, v2
  s_lshl_b32 s62, s21, 7
  s_add_u32 s62, s62, 1414144
  v_min_u32 v52, 63, v0
  v_lshlrev_b32 v52, 7, v52
  v_add_u32 v52, 1424384, v52
  s_nop 1
Lpoll_41:
  buffer_load_dword v53, v52, s[4:7], 0 offen sc1
  s_sub_u32 s24, s24, 1
  s_cbranch_scc1 L_FAIL
  s_waitcnt vmcnt(0)
  v_cmp_gt_i32 vcc, 0, v53
  s_cbranch_vccz Lpolld_42
  s_sleep 1
  s_branch Lpoll_41
Lpolld_42:
  v_lshrrev_b32 v53, 8, v53
  v_and_b32 v54, 3, v0
  v_lshl_or_b32 v53, v53, 2, v54
  s_nop 1
  v_min_u32_dpp v53, v53, v53 row_ror:8 row_mask:0xf bank_mask:0xf
  s_nop 1
  v_min_u32_dpp v53, v53, v53 row_ror:4 row_mask:0xf bank_mask:0xf
  v_mov_b32 v54, v53
  s_nop 1
  v_permlane16_swap_b32 v54, v53
  v_min_u32 v53, v53, v54
  v_mov_b32 v54, v53
  s_nop 1
  v_permlane32_swap_b32 v54, v53
  v_min_u32 v53, v53, v54
  s_nop 1
  v_min_u32_dpp v53, v53, v53 row_ror:2 row_mask:0xf bank_mask:0xf
  s_nop 1
  v_min_u32_dpp v53, v53, v53 row_ror:1 row_mask:0xf bank_mask:0xf
  s_nop 0
  v_readfirstlane_b32 s38, v53
  s_and_b32 s38, s38, 3
  s_lshl_b32 s38, s38, 13
  s_and_b32 s38, s38, 0x2000
  s_xor_b32 s38, s38, 16785408
  s_lshr_b32 s40, s20, 1
  s_lshl_b32 s40, s40, 14
  s_and_b32 s41, s20, 1
  s_lshl_b32 s41, s41, 12
  s_add_u32 s27, s40, s41
  s_lshr_b32 s40, s21, 1
  s_lshl_b32 s40, s40, 14
  s_and_b32 s41, s21, 1
  s_lshl_b32 s41, s41, 12
  s_add_u32 s31, s40, s41
  s_add_u32 s27, s27, s38
  s_add_u32 s27, s27, 917504
  s_add_u32 s31, s31, s38
  s_add_u32 s31, s31, 1179648
  s_lshr_b32 s40, s20, 1
  s_lshl_b32 s40, s40, 11
  s_and_b32 s41, s20, 1
  s_lshl_b32 s41, s41, 9
  s_add_u32 s40, s40, s41
  v_and_b32 v52, 31, v0
  v_lshl_add_u32 v68, v52, 4, s40
  v_lshrrev_b32 v52, 5, v0
  v_lshl_add_u32 v68, v52, 10, v68
  s_mov_b32 s37, 0xbfb8aa3b
  v_lshlrev_b32 v71, 2, v0
  v_add_u32 v71, 131072, v71
  s_mov_b32 s25, 0
  s_mov_b32 s26, 0
  s_mov_b32 s29, 1
  s_mov_b32 s30, 0
  s_mov_b32 s28, 0
L_F1_top:
  s_cmp_eq_u32 s28, 1
  s_cbranch_scc1 L_F1_go
  s_cmp_eq_u32 s28, 2
  s_cbranch_scc1 L_F1_mid
  s_cmp_lg_u32 s20, 0
  s_cbranch_scc1 L_F1_park
  buffer_load_dword v3, v2, s[4:7], s30 offen sc1
  s_waitcnt vmcnt(1)
  s_barrier
  s_mov_b32 s63, s25
  s_atomic_smax s63, s[4:5], s62 glc
Lnosig_43:
  s_cmp_ge_u32 s25, 64
  s_cbranch_scc1 L_END
  s_waitcnt vmcnt(0)
  v_cmp_gt_i32 vcc, s29, v3
  s_cbranch_vccz L_F1_issue
  s_nop 3
Lpoll_44:
  buffer_load_dword v3, v2, s[4:7], s30 offen sc1
  s_sub_u32 s24, s24, 1
  s_cbranch_scc1 L_FAIL
  s_waitcnt vmcnt(0)
  v_cmp_gt_i32 vcc, s29, v3
  s_cbranch_vccz Lpolld_45
  s_sleep 1
  s_branch Lpoll_44
Lpolld_45:
  s_branch L_F1_issue
L_F1_park:
  s_waitcnt vmcnt(0)
  s_barrier
  s_cmp_ge_u32 s25, 64
  s_cbranch_scc1 L_END
L_F1_issue:
  s_barrier
L_F1_mid:
  s_mov_b32 s34, s26
  s_mov_b32 s35, s27
  s_add_u32 s36, s32, 0
  s_add_u32 m0, s34, s36
  s_add_u32 s36, s35, 0
  buffer_load_dwordx4 v1, s[4:7], s36 offen offset:0 sc1 lds
  s_nop 0
  buffer_load_dwordx4 v1, s[4:7], s36 offen offset:1024 sc1 lds
  s_nop 0
  buffer_load_dwordx4 v1, s[4:7], s36 offen offset:2048 sc1 lds
  s_nop 0
  buffer_load_dwordx4 v1, s[4:7], s36 offen offset:3072 sc1 lds
  s_nop 0
  s_add_u32 s36, s32, 16384
  s_add_u32 m0, s34, s36
  s_add_u32 s36, s35, 32768
  buffer_load_dwordx4 v1, s[4:7], s36 offen offset:0 sc1 lds
  s_nop 0
  buffer_load_dwordx4 v1, s[4:7], s36 offen offset:1024 sc1 lds
  s_nop 0
  buffer_load_dwordx4 v1, s[4:7], s36 offen offset:2048 sc1 lds
  s_nop 0
  buffer_load_dwordx4 v1, s[4:7], s36 offen offset:3072 sc1 lds
  s_nop 0
  s_add_u32 s36, s32, 32768
  s_add_u32 m0, s34, s36
  s_add_u32 s36, s35, 65536
  buffer_load_dwordx4 v1, s[4:7], s36 offen offset:0 sc1 lds
  s_nop 0
  buffer_load_dwordx4 v1, s[4:7], s36 offen offset:1024 sc1 lds
  s_nop 0
  buffer_load_dwordx4 v1, s[4:7], s36 offen offset:2048 sc1 lds
  s_nop 0
  buffer_load_dwordx4 v1, s[4:7], s36 offen offset:3072 sc1 lds
  s_nop 0
  s_cmp_eq_u32 s28, 0
  s_cbranch_scc1 L_F1_go
  s_mov_b32 s28, 0
  s_waitcnt vmcnt(12)
  s_barrier
  s_cmp_lg_u32 s20, 0
  s_cbranch_scc1 Lnosig_46
  s_mov_b32 s63, s25
  s_atomic_smax s63, s[4:5], s62 glc
Lnosig_46:
L_F1_go:
  v_add_u32 v73, s26, v69
  v_add_u32 v74, s26, v70
  s_sub_u32 s26, 65536, s26
  s_add_u32 s27, s27, 2097152
  s_xor_b32 s27, s27, 0x2000
  s_add_u32 s29, s29, 1
  s_waitcnt vmcnt(8)
  s_barrier
  ds_read_b128 v[4:7], v73 offset:0
  ds_read_b128 v[8:11], v73 offset:1024
  ds_read_b128 v[12:15], v73 offset:2048
  ds_read_b128 v[16:19], v73 offset:3072
  ds_read_b128 v[20:23], v73 offset:4096
  ds_read_b128 v[24:27], v73 offset:5120
  s_waitcnt lgkmcnt(4)
  v_mfma_f32_16x16x32_bf16 v[36:39], a[0:3], v[4:7], 0
  ds_read_b128 v[28:31], v73 offset:6144
  v_mfma_f32_16x16x32_bf16 v[40:43], a[0:3], v[8:11], 0
  ds_read_b128 v[32:35], v73 offset:7168
  v_mfma_f32_16x16x32_bf16 v[44:47], a[128:131], v[4:7], 0
  s_add_u32 s36, s32, 49152
  s_add_u32 m0, s34, s36
  s_add_u32 s36, s35, 98304
  buffer_load_dwordx4 v1, s[4:7], s36 offen offset:0 sc1 lds
  v_mfma_f32_16x16x32_bf16 v[48:51], a[128:131], v[8:11], 0
  s_waitcnt lgkmcnt(4)
  v_mfma_f32_16x16x32_bf16 v[36:39], a[4:7], v[12:15], v[36:39]
  ds_read_b128 v[4:7], v73 offset:8192
  v_mfma_f32_16x16x32_bf16 v[40:43], a[4:7], v[16:19], v[40:43]
  ds_read_b128 v[8:11], v73 offset:9216
  v_mfma_f32_16x16x32_bf16 v[44:47], a[132:135], v[12:15], v[44:47]
  buffer_load_dwordx4 v1, s[4:7], s36 offen offset:1024 sc1 lds
  v_mfma_f32_16x16x32_bf16 v[48:51], a[132:135], v[16:19], v[48:51]
  s_waitcnt lgkmcnt(4)
  v_mfma_f32_16x16x32_bf16 v[36:39], a[8:11], v[20:23], v[36:39]
  ds_read_b128 v[12:15], v73 offset:10240
  v_mfma_f32_16x16x32_bf16 v[40:43], a[8:11], v[24:27], v[40:43]
  ds_read_b128 v[16:19], v73 offset:11264
  v_mfma_f32_16x16x32_bf16 v[44:47], a[136:139], v[20:23], v[44:47]
  buffer_load_dwordx4 v1, s[4:7], s36 offen offset:2048 sc1 lds
  v_mfma_f32_16x16x32_bf16 v[48:51], a[136:139], v[24:27], v[48:51]
  s_waitcnt lgkmcnt(4)
  v_mfma_f32_16x16x32_bf16 v[36:39], a[12:15], v[28:31], v[36:39]
  ds_read_b128 v[20:23], v73 offset:12288
  v_mfma_f32_16x16x32_bf16 v[40:43], a[12:15], v[32:35], v[40:43]
  ds_read_b128 v[24:27], v73 offset:13312
  v_mfma_f32_16x16x32_bf16 v[44:47], a[140:143], v[28:31], v[44:47]
  buffer_load_dwordx4 v1, s[4:7], s36 offen offset:3072 sc1 lds
  v_mfma_f32_16x16x32_bf16 v[48:51], a[140:143], v[32:35], v[48:51]
  s_waitcnt lgkmcnt(4)
  v_mfma_f32_16x16x32_bf16 v[36:39], a[16:19], v[4:7], v[36:39]
  ds_read_b128 v[28:31], v73 offset:14336
  v_mfma_f32_16x16x32_bf16 v[40:43], a[16:19], v[8:11], v[40:43]
  ds_read_b128 v[32:35], v73 offset:15360
  v_mfma_f32_16x16x32_bf16 v[44:47], a[144:147], v[4:7], v[44:47]
  v_mfma_f32_16x16x32_bf16 v[48:51], a[144:147], v[8:11], v[48:51]
  s_waitcnt vmcnt(8)
  s_barrier
  s_mov_b32 s34, s26
  s_mov_b32 s35, s27
  s_waitcnt lgkmcnt(4)
  v_mfma_f32_16x16x32_bf16 v[36:39], a[20:23], v[12:15], v[36:39]
  ds_read_b128 v[4:7], v73 offset:16384
  v_mfma_f32_16x16x32_bf16 v[40:43], a[20:23], v[16:19], v[40:43]
  ds_read_b128 v[8:11], v73 offset:17408
  v_mfma_f32_16x16x32_bf16 v[44:47], a[148:151], v[12:15], v[44:47]
  v_mfma_f32_16x16x32_bf16 v[48:51], a[148:151], v[16:19], v[48:51]
  s_waitcnt lgkmcnt(4)
  v_mfma_f32_16x16x32_bf16 v[36:39], a[24:27], v[20:23], v[36:39]
  ds_read_b128 v[12:15], v73 offset:18432
  v_mfma_f32_16x16x32_bf16 v[40:43], a[24:27], v[24:27], v[40:43]
  ds_read_b128 v[16:19], v73 offset:19456
  v_mfma_f32_16x16x32_bf16 v[44:47], a[152:155], v[20:23], v[44:47]
  v_mfma_f32_16x16x32_bf16 v[48:51], a[152:155], v[24:27], v[48:51]
  s_waitcnt lgkmcnt(4)
  v_mfma_f32_16x16x32_bf16 v[36:39], a[28:31], v[28:31], v[36:39]
  ds_read_b128 v[20:23], v73 offset:20480
  v_mfma_f32_16x16x32_bf16 v[40:43], a[28:31], v[32:35], v[40:43]
  ds_read_b128 v[24:27], v73 offset:21504
  v_mfma_f32_16x16x32_bf16 v[44:47], a[156:159], v[28:31], v[44:47]
  v_mfma_f32_16x16x32_bf16 v[48:51], a[156:159], v[32:35], v[48:51]
  s_waitcnt lgkmcnt(4)
  v_mfma_f32_16x16x32_bf16 v[36:39], a[32:35], v[4:7], v[36:39]
  ds_read_b128 v[28:31], v73 offset:22528
  v_mfma_f32_16x16x32_bf16 v[40:43], a[32:35], v[8:11], v[40:43]
  ds_read_b128 v[32:35], v73 offset:23552
  v_mfma_f32_16x16x32_bf16 v[44:47], a[160:163], v[4:7], v[44:47]
  v_mfma_f32_16x16x32_bf16 v[48:51], a[160:163], v[8:11], v[48:51]
  s_waitcnt lgkmcnt(4)
  v_mfma_f32_16x16x32_bf16 v[36:39], a[36:39], v[12:15], v[36:39]
  ds_read_b128 v[4:7], v73 offset:24576
  v_mfma_f32_16x16x32_bf16 v[40:43], a[36:39], v[16:19], v[40:43]
  ds_read_b128 v[8:11], v73 offset:25600
  v_mfma_f32_16x16x32_bf16 v[44:47], a[164:167], v[12:15], v[44:47]
  v_mfma_f32_16x16x32_bf16 v[48:51], a[164:167], v[16:19], v[48:51]
  s_waitcnt lgkmcnt(4)
  v_mfma_f32_16x16x32_bf16 v[36:39], a[40:43], v[20:23], v[36:39]
  ds_read_b128 v[12:15], v73 offset:26624
  v_mfma_f32_16x16x32_bf16 v[40:43], a[40:43], v[24:27], v[40:43]
  ds_read_b128 v[16:19], v73 offset:27648
  v_mfma_f32_16x16x32_bf16 v[44:47], a[168:171], v[20:23], v[44:47]
  v_mfma_f32_16x16x32_bf16 v[48:51], a[168:171], v[24:27], v[48:51]
  s_waitcnt lgkmcnt(4)
  v_mfma_f32_16x16x32_bf16 v[36:39], a[44:47], v[28:31], v[36:39]
  ds_read_b128 v[20:23], v73 offset:28672
  v_mfma_f32_16x16x32_bf16 v[40:43], a[44:47], v[32:35], v[40:43]
  ds_read_b128 v[24:27], v73 offset:29696
  v_mfma_f32_16x16x32_bf16 v[44:47], a[172:175], v[28:31], v[44:47]
  v_mfma_f32_16x16x32_bf16 v[48:51], a[172:175], v[32:35], v[48:51]
  s_lshl_b32 s40, s20, 8
  s_add_u32 m0, s40, 131072
  s_cmp_eq_u32 s20, 0
  s_cselect_b32 s40, s30, 2147483392
  buffer_load_dword v2, s[4:7], s40 offen sc1 lds
  s_waitcnt lgkmcnt(4)
  v_mfma_f32_16x16x32_bf16 v[36:39], a[48:51], v[4:7], v[36:39]
  ds_read_b128 v[28:31], v73 offset:30720
  v_mfma_f32_16x16x32_bf16 v[40:43], a[48:51], v[8:11], v[40:43]
  ds_read_b128 v[32:35], v73 offset:31744
  v_mfma_f32_16x16x32_bf16 v[44:47], a[176:179], v[4:7], v[44:47]
  v_mfma_f32_16x16x32_bf16 v[48:51], a[176:179], v[8:11], v[48:51]
  s_waitcnt vmcnt(5)
  s_barrier
  s_lshl_b32 s40, s20, 1
  s_add_u32 s40, s40, 1
  s_cmp_lg_u32 s40, s28
  s_cbranch_scc1 L_F1_s2
  s_mov_b32 s63, s25
  s_atomic_smax s63, s[4:5], s62 glc
Lnosig_47:
L_F1_s2:
  s_waitcnt lgkmcnt(4)
  v_mfma_f32_16x16x32_bf16 v[36:39], a[52:55], v[12:15], v[36:39]
  ds_read_b128 v[4:7], v73 offset:32768
  v_mfma_f32_16x16x32_bf16 v[40:43], a[52:55], v[16:19], v[40:43]
  ds_read_b128 v[8:11], v73 offset:33792
  v_mfma_f32_16x16x32_bf16 v[44:47], a[180:183], v[12:15], v[44:47]
  v_mfma_f32_16x16x32_bf16 v[48:51], a[180:183], v[16:19], v[48:51]
  s_waitcnt lgkmcnt(4)
  v_mfma_f32_16x16x32_bf16 v[36:39], a[56:59], v[20:23], v[36:39]
  ds_read_b128 v[12:15], v73 offset:34816
  v_mfma_f32_16x16x32_bf16 v[40:43], a[56:59], v[24:27], v[40:43]
  ds_read_b128 v[16:19], v73 offset:35840
  v_mfma_f32_16x16x32_bf16 v[44:47], a[184:187], v[20:23], v[44:47]
  v_mfma_f32_16x16x32_bf16 v[48:51], a[184:187], v[24:27], v[48:51]
  s_waitcnt lgkmcnt(4)
  v_mfma_f32_16x16x32_bf16 v[36:39], a[60:63], v[28:31], v[36:39]
  ds_read_b128 v[20:23], v73 offset:36864
  v_mfma_f32_16x16x32_bf16 v[40:43], a[60:63], v[32:35], v[40:43]
  ds_read_b128 v[24:27], v73 offset:37888
  v_mfma_f32_16x16x32_bf16 v[44:47], a[188:191], v[28:31], v[44:47]
  v_mfma_f32_16x16x32_bf16 v[48:51], a[188:191], v[32:35], v[48:51]
  s_waitcnt lgkmcnt(4)
  v_mfma_f32_16x16x32_bf16 v[36:39], a[64:67], v[4:7], v[36:39]
  ds_read_b128 v[28:31], v73 offset:38912
  v_mfma_f32_16x16x32_bf16 v[40:43], a[64:67], v[8:11], v[40:43]
  ds_read_b128 v[32:35], v73 offset:39936
  v_mfma_f32_16x16x32_bf16 v[44:47], a[192:195], v[4:7], v[44:47]
  v_mfma_f32_16x16x32_bf16 v[48:51], a[192:195], v[8:11], v[48:51]
  s_waitcnt lgkmcnt(4)
  v_mfma_f32_16x16x32_bf16 v[36:39], a[68:71], v[12:15], v[36:39]
  ds_read_b128 v[4:7], v73 offset:40960
  v_mfma_f32_16x16x32_bf16 v[40:43], a[68:71], v[16:19], v[40:43]
  ds_read_b128 v[8:11], v73 offset:41984
  v_mfma_f32_16x16x32_bf16 v[44:47], a[196:199], v[12:15], v[44:47]
  v_mfma_f32_16x16x32_bf16 v[48:51], a[196:199], v[16:19], v[48:51]
  s_waitcnt lgkmcnt(4)
  v_mfma_f32_16x16x32_bf16 v[36:39], a[72:75], v[20:23], v[36:39]
  ds_read_b128 v[12:15], v73 offset:43008
  v_mfma_f32_16x16x32_bf16 v[40:43], a[72:75], v[24:27], v[40:43]
  ds_read_b128 v[16:19], v73 offset:44032
  v_mfma_f32_16x16x32_bf16 v[44:47], a[200:203], v[20:23], v[44:47]
  v_mfma_f32_16x16x32_bf16 v[48:51], a[200:203], v[24:27], v[48:51]
  s_waitcnt vmcnt(0)
  s_barrier
  ds_read_b32 v3, v71
  s_waitcnt lgkmcnt(4)
  v_mfma_f32_16x16x32_bf16 v[36:39], a[76:79], v[28:31], v[36:39]
  ds_read_b128 v[20:23], v73 offset:45056
  v_mfma_f32_16x16x32_bf16 v[40:43], a[76:79], v[32:35], v[40:43]
  ds_read_b128 v[24:27], v73 offset:46080
  v_mfma_f32_16x16x32_bf16 v[44:47], a[204:207], v[28:31], v[44:47]
  v_mfma_f32_16x16x32_bf16 v[48:51], a[204:207], v[32:35], v[48:51]
  s_waitcnt lgkmcnt(4)
  v_mfma_f32_16x16x32_bf16 v[36:39], a[80:83], v[4:7], v[36:39]
  ds_read_b128 v[28:31], v73 offset:47104
  v_mfma_f32_16x16x32_bf16 v[40:43], a[80:83], v[8:11], v[40:43]
  ds_read_b128 v[32:35], v73 offset:48128
  v_mfma_f32_16x16x32_bf16 v[44:47], a[208:211], v[4:7], v[44:47]
  v_mfma_f32_16x16x32_bf16 v[48:51], a[208:211], v[8:11], v[48:51]
  s_waitcnt lgkmcnt(4)
  v_cmp_gt_i32 vcc, s29, v3
  s_mov_b32 s28, 0
  s_cbranch_vccnz L_F1_nopf
  s_cmp_ge_u32 s25, 63
  s_cbranch_scc1 L_F1_nopf
  s_mov_b32 s28, 1
  s_waitcnt lgkmcnt(4)
  v_mfma_f32_16x16x32_bf16 v[36:39], a[84:87], v[12:15], v[36:39]
  ds_read_b128 v[4:7], v73 offset:49152
  v_mfma_f32_16x16x32_bf16 v[40:43], a[84:87], v[16:19], v[40:43]
  ds_read_b128 v[8:11], v73 offset:50176
  v_mfma_f32_16x16x32_bf16 v[44:47], a[212:215], v[12:15], v[44:47]
  s_add_u32 s36, s32, 0
  s_add_u32 m0, s34, s36
  s_add_u32 s36, s35, 0
  buffer_load_dwordx4 v1, s[4:7], s36 offen offset:0 sc1 lds
  v_mfma_f32_16x16x32_bf16 v[48:51], a[212:215], v[16:19], v[48:51]
  buffer_load_dwordx4 v1, s[4:7], s36 offen offset:1024 sc1 lds
  s_waitcnt lgkmcnt(4)
  v_mfma_f32_16x16x32_bf16 v[36:39], a[88:91], v[20:23], v[36:39]
  ds_read_b128 v[12:15], v73 offset:51200
  v_mfma_f32_16x16x32_bf16 v[40:43], a[88:91], v[24:27], v[40:43]
  ds_read_b128 v[16:19], v73 offset:52224
  v_mfma_f32_16x16x32_bf16 v[44:47], a[216:219], v[20:23], v[44:47]
  buffer_load_dwordx4 v1, s[4:7], s36 offen offset:2048 sc1 lds
  v_mfma_f32_16x16x32_bf16 v[48:51], a[216:219], v[24:27], v[48:51]
  buffer_load_dwordx4 v1, s[4:7], s36 offen offset:3072 sc1 lds
  s_waitcnt lgkmcnt(4)
  v_mfma_f32_16x16x32_bf16 v[36:39], a[92:95], v[28:31], v[36:39]
  ds_read_b128 v[20:23], v73 offset:53248
  v_mfma_f32_16x16x32_bf16 v[40:43], a[92:95], v[32:35], v[40:43]
  ds_read_b128 v[24:27], v73 offset:54272
  v_mfma_f32_16x16x32_bf16 v[44:47], a[220:223], v[28:31], v[44:47]
  s_add_u32 s36, s32, 16384
  s_add_u32 m0, s34, s36
  s_add_u32 s36, s35, 32768
  buffer_load_dwordx4 v1, s[4:7], s36 offen offset:0 sc1 lds
  v_mfma_f32_16x16x32_bf16 v[48:51], a[220:223], v[32:35], v[48:51]
  buffer_load_dwordx4 v1, s[4:7], s36 offen offset:1024 sc1 lds
  s_waitcnt lgkmcnt(4)
  v_mfma_f32_16x16x32_bf16 v[36:39], a[96:99], v[4:7], v[36:39]
  ds_read_b128 v[28:31], v73 offset:55296
  v_mfma_f32_16x16x32_bf16 v[40:43], a[96:99], v[8:11], v[40:43]
  ds_read_b128 v[32:35], v73 offset:56320
  v_mfma_f32_16x16x32_bf16 v[44:47], a[224:227], v[4:7], v[44:47]
  buffer_load_dwordx4 v1, s[4:7], s36 offen offset:2048 sc1 lds
  v_mfma_f32_16x16x32_bf16 v[48:51], a[224:227], v[8:11], v[48:51]
  buffer_load_dwordx4 v1, s[4:7], s36 offen offset:3072 sc1 lds
  s_waitcnt lgkmcnt(4)
  v_mfma_f32_16x16x32_bf16 v[36:39], a[100:103], v[12:15], v[36:39]
  ds_read_b128 v[4:7], v73 offset:57344
  v_mfma_f32_16x16x32_bf16 v[40:43], a[100:103], v[16:19], v[40:43]
  ds_read_b128 v[8:11], v73 offset:58368
  v_mfma_f32_16x16x32_bf16 v[44:47], a[228:231], v[12:15], v[44:47]
  s_add_u32 s36, s32, 32768
  s_add_u32 m0, s34, s36
  s_add_u32 s36, s35, 65536
  buffer_load_dwordx4 v1, s[4:7], s36 offen offset:0 sc1 lds
  v_mfma_f32_16x16x32_bf16 v[48:51], a[228:231], v[16:19], v[48:51]
  buffer_load_dwordx4 v1, s[4:7], s36 offen offset:1024 sc1 lds
  s_waitcnt lgkmcnt(4)
  v_mfma_f32_16x16x32_bf16 v[36:39], a[104:107], v[20:23], v[36:39]
  ds_read_b128 v[12:15], v73 offset:59392
  v_mfma_f32_16x16x32_bf16 v[40:43], a[104:107], v[24:27], v[40:43]
  ds_read_b128 v[16:19], v73 offset:60416
  v_mfma_f32_16x16x32_bf16 v[44:47], a[232:235], v[20:23], v[44:47]
  buffer_load_dwordx4 v1, s[4:7], s36 offen offset:2048 sc1 lds
  v_mfma_f32_16x16x32_bf16 v[48:51], a[232:235], v[24:27], v[48:51]
  buffer_load_dwordx4 v1, s[4:7], s36 offen offset:3072 sc1 lds
  s_waitcnt lgkmcnt(4)
  v_mfma_f32_16x16x32_bf16 v[36:39], a[108:111], v[28:31], v[36:39]
  ds_read_b128 v[20:23], v73 offset:61440
  v_mfma_f32_16x16x32_bf16 v[40:43], a[108:111], v[32:35], v[40:43]
  ds_read_b128 v[24:27], v73 offset:62464
  v_mfma_f32_16x16x32_bf16 v[44:47], a[236:239], v[28:31], v[44:47]
  v_mfma_f32_16x16x32_bf16 v[48:51], a[236:239], v[32:35], v[48:51]
  s_waitcnt lgkmcnt(4)
  v_mfma_f32_16x16x32_bf16 v[36:39], a[112:115], v[4:7], v[36:39]
  ds_read_b128 v[28:31], v73 offset:63488
  v_mfma_f32_16x16x32_bf16 v[40:43], a[112:115], v[8:11], v[40:43]
  ds_read_b128 v[32:35], v73 offset:64512
  v_mfma_f32_16x16x32_bf16 v[44:47], a[240:243], v[4:7], v[44:47]
  v_mfma_f32_16x16x32_bf16 v[48:51], a[240:243], v[8:11], v[48:51]
  s_waitcnt lgkmcnt(4)
  v_mfma_f32_16x16x32_bf16 v[36:39], a[116:119], v[12:15], v[36:39]
  v_mfma_f32_16x16x32_bf16 v[40:43], a[116:119], v[16:19], v[40:43]
  v_mfma_f32_16x16x32_bf16 v[44:47], a[244:247], v[12:15], v[44:47]
  v_mfma_f32_16x16x32_bf16 v[48:51], a[244:247], v[16:19], v[48:51]
  s_waitcnt lgkmcnt(2)
  v_mfma_f32_16x16x32_bf16 v[36:39], a[120:123], v[20:23], v[36:39]
  v_mfma_f32_16x16x32_bf16 v[40:43], a[120:123], v[24:27], v[40:43]
  v_mfma_f32_16x16x32_bf16 v[44:47], a[248:251], v[20:23], v[44:47]
  v_mfma_f32_16x16x32_bf16 v[48:51], a[248:251], v[24:27], v[48:51]
  s_waitcnt lgkmcnt(0)
  v_mfma_f32_16x16x32_bf16 v[36:39], a[124:127], v[28:31], v[36:39]
  v_mfma_f32_16x16x32_bf16 v[40:43], a[124:127], v[32:35], v[40:43]
  v_mfma_f32_16x16x32_bf16 v[44:47], a[252:255], v[28:31], v[44:47]
  v_mfma_f32_16x16x32_bf16 v[48:51], a[252:255], v[32:35], v[48:51]
  s_nop 7
  s_branch L_F1_epi
L_F1_nopf:
  s_waitcnt lgkmcnt(4)
  v_mfma_f32_16x16x32_bf16 v[36:39], a[84:87], v[12:15], v[36:39]
  ds_read_b128 v[4:7], v73 offset:49152
  v_mfma_f32_16x16x32_bf16 v[40:43], a[84:87], v[16:19], v[40:43]
  ds_read_b128 v[8:11], v73 offset:50176
  v_mfma_f32_16x16x32_bf16 v[44:47], a[212:215], v[12:15], v[44:47]
  v_mfma_f32_16x16x32_bf16 v[48:51], a[212:215], v[16:19], v[48:51]
  s_waitcnt lgkmcnt(4)
  v_mfma_f32_16x16x32_bf16 v[36:39], a[88:91], v[20:23], v[36:39]
  ds_read_b128 v[12:15], v73 offset:51200
  v_mfma_f32_16x16x32_bf16 v[40:43], a[88:91], v[24:27], v[40:43]
  ds_read_b128 v[16:19], v73 offset:52224
  v_mfma_f32_16x16x32_bf16 v[44:47], a[216:219], v[20:23], v[44:47]
  v_mfma_f32_16x16x32_bf16 v[48:51], a[216:219], v[24:27], v[48:51]
  s_waitcnt lgkmcnt(4)
  v_mfma_f32_16x16x32_bf16 v[36:39], a[92:95], v[28:31], v[36:39]
  ds_read_b128 v[20:23], v73 offset:53248
  v_mfma_f32_16x16x32_bf16 v[40:43], a[92:95], v[32:35], v[40:43]
  ds_read_b128 v[24:27], v73 offset:54272
  v_mfma_f32_16x16x32_bf16 v[44:47], a[220:223], v[28:31], v[44:47]
  v_mfma_f32_16x16x32_bf16 v[48:51], a[220:223], v[32:35], v[48:51]
  s_barrier
  s_lshl_b32 s40, s20, 8
  s_add_u32 m0, s40, 131072
  s_cmp_eq_u32 s20, 0
  s_cselect_b32 s40, s30, 2147483392
  buffer_load_dword v2, s[4:7], s40 offen sc1 lds
  s_waitcnt lgkmcnt(4)
  v_mfma_f32_16x16x32_bf16 v[36:39], a[96:99], v[4:7], v[36:39]
  ds_read_b128 v[28:31], v73 offset:55296
  v_mfma_f32_16x16x32_bf16 v[40:43], a[96:99], v[8:11], v[40:43]
  ds_read_b128 v[32:35], v73 offset:56320
  v_mfma_f32_16x16x32_bf16 v[44:47], a[224:227], v[4:7], v[44:47]
  v_mfma_f32_16x16x32_bf16 v[48:51], a[224:227], v[8:11], v[48:51]
  s_waitcnt lgkmcnt(4)
  v_mfma_f32_16x16x32_bf16 v[36:39], a[100:103], v[12:15], v[36:39]
  ds_read_b128 v[4:7], v73 offset:57344
  v_mfma_f32_16x16x32_bf16 v[40:43], a[100:103], v[16:19], v[40:43]
  ds_read_b128 v[8:11], v73 offset:58368
  v_mfma_f32_16x16x32_bf16 v[44:47], a[228:231], v[12:15], v[44:47]
  v_mfma_f32_16x16x32_bf16 v[48:51], a[228:231], v[16:19], v[48:51]
  s_waitcnt lgkmcnt(4)
  v_mfma_f32_16x16x32_bf16 v[36:39], a[104:107], v[20:23], v[36:39]
  ds_read_b128 v[12:15], v73 offset:59392
  v_mfma_f32_16x16x32_bf16 v[40:43], a[104:107], v[24:27], v[40:43]
  ds_read_b128 v[16:19], v73 offset:60416
  v_mfma_f32_16x16x32_bf16 v[44:47], a[232:235], v[20:23], v[44:47]
  v_mfma_f32_16x16x32_bf16 v[48:51], a[232:235], v[24:27], v[48:51]
  s_waitcnt lgkmcnt(4)
  v_mfma_f32_16x16x32_bf16 v[36:39], a[108:111], v[28:31], v[36:39]
  ds_read_b128 v[20:23], v73 offset:61440
  v_mfma_f32_16x16x32_bf16 v[40:43], a[108:111], v[32:35], v[40:43]
  ds_read_b128 v[24:27], v73 offset:62464
  v_mfma_f32_16x16x32_bf16 v[44:47], a[236:239], v[28:31], v[44:47]
  v_mfma_f32_16x16x32_bf16 v[48:51], a[236:239], v[32:35], v[48:51]
  s_waitcnt lgkmcnt(4)
  v_mfma_f32_16x16x32_bf16 v[36:39], a[112:115], v[4:7], v[36:39]
  ds_read_b128 v[28:31], v73 offset:63488
  v_mfma_f32_16x16x32_bf16 v[40:43], a[112:115], v[8:11], v[40:43]
  ds_read_b128 v[32:35], v73 offset:64512
  v_mfma_f32_16x16x32_bf16 v[44:47], a[240:243], v[4:7], v[44:47]
  v_mfma_f32_16x16x32_bf16 v[48:51], a[240:243], v[8:11], v[48:51]
  s_waitcnt lgkmcnt(4)
  v_mfma_f32_16x16x32_bf16 v[36:39], a[116:119], v[12:15], v[36:39]
  v_mfma_f32_16x16x32_bf16 v[40:43], a[116:119], v[16:19], v[40:43]
  v_mfma_f32_16x16x32_bf16 v[44:47], a[244:247], v[12:15], v[44:47]
  v_mfma_f32_16x16x32_bf16 v[48:51], a[244:247], v[16:19], v[48:51]
  s_waitcnt vmcnt(0)
  s_barrier
  ds_read_b32 v3, v71
  s_waitcnt lgkmcnt(2)
  v_mfma_f32_16x16x32_bf16 v[36:39], a[120:123], v[20:23], v[36:39]
  v_mfma_f32_16x16x32_bf16 v[40:43], a[120:123], v[24:27], v[40:43]
  v_mfma_f32_16x16x32_bf16 v[44:47], a[248:251], v[20:23], v[44:47]
  v_mfma_f32_16x16x32_bf16 v[48:51], a[248:251], v[24:27], v[48:51]
  s_waitcnt lgkmcnt(0)
  v_mfma_f32_16x16x32_bf16 v[36:39], a[124:127], v[28:31], v[36:39]
  v_mfma_f32_16x16x32_bf16 v[40:43], a[124:127], v[32:35], v[40:43]
  v_mfma_f32_16x16x32_bf16 v[44:47], a[252:255], v[28:31], v[44:47]
  v_mfma_f32_16x16x32_bf16 v[48:51], a[252:255], v[32:35], v[48:51]
  v_cmp_gt_i32 vcc, s29, v3
  s_cmp_eq_u64 vcc, 0
  s_cselect_b32 s28, 2, 0
  s_cmp_lt_u32 s25, 63
  s_cselect_b32 s28, s28, 0
L_F1_epi:
  v_mul_f32 v52, s37, v36
  v_mul_f32 v53, s37, v37
  v_mul_f32 v54, s37, v38
  v_mul_f32 v55, s37, v39
  v_mul_f32 v56, s37, v40
  v_mul_f32 v57, s37, v41
  v_mul_f32 v58, s37, v42
  v_mul_f32 v59, s37, v43
  v_exp_f32 v52, v52
  v_exp_f32 v53, v53
  v_exp_f32 v54, v54
  v_exp_f32 v55, v55
  v_exp_f32 v56, v56
  v_exp_f32 v57, v57
  v_exp_f32 v58, v58
  v_exp_f32 v59, v59
  v_pk_mul_f32 v[36:37], v[36:37], v[44:45]
  v_pk_mul_f32 v[38:39], v[38:39], v[46:47]
  v_pk_mul_f32 v[40:41], v[40:41], v[48:49]
  v_pk_mul_f32 v[42:43], v[42:43], v[50:51]
  v_add_f32 v52, 1.0, v52
  v_add_f32 v53, 1.0, v53
  v_add_f32 v54, 1.0, v54
  v_add_f32 v55, 1.0, v55
  v_add_f32 v56, 1.0, v56
  v_add_f32 v57, 1.0, v57
  v_add_f32 v58, 1.0, v58
  v_add_f32 v59, 1.0, v59
  v_rcp_f32 v52, v52
  v_rcp_f32 v53, v53
  v_rcp_f32 v54, v54
  v_rcp_f32 v55, v55
  v_rcp_f32 v56, v56
  v_rcp_f32 v57, v57
  v_rcp_f32 v58, v58
  v_rcp_f32 v59, v59
  v_pk_mul_f32 v[36:37], v[36:37], v[52:53]
  v_pk_mul_f32 v[38:39], v[38:39], v[54:55]
  v_pk_mul_f32 v[40:41], v[40:41], v[56:57]
  v_pk_mul_f32 v[42:43], v[42:43], v[58:59]
  v_cvt_pk_bf16_f32 v60, v36, v37
  v_cvt_pk_bf16_f32 v61, v38, v39
  v_cvt_pk_bf16_f32 v62, v40, v41
  v_cvt_pk_bf16_f32 v63, v42, v43
  s_nop 0
  v_permlane32_swap_b32 v60, v62
  v_permlane32_swap_b32 v61, v63
  buffer_store_dwordx4 v[60:63], v68, s[4:7], s31 offen sc1
  s_add_u32 s25, s25, 1
  s_add_u32 s31, s31, 2097152
  s_xor_b32 s31, s31, 0x2000
  s_branch L_F1_top
L_F2:
  v_lshlrev_b32 v1, 4, v0
  s_lshl_b32 s32, s20, 12
  s_min_u32 s33, s32, 0x2000
  v_mov_b32 v69, v1
  v_add_u32 v70, 0x10000, v69
  s_load_dwordx2 s[8:9], s[0:1], 80
  s_mov_b32 s10, 7340032
  s_mov_b32 s11, 0x20000
  s_waitcnt lgkmcnt(0)
  s_lshr_b32 s44, s21, 3
  s_mul_i32 s44, s44, 2490368
  s_and_b32 s45, s21, 7
  s_lshl_b32 s45, s45, 8
  s_add_u32 s44, s44, s45
  s_add_u32 s45, s44, 128
  s_cmp_ge_u32 s21, 16
  s_cselect_b32 s40, 131072, 0
  s_sub_u32 s44, s44, s40
  s_sub_u32 s45, s45, s40
  v_bfe_u32 v4, v0, 5, 1
  v_mul_u32_u24 v4, 8192, v4
  v_bfe_u32 v5, v0, 4, 1
  v_mul_u32_u24 v5, 4096, v5
  v_add_u32 v4, v4, v5
  v_bfe_u32 v5, v0, 3, 1
  v_mul_u32_u24 v5, 2048, v5
  v_add_u32 v4, v4, v5
  v_lshrrev_b32 v5, 3, v0
  v_and_b32 v5, 6, v5
  v_xor_b32 v5, v5, v0
  v_and_b32 v5, 7, v5
  v_lshl_add_u32 v4, v5, 4, v4
  s_lshr_b32 s40, s20, 1
  s_mul_i32 s40, s40, 16384
  s_and_b32 s41, s20, 1
  s_mul_i32 s41, s41, 32768
  s_add_u32 s40, s40, s41
  v_add_u32 v4, s40, v4
  v_bfe_u32 v5, v0, 3, 2
  v_xor_b32 v5, s20, v5
  v_lshlrev_b32 v5, 5, v5
  v_lshrrev_b32 v6, 2, v0
  v_lshl_add_u32 v6, v6, 7, v5
  v_and_b32 v5, 3, v0
  v_lshl_add_u32 v6, v5, 3, v6
  v_add_u32 v7, 0x10000, v6
  v_add_u32 v8, s44, v4
  v_add_u32 v9, s45, v4
  s_lshl_b32 s41, s20, 10
  s_add_u32 m0, s41, 0
  s_mov_b32 s42, 0
  buffer_load_dwordx4 v8, s[8:11], s42 offen nt lds
  s_add_u32 m0, s41, 4096
  s_mov_b32 s42, 0
  buffer_load_dwordx4 v9, s[8:11], s42 offen nt lds
  s_add_u32 m0, s41, 8192
  s_mov_b32 s42, 65536
  buffer_load_dwordx4 v8, s[8:11], s42 offen nt lds
  s_add_u32 m0, s41, 12288
  s_mov_b32 s42, 65536
  buffer_load_dwordx4 v9, s[8:11], s42 offen nt lds
  s_add_u32 m0, s41, 16384
  s_mov_b32 s42, 131072
  buffer_load_dwordx4 v8, s[8:11], s42 offen nt lds
  s_add_u32 m0, s41, 20480
  s_mov_b32 s42, 131072
  buffer_load_dwordx4 v9, s[8:11], s42 offen nt lds
  s_add_u32 m0, s41, 24576
  s_mov_b32 s42, 196608
  buffer_load_dwordx4 v8, s[8:11], s42 offen nt lds
  s_add_u32 m0, s41, 28672
  s_mov_b32 s42, 196608
  buffer_load_dwordx4 v9, s[8:11], s42 offen nt lds
  s_add_u32 m0, s41, 32768
  s_mov_b32 s42, 262144
  buffer_load_dwordx4 v8, s[8:11], s42 offen nt lds
  s_add_u32 m0, s41, 36864
  s_mov_b32 s42, 262144
  buffer_load_dwordx4 v9, s[8:11], s42 offen nt lds
  s_add_u32 m0, s41, 40960
  s_mov_b32 s42, 327680
  buffer_load_dwordx4 v8, s[8:11], s42 offen nt lds
  s_add_u32 m0, s41, 45056
  s_mov_b32 s42, 327680
  buffer_load_dwordx4 v9, s[8:11], s42 offen nt lds
  s_add_u32 m0, s41, 49152
  s_mov_b32 s42, 393216
  buffer_load_dwordx4 v8, s[8:11], s42 offen nt lds
  s_add_u32 m0, s41, 53248
  s_mov_b32 s42, 393216
  buffer_load_dwordx4 v9, s[8:11], s42 offen nt lds
  s_add_u32 m0, s41, 57344
  s_mov_b32 s42, 458752
  buffer_load_dwordx4 v8, s[8:11], s42 offen nt lds
  s_add_u32 m0, s41, 61440
  s_mov_b32 s42, 458752
  buffer_load_dwordx4 v9, s[8:11], s42 offen nt lds
  s_add_u32 m0, s41, 65536
  s_mov_b32 s42, 524288
  buffer_load_dwordx4 v8, s[8:11], s42 offen nt lds
  s_add_u32 m0, s41, 69632
  s_mov_b32 s42, 524288
  buffer_load_dwordx4 v9, s[8:11], s42 offen nt lds
  s_add_u32 m0, s41, 73728
  s_mov_b32 s42, 589824
  buffer_load_dwordx4 v8, s[8:11], s42 offen nt lds
  s_add_u32 m0, s41, 77824
  s_mov_b32 s42, 589824
  buffer_load_dwordx4 v9, s[8:11], s42 offen nt lds
  s_add_u32 m0, s41, 81920
  s_mov_b32 s42, 655360
  buffer_load_dwordx4 v8, s[8:11], s42 offen nt lds
  s_add_u32 m0, s41, 86016
  s_mov_b32 s42, 655360
  buffer_load_dwordx4 v9, s[8:11], s42 offen nt lds
  s_add_u32 m0, s41, 90112
  s_mov_b32 s42, 720896
  buffer_load_dwordx4 v8, s[8:11], s42 offen nt lds
  s_add_u32 m0, s41, 94208
  s_mov_b32 s42, 720896
  buffer_load_dwordx4 v9, s[8:11], s42 offen nt lds
  s_add_u32 m0, s41, 98304
  s_mov_b32 s42, 786432
  buffer_load_dwordx4 v8, s[8:11], s42 offen nt lds
  s_add_u32 m0, s41, 102400
  s_mov_b32 s42, 786432
  buffer_load_dwordx4 v9, s[8:11], s42 offen nt lds
  s_add_u32 m0, s41, 106496
  s_mov_b32 s42, 851968
  buffer_load_dwordx4 v8, s[8:11], s42 offen nt lds
  s_add_u32 m0, s41, 110592
  s_mov_b32 s42, 851968
  buffer_load_dwordx4 v9, s[8:11], s42 offen nt lds
  s_waitcnt vmcnt(24) lgkmcnt(0)
  s_barrier
  s_add_u32 m0, s41, 114688
  s_mov_b32 s42, 917504
  buffer_load_dwordx4 v8, s[8:11], s42 offen nt lds
  s_add_u32 m0, s41, 118784
  s_mov_b32 s42, 917504
  buffer_load_dwordx4 v9, s[8:11], s42 offen nt lds
  s_add_u32 m0, s41, 122880
  s_mov_b32 s42, 983040
  buffer_load_dwordx4 v8, s[8:11], s42 offen nt lds
  s_add_u32 m0, s41, 126976
  s_mov_b32 s42, 983040
  buffer_load_dwordx4 v9, s[8:11], s42 offen nt lds
  ds_read_b64_tr_b16 a[0:1], v6 offset:0
  ds_read_b64_tr_b16 a[2:3], v6 offset:2048
  ds_read_b64_tr_b16 a[152:153], v6 offset:4096
  ds_read_b64_tr_b16 a[154:155], v6 offset:6144
  ds_read_b64_tr_b16 a[4:5], v6 offset:8192
  ds_read_b64_tr_b16 a[6:7], v6 offset:10240
  ds_read_b64_tr_b16 a[156:157], v6 offset:12288
  ds_read_b64_tr_b16 a[158:159], v6 offset:14336
  s_waitcnt vmcnt(24) lgkmcnt(0)
  s_barrier
  s_add_u32 m0, s41, 0
  s_mov_b32 s42, 1048576
  buffer_load_dwordx4 v8, s[8:11], s42 offen nt lds
  s_add_u32 m0, s41, 4096
  s_mov_b32 s42, 1048576
  buffer_load_dwordx4 v9, s[8:11], s42 offen nt lds
  s_add_u32 m0, s41, 8192
  s_mov_b32 s42, 1114112
  buffer_load_dwordx4 v8, s[8:11], s42 offen nt lds
  s_add_u32 m0, s41, 12288
  s_mov_b32 s42, 1114112
  buffer_load_dwordx4 v9, s[8:11], s42 offen nt lds
  ds_read_b64_tr_b16 a[8:9], v6 offset:16384
  ds_read_b64_tr_b16 a[10:11], v6 offset:18432
  ds_read_b64_tr_b16 a[160:161], v6 offset:20480
  ds_read_b64_tr_b16 a[162:163], v6 offset:22528
  ds_read_b64_tr_b16 a[12:13], v6 offset:24576
  ds_read_b64_tr_b16 a[14:15], v6 offset:26624
  ds_read_b64_tr_b16 a[164:165], v6 offset:28672
  ds_read_b64_tr_b16 a[166:167], v6 offset:30720
  s_waitcnt vmcnt(24) lgkmcnt(0)
  s_barrier
  s_add_u32 m0, s41, 16384
  s_mov_b32 s42, 1179648
  buffer_load_dwordx4 v8, s[8:11], s42 offen nt lds
  s_add_u32 m0, s41, 20480
  s_mov_b32 s42, 1179648
  buffer_load_dwordx4 v9, s[8:11], s42 offen nt lds
  s_add_u32 m0, s41, 24576
  s_mov_b32 s42, 1245184
  buffer_load_dwordx4 v8, s[8:11], s42 offen nt lds
  s_add_u32 m0, s41, 28672
  s_mov_b32 s42, 1245184
  buffer_load_dwordx4 v9, s[8:11], s42 offen nt lds
  ds_read_b64_tr_b16 a[16:17], v6 offset:32768
  ds_read_b64_tr_b16 a[18:19], v6 offset:34816
  ds_read_b64_tr_b16 a[168:169], v6 offset:36864
  ds_read_b64_tr_b16 a[170:171], v6 offset:38912
  ds_read_b64_tr_b16 a[20:21], v6 offset:40960
  ds_read_b64_tr_b16 a[22:23], v6 offset:43008
  ds_read_b64_tr_b16 a[172:173], v6 offset:45056
  ds_read_b64_tr_b16 a[174:175], v6 offset:47104
  s_waitcnt vmcnt(24) lgkmcnt(0)
  s_barrier
  s_add_u32 m0, s41, 32768
  s_mov_b32 s42, 1310720
  buffer_load_dwordx4 v8, s[8:11], s42 offen nt lds
  s_add_u32 m0, s41, 36864
  s_mov_b32 s42, 1310720
  buffer_load_dwordx4 v9, s[8:11], s42 offen nt lds
  s_add_u32 m0, s41, 40960
  s_mov_b32 s42, 1376256
  buffer_load_dwordx4 v8, s[8:11], s42 offen nt lds
  s_add_u32 m0, s41, 45056
  s_mov_b32 s42, 1376256
  buffer_load_dwordx4 v9, s[8:11], s42 offen nt lds
  ds_read_b64_tr_b16 a[24:25], v6 offset:49152
  ds_read_b64_tr_b16 a[26:27], v6 offset:51200
  ds_read_b64_tr_b16 a[176:177], v6 offset:53248
  ds_read_b64_tr_b16 a[178:179], v6 offset:55296
  ds_read_b64_tr_b16 a[28:29], v6 offset:57344
  ds_read_b64_tr_b16 a[30:31], v6 offset:59392
  ds_read_b64_tr_b16 a[180:181], v6 offset:61440
  ds_read_b64_tr_b16 a[182:183], v6 offset:63488
  s_waitcnt vmcnt(24) lgkmcnt(0)
  s_barrier
  s_add_u32 m0, s41, 49152
  s_mov_b32 s42, 1441792
  buffer_load_dwordx4 v8, s[8:11], s42 offen nt lds
  s_add_u32 m0, s41, 53248
  s_mov_b32 s42, 1441792
  buffer_load_dwordx4 v9, s[8:11], s42 offen nt lds
  s_add_u32 m0, s41, 57344
  s_mov_b32 s42, 1507328
  buffer_load_dwordx4 v8, s[8:11], s42 offen nt lds
  s_add_u32 m0, s41, 61440
  s_mov_b32 s42, 1507328
  buffer_load_dwordx4 v9, s[8:11], s42 offen nt lds
  ds_read_b64_tr_b16 a[32:33], v7 offset:0
  ds_read_b64_tr_b16 a[34:35], v7 offset:2048
  ds_read_b64_tr_b16 a[184:185], v7 offset:4096
  ds_read_b64_tr_b16 a[186:187], v7 offset:6144
  ds_read_b64_tr_b16 a[36:37], v7 offset:8192
  ds_read_b64_tr_b16 a[38:39], v7 offset:10240
  ds_read_b64_tr_b16 a[188:189], v7 offset:12288
  ds_read_b64_tr_b16 a[190:191], v7 offset:14336
  s_waitcnt vmcnt(24) lgkmcnt(0)
  s_barrier
  s_add_u32 m0, s41, 65536
  s_mov_b32 s42, 1572864
  buffer_load_dwordx4 v8, s[8:11], s42 offen nt lds
  s_add_u32 m0, s41, 69632
  s_mov_b32 s42, 1572864
  buffer_load_dwordx4 v9, s[8:11], s42 offen nt lds
  s_add_u32 m0, s41, 73728
  s_mov_b32 s42, 1638400
  buffer_load_dwordx4 v8, s[8:11], s42 offen nt lds
  s_add_u32 m0, s41, 77824
  s_mov_b32 s42, 1638400
  buffer_load_dwordx4 v9, s[8:11], s42 offen nt lds
  ds_read_b64_tr_b16 a[40:41], v7 offset:16384
  ds_read_b64_tr_b16 a[42:43], v7 offset:18432
  ds_read_b64_tr_b16 a[192:193], v7 offset:20480
  ds_read_b64_tr_b16 a[194:195], v7 offset:22528
  ds_read_b64_tr_b16 a[44:45], v7 offset:24576
  ds_read_b64_tr_b16 a[46:47], v7 offset:26624
  ds_read_b64_tr_b16 a[196:197], v7 offset:28672
  ds_read_b64_tr_b16 a[198:199], v7 offset:30720
  s_waitcnt vmcnt(24) lgkmcnt(0)
  s_barrier
  s_add_u32 m0, s41, 81920
  s_mov_b32 s42, 1703936
  buffer_load_dwordx4 v8, s[8:11], s42 offen nt lds
  s_add_u32 m0, s41, 86016
  s_mov_b32 s42, 1703936
  buffer_load_dwordx4 v9, s[8:11], s42 offen nt lds
  s_add_u32 m0, s41, 90112
  s_mov_b32 s42, 1769472
  buffer_load_dwordx4 v8, s[8:11], s42 offen nt lds
  s_add_u32 m0, s41, 94208
  s_mov_b32 s42, 1769472
  buffer_load_dwordx4 v9, s[8:11], s42 offen nt lds
  ds_read_b64_tr_b16 a[48:49], v7 offset:32768
  ds_read_b64_tr_b16 a[50:51], v7 offset:34816
  ds_read_b64_tr_b16 a[200:201], v7 offset:36864
  ds_read_b64_tr_b16 a[202:203], v7 offset:38912
  ds_read_b64_tr_b16 a[52:53], v7 offset:40960
  ds_read_b64_tr_b16 a[54:55], v7 offset:43008
  ds_read_b64_tr_b16 a[204:205], v7 offset:45056
  ds_read_b64_tr_b16 a[206:207], v7 offset:47104
  s_waitcnt vmcnt(24) lgkmcnt(0)
  s_barrier
  s_add_u32 m0, s41, 98304
  s_mov_b32 s42, 1835008
  buffer_load_dwordx4 v8, s[8:11], s42 offen nt lds
  s_add_u32 m0, s41, 102400
  s_mov_b32 s42, 1835008
  buffer_load_dwordx4 v9, s[8:11], s42 offen nt lds
  s_add_u32 m0, s41, 106496
  s_mov_b32 s42, 1900544
  buffer_load_dwordx4 v8, s[8:11], s42 offen nt lds
  s_add_u32 m0, s41, 110592
  s_mov_b32 s42, 1900544
  buffer_load_dwordx4 v9, s[8:11], s42 offen nt lds
  ds_read_b64_tr_b16 a[56:57], v7 offset:49152
  ds_read_b64_tr_b16 a[58:59], v7 offset:51200
  ds_read_b64_tr_b16 a[208:209], v7 offset:53248
  ds_read_b64_tr_b16 a[210:211], v7 offset:55296
  ds_read_b64_tr_b16 a[60:61], v7 offset:57344
  ds_read_b64_tr_b16 a[62:63], v7 offset:59392
  ds_read_b64_tr_b16 a[212:213], v7 offset:61440
  ds_read_b64_tr_b16 a[214:215], v7 offset:63488
  s_waitcnt vmcnt(24) lgkmcnt(0)
  s_barrier
  s_add_u32 m0, s41, 114688
  s_mov_b32 s42, 1966080
  buffer_load_dwordx4 v8, s[8:11], s42 offen nt lds
  s_add_u32 m0, s41, 118784
  s_mov_b32 s42, 1966080
  buffer_load_dwordx4 v9, s[8:11], s42 offen nt lds
  s_add_u32 m0, s41, 122880
  s_mov_b32 s42, 2031616
  buffer_load_dwordx4 v8, s[8:11], s42 offen nt lds
  s_add_u32 m0, s41, 126976
  s_mov_b32 s42, 2031616
  buffer_load_dwordx4 v9, s[8:11], s42 offen nt lds
  ds_read_b64_tr_b16 a[64:65], v6 offset:0
  ds_read_b64_tr_b16 a[66:67], v6 offset:2048
  ds_read_b64_tr_b16 a[216:217], v6 offset:4096
  ds_read_b64_tr_b16 a[218:219], v6 offset:6144
  ds_read_b64_tr_b16 a[68:69], v6 offset:8192
  ds_read_b64_tr_b16 a[70:71], v6 offset:10240
  ds_read_b64_tr_b16 a[220:221], v6 offset:12288
  ds_read_b64_tr_b16 a[222:223], v6 offset:14336
  s_waitcnt vmcnt(24) lgkmcnt(0)
  s_barrier
  s_add_u32 m0, s41, 0
  s_mov_b32 s42, 2097152
  buffer_load_dwordx4 v8, s[8:11], s42 offen nt lds
  s_add_u32 m0, s41, 4096
  s_mov_b32 s42, 2097152
  buffer_load_dwordx4 v9, s[8:11], s42 offen nt lds
  s_add_u32 m0, s41, 8192
  s_mov_b32 s42, 2162688
  buffer_load_dwordx4 v8, s[8:11], s42 offen nt lds
  s_add_u32 m0, s41, 12288
  s_mov_b32 s42, 2162688
  buffer_load_dwordx4 v9, s[8:11], s42 offen nt lds
  ds_read_b64_tr_b16 a[72:73], v6 offset:16384
  ds_read_b64_tr_b16 a[74:75], v6 offset:18432
  ds_read_b64_tr_b16 a[224:225], v6 offset:20480
  ds_read_b64_tr_b16 a[226:227], v6 offset:22528
  ds_read_b64_tr_b16 a[76:77], v6 offset:24576
  ds_read_b64_tr_b16 a[78:79], v6 offset:26624
  ds_read_b64_tr_b16 a[228:229], v6 offset:28672
  ds_read_b64_tr_b16 a[230:231], v6 offset:30720
  s_waitcnt vmcnt(24) lgkmcnt(0)
  s_barrier
  s_add_u32 m0, s41, 16384
  s_mov_b32 s42, 2228224
  buffer_load_dwordx4 v8, s[8:11], s42 offen nt lds
  s_add_u32 m0, s41, 20480
  s_mov_b32 s42, 2228224
  buffer_load_dwordx4 v9, s[8:11], s42 offen nt lds
  s_add_u32 m0, s41, 24576
  s_mov_b32 s42, 2293760
  buffer_load_dwordx4 v8, s[8:11], s42 offen nt lds
  s_add_u32 m0, s41, 28672
  s_mov_b32 s42, 2293760
  buffer_load_dwordx4 v9, s[8:11], s42 offen nt lds
  ds_read_b64_tr_b16 a[80:81], v6 offset:32768
  ds_read_b64_tr_b16 a[82:83], v6 offset:34816
  ds_read_b64_tr_b16 a[232:233], v6 offset:36864
  ds_read_b64_tr_b16 a[234:235], v6 offset:38912
  ds_read_b64_tr_b16 a[84:85], v6 offset:40960
  ds_read_b64_tr_b16 a[86:87], v6 offset:43008
  ds_read_b64_tr_b16 a[236:237], v6 offset:45056
  ds_read_b64_tr_b16 a[238:239], v6 offset:47104
  s_waitcnt vmcnt(24) lgkmcnt(0)
  s_barrier
  s_add_u32 m0, s41, 32768
  s_mov_b32 s42, 2359296
  buffer_load_dwordx4 v8, s[8:11], s42 offen nt lds
  s_add_u32 m0, s41, 36864
  s_mov_b32 s42, 2359296
  buffer_load_dwordx4 v9, s[8:11], s42 offen nt lds
  s_add_u32 m0, s41, 40960
  s_mov_b32 s42, 2424832
  buffer_load_dwordx4 v8, s[8:11], s42 offen nt lds
  s_add_u32 m0, s41, 45056
  s_mov_b32 s42, 2424832
  buffer_load_dwordx4 v9, s[8:11], s42 offen nt lds
  ds_read_b64_tr_b16 a[88:89], v6 offset:49152
  ds_read_b64_tr_b16 a[90:91], v6 offset:51200
  ds_read_b64_tr_b16 a[240:241], v6 offset:53248
  ds_read_b64_tr_b16 a[242:243], v6 offset:55296
  ds_read_b64_tr_b16 a[92:93], v6 offset:57344
  ds_read_b64_tr_b16 a[94:95], v6 offset:59392
  ds_read_b64_tr_b16 a[244:245], v6 offset:61440
  ds_read_b64_tr_b16 a[246:247], v6 offset:63488
  s_waitcnt vmcnt(24) lgkmcnt(0)
  s_barrier
  ds_read_b64_tr_b16 a[96:97], v7 offset:0
  ds_read_b64_tr_b16 a[98:99], v7 offset:2048
  ds_read_b64_tr_b16 a[248:249], v7 offset:4096
  ds_read_b64_tr_b16 a[250:251], v7 offset:6144
  ds_read_b64_tr_b16 a[100:101], v7 offset:8192
  ds_read_b64_tr_b16 a[102:103], v7 offset:10240
  ds_read_b64_tr_b16 a[252:253], v7 offset:12288
  ds_read_b64_tr_b16 a[254:255], v7 offset:14336
  s_waitcnt vmcnt(20) lgkmcnt(0)
  s_barrier
  ds_read_b64_tr_b16 a[104:105], v7 offset:16384
  ds_read_b64_tr_b16 a[106:107], v7 offset:18432
  ds_read_b64_tr_b16 v[128:129], v7 offset:20480
  ds_read_b64_tr_b16 v[130:131], v7 offset:22528
  ds_read_b64_tr_b16 a[108:109], v7 offset:24576
  ds_read_b64_tr_b16 a[110:111], v7 offset:26624
  ds_read_b64_tr_b16 v[132:133], v7 offset:28672
  ds_read_b64_tr_b16 v[134:135], v7 offset:30720
  s_waitcnt vmcnt(16) lgkmcnt(0)
  s_barrier
  ds_read_b64_tr_b16 a[112:113], v7 offset:32768
  ds_read_b64_tr_b16 a[114:115], v7 offset:34816
  ds_read_b64_tr_b16 v[136:137], v7 offset:36864
  ds_read_b64_tr_b16 v[138:139], v7 offset:38912
  ds_read_b64_tr_b16 a[116:117], v7 offset:40960
  ds_read_b64_tr_b16 a[118:119], v7 offset:43008
  ds_read_b64_tr_b16 v[140:141], v7 offset:45056
  ds_read_b64_tr_b16 v[142:143], v7 offset:47104
  s_waitcnt vmcnt(12) lgkmcnt(0)
  s_barrier
  ds_read_b64_tr_b16 a[120:121], v7 offset:49152
  ds_read_b64_tr_b16 a[122:123], v7 offset:51200
  ds_read_b64_tr_b16 v[144:145], v7 offset:53248
  ds_read_b64_tr_b16 v[146:147], v7 offset:55296
  ds_read_b64_tr_b16 a[124:125], v7 offset:57344
  ds_read_b64_tr_b16 a[126:127], v7 offset:59392
  ds_read_b64_tr_b16 v[148:149], v7 offset:61440
  ds_read_b64_tr_b16 v[150:151], v7 offset:63488
  s_waitcnt vmcnt(8) lgkmcnt(0)
  s_barrier
  ds_read_b64_tr_b16 a[128:129], v6 offset:0
  ds_read_b64_tr_b16 a[130:131], v6 offset:2048
  ds_read_b64_tr_b16 v[152:153], v6 offset:4096
  ds_read_b64_tr_b16 v[154:155], v6 offset:6144
  ds_read_b64_tr_b16 a[132:133], v6 offset:8192
  ds_read_b64_tr_b16 a[134:135], v6 offset:10240
  ds_read_b64_tr_b16 v[156:157], v6 offset:12288
  ds_read_b64_tr_b16 v[158:159], v6 offset:14336
  s_waitcnt vmcnt(4) lgkmcnt(0)
  s_barrier
  ds_read_b64_tr_b16 a[136:137], v6 offset:16384
  ds_read_b64_tr_b16 a[138:139], v6 offset:18432
  ds_read_b64_tr_b16 v[160:161], v6 offset:20480
  ds_read_b64_tr_b16 v[162:163], v6 offset:22528
  ds_read_b64_tr_b16 a[140:141], v6 offset:24576
  ds_read_b64_tr_b16 a[142:143], v6 offset:26624
  ds_read_b64_tr_b16 v[164:165], v6 offset:28672
  ds_read_b64_tr_b16 v[166:167], v6 offset:30720
  s_waitcnt vmcnt(0) lgkmcnt(0)
  s_barrier
  ds_read_b64_tr_b16 a[144:145], v6 offset:32768
  ds_read_b64_tr_b16 a[146:147], v6 offset:34816
  ds_read_b64_tr_b16 v[168:169], v6 offset:36864
  ds_read_b64_tr_b16 v[170:171], v6 offset:38912
  ds_read_b64_tr_b16 a[148:149], v6 offset:40960
  ds_read_b64_tr_b16 a[150:151], v6 offset:43008
  ds_read_b64_tr_b16 v[172:173], v6 offset:45056
  ds_read_b64_tr_b16 v[174:175], v6 offset:47104
  s_waitcnt lgkmcnt(0)
  s_barrier
  s_cmp_lt_u32 s21, 16
  s_cbranch_scc1 L_F2_keep
  v_accvgpr_write_b32 a0, 0
  v_accvgpr_write_b32 a1, 0
  v_accvgpr_write_b32 a2, 0
  v_accvgpr_write_b32 a3, 0
  v_accvgpr_write_b32 a4, 0
  v_accvgpr_write_b32 a5, 0
  v_accvgpr_write_b32 a6, 0
  v_accvgpr_write_b32 a7, 0
  v_accvgpr_write_b32 a152, 0
  v_accvgpr_write_b32 a153, 0
  v_accvgpr_write_b32 a154, 0
  v_accvgpr_write_b32 a155, 0
  v_accvgpr_write_b32 a156, 0
  v_accvgpr_write_b32 a157, 0
  v_accvgpr_write_b32 a158, 0
  v_accvgpr_write_b32 a159, 0
  s_nop 1
L_F2_keep:
  v_min_u32 v52, 63, v0
  v_lshlrev_b32 v52, 7, v52
  v_add_u32 v52, 1424384, v52
  s_nop 1
Lpoll_48:
  buffer_load_dword v53, v52, s[4:7], 0 offen sc1
  s_sub_u32 s24, s24, 1
  s_cbranch_scc1 L_FAIL
  s_waitcnt vmcnt(0)
  v_cmp_gt_i32 vcc, 0, v53
  s_cbranch_vccz Lpolld_49
  s_sleep 1
  s_branch Lpoll_48
Lpolld_49:
  v_lshrrev_b32 v53, 8, v53
  v_and_b32 v54, 3, v0
  v_lshl_or_b32 v53, v53, 2, v54
  s_nop 1
  v_min_u32_dpp v53, v53, v53 row_ror:8 row_mask:0xf bank_mask:0xf
  s_nop 1
  v_min_u32_dpp v53, v53, v53 row_ror:4 row_mask:0xf bank_mask:0xf
  v_mov_b32 v54, v53
  s_nop 1
  v_permlane16_swap_b32 v54, v53
  v_min_u32 v53, v53, v54
  v_mov_b32 v54, v53
  s_nop 1
  v_permlane32_swap_b32 v54, v53
  v_min_u32 v53, v53, v54
  s_nop 1
  v_min_u32_dpp v53, v53, v53 row_ror:2 row_mask:0xf bank_mask:0xf
  s_nop 1
  v_min_u32_dpp v53, v53, v53 row_ror:1 row_mask:0xf bank_mask:0xf
  s_nop 0
  v_readfirstlane_b32 s38, v53
  s_and_b32 s38, s38, 3
  s_lshl_b32 s38, s38, 13
  s_and_b32 s38, s38, 0x2000
  s_xor_b32 s38, s38, 16785408
  s_lshr_b32 s43, s21, 3
  s_mul_i32 s43, s43, 19
  s_min_u32 s43, s43, 37
  v_min_u32 v2, 18, v0
  v_add_u32 v2, s43, v2
  v_lshlrev_b32 v2, 7, v2
  v_add_u32 v2, 1414144, v2
  s_add_u32 s44, s43, s20
  s_min_u32 s45, s20, 2
  s_add_u32 s45, s45, s43
  s_lshr_b32 s40, s44, 1
  s_lshl_b32 s40, s40, 14
  s_and_b32 s41, s44, 1
  s_lshl_b32 s41, s41, 12
  s_add_u32 s27, s40, s41
  s_lshr_b32 s40, s45, 1
  s_lshl_b32 s40, s40, 14
  s_and_b32 s41, s45, 1
  s_lshl_b32 s41, s41, 12
  s_add_u32 s39, s40, s41
  s_sub_u32 s39, s39, s27
  s_add_u32 s27, s27, s38
  s_add_u32 s27, s27, 1179648
  s_lshl_b32 s62, s21, 7
  s_add_u32 s62, s62, 1421312
  s_lshl_b32 s40, s21, 14
  s_add_u32 s40, s40, s38
  s_add_u32 s31, s40, 524288
  s_lshl_b32 s40, s20, 11
  v_and_b32 v68, 3, v0
  v_lshlrev_b32 v68, 4, v68
  v_lshrrev_b32 v52, 4, v0
  v_lshl_add_u32 v68, v52, 6, v68
  v_bfe_u32 v52, v0, 2, 2
  v_lshl_add_u32 v68, v52, 8, v68
  v_add_u32 v68, s40, v68
  v_lshlrev_b32 v71, 2, v0
  v_add_u32 v71, 155648, v71
  s_mov_b32 s25, 0
  s_mov_b32 s26, 0
  s_mov_b32 s29, 1
  s_mov_b32 s30, 0
  s_mov_b32 s28, 0
L_F2_top:
  s_cmp_eq_u32 s28, 1
  s_cbranch_scc1 L_F2_go
  s_cmp_eq_u32 s28, 2
  s_cbranch_scc1 L_F2_mid
  s_cmp_lg_u32 s20, 0
  s_cbranch_scc1 L_F2_park
  buffer_load_dword v3, v2, s[4:7], s30 offen sc1
  s_waitcnt vmcnt(1)
  s_barrier
  s_mov_b32 s63, s25
  s_atomic_smax s63, s[4:5], s62 glc
Lnosig_50:
  s_cmp_ge_u32 s25, 64
  s_cbranch_scc1 L_END
  s_waitcnt vmcnt(0)
  v_cmp_gt_i32 vcc, s29, v3
  s_cbranch_vccz L_F2_issue
  s_nop 3
Lpoll_51:
  buffer_load_dword v3, v2, s[4:7], s30 offen sc1
  s_sub_u32 s24, s24, 1
  s_cbranch_scc1 L_FAIL
  s_waitcnt vmcnt(0)
  v_cmp_gt_i32 vcc, s29, v3
  s_cbranch_vccz Lpolld_52
  s_sleep 1
  s_branch Lpoll_51
Lpolld_52:
  s_branch L_F2_issue
L_F2_park:
  s_waitcnt vmcnt(0)
  s_barrier
  s_cmp_ge_u32 s25, 64
  s_cbranch_scc1 L_END
L_F2_issue:
  s_barrier
L_F2_mid:
  s_mov_b32 s34, s26
  s_mov_b32 s35, s27
  s_add_u32 s36, s32, 0
  s_add_u32 m0, s34, s36
  s_add_u32 s36, s35, 0
  buffer_load_dwordx4 v1, s[4:7], s36 offen offset:0 sc1 lds
  s_nop 0
  buffer_load_dwordx4 v1, s[4:7], s36 offen offset:1024 sc1 lds
  s_nop 0
  buffer_load_dwordx4 v1, s[4:7], s36 offen offset:2048 sc1 lds
  s_nop 0
  buffer_load_dwordx4 v1, s[4:7], s36 offen offset:3072 sc1 lds
  s_nop 0
  s_add_u32 s36, s32, 16384
  s_add_u32 m0, s34, s36
  s_add_u32 s36, s35, 32768
  buffer_load_dwordx4 v1, s[4:7], s36 offen offset:0 sc1 lds
  s_nop 0
  buffer_load_dwordx4 v1, s[4:7], s36 offen offset:1024 sc1 lds
  s_nop 0
  buffer_load_dwordx4 v1, s[4:7], s36 offen offset:2048 sc1 lds
  s_nop 0
  buffer_load_dwordx4 v1, s[4:7], s36 offen offset:3072 sc1 lds
  s_nop 0
  s_add_u32 s36, s32, 32768
  s_add_u32 m0, s34, s36
  s_add_u32 s36, s35, 65536
  buffer_load_dwordx4 v1, s[4:7], s36 offen offset:0 sc1 lds
  s_nop 0
  buffer_load_dwordx4 v1, s[4:7], s36 offen offset:1024 sc1 lds
  s_nop 0
  buffer_load_dwordx4 v1, s[4:7], s36 offen offset:2048 sc1 lds
  s_nop 0
  buffer_load_dwordx4 v1, s[4:7], s36 offen offset:3072 sc1 lds
  s_nop 0
  s_cmp_eq_u32 s28, 0
  s_cbranch_scc1 L_F2_go
  s_mov_b32 s28, 0
  s_waitcnt vmcnt(12)
  s_barrier
  s_cmp_lg_u32 s20, 0
  s_cbranch_scc1 Lnosig_53
  s_mov_b32 s63, s25
  s_atomic_smax s63, s[4:5], s62 glc
Lnosig_53:
L_F2_go:
  v_add_u32 v73, s26, v69
  v_add_u32 v74, s26, v70
  s_sub_u32 s26, 77824, s26
  s_add_u32 s27, s27, 2097152
  s_xor_b32 s27, s27, 0x2000
  s_add_u32 s29, s29, 1
  s_waitcnt vmcnt(8)
  s_barrier
  ds_read_b128 v[4:7], v73 offset:0
  ds_read_b128 v[8:11], v73 offset:1024
  ds_read_b128 v[12:15], v73 offset:2048
  ds_read_b128 v[16:19], v73 offset:3072
  ds_read_b128 v[20:23], v73 offset:4096
  ds_read_b128 v[24:27], v73 offset:5120
  s_waitcnt lgkmcnt(4)
  v_mfma_f32_16x16x32_bf16 v[36:39], a[0:3], v[4:7], 0
  ds_read_b128 v[28:31], v73 offset:6144
  v_mfma_f32_16x16x32_bf16 v[40:43], a[0:3], v[8:11], 0
  ds_read_b128 v[32:35], v73 offset:7168
  v_mfma_f32_16x16x32_bf16 v[44:47], a[152:155], v[4:7], 0
  s_add_u32 s36, s32, 49152
  s_add_u32 m0, s34, s36
  s_add_u32 s36, s35, 98304
  buffer_load_dwordx4 v1, s[4:7], s36 offen offset:0 sc1 lds
  v_mfma_f32_16x16x32_bf16 v[48:51], a[152:155], v[8:11], 0
  buffer_load_dwordx4 v1, s[4:7], s36 offen offset:1024 sc1 lds
  s_waitcnt lgkmcnt(4)
  v_mfma_f32_16x16x32_bf16 v[36:39], a[4:7], v[12:15], v[36:39]
  ds_read_b128 v[4:7], v73 offset:8192
  v_mfma_f32_16x16x32_bf16 v[40:43], a[4:7], v[16:19], v[40:43]
  ds_read_b128 v[8:11], v73 offset:9216
  v_mfma_f32_16x16x32_bf16 v[44:47], a[156:159], v[12:15], v[44:47]
  buffer_load_dwordx4 v1, s[4:7], s36 offen offset:2048 sc1 lds
  v_mfma_f32_16x16x32_bf16 v[48:51], a[156:159], v[16:19], v[48:51]
  buffer_load_dwordx4 v1, s[4:7], s36 offen offset:3072 sc1 lds
  s_waitcnt lgkmcnt(4)
  v_mfma_f32_16x16x32_bf16 v[36:39], a[8:11], v[20:23], v[36:39]
  ds_read_b128 v[12:15], v73 offset:10240
  v_mfma_f32_16x16x32_bf16 v[40:43], a[8:11], v[24:27], v[40:43]
  ds_read_b128 v[16:19], v73 offset:11264
  v_mfma_f32_16x16x32_bf16 v[44:47], a[160:163], v[20:23], v[44:47]
  s_add_u32 s36, s33, 65536
  s_add_u32 m0, s34, s36
  s_add_u32 s36, s35, 131072
  s_add_u32 s36, s36, s39
  buffer_load_dwordx4 v1, s[4:7], s36 offen offset:0 sc1 lds
  v_mfma_f32_16x16x32_bf16 v[48:51], a[160:163], v[24:27], v[48:51]
  buffer_load_dwordx4 v1, s[4:7], s36 offen offset:1024 sc1 lds
  s_waitcnt lgkmcnt(4)
  v_mfma_f32_16x16x32_bf16 v[36:39], a[12:15], v[28:31], v[36:39]
  ds_read_b128 v[20:23], v73 offset:12288
  v_mfma_f32_16x16x32_bf16 v[40:43], a[12:15], v[32:35], v[40:43]
  ds_read_b128 v[24:27], v73 offset:13312
  v_mfma_f32_16x16x32_bf16 v[44:47], a[164:167], v[28:31], v[44:47]
  buffer_load_dwordx4 v1, s[4:7], s36 offen offset:2048 sc1 lds
  v_mfma_f32_16x16x32_bf16 v[48:51], a[164:167], v[32:35], v[48:51]
  buffer_load_dwordx4 v1, s[4:7], s36 offen offset:3072 sc1 lds
  s_waitcnt lgkmcnt(4)
  v_mfma_f32_16x16x32_bf16 v[36:39], a[16:19], v[4:7], v[36:39]
  ds_read_b128 v[28:31], v73 offset:14336
  v_mfma_f32_16x16x32_bf16 v[40:43], a[16:19], v[8:11], v[40:43]
  ds_read_b128 v[32:35], v73 offset:15360
  v_mfma_f32_16x16x32_bf16 v[44:47], a[168:171], v[4:7], v[44:47]
  v_mfma_f32_16x16x32_bf16 v[48:51], a[168:171], v[8:11], v[48:51]
  s_waitcnt vmcnt(12)
  s_barrier
  s_mov_b32 s34, s26
  s_mov_b32 s35, s27
  s_waitcnt lgkmcnt(4)
  v_mfma_f32_16x16x32_bf16 v[36:39], a[20:23], v[12:15], v[36:39]
  ds_read_b128 v[4:7], v73 offset:16384
  v_mfma_f32_16x16x32_bf16 v[40:43], a[20:23], v[16:19], v[40:43]
  ds_read_b128 v[8:11], v73 offset:17408
  v_mfma_f32_16x16x32_bf16 v[44:47], a[172:175], v[12:15], v[44:47]
  v_mfma_f32_16x16x32_bf16 v[48:51], a[172:175], v[16:19], v[48:51]
  s_waitcnt lgkmcnt(4)
  v_mfma_f32_16x16x32_bf16 v[36:39], a[24:27], v[20:23], v[36:39]
  ds_read_b128 v[12:15], v73 offset:18432
  v_mfma_f32_16x16x32_bf16 v[40:43], a[24:27], v[24:27], v[40:43]
  ds_read_b128 v[16:19], v73 offset:19456
  v_mfma_f32_16x16x32_bf16 v[44:47], a[176:179], v[20:23], v[44:47]
  v_mfma_f32_16x16x32_bf16 v[48:51], a[176:179], v[24:27], v[48:51]
  s_waitcnt lgkmcnt(4)
  v_mfma_f32_16x16x32_bf16 v[36:39], a[28:31], v[28:31], v[36:39]
  ds_read_b128 v[20:23], v73 offset:20480
  v_mfma_f32_16x16x32_bf16 v[40:43], a[28:31], v[32:35], v[40:43]
  ds_read_b128 v[24:27], v73 offset:21504
  v_mfma_f32_16x16x32_bf16 v[44:47], a[180:183], v[28:31], v[44:47]
  v_mfma_f32_16x16x32_bf16 v[48:51], a[180:183], v[32:35], v[48:51]
  s_waitcnt lgkmcnt(4)
  v_mfma_f32_16x16x32_bf16 v[36:39], a[32:35], v[4:7], v[36:39]
  ds_read_b128 v[28:31], v73 offset:22528
  v_mfma_f32_16x16x32_bf16 v[40:43], a[32:35], v[8:11], v[40:43]
  ds_read_b128 v[32:35], v73 offset:23552
  v_mfma_f32_16x16x32_bf16 v[44:47], a[184:187], v[4:7], v[44:47]
  v_mfma_f32_16x16x32_bf16 v[48:51], a[184:187], v[8:11], v[48:51]
  s_waitcnt lgkmcnt(4)
  v_mfma_f32_16x16x32_bf16 v[36:39], a[36:39], v[12:15], v[36:39]
  ds_read_b128 v[4:7], v73 offset:24576
  v_mfma_f32_16x16x32_bf16 v[40:43], a[36:39], v[16:19], v[40:43]
  ds_read_b128 v[8:11], v73 offset:25600
  v_mfma_f32_16x16x32_bf16 v[44:47], a[188:191], v[12:15], v[44:47]
  v_mfma_f32_16x16x32_bf16 v[48:51], a[188:191], v[16:19], v[48:51]
  s_waitcnt lgkmcnt(4)
  v_mfma_f32_16x16x32_bf16 v[36:39], a[40:43], v[20:23], v[36:39]
  ds_read_b128 v[12:15], v73 offset:26624
  v_mfma_f32_16x16x32_bf16 v[40:43], a[40:43], v[24:27], v[40:43]
  ds_read_b128 v[16:19], v73 offset:27648
  v_mfma_f32_16x16x32_bf16 v[44:47], a[192:195], v[20:23], v[44:47]
  v_mfma_f32_16x16x32_bf16 v[48:51], a[192:195], v[24:27], v[48:51]
  s_waitcnt lgkmcnt(4)
  v_mfma_f32_16x16x32_bf16 v[36:39], a[44:47], v[28:31], v[36:39]
  ds_read_b128 v[20:23], v73 offset:28672
  v_mfma_f32_16x16x32_bf16 v[40:43], a[44:47], v[32:35], v[40:43]
  ds_read_b128 v[24:27], v73 offset:29696
  v_mfma_f32_16x16x32_bf16 v[44:47], a[196:199], v[28:31], v[44:47]
  v_mfma_f32_16x16x32_bf16 v[48:51], a[196:199], v[32:35], v[48:51]
  s_lshl_b32 s40, s20, 8
  s_add_u32 m0, s40, 155648
  s_cmp_eq_u32 s20, 0
  s_cselect_b32 s40, s30, 2147483392
  buffer_load_dword v2, s[4:7], s40 offen sc1 lds
  s_waitcnt lgkmcnt(4)
  v_mfma_f32_16x16x32_bf16 v[36:39], a[48:51], v[4:7], v[36:39]
  ds_read_b128 v[28:31], v73 offset:30720
  v_mfma_f32_16x16x32_bf16 v[40:43], a[48:51], v[8:11], v[40:43]
  ds_read_b128 v[32:35], v73 offset:31744
  v_mfma_f32_16x16x32_bf16 v[44:47], a[200:203], v[4:7], v[44:47]
  v_mfma_f32_16x16x32_bf16 v[48:51], a[200:203], v[8:11], v[48:51]
  s_waitcnt vmcnt(9)
  s_barrier
  s_lshl_b32 s40, s20, 1
  s_add_u32 s40, s40, 1
  s_cmp_lg_u32 s40, s28
  s_cbranch_scc1 L_F2_s2
  s_mov_b32 s63, s25
  s_atomic_smax s63, s[4:5], s62 glc
Lnosig_54:
L_F2_s2:
  s_waitcnt lgkmcnt(4)
  v_mfma_f32_16x16x32_bf16 v[36:39], a[52:55], v[12:15], v[36:39]
  ds_read_b128 v[4:7], v73 offset:32768
  v_mfma_f32_16x16x32_bf16 v[40:43], a[52:55], v[16:19], v[40:43]
  ds_read_b128 v[8:11], v73 offset:33792
  v_mfma_f32_16x16x32_bf16 v[44:47], a[204:207], v[12:15], v[44:47]
  v_mfma_f32_16x16x32_bf16 v[48:51], a[204:207], v[16:19], v[48:51]
  s_waitcnt lgkmcnt(4)
  v_mfma_f32_16x16x32_bf16 v[36:39], a[56:59], v[20:23], v[36:39]
  ds_read_b128 v[12:15], v73 offset:34816
  v_mfma_f32_16x16x32_bf16 v[40:43], a[56:59], v[24:27], v[40:43]
  ds_read_b128 v[16:19], v73 offset:35840
  v_mfma_f32_16x16x32_bf16 v[44:47], a[208:211], v[20:23], v[44:47]
  v_mfma_f32_16x16x32_bf16 v[48:51], a[208:211], v[24:27], v[48:51]
  s_waitcnt lgkmcnt(4)
  v_mfma_f32_16x16x32_bf16 v[36:39], a[60:63], v[28:31], v[36:39]
  ds_read_b128 v[20:23], v73 offset:36864
  v_mfma_f32_16x16x32_bf16 v[40:43], a[60:63], v[32:35], v[40:43]
  ds_read_b128 v[24:27], v73 offset:37888
  v_mfma_f32_16x16x32_bf16 v[44:47], a[212:215], v[28:31], v[44:47]
  v_mfma_f32_16x16x32_bf16 v[48:51], a[212:215], v[32:35], v[48:51]
  s_waitcnt lgkmcnt(4)
  v_mfma_f32_16x16x32_bf16 v[36:39], a[64:67], v[4:7], v[36:39]
  ds_read_b128 v[28:31], v73 offset:38912
  v_mfma_f32_16x16x32_bf16 v[40:43], a[64:67], v[8:11], v[40:43]
  ds_read_b128 v[32:35], v73 offset:39936
  v_mfma_f32_16x16x32_bf16 v[44:47], a[216:219], v[4:7], v[44:47]
  v_mfma_f32_16x16x32_bf16 v[48:51], a[216:219], v[8:11], v[48:51]
  s_waitcnt lgkmcnt(4)
  v_mfma_f32_16x16x32_bf16 v[36:39], a[68:71], v[12:15], v[36:39]
  ds_read_b128 v[4:7], v73 offset:40960
  v_mfma_f32_16x16x32_bf16 v[40:43], a[68:71], v[16:19], v[40:43]
  ds_read_b128 v[8:11], v73 offset:41984
  v_mfma_f32_16x16x32_bf16 v[44:47], a[220:223], v[12:15], v[44:47]
  v_mfma_f32_16x16x32_bf16 v[48:51], a[220:223], v[16:19], v[48:51]
  s_waitcnt lgkmcnt(4)
  v_mfma_f32_16x16x32_bf16 v[36:39], a[72:75], v[20:23], v[36:39]
  ds_read_b128 v[12:15], v73 offset:43008
  v_mfma_f32_16x16x32_bf16 v[40:43], a[72:75], v[24:27], v[40:43]
  ds_read_b128 v[16:19], v73 offset:44032
  v_mfma_f32_16x16x32_bf16 v[44:47], a[224:227], v[20:23], v[44:47]
  v_mfma_f32_16x16x32_bf16 v[48:51], a[224:227], v[24:27], v[48:51]
  s_waitcnt vmcnt(0)
  s_barrier
  ds_read_b32 v3, v71
  s_waitcnt lgkmcnt(4)
  v_mfma_f32_16x16x32_bf16 v[36:39], a[76:79], v[28:31], v[36:39]
  ds_read_b128 v[20:23], v73 offset:45056
  v_mfma_f32_16x16x32_bf16 v[40:43], a[76:79], v[32:35], v[40:43]
  ds_read_b128 v[24:27], v73 offset:46080
  v_mfma_f32_16x16x32_bf16 v[44:47], a[228:231], v[28:31], v[44:47]
  v_mfma_f32_16x16x32_bf16 v[48:51], a[228:231], v[32:35], v[48:51]
  s_waitcnt lgkmcnt(4)
  v_mfma_f32_16x16x32_bf16 v[36:39], a[80:83], v[4:7], v[36:39]
  ds_read_b128 v[28:31], v73 offset:47104
  v_mfma_f32_16x16x32_bf16 v[40:43], a[80:83], v[8:11], v[40:43]
  ds_read_b128 v[32:35], v73 offset:48128
  v_mfma_f32_16x16x32_bf16 v[44:47], a[232:235], v[4:7], v[44:47]
  v_mfma_f32_16x16x32_bf16 v[48:51], a[232:235], v[8:11], v[48:51]
  s_waitcnt lgkmcnt(4)
  v_cmp_gt_i32 vcc, s29, v3
  s_mov_b32 s28, 0
  s_cbranch_vccnz L_F2_nopf
  s_cmp_ge_u32 s25, 63
  s_cbranch_scc1 L_F2_nopf
  s_mov_b32 s28, 1
  s_waitcnt lgkmcnt(4)
  v_mfma_f32_16x16x32_bf16 v[36:39], a[84:87], v[12:15], v[36:39]
  ds_read_b128 v[4:7], v73 offset:49152
  v_mfma_f32_16x16x32_bf16 v[40:43], a[84:87], v[16:19], v[40:43]
  ds_read_b128 v[8:11], v73 offset:50176
  v_mfma_f32_16x16x32_bf16 v[44:47], a[236:239], v[12:15], v[44:47]
  s_add_u32 s36, s32, 0
  s_add_u32 m0, s34, s36
  s_add_u32 s36, s35, 0
  buffer_load_dwordx4 v1, s[4:7], s36 offen offset:0 sc1 lds
  v_mfma_f32_16x16x32_bf16 v[48:51], a[236:239], v[16:19], v[48:51]
  s_waitcnt lgkmcnt(4)
  v_mfma_f32_16x16x32_bf16 v[36:39], a[88:91], v[20:23], v[36:39]
  ds_read_b128 v[12:15], v73 offset:51200
  v_mfma_f32_16x16x32_bf16 v[40:43], a[88:91], v[24:27], v[40:43]
  ds_read_b128 v[16:19], v73 offset:52224
  v_mfma_f32_16x16x32_bf16 v[44:47], a[240:243], v[20:23], v[44:47]
  buffer_load_dwordx4 v1, s[4:7], s36 offen offset:1024 sc1 lds
  v_mfma_f32_16x16x32_bf16 v[48:51], a[240:243], v[24:27], v[48:51]
  s_waitcnt lgkmcnt(4)
  v_mfma_f32_16x16x32_bf16 v[36:39], a[92:95], v[28:31], v[36:39]
  ds_read_b128 v[20:23], v73 offset:53248
  v_mfma_f32_16x16x32_bf16 v[40:43], a[92:95], v[32:35], v[40:43]
  ds_read_b128 v[24:27], v73 offset:54272
  v_mfma_f32_16x16x32_bf16 v[44:47], a[244:247], v[28:31], v[44:47]
  buffer_load_dwordx4 v1, s[4:7], s36 offen offset:2048 sc1 lds
  v_mfma_f32_16x16x32_bf16 v[48:51], a[244:247], v[32:35], v[48:51]
  s_waitcnt lgkmcnt(4)
  v_mfma_f32_16x16x32_bf16 v[36:39], a[96:99], v[4:7], v[36:39]
  ds_read_b128 v[28:31], v73 offset:55296
  v_mfma_f32_16x16x32_bf16 v[40:43], a[96:99], v[8:11], v[40:43]
  ds_read_b128 v[32:35], v73 offset:56320
  v_mfma_f32_16x16x32_bf16 v[44:47], a[248:251], v[4:7], v[44:47]
  buffer_load_dwordx4 v1, s[4:7], s36 offen offset:3072 sc1 lds
  v_mfma_f32_16x16x32_bf16 v[48:51], a[248:251], v[8:11], v[48:51]
  s_waitcnt lgkmcnt(4)
  v_mfma_f32_16x16x32_bf16 v[36:39], a[100:103], v[12:15], v[36:39]
  ds_read_b128 v[4:7], v73 offset:57344
  v_mfma_f32_16x16x32_bf16 v[40:43], a[100:103], v[16:19], v[40:43]
  ds_read_b128 v[8:11], v73 offset:58368
  v_mfma_f32_16x16x32_bf16 v[44:47], a[252:255], v[12:15], v[44:47]
  s_add_u32 s36, s32, 16384
  s_add_u32 m0, s34, s36
  s_add_u32 s36, s35, 32768
  buffer_load_dwordx4 v1, s[4:7], s36 offen offset:0 sc1 lds
  v_mfma_f32_16x16x32_bf16 v[48:51], a[252:255], v[16:19], v[48:51]
  s_waitcnt lgkmcnt(4)
  v_mfma_f32_16x16x32_bf16 v[36:39], a[104:107], v[20:23], v[36:39]
  ds_read_b128 v[12:15], v73 offset:59392
  v_mfma_f32_16x16x32_bf16 v[40:43], a[104:107], v[24:27], v[40:43]
  ds_read_b128 v[16:19], v73 offset:60416
  v_mfma_f32_16x16x32_bf16 v[44:47], v[128:131], v[20:23], v[44:47]
  buffer_load_dwordx4 v1, s[4:7], s36 offen offset:1024 sc1 lds
  v_mfma_f32_16x16x32_bf16 v[48:51], v[128:131], v[24:27], v[48:51]
  s_waitcnt lgkmcnt(4)
  v_mfma_f32_16x16x32_bf16 v[36:39], a[108:111], v[28:31], v[36:39]
  ds_read_b128 v[20:23], v73 offset:61440
  v_mfma_f32_16x16x32_bf16 v[40:43], a[108:111], v[32:35], v[40:43]
  ds_read_b128 v[24:27], v73 offset:62464
  v_mfma_f32_16x16x32_bf16 v[44:47], v[132:135], v[28:31], v[44:47]
  buffer_load_dwordx4 v1, s[4:7], s36 offen offset:2048 sc1 lds
  v_mfma_f32_16x16x32_bf16 v[48:51], v[132:135], v[32:35], v[48:51]
  s_waitcnt lgkmcnt(4)
  v_mfma_f32_16x16x32_bf16 v[36:39], a[112:115], v[4:7], v[36:39]
  ds_read_b128 v[28:31], v73 offset:63488
  v_mfma_f32_16x16x32_bf16 v[40:43], a[112:115], v[8:11], v[40:43]
  ds_read_b128 v[32:35], v73 offset:64512
  v_mfma_f32_16x16x32_bf16 v[44:47], v[136:139], v[4:7], v[44:47]
  buffer_load_dwordx4 v1, s[4:7], s36 offen offset:3072 sc1 lds
  v_mfma_f32_16x16x32_bf16 v[48:51], v[136:139], v[8:11], v[48:51]
  s_waitcnt lgkmcnt(4)
  v_mfma_f32_16x16x32_bf16 v[36:39], a[116:119], v[12:15], v[36:39]
  ds_read_b128 v[4:7], v74 offset:0
  v_mfma_f32_16x16x32_bf16 v[40:43], a[116:119], v[16:19], v[40:43]
  ds_read_b128 v[8:11], v74 offset:1024
  v_mfma_f32_16x16x32_bf16 v[44:47], v[140:143], v[12:15], v[44:47]
  s_add_u32 s36, s32, 32768
  s_add_u32 m0, s34, s36
  s_add_u32 s36, s35, 65536
  buffer_load_dwordx4 v1, s[4:7], s36 offen offset:0 sc1 lds
  v_mfma_f32_16x16x32_bf16 v[48:51], v[140:143], v[16:19], v[48:51]
  s_waitcnt lgkmcnt(4)
  v_mfma_f32_16x16x32_bf16 v[36:39], a[120:123], v[20:23], v[36:39]
  ds_read_b128 v[12:15], v74 offset:2048
  v_mfma_f32_16x16x32_bf16 v[40:43], a[120:123], v[24:27], v[40:43]
  ds_read_b128 v[16:19], v74 offset:3072
  v_mfma_f32_16x16x32_bf16 v[44:47], v[144:147], v[20:23], v[44:47]
  buffer_load_dwordx4 v1, s[4:7], s36 offen offset:1024 sc1 lds
  v_mfma_f32_16x16x32_bf16 v[48:51], v[144:147], v[24:27], v[48:51]
  s_waitcnt lgkmcnt(4)
  v_mfma_f32_16x16x32_bf16 v[36:39], a[124:127], v[28:31], v[36:39]
  ds_read_b128 v[20:23], v74 offset:4096
  v_mfma_f32_16x16x32_bf16 v[40:43], a[124:127], v[32:35], v[40:43]
  ds_read_b128 v[24:27], v74 offset:5120
  v_mfma_f32_16x16x32_bf16 v[44:47], v[148:151], v[28:31], v[44:47]
  buffer_load_dwordx4 v1, s[4:7], s36 offen offset:2048 sc1 lds
  v_mfma_f32_16x16x32_bf16 v[48:51], v[148:151], v[32:35], v[48:51]
  s_waitcnt lgkmcnt(4)
  v_mfma_f32_16x16x32_bf16 v[36:39], a[128:131], v[4:7], v[36:39]
  ds_read_b128 v[28:31], v74 offset:6144
  v_mfma_f32_16x16x32_bf16 v[40:43], a[128:131], v[8:11], v[40:43]
  ds_read_b128 v[32:35], v74 offset:7168
  v_mfma_f32_16x16x32_bf16 v[44:47], v[152:155], v[4:7], v[44:47]
  buffer_load_dwordx4 v1, s[4:7], s36 offen offset:3072 sc1 lds
  v_mfma_f32_16x16x32_bf16 v[48:51], v[152:155], v[8:11], v[48:51]
  s_waitcnt lgkmcnt(4)
  v_mfma_f32_16x16x32_bf16 v[36:39], a[132:135], v[12:15], v[36:39]
  ds_read_b128 v[4:7], v74 offset:8192
  v_mfma_f32_16x16x32_bf16 v[40:43], a[132:135], v[16:19], v[40:43]
  ds_read_b128 v[8:11], v74 offset:9216
  v_mfma_f32_16x16x32_bf16 v[44:47], v[156:159], v[12:15], v[44:47]
  v_mfma_f32_16x16x32_bf16 v[48:51], v[156:159], v[16:19], v[48:51]
  s_waitcnt lgkmcnt(4)
  v_mfma_f32_16x16x32_bf16 v[36:39], a[136:139], v[20:23], v[36:39]
  ds_read_b128 v[12:15], v74 offset:10240
  v_mfma_f32_16x16x32_bf16 v[40:43], a[136:139], v[24:27], v[40:43]
  ds_read_b128 v[16:19], v74 offset:11264
  v_mfma_f32_16x16x32_bf16 v[44:47], v[160:163], v[20:23], v[44:47]
  v_mfma_f32_16x16x32_bf16 v[48:51], v[160:163], v[24:27], v[48:51]
  s_waitcnt lgkmcnt(4)
  v_mfma_f32_16x16x32_bf16 v[36:39], a[140:143], v[28:31], v[36:39]
  v_mfma_f32_16x16x32_bf16 v[40:43], a[140:143], v[32:35], v[40:43]
  v_mfma_f32_16x16x32_bf16 v[44:47], v[164:167], v[28:31], v[44:47]
  v_mfma_f32_16x16x32_bf16 v[48:51], v[164:167], v[32:35], v[48:51]
  s_waitcnt lgkmcnt(2)
  v_mfma_f32_16x16x32_bf16 v[36:39], a[144:147], v[4:7], v[36:39]
  v_mfma_f32_16x16x32_bf16 v[40:43], a[144:147], v[8:11], v[40:43]
  v_mfma_f32_16x16x32_bf16 v[44:47], v[168:171], v[4:7], v[44:47]
  v_mfma_f32_16x16x32_bf16 v[48:51], v[168:171], v[8:11], v[48:51]
  s_waitcnt lgkmcnt(0)
  v_mfma_f32_16x16x32_bf16 v[36:39], a[148:151], v[12:15], v[36:39]
  v_mfma_f32_16x16x32_bf16 v[40:43], a[148:151], v[16:19], v[40:43]
  v_mfma_f32_16x16x32_bf16 v[44:47], v[172:175], v[12:15], v[44:47]
  v_mfma_f32_16x16x32_bf16 v[48:51], v[172:175], v[16:19], v[48:51]
  s_nop 7
  s_branch L_F2_epi
L_F2_nopf:
  s_waitcnt lgkmcnt(4)
  v_mfma_f32_16x16x32_bf16 v[36:39], a[84:87], v[12:15], v[36:39]
  ds_read_b128 v[4:7], v73 offset:49152
  v_mfma_f32_16x16x32_bf16 v[40:43], a[84:87], v[16:19], v[40:43]
  ds_read_b128 v[8:11], v73 offset:50176
  v_mfma_f32_16x16x32_bf16 v[44:47], a[236:239], v[12:15], v[44:47]
  v_mfma_f32_16x16x32_bf16 v[48:51], a[236:239], v[16:19], v[48:51]
  s_waitcnt lgkmcnt(4)
  v_mfma_f32_16x16x32_bf16 v[36:39], a[88:91], v[20:23], v[36:39]
  ds_read_b128 v[12:15], v73 offset:51200
  v_mfma_f32_16x16x32_bf16 v[40:43], a[88:91], v[24:27], v[40:43]
  ds_read_b128 v[16:19], v73 offset:52224
  v_mfma_f32_16x16x32_bf16 v[44:47], a[240:243], v[20:23], v[44:47]
  v_mfma_f32_16x16x32_bf16 v[48:51], a[240:243], v[24:27], v[48:51]
  s_waitcnt lgkmcnt(4)
  v_mfma_f32_16x16x32_bf16 v[36:39], a[92:95], v[28:31], v[36:39]
  ds_read_b128 v[20:23], v73 offset:53248
  v_mfma_f32_16x16x32_bf16 v[40:43], a[92:95], v[32:35], v[40:43]
  ds_read_b128 v[24:27], v73 offset:54272
  v_mfma_f32_16x16x32_bf16 v[44:47], a[244:247], v[28:31], v[44:47]
  v_mfma_f32_16x16x32_bf16 v[48:51], a[244:247], v[32:35], v[48:51]
  s_waitcnt lgkmcnt(4)
  v_mfma_f32_16x16x32_bf16 v[36:39], a[96:99], v[4:7], v[36:39]
  ds_read_b128 v[28:31], v73 offset:55296
  v_mfma_f32_16x16x32_bf16 v[40:43], a[96:99], v[8:11], v[40:43]
  ds_read_b128 v[32:35], v73 offset:56320
  v_mfma_f32_16x16x32_bf16 v[44:47], a[248:251], v[4:7], v[44:47]
  v_mfma_f32_16x16x32_bf16 v[48:51], a[248:251], v[8:11], v[48:51]
  s_waitcnt lgkmcnt(4)
  v_mfma_f32_16x16x32_bf16 v[36:39], a[100:103], v[12:15], v[36:39]
  ds_read_b128 v[4:7], v73 offset:57344
  v_mfma_f32_16x16x32_bf16 v[40:43], a[100:103], v[16:19], v[40:43]
  ds_read_b128 v[8:11], v73 offset:58368
  v_mfma_f32_16x16x32_bf16 v[44:47], a[252:255], v[12:15], v[44:47]
  v_mfma_f32_16x16x32_bf16 v[48:51], a[252:255], v[16:19], v[48:51]
  s_waitcnt lgkmcnt(4)
  v_mfma_f32_16x16x32_bf16 v[36:39], a[104:107], v[20:23], v[36:39]
  ds_read_b128 v[12:15], v73 offset:59392
  v_mfma_f32_16x16x32_bf16 v[40:43], a[104:107], v[24:27], v[40:43]
  ds_read_b128 v[16:19], v73 offset:60416
  v_mfma_f32_16x16x32_bf16 v[44:47], v[128:131], v[20:23], v[44:47]
  v_mfma_f32_16x16x32_bf16 v[48:51], v[128:131], v[24:27], v[48:51]
  s_waitcnt lgkmcnt(4)
  v_mfma_f32_16x16x32_bf16 v[36:39], a[108:111], v[28:31], v[36:39]
  ds_read_b128 v[20:23], v73 offset:61440
  v_mfma_f32_16x16x32_bf16 v[40:43], a[108:111], v[32:35], v[40:43]
  ds_read_b128 v[24:27], v73 offset:62464
  v_mfma_f32_16x16x32_bf16 v[44:47], v[132:135], v[28:31], v[44:47]
  v_mfma_f32_16x16x32_bf16 v[48:51], v[132:135], v[32:35], v[48:51]
  s_waitcnt lgkmcnt(4)
  v_mfma_f32_16x16x32_bf16 v[36:39], a[112:115], v[4:7], v[36:39]
  ds_read_b128 v[28:31], v73 offset:63488
  v_mfma_f32_16x16x32_bf16 v[40:43], a[112:115], v[8:11], v[40:43]
  ds_read_b128 v[32:35], v73 offset:64512
  v_mfma_f32_16x16x32_bf16 v[44:47], v[136:139], v[4:7], v[44:47]
  v_mfma_f32_16x16x32_bf16 v[48:51], v[136:139], v[8:11], v[48:51]
  s_waitcnt lgkmcnt(4)
  v_mfma_f32_16x16x32_bf16 v[36:39], a[116:119], v[12:15], v[36:39]
  ds_read_b128 v[4:7], v74 offset:0
  v_mfma_f32_16x16x32_bf16 v[40:43], a[116:119], v[16:19], v[40:43]
  ds_read_b128 v[8:11], v74 offset:1024
  v_mfma_f32_16x16x32_bf16 v[44:47], v[140:143], v[12:15], v[44:47]
  v_mfma_f32_16x16x32_bf16 v[48:51], v[140:143], v[16:19], v[48:51]
  s_barrier
  s_lshl_b32 s40, s20, 8
  s_add_u32 m0, s40, 155648
  s_cmp_eq_u32 s20, 0
  s_cselect_b32 s40, s30, 2147483392
  buffer_load_dword v2, s[4:7], s40 offen sc1 lds
  s_waitcnt lgkmcnt(4)
  v_mfma_f32_16x16x32_bf16 v[36:39], a[120:123], v[20:23], v[36:39]
  ds_read_b128 v[12:15], v74 offset:2048
  v_mfma_f32_16x16x32_bf16 v[40:43], a[120:123], v[24:27], v[40:43]
  ds_read_b128 v[16:19], v74 offset:3072
  v_mfma_f32_16x16x32_bf16 v[44:47], v[144:147], v[20:23], v[44:47]
  v_mfma_f32_16x16x32_bf16 v[48:51], v[144:147], v[24:27], v[48:51]
  s_waitcnt lgkmcnt(4)
  v_mfma_f32_16x16x32_bf16 v[36:39], a[124:127], v[28:31], v[36:39]
  ds_read_b128 v[20:23], v74 offset:4096
  v_mfma_f32_16x16x32_bf16 v[40:43], a[124:127], v[32:35], v[40:43]
  ds_read_b128 v[24:27], v74 offset:5120
  v_mfma_f32_16x16x32_bf16 v[44:47], v[148:151], v[28:31], v[44:47]
  v_mfma_f32_16x16x32_bf16 v[48:51], v[148:151], v[32:35], v[48:51]
  s_waitcnt lgkmcnt(4)
  v_mfma_f32_16x16x32_bf16 v[36:39], a[128:131], v[4:7], v[36:39]
  ds_read_b128 v[28:31], v74 offset:6144
  v_mfma_f32_16x16x32_bf16 v[40:43], a[128:131], v[8:11], v[40:43]
  ds_read_b128 v[32:35], v74 offset:7168
  v_mfma_f32_16x16x32_bf16 v[44:47], v[152:155], v[4:7], v[44:47]
  v_mfma_f32_16x16x32_bf16 v[48:51], v[152:155], v[8:11], v[48:51]
  s_waitcnt lgkmcnt(4)
  v_mfma_f32_16x16x32_bf16 v[36:39], a[132:135], v[12:15], v[36:39]
  ds_read_b128 v[4:7], v74 offset:8192
  v_mfma_f32_16x16x32_bf16 v[40:43], a[132:135], v[16:19], v[40:43]
  ds_read_b128 v[8:11], v74 offset:9216
  v_mfma_f32_16x16x32_bf16 v[44:47], v[156:159], v[12:15], v[44:47]
  v_mfma_f32_16x16x32_bf16 v[48:51], v[156:159], v[16:19], v[48:51]
  s_waitcnt lgkmcnt(4)
  v_mfma_f32_16x16x32_bf16 v[36:39], a[136:139], v[20:23], v[36:39]
  ds_read_b128 v[12:15], v74 offset:10240
  v_mfma_f32_16x16x32_bf16 v[40:43], a[136:139], v[24:27], v[40:43]
  ds_read_b128 v[16:19], v74 offset:11264
  v_mfma_f32_16x16x32_bf16 v[44:47], v[160:163], v[20:23], v[44:47]
  v_mfma_f32_16x16x32_bf16 v[48:51], v[160:163], v[24:27], v[48:51]
  s_waitcnt lgkmcnt(4)
  v_mfma_f32_16x16x32_bf16 v[36:39], a[140:143], v[28:31], v[36:39]
  v_mfma_f32_16x16x32_bf16 v[40:43], a[140:143], v[32:35], v[40:43]
  v_mfma_f32_16x16x32_bf16 v[44:47], v[164:167], v[28:31], v[44:47]
  v_mfma_f32_16x16x32_bf16 v[48:51], v[164:167], v[32:35], v[48:51]
  s_waitcnt vmcnt(0)
  s_barrier
  ds_read_b32 v3, v71
  s_waitcnt lgkmcnt(2)
  v_mfma_f32_16x16x32_bf16 v[36:39], a[144:147], v[4:7], v[36:39]
  v_mfma_f32_16x16x32_bf16 v[40:43], a[144:147], v[8:11], v[40:43]
  v_mfma_f32_16x16x32_bf16 v[44:47], v[168:171], v[4:7], v[44:47]
  v_mfma_f32_16x16x32_bf16 v[48:51], v[168:171], v[8:11], v[48:51]
  s_waitcnt lgkmcnt(0)
  v_mfma_f32_16x16x32_bf16 v[36:39], a[148:151], v[12:15], v[36:39]
  v_mfma_f32_16x16x32_bf16 v[40:43], a[148:151], v[16:19], v[40:43]
  v_mfma_f32_16x16x32_bf16 v[44:47], v[172:175], v[12:15], v[44:47]
  v_mfma_f32_16x16x32_bf16 v[48:51], v[172:175], v[16:19], v[48:51]
  v_cmp_gt_i32 vcc, s29, v3
  s_cmp_eq_u64 vcc, 0
  s_cselect_b32 s28, 2, 0
  s_cmp_lt_u32 s25, 63
  s_cselect_b32 s28, s28, 0
L_F2_epi:
  v_cvt_pk_bf16_f32 v52, v36, v37
  v_cvt_pk_bf16_f32 v53, v38, v39
  v_cvt_pk_bf16_f32 v54, v44, v45
  v_cvt_pk_bf16_f32 v55, v46, v47
  buffer_store_dwordx4 v[52:55], v68, s[4:7], s31 offen offset:0 sc1
  v_cvt_pk_bf16_f32 v56, v40, v41
  v_cvt_pk_bf16_f32 v57, v42, v43
  v_cvt_pk_bf16_f32 v58, v48, v49
  v_cvt_pk_bf16_f32 v59, v50, v51
  buffer_store_dwordx4 v[56:59], v68, s[4:7], s31 offen offset:1024 sc1
  s_add_u32 s25, s25, 1
  s_add_u32 s31, s31, 2097152
  s_xor_b32 s31, s31, 0x2000
  s_branch L_F2_top
L_WOF:
  s_load_dwordx2 s[8:9], s[0:1], 40
  s_mov_b32 s10, 8388608
  s_mov_b32 s11, 0x20000
  s_waitcnt lgkmcnt(0)
  v_bfe_u32 v1, v0, 5, 1
  v_mul_u32_u24 v1, 131072, v1
  v_bfe_u32 v2, v0, 4, 1
  v_mul_u32_u24 v2, 8192, v2
  v_add_u32 v1, v1, v2
  v_bfe_u32 v2, v0, 3, 1
  v_mul_u32_u24 v2, 2048, v2
  v_add_u32 v1, v1, v2
  v_lshrrev_b32 v2, 3, v0
  v_and_b32 v2, 6, v2
  v_xor_b32 v2, v2, v0
  v_and_b32 v2, 7, v2
  v_lshl_add_u32 v1, v2, 4, v1
  v_bfe_u32 v2, v0, 3, 2
  v_xor_b32 v2, 0, v2
  v_lshlrev_b32 v2, 5, v2
  v_lshrrev_b32 v4, 2, v0
  v_lshl_add_u32 v4, v4, 7, v2
  v_and_b32 v2, 3, v0
  v_lshl_add_u32 v4, v2, 3, v4
  s_and_b32 s43, s21, 3
  s_lshl_b32 s43, s43, 2
  s_add_u32 s43, s43, s20
  s_lshr_b32 s44, s21, 2
  s_lshl_b32 s40, s43, 19
  s_lshl_b32 s41, s44, 7
  s_add_u32 s40, s40, s41
  v_add_u32 v1, s40, v1
  s_lshl_b32 s41, s20, 15
  v_add_u32 v4, s41, v4
  s_lshl_b32 s40, s44, 19
  s_lshl_b32 s45, s43, 14
  s_add_u32 s40, s40, s45
  v_lshl_add_u32 v3, v0, 4, s40
  v_xor_b32 v5, 32, v4
  v_xor_b32 v6, 64, v4
  v_xor_b32 v7, 96, v4
  s_add_u32 m0, s41, 0
  s_mov_b32 s42, 0
  buffer_load_dwordx4 v1, s[8:11], s42 offen nt lds
  s_add_u32 m0, s41, 1024
  s_mov_b32 s42, 16384
  buffer_load_dwordx4 v1, s[8:11], s42 offen nt lds
  s_add_u32 m0, s41, 2048
  s_mov_b32 s42, 4096
  buffer_load_dwordx4 v1, s[8:11], s42 offen nt lds
  s_add_u32 m0, s41, 3072
  s_mov_b32 s42, 20480
  buffer_load_dwordx4 v1, s[8:11], s42 offen nt lds
  s_add_u32 m0, s41, 4096
  s_mov_b32 s42, 32768
  buffer_load_dwordx4 v1, s[8:11], s42 offen nt lds
  s_add_u32 m0, s41, 5120
  s_mov_b32 s42, 49152
  buffer_load_dwordx4 v1, s[8:11], s42 offen nt lds
  s_add_u32 m0, s41, 6144
  s_mov_b32 s42, 36864
  buffer_load_dwordx4 v1, s[8:11], s42 offen nt lds
  s_add_u32 m0, s41, 7168
  s_mov_b32 s42, 53248
  buffer_load_dwordx4 v1, s[8:11], s42 offen nt lds
  s_add_u32 m0, s41, 8192
  s_mov_b32 s42, 65536
  buffer_load_dwordx4 v1, s[8:11], s42 offen nt lds
  s_add_u32 m0, s41, 9216
  s_mov_b32 s42, 81920
  buffer_load_dwordx4 v1, s[8:11], s42 offen nt lds
  s_add_u32 m0, s41, 10240
  s_mov_b32 s42, 69632
  buffer_load_dwordx4 v1, s[8:11], s42 offen nt lds
  s_add_u32 m0, s41, 11264
  s_mov_b32 s42, 86016
  buffer_load_dwordx4 v1, s[8:11], s42 offen nt lds
  s_add_u32 m0, s41, 12288
  s_mov_b32 s42, 98304
  buffer_load_dwordx4 v1, s[8:11], s42 offen nt lds
  s_add_u32 m0, s41, 13312
  s_mov_b32 s42, 114688
  buffer_load_dwordx4 v1, s[8:11], s42 offen nt lds
  s_add_u32 m0, s41, 14336
  s_mov_b32 s42, 102400
  buffer_load_dwordx4 v1, s[8:11], s42 offen nt lds
  s_add_u32 m0, s41, 15360
  s_mov_b32 s42, 118784
  buffer_load_dwordx4 v1, s[8:11], s42 offen nt lds
  s_add_u32 m0, s41, 16384
  s_mov_b32 s42, 262144
  buffer_load_dwordx4 v1, s[8:11], s42 offen nt lds
  s_add_u32 m0, s41, 17408
  s_mov_b32 s42, 278528
  buffer_load_dwordx4 v1, s[8:11], s42 offen nt lds
  s_add_u32 m0, s41, 18432
  s_mov_b32 s42, 266240
  buffer_load_dwordx4 v1, s[8:11], s42 offen nt lds
  s_add_u32 m0, s41, 19456
  s_mov_b32 s42, 282624
  buffer_load_dwordx4 v1, s[8:11], s42 offen nt lds
  s_add_u32 m0, s41, 20480
  s_mov_b32 s42, 294912
  buffer_load_dwordx4 v1, s[8:11], s42 offen nt lds
  s_add_u32 m0, s41, 21504
  s_mov_b32 s42, 311296
  buffer_load_dwordx4 v1, s[8:11], s42 offen nt lds
  s_add_u32 m0, s41, 22528
  s_mov_b32 s42, 299008
  buffer_load_dwordx4 v1, s[8:11], s42 offen nt lds
  s_add_u32 m0, s41, 23552
  s_mov_b32 s42, 315392
  buffer_load_dwordx4 v1, s[8:11], s42 offen nt lds
  s_add_u32 m0, s41, 24576
  s_mov_b32 s42, 327680
  buffer_load_dwordx4 v1, s[8:11], s42 offen nt lds
  s_add_u32 m0, s41, 25600
  s_mov_b32 s42, 344064
  buffer_load_dwordx4 v1, s[8:11], s42 offen nt lds
  s_add_u32 m0, s41, 26624
  s_mov_b32 s42, 331776
  buffer_load_dwordx4 v1, s[8:11], s42 offen nt lds
  s_add_u32 m0, s41, 27648
  s_mov_b32 s42, 348160
  buffer_load_dwordx4 v1, s[8:11], s42 offen nt lds
  s_add_u32 m0, s41, 28672
  s_mov_b32 s42, 360448
  buffer_load_dwordx4 v1, s[8:11], s42 offen nt lds
  s_add_u32 m0, s41, 29696
  s_mov_b32 s42, 376832
  buffer_load_dwordx4 v1, s[8:11], s42 offen nt lds
  s_add_u32 m0, s41, 30720
  s_mov_b32 s42, 364544
  buffer_load_dwordx4 v1, s[8:11], s42 offen nt lds
  s_add_u32 m0, s41, 31744
  s_mov_b32 s42, 380928
  buffer_load_dwordx4 v1, s[8:11], s42 offen nt lds
  s_waitcnt vmcnt(24)
  ds_read_b64_tr_b16 v[8:9], v4 offset:0
  ds_read_b64_tr_b16 v[10:11], v4 offset:2048
  ds_read_b64_tr_b16 v[12:13], v4 offset:4096
  ds_read_b64_tr_b16 v[14:15], v4 offset:6144
  ds_read_b64_tr_b16 v[16:17], v5 offset:0
  ds_read_b64_tr_b16 v[18:19], v5 offset:2048
  ds_read_b64_tr_b16 v[20:21], v5 offset:4096
  ds_read_b64_tr_b16 v[22:23], v5 offset:6144
  ds_read_b64_tr_b16 v[24:25], v6 offset:0
  ds_read_b64_tr_b16 v[26:27], v6 offset:2048
  ds_read_b64_tr_b16 v[28:29], v6 offset:4096
  ds_read_b64_tr_b16 v[30:31], v6 offset:6144
  ds_read_b64_tr_b16 v[32:33], v7 offset:0
  ds_read_b64_tr_b16 v[34:35], v7 offset:2048
  ds_read_b64_tr_b16 v[36:37], v7 offset:4096
  ds_read_b64_tr_b16 v[38:39], v7 offset:6144
  s_mov_b32 s42, 6291456
  s_waitcnt lgkmcnt(12)
  buffer_store_dwordx4 v[8:11], v3, s[4:7], s42 offen offset:0 sc1
  buffer_store_dwordx4 v[12:15], v3, s[4:7], s42 offen offset:1024 sc1
  s_mov_b32 s42, 6291456
  s_waitcnt lgkmcnt(8)
  buffer_store_dwordx4 v[16:19], v3, s[4:7], s42 offen offset:2048 sc1
  buffer_store_dwordx4 v[20:23], v3, s[4:7], s42 offen offset:3072 sc1
  s_mov_b32 s42, 6553600
  s_waitcnt lgkmcnt(4)
  buffer_store_dwordx4 v[24:27], v3, s[4:7], s42 offen offset:0 sc1
  buffer_store_dwordx4 v[28:31], v3, s[4:7], s42 offen offset:1024 sc1
  s_mov_b32 s42, 6553600
  s_waitcnt lgkmcnt(0)
  buffer_store_dwordx4 v[32:35], v3, s[4:7], s42 offen offset:2048 sc1
  buffer_store_dwordx4 v[36:39], v3, s[4:7], s42 offen offset:3072 sc1
  s_waitcnt vmcnt(24)
  ds_read_b64_tr_b16 v[40:41], v4 offset:8192
  ds_read_b64_tr_b16 v[42:43], v4 offset:10240
  ds_read_b64_tr_b16 v[44:45], v4 offset:12288
  ds_read_b64_tr_b16 v[46:47], v4 offset:14336
  ds_read_b64_tr_b16 v[48:49], v5 offset:8192
  ds_read_b64_tr_b16 v[50:51], v5 offset:10240
  ds_read_b64_tr_b16 v[52:53], v5 offset:12288
  ds_read_b64_tr_b16 v[54:55], v5 offset:14336
  ds_read_b64_tr_b16 v[56:57], v6 offset:8192
  ds_read_b64_tr_b16 v[58:59], v6 offset:10240
  ds_read_b64_tr_b16 v[60:61], v6 offset:12288
  ds_read_b64_tr_b16 v[62:63], v6 offset:14336
  ds_read_b64_tr_b16 v[64:65], v7 offset:8192
  ds_read_b64_tr_b16 v[66:67], v7 offset:10240
  ds_read_b64_tr_b16 v[68:69], v7 offset:12288
  ds_read_b64_tr_b16 v[70:71], v7 offset:14336
  s_mov_b32 s42, 6295552
  s_waitcnt lgkmcnt(12)
  buffer_store_dwordx4 v[40:43], v3, s[4:7], s42 offen offset:0 sc1
  buffer_store_dwordx4 v[44:47], v3, s[4:7], s42 offen offset:1024 sc1
  s_mov_b32 s42, 6295552
  s_waitcnt lgkmcnt(8)
  buffer_store_dwordx4 v[48:51], v3, s[4:7], s42 offen offset:2048 sc1
  buffer_store_dwordx4 v[52:55], v3, s[4:7], s42 offen offset:3072 sc1
  s_mov_b32 s42, 6557696
  s_waitcnt lgkmcnt(4)
  buffer_store_dwordx4 v[56:59], v3, s[4:7], s42 offen offset:0 sc1
  buffer_store_dwordx4 v[60:63], v3, s[4:7], s42 offen offset:1024 sc1
  s_mov_b32 s42, 6557696
  s_waitcnt lgkmcnt(0)
  buffer_store_dwordx4 v[64:67], v3, s[4:7], s42 offen offset:2048 sc1
  buffer_store_dwordx4 v[68:71], v3, s[4:7], s42 offen offset:3072 sc1
  s_waitcnt vmcnt(24)
  ds_read_b64_tr_b16 v[72:73], v4 offset:16384
  ds_read_b64_tr_b16 v[74:75], v4 offset:18432
  ds_read_b64_tr_b16 v[76:77], v4 offset:20480
  ds_read_b64_tr_b16 v[78:79], v4 offset:22528
  ds_read_b64_tr_b16 v[80:81], v5 offset:16384
  ds_read_b64_tr_b16 v[82:83], v5 offset:18432
  ds_read_b64_tr_b16 v[84:85], v5 offset:20480
  ds_read_b64_tr_b16 v[86:87], v5 offset:22528
  ds_read_b64_tr_b16 v[88:89], v6 offset:16384
  ds_read_b64_tr_b16 v[90:91], v6 offset:18432
  ds_read_b64_tr_b16 v[92:93], v6 offset:20480
  ds_read_b64_tr_b16 v[94:95], v6 offset:22528
  ds_read_b64_tr_b16 v[96:97], v7 offset:16384
  ds_read_b64_tr_b16 v[98:99], v7 offset:18432
  ds_read_b64_tr_b16 v[100:101], v7 offset:20480
  ds_read_b64_tr_b16 v[102:103], v7 offset:22528
  s_mov_b32 s42, 6299648
  s_waitcnt lgkmcnt(12)
  buffer_store_dwordx4 v[72:75], v3, s[4:7], s42 offen offset:0 sc1
  buffer_store_dwordx4 v[76:79], v3, s[4:7], s42 offen offset:1024 sc1
  s_mov_b32 s42, 6299648
  s_waitcnt lgkmcnt(8)
  buffer_store_dwordx4 v[80:83], v3, s[4:7], s42 offen offset:2048 sc1
  buffer_store_dwordx4 v[84:87], v3, s[4:7], s42 offen offset:3072 sc1
  s_mov_b32 s42, 6561792
  s_waitcnt lgkmcnt(4)
  buffer_store_dwordx4 v[88:91], v3, s[4:7], s42 offen offset:0 sc1
  buffer_store_dwordx4 v[92:95], v3, s[4:7], s42 offen offset:1024 sc1
  s_mov_b32 s42, 6561792
  s_waitcnt lgkmcnt(0)
  buffer_store_dwordx4 v[96:99], v3, s[4:7], s42 offen offset:2048 sc1
  buffer_store_dwordx4 v[100:103], v3, s[4:7], s42 offen offset:3072 sc1
  s_waitcnt vmcnt(24)
  ds_read_b64_tr_b16 v[104:105], v4 offset:24576
  ds_read_b64_tr_b16 v[106:107], v4 offset:26624
  ds_read_b64_tr_b16 v[108:109], v4 offset:28672
  ds_read_b64_tr_b16 v[110:111], v4 offset:30720
  ds_read_b64_tr_b16 v[112:113], v5 offset:24576
  ds_read_b64_tr_b16 v[114:115], v5 offset:26624
  ds_read_b64_tr_b16 v[116:117], v5 offset:28672
  ds_read_b64_tr_b16 v[118:119], v5 offset:30720
  ds_read_b64_tr_b16 v[120:121], v6 offset:24576
  ds_read_b64_tr_b16 v[122:123], v6 offset:26624
  ds_read_b64_tr_b16 v[124:125], v6 offset:28672
  ds_read_b64_tr_b16 v[126:127], v6 offset:30720
  ds_read_b64_tr_b16 v[128:129], v7 offset:24576
  ds_read_b64_tr_b16 v[130:131], v7 offset:26624
  ds_read_b64_tr_b16 v[132:133], v7 offset:28672
  ds_read_b64_tr_b16 v[134:135], v7 offset:30720
  s_mov_b32 s42, 6303744
  s_waitcnt lgkmcnt(12)
  buffer_store_dwordx4 v[104:107], v3, s[4:7], s42 offen offset:0 sc1
  buffer_store_dwordx4 v[108:111], v3, s[4:7], s42 offen offset:1024 sc1
  s_mov_b32 s42, 6303744
  s_waitcnt lgkmcnt(8)
  buffer_store_dwordx4 v[112:115], v3, s[4:7], s42 offen offset:2048 sc1
  buffer_store_dwordx4 v[116:119], v3, s[4:7], s42 offen offset:3072 sc1
  s_mov_b32 s42, 6565888
  s_waitcnt lgkmcnt(4)
  buffer_store_dwordx4 v[120:123], v3, s[4:7], s42 offen offset:0 sc1
  buffer_store_dwordx4 v[124:127], v3, s[4:7], s42 offen offset:1024 sc1
  s_mov_b32 s42, 6565888
  s_waitcnt lgkmcnt(0)
  buffer_store_dwordx4 v[128:131], v3, s[4:7], s42 offen offset:2048 sc1
  buffer_store_dwordx4 v[132:135], v3, s[4:7], s42 offen offset:3072 sc1
  v_min_u32 v1, 31, v0
  v_lshlrev_b32 v1, 2, v1
  v_add_u32 v1, 128, v1
  s_nop 1
Lpoll_55:
  buffer_load_dword v2, v1, s[12:15], 0 offen sc1
  s_sub_u32 s24, s24, 1
  s_cbranch_scc1 L_FAIL
  s_waitcnt vmcnt(0)
  v_cmp_gt_i32 vcc, 1, v2
  s_cbranch_vccz Lpolld_56
  s_sleep 2
  s_branch Lpoll_55
Lpolld_56:
  s_barrier
  s_lshl_b32 s40, s21, 7
  s_add_u32 s40, s40, 1432576
  s_cmp_lg_u32 s20, 0
  s_cbranch_scc1 Lnosig_57
  s_mov_b32 s63, 1
  s_atomic_smax s63, s[4:5], s40 glc
Lnosig_57:
  s_branch L_LN1
L_QK:
  v_bfe_u32 v76, v0, 3, 2
  v_xor_b32 v76, s20, v76
  v_lshlrev_b32 v76, 5, v76
  v_lshrrev_b32 v4, 2, v0
  v_lshl_add_u32 v4, v4, 7, v76
  v_and_b32 v76, 3, v0
  v_lshl_add_u32 v4, v76, 3, v4
  s_lshl_b32 s40, s20, 15
  v_add_u32 v4, s40, v4
  v_lshl_add_u32 v85, v0, 4, s40
  s_lshl_b32 s40, s20, 12
  s_add_u32 s40, s40, 131072
  v_lshl_add_u32 v1, v0, 4, s40
  s_lshr_b32 s54, s21, 4
  s_lshl_b32 s52, s54, 22
  s_sub_u32 s53, 0, s52
  v_xor_b32 v5, 32768, v4
  v_xor_b32 v2, 4096, v1
  v_xor_b32 v6, 65536, v4
  v_xor_b32 v3, 8192, v1
  v_xor_b32 v7, 98304, v4
  v_xor_b32 v84, 12288, v1
  v_bfe_u32 v8, v0, 5, 1
  v_mul_u32_u24 v8, 16384, v8
  v_bfe_u32 v76, v0, 4, 1
  v_mul_u32_u24 v76, 32768, v76
  v_add_u32 v8, v8, v76
  v_bfe_u32 v76, v0, 3, 1
  v_mul_u32_u24 v76, 131072, v76
  v_add_u32 v8, v8, v76
  v_lshrrev_b32 v76, 3, v0
  v_and_b32 v76, 6, v76
  v_xor_b32 v76, v76, v0
  v_and_b32 v76, 7, v76
  v_lshl_add_u32 v8, v76, 4, v8
  s_lshl_b32 s40, s20, 19
  v_add_u32 v8, s40, v8
  s_lshl_b32 s44, s21, 8
  s_add_u32 s45, s44, 128
  s_load_dwordx2 s[8:9], s[0:1], 16
  s_mov_b32 s10, 8388608
  s_mov_b32 s11, 0x20000
  s_waitcnt lgkmcnt(0)
  v_add_u32 v9, s44, v8
  v_add_u32 v10, s45, v8
  v_add_u32 v11, s44, v8
  v_add_u32 v12, s45, v8
  s_lshl_b32 s41, s20, 15
  s_add_u32 m0, s41, 0
  s_add_u32 s42, s52, 0
  buffer_load_dwordx4 v9, s[8:11], s42 offen lds
  s_add_u32 m0, s41, 1024
  s_add_u32 s42, s52, 65536
  buffer_load_dwordx4 v9, s[8:11], s42 offen lds
  s_add_u32 m0, s41, 2048
  s_add_u32 s42, s52, 8192
  buffer_load_dwordx4 v9, s[8:11], s42 offen lds
  s_add_u32 m0, s41, 3072
  s_add_u32 s42, s52, 73728
  buffer_load_dwordx4 v9, s[8:11], s42 offen lds
  s_add_u32 m0, s41, 4096
  s_add_u32 s42, s52, 262144
  buffer_load_dwordx4 v9, s[8:11], s42 offen lds
  s_add_u32 m0, s41, 5120
  s_add_u32 s42, s52, 327680
  buffer_load_dwordx4 v9, s[8:11], s42 offen lds
  s_add_u32 m0, s41, 6144
  s_add_u32 s42, s52, 270336
  buffer_load_dwordx4 v9, s[8:11], s42 offen lds
  s_add_u32 m0, s41, 7168
  s_add_u32 s42, s52, 335872
  buffer_load_dwordx4 v9, s[8:11], s42 offen lds
  s_add_u32 m0, s41, 8192
  s_add_u32 s42, s52, 2097152
  buffer_load_dwordx4 v9, s[8:11], s42 offen lds
  s_add_u32 m0, s41, 9216
  s_add_u32 s42, s52, 2162688
  buffer_load_dwordx4 v9, s[8:11], s42 offen lds
  s_add_u32 m0, s41, 10240
  s_add_u32 s42, s52, 2105344
  buffer_load_dwordx4 v9, s[8:11], s42 offen lds
  s_add_u32 m0, s41, 11264
  s_add_u32 s42, s52, 2170880
  buffer_load_dwordx4 v9, s[8:11], s42 offen lds
  s_add_u32 m0, s41, 12288
  s_add_u32 s42, s52, 2359296
  buffer_load_dwordx4 v9, s[8:11], s42 offen lds
  s_add_u32 m0, s41, 13312
  s_add_u32 s42, s52, 2424832
  buffer_load_dwordx4 v9, s[8:11], s42 offen lds
  s_add_u32 m0, s41, 14336
  s_add_u32 s42, s52, 2367488
  buffer_load_dwordx4 v9, s[8:11], s42 offen lds
  s_add_u32 m0, s41, 15360
  s_add_u32 s42, s52, 2433024
  buffer_load_dwordx4 v9, s[8:11], s42 offen lds
  s_add_u32 m0, s41, 16384
  s_add_u32 s42, s53, 4194304
  buffer_load_dwordx4 v9, s[8:11], s42 offen lds
  s_add_u32 m0, s41, 17408
  s_add_u32 s42, s53, 4259840
  buffer_load_dwordx4 v9, s[8:11], s42 offen lds
  s_add_u32 m0, s41, 18432
  s_add_u32 s42, s53, 4202496
  buffer_load_dwordx4 v9, s[8:11], s42 offen lds
  s_add_u32 m0, s41, 19456
  s_add_u32 s42, s53, 4268032
  buffer_load_dwordx4 v9, s[8:11], s42 offen lds
  s_add_u32 m0, s41, 20480
  s_add_u32 s42, s53, 4456448
  buffer_load_dwordx4 v9, s[8:11], s42 offen lds
  s_add_u32 m0, s41, 21504
  s_add_u32 s42, s53, 4521984
  buffer_load_dwordx4 v9, s[8:11], s42 offen lds
  s_add_u32 m0, s41, 22528
  s_add_u32 s42, s53, 4464640
  buffer_load_dwordx4 v9, s[8:11], s42 offen lds
  s_add_u32 m0, s41, 23552
  s_add_u32 s42, s53, 4530176
  buffer_load_dwordx4 v9, s[8:11], s42 offen lds
  s_waitcnt vmcnt(16) lgkmcnt(0)
  s_barrier
  s_add_u32 m0, s41, 24576
  s_add_u32 s42, s53, 6291456
  buffer_load_dwordx4 v9, s[8:11], s42 offen lds
  s_add_u32 m0, s41, 25600
  s_add_u32 s42, s53, 6356992
  buffer_load_dwordx4 v9, s[8:11], s42 offen lds
  s_add_u32 m0, s41, 26624
  s_add_u32 s42, s53, 6299648
  buffer_load_dwordx4 v9, s[8:11], s42 offen lds
  s_add_u32 m0, s41, 27648
  s_add_u32 s42, s53, 6365184
  buffer_load_dwordx4 v9, s[8:11], s42 offen lds
  s_add_u32 m0, s41, 28672
  s_add_u32 s42, s53, 6553600
  buffer_load_dwordx4 v9, s[8:11], s42 offen lds
  s_add_u32 m0, s41, 29696
  s_add_u32 s42, s53, 6619136
  buffer_load_dwordx4 v9, s[8:11], s42 offen lds
  s_add_u32 m0, s41, 30720
  s_add_u32 s42, s53, 6561792
  buffer_load_dwordx4 v9, s[8:11], s42 offen lds
  s_add_u32 m0, s41, 31744
  s_add_u32 s42, s53, 6627328
  buffer_load_dwordx4 v9, s[8:11], s42 offen lds
  ds_read_b64_tr_b16 a[0:1], v4 offset:0
  ds_read_b64_tr_b16 a[2:3], v4 offset:2048
  ds_read_b64_tr_b16 a[4:5], v4 offset:4096
  ds_read_b64_tr_b16 a[6:7], v4 offset:6144
  ds_read_b64_tr_b16 a[16:17], v5 offset:0
  ds_read_b64_tr_b16 a[18:19], v5 offset:2048
  ds_read_b64_tr_b16 a[20:21], v5 offset:4096
  ds_read_b64_tr_b16 a[22:23], v5 offset:6144
  ds_read_b64_tr_b16 a[32:33], v6 offset:0
  ds_read_b64_tr_b16 a[34:35], v6 offset:2048
  ds_read_b64_tr_b16 a[36:37], v6 offset:4096
  ds_read_b64_tr_b16 a[38:39], v6 offset:6144
  ds_read_b64_tr_b16 a[48:49], v7 offset:0
  ds_read_b64_tr_b16 a[50:51], v7 offset:2048
  ds_read_b64_tr_b16 a[52:53], v7 offset:4096
  ds_read_b64_tr_b16 a[54:55], v7 offset:6144
  s_waitcnt vmcnt(16) lgkmcnt(0)
  s_barrier
  s_add_u32 m0, s41, 0
  s_add_u32 s42, s52, 0
  buffer_load_dwordx4 v10, s[8:11], s42 offen lds
  s_add_u32 m0, s41, 1024
  s_add_u32 s42, s52, 65536
  buffer_load_dwordx4 v10, s[8:11], s42 offen lds
  s_add_u32 m0, s41, 2048
  s_add_u32 s42, s52, 8192
  buffer_load_dwordx4 v10, s[8:11], s42 offen lds
  s_add_u32 m0, s41, 3072
  s_add_u32 s42, s52, 73728
  buffer_load_dwordx4 v10, s[8:11], s42 offen lds
  s_add_u32 m0, s41, 4096
  s_add_u32 s42, s52, 262144
  buffer_load_dwordx4 v10, s[8:11], s42 offen lds
  s_add_u32 m0, s41, 5120
  s_add_u32 s42, s52, 327680
  buffer_load_dwordx4 v10, s[8:11], s42 offen lds
  s_add_u32 m0, s41, 6144
  s_add_u32 s42, s52, 270336
  buffer_load_dwordx4 v10, s[8:11], s42 offen lds
  s_add_u32 m0, s41, 7168
  s_add_u32 s42, s52, 335872
  buffer_load_dwordx4 v10, s[8:11], s42 offen lds
  ds_read_b64_tr_b16 a[8:9], v4 offset:8192
  ds_read_b64_tr_b16 a[10:11], v4 offset:10240
  ds_read_b64_tr_b16 a[12:13], v4 offset:12288
  ds_read_b64_tr_b16 a[14:15], v4 offset:14336
  ds_read_b64_tr_b16 a[24:25], v5 offset:8192
  ds_read_b64_tr_b16 a[26:27], v5 offset:10240
  ds_read_b64_tr_b16 a[28:29], v5 offset:12288
  ds_read_b64_tr_b16 a[30:31], v5 offset:14336
  ds_read_b64_tr_b16 a[40:41], v6 offset:8192
  ds_read_b64_tr_b16 a[42:43], v6 offset:10240
  ds_read_b64_tr_b16 a[44:45], v6 offset:12288
  ds_read_b64_tr_b16 a[46:47], v6 offset:14336
  ds_read_b64_tr_b16 a[56:57], v7 offset:8192
  ds_read_b64_tr_b16 a[58:59], v7 offset:10240
  ds_read_b64_tr_b16 a[60:61], v7 offset:12288
  ds_read_b64_tr_b16 a[62:63], v7 offset:14336
  s_waitcnt vmcnt(16) lgkmcnt(0)
  s_barrier
  s_add_u32 m0, s41, 8192
  s_add_u32 s42, s52, 2097152
  buffer_load_dwordx4 v10, s[8:11], s42 offen lds
  s_add_u32 m0, s41, 9216
  s_add_u32 s42, s52, 2162688
  buffer_load_dwordx4 v10, s[8:11], s42 offen lds
  s_add_u32 m0, s41, 10240
  s_add_u32 s42, s52, 2105344
  buffer_load_dwordx4 v10, s[8:11], s42 offen lds
  s_add_u32 m0, s41, 11264
  s_add_u32 s42, s52, 2170880
  buffer_load_dwordx4 v10, s[8:11], s42 offen lds
  s_add_u32 m0, s41, 12288
  s_add_u32 s42, s52, 2359296
  buffer_load_dwordx4 v10, s[8:11], s42 offen lds
  s_add_u32 m0, s41, 13312
  s_add_u32 s42, s52, 2424832
  buffer_load_dwordx4 v10, s[8:11], s42 offen lds
  s_add_u32 m0, s41, 14336
  s_add_u32 s42, s52, 2367488
  buffer_load_dwordx4 v10, s[8:11], s42 offen lds
  s_add_u32 m0, s41, 15360
  s_add_u32 s42, s52, 2433024
  buffer_load_dwordx4 v10, s[8:11], s42 offen lds
  ds_read_b64_tr_b16 a[64:65], v4 offset:16384
  ds_read_b64_tr_b16 a[66:67], v4 offset:18432
  ds_read_b64_tr_b16 a[68:69], v4 offset:20480
  ds_read_b64_tr_b16 a[70:71], v4 offset:22528
  ds_read_b64_tr_b16 a[80:81], v5 offset:16384
  ds_read_b64_tr_b16 a[82:83], v5 offset:18432
  ds_read_b64_tr_b16 a[84:85], v5 offset:20480
  ds_read_b64_tr_b16 a[86:87], v5 offset:22528
  ds_read_b64_tr_b16 a[96:97], v6 offset:16384
  ds_read_b64_tr_b16 a[98:99], v6 offset:18432
  ds_read_b64_tr_b16 a[100:101], v6 offset:20480
  ds_read_b64_tr_b16 a[102:103], v6 offset:22528
  ds_read_b64_tr_b16 a[112:113], v7 offset:16384
  ds_read_b64_tr_b16 a[114:115], v7 offset:18432
  ds_read_b64_tr_b16 a[116:117], v7 offset:20480
  ds_read_b64_tr_b16 a[118:119], v7 offset:22528
  s_waitcnt vmcnt(16) lgkmcnt(0)
  s_barrier
  s_add_u32 m0, s41, 16384
  s_add_u32 s42, s53, 4194304
  buffer_load_dwordx4 v10, s[8:11], s42 offen lds
  s_add_u32 m0, s41, 17408
  s_add_u32 s42, s53, 4259840
  buffer_load_dwordx4 v10, s[8:11], s42 offen lds
  s_add_u32 m0, s41, 18432
  s_add_u32 s42, s53, 4202496
  buffer_load_dwordx4 v10, s[8:11], s42 offen lds
  s_add_u32 m0, s41, 19456
  s_add_u32 s42, s53, 4268032
  buffer_load_dwordx4 v10, s[8:11], s42 offen lds
  s_add_u32 m0, s41, 20480
  s_add_u32 s42, s53, 4456448
  buffer_load_dwordx4 v10, s[8:11], s42 offen lds
  s_add_u32 m0, s41, 21504
  s_add_u32 s42, s53, 4521984
  buffer_load_dwordx4 v10, s[8:11], s42 offen lds
  s_add_u32 m0, s41, 22528
  s_add_u32 s42, s53, 4464640
  buffer_load_dwordx4 v10, s[8:11], s42 offen lds
  s_add_u32 m0, s41, 23552
  s_add_u32 s42, s53, 4530176
  buffer_load_dwordx4 v10, s[8:11], s42 offen lds
  ds_read_b64_tr_b16 a[72:73], v4 offset:24576
  ds_read_b64_tr_b16 a[74:75], v4 offset:26624
  ds_read_b64_tr_b16 a[76:77], v4 offset:28672
  ds_read_b64_tr_b16 a[78:79], v4 offset:30720
  ds_read_b64_tr_b16 a[88:89], v5 offset:24576
  ds_read_b64_tr_b16 a[90:91], v5 offset:26624
  ds_read_b64_tr_b16 a[92:93], v5 offset:28672
  ds_read_b64_tr_b16 a[94:95], v5 offset:30720
  ds_read_b64_tr_b16 a[104:105], v6 offset:24576
  ds_read_b64_tr_b16 a[106:107], v6 offset:26624
  ds_read_b64_tr_b16 a[108:109], v6 offset:28672
  ds_read_b64_tr_b16 a[110:111], v6 offset:30720
  ds_read_b64_tr_b16 a[120:121], v7 offset:24576
  ds_read_b64_tr_b16 a[122:123], v7 offset:26624
  ds_read_b64_tr_b16 a[124:125], v7 offset:28672
  ds_read_b64_tr_b16 a[126:127], v7 offset:30720
  s_waitcnt vmcnt(16) lgkmcnt(0)
  s_barrier
  s_add_u32 m0, s41, 24576
  s_add_u32 s42, s53, 6291456
  buffer_load_dwordx4 v10, s[8:11], s42 offen lds
  s_add_u32 m0, s41, 25600
  s_add_u32 s42, s53, 6356992
  buffer_load_dwordx4 v10, s[8:11], s42 offen lds
  s_add_u32 m0, s41, 26624
  s_add_u32 s42, s53, 6299648
  buffer_load_dwordx4 v10, s[8:11], s42 offen lds
  s_add_u32 m0, s41, 27648
  s_add_u32 s42, s53, 6365184
  buffer_load_dwordx4 v10, s[8:11], s42 offen lds
  s_add_u32 m0, s41, 28672
  s_add_u32 s42, s53, 6553600
  buffer_load_dwordx4 v10, s[8:11], s42 offen lds
  s_add_u32 m0, s41, 29696
  s_add_u32 s42, s53, 6619136
  buffer_load_dwordx4 v10, s[8:11], s42 offen lds
  s_add_u32 m0, s41, 30720
  s_add_u32 s42, s53, 6561792
  buffer_load_dwordx4 v10, s[8:11], s42 offen lds
  s_add_u32 m0, s41, 31744
  s_add_u32 s42, s53, 6627328
  buffer_load_dwordx4 v10, s[8:11], s42 offen lds
  ds_read_b64_tr_b16 a[128:129], v4 offset:0
  ds_read_b64_tr_b16 a[130:131], v4 offset:2048
  ds_read_b64_tr_b16 a[132:133], v4 offset:4096
  ds_read_b64_tr_b16 a[134:135], v4 offset:6144
  ds_read_b64_tr_b16 a[144:145], v5 offset:0
  ds_read_b64_tr_b16 a[146:147], v5 offset:2048
  ds_read_b64_tr_b16 a[148:149], v5 offset:4096
  ds_read_b64_tr_b16 a[150:151], v5 offset:6144
  ds_read_b64_tr_b16 a[160:161], v6 offset:0
  ds_read_b64_tr_b16 a[162:163], v6 offset:2048
  ds_read_b64_tr_b16 a[164:165], v6 offset:4096
  ds_read_b64_tr_b16 a[166:167], v6 offset:6144
  ds_read_b64_tr_b16 a[176:177], v7 offset:0
  ds_read_b64_tr_b16 a[178:179], v7 offset:2048
  ds_read_b64_tr_b16 a[180:181], v7 offset:4096
  ds_read_b64_tr_b16 a[182:183], v7 offset:6144
  s_waitcnt vmcnt(16) lgkmcnt(0)
  s_barrier
  s_load_dwordx2 s[8:9], s[0:1], 24
  s_mov_b32 s10, 8388608
  s_mov_b32 s11, 0x20000
  s_waitcnt lgkmcnt(0)
  s_add_u32 m0, s41, 0
  s_add_u32 s42, s52, 0
  buffer_load_dwordx4 v11, s[8:11], s42 offen lds
  s_add_u32 m0, s41, 1024
  s_add_u32 s42, s52, 65536
  buffer_load_dwordx4 v11, s[8:11], s42 offen lds
  s_add_u32 m0, s41, 2048
  s_add_u32 s42, s52, 8192
  buffer_load_dwordx4 v11, s[8:11], s42 offen lds
  s_add_u32 m0, s41, 3072
  s_add_u32 s42, s52, 73728
  buffer_load_dwordx4 v11, s[8:11], s42 offen lds
  s_add_u32 m0, s41, 4096
  s_add_u32 s42, s52, 262144
  buffer_load_dwordx4 v11, s[8:11], s42 offen lds
  s_add_u32 m0, s41, 5120
  s_add_u32 s42, s52, 327680
  buffer_load_dwordx4 v11, s[8:11], s42 offen lds
  s_add_u32 m0, s41, 6144
  s_add_u32 s42, s52, 270336
  buffer_load_dwordx4 v11, s[8:11], s42 offen lds
  s_add_u32 m0, s41, 7168
  s_add_u32 s42, s52, 335872
  buffer_load_dwordx4 v11, s[8:11], s42 offen lds
  ds_read_b64_tr_b16 a[136:137], v4 offset:8192
  ds_read_b64_tr_b16 a[138:139], v4 offset:10240
  ds_read_b64_tr_b16 a[140:141], v4 offset:12288
  ds_read_b64_tr_b16 a[142:143], v4 offset:14336
  ds_read_b64_tr_b16 a[152:153], v5 offset:8192
  ds_read_b64_tr_b16 a[154:155], v5 offset:10240
  ds_read_b64_tr_b16 a[156:157], v5 offset:12288
  ds_read_b64_tr_b16 a[158:159], v5 offset:14336
  ds_read_b64_tr_b16 a[168:169], v6 offset:8192
  ds_read_b64_tr_b16 a[170:171], v6 offset:10240
  ds_read_b64_tr_b16 a[172:173], v6 offset:12288
  ds_read_b64_tr_b16 a[174:175], v6 offset:14336
  ds_read_b64_tr_b16 a[184:185], v7 offset:8192
  ds_read_b64_tr_b16 a[186:187], v7 offset:10240
  ds_read_b64_tr_b16 a[188:189], v7 offset:12288
  ds_read_b64_tr_b16 a[190:191], v7 offset:14336
  s_waitcnt vmcnt(16) lgkmcnt(0)
  s_barrier
  s_add_u32 m0, s41, 8192
  s_add_u32 s42, s52, 2097152
  buffer_load_dwordx4 v11, s[8:11], s42 offen lds
  s_add_u32 m0, s41, 9216
  s_add_u32 s42, s52, 2162688
  buffer_load_dwordx4 v11, s[8:11], s42 offen lds
  s_add_u32 m0, s41, 10240
  s_add_u32 s42, s52, 2105344
  buffer_load_dwordx4 v11, s[8:11], s42 offen lds
  s_add_u32 m0, s41, 11264
  s_add_u32 s42, s52, 2170880
  buffer_load_dwordx4 v11, s[8:11], s42 offen lds
  s_add_u32 m0, s41, 12288
  s_add_u32 s42, s52, 2359296
  buffer_load_dwordx4 v11, s[8:11], s42 offen lds
  s_add_u32 m0, s41, 13312
  s_add_u32 s42, s52, 2424832
  buffer_load_dwordx4 v11, s[8:11], s42 offen lds
  s_add_u32 m0, s41, 14336
  s_add_u32 s42, s52, 2367488
  buffer_load_dwordx4 v11, s[8:11], s42 offen lds
  s_add_u32 m0, s41, 15360
  s_add_u32 s42, s52, 2433024
  buffer_load_dwordx4 v11, s[8:11], s42 offen lds
  ds_read_b64_tr_b16 a[192:193], v4 offset:16384
  ds_read_b64_tr_b16 a[194:195], v4 offset:18432
  ds_read_b64_tr_b16 a[196:197], v4 offset:20480
  ds_read_b64_tr_b16 a[198:199], v4 offset:22528
  ds_read_b64_tr_b16 a[208:209], v5 offset:16384
  ds_read_b64_tr_b16 a[210:211], v5 offset:18432
  ds_read_b64_tr_b16 a[212:213], v5 offset:20480
  ds_read_b64_tr_b16 a[214:215], v5 offset:22528
  ds_read_b64_tr_b16 a[224:225], v6 offset:16384
  ds_read_b64_tr_b16 a[226:227], v6 offset:18432
  ds_read_b64_tr_b16 a[228:229], v6 offset:20480
  ds_read_b64_tr_b16 a[230:231], v6 offset:22528
  ds_read_b64_tr_b16 a[240:241], v7 offset:16384
  ds_read_b64_tr_b16 a[242:243], v7 offset:18432
  ds_read_b64_tr_b16 a[244:245], v7 offset:20480
  ds_read_b64_tr_b16 a[246:247], v7 offset:22528
  s_waitcnt vmcnt(16) lgkmcnt(0)
  s_barrier
  s_add_u32 m0, s41, 16384
  s_add_u32 s42, s53, 4194304
  buffer_load_dwordx4 v11, s[8:11], s42 offen lds
  s_add_u32 m0, s41, 17408
  s_add_u32 s42, s53, 4259840
  buffer_load_dwordx4 v11, s[8:11], s42 offen lds
  s_add_u32 m0, s41, 18432
  s_add_u32 s42, s53, 4202496
  buffer_load_dwordx4 v11, s[8:11], s42 offen lds
  s_add_u32 m0, s41, 19456
  s_add_u32 s42, s53, 4268032
  buffer_load_dwordx4 v11, s[8:11], s42 offen lds
  s_add_u32 m0, s41, 20480
  s_add_u32 s42, s53, 4456448
  buffer_load_dwordx4 v11, s[8:11], s42 offen lds
  s_add_u32 m0, s41, 21504
  s_add_u32 s42, s53, 4521984
  buffer_load_dwordx4 v11, s[8:11], s42 offen lds
  s_add_u32 m0, s41, 22528
  s_add_u32 s42, s53, 4464640
  buffer_load_dwordx4 v11, s[8:11], s42 offen lds
  s_add_u32 m0, s41, 23552
  s_add_u32 s42, s53, 4530176
  buffer_load_dwordx4 v11, s[8:11], s42 offen lds
  ds_read_b64_tr_b16 a[200:201], v4 offset:24576
  ds_read_b64_tr_b16 a[202:203], v4 offset:26624
  ds_read_b64_tr_b16 a[204:205], v4 offset:28672
  ds_read_b64_tr_b16 a[206:207], v4 offset:30720
  ds_read_b64_tr_b16 a[216:217], v5 offset:24576
  ds_read_b64_tr_b16 a[218:219], v5 offset:26624
  ds_read_b64_tr_b16 a[220:221], v5 offset:28672
  ds_read_b64_tr_b16 a[222:223], v5 offset:30720
  ds_read_b64_tr_b16 a[232:233], v6 offset:24576
  ds_read_b64_tr_b16 a[234:235], v6 offset:26624
  ds_read_b64_tr_b16 a[236:237], v6 offset:28672
  ds_read_b64_tr_b16 a[238:239], v6 offset:30720
  ds_read_b64_tr_b16 a[248:249], v7 offset:24576
  ds_read_b64_tr_b16 a[250:251], v7 offset:26624
  ds_read_b64_tr_b16 a[252:253], v7 offset:28672
  ds_read_b64_tr_b16 a[254:255], v7 offset:30720
  s_waitcnt vmcnt(16) lgkmcnt(0)
  s_barrier
  s_add_u32 m0, s41, 24576
  s_add_u32 s42, s53, 6291456
  buffer_load_dwordx4 v11, s[8:11], s42 offen lds
  s_add_u32 m0, s41, 25600
  s_add_u32 s42, s53, 6356992
  buffer_load_dwordx4 v11, s[8:11], s42 offen lds
  s_add_u32 m0, s41, 26624
  s_add_u32 s42, s53, 6299648
  buffer_load_dwordx4 v11, s[8:11], s42 offen lds
  s_add_u32 m0, s41, 27648
  s_add_u32 s42, s53, 6365184
  buffer_load_dwordx4 v11, s[8:11], s42 offen lds
  s_add_u32 m0, s41, 28672
  s_add_u32 s42, s53, 6553600
  buffer_load_dwordx4 v11, s[8:11], s42 offen lds
  s_add_u32 m0, s41, 29696
  s_add_u32 s42, s53, 6619136
  buffer_load_dwordx4 v11, s[8:11], s42 offen lds
  s_add_u32 m0, s41, 30720
  s_add_u32 s42, s53, 6561792
  buffer_load_dwordx4 v11, s[8:11], s42 offen lds
  s_add_u32 m0, s41, 31744
  s_add_u32 s42, s53, 6627328
  buffer_load_dwordx4 v11, s[8:11], s42 offen lds
  ds_read_b64_tr_b16 v[128:129], v4 offset:0
  ds_read_b64_tr_b16 v[130:131], v4 offset:2048
  ds_read_b64_tr_b16 v[132:133], v4 offset:4096
  ds_read_b64_tr_b16 v[134:135], v4 offset:6144
  ds_read_b64_tr_b16 v[144:145], v5 offset:0
  ds_read_b64_tr_b16 v[146:147], v5 offset:2048
  ds_read_b64_tr_b16 v[148:149], v5 offset:4096
  ds_read_b64_tr_b16 v[150:151], v5 offset:6144
  ds_read_b64_tr_b16 v[160:161], v6 offset:0
  ds_read_b64_tr_b16 v[162:163], v6 offset:2048
  ds_read_b64_tr_b16 v[164:165], v6 offset:4096
  ds_read_b64_tr_b16 v[166:167], v6 offset:6144
  ds_read_b64_tr_b16 v[176:177], v7 offset:0
  ds_read_b64_tr_b16 v[178:179], v7 offset:2048
  ds_read_b64_tr_b16 v[180:181], v7 offset:4096
  ds_read_b64_tr_b16 v[182:183], v7 offset:6144
  s_waitcnt vmcnt(16) lgkmcnt(0)
  s_barrier
  s_add_u32 m0, s41, 0
  s_add_u32 s42, s52, 0
  buffer_load_dwordx4 v12, s[8:11], s42 offen lds
  s_add_u32 m0, s41, 1024
  s_add_u32 s42, s52, 65536
  buffer_load_dwordx4 v12, s[8:11], s42 offen lds
  s_add_u32 m0, s41, 2048
  s_add_u32 s42, s52, 8192
  buffer_load_dwordx4 v12, s[8:11], s42 offen lds
  s_add_u32 m0, s41, 3072
  s_add_u32 s42, s52, 73728
  buffer_load_dwordx4 v12, s[8:11], s42 offen lds
  s_add_u32 m0, s41, 4096
  s_add_u32 s42, s52, 262144
  buffer_load_dwordx4 v12, s[8:11], s42 offen lds
  s_add_u32 m0, s41, 5120
  s_add_u32 s42, s52, 327680
  buffer_load_dwordx4 v12, s[8:11], s42 offen lds
  s_add_u32 m0, s41, 6144
  s_add_u32 s42, s52, 270336
  buffer_load_dwordx4 v12, s[8:11], s42 offen lds
  s_add_u32 m0, s41, 7168
  s_add_u32 s42, s52, 335872
  buffer_load_dwordx4 v12, s[8:11], s42 offen lds
  ds_read_b64_tr_b16 v[136:137], v4 offset:8192
  ds_read_b64_tr_b16 v[138:139], v4 offset:10240
  ds_read_b64_tr_b16 v[140:141], v4 offset:12288
  ds_read_b64_tr_b16 v[142:143], v4 offset:14336
  ds_read_b64_tr_b16 v[152:153], v5 offset:8192
  ds_read_b64_tr_b16 v[154:155], v5 offset:10240
  ds_read_b64_tr_b16 v[156:157], v5 offset:12288
  ds_read_b64_tr_b16 v[158:159], v5 offset:14336
  ds_read_b64_tr_b16 v[168:169], v6 offset:8192
  ds_read_b64_tr_b16 v[170:171], v6 offset:10240
  ds_read_b64_tr_b16 v[172:173], v6 offset:12288
  ds_read_b64_tr_b16 v[174:175], v6 offset:14336
  ds_read_b64_tr_b16 v[184:185], v7 offset:8192
  ds_read_b64_tr_b16 v[186:187], v7 offset:10240
  ds_read_b64_tr_b16 v[188:189], v7 offset:12288
  ds_read_b64_tr_b16 v[190:191], v7 offset:14336
  s_cmp_lg_u32 s20, 0
  s_cbranch_scc1 Lchore_58
Lini_59:
  s_load_dwordx16 s[64:79], s[12:13], 128 glc
  s_load_dwordx16 s[80:95], s[12:13], 192 glc
  s_sub_u32 s24, s24, 1
  s_cbranch_scc1 L_FAIL
  s_waitcnt lgkmcnt(0)
  s_and_b64 s[64:65], s[64:65], s[66:67]
  s_and_b64 s[64:65], s[64:65], s[68:69]
  s_and_b64 s[64:65], s[64:65], s[70:71]
  s_and_b64 s[64:65], s[64:65], s[72:73]
  s_and_b64 s[64:65], s[64:65], s[74:75]
  s_and_b64 s[64:65], s[64:65], s[76:77]
  s_and_b64 s[64:65], s[64:65], s[78:79]
  s_and_b64 s[64:65], s[64:65], s[80:81]
  s_and_b64 s[64:65], s[64:65], s[82:83]
  s_and_b64 s[64:65], s[64:65], s[84:85]
  s_and_b64 s[64:65], s[64:65], s[86:87]
  s_and_b64 s[64:65], s[64:65], s[88:89]
  s_and_b64 s[64:65], s[64:65], s[90:91]
  s_and_b64 s[64:65], s[64:65], s[92:93]
  s_and_b64 s[64:65], s[64:65], s[94:95]
  s_and_b32 s64, s64, s65
  s_cbranch_scc0 Lini_59
  s_mov_b32 s46, 0xffff
  s_and_b32 s40, s21, 3
  s_lshl_b32 s40, s40, 13
  s_lshr_b32 s43, s21, 2
  s_lshl_b32 s43, s43, 10
  s_add_u32 s43, s43, s40
  s_add_u32 s43, s43, 1343488
  s_waitcnt lgkmcnt(0)
  s_memtime s[64:65]
  s_waitcnt lgkmcnt(0)
  s_load_dword s68, s[4:5], s43 glc
  s_waitcnt lgkmcnt(0)
  s_memtime s[66:67]
  s_waitcnt lgkmcnt(0)
  s_sub_u32 s64, s66, s64
  s_min_u32 s46, s46, s64
Lchore_58:
  s_waitcnt vmcnt(16) lgkmcnt(0)
  s_barrier
  s_add_u32 m0, s41, 8192
  s_add_u32 s42, s52, 2097152
  buffer_load_dwordx4 v12, s[8:11], s42 offen lds
  s_add_u32 m0, s41, 9216
  s_add_u32 s42, s52, 2162688
  buffer_load_dwordx4 v12, s[8:11], s42 offen lds
  s_add_u32 m0, s41, 10240
  s_add_u32 s42, s52, 2105344
  buffer_load_dwordx4 v12, s[8:11], s42 offen lds
  s_add_u32 m0, s41, 11264
  s_add_u32 s42, s52, 2170880
  buffer_load_dwordx4 v12, s[8:11], s42 offen lds
  s_add_u32 m0, s41, 12288
  s_add_u32 s42, s52, 2359296
  buffer_load_dwordx4 v12, s[8:11], s42 offen lds
  s_add_u32 m0, s41, 13312
  s_add_u32 s42, s52, 2424832
  buffer_load_dwordx4 v12, s[8:11], s42 offen lds
  s_add_u32 m0, s41, 14336
  s_add_u32 s42, s52, 2367488
  buffer_load_dwordx4 v12, s[8:11], s42 offen lds
  s_add_u32 m0, s41, 15360
  s_add_u32 s42, s52, 2433024
  buffer_load_dwordx4 v12, s[8:11], s42 offen lds
  ds_read_b64_tr_b16 v[192:193], v4 offset:16384
  ds_read_b64_tr_b16 v[194:195], v4 offset:18432
  ds_read_b64_tr_b16 v[196:197], v4 offset:20480
  ds_read_b64_tr_b16 v[198:199], v4 offset:22528
  ds_read_b64_tr_b16 v[208:209], v5 offset:16384
  ds_read_b64_tr_b16 v[210:211], v5 offset:18432
  ds_read_b64_tr_b16 v[212:213], v5 offset:20480
  ds_read_b64_tr_b16 v[214:215], v5 offset:22528
  ds_read_b64_tr_b16 v[224:225], v6 offset:16384
  ds_read_b64_tr_b16 v[226:227], v6 offset:18432
  ds_read_b64_tr_b16 v[228:229], v6 offset:20480
  ds_read_b64_tr_b16 v[230:231], v6 offset:22528
  ds_read_b64_tr_b16 v[240:241], v7 offset:16384
  ds_read_b64_tr_b16 v[242:243], v7 offset:18432
  ds_read_b64_tr_b16 v[244:245], v7 offset:20480
  ds_read_b64_tr_b16 v[246:247], v7 offset:22528
  s_cmp_lg_u32 s20, 0
  s_cbranch_scc1 Lchore_60
  s_waitcnt lgkmcnt(0)
  s_memtime s[64:65]
  s_waitcnt lgkmcnt(0)
  s_load_dword s68, s[4:5], s43 glc
  s_waitcnt lgkmcnt(0)
  s_memtime s[66:67]
  s_waitcnt lgkmcnt(0)
  s_sub_u32 s64, s66, s64
  s_min_u32 s46, s46, s64
  s_getreg_b32 s55, hwreg(HW_REG_XCC_ID)
  s_and_b32 s55, s55, 15
  s_lshl_b32 s46, s46, 8
  s_or_b32 s46, s46, s55
  s_add_u32 s40, s21, 0
  s_lshl_b32 s40, s40, 7
  s_add_u32 s40, s40, 1424384
  s_mov_b32 s63, s46
  s_atomic_smax s63, s[4:5], s40 glc
Lnosig_61:
Lchore_60:
  s_waitcnt vmcnt(16) lgkmcnt(0)
  s_barrier
  s_add_u32 m0, s41, 16384
  s_add_u32 s42, s53, 4194304
  buffer_load_dwordx4 v12, s[8:11], s42 offen lds
  s_add_u32 m0, s41, 17408
  s_add_u32 s42, s53, 4259840
  buffer_load_dwordx4 v12, s[8:11], s42 offen lds
  s_add_u32 m0, s41, 18432
  s_add_u32 s42, s53, 4202496
  buffer_load_dwordx4 v12, s[8:11], s42 offen lds
  s_add_u32 m0, s41, 19456
  s_add_u32 s42, s53, 4268032
  buffer_load_dwordx4 v12, s[8:11], s42 offen lds
  s_add_u32 m0, s41, 20480
  s_add_u32 s42, s53, 4456448
  buffer_load_dwordx4 v12, s[8:11], s42 offen lds
  s_add_u32 m0, s41, 21504
  s_add_u32 s42, s53, 4521984
  buffer_load_dwordx4 v12, s[8:11], s42 offen lds
  s_add_u32 m0, s41, 22528
  s_add_u32 s42, s53, 4464640
  buffer_load_dwordx4 v12, s[8:11], s42 offen lds
  s_add_u32 m0, s41, 23552
  s_add_u32 s42, s53, 4530176
  buffer_load_dwordx4 v12, s[8:11], s42 offen lds
  ds_read_b64_tr_b16 v[200:201], v4 offset:24576
  ds_read_b64_tr_b16 v[202:203], v4 offset:26624
  ds_read_b64_tr_b16 v[204:205], v4 offset:28672
  ds_read_b64_tr_b16 v[206:207], v4 offset:30720
  ds_read_b64_tr_b16 v[216:217], v5 offset:24576
  ds_read_b64_tr_b16 v[218:219], v5 offset:26624
  ds_read_b64_tr_b16 v[220:221], v5 offset:28672
  ds_read_b64_tr_b16 v[222:223], v5 offset:30720
  ds_read_b64_tr_b16 v[232:233], v6 offset:24576
  ds_read_b64_tr_b16 v[234:235], v6 offset:26624
  ds_read_b64_tr_b16 v[236:237], v6 offset:28672
  ds_read_b64_tr_b16 v[238:239], v6 offset:30720
  ds_read_b64_tr_b16 v[248:249], v7 offset:24576
  ds_read_b64_tr_b16 v[250:251], v7 offset:26624
  ds_read_b64_tr_b16 v[252:253], v7 offset:28672
  ds_read_b64_tr_b16 v[254:255], v7 offset:30720
  s_waitcnt vmcnt(16) lgkmcnt(0)
  s_barrier
  s_add_u32 m0, s41, 24576
  s_add_u32 s42, s53, 6291456
  buffer_load_dwordx4 v12, s[8:11], s42 offen lds
  s_add_u32 m0, s41, 25600
  s_add_u32 s42, s53, 6356992
  buffer_load_dwordx4 v12, s[8:11], s42 offen lds
  s_add_u32 m0, s41, 26624
  s_add_u32 s42, s53, 6299648
  buffer_load_dwordx4 v12, s[8:11], s42 offen lds
  s_add_u32 m0, s41, 27648
  s_add_u32 s42, s53, 6365184
  buffer_load_dwordx4 v12, s[8:11], s42 offen lds
  s_add_u32 m0, s41, 28672
  s_add_u32 s42, s53, 6553600
  buffer_load_dwordx4 v12, s[8:11], s42 offen lds
  s_add_u32 m0, s41, 29696
  s_add_u32 s42, s53, 6619136
  buffer_load_dwordx4 v12, s[8:11], s42 offen lds
  s_add_u32 m0, s41, 30720
  s_add_u32 s42, s53, 6561792
  buffer_load_dwordx4 v12, s[8:11], s42 offen lds
  s_add_u32 m0, s41, 31744
  s_add_u32 s42, s53, 6627328
  buffer_load_dwordx4 v12, s[8:11], s42 offen lds
  ds_read_b64_tr_b16 v[20:21], v4 offset:0
  ds_read_b64_tr_b16 v[22:23], v4 offset:2048
  ds_read_b64_tr_b16 v[24:25], v4 offset:4096
  ds_read_b64_tr_b16 v[26:27], v4 offset:6144
  ds_read_b64_tr_b16 v[28:29], v5 offset:0
  ds_read_b64_tr_b16 v[30:31], v5 offset:2048
  ds_read_b64_tr_b16 v[32:33], v5 offset:4096
  ds_read_b64_tr_b16 v[34:35], v5 offset:6144
  ds_read_b64_tr_b16 v[36:37], v6 offset:0
  ds_read_b64_tr_b16 v[38:39], v6 offset:2048
  ds_read_b64_tr_b16 v[40:41], v6 offset:4096
  ds_read_b64_tr_b16 v[42:43], v6 offset:6144
  ds_read_b64_tr_b16 v[44:45], v7 offset:0
  ds_read_b64_tr_b16 v[46:47], v7 offset:2048
  ds_read_b64_tr_b16 v[48:49], v7 offset:4096
  ds_read_b64_tr_b16 v[50:51], v7 offset:6144
  s_waitcnt lgkmcnt(0)
  s_barrier
  ds_write_b128 v85, v[20:23] offset:0
  ds_write_b128 v85, v[24:27] offset:1024
  ds_write_b128 v85, v[28:31] offset:2048
  ds_write_b128 v85, v[32:35] offset:3072
  ds_write_b128 v85, v[36:39] offset:4096
  ds_write_b128 v85, v[40:43] offset:5120
  ds_write_b128 v85, v[44:47] offset:6144
  ds_write_b128 v85, v[48:51] offset:7168
  s_waitcnt vmcnt(16) lgkmcnt(0)
  s_barrier
  ds_read_b64_tr_b16 v[20:21], v4 offset:8192
  ds_read_b64_tr_b16 v[22:23], v4 offset:10240
  ds_read_b64_tr_b16 v[24:25], v4 offset:12288
  ds_read_b64_tr_b16 v[26:27], v4 offset:14336
  ds_read_b64_tr_b16 v[28:29], v5 offset:8192
  ds_read_b64_tr_b16 v[30:31], v5 offset:10240
  ds_read_b64_tr_b16 v[32:33], v5 offset:12288
  ds_read_b64_tr_b16 v[34:35], v5 offset:14336
  ds_read_b64_tr_b16 v[36:37], v6 offset:8192
  ds_read_b64_tr_b16 v[38:39], v6 offset:10240
  ds_read_b64_tr_b16 v[40:41], v6 offset:12288
  ds_read_b64_tr_b16 v[42:43], v6 offset:14336
  ds_read_b64_tr_b16 v[44:45], v7 offset:8192
  ds_read_b64_tr_b16 v[46:47], v7 offset:10240
  ds_read_b64_tr_b16 v[48:49], v7 offset:12288
  ds_read_b64_tr_b16 v[50:51], v7 offset:14336
  s_waitcnt lgkmcnt(0)
  s_barrier
  ds_write_b128 v85, v[20:23] offset:8192
  ds_write_b128 v85, v[24:27] offset:9216
  ds_write_b128 v85, v[28:31] offset:10240
  ds_write_b128 v85, v[32:35] offset:11264
  ds_write_b128 v85, v[36:39] offset:12288
  ds_write_b128 v85, v[40:43] offset:13312
  ds_write_b128 v85, v[44:47] offset:14336
  ds_write_b128 v85, v[48:51] offset:15360
  s_waitcnt vmcnt(8) lgkmcnt(0)
  s_barrier
  ds_read_b64_tr_b16 v[20:21], v4 offset:16384
  ds_read_b64_tr_b16 v[22:23], v4 offset:18432
  ds_read_b64_tr_b16 v[24:25], v4 offset:20480
  ds_read_b64_tr_b16 v[26:27], v4 offset:22528
  ds_read_b64_tr_b16 v[28:29], v5 offset:16384
  ds_read_b64_tr_b16 v[30:31], v5 offset:18432
  ds_read_b64_tr_b16 v[32:33], v5 offset:20480
  ds_read_b64_tr_b16 v[34:35], v5 offset:22528
  ds_read_b64_tr_b16 v[36:37], v6 offset:16384
  ds_read_b64_tr_b16 v[38:39], v6 offset:18432
  ds_read_b64_tr_b16 v[40:41], v6 offset:20480
  ds_read_b64_tr_b16 v[42:43], v6 offset:22528
  ds_read_b64_tr_b16 v[44:45], v7 offset:16384
  ds_read_b64_tr_b16 v[46:47], v7 offset:18432
  ds_read_b64_tr_b16 v[48:49], v7 offset:20480
  ds_read_b64_tr_b16 v[50:51], v7 offset:22528
  s_waitcnt lgkmcnt(0)
  s_barrier
  ds_write_b128 v85, v[20:23] offset:16384
  ds_write_b128 v85, v[24:27] offset:17408
  ds_write_b128 v85, v[28:31] offset:18432
  ds_write_b128 v85, v[32:35] offset:19456
  ds_write_b128 v85, v[36:39] offset:20480
  ds_write_b128 v85, v[40:43] offset:21504
  ds_write_b128 v85, v[44:47] offset:22528
  ds_write_b128 v85, v[48:51] offset:23552
  s_waitcnt vmcnt(0) lgkmcnt(0)
  s_barrier
  ds_read_b64_tr_b16 v[20:21], v4 offset:24576
  ds_read_b64_tr_b16 v[22:23], v4 offset:26624
  ds_read_b64_tr_b16 v[24:25], v4 offset:28672
  ds_read_b64_tr_b16 v[26:27], v4 offset:30720
  ds_read_b64_tr_b16 v[28:29], v5 offset:24576
  ds_read_b64_tr_b16 v[30:31], v5 offset:26624
  ds_read_b64_tr_b16 v[32:33], v5 offset:28672
  ds_read_b64_tr_b16 v[34:35], v5 offset:30720
  ds_read_b64_tr_b16 v[36:37], v6 offset:24576
  ds_read_b64_tr_b16 v[38:39], v6 offset:26624
  ds_read_b64_tr_b16 v[40:41], v6 offset:28672
  ds_read_b64_tr_b16 v[42:43], v6 offset:30720
  ds_read_b64_tr_b16 v[44:45], v7 offset:24576
  ds_read_b64_tr_b16 v[46:47], v7 offset:26624
  ds_read_b64_tr_b16 v[48:49], v7 offset:28672
  ds_read_b64_tr_b16 v[50:51], v7 offset:30720
  s_waitcnt lgkmcnt(0)
  s_barrier
  ds_write_b128 v85, v[20:23] offset:24576
  ds_write_b128 v85, v[24:27] offset:25600
  ds_write_b128 v85, v[28:31] offset:26624
  ds_write_b128 v85, v[32:35] offset:27648
  ds_write_b128 v85, v[36:39] offset:28672
  ds_write_b128 v85, v[40:43] offset:29696
  ds_write_b128 v85, v[44:47] offset:30720
  ds_write_b128 v85, v[48:51] offset:31744
  s_waitcnt lgkmcnt(0)
  s_getreg_b32 s55, hwreg(HW_REG_XCC_ID)
  s_and_b32 s55, s55, 15
  v_min_u32 v76, 63, v0
  v_lshlrev_b32 v76, 7, v76
  v_add_u32 v76, 1424384, v76
  s_nop 1
Lpoll_62:
  buffer_load_dword v77, v76, s[4:7], 0 offen sc1
  s_sub_u32 s24, s24, 1
  s_cbranch_scc1 L_FAIL
  s_waitcnt vmcnt(0)
  v_cmp_gt_i32 vcc, 0, v77
  s_cbranch_vccz Lpolld_63
  s_sleep 1
  s_branch Lpoll_62
Lpolld_63:
  v_and_b32 v78, 15, v77
  v_cmp_ne_u32 vcc, s55, v78
  s_lshl_b32 s40, s54, 4
  s_lshl_b32 s40, 0xffff, s40
  s_or_b32 s41, vcc_lo, vcc_hi
  s_and_b32 s40, s40, s41
  s_cselect_b32 s36, 0, 8192
  v_lshrrev_b32 v77, 8, v77
  v_and_b32 v78, 3, v0
  v_lshl_or_b32 v77, v77, 2, v78
  s_nop 1
  v_min_u32_dpp v77, v77, v77 row_ror:8 row_mask:0xf bank_mask:0xf
  s_nop 1
  v_min_u32_dpp v77, v77, v77 row_ror:4 row_mask:0xf bank_mask:0xf
  v_mov_b32 v78, v77
  s_nop 1
  v_permlane16_swap_b32 v78, v77
  v_min_u32 v77, v77, v78
  v_mov_b32 v78, v77
  s_nop 1
  v_permlane32_swap_b32 v78, v77
  v_min_u32 v77, v77, v78
  s_nop 1
  v_min_u32_dpp v77, v77, v77 row_ror:2 row_mask:0xf bank_mask:0xf
  s_nop 1
  v_min_u32_dpp v77, v77, v77 row_ror:1 row_mask:0xf bank_mask:0xf
  s_nop 0
  v_readfirstlane_b32 s26, v77
  s_and_b32 s26, s26, 3
  s_lshl_b32 s26, s26, 13
  s_lshr_b32 s40, s20, 1
  s_mul_i32 s40, s40, 32768
  s_and_b32 s41, s20, 1
  s_lshl_b32 s41, s41, 10
  s_add_u32 s40, s40, s41
  s_lshl_b32 s41, s54, 12
  s_add_u32 s40, s40, s41
  v_lshl_add_u32 v86, v0, 4, s40
  v_xor_b32 v87, 0x1000, v86
  v_and_b32 v76, 2, v0
  v_cmp_eq_u32 vcc, 0, v76
  v_mov_b32 v76, 0xeeee
  v_mov_b32 v77, 0x4444
  v_cndmask_b32 v88, v76, v77, vcc
  s_lshr_b32 s40, s21, 2
  s_mul_i32 s40, s40, 32768
  s_and_b32 s41, s21, 3
  s_lshl_b32 s41, s41, 11
  s_add_u32 s47, s40, s41
  s_lshl_b32 s41, s20, 9
  s_add_u32 s47, s47, s41
  v_lshl_add_u32 v92, v0, 3, s47
  s_lshl_b32 s41, s54, 12
  s_add_u32 s40, s41, 1310720
  s_add_u32 s40, s40, s26
  v_lshrrev_b32 v76, 2, v0
  v_lshl_add_u32 v76, v76, 7, s40
  v_and_b32 v77, 3, v0
  v_lshl_add_u32 v90, v77, 2, v76
  s_mov_b32 s57, s40
  s_cmp_eq_u32 s36, 0
  s_cselect_b32 s56, 1, s20
  s_and_b32 s41, s21, 15
  s_lshl_b32 s41, s41, 7
  s_lshl_b32 s40, s20, 2
  s_add_u32 s40, s40, s41
  s_add_u32 s40, s40, 2048
  s_mov_b32 s25, 0
  s_mov_b32 s60, 0
  s_mov_b32 s61, 0
  s_mov_b32 s51, -1
  v_mov_b32 v91, 2147483392
  s_mov_b64 exec, 1
  v_mov_b32 v91, s40
  s_mov_b64 exec, -1
  v_mov_b32 v80, -1
  v_mov_b32 v81, -1
  v_mov_b32 v82, -1
  v_mov_b32 v83, -1
  v_mov_b32 v112, 0
  v_mov_b32 v113, 0
  v_mov_b32 v114, 0
  v_mov_b32 v115, 0
  v_mov_b32 v116, 0
  v_mov_b32 v117, 0
  v_mov_b32 v118, 0
  v_mov_b32 v119, 0
  v_mov_b32 v120, 0
  v_mov_b32 v121, 0
  v_mov_b32 v108, 0x3f803f80
  v_mov_b32 v109, 0x3f803f80
  v_mov_b32 v110, 0x3f803f80
  v_mov_b32 v111, 0x3f803f80
  v_lshlrev_b32 v95, 4, v0
  s_lshl_b32 s58, s20, 12
  s_add_u32 s40, s58, 149504
  s_add_u32 s58, s58, 131072
  v_lshrrev_b32 v76, 4, v0
  v_bfe_u32 v77, v0, 1, 2
  v_xor_b32 v76, v76, v77
  v_lshl_add_u32 v76, v76, 4, s40
  v_and_b32 v77, 15, v0
  v_lshl_add_u32 v123, v77, 6, v76
  v_bfe_u32 v76, v0, 3, 2
  v_xor_b32 v76, v76, v0
  v_lshl_add_u32 v124, v76, 4, s40
  v_bfe_u32 v76, v0, 4, 1
  v_lshlrev_b32 v76, 1, v76
  v_and_b32 v77, 13, v0
  v_or_b32 v76, v76, v77
  v_lshl_add_u32 v122, v76, 4, s47
  v_lshrrev_b32 v76, 5, v0
  v_lshl_add_u32 v122, v76, 8, v122
  v_and_b32 v76, 2, v0
  v_cmp_eq_u32 vcc, 0, v76
  v_mov_b32 v77, 2147483392
  s_nop 0
  v_cndmask_b32 v122, v122, v77, vcc
  s_lshl_b32 s43, s21, 2
  s_add_u32 s43, s43, s20
  s_and_b32 s46, s20, 1
  s_lshl_b32 s46, s46, 10
  s_mul_i32 s32, s21, 65536
  s_lshl_b32 s40, s20, 11
  s_add_u32 s32, s32, s40
  s_and_b32 s40, s26, 0x2000
  s_xor_b32 s40, s40, 16777216
  s_add_u32 s32, s32, s40
  s_add_u32 s30, s32, s46
  s_add_u32 s30, s30, 49152
  s_lshl_b32 s59, s21, 7
  s_add_u32 s59, s59, 1396736
  s_lshl_b32 s62, s21, 7
  s_add_u32 s62, s62, 1404928
  s_mov_b32 s38, 0x3e0293ee
  s_mov_b32 s39, s38
  v_xor_b32 v125, 4096, v124
  v_xor_b32 v126, 8192, v124
  v_xor_b32 v127, 12288, v124
  v_readfirstlane_b32 s88, v86
  s_xor_b32 s41, s47, 131072
  v_min_u32 v76, 3, v0
  v_lshl_add_u32 v87, v76, 7, s41
  v_lshrrev_b32 v76, 4, v0
  v_lshlrev_b32 v76, 2, v76
  v_and_b32 v77, 15, v0
  v_sub_u32 v76, v77, v76
  s_lshr_b32 s41, s46, 6
  v_add_u32 v76, s41, v76
  v_and_b32 v92, 0xfffffdff, v92
  v_mov_b32 v86, 0xd028965f
  v_cmp_le_i32 s[8:9], 0, v76
  v_cmp_le_i32 s[10:11], 1, v76
  v_cmp_le_i32 s[16:17], 2, v76
  v_cmp_le_i32 s[18:19], 3, v76
  v_cmp_le_i32 s[42:43], 16, v76
  v_cmp_le_i32 s[44:45], 17, v76
  v_cmp_le_i32 s[52:53], 18, v76
  v_cmp_le_i32 s[54:55], 19, v76
  s_xor_b32 s89, s88, 1024
  s_xor_b32 s90, s88, 32768
  s_xor_b32 s91, s88, 33792
  v_lshrrev_b32 v76, 4, v0
  v_lshl_add_u32 v76, v76, 7, s57
  v_and_b32 v77, 15, v0
  v_lshl_add_u32 v90, v77, 2, v76
  s_mov_b32 s25, 0
  s_and_b32 s40, s25, 3
  s_lshl_b32 s40, s40, 16
  s_add_u32 s27, s40, s26
  s_add_u32 s27, s27, 1048576
  s_xor_b32 s37, s27, s36
  s_lshl_b32 s40, s40, 2
  s_add_u32 s28, s40, s26
  s_lshr_b32 s40, s40, 5
  s_and_b32 s40, s40, 0x4000
  s_xor_b32 s28, s28, s40
  s_xor_b32 s29, s28, 0x4000
  s_xor_b32 s40, s28, 8192
  buffer_load_dword v89, v122, s[4:7], s40 offen sc1
  s_mov_b32 s25, 1
  s_and_b32 s40, s25, 3
  s_lshl_b32 s40, s40, 16
  s_add_u32 s27, s40, s26
  s_add_u32 s27, s27, 1048576
  s_xor_b32 s37, s27, s36
  s_lshl_b32 s40, s40, 2
  s_add_u32 s28, s40, s26
  s_lshr_b32 s40, s40, 5
  s_and_b32 s40, s40, 0x4000
  s_xor_b32 s28, s28, s40
  s_xor_b32 s29, s28, 0x4000
  s_xor_b32 s40, s28, 8192
  buffer_load_dword v89, v122, s[4:7], s40 offen sc1
  s_mov_b32 s25, 2
  s_and_b32 s40, s25, 3
  s_lshl_b32 s40, s40, 16
  s_add_u32 s27, s40, s26
  s_add_u32 s27, s27, 1048576
  s_xor_b32 s37, s27, s36
  s_lshl_b32 s40, s40, 2
  s_add_u32 s28, s40, s26
  s_lshr_b32 s40, s40, 5
  s_and_b32 s40, s40, 0x4000
  s_xor_b32 s28, s28, s40
  s_xor_b32 s29, s28, 0x4000
  s_xor_b32 s40, s28, 8192
  buffer_load_dword v89, v122, s[4:7], s40 offen sc1
  s_mov_b32 s25, 3
  s_and_b32 s40, s25, 3
  s_lshl_b32 s40, s40, 16
  s_add_u32 s27, s40, s26
  s_add_u32 s27, s27, 1048576
  s_xor_b32 s37, s27, s36
  s_lshl_b32 s40, s40, 2
  s_add_u32 s28, s40, s26
  s_lshr_b32 s40, s40, 5
  s_and_b32 s40, s40, 0x4000
  s_xor_b32 s28, s28, s40
  s_xor_b32 s29, s28, 0x4000
  s_xor_b32 s40, s28, 8192
  buffer_load_dword v89, v122, s[4:7], s40 offen sc1
  buffer_load_dword v89, v90, s[4:7], 0 offen offset:0 sc1
  s_mov_b32 s25, 0
  s_mov_b32 s33, 1
  s_mov_b64 s[100:101], 0
  s_cmp_lg_u32 s20, 1
  s_cbranch_scc1 Lskip_66
Lask_64:
  s_min_i32 s47, s100, s101
  s_cmp_ge_i32 s47, s33
  s_cbranch_scc1 Lhave_65
  s_load_dwordx2 s[100:101], s[4:5], s59 glc
  s_sub_u32 s24, s24, 1
  s_cbranch_scc1 L_FAIL
  s_waitcnt lgkmcnt(0)
  s_branch Lask_64
Lhave_65:
  s_add_u32 s33, s33, 2
  s_min_u32 s33, s33, 64
  s_cmp_ge_i32 s47, s33
  s_cbranch_scc1 Lskip_66
  s_load_dwordx2 s[100:101], s[4:5], s59 glc
Lskip_66:
  s_barrier
  s_add_u32 m0, s58, 16384
  s_add_u32 s31, s32, 16384
  buffer_load_dwordx4 v95, s[4:7], s31 offen offset:0 sc1 lds
  buffer_load_dwordx4 v95, s[4:7], s31 offen offset:1024 sc1 lds
  s_add_u32 m0, s58, 2048
  s_add_u32 s31, s32, 32768
  buffer_load_dwordx4 v95, s[4:7], s31 offen offset:0 sc1 lds
  buffer_load_dwordx4 v95, s[4:7], s31 offen offset:1024 sc1 lds
  s_mov_b32 m0, s58
  s_add_u32 s31, s32, s46
  buffer_load_dwordx4 v95, s[4:7], s31 offen offset:0 sc1 lds
  s_sub_u32 s31, s32, s46
  buffer_load_dwordx4 v95, s[4:7], s31 offen offset:1024 sc1 lds
  s_and_b32 s40, s25, 3
  s_lshl_b32 s40, s40, 16
  s_add_u32 s27, s40, s26
  s_add_u32 s27, s27, 1048576
  s_xor_b32 s37, s27, s36
  s_lshl_b32 s40, s40, 2
  s_add_u32 s28, s40, s26
  s_lshr_b32 s40, s40, 5
  s_and_b32 s40, s40, 0x4000
  s_xor_b32 s28, s28, s40
  s_xor_b32 s29, s28, 0x4000
  s_xor_b32 s34, s28, 0x84000
  s_xor_b32 s48, s28, 8192
  s_lshr_b32 s40, s46, 1
  s_add_u32 s29, s29, s40
  s_xor_b32 s35, s29, 512
  s_add_u32 s92, s37, s88
  s_add_u32 s96, s27, s88
  s_xor_b32 s96, s96, 0x1000
  s_add_u32 s93, s37, s89
  s_add_u32 s97, s27, s89
  s_xor_b32 s97, s97, 0x1000
  s_add_u32 s94, s37, s90
  s_add_u32 s98, s27, s90
  s_xor_b32 s98, s98, 0x1000
  s_add_u32 s95, s37, s91
  s_add_u32 s99, s27, s91
  s_xor_b32 s99, s99, 0x1000
L_QK_top:
  v_mov_b32 v94, s25
  v_mov_b64 v[52:53], 0
  v_mov_b64 v[54:55], 0
  v_mov_b64 v[56:57], 0
  v_mov_b64 v[58:59], 0
  v_mov_b64 v[60:61], 0
  v_mov_b64 v[62:63], 0
  v_mov_b64 v[64:65], 0
  v_mov_b64 v[66:67], 0
  ds_read_b128 v[20:23], v85 offset:0
  ds_read_b128 v[24:27], v85 offset:1024
  ds_read_b128 v[28:31], v85 offset:8192
  ds_read_b128 v[32:35], v85 offset:9216
  ds_read_b128 v[36:39], v85 offset:2048
  ds_read_b128 v[40:43], v85 offset:3072
  ds_read_b128 v[44:47], v85 offset:10240
  ds_read_b128 v[48:51], v85 offset:11264
  s_waitcnt lgkmcnt(0)
  s_and_b32 s40, s25, 63
  s_cselect_b32 s40, s56, 1
  s_cmp_lg_u32 s40, 0
  s_cbranch_scc1 L_QK_park
  v_mov_b32 v76, -1
  s_sleep 4
  s_nop 0
  s_nop 0
L_QK_spin:
  s_sub_u32 s24, s24, 1
  s_nop 0
  s_nop 0
  s_cbranch_scc1 L_FAIL
  s_nop 0
  s_waitcnt vmcnt(40)
  buffer_load_dword v76, v90, s[4:7], 0 offen sc1
  s_nop 3
  v_cmp_gt_i32_e64 vcc, s25, v76
  s_cbranch_vccz L_QK_rel
  buffer_load_dword v76, v90, s[4:7], 0 offen sc1
  s_nop 3
  v_cmp_gt_i32 vcc, s25, v76
  s_cbranch_vccz L_QK_rel
  buffer_load_dword v76, v90, s[4:7], 0 offen sc1
  s_nop 3
  v_cmp_gt_i32 vcc, s25, v76
  s_cbranch_vccz L_QK_rel
  buffer_load_dword v76, v90, s[4:7], 0 offen sc1
  s_nop 3
  v_cmp_gt_i32_e64 vcc, s25, v76
  s_cbranch_vccnz L_QK_spin
L_QK_rel:
  s_barrier
  s_mov_b64 exec, -1
L_QK_go:
L_QKM_again:
  buffer_load_dwordx4 v[96:99], v95, s[4:7], s92 offen offset:0 sc1
  s_nop 0
  buffer_load_dwordx4 v[100:103], v95, s[4:7], s92 offen offset:2048 sc1
  s_nop 0
  buffer_load_dwordx4 v[68:71], v95, s[4:7], s93 offen offset:0 sc1
  s_nop 0
  buffer_load_dwordx4 v[72:75], v95, s[4:7], s93 offen offset:2048 sc1
  s_nop 0
  buffer_load_dwordx4 v[4:7], v95, s[4:7], s94 offen offset:0 sc1
  s_nop 0
  buffer_load_dwordx4 v[8:11], v95, s[4:7], s94 offen offset:2048 sc1
  s_nop 0
  s_cmp_lg_u32 s20, 0
  s_nop 0
  s_nop 0
  s_cbranch_scc1 L_QK_sigd
  s_mov_b32 s63, s25
  s_waitcnt vmcnt(6)
  s_atomic_smax s63, s[4:5], s62 glc
L_QK_sigd:
  s_waitcnt vmcnt(5)
  v_cmp_eq_u32_e64 vcc, -1, v96
  s_cbranch_vccnz L_QKM_g0
L_QKM_ok0:
  v_smfmac_f32_16x16x64_bf16 v[52:55], v[96:99], a[0:7], v88
  buffer_load_dwordx4 v[12:15], v95, s[4:7], s95 offen offset:0 sc1
  buffer_load_dwordx4 v[16:19], v95, s[4:7], s95 offen offset:2048 sc1
  v_smfmac_f32_16x16x64_bf16 v[60:63], v[96:99], v[128:135], v88
  s_waitcnt vmcnt(6)
  v_cmp_eq_u32_e64 vcc, -1, v100
  v_smfmac_f32_16x16x64_bf16 v[56:59], v[96:99], a[128:135], v88
  v_smfmac_f32_16x16x64_bf16 v[64:67], v[96:99], v[20:27], v88
  s_cbranch_vccnz L_QKM_g1
L_QKM_ok1:
  v_smfmac_f32_16x16x64_bf16 v[52:55], v[100:103], a[8:15], v88
  buffer_load_dwordx4 v[96:99], v95, s[4:7], s96 offen offset:0 sc1
  ds_read_b128 v[20:23], v85 offset:4096
  v_smfmac_f32_16x16x64_bf16 v[60:63], v[100:103], v[136:143], v88
  s_waitcnt vmcnt(6)
  v_cmp_eq_u32 vcc, -1, v68
  v_smfmac_f32_16x16x64_bf16 v[56:59], v[100:103], a[136:143], v88
  ds_read_b128 v[24:27], v85 offset:5120
  v_smfmac_f32_16x16x64_bf16 v[64:67], v[100:103], v[28:35], v88
  s_cbranch_vccnz L_QKM_g2
L_QKM_ok2:
  v_smfmac_f32_16x16x64_bf16 v[52:55], v[68:71], a[16:23], v88
  buffer_load_dwordx4 v[100:103], v95, s[4:7], s96 offen offset:2048 sc1
  ds_read_b128 v[28:31], v85 offset:12288
  v_smfmac_f32_16x16x64_bf16 v[60:63], v[68:71], v[144:151], v88
  s_waitcnt vmcnt(6)
  v_cmp_eq_u32 vcc, -1, v72
  v_smfmac_f32_16x16x64_bf16 v[56:59], v[68:71], a[144:151], v88
  ds_read_b128 v[32:35], v85 offset:13312
  v_smfmac_f32_16x16x64_bf16 v[64:67], v[68:71], v[36:43], v88
  s_cbranch_vccnz L_QKM_g3
L_QKM_ok3:
  v_smfmac_f32_16x16x64_bf16 v[52:55], v[72:75], a[24:31], v88
  buffer_load_dwordx4 v[68:71], v95, s[4:7], s97 offen offset:0 sc1
  ds_read_b128 v[36:39], v85 offset:6144
  v_smfmac_f32_16x16x64_bf16 v[60:63], v[72:75], v[152:159], v88
  s_waitcnt vmcnt(6)
  v_cmp_eq_u32 vcc, -1, v4
  v_smfmac_f32_16x16x64_bf16 v[56:59], v[72:75], a[152:159], v88
  ds_read_b128 v[40:43], v85 offset:7168
  v_smfmac_f32_16x16x64_bf16 v[64:67], v[72:75], v[44:51], v88
  s_cbranch_vccnz L_QKM_g4
L_QKM_ok4:
  v_smfmac_f32_16x16x64_bf16 v[52:55], v[4:7], a[32:39], v88
  buffer_load_dwordx4 v[72:75], v95, s[4:7], s97 offen offset:2048 sc1
  ds_read_b128 v[44:47], v85 offset:14336
  v_smfmac_f32_16x16x64_bf16 v[60:63], v[4:7], v[160:167], v88
  s_waitcnt vmcnt(6)
  v_cmp_eq_u32 vcc, -1, v8
  v_smfmac_f32_16x16x64_bf16 v[56:59], v[4:7], a[160:167], v88
  ds_read_b128 v[48:51], v85 offset:15360
  s_waitcnt lgkmcnt(6)
  v_smfmac_f32_16x16x64_bf16 v[64:67], v[4:7], v[20:27], v88
  s_cbranch_vccnz L_QKM_g5
L_QKM_ok5:
  v_smfmac_f32_16x16x64_bf16 v[52:55], v[8:11], a[40:47], v88
  buffer_load_dwordx4 v[4:7], v95, s[4:7], s98 offen offset:0 sc1
  ds_read_b128 v[20:23], v85 offset:16384
  v_smfmac_f32_16x16x64_bf16 v[60:63], v[8:11], v[168:175], v88
  s_waitcnt vmcnt(6)
  v_cmp_eq_u32_e64 vcc, -1, v12
  v_smfmac_f32_16x16x64_bf16 v[56:59], v[8:11], a[168:175], v88
  ds_read_b128 v[24:27], v85 offset:17408
  s_waitcnt lgkmcnt(6)
  v_smfmac_f32_16x16x64_bf16 v[64:67], v[8:11], v[28:35], v88
  s_cbranch_vccnz L_QKM_g6
L_QKM_ok6:
  v_smfmac_f32_16x16x64_bf16 v[52:55], v[12:15], a[48:55], v88
  buffer_load_dwordx4 v[8:11], v95, s[4:7], s98 offen offset:2048 sc1
  ds_read_b128 v[28:31], v85 offset:24576
  v_smfmac_f32_16x16x64_bf16 v[60:63], v[12:15], v[176:183], v88
  s_waitcnt vmcnt(6)
  v_cmp_eq_u32 vcc, -1, v16
  v_smfmac_f32_16x16x64_bf16 v[56:59], v[12:15], a[176:183], v88
  ds_read_b128 v[32:35], v85 offset:25600
  s_waitcnt lgkmcnt(6)
  v_smfmac_f32_16x16x64_bf16 v[64:67], v[12:15], v[36:43], v88
  s_cbranch_vccnz L_QKM_g7
L_QKM_ok7:
  v_smfmac_f32_16x16x64_bf16 v[52:55], v[16:19], a[56:63], v88
  buffer_load_dwordx4 v[12:15], v95, s[4:7], s99 offen offset:0 sc1
  ds_read_b128 v[36:39], v85 offset:18432
  v_smfmac_f32_16x16x64_bf16 v[60:63], v[16:19], v[184:191], v88
  s_waitcnt vmcnt(6)
  v_cmp_eq_u32 vcc, -1, v96
  v_smfmac_f32_16x16x64_bf16 v[56:59], v[16:19], a[184:191], v88
  ds_read_b128 v[40:43], v85 offset:19456
  s_waitcnt lgkmcnt(6)
  v_smfmac_f32_16x16x64_bf16 v[64:67], v[16:19], v[44:51], v88
  s_cbranch_vccnz L_QKM_g8
L_QKM_ok8:
  v_smfmac_f32_16x16x64_bf16 v[52:55], v[96:99], a[64:71], v88
  buffer_load_dwordx4 v[16:19], v95, s[4:7], s99 offen offset:2048 sc1
  ds_read_b128 v[44:47], v85 offset:26624
  v_smfmac_f32_16x16x64_bf16 v[60:63], v[96:99], v[192:199], v88
  s_waitcnt vmcnt(6)
  v_cmp_eq_u32_e64 vcc, -1, v100
  v_smfmac_f32_16x16x64_bf16 v[56:59], v[96:99], a[192:199], v88
  ds_read_b128 v[48:51], v85 offset:27648
  s_nop 0
  s_waitcnt lgkmcnt(6)
  v_smfmac_f32_16x16x64_bf16 v[64:67], v[96:99], v[20:27], v88
  s_cbranch_vccnz L_QKM_g9
L_QKM_ok9:
  v_smfmac_f32_16x16x64_bf16 v[52:55], v[100:103], a[72:79], v88
  ds_read_b128 v[20:23], v85 offset:20480
  v_smfmac_f32_16x16x64_bf16 v[60:63], v[100:103], v[200:207], v88
  s_waitcnt vmcnt(5)
  v_cmp_eq_u32 vcc, -1, v68
  v_smfmac_f32_16x16x64_bf16 v[56:59], v[100:103], a[200:207], v88
  ds_read_b128 v[24:27], v85 offset:21504
  s_waitcnt lgkmcnt(6)
  v_smfmac_f32_16x16x64_bf16 v[64:67], v[100:103], v[28:35], v88
  s_cbranch_vccnz L_QKM_g10
L_QKM_ok10:
  v_smfmac_f32_16x16x64_bf16 v[52:55], v[68:71], a[80:87], v88
  ds_read_b128 v[28:31], v85 offset:28672
  v_smfmac_f32_16x16x64_bf16 v[60:63], v[68:71], v[208:215], v88
  s_waitcnt vmcnt(4)
  v_cmp_eq_u32 vcc, -1, v72
  v_smfmac_f32_16x16x64_bf16 v[56:59], v[68:71], a[208:215], v88
  ds_read_b128 v[32:35], v85 offset:29696
  s_waitcnt lgkmcnt(6)
  v_smfmac_f32_16x16x64_bf16 v[64:67], v[68:71], v[36:43], v88
  s_cbranch_vccnz L_QKM_g11
L_QKM_ok11:
  v_smfmac_f32_16x16x64_bf16 v[52:55], v[72:75], a[88:95], v88
  ds_read_b128 v[36:39], v85 offset:22528
  ds_read_b128 v[40:43], v85 offset:23552
  v_smfmac_f32_16x16x64_bf16 v[60:63], v[72:75], v[216:223], v88
  s_waitcnt vmcnt(3)
  v_cmp_eq_u32 vcc, -1, v4
  v_smfmac_f32_16x16x64_bf16 v[56:59], v[72:75], a[216:223], v88
  ds_read_b128 v[96:99], v1 offset:2048
  s_waitcnt lgkmcnt(7)
  v_smfmac_f32_16x16x64_bf16 v[64:67], v[72:75], v[44:51], v88
  s_cbranch_vccnz L_QKM_g12
L_QKM_ok12:
  v_smfmac_f32_16x16x64_bf16 v[52:55], v[4:7], a[96:103], v88
  ds_read_b128 v[44:47], v85 offset:30720
  ds_read_b128 v[48:51], v85 offset:31744
  v_smfmac_f32_16x16x64_bf16 v[60:63], v[4:7], v[224:231], v88
  s_waitcnt vmcnt(2)
  v_cmp_eq_u32 vcc, -1, v8
  v_smfmac_f32_16x16x64_bf16 v[56:59], v[4:7], a[224:231], v88
  ds_read_b128 v[100:103], v1 offset:3072
  s_waitcnt lgkmcnt(8)
  v_smfmac_f32_16x16x64_bf16 v[64:67], v[4:7], v[20:27], v88
  s_cbranch_vccnz L_QKM_g13
L_QKM_ok13:
  v_smfmac_f32_16x16x64_bf16 v[52:55], v[8:11], a[104:111], v88
  ds_read_b128 v[68:71], v84 offset:16384
  ds_read_b128 v[72:75], v84 offset:17408
  v_smfmac_f32_16x16x64_bf16 v[60:63], v[8:11], v[232:239], v88
  s_waitcnt vmcnt(1)
  v_cmp_eq_u32_e64 vcc, -1, v12
  v_smfmac_f32_16x16x64_bf16 v[56:59], v[8:11], a[232:239], v88
  ds_read_b128 v[20:23], v1 offset:16384
  s_nop 0
  s_waitcnt lgkmcnt(9)
  v_smfmac_f32_16x16x64_bf16 v[64:67], v[8:11], v[28:35], v88
  s_cbranch_vccnz L_QKM_g14
L_QKM_ok14:
  v_smfmac_f32_16x16x64_bf16 v[52:55], v[12:15], a[112:119], v88
  ds_read_b128 v[24:27], v1 offset:17408
  ds_read_b128 v[28:31], v2 offset:16384
  v_smfmac_f32_16x16x64_bf16 v[60:63], v[12:15], v[240:247], v88
  s_waitcnt vmcnt(0)
  v_cmp_eq_u32 vcc, -1, v16
  v_smfmac_f32_16x16x64_bf16 v[56:59], v[12:15], a[240:247], v88
  ds_read_b128 v[32:35], v2 offset:17408
  s_waitcnt lgkmcnt(10)
  v_smfmac_f32_16x16x64_bf16 v[64:67], v[12:15], v[36:43], v88
  s_cbranch_vccnz L_QKM_g15
L_QKM_ok15:
  v_smfmac_f32_16x16x64_bf16 v[52:55], v[16:19], a[120:127], v88
  ds_read_b128 v[36:39], v3 offset:16384
  v_smfmac_f32_16x16x64_bf16 v[60:63], v[16:19], v[248:255], v88
  ds_read_b128 v[40:43], v3 offset:17408
  v_smfmac_f32_16x16x64_bf16 v[56:59], v[16:19], a[248:255], v88
  s_waitcnt lgkmcnt(9)
  v_smfmac_f32_16x16x64_bf16 v[64:67], v[16:19], v[44:51], v88
  s_nop 1
  v_pk_add_f32 v[52:53], v[52:53], v[54:55]
  s_nop 0
  v_pk_add_f32 v[60:61], v[60:61], v[62:63]
  v_cmp_u_f32 vcc, v52, v53
  v_cvt_pk_bf16_f32 v77, v52, v53
  v_cvt_pk_bf16_f32 v76, v60, v61
  v_pk_add_f32 v[56:57], v[56:57], v[58:59]
  v_pk_add_f32 v[64:65], v[64:65], v[66:67]
  v_cvt_pk_bf16_f32 v79, v56, v57
  v_cvt_pk_bf16_f32 v78, v64, v65
  ds_write_b128 v123, v[76:79]
  ds_read_b64_tr_b16 v[4:5], v124 offset:0
  ds_read_b64_tr_b16 v[6:7], v124 offset:8
  s_cbranch_vccnz L_QKM_nan
L_QKM_done:
  s_waitcnt lgkmcnt(2)
  s_barrier
  ds_read_b64_tr_b16 v[8:9], v125 offset:0
  ds_read_b64_tr_b16 v[10:11], v125 offset:8
  ds_read_b64_tr_b16 v[12:13], v126 offset:0
  ds_read_b64_tr_b16 v[14:15], v126 offset:8
  ds_read_b64_tr_b16 v[16:17], v127 offset:0
  ds_read_b64_tr_b16 v[18:19], v127 offset:8
  s_waitcnt lgkmcnt(6)
  v_mfma_f32_16x16x32_bf16 v[52:55], v[20:23], v[4:7], 0
  v_mfma_f32_16x16x32_bf16 v[56:59], v[24:27], v[4:7], 0
  v_mfma_f32_16x16x32_bf16 v[60:63], v[4:7], v[4:7], 0
  s_waitcnt lgkmcnt(4)
  v_mfma_f32_16x16x32_bf16 v[52:55], v[28:31], v[8:11], v[52:55]
  v_mfma_f32_16x16x32_bf16 v[56:59], v[32:35], v[8:11], v[56:59]
  v_mfma_f32_16x16x32_bf16 v[60:63], v[8:11], v[8:11], v[60:63]
  buffer_load_dwordx2 v[104:105], v92, s[4:7], s29 offen sc1
  buffer_load_dwordx2 v[106:107], v92, s[4:7], s35 offen sc1
  s_waitcnt lgkmcnt(2)
  v_mfma_f32_16x16x32_bf16 v[52:55], v[36:39], v[12:15], v[52:55]
  v_mfma_f32_16x16x32_bf16 v[56:59], v[40:43], v[12:15], v[56:59]
  v_mfma_f32_16x16x32_bf16 v[60:63], v[12:15], v[12:15], v[60:63]
  s_waitcnt lgkmcnt(0)
  v_mfma_f32_16x16x32_bf16 v[52:55], v[68:71], v[16:19], v[52:55]
  v_mfma_f32_16x16x32_bf16 v[56:59], v[72:75], v[16:19], v[56:59]
  v_mfma_f32_16x16x32_bf16 v[60:63], v[16:19], v[16:19], v[60:63]
  s_mov_b32 vcc_lo, 0xcccccccc
  s_mov_b32 vcc_hi, 0xcccccccc
  v_mov_b32 v79, s38
  s_nop 2
  v_max3_f32 v64, v52, v53, v54
  v_max3_f32 v65, v55, v56, v57
  v_max3_f32 v64, v64, v58, v59
  v_max3_f32 v65, v65, v60, v61
  v_max_f32 v66, v64, v65
  v_max_f32 v67, v64, v65
  v_cndmask_b32_dpp v60, v61, v60, vcc quad_perm:[2,3,2,3] row_mask:0xf bank_mask:0xf
  v_cndmask_b32_dpp v52, v56, v52, vcc quad_perm:[2,3,2,3] row_mask:0xf bank_mask:0xf
  v_permlane16_swap_b32 v66, v67
  v_max_f32 v64, v66, v67
  v_max_f32 v65, v66, v67
  v_cndmask_b32_dpp v53, v57, v53, vcc quad_perm:[2,3,2,3] row_mask:0xf bank_mask:0xf
  v_cndmask_b32_dpp v54, v58, v54, vcc quad_perm:[2,3,2,3] row_mask:0xf bank_mask:0xf
  v_permlane32_swap_b32 v64, v65
  v_max_f32 v64, v64, v65
  v_cndmask_b32_dpp v55, v59, v55, vcc quad_perm:[2,3,2,3] row_mask:0xf bank_mask:0xf
  s_nop 0
  v_mul_f32_dpp v64, v64, v79 quad_perm:[2,3,2,3] row_mask:0xf bank_mask:0xf
  v_pk_fma_f32 v[52:53], v[52:53], s[38:39], v[64:65] op_sel_hi:[1,1,0] neg_lo:[0,0,1] neg_hi:[0,0,1]
  v_pk_fma_f32 v[54:55], v[54:55], s[38:39], v[64:65] op_sel_hi:[1,1,0] neg_lo:[0,0,1] neg_hi:[0,0,1]
  v_exp_f32 v52, v52
  v_exp_f32 v53, v53
  v_exp_f32 v54, v54
  v_cvt_pk_bf16_f32 v76, v52, v53
  v_exp_f32 v55, v55
  v_fma_f32 v60, v60, s38, -v64
  v_cvt_pk_bf16_f32 v77, v54, v55
  v_mov_b32_dpp v78, v76 quad_perm:[0,1,0,1] row_mask:0xf bank_mask:0xf
  v_exp_f32 v60, v60
  v_mov_b32_dpp v79, v77 quad_perm:[0,1,0,1] row_mask:0xf bank_mask:0xf
  s_nop 0
  v_mov_b32_dpp v61, v60 quad_perm:[0,1,0,1] row_mask:0xf bank_mask:0xf
  v_mfma_f32_16x16x32_bf16 v[64:67], v[108:111], v[76:79], 0
  v_cvt_pk_bf16_f32 v114, v60, v61
  v_cvt_pk_bf16_f32 v119, v60, v61
  s_waitcnt vmcnt(0)
  v_mfma_f32_16x16x32_bf16 v[44:47], v[96:99], v[76:79], 0
  v_max3_u32 v89, v104, v105, v106
  v_max_u32 v89, v89, v107
  v_mfma_f32_16x16x32_bf16 v[64:67], v[108:111], v[114:117], v[64:67]
  v_cmp_eq_u32 vcc, -1, v89
  v_mfma_f32_16x16x32_bf16 v[48:51], v[100:103], v[76:79], 0
  s_cbranch_vccnz L_QK_vbad
L_QK_vok:
  buffer_store_dword v94, v91, s[4:7], s57 offen
  v_mfma_f32_16x16x32_bf16 v[44:47], v[104:107], v[114:117], v[44:47]
  v_mfma_f32_16x16x32_bf16 v[48:51], v[104:107], v[118:121], v[48:51]
  s_nop 1
  v_rcp_f32 v64, v64
  s_nop 3
  v_pk_mul_f32 v[44:45], v[44:45], v[64:65] op_sel_hi:[1,0]
  v_pk_mul_f32 v[46:47], v[46:47], v[64:65] op_sel_hi:[1,0]
  v_pk_mul_f32 v[48:49], v[48:49], v[64:65] op_sel_hi:[1,0]
  v_pk_mul_f32 v[50:51], v[50:51], v[64:65] op_sel_hi:[1,0]
  v_cvt_pk_bf16_f32 v52, v44, v45
  v_cvt_pk_bf16_f32 v53, v46, v47
  v_cvt_pk_bf16_f32 v54, v48, v49
  v_cvt_pk_bf16_f32 v55, v50, v51
  buffer_store_dwordx4 v[52:55], v122, s[4:7], s48 offen
  ds_read_b128 v[44:47], v1 offset:0
  ds_read_b128 v[48:51], v2 offset:1024
  s_add_u32 s32, s32, 2097152
  s_xor_b32 s32, s32, 0x2000
  s_add_u32 s33, s25, 2
  s_min_u32 s33, s33, 64
  s_waitcnt lgkmcnt(0)
  buffer_store_dwordx4 v[52:55], v122, s[4:7], s28 offen sc1
  v_mfma_f32_16x16x32_bf16 v[56:59], v[20:23], v[44:47], 0
  v_mfma_f32_16x16x32_bf16 v[60:63], v[24:27], v[44:47], 0
  v_mfma_f32_16x16x32_bf16 v[64:67], v[4:7], v[44:47], 0
  ds_read_b128 v[20:23], v3 offset:0
  ds_read_b128 v[24:27], v2 offset:2048
  v_mfma_f32_16x16x32_bf16 v[56:59], v[28:31], v[48:51], v[56:59]
  v_mfma_f32_16x16x32_bf16 v[60:63], v[32:35], v[48:51], v[60:63]
  v_mfma_f32_16x16x32_bf16 v[64:67], v[8:11], v[48:51], v[64:67]
  ds_read_b128 v[28:31], v84 offset:1024
  ds_read_b128 v[32:35], v2 offset:3072
  s_waitcnt lgkmcnt(3)
  v_mfma_f32_16x16x32_bf16 v[56:59], v[36:39], v[20:23], v[56:59]
  v_mfma_f32_16x16x32_bf16 v[60:63], v[40:43], v[20:23], v[60:63]
  v_mfma_f32_16x16x32_bf16 v[64:67], v[12:15], v[20:23], v[64:67]
  s_waitcnt lgkmcnt(0)
  v_mfma_f32_16x16x32_bf16 v[56:59], v[68:71], v[28:31], v[56:59]
  v_mfma_f32_16x16x32_bf16 v[60:63], v[72:75], v[28:31], v[60:63]
  v_mfma_f32_16x16x32_bf16 v[64:67], v[16:19], v[28:31], v[64:67]
  s_cmp_lg_u32 s20, 1
  s_cbranch_scc1 Lskip_69
Lask_67:
  s_min_i32 s47, s100, s101
  s_cmp_ge_i32 s47, s33
  s_cbranch_scc1 Lhave_68
  s_load_dwordx2 s[100:101], s[4:5], s59 glc
  s_sub_u32 s24, s24, 1
  s_cbranch_scc1 L_FAIL
  s_waitcnt lgkmcnt(0)
  s_branch Lask_67
Lhave_68:
  s_add_u32 s33, s33, 2
  s_min_u32 s33, s33, 64
  s_cmp_ge_i32 s47, s33
  s_cbranch_scc1 Lskip_69
  s_load_dwordx2 s[100:101], s[4:5], s59 glc
Lskip_69:
  s_barrier
  v_cndmask_b32 v56, v86, v56, s[8:9]
  v_cndmask_b32 v57, v86, v57, s[10:11]
  v_cndmask_b32 v58, v86, v58, s[16:17]
  v_cndmask_b32 v59, v86, v59, s[18:19]
  v_cndmask_b32 v60, v86, v60, s[42:43]
  v_cndmask_b32 v61, v86, v61, s[44:45]
  v_cndmask_b32 v62, v86, v62, s[52:53]
  v_cndmask_b32 v63, v86, v63, s[54:55]
  v_max3_f32 v72, v56, v57, v58
  v_max3_f32 v73, v59, v60, v61
  buffer_load_dword v89, v87, s[4:7], s28 offen sc1
  v_max3_f32 v72, v72, v62, v63
  v_max3_f32 v73, v73, v64, v65
  s_add_u32 m0, s58, 16384
  s_add_u32 s31, s32, 16384
  buffer_load_dwordx4 v95, s[4:7], s31 offen offset:0 sc1 lds
  v_max_f32 v74, v72, v73
  v_max_f32 v75, v72, v73
  buffer_load_dwordx4 v95, s[4:7], s31 offen offset:1024 sc1 lds
  s_nop 0
  v_permlane16_swap_b32 v74, v75
  v_max_f32 v72, v74, v75
  s_add_u32 m0, s58, 2048
  s_add_u32 s31, s32, 32768
  buffer_load_dwordx4 v95, s[4:7], s31 offen offset:0 sc1 lds
  v_max_f32 v73, v74, v75
  s_nop 1
  v_permlane32_swap_b32 v72, v73
  buffer_load_dwordx4 v95, s[4:7], s31 offen offset:1024 sc1 lds
  v_max_f32 v72, v72, v73
  v_mul_f32 v72, s38, v72
  s_mov_b32 m0, s58
  s_add_u32 s31, s32, s46
  buffer_load_dwordx4 v95, s[4:7], s31 offen offset:0 sc1 lds
  v_pk_fma_f32 v[56:57], v[56:57], s[38:39], v[72:73] op_sel_hi:[1,1,0] neg_lo:[0,0,1] neg_hi:[0,0,1]
  v_pk_fma_f32 v[58:59], v[58:59], s[38:39], v[72:73] op_sel_hi:[1,1,0] neg_lo:[0,0,1] neg_hi:[0,0,1]
  s_sub_u32 s31, s32, s46
  buffer_load_dwordx4 v95, s[4:7], s31 offen offset:1024 sc1 lds
  v_pk_fma_f32 v[60:61], v[60:61], s[38:39], v[72:73] op_sel_hi:[1,1,0] neg_lo:[0,0,1] neg_hi:[0,0,1]
  v_pk_fma_f32 v[62:63], v[62:63], s[38:39], v[72:73] op_sel_hi:[1,1,0] neg_lo:[0,0,1] neg_hi:[0,0,1]
  buffer_store_dwordx4 v[80:83], v122, s[4:7], s34 offen sc1
  v_pk_fma_f32 v[64:65], v[64:65], s[38:39], v[72:73] op_sel_hi:[1,1,0] neg_lo:[0,0,1] neg_hi:[0,0,1]
  v_exp_f32 v56, v56
  s_xor_b32 s40, s34, 8192
  buffer_store_dwordx4 v[80:83], v122, s[4:7], s40 offen
  v_exp_f32 v57, v57
  v_exp_f32 v58, v58
  v_exp_f32 v59, v59
  v_exp_f32 v60, v60
  v_exp_f32 v61, v61
  v_exp_f32 v62, v62
  v_exp_f32 v63, v63
  v_exp_f32 v64, v64
  v_exp_f32 v65, v65
  v_cvt_pk_bf16_f32 v36, v56, v57
  v_cvt_pk_bf16_f32 v37, v58, v59
  v_cvt_pk_bf16_f32 v38, v60, v61
  v_cvt_pk_bf16_f32 v39, v62, v63
  v_cvt_pk_bf16_f32 v114, v64, v65
  v_cvt_pk_bf16_f32 v119, v64, v65
  s_add_u32 s25, s25, 1
  s_xor_b32 s41, s30, 2048
  v_mfma_f32_16x16x32_bf16 v[40:43], v[108:111], v[36:39], 0
  s_and_b32 s40, s25, 3
  s_lshl_b32 s40, s40, 16
  s_add_u32 s27, s40, s26
  v_mfma_f32_16x16x32_bf16 v[52:55], v[96:99], v[36:39], 0
  s_add_u32 s27, s27, 1048576
  s_xor_b32 s37, s27, s36
  s_lshl_b32 s40, s40, 2
  v_mfma_f32_16x16x32_bf16 v[56:59], v[100:103], v[36:39], 0
  s_add_u32 s28, s40, s26
  s_lshr_b32 s40, s40, 5
  s_and_b32 s40, s40, 0x4000
  v_mfma_f32_16x16x32_bf16 v[60:63], v[24:27], v[36:39], 0
  s_xor_b32 s28, s28, s40
  s_xor_b32 s29, s28, 0x4000
  s_xor_b32 s34, s28, 0x84000
  v_mfma_f32_16x16x32_bf16 v[64:67], v[32:35], v[36:39], 0
  s_xor_b32 s48, s28, 8192
  s_lshr_b32 s40, s46, 1
  s_add_u32 s29, s29, s40
  v_mfma_f32_16x16x32_bf16 v[40:43], v[108:111], v[114:117], v[40:43]
  s_xor_b32 s35, s29, 512
  s_add_u32 s92, s37, s88
  s_add_u32 s96, s27, s88
  v_mfma_f32_16x16x32_bf16 v[52:55], v[104:107], v[114:117], v[52:55]
  s_xor_b32 s96, s96, 0x1000
  s_add_u32 s93, s37, s89
  s_add_u32 s97, s27, s89
  v_mfma_f32_16x16x32_bf16 v[56:59], v[104:107], v[118:121], v[56:59]
  s_xor_b32 s97, s97, 0x1000
  s_add_u32 s94, s37, s90
  s_add_u32 s98, s27, s90
  v_mfma_f32_16x16x32_bf16 v[60:63], v[104:107], v[112:115], v[60:63]
  s_xor_b32 s98, s98, 0x1000
  s_add_u32 s95, s37, s91
  s_add_u32 s99, s27, s91
  v_mfma_f32_16x16x32_bf16 v[64:67], v[104:107], v[116:119], v[64:67]
  s_xor_b32 s99, s99, 0x1000
  v_rcp_f32 v40, v40
  s_nop 0
  v_pk_mul_f32 v[52:53], v[52:53], v[40:41] op_sel_hi:[1,0]
  v_pk_mul_f32 v[54:55], v[54:55], v[40:41] op_sel_hi:[1,0]
  v_pk_mul_f32 v[56:57], v[56:57], v[40:41] op_sel_hi:[1,0]
  v_pk_mul_f32 v[58:59], v[58:59], v[40:41] op_sel_hi:[1,0]
  v_cvt_pk_bf16_f32 v4, v52, v53
  v_cvt_pk_bf16_f32 v5, v54, v55
  v_cvt_pk_bf16_f32 v6, v56, v57
  v_cvt_pk_bf16_f32 v7, v58, v59
  buffer_store_dwordx4 v[4:7], v95, s[4:7], s30 offen sc1
  v_pk_mul_f32 v[60:61], v[60:61], v[40:41] op_sel_hi:[1,0]
  v_pk_mul_f32 v[62:63], v[62:63], v[40:41] op_sel_hi:[1,0]
  v_pk_mul_f32 v[64:65], v[64:65], v[40:41] op_sel_hi:[1,0]
  v_pk_mul_f32 v[66:67], v[66:67], v[40:41] op_sel_hi:[1,0]
  v_cvt_pk_bf16_f32 v8, v60, v61
  v_cvt_pk_bf16_f32 v9, v62, v63
  v_cvt_pk_bf16_f32 v10, v64, v65
  v_cvt_pk_bf16_f32 v11, v66, v67
  buffer_store_dwordx4 v[8:11], v95, s[4:7], s41 offen sc1
  s_add_u32 s30, s30, 2097152
  s_xor_b32 s30, s30, 0x2000
  s_branch L_QK_top
L_QK_park:
  s_waitcnt vmcnt(0)
  s_cmp_lt_u32 s25, 64
  s_cbranch_scc1 L_QK_rel
  s_barrier
  s_cmp_lg_u32 s20, 0
  s_cbranch_scc1 Lnosig_70
  s_mov_b32 s63, s25
  s_atomic_smax s63, s[4:5], s62 glc
Lnosig_70:
  s_branch L_END
L_QKM_nan:
  s_cmp_eq_u32 s51, s25
  s_cbranch_scc1 L_QKM_done
  s_mov_b32 s51, s25
  s_add_u32 s60, s60, 0x10000
  s_waitcnt vmcnt(0) lgkmcnt(0)
L_QKM_v0:
  s_sub_u32 s24, s24, 1
  s_cbranch_scc1 L_FAIL
  buffer_load_dwordx4 v[96:99], v95, s[4:7], s92 offen offset:0 sc1
  buffer_load_dwordx4 v[100:103], v95, s[4:7], s92 offen offset:2048 sc1
  buffer_load_dwordx4 v[68:71], v95, s[4:7], s93 offen offset:0 sc1
  buffer_load_dwordx4 v[72:75], v95, s[4:7], s93 offen offset:2048 sc1
  v_mov_b32 v89, 0
  s_waitcnt vmcnt(0)
  v_max3_u32 v89, v96, v97, v89
  v_max3_u32 v89, v98, v99, v89
  v_max3_u32 v89, v100, v101, v89
  v_max3_u32 v89, v102, v103, v89
  v_max3_u32 v89, v68, v69, v89
  v_max3_u32 v89, v70, v71, v89
  v_max3_u32 v89, v72, v73, v89
  v_max3_u32 v89, v74, v75, v89
  v_cmp_eq_u32 vcc, -1, v89
  s_cbranch_vccnz L_QKM_v0
L_QKM_v4:
  s_sub_u32 s24, s24, 1
  s_cbranch_scc1 L_FAIL
  buffer_load_dwordx4 v[4:7], v95, s[4:7], s94 offen offset:0 sc1
  buffer_load_dwordx4 v[8:11], v95, s[4:7], s94 offen offset:2048 sc1
  buffer_load_dwordx4 v[12:15], v95, s[4:7], s95 offen offset:0 sc1
  buffer_load_dwordx4 v[16:19], v95, s[4:7], s95 offen offset:2048 sc1
  v_mov_b32 v89, 0
  s_waitcnt vmcnt(0)
  v_max3_u32 v89, v4, v5, v89
  v_max3_u32 v89, v6, v7, v89
  v_max3_u32 v89, v8, v9, v89
  v_max3_u32 v89, v10, v11, v89
  v_max3_u32 v89, v12, v13, v89
  v_max3_u32 v89, v14, v15, v89
  v_max3_u32 v89, v16, v17, v89
  v_max3_u32 v89, v18, v19, v89
  v_cmp_eq_u32 vcc, -1, v89
  s_cbranch_vccnz L_QKM_v4
L_QKM_v8:
  s_sub_u32 s24, s24, 1
  s_cbranch_scc1 L_FAIL
  buffer_load_dwordx4 v[96:99], v95, s[4:7], s96 offen offset:0 sc1
  buffer_load_dwordx4 v[100:103], v95, s[4:7], s96 offen offset:2048 sc1
  buffer_load_dwordx4 v[68:71], v95, s[4:7], s97 offen offset:0 sc1
  buffer_load_dwordx4 v[72:75], v95, s[4:7], s97 offen offset:2048 sc1
  v_mov_b32 v89, 0
  s_waitcnt vmcnt(0)
  v_max3_u32 v89, v96, v97, v89
  v_max3_u32 v89, v98, v99, v89
  v_max3_u32 v89, v100, v101, v89
  v_max3_u32 v89, v102, v103, v89
  v_max3_u32 v89, v68, v69, v89
  v_max3_u32 v89, v70, v71, v89
  v_max3_u32 v89, v72, v73, v89
  v_max3_u32 v89, v74, v75, v89
  v_cmp_eq_u32 vcc, -1, v89
  s_cbranch_vccnz L_QKM_v8
L_QKM_v12:
  s_sub_u32 s24, s24, 1
  s_cbranch_scc1 L_FAIL
  buffer_load_dwordx4 v[4:7], v95, s[4:7], s98 offen offset:0 sc1
  buffer_load_dwordx4 v[8:11], v95, s[4:7], s98 offen offset:2048 sc1
  buffer_load_dwordx4 v[12:15], v95, s[4:7], s99 offen offset:0 sc1
  buffer_load_dwordx4 v[16:19], v95, s[4:7], s99 offen offset:2048 sc1
  v_mov_b32 v89, 0
  s_waitcnt vmcnt(0)
  v_max3_u32 v89, v4, v5, v89
  v_max3_u32 v89, v6, v7, v89
  v_max3_u32 v89, v8, v9, v89
  v_max3_u32 v89, v10, v11, v89
  v_max3_u32 v89, v12, v13, v89
  v_max3_u32 v89, v14, v15, v89
  v_max3_u32 v89, v16, v17, v89
  v_max3_u32 v89, v18, v19, v89
  v_cmp_eq_u32 vcc, -1, v89
  s_cbranch_vccnz L_QKM_v12
  v_mov_b64 v[52:53], 0
  v_mov_b64 v[54:55], 0
  v_mov_b64 v[56:57], 0
  v_mov_b64 v[58:59], 0
  v_mov_b64 v[60:61], 0
  v_mov_b64 v[62:63], 0
  v_mov_b64 v[64:65], 0
  v_mov_b64 v[66:67], 0
  ds_read_b128 v[20:23], v85 offset:0
  ds_read_b128 v[24:27], v85 offset:1024
  ds_read_b128 v[28:31], v85 offset:8192
  ds_read_b128 v[32:35], v85 offset:9216
  ds_read_b128 v[36:39], v85 offset:2048
  ds_read_b128 v[40:43], v85 offset:3072
  ds_read_b128 v[44:47], v85 offset:10240
  ds_read_b128 v[48:51], v85 offset:11264
  s_waitcnt lgkmcnt(0)
  s_branch L_QKM_again
L_QKM_g0:
  s_sub_u32 s24, s24, 1
  s_cbranch_scc1 L_FAIL
  s_add_u32 s60, s60, 1
  buffer_load_dwordx4 v[96:99], v95, s[4:7], s92 offen offset:0 sc1
  s_waitcnt vmcnt(0)
  v_cmp_eq_u32 vcc, -1, v96
  s_cbranch_vccnz L_QKM_g0
  v_mov_b32 v89, 0
  v_max3_u32 v89, v100, v68, v89
  v_max3_u32 v89, v72, v4, v89
  v_max3_u32 v89, v8, v8, v89
  v_cmp_eq_u32 vcc, -1, v89
  s_cbranch_vccz L_QKM_ok0
  buffer_load_dwordx4 v[100:103], v95, s[4:7], s92 offen offset:2048 sc1
  s_nop 0
  buffer_load_dwordx4 v[68:71], v95, s[4:7], s93 offen offset:0 sc1
  s_nop 0
  buffer_load_dwordx4 v[72:75], v95, s[4:7], s93 offen offset:2048 sc1
  s_nop 0
  buffer_load_dwordx4 v[4:7], v95, s[4:7], s94 offen offset:0 sc1
  s_nop 0
  buffer_load_dwordx4 v[8:11], v95, s[4:7], s94 offen offset:2048 sc1
  s_nop 0
  s_branch L_QKM_ok0
L_QKM_g1:
  s_sub_u32 s24, s24, 1
  s_cbranch_scc1 L_FAIL
  s_add_u32 s60, s60, 1
  buffer_load_dwordx4 v[100:103], v95, s[4:7], s92 offen offset:2048 sc1
  s_waitcnt vmcnt(0)
  v_cmp_eq_u32 vcc, -1, v100
  s_cbranch_vccnz L_QKM_g1
  v_mov_b32 v89, 0
  v_max3_u32 v89, v68, v72, v89
  v_max3_u32 v89, v4, v8, v89
  v_max3_u32 v89, v12, v16, v89
  v_cmp_eq_u32 vcc, -1, v89
  s_cbranch_vccz L_QKM_ok1
  buffer_load_dwordx4 v[68:71], v95, s[4:7], s93 offen offset:0 sc1
  s_nop 0
  buffer_load_dwordx4 v[72:75], v95, s[4:7], s93 offen offset:2048 sc1
  s_nop 0
  buffer_load_dwordx4 v[4:7], v95, s[4:7], s94 offen offset:0 sc1
  s_nop 0
  buffer_load_dwordx4 v[8:11], v95, s[4:7], s94 offen offset:2048 sc1
  s_nop 0
  buffer_load_dwordx4 v[12:15], v95, s[4:7], s95 offen offset:0 sc1
  s_nop 0
  buffer_load_dwordx4 v[16:19], v95, s[4:7], s95 offen offset:2048 sc1
  s_nop 0
  s_branch L_QKM_ok1
L_QKM_g2:
  s_sub_u32 s24, s24, 1
  s_cbranch_scc1 L_FAIL
  s_add_u32 s60, s60, 1
  buffer_load_dwordx4 v[68:71], v95, s[4:7], s93 offen offset:0 sc1
  s_waitcnt vmcnt(0)
  v_cmp_eq_u32 vcc, -1, v68
  s_cbranch_vccnz L_QKM_g2
  v_mov_b32 v89, 0
  v_max3_u32 v89, v72, v4, v89
  v_max3_u32 v89, v8, v12, v89
  v_max3_u32 v89, v16, v96, v89
  v_cmp_eq_u32 vcc, -1, v89
  s_cbranch_vccz L_QKM_ok2
  buffer_load_dwordx4 v[72:75], v95, s[4:7], s93 offen offset:2048 sc1
  s_nop 0
  buffer_load_dwordx4 v[4:7], v95, s[4:7], s94 offen offset:0 sc1
  s_nop 0
  buffer_load_dwordx4 v[8:11], v95, s[4:7], s94 offen offset:2048 sc1
  s_nop 0
  buffer_load_dwordx4 v[12:15], v95, s[4:7], s95 offen offset:0 sc1
  s_nop 0
  buffer_load_dwordx4 v[16:19], v95, s[4:7], s95 offen offset:2048 sc1
  s_nop 0
  buffer_load_dwordx4 v[96:99], v95, s[4:7], s96 offen offset:0 sc1
  s_nop 0
  s_branch L_QKM_ok2
L_QKM_g3:
  s_sub_u32 s24, s24, 1
  s_cbranch_scc1 L_FAIL
  s_add_u32 s60, s60, 1
  buffer_load_dwordx4 v[72:75], v95, s[4:7], s93 offen offset:2048 sc1
  s_waitcnt vmcnt(0)
  v_cmp_eq_u32 vcc, -1, v72
  s_cbranch_vccnz L_QKM_g3
  v_mov_b32 v89, 0
  v_max3_u32 v89, v4, v8, v89
  v_max3_u32 v89, v12, v16, v89
  v_max3_u32 v89, v96, v100, v89
  v_cmp_eq_u32 vcc, -1, v89
  s_cbranch_vccz L_QKM_ok3
  buffer_load_dwordx4 v[4:7], v95, s[4:7], s94 offen offset:0 sc1
  s_nop 0
  buffer_load_dwordx4 v[8:11], v95, s[4:7], s94 offen offset:2048 sc1
  s_nop 0
  buffer_load_dwordx4 v[12:15], v95, s[4:7], s95 offen offset:0 sc1
  s_nop 0
  buffer_load_dwordx4 v[16:19], v95, s[4:7], s95 offen offset:2048 sc1
  s_nop 0
  buffer_load_dwordx4 v[96:99], v95, s[4:7], s96 offen offset:0 sc1
  s_nop 0
  buffer_load_dwordx4 v[100:103], v95, s[4:7], s96 offen offset:2048 sc1
  s_nop 0
  s_branch L_QKM_ok3
L_QKM_g4:
  s_sub_u32 s24, s24, 1
  s_cbranch_scc1 L_FAIL
  s_add_u32 s60, s60, 1
  buffer_load_dwordx4 v[4:7], v95, s[4:7], s94 offen offset:0 sc1
  s_waitcnt vmcnt(0)
  v_cmp_eq_u32 vcc, -1, v4
  s_cbranch_vccnz L_QKM_g4
  v_mov_b32 v89, 0
  v_max3_u32 v89, v8, v12, v89
  v_max3_u32 v89, v16, v96, v89
  v_max3_u32 v89, v100, v68, v89
  v_cmp_eq_u32 vcc, -1, v89
  s_cbranch_vccz L_QKM_ok4
  buffer_load_dwordx4 v[8:11], v95, s[4:7], s94 offen offset:2048 sc1
  s_nop 0
  buffer_load_dwordx4 v[12:15], v95, s[4:7], s95 offen offset:0 sc1
  s_nop 0
  buffer_load_dwordx4 v[16:19], v95, s[4:7], s95 offen offset:2048 sc1
  s_nop 0
  buffer_load_dwordx4 v[96:99], v95, s[4:7], s96 offen offset:0 sc1
  s_nop 0
  buffer_load_dwordx4 v[100:103], v95, s[4:7], s96 offen offset:2048 sc1
  s_nop 0
  buffer_load_dwordx4 v[68:71], v95, s[4:7], s97 offen offset:0 sc1
  s_nop 0
  s_branch L_QKM_ok4
L_QKM_g5:
  s_sub_u32 s24, s24, 1
  s_cbranch_scc1 L_FAIL
  s_add_u32 s60, s60, 1
  buffer_load_dwordx4 v[8:11], v95, s[4:7], s94 offen offset:2048 sc1
  s_waitcnt vmcnt(0)
  v_cmp_eq_u32 vcc, -1, v8
  s_cbranch_vccnz L_QKM_g5
  v_mov_b32 v89, 0
  v_max3_u32 v89, v12, v16, v89
  v_max3_u32 v89, v96, v100, v89
  v_max3_u32 v89, v68, v72, v89
  v_cmp_eq_u32 vcc, -1, v89
  s_cbranch_vccz L_QKM_ok5
  buffer_load_dwordx4 v[12:15], v95, s[4:7], s95 offen offset:0 sc1
  s_nop 0
  buffer_load_dwordx4 v[16:19], v95, s[4:7], s95 offen offset:2048 sc1
  s_nop 0
  buffer_load_dwordx4 v[96:99], v95, s[4:7], s96 offen offset:0 sc1
  s_nop 0
  buffer_load_dwordx4 v[100:103], v95, s[4:7], s96 offen offset:2048 sc1
  s_nop 0
  buffer_load_dwordx4 v[68:71], v95, s[4:7], s97 offen offset:0 sc1
  s_nop 0
  buffer_load_dwordx4 v[72:75], v95, s[4:7], s97 offen offset:2048 sc1
  s_nop 0
  s_branch L_QKM_ok5
L_QKM_g6:
  s_sub_u32 s24, s24, 1
  s_cbranch_scc1 L_FAIL
  s_add_u32 s60, s60, 1
  buffer_load_dwordx4 v[12:15], v95, s[4:7], s95 offen offset:0 sc1
  s_waitcnt vmcnt(0)
  v_cmp_eq_u32 vcc, -1, v12
  s_cbranch_vccnz L_QKM_g6
  v_mov_b32 v89, 0
  v_max3_u32 v89, v16, v96, v89
  v_max3_u32 v89, v100, v68, v89
  v_max3_u32 v89, v72, v4, v89
  v_cmp_eq_u32 vcc, -1, v89
  s_cbranch_vccz L_QKM_ok6
  buffer_load_dwordx4 v[16:19], v95, s[4:7], s95 offen offset:2048 sc1
  s_nop 0
  buffer_load_dwordx4 v[96:99], v95, s[4:7], s96 offen offset:0 sc1
  s_nop 0
  buffer_load_dwordx4 v[100:103], v95, s[4:7], s96 offen offset:2048 sc1
  s_nop 0
  buffer_load_dwordx4 v[68:71], v95, s[4:7], s97 offen offset:0 sc1
  s_nop 0
  buffer_load_dwordx4 v[72:75], v95, s[4:7], s97 offen offset:2048 sc1
  s_nop 0
  buffer_load_dwordx4 v[4:7], v95, s[4:7], s98 offen offset:0 sc1
  s_nop 0
  s_branch L_QKM_ok6
L_QKM_g7:
  s_sub_u32 s24, s24, 1
  s_cbranch_scc1 L_FAIL
  s_add_u32 s60, s60, 1
  buffer_load_dwordx4 v[16:19], v95, s[4:7], s95 offen offset:2048 sc1
  s_waitcnt vmcnt(0)
  v_cmp_eq_u32 vcc, -1, v16
  s_cbranch_vccnz L_QKM_g7
  v_mov_b32 v89, 0
  v_max3_u32 v89, v96, v100, v89
  v_max3_u32 v89, v68, v72, v89
  v_max3_u32 v89, v4, v8, v89
  v_cmp_eq_u32 vcc, -1, v89
  s_cbranch_vccz L_QKM_ok7
  buffer_load_dwordx4 v[96:99], v95, s[4:7], s96 offen offset:0 sc1
  s_nop 0
  buffer_load_dwordx4 v[100:103], v95, s[4:7], s96 offen offset:2048 sc1
  s_nop 0
  buffer_load_dwordx4 v[68:71], v95, s[4:7], s97 offen offset:0 sc1
  s_nop 0
  buffer_load_dwordx4 v[72:75], v95, s[4:7], s97 offen offset:2048 sc1
  s_nop 0
  buffer_load_dwordx4 v[4:7], v95, s[4:7], s98 offen offset:0 sc1
  s_nop 0
  buffer_load_dwordx4 v[8:11], v95, s[4:7], s98 offen offset:2048 sc1
  s_nop 0
  s_branch L_QKM_ok7
L_QKM_g8:
  s_sub_u32 s24, s24, 1
  s_cbranch_scc1 L_FAIL
  s_add_u32 s60, s60, 256
  buffer_load_dwordx4 v[96:99], v95, s[4:7], s96 offen offset:0 sc1
  s_waitcnt vmcnt(0)
  v_cmp_eq_u32 vcc, -1, v96
  s_cbranch_vccnz L_QKM_g8
  v_mov_b32 v89, 0
  v_max3_u32 v89, v100, v68, v89
  v_max3_u32 v89, v72, v4, v89
  v_max3_u32 v89, v8, v12, v89
  v_cmp_eq_u32 vcc, -1, v89
  s_cbranch_vccz L_QKM_ok8
  buffer_load_dwordx4 v[100:103], v95, s[4:7], s96 offen offset:2048 sc1
  s_nop 0
  buffer_load_dwordx4 v[68:71], v95, s[4:7], s97 offen offset:0 sc1
  s_nop 0
  buffer_load_dwordx4 v[72:75], v95, s[4:7], s97 offen offset:2048 sc1
  s_nop 0
  buffer_load_dwordx4 v[4:7], v95, s[4:7], s98 offen offset:0 sc1
  s_nop 0
  buffer_load_dwordx4 v[8:11], v95, s[4:7], s98 offen offset:2048 sc1
  s_nop 0
  buffer_load_dwordx4 v[12:15], v95, s[4:7], s99 offen offset:0 sc1
  s_nop 0
  s_branch L_QKM_ok8
L_QKM_g9:
  s_sub_u32 s24, s24, 1
  s_cbranch_scc1 L_FAIL
  s_add_u32 s60, s60, 256
  buffer_load_dwordx4 v[100:103], v95, s[4:7], s96 offen offset:2048 sc1
  s_waitcnt vmcnt(0)
  v_cmp_eq_u32 vcc, -1, v100
  s_cbranch_vccnz L_QKM_g9
  v_mov_b32 v89, 0
  v_max3_u32 v89, v68, v72, v89
  v_max3_u32 v89, v4, v8, v89
  v_max3_u32 v89, v12, v16, v89
  v_cmp_eq_u32 vcc, -1, v89
  s_cbranch_vccz L_QKM_ok9
  buffer_load_dwordx4 v[68:71], v95, s[4:7], s97 offen offset:0 sc1
  s_nop 0
  buffer_load_dwordx4 v[72:75], v95, s[4:7], s97 offen offset:2048 sc1
  s_nop 0
  buffer_load_dwordx4 v[4:7], v95, s[4:7], s98 offen offset:0 sc1
  s_nop 0
  buffer_load_dwordx4 v[8:11], v95, s[4:7], s98 offen offset:2048 sc1
  s_nop 0
  buffer_load_dwordx4 v[12:15], v95, s[4:7], s99 offen offset:0 sc1
  s_nop 0
  buffer_load_dwordx4 v[16:19], v95, s[4:7], s99 offen offset:2048 sc1
  s_nop 0
  s_branch L_QKM_ok9
L_QKM_g10:
  s_sub_u32 s24, s24, 1
  s_cbranch_scc1 L_FAIL
  s_add_u32 s60, s60, 256
  buffer_load_dwordx4 v[68:71], v95, s[4:7], s97 offen offset:0 sc1
  s_waitcnt vmcnt(0)
  v_cmp_eq_u32 vcc, -1, v68
  s_cbranch_vccnz L_QKM_g10
  v_mov_b32 v89, 0
  v_max3_u32 v89, v72, v4, v89
  v_max3_u32 v89, v8, v12, v89
  v_max3_u32 v89, v16, v16, v89
  v_cmp_eq_u32 vcc, -1, v89
  s_cbranch_vccz L_QKM_ok10
  buffer_load_dwordx4 v[72:75], v95, s[4:7], s97 offen offset:2048 sc1
  s_nop 0
  buffer_load_dwordx4 v[4:7], v95, s[4:7], s98 offen offset:0 sc1
  s_nop 0
  buffer_load_dwordx4 v[8:11], v95, s[4:7], s98 offen offset:2048 sc1
  s_nop 0
  buffer_load_dwordx4 v[12:15], v95, s[4:7], s99 offen offset:0 sc1
  s_nop 0
  buffer_load_dwordx4 v[16:19], v95, s[4:7], s99 offen offset:2048 sc1
  s_nop 0
  s_branch L_QKM_ok10
L_QKM_g11:
  s_sub_u32 s24, s24, 1
  s_cbranch_scc1 L_FAIL
  s_add_u32 s60, s60, 256
  buffer_load_dwordx4 v[72:75], v95, s[4:7], s97 offen offset:2048 sc1
  s_waitcnt vmcnt(0)
  v_cmp_eq_u32 vcc, -1, v72
  s_cbranch_vccnz L_QKM_g11
  v_mov_b32 v89, 0
  v_max3_u32 v89, v4, v8, v89
  v_max3_u32 v89, v12, v16, v89
  v_cmp_eq_u32 vcc, -1, v89
  s_cbranch_vccz L_QKM_ok11
  buffer_load_dwordx4 v[4:7], v95, s[4:7], s98 offen offset:0 sc1
  s_nop 0
  buffer_load_dwordx4 v[8:11], v95, s[4:7], s98 offen offset:2048 sc1
  s_nop 0
  buffer_load_dwordx4 v[12:15], v95, s[4:7], s99 offen offset:0 sc1
  s_nop 0
  buffer_load_dwordx4 v[16:19], v95, s[4:7], s99 offen offset:2048 sc1
  s_nop 0
  s_branch L_QKM_ok11
L_QKM_g12:
  s_sub_u32 s24, s24, 1
  s_cbranch_scc1 L_FAIL
  s_add_u32 s60, s60, 256
  buffer_load_dwordx4 v[4:7], v95, s[4:7], s98 offen offset:0 sc1
  s_waitcnt vmcnt(0)
  v_cmp_eq_u32 vcc, -1, v4
  s_cbranch_vccnz L_QKM_g12
  v_mov_b32 v89, 0
  v_max3_u32 v89, v8, v12, v89
  v_max3_u32 v89, v16, v16, v89
  v_cmp_eq_u32 vcc, -1, v89
  s_cbranch_vccz L_QKM_ok12
  buffer_load_dwordx4 v[8:11], v95, s[4:7], s98 offen offset:2048 sc1
  s_nop 0
  buffer_load_dwordx4 v[12:15], v95, s[4:7], s99 offen offset:0 sc1
  s_nop 0
  buffer_load_dwordx4 v[16:19], v95, s[4:7], s99 offen offset:2048 sc1
  s_nop 0
  s_branch L_QKM_ok12
L_QKM_g13:
  s_sub_u32 s24, s24, 1
  s_cbranch_scc1 L_FAIL
  s_add_u32 s60, s60, 256
  buffer_load_dwordx4 v[8:11], v95, s[4:7], s98 offen offset:2048 sc1
  s_waitcnt vmcnt(0)
  v_cmp_eq_u32 vcc, -1, v8
  s_cbranch_vccnz L_QKM_g13
  v_mov_b32 v89, 0
  v_max3_u32 v89, v12, v16, v89
  v_cmp_eq_u32 vcc, -1, v89
  s_cbranch_vccz L_QKM_ok13
  buffer_load_dwordx4 v[12:15], v95, s[4:7], s99 offen offset:0 sc1
  s_nop 0
  buffer_load_dwordx4 v[16:19], v95, s[4:7], s99 offen offset:2048 sc1
  s_nop 0
  s_branch L_QKM_ok13
L_QKM_g14:
  s_sub_u32 s24, s24, 1
  s_cbranch_scc1 L_FAIL
  s_add_u32 s60, s60, 256
  buffer_load_dwordx4 v[12:15], v95, s[4:7], s99 offen offset:0 sc1
  s_waitcnt vmcnt(0)
  v_cmp_eq_u32 vcc, -1, v12
  s_cbranch_vccnz L_QKM_g14
  v_mov_b32 v89, 0
  v_max3_u32 v89, v16, v16, v89
  v_cmp_eq_u32 vcc, -1, v89
  s_cbranch_vccz L_QKM_ok14
  buffer_load_dwordx4 v[16:19], v95, s[4:7], s99 offen offset:2048 sc1
  s_nop 0
  s_branch L_QKM_ok14
L_QKM_g15:
  s_sub_u32 s24, s24, 1
  s_cbranch_scc1 L_FAIL
  s_add_u32 s60, s60, 256
  buffer_load_dwordx4 v[16:19], v95, s[4:7], s99 offen offset:2048 sc1
  s_waitcnt vmcnt(0)
  v_cmp_eq_u32 vcc, -1, v16
  s_cbranch_vccnz L_QKM_g15
  s_branch L_QKM_ok15
L_QK_vbad:
  s_sub_u32 s24, s24, 1
  s_cbranch_scc1 L_FAIL
  s_add_u32 s61, s61, 1
  buffer_load_dwordx2 v[104:105], v92, s[4:7], s29 offen sc1
  buffer_load_dwordx2 v[106:107], v92, s[4:7], s35 offen sc1
  s_waitcnt vmcnt(0)
  v_max3_u32 v89, v104, v105, v106
  v_max_u32 v89, v89, v107
  v_cmp_eq_u32 vcc, -1, v89
  s_cbranch_vccnz L_QK_vbad
  s_branch L_QK_vok
L_VO:
  v_bfe_u32 v76, v0, 3, 2
  v_xor_b32 v76, s20, v76
  v_lshlrev_b32 v76, 5, v76
  v_lshrrev_b32 v4, 2, v0
  v_lshl_add_u32 v4, v4, 7, v76
  v_and_b32 v76, 3, v0
  v_lshl_add_u32 v4, v76, 3, v4
  s_lshl_b32 s40, s20, 15
  v_add_u32 v4, s40, v4
  v_lshl_add_u32 v85, v0, 4, s40
  s_lshl_b32 s40, s20, 12
  s_add_u32 s40, s40, 131072
  v_lshl_add_u32 v1, v0, 4, s40
  s_lshr_b32 s54, s21, 4
  s_lshl_b32 s52, s54, 22
  s_sub_u32 s53, 0, s52
  v_xor_b32 v5, 32768, v4
  v_xor_b32 v2, 4096, v1
  v_xor_b32 v6, 65536, v4
  v_xor_b32 v3, 8192, v1
  v_xor_b32 v7, 98304, v4
  v_xor_b32 v84, 12288, v1
  v_bfe_u32 v8, v0, 5, 1
  v_mul_u32_u24 v8, 16384, v8
  v_bfe_u32 v76, v0, 4, 1
  v_mul_u32_u24 v76, 32768, v76
  v_add_u32 v8, v8, v76
  v_bfe_u32 v76, v0, 3, 1
  v_mul_u32_u24 v76, 131072, v76
  v_add_u32 v8, v8, v76
  v_lshrrev_b32 v76, 3, v0
  v_and_b32 v76, 6, v76
  v_xor_b32 v76, v76, v0
  v_and_b32 v76, 7, v76
  v_lshl_add_u32 v8, v76, 4, v8
  s_lshl_b32 s40, s20, 19
  v_add_u32 v8, s40, v8
  s_lshl_b32 s44, s21, 8
  s_add_u32 s45, s44, 128
  s_load_dwordx2 s[8:9], s[0:1], 32
  s_mov_b32 s10, 8388608
  s_mov_b32 s11, 0x20000
  s_waitcnt lgkmcnt(0)
  v_add_u32 v9, s44, v8
  v_add_u32 v10, s45, v8
  s_lshl_b32 s41, s20, 15
  s_add_u32 m0, s41, 0
  s_add_u32 s42, s52, 0
  buffer_load_dwordx4 v9, s[8:11], s42 offen lds
  s_add_u32 m0, s41, 1024
  s_add_u32 s42, s52, 65536
  buffer_load_dwordx4 v9, s[8:11], s42 offen lds
  s_add_u32 m0, s41, 2048
  s_add_u32 s42, s52, 8192
  buffer_load_dwordx4 v9, s[8:11], s42 offen lds
  s_add_u32 m0, s41, 3072
  s_add_u32 s42, s52, 73728
  buffer_load_dwordx4 v9, s[8:11], s42 offen lds
  s_add_u32 m0, s41, 4096
  s_add_u32 s42, s52, 262144
  buffer_load_dwordx4 v9, s[8:11], s42 offen lds
  s_add_u32 m0, s41, 5120
  s_add_u32 s42, s52, 327680
  buffer_load_dwordx4 v9, s[8:11], s42 offen lds
  s_add_u32 m0, s41, 6144
  s_add_u32 s42, s52, 270336
  buffer_load_dwordx4 v9, s[8:11], s42 offen lds
  s_add_u32 m0, s41, 7168
  s_add_u32 s42, s52, 335872
  buffer_load_dwordx4 v9, s[8:11], s42 offen lds
  s_add_u32 m0, s41, 8192
  s_add_u32 s42, s52, 2097152
  buffer_load_dwordx4 v9, s[8:11], s42 offen lds
  s_add_u32 m0, s41, 9216
  s_add_u32 s42, s52, 2162688
  buffer_load_dwordx4 v9, s[8:11], s42 offen lds
  s_add_u32 m0, s41, 10240
  s_add_u32 s42, s52, 2105344
  buffer_load_dwordx4 v9, s[8:11], s42 offen lds
  s_add_u32 m0, s41, 11264
  s_add_u32 s42, s52, 2170880
  buffer_load_dwordx4 v9, s[8:11], s42 offen lds
  s_add_u32 m0, s41, 12288
  s_add_u32 s42, s52, 2359296
  buffer_load_dwordx4 v9, s[8:11], s42 offen lds
  s_add_u32 m0, s41, 13312
  s_add_u32 s42, s52, 2424832
  buffer_load_dwordx4 v9, s[8:11], s42 offen lds
  s_add_u32 m0, s41, 14336
  s_add_u32 s42, s52, 2367488
  buffer_load_dwordx4 v9, s[8:11], s42 offen lds
  s_add_u32 m0, s41, 15360
  s_add_u32 s42, s52, 2433024
  buffer_load_dwordx4 v9, s[8:11], s42 offen lds
  s_add_u32 m0, s41, 16384
  s_add_u32 s42, s53, 4194304
  buffer_load_dwordx4 v9, s[8:11], s42 offen lds
  s_add_u32 m0, s41, 17408
  s_add_u32 s42, s53, 4259840
  buffer_load_dwordx4 v9, s[8:11], s42 offen lds
  s_add_u32 m0, s41, 18432
  s_add_u32 s42, s53, 4202496
  buffer_load_dwordx4 v9, s[8:11], s42 offen lds
  s_add_u32 m0, s41, 19456
  s_add_u32 s42, s53, 4268032
  buffer_load_dwordx4 v9, s[8:11], s42 offen lds
  s_add_u32 m0, s41, 20480
  s_add_u32 s42, s53, 4456448
  buffer_load_dwordx4 v9, s[8:11], s42 offen lds
  s_add_u32 m0, s41, 21504
  s_add_u32 s42, s53, 4521984
  buffer_load_dwordx4 v9, s[8:11], s42 offen lds
  s_add_u32 m0, s41, 22528
  s_add_u32 s42, s53, 4464640
  buffer_load_dwordx4 v9, s[8:11], s42 offen lds
  s_add_u32 m0, s41, 23552
  s_add_u32 s42, s53, 4530176
  buffer_load_dwordx4 v9, s[8:11], s42 offen lds
  s_waitcnt vmcnt(16) lgkmcnt(0)
  s_barrier
  s_add_u32 m0, s41, 24576
  s_add_u32 s42, s53, 6291456
  buffer_load_dwordx4 v9, s[8:11], s42 offen lds
  s_add_u32 m0, s41, 25600
  s_add_u32 s42, s53, 6356992
  buffer_load_dwordx4 v9, s[8:11], s42 offen lds
  s_add_u32 m0, s41, 26624
  s_add_u32 s42, s53, 6299648
  buffer_load_dwordx4 v9, s[8:11], s42 offen lds
  s_add_u32 m0, s41, 27648
  s_add_u32 s42, s53, 6365184
  buffer_load_dwordx4 v9, s[8:11], s42 offen lds
  s_add_u32 m0, s41, 28672
  s_add_u32 s42, s53, 6553600
  buffer_load_dwordx4 v9, s[8:11], s42 offen lds
  s_add_u32 m0, s41, 29696
  s_add_u32 s42, s53, 6619136
  buffer_load_dwordx4 v9, s[8:11], s42 offen lds
  s_add_u32 m0, s41, 30720
  s_add_u32 s42, s53, 6561792
  buffer_load_dwordx4 v9, s[8:11], s42 offen lds
  s_add_u32 m0, s41, 31744
  s_add_u32 s42, s53, 6627328
  buffer_load_dwordx4 v9, s[8:11], s42 offen lds
  ds_read_b64_tr_b16 v[128:129], v4 offset:0
  ds_read_b64_tr_b16 v[130:131], v4 offset:2048
  ds_read_b64_tr_b16 v[132:133], v4 offset:4096
  ds_read_b64_tr_b16 v[134:135], v4 offset:6144
  ds_read_b64_tr_b16 v[144:145], v5 offset:0
  ds_read_b64_tr_b16 v[146:147], v5 offset:2048
  ds_read_b64_tr_b16 v[148:149], v5 offset:4096
  ds_read_b64_tr_b16 v[150:151], v5 offset:6144
  ds_read_b64_tr_b16 v[160:161], v6 offset:0
  ds_read_b64_tr_b16 v[162:163], v6 offset:2048
  ds_read_b64_tr_b16 v[164:165], v6 offset:4096
  ds_read_b64_tr_b16 v[166:167], v6 offset:6144
  ds_read_b64_tr_b16 v[176:177], v7 offset:0
  ds_read_b64_tr_b16 v[178:179], v7 offset:2048
  ds_read_b64_tr_b16 v[180:181], v7 offset:4096
  ds_read_b64_tr_b16 v[182:183], v7 offset:6144
  s_waitcnt vmcnt(16) lgkmcnt(0)
  s_barrier
  s_add_u32 m0, s41, 0
  s_add_u32 s42, s52, 0
  buffer_load_dwordx4 v10, s[8:11], s42 offen lds
  s_add_u32 m0, s41, 1024
  s_add_u32 s42, s52, 65536
  buffer_load_dwordx4 v10, s[8:11], s42 offen lds
  s_add_u32 m0, s41, 2048
  s_add_u32 s42, s52, 8192
  buffer_load_dwordx4 v10, s[8:11], s42 offen lds
  s_add_u32 m0, s41, 3072
  s_add_u32 s42, s52, 73728
  buffer_load_dwordx4 v10, s[8:11], s42 offen lds
  s_add_u32 m0, s41, 4096
  s_add_u32 s42, s52, 262144
  buffer_load_dwordx4 v10, s[8:11], s42 offen lds
  s_add_u32 m0, s41, 5120
  s_add_u32 s42, s52, 327680
  buffer_load_dwordx4 v10, s[8:11], s42 offen lds
  s_add_u32 m0, s41, 6144
  s_add_u32 s42, s52, 270336
  buffer_load_dwordx4 v10, s[8:11], s42 offen lds
  s_add_u32 m0, s41, 7168
  s_add_u32 s42, s52, 335872
  buffer_load_dwordx4 v10, s[8:11], s42 offen lds
  ds_read_b64_tr_b16 v[136:137], v4 offset:8192
  ds_read_b64_tr_b16 v[138:139], v4 offset:10240
  ds_read_b64_tr_b16 v[140:141], v4 offset:12288
  ds_read_b64_tr_b16 v[142:143], v4 offset:14336
  ds_read_b64_tr_b16 v[152:153], v5 offset:8192
  ds_read_b64_tr_b16 v[154:155], v5 offset:10240
  ds_read_b64_tr_b16 v[156:157], v5 offset:12288
  ds_read_b64_tr_b16 v[158:159], v5 offset:14336
  ds_read_b64_tr_b16 v[168:169], v6 offset:8192
  ds_read_b64_tr_b16 v[170:171], v6 offset:10240
  ds_read_b64_tr_b16 v[172:173], v6 offset:12288
  ds_read_b64_tr_b16 v[174:175], v6 offset:14336
  ds_read_b64_tr_b16 v[184:185], v7 offset:8192
  ds_read_b64_tr_b16 v[186:187], v7 offset:10240
  ds_read_b64_tr_b16 v[188:189], v7 offset:12288
  ds_read_b64_tr_b16 v[190:191], v7 offset:14336
  s_waitcnt vmcnt(16) lgkmcnt(0)
  s_barrier
  s_add_u32 m0, s41, 8192
  s_add_u32 s42, s52, 2097152
  buffer_load_dwordx4 v10, s[8:11], s42 offen lds
  s_add_u32 m0, s41, 9216
  s_add_u32 s42, s52, 2162688
  buffer_load_dwordx4 v10, s[8:11], s42 offen lds
  s_add_u32 m0, s41, 10240
  s_add_u32 s42, s52, 2105344
  buffer_load_dwordx4 v10, s[8:11], s42 offen lds
  s_add_u32 m0, s41, 11264
  s_add_u32 s42, s52, 2170880
  buffer_load_dwordx4 v10, s[8:11], s42 offen lds
  s_add_u32 m0, s41, 12288
  s_add_u32 s42, s52, 2359296
  buffer_load_dwordx4 v10, s[8:11], s42 offen lds
  s_add_u32 m0, s41, 13312
  s_add_u32 s42, s52, 2424832
  buffer_load_dwordx4 v10, s[8:11], s42 offen lds
  s_add_u32 m0, s41, 14336
  s_add_u32 s42, s52, 2367488
  buffer_load_dwordx4 v10, s[8:11], s42 offen lds
  s_add_u32 m0, s41, 15360
  s_add_u32 s42, s52, 2433024
  buffer_load_dwordx4 v10, s[8:11], s42 offen lds
  ds_read_b64_tr_b16 v[192:193], v4 offset:16384
  ds_read_b64_tr_b16 v[194:195], v4 offset:18432
  ds_read_b64_tr_b16 v[196:197], v4 offset:20480
  ds_read_b64_tr_b16 v[198:199], v4 offset:22528
  ds_read_b64_tr_b16 v[208:209], v5 offset:16384
  ds_read_b64_tr_b16 v[210:211], v5 offset:18432
  ds_read_b64_tr_b16 v[212:213], v5 offset:20480
  ds_read_b64_tr_b16 v[214:215], v5 offset:22528
  ds_read_b64_tr_b16 v[224:225], v6 offset:16384
  ds_read_b64_tr_b16 v[226:227], v6 offset:18432
  ds_read_b64_tr_b16 v[228:229], v6 offset:20480
  ds_read_b64_tr_b16 v[230:231], v6 offset:22528
  ds_read_b64_tr_b16 v[240:241], v7 offset:16384
  ds_read_b64_tr_b16 v[242:243], v7 offset:18432
  ds_read_b64_tr_b16 v[244:245], v7 offset:20480
  ds_read_b64_tr_b16 v[246:247], v7 offset:22528
  s_waitcnt vmcnt(16) lgkmcnt(0)
  s_barrier
  s_add_u32 m0, s41, 16384
  s_add_u32 s42, s53, 4194304
  buffer_load_dwordx4 v10, s[8:11], s42 offen lds
  s_add_u32 m0, s41, 17408
  s_add_u32 s42, s53, 4259840
  buffer_load_dwordx4 v10, s[8:11], s42 offen lds
  s_add_u32 m0, s41, 18432
  s_add_u32 s42, s53, 4202496
  buffer_load_dwordx4 v10, s[8:11], s42 offen lds
  s_add_u32 m0, s41, 19456
  s_add_u32 s42, s53, 4268032
  buffer_load_dwordx4 v10, s[8:11], s42 offen lds
  s_add_u32 m0, s41, 20480
  s_add_u32 s42, s53, 4456448
  buffer_load_dwordx4 v10, s[8:11], s42 offen lds
  s_add_u32 m0, s41, 21504
  s_add_u32 s42, s53, 4521984
  buffer_load_dwordx4 v10, s[8:11], s42 offen lds
  s_add_u32 m0, s41, 22528
  s_add_u32 s42, s53, 4464640
  buffer_load_dwordx4 v10, s[8:11], s42 offen lds
  s_add_u32 m0, s41, 23552
  s_add_u32 s42, s53, 4530176
  buffer_load_dwordx4 v10, s[8:11], s42 offen lds
  ds_read_b64_tr_b16 v[200:201], v4 offset:24576
  ds_read_b64_tr_b16 v[202:203], v4 offset:26624
  ds_read_b64_tr_b16 v[204:205], v4 offset:28672
  ds_read_b64_tr_b16 v[206:207], v4 offset:30720
  ds_read_b64_tr_b16 v[216:217], v5 offset:24576
  ds_read_b64_tr_b16 v[218:219], v5 offset:26624
  ds_read_b64_tr_b16 v[220:221], v5 offset:28672
  ds_read_b64_tr_b16 v[222:223], v5 offset:30720
  ds_read_b64_tr_b16 v[232:233], v6 offset:24576
  ds_read_b64_tr_b16 v[234:235], v6 offset:26624
  ds_read_b64_tr_b16 v[236:237], v6 offset:28672
  ds_read_b64_tr_b16 v[238:239], v6 offset:30720
  ds_read_b64_tr_b16 v[248:249], v7 offset:24576
  ds_read_b64_tr_b16 v[250:251], v7 offset:26624
  ds_read_b64_tr_b16 v[252:253], v7 offset:28672
  ds_read_b64_tr_b16 v[254:255], v7 offset:30720
  s_cmp_lg_u32 s20, 0
  s_cbranch_scc1 Lchore_71
Lini_72:
  s_load_dwordx16 s[64:79], s[12:13], 128 glc
  s_load_dwordx16 s[80:95], s[12:13], 192 glc
  s_sub_u32 s24, s24, 1
  s_cbranch_scc1 L_FAIL
  s_waitcnt lgkmcnt(0)
  s_and_b64 s[64:65], s[64:65], s[66:67]
  s_and_b64 s[64:65], s[64:65], s[68:69]
  s_and_b64 s[64:65], s[64:65], s[70:71]
  s_and_b64 s[64:65], s[64:65], s[72:73]
  s_and_b64 s[64:65], s[64:65], s[74:75]
  s_and_b64 s[64:65], s[64:65], s[76:77]
  s_and_b64 s[64:65], s[64:65], s[78:79]
  s_and_b64 s[64:65], s[64:65], s[80:81]
  s_and_b64 s[64:65], s[64:65], s[82:83]
  s_and_b64 s[64:65], s[64:65], s[84:85]
  s_and_b64 s[64:65], s[64:65], s[86:87]
  s_and_b64 s[64:65], s[64:65], s[88:89]
  s_and_b64 s[64:65], s[64:65], s[90:91]
  s_and_b64 s[64:65], s[64:65], s[92:93]
  s_and_b64 s[64:65], s[64:65], s[94:95]
  s_and_b32 s64, s64, s65
  s_cbranch_scc0 Lini_72
  s_mov_b32 s46, 0xffff
  s_and_b32 s40, s21, 3
  s_lshl_b32 s40, s40, 13
  s_lshr_b32 s43, s21, 2
  s_lshl_b32 s43, s43, 10
  s_add_u32 s43, s43, s40
  s_add_u32 s43, s43, 1344000
  s_waitcnt lgkmcnt(0)
  s_memtime s[64:65]
  s_waitcnt lgkmcnt(0)
  s_load_dword s68, s[4:5], s43 glc
  s_waitcnt lgkmcnt(0)
  s_memtime s[66:67]
  s_waitcnt lgkmcnt(0)
  s_sub_u32 s64, s66, s64
  s_min_u32 s46, s46, s64
  s_getreg_b32 s55, hwreg(HW_REG_XCC_ID)
  s_and_b32 s55, s55, 15
  s_lshl_b32 s46, s46, 8
  s_or_b32 s46, s46, s55
  s_add_u32 s40, s21, 32
  s_lshl_b32 s40, s40, 7
  s_add_u32 s40, s40, 1424384
  s_mov_b32 s63, s46
  s_atomic_smax s63, s[4:5], s40 glc
Lnosig_73:
Lchore_71:
  s_waitcnt vmcnt(16) lgkmcnt(0)
  s_barrier
  s_add_u32 m0, s41, 24576
  s_add_u32 s42, s53, 6291456
  buffer_load_dwordx4 v10, s[8:11], s42 offen lds
  s_add_u32 m0, s41, 25600
  s_add_u32 s42, s53, 6356992
  buffer_load_dwordx4 v10, s[8:11], s42 offen lds
  s_add_u32 m0, s41, 26624
  s_add_u32 s42, s53, 6299648
  buffer_load_dwordx4 v10, s[8:11], s42 offen lds
  s_add_u32 m0, s41, 27648
  s_add_u32 s42, s53, 6365184
  buffer_load_dwordx4 v10, s[8:11], s42 offen lds
  s_add_u32 m0, s41, 28672
  s_add_u32 s42, s53, 6553600
  buffer_load_dwordx4 v10, s[8:11], s42 offen lds
  s_add_u32 m0, s41, 29696
  s_add_u32 s42, s53, 6619136
  buffer_load_dwordx4 v10, s[8:11], s42 offen lds
  s_add_u32 m0, s41, 30720
  s_add_u32 s42, s53, 6561792
  buffer_load_dwordx4 v10, s[8:11], s42 offen lds
  s_add_u32 m0, s41, 31744
  s_add_u32 s42, s53, 6627328
  buffer_load_dwordx4 v10, s[8:11], s42 offen lds
  ds_read_b64_tr_b16 v[20:21], v4 offset:0
  ds_read_b64_tr_b16 v[22:23], v4 offset:2048
  ds_read_b64_tr_b16 v[24:25], v4 offset:4096
  ds_read_b64_tr_b16 v[26:27], v4 offset:6144
  ds_read_b64_tr_b16 v[28:29], v5 offset:0
  ds_read_b64_tr_b16 v[30:31], v5 offset:2048
  ds_read_b64_tr_b16 v[32:33], v5 offset:4096
  ds_read_b64_tr_b16 v[34:35], v5 offset:6144
  ds_read_b64_tr_b16 v[36:37], v6 offset:0
  ds_read_b64_tr_b16 v[38:39], v6 offset:2048
  ds_read_b64_tr_b16 v[40:41], v6 offset:4096
  ds_read_b64_tr_b16 v[42:43], v6 offset:6144
  ds_read_b64_tr_b16 v[44:45], v7 offset:0
  ds_read_b64_tr_b16 v[46:47], v7 offset:2048
  ds_read_b64_tr_b16 v[48:49], v7 offset:4096
  ds_read_b64_tr_b16 v[50:51], v7 offset:6144
  s_waitcnt lgkmcnt(0)
  s_barrier
  ds_write_b128 v85, v[20:23] offset:0
  ds_write_b128 v85, v[24:27] offset:1024
  ds_write_b128 v85, v[28:31] offset:2048
  ds_write_b128 v85, v[32:35] offset:3072
  ds_write_b128 v85, v[36:39] offset:4096
  ds_write_b128 v85, v[40:43] offset:5120
  ds_write_b128 v85, v[44:47] offset:6144
  ds_write_b128 v85, v[48:51] offset:7168
  s_waitcnt vmcnt(16) lgkmcnt(0)
  s_barrier
  ds_read_b64_tr_b16 v[20:21], v4 offset:8192
  ds_read_b64_tr_b16 v[22:23], v4 offset:10240
  ds_read_b64_tr_b16 v[24:25], v4 offset:12288
  ds_read_b64_tr_b16 v[26:27], v4 offset:14336
  ds_read_b64_tr_b16 v[28:29], v5 offset:8192
  ds_read_b64_tr_b16 v[30:31], v5 offset:10240
  ds_read_b64_tr_b16 v[32:33], v5 offset:12288
  ds_read_b64_tr_b16 v[34:35], v5 offset:14336
  ds_read_b64_tr_b16 v[36:37], v6 offset:8192
  ds_read_b64_tr_b16 v[38:39], v6 offset:10240
  ds_read_b64_tr_b16 v[40:41], v6 offset:12288
  ds_read_b64_tr_b16 v[42:43], v6 offset:14336
  ds_read_b64_tr_b16 v[44:45], v7 offset:8192
  ds_read_b64_tr_b16 v[46:47], v7 offset:10240
  ds_read_b64_tr_b16 v[48:49], v7 offset:12288
  ds_read_b64_tr_b16 v[50:51], v7 offset:14336
  s_waitcnt lgkmcnt(0)
  s_barrier
  ds_write_b128 v85, v[20:23] offset:8192
  ds_write_b128 v85, v[24:27] offset:9216
  ds_write_b128 v85, v[28:31] offset:10240
  ds_write_b128 v85, v[32:35] offset:11264
  ds_write_b128 v85, v[36:39] offset:12288
  ds_write_b128 v85, v[40:43] offset:13312
  ds_write_b128 v85, v[44:47] offset:14336
  ds_write_b128 v85, v[48:51] offset:15360
  s_waitcnt vmcnt(8) lgkmcnt(0)
  s_barrier
  ds_read_b64_tr_b16 v[20:21], v4 offset:16384
  ds_read_b64_tr_b16 v[22:23], v4 offset:18432
  ds_read_b64_tr_b16 v[24:25], v4 offset:20480
  ds_read_b64_tr_b16 v[26:27], v4 offset:22528
  ds_read_b64_tr_b16 v[28:29], v5 offset:16384
  ds_read_b64_tr_b16 v[30:31], v5 offset:18432
  ds_read_b64_tr_b16 v[32:33], v5 offset:20480
  ds_read_b64_tr_b16 v[34:35], v5 offset:22528
  ds_read_b64_tr_b16 v[36:37], v6 offset:16384
  ds_read_b64_tr_b16 v[38:39], v6 offset:18432
  ds_read_b64_tr_b16 v[40:41], v6 offset:20480
  ds_read_b64_tr_b16 v[42:43], v6 offset:22528
  ds_read_b64_tr_b16 v[44:45], v7 offset:16384
  ds_read_b64_tr_b16 v[46:47], v7 offset:18432
  ds_read_b64_tr_b16 v[48:49], v7 offset:20480
  ds_read_b64_tr_b16 v[50:51], v7 offset:22528
  s_waitcnt lgkmcnt(0)
  s_barrier
  ds_write_b128 v85, v[20:23] offset:16384
  ds_write_b128 v85, v[24:27] offset:17408
  ds_write_b128 v85, v[28:31] offset:18432
  ds_write_b128 v85, v[32:35] offset:19456
  ds_write_b128 v85, v[36:39] offset:20480
  ds_write_b128 v85, v[40:43] offset:21504
  ds_write_b128 v85, v[44:47] offset:22528
  ds_write_b128 v85, v[48:51] offset:23552
  s_waitcnt vmcnt(0) lgkmcnt(0)
  s_barrier
  ds_read_b64_tr_b16 v[20:21], v4 offset:24576
  ds_read_b64_tr_b16 v[22:23], v4 offset:26624
  ds_read_b64_tr_b16 v[24:25], v4 offset:28672
  ds_read_b64_tr_b16 v[26:27], v4 offset:30720
  ds_read_b64_tr_b16 v[28:29], v5 offset:24576
  ds_read_b64_tr_b16 v[30:31], v5 offset:26624
  ds_read_b64_tr_b16 v[32:33], v5 offset:28672
  ds_read_b64_tr_b16 v[34:35], v5 offset:30720
  ds_read_b64_tr_b16 v[36:37], v6 offset:24576
  ds_read_b64_tr_b16 v[38:39], v6 offset:26624
  ds_read_b64_tr_b16 v[40:41], v6 offset:28672
  ds_read_b64_tr_b16 v[42:43], v6 offset:30720
  ds_read_b64_tr_b16 v[44:45], v7 offset:24576
  ds_read_b64_tr_b16 v[46:47], v7 offset:26624
  ds_read_b64_tr_b16 v[48:49], v7 offset:28672
  ds_read_b64_tr_b16 v[50:51], v7 offset:30720
  s_waitcnt lgkmcnt(0)
  s_barrier
  ds_write_b128 v85, v[20:23] offset:24576
  ds_write_b128 v85, v[24:27] offset:25600
  ds_write_b128 v85, v[28:31] offset:26624
  ds_write_b128 v85, v[32:35] offset:27648
  ds_write_b128 v85, v[36:39] offset:28672
  ds_write_b128 v85, v[40:43] offset:29696
  ds_write_b128 v85, v[44:47] offset:30720
  ds_write_b128 v85, v[48:51] offset:31744
  s_waitcnt lgkmcnt(0)
  s_lshr_b32 s40, s21, 1
  s_lshl_b32 s40, s40, 2
  v_min_u32 v76, 3, v0
  v_add_u32 v76, s40, v76
  v_lshlrev_b32 v76, 7, v76
  v_add_u32 v76, 1432576, v76
  s_nop 1
Lpoll_74:
  buffer_load_dword v77, v76, s[4:7], 0 offen sc1
  s_sub_u32 s24, s24, 1
  s_cbranch_scc1 L_FAIL
  s_waitcnt vmcnt(0)
  v_cmp_gt_i32 vcc, 1, v77
  s_cbranch_vccz Lpolld_75
  s_sleep 1
  s_branch Lpoll_74
Lpolld_75:
  s_lshl_b32 s40, s21, 18
  s_lshl_b32 s41, s20, 15
  s_add_u32 s40, s40, s41
  v_lshl_add_u32 v76, v0, 4, s40
  s_add_u32 s50, s21, s20
  s_and_b32 s50, s50, 3
  s_lshl_b32 s41, s54, 5
  s_add_u32 s41, s41, s50
  s_lshl_b32 s41, s41, 12
  s_xor_b32 s40, s41, 0
  s_add_u32 s40, s40, 6291456
  buffer_load_dwordx4 a[0:3], v76, s[4:7], s40 offen offset:0 sc1
  buffer_load_dwordx4 a[4:7], v76, s[4:7], s40 offen offset:1024 sc1
  buffer_load_dwordx4 a[8:11], v76, s[4:7], s40 offen offset:2048 sc1
  buffer_load_dwordx4 a[12:15], v76, s[4:7], s40 offen offset:3072 sc1
  s_xor_b32 s40, s41, 4096
  s_add_u32 s40, s40, 6291456
  buffer_load_dwordx4 a[16:19], v76, s[4:7], s40 offen offset:0 sc1
  buffer_load_dwordx4 a[20:23], v76, s[4:7], s40 offen offset:1024 sc1
  buffer_load_dwordx4 a[24:27], v76, s[4:7], s40 offen offset:2048 sc1
  buffer_load_dwordx4 a[28:31], v76, s[4:7], s40 offen offset:3072 sc1
  s_xor_b32 s40, s41, 8192
  s_add_u32 s40, s40, 6291456
  buffer_load_dwordx4 a[32:35], v76, s[4:7], s40 offen offset:0 sc1
  buffer_load_dwordx4 a[36:39], v76, s[4:7], s40 offen offset:1024 sc1
  buffer_load_dwordx4 a[40:43], v76, s[4:7], s40 offen offset:2048 sc1
  buffer_load_dwordx4 a[44:47], v76, s[4:7], s40 offen offset:3072 sc1
  s_xor_b32 s40, s41, 12288
  s_add_u32 s40, s40, 6291456
  buffer_load_dwordx4 a[48:51], v76, s[4:7], s40 offen offset:0 sc1
  buffer_load_dwordx4 a[52:55], v76, s[4:7], s40 offen offset:1024 sc1
  buffer_load_dwordx4 a[56:59], v76, s[4:7], s40 offen offset:2048 sc1
  buffer_load_dwordx4 a[60:63], v76, s[4:7], s40 offen offset:3072 sc1
  s_xor_b32 s40, s41, 16384
  s_add_u32 s40, s40, 6291456
  buffer_load_dwordx4 a[64:67], v76, s[4:7], s40 offen offset:0 sc1
  buffer_load_dwordx4 a[68:71], v76, s[4:7], s40 offen offset:1024 sc1
  buffer_load_dwordx4 a[72:75], v76, s[4:7], s40 offen offset:2048 sc1
  buffer_load_dwordx4 a[76:79], v76, s[4:7], s40 offen offset:3072 sc1
  s_xor_b32 s40, s41, 20480
  s_add_u32 s40, s40, 6291456
  buffer_load_dwordx4 a[80:83], v76, s[4:7], s40 offen offset:0 sc1
  buffer_load_dwordx4 a[84:87], v76, s[4:7], s40 offen offset:1024 sc1
  buffer_load_dwordx4 a[88:91], v76, s[4:7], s40 offen offset:2048 sc1
  buffer_load_dwordx4 a[92:95], v76, s[4:7], s40 offen offset:3072 sc1
  s_xor_b32 s40, s41, 24576
  s_add_u32 s40, s40, 6291456
  buffer_load_dwordx4 a[96:99], v76, s[4:7], s40 offen offset:0 sc1
  buffer_load_dwordx4 a[100:103], v76, s[4:7], s40 offen offset:1024 sc1
  buffer_load_dwordx4 a[104:107], v76, s[4:7], s40 offen offset:2048 sc1
  buffer_load_dwordx4 a[108:111], v76, s[4:7], s40 offen offset:3072 sc1
  s_xor_b32 s40, s41, 28672
  s_add_u32 s40, s40, 6291456
  buffer_load_dwordx4 a[112:115], v76, s[4:7], s40 offen offset:0 sc1
  buffer_load_dwordx4 a[116:119], v76, s[4:7], s40 offen offset:1024 sc1
  buffer_load_dwordx4 a[120:123], v76, s[4:7], s40 offen offset:2048 sc1
  buffer_load_dwordx4 a[124:127], v76, s[4:7], s40 offen offset:3072 sc1
  s_xor_b32 s40, s41, 131072
  s_add_u32 s40, s40, 6291456
  buffer_load_dwordx4 a[128:131], v76, s[4:7], s40 offen offset:0 sc1
  buffer_load_dwordx4 a[132:135], v76, s[4:7], s40 offen offset:1024 sc1
  buffer_load_dwordx4 a[136:139], v76, s[4:7], s40 offen offset:2048 sc1
  buffer_load_dwordx4 a[140:143], v76, s[4:7], s40 offen offset:3072 sc1
  s_waitcnt vmcnt(32)
  s_xor_b32 s40, s41, 135168
  s_add_u32 s40, s40, 6291456
  buffer_load_dwordx4 a[144:147], v76, s[4:7], s40 offen offset:0 sc1
  buffer_load_dwordx4 a[148:151], v76, s[4:7], s40 offen offset:1024 sc1
  buffer_load_dwordx4 a[152:155], v76, s[4:7], s40 offen offset:2048 sc1
  buffer_load_dwordx4 a[156:159], v76, s[4:7], s40 offen offset:3072 sc1
  s_waitcnt vmcnt(32)
  s_xor_b32 s40, s41, 139264
  s_add_u32 s40, s40, 6291456
  buffer_load_dwordx4 a[160:163], v76, s[4:7], s40 offen offset:0 sc1
  buffer_load_dwordx4 a[164:167], v76, s[4:7], s40 offen offset:1024 sc1
  buffer_load_dwordx4 a[168:171], v76, s[4:7], s40 offen offset:2048 sc1
  buffer_load_dwordx4 a[172:175], v76, s[4:7], s40 offen offset:3072 sc1
  s_waitcnt vmcnt(32)
  s_xor_b32 s40, s41, 143360
  s_add_u32 s40, s40, 6291456
  buffer_load_dwordx4 a[176:179], v76, s[4:7], s40 offen offset:0 sc1
  buffer_load_dwordx4 a[180:183], v76, s[4:7], s40 offen offset:1024 sc1
  buffer_load_dwordx4 a[184:187], v76, s[4:7], s40 offen offset:2048 sc1
  buffer_load_dwordx4 a[188:191], v76, s[4:7], s40 offen offset:3072 sc1
  s_waitcnt vmcnt(32)
  s_xor_b32 s40, s41, 147456
  s_add_u32 s40, s40, 6291456
  buffer_load_dwordx4 a[192:195], v76, s[4:7], s40 offen offset:0 sc1
  buffer_load_dwordx4 a[196:199], v76, s[4:7], s40 offen offset:1024 sc1
  buffer_load_dwordx4 a[200:203], v76, s[4:7], s40 offen offset:2048 sc1
  buffer_load_dwordx4 a[204:207], v76, s[4:7], s40 offen offset:3072 sc1
  s_waitcnt vmcnt(32)
  s_xor_b32 s40, s41, 151552
  s_add_u32 s40, s40, 6291456
  buffer_load_dwordx4 a[208:211], v76, s[4:7], s40 offen offset:0 sc1
  buffer_load_dwordx4 a[212:215], v76, s[4:7], s40 offen offset:1024 sc1
  buffer_load_dwordx4 a[216:219], v76, s[4:7], s40 offen offset:2048 sc1
  buffer_load_dwordx4 a[220:223], v76, s[4:7], s40 offen offset:3072 sc1
  s_waitcnt vmcnt(32)
  s_xor_b32 s40, s41, 155648
  s_add_u32 s40, s40, 6291456
  buffer_load_dwordx4 a[224:227], v76, s[4:7], s40 offen offset:0 sc1
  buffer_load_dwordx4 a[228:231], v76, s[4:7], s40 offen offset:1024 sc1
  buffer_load_dwordx4 a[232:235], v76, s[4:7], s40 offen offset:2048 sc1
  buffer_load_dwordx4 a[236:239], v76, s[4:7], s40 offen offset:3072 sc1
  s_waitcnt vmcnt(32)
  s_xor_b32 s40, s41, 159744
  s_add_u32 s40, s40, 6291456
  buffer_load_dwordx4 a[240:243], v76, s[4:7], s40 offen offset:0 sc1
  buffer_load_dwordx4 a[244:247], v76, s[4:7], s40 offen offset:1024 sc1
  buffer_load_dwordx4 a[248:251], v76, s[4:7], s40 offen offset:2048 sc1
  buffer_load_dwordx4 a[252:255], v76, s[4:7], s40 offen offset:3072 sc1
  s_waitcnt vmcnt(32)
  s_cmp_lg_u32 s20, 2
  s_cbranch_scc1 Lnotlb_76
  v_lshlrev_b32 v77, 21, v0
  s_mov_b32 s40, 0x1fff80
  buffer_load_dword v78, v77, s[4:7], s40 offen sc1
  s_add_u32 s40, s40, 134217728
  buffer_load_dword v78, v77, s[4:7], s40 offen sc1
  s_waitcnt vmcnt(0)
Lnotlb_76:
  s_getreg_b32 s55, hwreg(HW_REG_XCC_ID)
  s_and_b32 s55, s55, 15
  v_min_u32 v76, 63, v0
  v_lshlrev_b32 v76, 7, v76
  v_add_u32 v76, 1424384, v76
  s_nop 1
Lpoll_77:
  buffer_load_dword v77, v76, s[4:7], 0 offen sc1
  s_sub_u32 s24, s24, 1
  s_cbranch_scc1 L_FAIL
  s_waitcnt vmcnt(0)
  v_cmp_gt_i32 vcc, 0, v77
  s_cbranch_vccz Lpolld_78
  s_sleep 1
  s_branch Lpoll_77
Lpolld_78:
  v_and_b32 v78, 15, v77
  v_cmp_ne_u32 vcc, s55, v78
  s_lshl_b32 s40, s54, 4
  s_lshl_b32 s40, 0xffff, s40
  s_or_b32 s41, vcc_lo, vcc_hi
  s_and_b32 s40, s40, s41
  s_cselect_b32 s36, 0, 8192
  v_lshrrev_b32 v77, 8, v77
  v_and_b32 v78, 3, v0
  v_lshl_or_b32 v77, v77, 2, v78
  s_nop 1
  v_min_u32_dpp v77, v77, v77 row_ror:8 row_mask:0xf bank_mask:0xf
  s_nop 1
  v_min_u32_dpp v77, v77, v77 row_ror:4 row_mask:0xf bank_mask:0xf
  v_mov_b32 v78, v77
  s_nop 1
  v_permlane16_swap_b32 v78, v77
  v_min_u32 v77, v77, v78
  v_mov_b32 v78, v77
  s_nop 1
  v_permlane32_swap_b32 v78, v77
  v_min_u32 v77, v77, v78
  s_nop 1
  v_min_u32_dpp v77, v77, v77 row_ror:2 row_mask:0xf bank_mask:0xf
  s_nop 1
  v_min_u32_dpp v77, v77, v77 row_ror:1 row_mask:0xf bank_mask:0xf
  s_nop 0
  v_readfirstlane_b32 s26, v77
  s_and_b32 s26, s26, 3
  s_lshl_b32 s26, s26, 13
  s_lshr_b32 s40, s20, 1
  s_mul_i32 s40, s40, 32768
  s_and_b32 s41, s20, 1
  s_lshl_b32 s41, s41, 10
  s_add_u32 s40, s40, s41
  s_lshl_b32 s41, s54, 12
  s_add_u32 s40, s40, s41
  v_lshl_add_u32 v86, v0, 4, s40
  v_xor_b32 v87, 0x1000, v86
  v_and_b32 v76, 2, v0
  v_cmp_eq_u32 vcc, 0, v76
  v_mov_b32 v76, 0xeeee
  v_mov_b32 v77, 0x4444
  v_cndmask_b32 v88, v76, v77, vcc
  s_lshr_b32 s40, s21, 2
  s_mul_i32 s40, s40, 32768
  s_and_b32 s41, s21, 3
  s_lshl_b32 s41, s41, 11
  s_add_u32 s47, s40, s41
  s_lshl_b32 s41, s20, 9
  s_add_u32 s47, s47, s41
  v_lshl_add_u32 v92, v0, 3, s47
  s_lshl_b32 s41, s54, 12
  s_add_u32 s40, s41, 1310720
  s_add_u32 s40, s40, s26
  v_lshrrev_b32 v76, 2, v0
  v_lshl_add_u32 v76, v76, 7, s40
  v_and_b32 v77, 3, v0
  v_lshl_add_u32 v90, v77, 2, v76
  s_mov_b32 s57, s40
  s_cmp_eq_u32 s36, 0
  s_cselect_b32 s56, 1, s20
  s_and_b32 s41, s21, 15
  s_lshl_b32 s41, s41, 7
  s_lshl_b32 s40, s20, 2
  s_add_u32 s40, s40, s41
  s_add_u32 s40, s40, 0
  s_mov_b32 s25, 0
  s_mov_b32 s60, 0
  s_mov_b32 s61, 0
  s_mov_b32 s51, -1
  v_mov_b32 v91, 2147483392
  s_mov_b64 exec, 1
  v_mov_b32 v91, s40
  s_mov_b64 exec, -1
  v_mov_b32 v80, -1
  v_mov_b32 v81, -1
  v_mov_b32 v82, -1
  v_mov_b32 v83, -1
  s_mul_i32 s40, s20, 32768
  s_and_b32 s41, s50, 3
  s_lshl_b32 s41, s41, 10
  s_add_u32 s40, s40, s41
  v_lshl_add_u32 v110, v0, 4, s40
  v_xor_b32 v111, 0x400, v110
  v_xor_b32 v112, 0x800, v110
  v_xor_b32 v113, 0xc00, v110
  s_mul_i32 s58, s54, 131072
  s_and_b32 s41, s50, 4
  s_lshl_b32 s41, s41, 10
  s_add_u32 s58, s58, s41
  s_bfe_u32 s40, s21, 0x20002
  s_lshl_b32 s40, s40, 7
  s_and_b32 s41, s21, 3
  s_lshl_b32 s41, s41, 4
  s_add_u32 s40, s40, s41
  s_lshl_b32 s41, s20, 2
  s_add_u32 s41, s41, s40
  s_cmp_eq_u32 s20, 0
  s_cselect_b32 s40, s40, s41
  s_mov_b64 exec, 1
  v_mov_b32 v91, s40
  s_mov_b64 exec, -1
  s_mul_i32 s40, s20, 512
  v_add_u32 v90, s40, v90
  s_lshl_b32 s40, s20, 10
  s_add_u32 s40, s40, 147456
  v_lshl_add_u32 v95, v0, 4, s40
  s_and_b32 s40, s20, 1
  s_lshl_b32 s40, s40, 3
  v_bfe_u32 v4, v0, 2, 3
  v_add_u32 v4, s40, v4
  s_lshr_b32 s40, s20, 1
  s_lshl_b32 s40, s40, 3
  v_and_b32 v5, 3, v0
  v_add_u32 v5, s40, v5
  v_bfe_u32 v76, v4, 1, 1
  v_lshl_add_u32 v5, v76, 2, v5
  v_lshrrev_b32 v76, 2, v4
  v_and_b32 v77, 1, v4
  v_lshl_add_u32 v78, v76, 4, v5
  v_lshlrev_b32 v78, 4, v78
  v_lshl_add_u32 v78, v77, 3, v78
  v_add_u32 v108, 147456, v78
  s_bfe_u32 s41, s21, 0x10002
  s_mul_i32 s41, s41, 32768
  s_lshr_b32 s40, s21, 3
  s_lshl_b32 s40, s40, 11
  s_add_u32 s40, s40, s41
  s_and_b32 s41, s21, 3
  s_lshl_b32 s41, s41, 9
  s_add_u32 s40, s40, s41
  s_lshl_b32 s41, s20, 7
  s_add_u32 s40, s40, s41
  v_lshl_add_u32 v109, v0, 2, s40
  s_mov_b32 exec_lo, 0
  v_mov_b32 v109, 2147483392
  s_mov_b64 exec, -1
  ds_read_b128 v[116:119], v85 offset:20480
  ds_read_b128 v[120:123], v85 offset:21504
  s_mov_b32 s25, 0
  s_and_b32 s40, s25, 3
  s_lshl_b32 s40, s40, 16
  s_add_u32 s27, s40, s26
  s_add_u32 s27, s27, 1048576
  s_xor_b32 s37, s27, s36
  s_lshl_b32 s40, s40, 2
  s_add_u32 s28, s40, s26
  s_lshr_b32 s40, s40, 5
  s_and_b32 s40, s40, 0x4000
  s_xor_b32 s28, s28, s40
  s_xor_b32 s29, s28, 0x4000
  s_xor_b32 s40, s29, 0
  buffer_load_dword v89, v92, s[4:7], s40 offen sc1
  s_xor_b32 s40, s27, 8192
  buffer_load_dword v89, v109, s[4:7], s40 offen sc1
  s_mov_b32 s25, 1
  s_and_b32 s40, s25, 3
  s_lshl_b32 s40, s40, 16
  s_add_u32 s27, s40, s26
  s_add_u32 s27, s27, 1048576
  s_xor_b32 s37, s27, s36
  s_lshl_b32 s40, s40, 2
  s_add_u32 s28, s40, s26
  s_lshr_b32 s40, s40, 5
  s_and_b32 s40, s40, 0x4000
  s_xor_b32 s28, s28, s40
  s_xor_b32 s29, s28, 0x4000
  s_xor_b32 s40, s29, 0
  buffer_load_dword v89, v92, s[4:7], s40 offen sc1
  s_xor_b32 s40, s27, 8192
  buffer_load_dword v89, v109, s[4:7], s40 offen sc1
  s_mov_b32 s25, 2
  s_and_b32 s40, s25, 3
  s_lshl_b32 s40, s40, 16
  s_add_u32 s27, s40, s26
  s_add_u32 s27, s27, 1048576
  s_xor_b32 s37, s27, s36
  s_lshl_b32 s40, s40, 2
  s_add_u32 s28, s40, s26
  s_lshr_b32 s40, s40, 5
  s_and_b32 s40, s40, 0x4000
  s_xor_b32 s28, s28, s40
  s_xor_b32 s29, s28, 0x4000
  s_xor_b32 s40, s29, 0
  buffer_load_dword v89, v92, s[4:7], s40 offen sc1
  s_xor_b32 s40, s27, 8192
  buffer_load_dword v89, v109, s[4:7], s40 offen sc1
  s_mov_b32 s25, 3
  s_and_b32 s40, s25, 3
  s_lshl_b32 s40, s40, 16
  s_add_u32 s27, s40, s26
  s_add_u32 s27, s27, 1048576
  s_xor_b32 s37, s27, s36
  s_lshl_b32 s40, s40, 2
  s_add_u32 s28, s40, s26
  s_lshr_b32 s40, s40, 5
  s_and_b32 s40, s40, 0x4000
  s_xor_b32 s28, s28, s40
  s_xor_b32 s29, s28, 0x4000
  s_xor_b32 s40, s29, 0
  buffer_load_dword v89, v92, s[4:7], s40 offen sc1
  s_xor_b32 s40, s27, 8192
  buffer_load_dword v89, v109, s[4:7], s40 offen sc1
  buffer_load_dword v89, v90, s[4:7], 0 offen offset:2048 sc1
  s_mov_b32 s25, 0
  v_mov_b64 v[52:53], 0
  v_mov_b64 v[54:55], 0
  v_mov_b64 v[56:57], 0
  v_mov_b64 v[58:59], 0
  ds_read_b128 v[20:23], v85 offset:0
  ds_read_b128 v[24:27], v85 offset:1024
  ds_read_b128 v[28:31], v85 offset:8192
  ds_read_b128 v[32:35], v85 offset:9216
  ds_read_b128 v[36:39], v85 offset:2048
  ds_read_b128 v[40:43], v85 offset:3072
  ds_read_b128 v[44:47], v85 offset:10240
  ds_read_b128 v[48:51], v85 offset:11264
L_VO_top:
  s_and_b32 s40, s25, 3
  s_lshl_b32 s40, s40, 16
  s_add_u32 s27, s40, s26
  s_add_u32 s27, s27, 1048576
  s_xor_b32 s37, s27, s36
  s_lshl_b32 s40, s40, 2
  s_add_u32 s28, s40, s26
  s_lshr_b32 s40, s40, 5
  s_and_b32 s40, s40, 0x4000
  s_xor_b32 s28, s28, s40
  s_xor_b32 s29, s28, 0x4000
  s_sleep 4
L_VO_retry:
  buffer_load_dwordx4 v[4:7], v86, s[4:7], s37 offen offset:0 sc1
  s_nop 0
  buffer_load_dwordx4 v[8:11], v86, s[4:7], s37 offen offset:2048 sc1
  s_nop 0
  s_waitcnt vmcnt(1) lgkmcnt(0)
  buffer_load_dwordx4 v[68:71], v87, s[4:7], s27 offen offset:0 sc1
  buffer_load_dwordx4 v[72:75], v87, s[4:7], s27 offen offset:2048 sc1
  v_smfmac_f32_16x16x64_bf16 v[52:55], v[4:7], v[128:135], v88
  ds_write_b128 v1, v[4:7] offset:0
  v_max3_u32 v89, v4, v5, v6
  v_smfmac_f32_16x16x64_bf16 v[56:59], v[4:7], v[20:27], v88
  v_max3_u32 v89, v6, v7, v89
  s_waitcnt vmcnt(2)
  ds_write_b128 v1, v[8:11] offset:1024
  v_max3_u32 v89, v8, v9, v89
  v_max3_u32 v89, v10, v11, v89
  v_cmp_eq_u32 vcc, -1, v89
  s_cbranch_vccnz L_VO_bad
  s_waitcnt lgkmcnt(0)
  s_barrier
  ds_read_b128 v[12:15], v2 offset:0
  ds_read_b128 v[16:19], v2 offset:1024
  v_smfmac_f32_16x16x64_bf16 v[52:55], v[8:11], v[136:143], v88
  ds_read_b128 v[4:7], v3 offset:0
  ds_read_b128 v[20:23], v85 offset:4096
  v_smfmac_f32_16x16x64_bf16 v[56:59], v[8:11], v[28:35], v88
  ds_read_b128 v[24:27], v85 offset:5120
  s_waitcnt lgkmcnt(4)
  v_smfmac_f32_16x16x64_bf16 v[52:55], v[12:15], v[144:151], v88
  ds_read_b128 v[8:11], v3 offset:1024
  ds_read_b128 v[28:31], v85 offset:12288
  v_smfmac_f32_16x16x64_bf16 v[56:59], v[12:15], v[36:43], v88
  ds_read_b128 v[32:35], v85 offset:13312
  s_waitcnt lgkmcnt(6)
  v_smfmac_f32_16x16x64_bf16 v[52:55], v[16:19], v[152:159], v88
  ds_read_b128 v[12:15], v84 offset:0
  ds_read_b128 v[36:39], v85 offset:6144
  v_smfmac_f32_16x16x64_bf16 v[56:59], v[16:19], v[44:51], v88
  ds_read_b128 v[40:43], v85 offset:7168
  s_waitcnt lgkmcnt(6)
  v_smfmac_f32_16x16x64_bf16 v[52:55], v[4:7], v[160:167], v88
  ds_read_b128 v[16:19], v84 offset:1024
  ds_read_b128 v[44:47], v85 offset:14336
  v_smfmac_f32_16x16x64_bf16 v[56:59], v[4:7], v[20:27], v88
  ds_read_b128 v[48:51], v85 offset:15360
  s_waitcnt lgkmcnt(6)
  v_smfmac_f32_16x16x64_bf16 v[52:55], v[8:11], v[168:175], v88
  ds_read_b128 v[20:23], v85 offset:16384
  v_smfmac_f32_16x16x64_bf16 v[56:59], v[8:11], v[28:35], v88
  ds_read_b128 v[24:27], v85 offset:17408
  s_waitcnt lgkmcnt(5)
  v_smfmac_f32_16x16x64_bf16 v[52:55], v[12:15], v[176:183], v88
  ds_read_b128 v[28:31], v85 offset:24576
  v_smfmac_f32_16x16x64_bf16 v[56:59], v[12:15], v[36:43], v88
  ds_read_b128 v[32:35], v85 offset:25600
  s_waitcnt lgkmcnt(4)
  s_waitcnt vmcnt(0)
  ds_write_b128 v1, v[68:71] offset:2048
  v_smfmac_f32_16x16x64_bf16 v[52:55], v[16:19], v[184:191], v88
  ds_write_b128 v1, v[72:75] offset:3072
  v_max3_u32 v89, v68, v69, v70
  v_max3_u32 v89, v70, v71, v89
  v_max3_u32 v89, v72, v73, v89
  v_smfmac_f32_16x16x64_bf16 v[56:59], v[16:19], v[44:51], v88
  v_max3_u32 v89, v74, v75, v89
  v_cmp_eq_u32 vcc, -1, v89
  ds_read_b128 v[36:39], v85 offset:18432
  ds_read_b128 v[40:43], v85 offset:19456
  s_cbranch_vccnz L_VO_rbad
L_VO_rok:
  s_waitcnt lgkmcnt(6)
  s_waitcnt lgkmcnt(2)
  s_barrier
  v_smfmac_f32_16x16x64_bf16 v[52:55], v[68:71], v[192:199], v88
  ds_read_b128 v[12:15], v2 offset:2048
  ds_read_b128 v[16:19], v2 offset:3072
  v_smfmac_f32_16x16x64_bf16 v[56:59], v[68:71], v[20:27], v88
  ds_read_b128 v[44:47], v85 offset:26624
  ds_read_b128 v[48:51], v85 offset:27648
  v_smfmac_f32_16x16x64_bf16 v[52:55], v[72:75], v[200:207], v88
  ds_read_b128 v[4:7], v3 offset:2048
  v_smfmac_f32_16x16x64_bf16 v[56:59], v[72:75], v[28:35], v88
  s_waitcnt lgkmcnt(4)
  v_smfmac_f32_16x16x64_bf16 v[52:55], v[12:15], v[208:215], v88
  ds_read_b128 v[8:11], v3 offset:3072
  ds_read_b128 v[28:31], v85 offset:28672
  v_smfmac_f32_16x16x64_bf16 v[56:59], v[12:15], v[36:43], v88
  ds_read_b128 v[32:35], v85 offset:29696
  s_waitcnt lgkmcnt(4)
  v_smfmac_f32_16x16x64_bf16 v[52:55], v[16:19], v[216:223], v88
  ds_read_b128 v[12:15], v84 offset:2048
  ds_read_b128 v[36:39], v85 offset:22528
  v_smfmac_f32_16x16x64_bf16 v[56:59], v[16:19], v[44:51], v88
  ds_read_b128 v[40:43], v85 offset:23552
  s_waitcnt lgkmcnt(6)
  v_smfmac_f32_16x16x64_bf16 v[52:55], v[4:7], v[224:231], v88
  ds_read_b128 v[16:19], v84 offset:3072
  ds_read_b128 v[44:47], v85 offset:30720
  v_smfmac_f32_16x16x64_bf16 v[56:59], v[4:7], v[116:123], v88
  ds_read_b128 v[48:51], v85 offset:31744
  s_waitcnt lgkmcnt(6)
  v_smfmac_f32_16x16x64_bf16 v[52:55], v[8:11], v[232:239], v88
  v_smfmac_f32_16x16x64_bf16 v[56:59], v[8:11], v[28:35], v88
  s_waitcnt lgkmcnt(3)
  v_smfmac_f32_16x16x64_bf16 v[52:55], v[12:15], v[240:247], v88
  v_smfmac_f32_16x16x64_bf16 v[56:59], v[12:15], v[36:43], v88
  s_waitcnt lgkmcnt(0)
  v_smfmac_f32_16x16x64_bf16 v[52:55], v[16:19], v[248:255], v88
  v_smfmac_f32_16x16x64_bf16 v[56:59], v[16:19], v[44:51], v88
  s_nop 6
  v_pk_add_f32 v[52:53], v[52:53], v[54:55]
  v_pk_add_f32 v[56:57], v[56:57], v[58:59]
  v_cvt_pk_bf16_f32 v100, v52, v53
  v_cvt_pk_bf16_f32 v101, v56, v57
  s_cmp_eq_u32 s36, 0
  s_cbranch_scc1 Lwt_79
  buffer_store_dwordx2 v[100:101], v92, s[4:7], s29 offen
  s_branch Lwtd_80
Lwt_79:
  buffer_store_dwordx2 v[100:101], v92, s[4:7], s29 offen sc1
Lwtd_80:
  s_cmp_ge_u32 s25, 63
  s_cbranch_scc1 L_VO_end
  s_add_u32 s42, s28, s58
  s_xor_b32 s30, s42, s36
  s_xor_b32 s31, s30, 4096
  s_xor_b32 s32, s42, 131072
  s_xor_b32 s48, s32, 4096
  s_add_u32 s41, s25, 1
  v_mov_b32 v94, s41
  s_and_b32 s41, s41, 3
  s_lshl_b32 s41, s41, 16
  s_add_u32 s33, s41, s26
  s_add_u32 s33, s33, 1048576
  s_xor_b32 s49, s33, 8192
  s_xor_b32 s34, s33, 0x20000
  s_xor_b32 s35, s29, 0x84000
  buffer_store_dword v80, v109, s[4:7], s34 offen sc1
  s_xor_b32 s40, s34, 8192
  buffer_store_dword v80, v109, s[4:7], s40 offen
  s_cmp_eq_u32 s36, 0
  s_cbranch_scc1 Lwt_81
  buffer_store_dwordx2 v[80:81], v92, s[4:7], s35 offen
  s_branch Lwtd_82
Lwt_81:
  buffer_store_dwordx2 v[80:81], v92, s[4:7], s35 offen sc1
Lwtd_82:
  v_mov_b64 v[60:61], 0
  v_mov_b64 v[62:63], 0
  v_mov_b64 v[64:65], 0
  v_mov_b64 v[66:67], 0
  v_mov_b64 v[52:53], 0
  v_mov_b64 v[54:55], 0
  v_mov_b64 v[56:57], 0
  v_mov_b64 v[58:59], 0
  ds_read_b128 v[20:23], v85 offset:0
  ds_read_b128 v[24:27], v85 offset:1024
  ds_read_b128 v[28:31], v85 offset:8192
  ds_read_b128 v[32:35], v85 offset:9216
  ds_read_b128 v[36:39], v85 offset:2048
  ds_read_b128 v[40:43], v85 offset:3072
  ds_read_b128 v[44:47], v85 offset:10240
  ds_read_b128 v[48:51], v85 offset:11264
  s_cmp_eq_u32 s36, 0
  s_nop 0
  s_cbranch_scc1 Ltrigd_84
  s_mov_b64 exec, 0xffff
  s_sleep 5
  s_nop 0
  s_nop 0
  s_nop 0
  buffer_load_dword v76, v90, s[4:7], 0 offen offset:2048 sc1
  s_sleep 1
  buffer_load_dword v77, v90, s[4:7], 0 offen offset:2048 sc1
  s_sleep 1
  buffer_load_dword v78, v90, s[4:7], 0 offen offset:2048 sc1
  s_sleep 1
Ltrig_83:
  s_sub_u32 s24, s24, 1
  s_cbranch_scc1 L_FAIL
  buffer_load_dword v79, v90, s[4:7], 0 offen offset:2048 sc1
  s_nop 0
  s_waitcnt vmcnt(3)
  v_cmp_gt_i32_e64 vcc, s25, v76
  s_cbranch_vccz Ltrigd_84
  buffer_load_dword v76, v90, s[4:7], 0 offen offset:2048 sc1
  s_waitcnt vmcnt(3)
  v_cmp_gt_i32 vcc, s25, v77
  s_cbranch_vccz Ltrigd_84
  buffer_load_dword v77, v90, s[4:7], 0 offen offset:2048 sc1
  s_waitcnt vmcnt(3)
  v_cmp_gt_i32 vcc, s25, v78
  s_cbranch_vccz Ltrigd_84
  buffer_load_dword v78, v90, s[4:7], 0 offen offset:2048 sc1
  s_waitcnt vmcnt(3)
  v_cmp_gt_i32_e64 vcc, s25, v79
  s_cbranch_vccnz Ltrig_83
Ltrigd_84:
  s_mov_b64 exec, -1
L_VOO_again:
  buffer_load_dwordx4 v[4:7], v110, s[4:7], s30 offen sc1
  s_nop 0
  buffer_load_dwordx4 v[8:11], v111, s[4:7], s30 offen sc1
  s_nop 0
  buffer_load_dwordx4 v[12:15], v112, s[4:7], s30 offen sc1
  s_nop 0
  buffer_load_dwordx4 v[16:19], v113, s[4:7], s30 offen sc1
  s_nop 0
  buffer_load_dwordx4 v[68:71], v110, s[4:7], s31 offen sc1
  s_nop 0
  buffer_load_dwordx4 v[72:75], v111, s[4:7], s31 offen sc1
  s_nop 0
  s_nop 0
  s_waitcnt vmcnt(5)
  v_cmp_eq_u32_e64 vcc, -1, v4
  s_cbranch_vccnz L_VOO_g0
L_VOO_ok0:
  buffer_load_dwordx4 v[96:99], v112, s[4:7], s31 offen sc1
  v_smfmac_f32_16x16x64_bf16 v[60:63], v[4:7], a[0:7], v88
  s_waitcnt vmcnt(5)
  v_cmp_eq_u32 vcc, -1, v8
  v_smfmac_f32_16x16x64_bf16 v[64:67], v[4:7], a[8:15], v88
  s_cbranch_vccnz L_VOO_g1
L_VOO_ok1:
  buffer_load_dwordx4 v[4:7], v113, s[4:7], s31 offen sc1
  v_smfmac_f32_16x16x64_bf16 v[60:63], v[8:11], a[16:23], v88
  s_waitcnt vmcnt(5)
  v_cmp_eq_u32 vcc, -1, v12
  v_smfmac_f32_16x16x64_bf16 v[64:67], v[8:11], a[24:31], v88
  s_cbranch_vccnz L_VOO_g2
L_VOO_ok2:
  buffer_load_dwordx4 v[8:11], v110, s[4:7], s32 offen sc1
  v_smfmac_f32_16x16x64_bf16 v[60:63], v[12:15], a[32:39], v88
  s_waitcnt vmcnt(5)
  v_cmp_eq_u32 vcc, -1, v16
  v_smfmac_f32_16x16x64_bf16 v[64:67], v[12:15], a[40:47], v88
  s_cbranch_vccnz L_VOO_g3
L_VOO_ok3:
  buffer_load_dwordx4 v[12:15], v111, s[4:7], s32 offen sc1
  v_smfmac_f32_16x16x64_bf16 v[60:63], v[16:19], a[48:55], v88
  s_waitcnt vmcnt(5)
  v_cmp_eq_u32 vcc, -1, v68
  v_smfmac_f32_16x16x64_bf16 v[64:67], v[16:19], a[56:63], v88
  s_cbranch_vccnz L_VOO_g4
L_VOO_ok4:
  buffer_load_dwordx4 v[16:19], v112, s[4:7], s32 offen sc1
  v_smfmac_f32_16x16x64_bf16 v[60:63], v[68:71], a[64:71], v88
  s_waitcnt vmcnt(5)
  v_cmp_eq_u32 vcc, -1, v72
  v_smfmac_f32_16x16x64_bf16 v[64:67], v[68:71], a[72:79], v88
  s_cbranch_vccnz L_VOO_g5
L_VOO_ok5:
  buffer_load_dwordx4 v[68:71], v113, s[4:7], s32 offen sc1
  v_smfmac_f32_16x16x64_bf16 v[60:63], v[72:75], a[80:87], v88
  s_nop 0
  s_waitcnt vmcnt(5)
  v_cmp_eq_u32_e64 vcc, -1, v96
  v_smfmac_f32_16x16x64_bf16 v[64:67], v[72:75], a[88:95], v88
  s_cbranch_vccnz L_VOO_g6
L_VOO_ok6:
  buffer_load_dwordx4 v[72:75], v110, s[4:7], s48 offen sc1
  v_smfmac_f32_16x16x64_bf16 v[60:63], v[96:99], a[96:103], v88
  s_waitcnt vmcnt(5)
  v_cmp_eq_u32 vcc, -1, v4
  v_smfmac_f32_16x16x64_bf16 v[64:67], v[96:99], a[104:111], v88
  s_cbranch_vccnz L_VOO_g7
L_VOO_ok7:
  buffer_load_dwordx4 v[96:99], v111, s[4:7], s48 offen sc1
  v_smfmac_f32_16x16x64_bf16 v[60:63], v[4:7], a[112:119], v88
  s_waitcnt vmcnt(5)
  v_cmp_eq_u32 vcc, -1, v8
  v_smfmac_f32_16x16x64_bf16 v[64:67], v[4:7], a[120:127], v88
  s_cbranch_vccnz L_VOO_g8
L_VOO_ok8:
  buffer_load_dwordx4 v[4:7], v112, s[4:7], s48 offen sc1
  v_smfmac_f32_16x16x64_bf16 v[60:63], v[8:11], a[128:135], v88
  s_waitcnt vmcnt(5)
  v_cmp_eq_u32 vcc, -1, v12
  v_smfmac_f32_16x16x64_bf16 v[64:67], v[8:11], a[136:143], v88
  s_cbranch_vccnz L_VOO_g9
L_VOO_ok9:
  buffer_load_dwordx4 v[8:11], v113, s[4:7], s48 offen sc1
  v_smfmac_f32_16x16x64_bf16 v[60:63], v[12:15], a[144:151], v88
  s_waitcnt vmcnt(5)
  v_cmp_eq_u32 vcc, -1, v16
  v_smfmac_f32_16x16x64_bf16 v[64:67], v[12:15], a[152:159], v88
  s_cbranch_vccnz L_VOO_g10
L_VOO_ok10:
  v_smfmac_f32_16x16x64_bf16 v[60:63], v[16:19], a[160:167], v88
  s_waitcnt vmcnt(4)
  v_cmp_eq_u32 vcc, -1, v68
  v_smfmac_f32_16x16x64_bf16 v[64:67], v[16:19], a[168:175], v88
  s_cbranch_vccnz L_VOO_g11
L_VOO_ok11:
  v_smfmac_f32_16x16x64_bf16 v[60:63], v[68:71], a[176:183], v88
  s_waitcnt vmcnt(3)
  v_cmp_eq_u32 vcc, -1, v72
  v_smfmac_f32_16x16x64_bf16 v[64:67], v[68:71], a[184:191], v88
  s_cbranch_vccnz L_VOO_g12
L_VOO_ok12:
  v_smfmac_f32_16x16x64_bf16 v[60:63], v[72:75], a[192:199], v88
  s_waitcnt vmcnt(2)
  v_cmp_eq_u32 vcc, -1, v96
  v_smfmac_f32_16x16x64_bf16 v[64:67], v[72:75], a[200:207], v88
  s_cbranch_vccnz L_VOO_g13
L_VOO_ok13:
  v_smfmac_f32_16x16x64_bf16 v[60:63], v[96:99], a[208:215], v88
  s_waitcnt vmcnt(1)
  v_cmp_eq_u32 vcc, -1, v4
  v_smfmac_f32_16x16x64_bf16 v[64:67], v[96:99], a[216:223], v88
  s_cbranch_vccnz L_VOO_g14
L_VOO_ok14:
  v_smfmac_f32_16x16x64_bf16 v[60:63], v[4:7], a[224:231], v88
  s_waitcnt vmcnt(0)
  v_cmp_eq_u32_e64 vcc, -1, v8
  v_smfmac_f32_16x16x64_bf16 v[64:67], v[4:7], a[232:239], v88
  s_cbranch_vccnz L_VOO_g15
L_VOO_ok15:
  v_smfmac_f32_16x16x64_bf16 v[60:63], v[8:11], a[240:247], v88
  v_smfmac_f32_16x16x64_bf16 v[64:67], v[8:11], a[248:255], v88
  s_nop 6
  v_add_f32 v100, v60, v62
  v_add_f32 v102, v61, v63
  v_add_f32 v101, v64, v66
  v_add_f32 v103, v65, v67
  ds_write_b128 v95, v[100:103]
  v_cmp_u_f32 vcc, v100, v102
  s_cbranch_vccnz L_VOO_nan
L_VOO_done:
  buffer_store_dword v94, v91, s[4:7], s57 offen
  s_waitcnt lgkmcnt(0)
  s_barrier
  ds_read2st64_b64 v[100:103], v108 offset0:0 offset1:2
  ds_read2st64_b64 v[104:107], v108 offset0:4 offset1:6
  s_waitcnt lgkmcnt(1)
  v_pk_add_f32 v[100:101], v[100:101], v[102:103]
  s_waitcnt lgkmcnt(0)
  v_pk_add_f32 v[104:105], v[104:105], v[106:107]
  v_pk_add_f32 v[100:101], v[100:101], v[104:105]
  v_cvt_pk_bf16_f32 v100, v100, v101
  buffer_store_dword v100, v109, s[4:7], s49 offen
  buffer_store_dword v100, v109, s[4:7], s33 offen sc1
  s_add_u32 s25, s25, 1
  s_branch L_VO_top
L_VO_end:
  s_branch L_END
L_VO_bad:
  s_nop 7
  s_sub_u32 s24, s24, 1
  s_cbranch_scc1 L_FAIL
  s_add_u32 s60, s60, 1
  v_mov_b64 v[52:53], 0
  v_mov_b64 v[54:55], 0
  v_mov_b64 v[56:57], 0
  v_mov_b64 v[58:59], 0
  s_nop 1
  s_branch L_VO_retry
L_VO_rbad:
  s_sub_u32 s24, s24, 1
  s_cbranch_scc1 L_FAIL
  s_add_u32 s60, s60, 0x10000
  s_waitcnt lgkmcnt(0)
  buffer_load_dwordx4 v[68:71], v87, s[4:7], s27 offen offset:0 sc1
  buffer_load_dwordx4 v[72:75], v87, s[4:7], s27 offen offset:2048 sc1
  s_waitcnt vmcnt(0)
  ds_write_b128 v1, v[68:71] offset:2048
  ds_write_b128 v1, v[72:75] offset:3072
  v_max3_u32 v89, v68, v69, v70
  v_max3_u32 v89, v70, v71, v89
  v_max3_u32 v89, v72, v73, v89
  v_max3_u32 v89, v74, v75, v89
  v_cmp_eq_u32 vcc, -1, v89
  s_waitcnt lgkmcnt(0)
  s_cbranch_vccnz L_VO_rbad
  s_branch L_VO_rok
L_VOO_nan:
  s_cmp_eq_u32 s51, s25
  s_cbranch_scc1 L_VOO_done
  s_mov_b32 s51, s25
  s_add_u32 s61, s61, 0x10000
  s_waitcnt vmcnt(0) lgkmcnt(0)
L_VOO_v0:
  s_sub_u32 s24, s24, 1
  s_cbranch_scc1 L_FAIL
  buffer_load_dwordx4 v[4:7], v110, s[4:7], s30 offen sc1
  buffer_load_dwordx4 v[8:11], v111, s[4:7], s30 offen sc1
  buffer_load_dwordx4 v[12:15], v112, s[4:7], s30 offen sc1
  buffer_load_dwordx4 v[16:19], v113, s[4:7], s30 offen sc1
  v_mov_b32 v89, 0
  s_waitcnt vmcnt(0)
  v_max3_u32 v89, v4, v5, v89
  v_max3_u32 v89, v6, v7, v89
  v_max3_u32 v89, v8, v9, v89
  v_max3_u32 v89, v10, v11, v89
  v_max3_u32 v89, v12, v13, v89
  v_max3_u32 v89, v14, v15, v89
  v_max3_u32 v89, v16, v17, v89
  v_max3_u32 v89, v18, v19, v89
  v_cmp_eq_u32 vcc, -1, v89
  s_cbranch_vccnz L_VOO_v0
L_VOO_v4:
  s_sub_u32 s24, s24, 1
  s_cbranch_scc1 L_FAIL
  buffer_load_dwordx4 v[68:71], v110, s[4:7], s31 offen sc1
  buffer_load_dwordx4 v[72:75], v111, s[4:7], s31 offen sc1
  buffer_load_dwordx4 v[96:99], v112, s[4:7], s31 offen sc1
  buffer_load_dwordx4 v[4:7], v113, s[4:7], s31 offen sc1
  v_mov_b32 v89, 0
  s_waitcnt vmcnt(0)
  v_max3_u32 v89, v68, v69, v89
  v_max3_u32 v89, v70, v71, v89
  v_max3_u32 v89, v72, v73, v89
  v_max3_u32 v89, v74, v75, v89
  v_max3_u32 v89, v96, v97, v89
  v_max3_u32 v89, v98, v99, v89
  v_max3_u32 v89, v4, v5, v89
  v_max3_u32 v89, v6, v7, v89
  v_cmp_eq_u32 vcc, -1, v89
  s_cbranch_vccnz L_VOO_v4
L_VOO_v8:
  s_sub_u32 s24, s24, 1
  s_cbranch_scc1 L_FAIL
  buffer_load_dwordx4 v[8:11], v110, s[4:7], s32 offen sc1
  buffer_load_dwordx4 v[12:15], v111, s[4:7], s32 offen sc1
  buffer_load_dwordx4 v[16:19], v112, s[4:7], s32 offen sc1
  buffer_load_dwordx4 v[68:71], v113, s[4:7], s32 offen sc1
  v_mov_b32 v89, 0
  s_waitcnt vmcnt(0)
  v_max3_u32 v89, v8, v9, v89
  v_max3_u32 v89, v10, v11, v89
  v_max3_u32 v89, v12, v13, v89
  v_max3_u32 v89, v14, v15, v89
  v_max3_u32 v89, v16, v17, v89
  v_max3_u32 v89, v18, v19, v89
  v_max3_u32 v89, v68, v69, v89
  v_max3_u32 v89, v70, v71, v89
  v_cmp_eq_u32 vcc, -1, v89
  s_cbranch_vccnz L_VOO_v8
L_VOO_v12:
  s_sub_u32 s24, s24, 1
  s_cbranch_scc1 L_FAIL
  buffer_load_dwordx4 v[72:75], v110, s[4:7], s48 offen sc1
  buffer_load_dwordx4 v[96:99], v111, s[4:7], s48 offen sc1
  buffer_load_dwordx4 v[4:7], v112, s[4:7], s48 offen sc1
  buffer_load_dwordx4 v[8:11], v113, s[4:7], s48 offen sc1
  v_mov_b32 v89, 0
  s_waitcnt vmcnt(0)
  v_max3_u32 v89, v72, v73, v89
  v_max3_u32 v89, v74, v75, v89
  v_max3_u32 v89, v96, v97, v89
  v_max3_u32 v89, v98, v99, v89
  v_max3_u32 v89, v4, v5, v89
  v_max3_u32 v89, v6, v7, v89
  v_max3_u32 v89, v8, v9, v89
  v_max3_u32 v89, v10, v11, v89
  v_cmp_eq_u32 vcc, -1, v89
  s_cbranch_vccnz L_VOO_v12
  v_mov_b64 v[60:61], 0
  v_mov_b64 v[62:63], 0
  v_mov_b64 v[64:65], 0
  v_mov_b64 v[66:67], 0
  s_nop 1
  s_branch L_VOO_again
L_VOO_g0:
  s_sub_u32 s24, s24, 1
  s_cbranch_scc1 L_FAIL
  s_add_u32 s61, s61, 1
  buffer_load_dwordx4 v[4:7], v110, s[4:7], s30 offen sc1
  s_waitcnt vmcnt(0)
  v_cmp_eq_u32 vcc, -1, v4
  s_cbranch_vccnz L_VOO_g0
  v_mov_b32 v89, 0
  v_max3_u32 v89, v8, v12, v89
  v_max3_u32 v89, v16, v68, v89
  v_max3_u32 v89, v72, v72, v89
  v_cmp_eq_u32 vcc, -1, v89
  s_cbranch_vccz L_VOO_ok0
  buffer_load_dwordx4 v[8:11], v111, s[4:7], s30 offen sc1
  s_nop 0
  buffer_load_dwordx4 v[12:15], v112, s[4:7], s30 offen sc1
  s_nop 0
  buffer_load_dwordx4 v[16:19], v113, s[4:7], s30 offen sc1
  s_nop 0
  buffer_load_dwordx4 v[68:71], v110, s[4:7], s31 offen sc1
  s_nop 0
  buffer_load_dwordx4 v[72:75], v111, s[4:7], s31 offen sc1
  s_nop 0
  s_branch L_VOO_ok0
L_VOO_g1:
  s_sub_u32 s24, s24, 1
  s_cbranch_scc1 L_FAIL
  s_add_u32 s61, s61, 1
  buffer_load_dwordx4 v[8:11], v111, s[4:7], s30 offen sc1
  s_waitcnt vmcnt(0)
  v_cmp_eq_u32 vcc, -1, v8
  s_cbranch_vccnz L_VOO_g1
  v_mov_b32 v89, 0
  v_max3_u32 v89, v12, v16, v89
  v_max3_u32 v89, v68, v72, v89
  v_max3_u32 v89, v96, v96, v89
  v_cmp_eq_u32 vcc, -1, v89
  s_cbranch_vccz L_VOO_ok1
  buffer_load_dwordx4 v[12:15], v112, s[4:7], s30 offen sc1
  s_nop 0
  buffer_load_dwordx4 v[16:19], v113, s[4:7], s30 offen sc1
  s_nop 0
  buffer_load_dwordx4 v[68:71], v110, s[4:7], s31 offen sc1
  s_nop 0
  buffer_load_dwordx4 v[72:75], v111, s[4:7], s31 offen sc1
  s_nop 0
  buffer_load_dwordx4 v[96:99], v112, s[4:7], s31 offen sc1
  s_nop 0
  s_branch L_VOO_ok1
L_VOO_g2:
  s_sub_u32 s24, s24, 1
  s_cbranch_scc1 L_FAIL
  s_add_u32 s61, s61, 1
  buffer_load_dwordx4 v[12:15], v112, s[4:7], s30 offen sc1
  s_waitcnt vmcnt(0)
  v_cmp_eq_u32 vcc, -1, v12
  s_cbranch_vccnz L_VOO_g2
  v_mov_b32 v89, 0
  v_max3_u32 v89, v16, v68, v89
  v_max3_u32 v89, v72, v96, v89
  v_max3_u32 v89, v4, v4, v89
  v_cmp_eq_u32 vcc, -1, v89
  s_cbranch_vccz L_VOO_ok2
  buffer_load_dwordx4 v[16:19], v113, s[4:7], s30 offen sc1
  s_nop 0
  buffer_load_dwordx4 v[68:71], v110, s[4:7], s31 offen sc1
  s_nop 0
  buffer_load_dwordx4 v[72:75], v111, s[4:7], s31 offen sc1
  s_nop 0
  buffer_load_dwordx4 v[96:99], v112, s[4:7], s31 offen sc1
  s_nop 0
  buffer_load_dwordx4 v[4:7], v113, s[4:7], s31 offen sc1
  s_nop 0
  s_branch L_VOO_ok2
L_VOO_g3:
  s_sub_u32 s24, s24, 1
  s_cbranch_scc1 L_FAIL
  s_add_u32 s61, s61, 1
  buffer_load_dwordx4 v[16:19], v113, s[4:7], s30 offen sc1
  s_waitcnt vmcnt(0)
  v_cmp_eq_u32 vcc, -1, v16
  s_cbranch_vccnz L_VOO_g3
  v_mov_b32 v89, 0
  v_max3_u32 v89, v68, v72, v89
  v_max3_u32 v89, v96, v4, v89
  v_max3_u32 v89, v8, v8, v89
  v_cmp_eq_u32 vcc, -1, v89
  s_cbranch_vccz L_VOO_ok3
  buffer_load_dwordx4 v[68:71], v110, s[4:7], s31 offen sc1
  s_nop 0
  buffer_load_dwordx4 v[72:75], v111, s[4:7], s31 offen sc1
  s_nop 0
  buffer_load_dwordx4 v[96:99], v112, s[4:7], s31 offen sc1
  s_nop 0
  buffer_load_dwordx4 v[4:7], v113, s[4:7], s31 offen sc1
  s_nop 0
  buffer_load_dwordx4 v[8:11], v110, s[4:7], s32 offen sc1
  s_nop 0
  s_branch L_VOO_ok3
L_VOO_g4:
  s_sub_u32 s24, s24, 1
  s_cbranch_scc1 L_FAIL
  s_add_u32 s61, s61, 1
  buffer_load_dwordx4 v[68:71], v110, s[4:7], s31 offen sc1
  s_waitcnt vmcnt(0)
  v_cmp_eq_u32 vcc, -1, v68
  s_cbranch_vccnz L_VOO_g4
  v_mov_b32 v89, 0
  v_max3_u32 v89, v72, v96, v89
  v_max3_u32 v89, v4, v8, v89
  v_max3_u32 v89, v12, v12, v89
  v_cmp_eq_u32 vcc, -1, v89
  s_cbranch_vccz L_VOO_ok4
  buffer_load_dwordx4 v[72:75], v111, s[4:7], s31 offen sc1
  s_nop 0
  buffer_load_dwordx4 v[96:99], v112, s[4:7], s31 offen sc1
  s_nop 0
  buffer_load_dwordx4 v[4:7], v113, s[4:7], s31 offen sc1
  s_nop 0
  buffer_load_dwordx4 v[8:11], v110, s[4:7], s32 offen sc1
  s_nop 0
  buffer_load_dwordx4 v[12:15], v111, s[4:7], s32 offen sc1
  s_nop 0
  s_branch L_VOO_ok4
L_VOO_g5:
  s_sub_u32 s24, s24, 1
  s_cbranch_scc1 L_FAIL
  s_add_u32 s61, s61, 1
  buffer_load_dwordx4 v[72:75], v111, s[4:7], s31 offen sc1
  s_waitcnt vmcnt(0)
  v_cmp_eq_u32 vcc, -1, v72
  s_cbranch_vccnz L_VOO_g5
  v_mov_b32 v89, 0
  v_max3_u32 v89, v96, v4, v89
  v_max3_u32 v89, v8, v12, v89
  v_max3_u32 v89, v16, v16, v89
  v_cmp_eq_u32 vcc, -1, v89
  s_cbranch_vccz L_VOO_ok5
  buffer_load_dwordx4 v[96:99], v112, s[4:7], s31 offen sc1
  s_nop 0
  buffer_load_dwordx4 v[4:7], v113, s[4:7], s31 offen sc1
  s_nop 0
  buffer_load_dwordx4 v[8:11], v110, s[4:7], s32 offen sc1
  s_nop 0
  buffer_load_dwordx4 v[12:15], v111, s[4:7], s32 offen sc1
  s_nop 0
  buffer_load_dwordx4 v[16:19], v112, s[4:7], s32 offen sc1
  s_nop 0
  s_branch L_VOO_ok5
L_VOO_g6:
  s_sub_u32 s24, s24, 1
  s_cbranch_scc1 L_FAIL
  s_add_u32 s61, s61, 1
  buffer_load_dwordx4 v[96:99], v112, s[4:7], s31 offen sc1
  s_waitcnt vmcnt(0)
  v_cmp_eq_u32 vcc, -1, v96
  s_cbranch_vccnz L_VOO_g6
  v_mov_b32 v89, 0
  v_max3_u32 v89, v4, v8, v89
  v_max3_u32 v89, v12, v16, v89
  v_max3_u32 v89, v68, v68, v89
  v_cmp_eq_u32 vcc, -1, v89
  s_cbranch_vccz L_VOO_ok6
  buffer_load_dwordx4 v[4:7], v113, s[4:7], s31 offen sc1
  s_nop 0
  buffer_load_dwordx4 v[8:11], v110, s[4:7], s32 offen sc1
  s_nop 0
  buffer_load_dwordx4 v[12:15], v111, s[4:7], s32 offen sc1
  s_nop 0
  buffer_load_dwordx4 v[16:19], v112, s[4:7], s32 offen sc1
  s_nop 0
  buffer_load_dwordx4 v[68:71], v113, s[4:7], s32 offen sc1
  s_nop 0
  s_branch L_VOO_ok6
L_VOO_g7:
  s_sub_u32 s24, s24, 1
  s_cbranch_scc1 L_FAIL
  s_add_u32 s61, s61, 1
  buffer_load_dwordx4 v[4:7], v113, s[4:7], s31 offen sc1
  s_waitcnt vmcnt(0)
  v_cmp_eq_u32 vcc, -1, v4
  s_cbranch_vccnz L_VOO_g7
  v_mov_b32 v89, 0
  v_max3_u32 v89, v8, v12, v89
  v_max3_u32 v89, v16, v68, v89
  v_max3_u32 v89, v72, v72, v89
  v_cmp_eq_u32 vcc, -1, v89
  s_cbranch_vccz L_VOO_ok7
  buffer_load_dwordx4 v[8:11], v110, s[4:7], s32 offen sc1
  s_nop 0
  buffer_load_dwordx4 v[12:15], v111, s[4:7], s32 offen sc1
  s_nop 0
  buffer_load_dwordx4 v[16:19], v112, s[4:7], s32 offen sc1
  s_nop 0
  buffer_load_dwordx4 v[68:71], v113, s[4:7], s32 offen sc1
  s_nop 0
  buffer_load_dwordx4 v[72:75], v110, s[4:7], s48 offen sc1
  s_nop 0
  s_branch L_VOO_ok7
L_VOO_g8:
  s_sub_u32 s24, s24, 1
  s_cbranch_scc1 L_FAIL
  s_add_u32 s61, s61, 256
  buffer_load_dwordx4 v[8:11], v110, s[4:7], s32 offen sc1
  s_waitcnt vmcnt(0)
  v_cmp_eq_u32 vcc, -1, v8
  s_cbranch_vccnz L_VOO_g8
  v_mov_b32 v89, 0
  v_max3_u32 v89, v12, v16, v89
  v_max3_u32 v89, v68, v72, v89
  v_max3_u32 v89, v96, v96, v89
  v_cmp_eq_u32 vcc, -1, v89
  s_cbranch_vccz L_VOO_ok8
  buffer_load_dwordx4 v[12:15], v111, s[4:7], s32 offen sc1
  s_nop 0
  buffer_load_dwordx4 v[16:19], v112, s[4:7], s32 offen sc1
  s_nop 0
  buffer_load_dwordx4 v[68:71], v113, s[4:7], s32 offen sc1
  s_nop 0
  buffer_load_dwordx4 v[72:75], v110, s[4:7], s48 offen sc1
  s_nop 0
  buffer_load_dwordx4 v[96:99], v111, s[4:7], s48 offen sc1
  s_nop 0
  s_branch L_VOO_ok8
L_VOO_g9:
  s_sub_u32 s24, s24, 1
  s_cbranch_scc1 L_FAIL
  s_add_u32 s61, s61, 256
  buffer_load_dwordx4 v[12:15], v111, s[4:7], s32 offen sc1
  s_waitcnt vmcnt(0)
  v_cmp_eq_u32 vcc, -1, v12
  s_cbranch_vccnz L_VOO_g9
  v_mov_b32 v89, 0
  v_max3_u32 v89, v16, v68, v89
  v_max3_u32 v89, v72, v96, v89
  v_max3_u32 v89, v4, v4, v89
  v_cmp_eq_u32 vcc, -1, v89
  s_cbranch_vccz L_VOO_ok9
  buffer_load_dwordx4 v[16:19], v112, s[4:7], s32 offen sc1
  s_nop 0
  buffer_load_dwordx4 v[68:71], v113, s[4:7], s32 offen sc1
  s_nop 0
  buffer_load_dwordx4 v[72:75], v110, s[4:7], s48 offen sc1
  s_nop 0
  buffer_load_dwordx4 v[96:99], v111, s[4:7], s48 offen sc1
  s_nop 0
  buffer_load_dwordx4 v[4:7], v112, s[4:7], s48 offen sc1
  s_nop 0
  s_branch L_VOO_ok9
L_VOO_g10:
  s_sub_u32 s24, s24, 1
  s_cbranch_scc1 L_FAIL
  s_add_u32 s61, s61, 256
  buffer_load_dwordx4 v[16:19], v112, s[4:7], s32 offen sc1
  s_waitcnt vmcnt(0)
  v_cmp_eq_u32 vcc, -1, v16
  s_cbranch_vccnz L_VOO_g10
  v_mov_b32 v89, 0
  v_max3_u32 v89, v68, v72, v89
  v_max3_u32 v89, v96, v4, v89
  v_max3_u32 v89, v8, v8, v89
  v_cmp_eq_u32 vcc, -1, v89
  s_cbranch_vccz L_VOO_ok10
  buffer_load_dwordx4 v[68:71], v113, s[4:7], s32 offen sc1
  s_nop 0
  buffer_load_dwordx4 v[72:75], v110, s[4:7], s48 offen sc1
  s_nop 0
  buffer_load_dwordx4 v[96:99], v111, s[4:7], s48 offen sc1
  s_nop 0
  buffer_load_dwordx4 v[4:7], v112, s[4:7], s48 offen sc1
  s_nop 0
  buffer_load_dwordx4 v[8:11], v113, s[4:7], s48 offen sc1
  s_nop 0
  s_branch L_VOO_ok10
L_VOO_g11:
  s_sub_u32 s24, s24, 1
  s_cbranch_scc1 L_FAIL
  s_add_u32 s61, s61, 256
  buffer_load_dwordx4 v[68:71], v113, s[4:7], s32 offen sc1
  s_waitcnt vmcnt(0)
  v_cmp_eq_u32 vcc, -1, v68
  s_cbranch_vccnz L_VOO_g11
  v_mov_b32 v89, 0
  v_max3_u32 v89, v72, v96, v89
  v_max3_u32 v89, v4, v8, v89
  v_cmp_eq_u32 vcc, -1, v89
  s_cbranch_vccz L_VOO_ok11
  buffer_load_dwordx4 v[72:75], v110, s[4:7], s48 offen sc1
  s_nop 0
  buffer_load_dwordx4 v[96:99], v111, s[4:7], s48 offen sc1
  s_nop 0
  buffer_load_dwordx4 v[4:7], v112, s[4:7], s48 offen sc1
  s_nop 0
  buffer_load_dwordx4 v[8:11], v113, s[4:7], s48 offen sc1
  s_nop 0
  s_branch L_VOO_ok11
L_VOO_g12:
  s_sub_u32 s24, s24, 1
  s_cbranch_scc1 L_FAIL
  s_add_u32 s61, s61, 256
  buffer_load_dwordx4 v[72:75], v110, s[4:7], s48 offen sc1
  s_waitcnt vmcnt(0)
  v_cmp_eq_u32 vcc, -1, v72
  s_cbranch_vccnz L_VOO_g12
  v_mov_b32 v89, 0
  v_max3_u32 v89, v96, v4, v89
  v_max3_u32 v89, v8, v8, v89
  v_cmp_eq_u32 vcc, -1, v89
  s_cbranch_vccz L_VOO_ok12
  buffer_load_dwordx4 v[96:99], v111, s[4:7], s48 offen sc1
  s_nop 0
  buffer_load_dwordx4 v[4:7], v112, s[4:7], s48 offen sc1
  s_nop 0
  buffer_load_dwordx4 v[8:11], v113, s[4:7], s48 offen sc1
  s_nop 0
  s_branch L_VOO_ok12
L_VOO_g13:
  s_sub_u32 s24, s24, 1
  s_cbranch_scc1 L_FAIL
  s_add_u32 s61, s61, 256
  buffer_load_dwordx4 v[96:99], v111, s[4:7], s48 offen sc1
  s_waitcnt vmcnt(0)
  v_cmp_eq_u32 vcc, -1, v96
  s_cbranch_vccnz L_VOO_g13
  v_mov_b32 v89, 0
  v_max3_u32 v89, v4, v8, v89
  v_cmp_eq_u32 vcc, -1, v89
  s_cbranch_vccz L_VOO_ok13
  buffer_load_dwordx4 v[4:7], v112, s[4:7], s48 offen sc1
  s_nop 0
  buffer_load_dwordx4 v[8:11], v113, s[4:7], s48 offen sc1
  s_nop 0
  s_branch L_VOO_ok13
L_VOO_g14:
  s_sub_u32 s24, s24, 1
  s_cbranch_scc1 L_FAIL
  s_add_u32 s61, s61, 256
  buffer_load_dwordx4 v[4:7], v112, s[4:7], s48 offen sc1
  s_waitcnt vmcnt(0)
  v_cmp_eq_u32 vcc, -1, v4
  s_cbranch_vccnz L_VOO_g14
  v_mov_b32 v89, 0
  v_max3_u32 v89, v8, v8, v89
  v_cmp_eq_u32 vcc, -1, v89
  s_cbranch_vccz L_VOO_ok14
  buffer_load_dwordx4 v[8:11], v113, s[4:7], s48 offen sc1
  s_nop 0
  s_branch L_VOO_ok14
L_VOO_g15:
  s_sub_u32 s24, s24, 1
  s_cbranch_scc1 L_FAIL
  s_add_u32 s61, s61, 256
  buffer_load_dwordx4 v[8:11], v113, s[4:7], s48 offen sc1
  s_waitcnt vmcnt(0)
  v_cmp_eq_u32 vcc, -1, v8
  s_cbranch_vccnz L_VOO_g15
  s_branch L_VOO_ok15
L_LAST:
  s_endpgm
.section .rodata,"a"
.p2align 6
.amdhsa_kernel adaLN_cond__memory_aug_recurrent_mem_tr__glu_gated_swiglu__prompt_kernel
  .amdhsa_next_free_vgpr 512
  .amdhsa_next_free_sgpr 102
  .amdhsa_accum_offset 256
  .amdhsa_group_segment_fixed_size 0
  .amdhsa_kernarg_size 128
  .amdhsa_user_sgpr_count 2
  .amdhsa_user_sgpr_kernarg_segment_ptr 1
  .amdhsa_system_sgpr_workgroup_id_x 1
  .amdhsa_float_denorm_mode_32 3
.end_amdhsa_kernel
```

```asm
; @launch grid=(256,1,1) block=(256,1,1) lds=163840
.amdgcn_target "amdgcn-amd-amdhsa--gfx950"
.text
.globl adaLN_cond__memory_aug_recurrent_mem_tr__glu_gated_swiglu__prompt_kernel
.p2align 8
.type adaLN_cond__memory_aug_recurrent_mem_tr__glu_gated_swiglu__prompt_kernel,@function
adaLN_cond__memory_aug_recurrent_mem_tr__glu_gated_swiglu__prompt_kernel:
  s_cmp_ge_u32 s2, 256
  s_cbranch_scc1 L_END
  s_load_dwordx2 s[4:5], s[0:1], 120
  s_load_dwordx2 s[12:13], s[0:1], 112
  v_lshrrev_b32 v1, 6, v0
  v_and_b32 v0, 63, v0
  v_readfirstlane_b32 s20, v1
  s_mov_b32 s6, 163610624
  s_mov_b32 s7, 0x20000
  s_mov_b32 s14, 256
  s_mov_b32 s15, 0x20000
  s_mov_b32 s24, 300000
  s_and_b32 s40, s2, 7
  s_mov_b32 s42, 0x3020100
  s_mov_b32 s43, 0x3020100
  s_cmp_eq_u32 s40, 1
  s_cselect_b32 s42, 0x1b161514, s42
  s_cselect_b32 s43, 0x1b1a1918, s43
  s_cmp_eq_u32 s40, 2
  s_cselect_b32 s42, 0xb0a0908, s42
  s_cselect_b32 s43, 0xb0a0908, s43
  s_cmp_eq_u32 s40, 3
  s_cselect_b32 s42, 0x1f1e1d1c, s42
  s_cselect_b32 s43, 0x1f1e1d1c, s43
  s_cmp_eq_u32 s40, 4
  s_cselect_b32 s42, 0x7060504, s42
  s_cselect_b32 s43, 0x7060504, s43
  s_cmp_eq_u32 s40, 5
  s_cselect_b32 s42, 0x13121110, s42
  s_cselect_b32 s43, 0x13121110, s43
  s_cmp_eq_u32 s40, 6
  s_cselect_b32 s42, 0xf0e0d0c, s42
  s_cselect_b32 s43, 0xf0e0d0c, s43
  s_cmp_eq_u32 s40, 7
  s_cselect_b32 s42, 0x1a191817, s42
  s_cselect_b32 s43, 0x17161514, s43
  s_lshr_b32 s40, s2, 6
  s_lshl_b32 s40, s40, 3
  s_lshr_b32 s42, s42, s40
  s_lshr_b32 s43, s43, s40
  s_bfe_u32 s41, s2, 0x30003
  s_and_b32 s42, s42, 31
  s_lshl_b32 s42, s42, 3
  s_add_u32 s3, s42, s41
  s_bfe_u32 s22, s43, 0x30002
  s_and_b32 s43, s43, 3
  s_lshl_b32 s43, s43, 3
  s_add_u32 s23, s43, s41
  s_waitcnt lgkmcnt(0)
  s_add_u32 s4, s4, 6291455
  s_addc_u32 s5, s5, 0
  s_and_b32 s4, s4, 0xffe00000
  s_cmp_lg_u32 s20, 3
  s_cbranch_scc1 L_NOPRE
  s_getpc_b64 s[40:41]
L_PC:
  s_lshr_b32 s42, s2, 3
  v_lshlrev_b32 v1, 12, v0
  s_lshl_b32 s42, s42, 7
  v_add_u32 v1, s42, v1
  v_min_u32 v1, L_LAST-L_PC, v1
  global_load_dword v255, v1, s[40:41]
L_NOPRE:
  s_cmp_ge_u32 s22, 4
  s_cbranch_scc1 L_TRAIL
  s_lshr_b32 s40, s22, 1
  s_bitcmp1_b32 s22, 0
  s_cbranch_scc0 L_REC
  s_lshl_b32 s40, s40, 5
  s_add_u32 s21, s40, s23
  s_branch L_QKV
L_REC:
  s_lshl_b32 s40, s40, 4
  s_lshr_b32 s41, s23, 1
  s_add_u32 s21, s40, s41
  s_bitcmp1_b32 s23, 0
  s_cbranch_scc1 L_VO
  s_branch L_QK
L_TRAIL:
  s_mov_b32 s21, s23
  s_cmp_eq_u32 s22, 6
  s_cbranch_scc1 L_MOD
  s_sub_u32 s40, s22, 4
  s_lshl_b32 s40, s40, 5
  s_add_u32 s21, s40, s23
  s_cmp_lg_u32 s22, 7
  s_cbranch_scc1 L_WOF
L_INIT:
  s_lshl_b32 s40, s23, 2
  s_add_u32 s40, s40, s20
  s_lshl_b32 s40, s40, 12
  s_add_u32 s41, s40, 1310720
  s_add_u32 s43, s40, 1900544
  s_add_u32 s42, s40, 0x80000
  v_lshlrev_b32 v1, 4, v0
  v_mov_b32 v4, -1
  v_mov_b32 v5, -1
  v_mov_b32 v6, -1
  v_mov_b32 v7, -1
  s_cmp_lt_u32 s23, 16
  s_cselect_b32 s41, s41, s43
  s_cmp_lt_u32 s23, 24
  s_cselect_b32 s41, s41, 2147483392
  buffer_store_dwordx4 v[4:7], v1, s[4:7], s41 offen offset:0 sc1
  buffer_store_dwordx4 v[4:7], v1, s[4:7], s41 offen offset:1024 sc1
  buffer_store_dwordx4 v[4:7], v1, s[4:7], s41 offen offset:2048 sc1
  buffer_store_dwordx4 v[4:7], v1, s[4:7], s41 offen offset:3072 sc1
  buffer_store_dwordx4 v[4:7], v1, s[4:7], s40 offen offset:0 sc1
  buffer_store_dwordx4 v[4:7], v1, s[4:7], s40 offen offset:1024 sc1
  buffer_store_dwordx4 v[4:7], v1, s[4:7], s40 offen offset:2048 sc1
  buffer_store_dwordx4 v[4:7], v1, s[4:7], s40 offen offset:3072 sc1
  buffer_store_dwordx4 v[4:7], v1, s[4:7], s42 offen offset:0 sc1
  buffer_store_dwordx4 v[4:7], v1, s[4:7], s42 offen offset:1024 sc1
  buffer_store_dwordx4 v[4:7], v1, s[4:7], s42 offen offset:2048 sc1
  buffer_store_dwordx4 v[4:7], v1, s[4:7], s42 offen offset:3072 sc1
  s_load_dwordx2 s[16:17], s[0:1], 8
  s_mov_b32 s18, 16384
  s_mov_b32 s19, 0x20000
  s_waitcnt lgkmcnt(0)
  s_and_b32 s40, s20, 1
  s_lshl_b32 s40, s40, 3
  v_bfe_u32 v8, v0, 2, 3
  v_add_u32 v8, s40, v8
  s_lshr_b32 s40, s20, 1
  s_lshl_b32 s40, s40, 3
  v_and_b32 v9, 3, v0
  v_add_u32 v9, s40, v9
  v_bfe_u32 v10, v8, 1, 1
  v_lshl_add_u32 v9, v10, 2, v9
  v_lshrrev_b32 v10, 2, v8
  v_and_b32 v11, 1, v8
  v_lshl_add_u32 v10, v10, 1, v11
  s_lshl_b32 s40, s23, 6
  v_lshl_add_u32 v10, v10, 11, s40
  v_lshl_add_u32 v10, v9, 1, v10
  buffer_load_ushort v11, v10, s[16:19], 0 offen
  buffer_load_ushort v12, v10, s[16:19], 0 offen offset:32
  s_bfe_u32 s41, s23, 0x10002
  s_mul_i32 s41, s41, 32768
  s_lshr_b32 s40, s23, 3
  s_lshl_b32 s40, s40, 11
  s_add_u32 s40, s40, s41
  s_and_b32 s41, s23, 3
  s_lshl_b32 s41, s41, 9
  s_add_u32 s40, s40, s41
  s_lshl_b32 s41, s20, 7
  s_add_u32 s40, s40, s41
  s_add_u32 s40, s40, 2097152
  s_add_u32 s41, s40, 0x4000
  v_and_b32 v8, 31, v0
  v_lshlrev_b32 v8, 2, v8
  v_lshrrev_b32 v9, 5, v0
  v_lshl_add_u32 v8, v9, 13, v8
  s_waitcnt vmcnt(0)
  v_lshl_or_b32 v11, v12, 16, v11
  v_min_u32 v11, -2, v11
  buffer_store_dword v11, v8, s[4:7], s40 offen sc1
  buffer_store_dword v11, v8, s[4:7], s41 offen sc1
  s_lshl_b32 s40, s23, 2
  s_add_u32 s40, s40, 128
  s_cmp_eq_u32 s20, 0
  s_cselect_b32 s40, s40, 2147483392
  v_mov_b32 v2, 2147483392
  s_mov_b64 exec, 1
  v_mov_b32 v2, s40
  s_mov_b64 exec, -1
  v_mov_b32 v3, 1
  s_waitcnt vmcnt(0)
  s_barrier
  buffer_store_dword v3, v2, s[12:15], 0 offen sc1
  s_branch L_LN1
L_MOD:
  s_load_dwordx2 s[16:17], s[0:1], 88
  s_mov_b32 s18, 2048
  s_mov_b32 s19, 0x20000
  s_waitcnt lgkmcnt(0)
  s_load_dwordx2 s[8:9], s[0:1], 96
  s_mov_b32 s10, 12582912
  s_mov_b32 s11, 0x20000
  s_waitcnt lgkmcnt(0)
  s_lshl_b32 s40, s20, 9
  v_lshl_add_u32 v1, v0, 3, s40
  buffer_load_dwordx2 v[8:9], v1, s[16:19], 0 offen
  v_bfe_u32 v2, v0, 5, 1
  v_mul_u32_u24 v2, 98304, v2
  v_bfe_u32 v3, v0, 4, 1
  v_mul_u32_u24 v3, 24576, v3
  v_add_u32 v2, v2, v3
  v_bfe_u32 v3, v0, 3, 1
  v_mul_u32_u24 v3, 12288, v3
  v_add_u32 v2, v2, v3
  v_lshrrev_b32 v3, 3, v0
  v_and_b32 v3, 6, v3
  v_xor_b32 v3, v3, v0
  v_and_b32 v3, 7, v3
  v_lshl_add_u32 v2, v3, 4, v2
  s_lshr_b32 s40, s20, 1
  s_mul_i32 s40, s40, 49152
  s_and_b32 s41, s20, 1
  s_mul_i32 s41, s41, 196608
  s_add_u32 s40, s40, s41
  s_lshl_b32 s41, s21, 7
  s_add_u32 s40, s40, s41
  v_add_u32 v2, s40, v2
  s_lshl_b32 s41, s20, 10
  s_add_u32 m0, s41, 0
  s_mov_b32 s42, 0
  buffer_load_dwordx4 v2, s[8:11], s42 offen nt lds
  s_add_u32 m0, s41, 4096
  s_mov_b32 s42, 393216
  buffer_load_dwordx4 v2, s[8:11], s42 offen nt lds
  s_add_u32 m0, s41, 8192
  s_mov_b32 s42, 786432
  buffer_load_dwordx4 v2, s[8:11], s42 offen nt lds
  s_add_u32 m0, s41, 12288
  s_mov_b32 s42, 1179648
  buffer_load_dwordx4 v2, s[8:11], s42 offen nt lds
  s_add_u32 m0, s41, 16384
  s_mov_b32 s42, 1572864
  buffer_load_dwordx4 v2, s[8:11], s42 offen nt lds
  s_add_u32 m0, s41, 20480
  s_mov_b32 s42, 1966080
  buffer_load_dwordx4 v2, s[8:11], s42 offen nt lds
  s_add_u32 m0, s41, 24576
  s_mov_b32 s42, 2359296
  buffer_load_dwordx4 v2, s[8:11], s42 offen nt lds
  s_add_u32 m0, s41, 28672
  s_mov_b32 s42, 2752512
  buffer_load_dwordx4 v2, s[8:11], s42 offen nt lds
  s_add_u32 m0, s41, 32768
  s_mov_b32 s42, 3145728
  buffer_load_dwordx4 v2, s[8:11], s42 offen nt lds
  s_add_u32 m0, s41, 36864
  s_mov_b32 s42, 3538944
  buffer_load_dwordx4 v2, s[8:11], s42 offen nt lds
  s_add_u32 m0, s41, 40960
  s_mov_b32 s42, 3932160
  buffer_load_dwordx4 v2, s[8:11], s42 offen nt lds
  s_add_u32 m0, s41, 45056
  s_mov_b32 s42, 4325376
  buffer_load_dwordx4 v2, s[8:11], s42 offen nt lds
  s_add_u32 m0, s41, 49152
  s_mov_b32 s42, 4718592
  buffer_load_dwordx4 v2, s[8:11], s42 offen nt lds
  s_add_u32 m0, s41, 53248
  s_mov_b32 s42, 5111808
  buffer_load_dwordx4 v2, s[8:11], s42 offen nt lds
  s_add_u32 m0, s41, 57344
  s_mov_b32 s42, 5505024
  buffer_load_dwordx4 v2, s[8:11], s42 offen nt lds
  s_add_u32 m0, s41, 61440
  s_mov_b32 s42, 5898240
  buffer_load_dwordx4 v2, s[8:11], s42 offen nt lds
  s_add_u32 m0, s41, 65536
  s_mov_b32 s42, 6291456
  buffer_load_dwordx4 v2, s[8:11], s42 offen nt lds
  s_add_u32 m0, s41, 69632
  s_mov_b32 s42, 6684672
  buffer_load_dwordx4 v2, s[8:11], s42 offen nt lds
  s_add_u32 m0, s41, 73728
  s_mov_b32 s42, 7077888
  buffer_load_dwordx4 v2, s[8:11], s42 offen nt lds
  s_add_u32 m0, s41, 77824
  s_mov_b32 s42, 7471104
  buffer_load_dwordx4 v2, s[8:11], s42 offen nt lds
  s_add_u32 m0, s41, 81920
  s_mov_b32 s42, 7864320
  buffer_load_dwordx4 v2, s[8:11], s42 offen nt lds
  s_add_u32 m0, s41, 86016
  s_mov_b32 s42, 8257536
  buffer_load_dwordx4 v2, s[8:11], s42 offen nt lds
  s_add_u32 m0, s41, 90112
  s_mov_b32 s42, 8650752
  buffer_load_dwordx4 v2, s[8:11], s42 offen nt lds
  s_add_u32 m0, s41, 94208
  s_mov_b32 s42, 9043968
  buffer_load_dwordx4 v2, s[8:11], s42 offen nt lds
  s_add_u32 m0, s41, 98304
  s_mov_b32 s42, 9437184
  buffer_load_dwordx4 v2, s[8:11], s42 offen nt lds
  s_add_u32 m0, s41, 102400
  s_mov_b32 s42, 9830400
  buffer_load_dwordx4 v2, s[8:11], s42 offen nt lds
  s_add_u32 m0, s41, 106496
  s_mov_b32 s42, 10223616
  buffer_load_dwordx4 v2, s[8:11], s42 offen nt lds
  s_add_u32 m0, s41, 110592
  s_mov_b32 s42, 10616832
  buffer_load_dwordx4 v2, s[8:11], s42 offen nt lds
  s_add_u32 m0, s41, 114688
  s_mov_b32 s42, 11010048
  buffer_load_dwordx4 v2, s[8:11], s42 offen nt lds
  s_add_u32 m0, s41, 118784
  s_mov_b32 s42, 11403264
  buffer_load_dwordx4 v2, s[8:11], s42 offen nt lds
  s_add_u32 m0, s41, 122880
  s_mov_b32 s42, 11796480
  buffer_load_dwordx4 v2, s[8:11], s42 offen nt lds
  s_add_u32 m0, s41, 126976
  s_mov_b32 s42, 12189696
  buffer_load_dwordx4 v2, s[8:11], s42 offen nt lds
  v_bfe_u32 v3, v0, 3, 2
  v_xor_b32 v3, s20, v3
  v_lshlrev_b32 v3, 5, v3
  v_lshrrev_b32 v4, 2, v0
  v_lshl_add_u32 v4, v4, 7, v3
  v_and_b32 v3, 3, v0
  v_lshl_add_u32 v4, v3, 3, v4
  v_add_u32 v5, 0x10000, v4
  v_lshrrev_b32 v6, 4, v0
  v_lshlrev_b32 v6, 4, v6
  v_add_u32 v6, 0x20000, v6
  v_add_u32 v1, 0x20000, v1
  s_mov_b32 s37, 0xbfb8aa3b
  s_waitcnt vmcnt(32)
  v_lshlrev_b32 v10, 16, v8
  v_and_b32 v11, 0xffff0000, v8
  v_lshlrev_b32 v12, 16, v9
  v_and_b32 v13, 0xffff0000, v9
  v_mul_f32 v14, s37, v10
  v_mul_f32 v15, s37, v11
  v_mul_f32 v16, s37, v12
  v_mul_f32 v17, s37, v13
  v_exp_f32 v14, v14
  v_exp_f32 v15, v15
  v_exp_f32 v16, v16
  v_exp_f32 v17, v17
  v_add_f32 v14, 1.0, v14
  v_add_f32 v15, 1.0, v15
  v_add_f32 v16, 1.0, v16
  v_add_f32 v17, 1.0, v17
  v_rcp_f32 v14, v14
  v_rcp_f32 v15, v15
  v_rcp_f32 v16, v16
  v_rcp_f32 v17, v17
  v_mul_f32 v10, v10, v14
  v_mul_f32 v11, v11, v15
  v_mul_f32 v12, v12, v16
  v_mul_f32 v13, v13, v17
  v_cvt_pk_bf16_f32 v8, v10, v11
  v_cvt_pk_bf16_f32 v9, v12, v13
  ds_write_b64 v1, v[8:9]
  s_waitcnt vmcnt(28) lgkmcnt(0)
  s_barrier
  ds_read_b64_tr_b16 v[24:25], v4 offset:0
  ds_read_b64_tr_b16 v[26:27], v4 offset:2048
  ds_read_b128 v[28:31], v6 offset:0
  ds_read_b64_tr_b16 v[32:33], v4 offset:4096
  ds_read_b64_tr_b16 v[34:35], v4 offset:6144
  ds_read_b128 v[36:39], v6 offset:64
  ds_read_b64_tr_b16 v[40:41], v4 offset:8192
  ds_read_b64_tr_b16 v[42:43], v4 offset:10240
  ds_read_b128 v[44:47], v6 offset:128
  ds_read_b64_tr_b16 v[48:49], v4 offset:12288
  ds_read_b64_tr_b16 v[50:51], v4 offset:14336
  ds_read_b128 v[52:55], v6 offset:192
  s_waitcnt lgkmcnt(9)
  v_mfma_f32_16x16x32_bf16 v[20:23], v[24:27], v[28:31], 0
  s_waitcnt lgkmcnt(6)
  v_mfma_f32_16x16x32_bf16 v[20:23], v[32:35], v[36:39], v[20:23]
  s_waitcnt lgkmcnt(3)
  v_mfma_f32_16x16x32_bf16 v[20:23], v[40:43], v[44:47], v[20:23]
  s_waitcnt lgkmcnt(0)
  v_mfma_f32_16x16x32_bf16 v[20:23], v[48:51], v[52:55], v[20:23]
  s_waitcnt vmcnt(24) lgkmcnt(0)
  s_barrier
  ds_read_b64_tr_b16 v[24:25], v4 offset:16384
  ds_read_b64_tr_b16 v[26:27], v4 offset:18432
  ds_read_b128 v[28:31], v6 offset:256
  ds_read_b64_tr_b16 v[32:33], v4 offset:20480
  ds_read_b64_tr_b16 v[34:35], v4 offset:22528
  ds_read_b128 v[36:39], v6 offset:320
  ds_read_b64_tr_b16 v[40:41], v4 offset:24576
  ds_read_b64_tr_b16 v[42:43], v4 offset:26624
  ds_read_b128 v[44:47], v6 offset:384
  ds_read_b64_tr_b16 v[48:49], v4 offset:28672
  ds_read_b64_tr_b16 v[50:51], v4 offset:30720
  ds_read_b128 v[52:55], v6 offset:448
  s_waitcnt lgkmcnt(9)
  v_mfma_f32_16x16x32_bf16 v[20:23], v[24:27], v[28:31], v[20:23]
  s_waitcnt lgkmcnt(6)
  v_mfma_f32_16x16x32_bf16 v[20:23], v[32:35], v[36:39], v[20:23]
  s_waitcnt lgkmcnt(3)
  v_mfma_f32_16x16x32_bf16 v[20:23], v[40:43], v[44:47], v[20:23]
  s_waitcnt lgkmcnt(0)
  v_mfma_f32_16x16x32_bf16 v[20:23], v[48:51], v[52:55], v[20:23]
  s_waitcnt vmcnt(20) lgkmcnt(0)
  s_barrier
  ds_read_b64_tr_b16 v[24:25], v4 offset:32768
  ds_read_b64_tr_b16 v[26:27], v4 offset:34816
  ds_read_b128 v[28:31], v6 offset:512
  ds_read_b64_tr_b16 v[32:33], v4 offset:36864
  ds_read_b64_tr_b16 v[34:35], v4 offset:38912
  ds_read_b128 v[36:39], v6 offset:576
  ds_read_b64_tr_b16 v[40:41], v4 offset:40960
  ds_read_b64_tr_b16 v[42:43], v4 offset:43008
  ds_read_b128 v[44:47], v6 offset:640
  ds_read_b64_tr_b16 v[48:49], v4 offset:45056
  ds_read_b64_tr_b16 v[50:51], v4 offset:47104
  ds_read_b128 v[52:55], v6 offset:704
  s_waitcnt lgkmcnt(9)
  v_mfma_f32_16x16x32_bf16 v[20:23], v[24:27], v[28:31], v[20:23]
  s_waitcnt lgkmcnt(6)
  v_mfma_f32_16x16x32_bf16 v[20:23], v[32:35], v[36:39], v[20:23]
  s_waitcnt lgkmcnt(3)
  v_mfma_f32_16x16x32_bf16 v[20:23], v[40:43], v[44:47], v[20:23]
  s_waitcnt lgkmcnt(0)
  v_mfma_f32_16x16x32_bf16 v[20:23], v[48:51], v[52:55], v[20:23]
  s_waitcnt vmcnt(16) lgkmcnt(0)
  s_barrier
  ds_read_b64_tr_b16 v[24:25], v4 offset:49152
  ds_read_b64_tr_b16 v[26:27], v4 offset:51200
  ds_read_b128 v[28:31], v6 offset:768
  ds_read_b64_tr_b16 v[32:33], v4 offset:53248
  ds_read_b64_tr_b16 v[34:35], v4 offset:55296
  ds_read_b128 v[36:39], v6 offset:832
  ds_read_b64_tr_b16 v[40:41], v4 offset:57344
  ds_read_b64_tr_b16 v[42:43], v4 offset:59392
  ds_read_b128 v[44:47], v6 offset:896
  ds_read_b64_tr_b16 v[48:49], v4 offset:61440
  ds_read_b64_tr_b16 v[50:51], v4 offset:63488
  ds_read_b128 v[52:55], v6 offset:960
  s_waitcnt lgkmcnt(9)
  v_mfma_f32_16x16x32_bf16 v[20:23], v[24:27], v[28:31], v[20:23]
  s_waitcnt lgkmcnt(6)
  v_mfma_f32_16x16x32_bf16 v[20:23], v[32:35], v[36:39], v[20:23]
  s_waitcnt lgkmcnt(3)
  v_mfma_f32_16x16x32_bf16 v[20:23], v[40:43], v[44:47], v[20:23]
  s_waitcnt lgkmcnt(0)
  v_mfma_f32_16x16x32_bf16 v[20:23], v[48:51], v[52:55], v[20:23]
  s_waitcnt vmcnt(12) lgkmcnt(0)
  s_barrier
  ds_read_b64_tr_b16 v[24:25], v5 offset:0
  ds_read_b64_tr_b16 v[26:27], v5 offset:2048
  ds_read_b128 v[28:31], v6 offset:1024
  ds_read_b64_tr_b16 v[32:33], v5 offset:4096
  ds_read_b64_tr_b16 v[34:35], v5 offset:6144
  ds_read_b128 v[36:39], v6 offset:1088
  ds_read_b64_tr_b16 v[40:41], v5 offset:8192
  ds_read_b64_tr_b16 v[42:43], v5 offset:10240
  ds_read_b128 v[44:47], v6 offset:1152
  ds_read_b64_tr_b16 v[48:49], v5 offset:12288
  ds_read_b64_tr_b16 v[50:51], v5 offset:14336
  ds_read_b128 v[52:55], v6 offset:1216
  s_waitcnt lgkmcnt(9)
  v_mfma_f32_16x16x32_bf16 v[20:23], v[24:27], v[28:31], v[20:23]
  s_waitcnt lgkmcnt(6)
  v_mfma_f32_16x16x32_bf16 v[20:23], v[32:35], v[36:39], v[20:23]
  s_waitcnt lgkmcnt(3)
  v_mfma_f32_16x16x32_bf16 v[20:23], v[40:43], v[44:47], v[20:23]
  s_waitcnt lgkmcnt(0)
  v_mfma_f32_16x16x32_bf16 v[20:23], v[48:51], v[52:55], v[20:23]
  s_waitcnt vmcnt(8) lgkmcnt(0)
  s_barrier
  ds_read_b64_tr_b16 v[24:25], v5 offset:16384
  ds_read_b64_tr_b16 v[26:27], v5 offset:18432
  ds_read_b128 v[28:31], v6 offset:1280
  ds_read_b64_tr_b16 v[32:33], v5 offset:20480
  ds_read_b64_tr_b16 v[34:35], v5 offset:22528
  ds_read_b128 v[36:39], v6 offset:1344
  ds_read_b64_tr_b16 v[40:41], v5 offset:24576
  ds_read_b64_tr_b16 v[42:43], v5 offset:26624
  ds_read_b128 v[44:47], v6 offset:1408
  ds_read_b64_tr_b16 v[48:49], v5 offset:28672
  ds_read_b64_tr_b16 v[50:51], v5 offset:30720
  ds_read_b128 v[52:55], v6 offset:1472
  s_waitcnt lgkmcnt(9)
  v_mfma_f32_16x16x32_bf16 v[20:23], v[24:27], v[28:31], v[20:23]
  s_waitcnt lgkmcnt(6)
  v_mfma_f32_16x16x32_bf16 v[20:23], v[32:35], v[36:39], v[20:23]
  s_waitcnt lgkmcnt(3)
  v_mfma_f32_16x16x32_bf16 v[20:23], v[40:43], v[44:47], v[20:23]
  s_waitcnt lgkmcnt(0)
  v_mfma_f32_16x16x32_bf16 v[20:23], v[48:51], v[52:55], v[20:23]
  s_waitcnt vmcnt(4) lgkmcnt(0)
  s_barrier
  ds_read_b64_tr_b16 v[24:25], v5 offset:32768
  ds_read_b64_tr_b16 v[26:27], v5 offset:34816
  ds_read_b128 v[28:31], v6 offset:1536
  ds_read_b64_tr_b16 v[32:33], v5 offset:36864
  ds_read_b64_tr_b16 v[34:35], v5 offset:38912
  ds_read_b128 v[36:39], v6 offset:1600
  ds_read_b64_tr_b16 v[40:41], v5 offset:40960
  ds_read_b64_tr_b16 v[42:43], v5 offset:43008
  ds_read_b128 v[44:47], v6 offset:1664
  ds_read_b64_tr_b16 v[48:49], v5 offset:45056
  ds_read_b64_tr_b16 v[50:51], v5 offset:47104
  ds_read_b128 v[52:55], v6 offset:1728
  s_waitcnt lgkmcnt(9)
  v_mfma_f32_16x16x32_bf16 v[20:23], v[24:27], v[28:31], v[20:23]
  s_waitcnt lgkmcnt(6)
  v_mfma_f32_16x16x32_bf16 v[20:23], v[32:35], v[36:39], v[20:23]
  s_waitcnt lgkmcnt(3)
  v_mfma_f32_16x16x32_bf16 v[20:23], v[40:43], v[44:47], v[20:23]
  s_waitcnt lgkmcnt(0)
  v_mfma_f32_16x16x32_bf16 v[20:23], v[48:51], v[52:55], v[20:23]
  s_waitcnt vmcnt(0) lgkmcnt(0)
  s_barrier
  ds_read_b64_tr_b16 v[24:25], v5 offset:49152
  ds_read_b64_tr_b16 v[26:27], v5 offset:51200
  ds_read_b128 v[28:31], v6 offset:1792
  ds_read_b64_tr_b16 v[32:33], v5 offset:53248
  ds_read_b64_tr_b16 v[34:35], v5 offset:55296
  ds_read_b128 v[36:39], v6 offset:1856
  ds_read_b64_tr_b16 v[40:41], v5 offset:57344
  ds_read_b64_tr_b16 v[42:43], v5 offset:59392
  ds_read_b128 v[44:47], v6 offset:1920
  ds_read_b64_tr_b16 v[48:49], v5 offset:61440
  ds_read_b64_tr_b16 v[50:51], v5 offset:63488
  ds_read_b128 v[52:55], v6 offset:1984
  s_waitcnt lgkmcnt(9)
  v_mfma_f32_16x16x32_bf16 v[20:23], v[24:27], v[28:31], v[20:23]
  s_waitcnt lgkmcnt(6)
  v_mfma_f32_16x16x32_bf16 v[20:23], v[32:35], v[36:39], v[20:23]
  s_waitcnt lgkmcnt(3)
  v_mfma_f32_16x16x32_bf16 v[20:23], v[40:43], v[44:47], v[20:23]
  s_waitcnt lgkmcnt(0)
  v_mfma_f32_16x16x32_bf16 v[20:23], v[48:51], v[52:55], v[20:23]
  s_lshl_b32 s40, s21, 8
  s_lshl_b32 s41, s20, 6
  s_add_u32 s40, s40, s41
  s_add_u32 s40, s40, 1572864
  v_and_b32 v2, 15, v0
  v_cmp_eq_u32 vcc, 0, v2
  v_mov_b32 v3, 2147483392
  s_nop 0
  v_cndmask_b32 v1, v3, v0, vcc
  v_cvt_pk_bf16_f32 v8, v20, v21
  v_cvt_pk_bf16_f32 v9, v22, v23
  v_lshlrev_b32 v20, 16, v8
  v_and_b32 v21, 0xffff0000, v8
  v_lshlrev_b32 v22, 16, v9
  v_and_b32 v23, 0xffff0000, v9
  buffer_store_dwordx4 v[20:23], v1, s[4:7], s40 offen sc1
  v_min_u32 v2, 31, v0
  v_lshlrev_b32 v2, 2, v2
  v_add_u32 v2, 128, v2
  s_nop 1
Lpoll_1:
  buffer_load_dword v3, v2, s[12:15], 0 offen sc1
  s_sub_u32 s24, s24, 1
  s_cbranch_scc1 L_FAIL
  s_waitcnt vmcnt(0)
  v_cmp_gt_i32 vcc, 1, v3
  s_cbranch_vccz Lpolld_2
  s_sleep 2
  s_branch Lpoll_1
Lpolld_2:
  s_lshl_b32 s40, s21, 7
  s_add_u32 s40, s40, 1376256
  v_mov_b32 v2, 2147483392
  s_mov_b64 exec, 1
  v_mov_b32 v2, s40
  s_mov_b64 exec, -1
  v_mov_b32 v3, 1
  s_barrier
  s_cmp_lg_u32 s20, 0
  s_cbranch_scc1 L_MOD_done
  buffer_store_dword v3, v2, s[4:7], 0 offen sc1
L_MOD_done:
  s_cmp_lg_u32 s22, 6
  s_cbranch_scc1 L_ROLE
L_LN1:
  s_load_dwordx2 s[16:17], s[0:1], 0
  s_mov_b32 s18, 4194304
  s_mov_b32 s19, 0x20000
  s_waitcnt lgkmcnt(0)
  s_sub_u32 s43, 7, s22
  s_lshl_b32 s43, s43, 5
  s_add_u32 s43, s43, s23
  s_lshl_b32 s43, s43, 2
  s_add_u32 s43, s43, s20
  s_lshl_b32 s44, s43, 13
  s_add_u32 s45, s44, 4096
  v_lshlrev_b32 v1, 3, v0
  v_lshlrev_b32 v2, 4, v0
  buffer_load_dwordx2 v[8:9], v1, s[16:19], s44 offen offset:0 nt
  buffer_load_dwordx2 v[10:11], v1, s[16:19], s44 offen offset:512 nt
  buffer_load_dwordx2 v[12:13], v1, s[16:19], s44 offen offset:1024 nt
  buffer_load_dwordx2 v[14:15], v1, s[16:19], s44 offen offset:1536 nt
  buffer_load_dwordx2 v[16:17], v1, s[16:19], s44 offen offset:2048 nt
  buffer_load_dwordx2 v[18:19], v1, s[16:19], s44 offen offset:2560 nt
  buffer_load_dwordx2 v[20:21], v1, s[16:19], s44 offen offset:3072 nt
  buffer_load_dwordx2 v[22:23], v1, s[16:19], s44 offen offset:3584 nt
  buffer_load_dwordx2 v[24:25], v1, s[16:19], s45 offen offset:0 nt
  buffer_load_dwordx2 v[26:27], v1, s[16:19], s45 offen offset:512 nt
  buffer_load_dwordx2 v[28:29], v1, s[16:19], s45 offen offset:1024 nt
  buffer_load_dwordx2 v[30:31], v1, s[16:19], s45 offen offset:1536 nt
  buffer_load_dwordx2 v[32:33], v1, s[16:19], s45 offen offset:2048 nt
  buffer_load_dwordx2 v[34:35], v1, s[16:19], s45 offen offset:2560 nt
  buffer_load_dwordx2 v[36:37], v1, s[16:19], s45 offen offset:3072 nt
  buffer_load_dwordx2 v[38:39], v1, s[16:19], s45 offen offset:3584 nt
  s_waitcnt vmcnt(0)
  v_lshlrev_b32 v40, 16, v8
  v_and_b32 v41, 0xffff0000, v8
  v_lshlrev_b32 v42, 16, v9
  v_and_b32 v43, 0xffff0000, v9
  v_lshlrev_b32 v44, 16, v10
  v_and_b32 v45, 0xffff0000, v10
  v_lshlrev_b32 v46, 16, v11
  v_and_b32 v47, 0xffff0000, v11
  v_lshlrev_b32 v48, 16, v12
  v_and_b32 v49, 0xffff0000, v12
  v_lshlrev_b32 v50, 16, v13
  v_and_b32 v51, 0xffff0000, v13
  v_lshlrev_b32 v52, 16, v14
  v_and_b32 v53, 0xffff0000, v14
  v_lshlrev_b32 v54, 16, v15
  v_and_b32 v55, 0xffff0000, v15
  v_lshlrev_b32 v56, 16, v16
  v_and_b32 v57, 0xffff0000, v16
  v_lshlrev_b32 v58, 16, v17
  v_and_b32 v59, 0xffff0000, v17
  v_lshlrev_b32 v60, 16, v18
  v_and_b32 v61, 0xffff0000, v18
  v_lshlrev_b32 v62, 16, v19
  v_and_b32 v63, 0xffff0000, v19
  v_lshlrev_b32 v64, 16, v20
  v_and_b32 v65, 0xffff0000, v20
  v_lshlrev_b32 v66, 16, v21
  v_and_b32 v67, 0xffff0000, v21
  v_lshlrev_b32 v68, 16, v22
  v_and_b32 v69, 0xffff0000, v22
  v_lshlrev_b32 v70, 16, v23
  v_and_b32 v71, 0xffff0000, v23
  v_lshlrev_b32 v72, 16, v24
  v_and_b32 v73, 0xffff0000, v24
  v_lshlrev_b32 v74, 16, v25
  v_and_b32 v75, 0xffff0000, v25
  v_lshlrev_b32 v76, 16, v26
  v_and_b32 v77, 0xffff0000, v26
  v_lshlrev_b32 v78, 16, v27
  v_and_b32 v79, 0xffff0000, v27
  v_lshlrev_b32 v80, 16, v28
  v_and_b32 v81, 0xffff0000, v28
  v_lshlrev_b32 v82, 16, v29
  v_and_b32 v83, 0xffff0000, v29
  v_lshlrev_b32 v84, 16, v30
  v_and_b32 v85, 0xffff0000, v30
  v_lshlrev_b32 v86, 16, v31
  v_and_b32 v87, 0xffff0000, v31
  v_lshlrev_b32 v88, 16, v32
  v_and_b32 v89, 0xffff0000, v32
  v_lshlrev_b32 v90, 16, v33
  v_and_b32 v91, 0xffff0000, v33
  v_lshlrev_b32 v92, 16, v34
  v_and_b32 v93, 0xffff0000, v34
  v_lshlrev_b32 v94, 16, v35
  v_and_b32 v95, 0xffff0000, v35
  v_lshlrev_b32 v96, 16, v36
  v_and_b32 v97, 0xffff0000, v36
  v_lshlrev_b32 v98, 16, v37
  v_and_b32 v99, 0xffff0000, v37
  v_lshlrev_b32 v100, 16, v38
  v_and_b32 v101, 0xffff0000, v38
  v_lshlrev_b32 v102, 16, v39
  v_and_b32 v103, 0xffff0000, v39
  v_pk_add_f32 v[104:105], v[40:41], v[42:43]
  v_pk_add_f32 v[108:109], v[56:57], v[58:59]
  v_pk_add_f32 v[112:113], v[72:73], v[74:75]
  v_pk_add_f32 v[116:117], v[88:89], v[90:91]
  v_pk_add_f32 v[104:105], v[104:105], v[44:45]
  v_pk_add_f32 v[108:109], v[108:109], v[60:61]
  v_pk_add_f32 v[112:113], v[112:113], v[76:77]
  v_pk_add_f32 v[116:117], v[116:117], v[92:93]
  v_pk_add_f32 v[104:105], v[104:105], v[46:47]
  v_pk_add_f32 v[108:109], v[108:109], v[62:63]
  v_pk_add_f32 v[112:113], v[112:113], v[78:79]
  v_pk_add_f32 v[116:117], v[116:117], v[94:95]
  v_pk_add_f32 v[104:105], v[104:105], v[48:49]
  v_pk_add_f32 v[108:109], v[108:109], v[64:65]
  v_pk_add_f32 v[112:113], v[112:113], v[80:81]
  v_pk_add_f32 v[116:117], v[116:117], v[96:97]
  v_pk_add_f32 v[104:105], v[104:105], v[50:51]
  v_pk_add_f32 v[108:109], v[108:109], v[66:67]
  v_pk_add_f32 v[112:113], v[112:113], v[82:83]
  v_pk_add_f32 v[116:117], v[116:117], v[98:99]
  v_pk_add_f32 v[104:105], v[104:105], v[52:53]
  v_pk_add_f32 v[108:109], v[108:109], v[68:69]
  v_pk_add_f32 v[112:113], v[112:113], v[84:85]
  v_pk_add_f32 v[116:117], v[116:117], v[100:101]
  v_pk_add_f32 v[104:105], v[104:105], v[54:55]
  v_pk_add_f32 v[108:109], v[108:109], v[70:71]
  v_pk_add_f32 v[112:113], v[112:113], v[86:87]
  v_pk_add_f32 v[116:117], v[116:117], v[102:103]
  v_add_f32 v104, v104, v105
  v_add_f32 v108, v108, v109
  v_add_f32 v112, v112, v113
  v_add_f32 v116, v116, v117
  v_add_f32_dpp v104, v104, v104 row_ror:8 row_mask:0xf bank_mask:0xf
  v_add_f32_dpp v108, v108, v108 row_ror:8 row_mask:0xf bank_mask:0xf
  v_add_f32_dpp v112, v112, v112 row_ror:8 row_mask:0xf bank_mask:0xf
  v_add_f32_dpp v116, v116, v116 row_ror:8 row_mask:0xf bank_mask:0xf
  v_add_f32_dpp v104, v104, v104 row_ror:4 row_mask:0xf bank_mask:0xf
  v_add_f32_dpp v108, v108, v108 row_ror:4 row_mask:0xf bank_mask:0xf
  v_add_f32_dpp v112, v112, v112 row_ror:4 row_mask:0xf bank_mask:0xf
  v_add_f32_dpp v116, v116, v116 row_ror:4 row_mask:0xf bank_mask:0xf
  v_add_f32_dpp v104, v104, v104 row_ror:2 row_mask:0xf bank_mask:0xf
  v_add_f32_dpp v108, v108, v108 row_ror:2 row_mask:0xf bank_mask:0xf
  v_add_f32_dpp v112, v112, v112 row_ror:2 row_mask:0xf bank_mask:0xf
  v_add_f32_dpp v116, v116, v116 row_ror:2 row_mask:0xf bank_mask:0xf
  v_add_f32_dpp v104, v104, v104 row_ror:1 row_mask:0xf bank_mask:0xf
  v_add_f32_dpp v108, v108, v108 row_ror:1 row_mask:0xf bank_mask:0xf
  v_add_f32_dpp v112, v112, v112 row_ror:1 row_mask:0xf bank_mask:0xf
  v_add_f32_dpp v116, v116, v116 row_ror:1 row_mask:0xf bank_mask:0xf
  v_mov_b32 v105, v104
  v_mov_b32 v109, v108
  v_mov_b32 v113, v112
  v_mov_b32 v117, v116
  v_permlane16_swap_b32 v105, v104
  v_permlane16_swap_b32 v109, v108
  v_permlane16_swap_b32 v113, v112
  v_permlane16_swap_b32 v117, v116
  v_add_f32 v104, v104, v105
  v_add_f32 v108, v108, v109
  v_add_f32 v112, v112, v113
  v_add_f32 v116, v116, v117
  v_mov_b32 v105, v104
  v_mov_b32 v109, v108
  v_mov_b32 v113, v112
  v_mov_b32 v117, v116
  v_permlane32_swap_b32 v105, v104
  v_permlane32_swap_b32 v109, v108
  v_permlane32_swap_b32 v113, v112
  v_permlane32_swap_b32 v117, v116
  v_add_f32 v104, v104, v105
  v_add_f32 v108, v108, v109
  v_add_f32 v112, v112, v113
  v_add_f32 v116, v116, v117
  v_mul_f32 v104, 0xba800000, v104
  v_mul_f32 v108, 0xba800000, v108
  v_mul_f32 v112, 0xba800000, v112
  v_mul_f32 v116, 0xba800000, v116
  v_pk_add_f32 v[40:41], v[40:41], v[104:105] op_sel_hi:[1,0]
  v_pk_add_f32 v[56:57], v[56:57], v[108:109] op_sel_hi:[1,0]
  v_pk_add_f32 v[72:73], v[72:73], v[112:113] op_sel_hi:[1,0]
  v_pk_add_f32 v[88:89], v[88:89], v[116:117] op_sel_hi:[1,0]
  v_pk_add_f32 v[42:43], v[42:43], v[104:105] op_sel_hi:[1,0]
  v_pk_add_f32 v[58:59], v[58:59], v[108:109] op_sel_hi:[1,0]
  v_pk_add_f32 v[74:75], v[74:75], v[112:113] op_sel_hi:[1,0]
  v_pk_add_f32 v[90:91], v[90:91], v[116:117] op_sel_hi:[1,0]
  v_pk_add_f32 v[44:45], v[44:45], v[104:105] op_sel_hi:[1,0]
  v_pk_add_f32 v[60:61], v[60:61], v[108:109] op_sel_hi:[1,0]
  v_pk_add_f32 v[76:77], v[76:77], v[112:113] op_sel_hi:[1,0]
  v_pk_add_f32 v[92:93], v[92:93], v[116:117] op_sel_hi:[1,0]
  v_pk_add_f32 v[46:47], v[46:47], v[104:105] op_sel_hi:[1,0]
  v_pk_add_f32 v[62:63], v[62:63], v[108:109] op_sel_hi:[1,0]
  v_pk_add_f32 v[78:79], v[78:79], v[112:113] op_sel_hi:[1,0]
  v_pk_add_f32 v[94:95], v[94:95], v[116:117] op_sel_hi:[1,0]
  v_pk_add_f32 v[48:49], v[48:49], v[104:105] op_sel_hi:[1,0]
  v_pk_add_f32 v[64:65], v[64:65], v[108:109] op_sel_hi:[1,0]
  v_pk_add_f32 v[80:81], v[80:81], v[112:113] op_sel_hi:[1,0]
  v_pk_add_f32 v[96:97], v[96:97], v[116:117] op_sel_hi:[1,0]
  v_pk_add_f32 v[50:51], v[50:51], v[104:105] op_sel_hi:[1,0]
  v_pk_add_f32 v[66:67], v[66:67], v[108:109] op_sel_hi:[1,0]
  v_pk_add_f32 v[82:83], v[82:83], v[112:113] op_sel_hi:[1,0]
  v_pk_add_f32 v[98:99], v[98:99], v[116:117] op_sel_hi:[1,0]
  v_pk_add_f32 v[52:53], v[52:53], v[104:105] op_sel_hi:[1,0]
  v_pk_add_f32 v[68:69], v[68:69], v[108:109] op_sel_hi:[1,0]
  v_pk_add_f32 v[84:85], v[84:85], v[112:113] op_sel_hi:[1,0]
  v_pk_add_f32 v[100:101], v[100:101], v[116:117] op_sel_hi:[1,0]
  v_pk_add_f32 v[54:55], v[54:55], v[104:105] op_sel_hi:[1,0]
  v_pk_add_f32 v[70:71], v[70:71], v[108:109] op_sel_hi:[1,0]
  v_pk_add_f32 v[86:87], v[86:87], v[112:113] op_sel_hi:[1,0]
  v_pk_add_f32 v[102:103], v[102:103], v[116:117] op_sel_hi:[1,0]
  v_pk_mul_f32 v[104:105], v[40:41], v[40:41]
  v_pk_mul_f32 v[108:109], v[56:57], v[56:57]
  v_pk_mul_f32 v[112:113], v[72:73], v[72:73]
  v_pk_mul_f32 v[116:117], v[88:89], v[88:89]
  v_pk_fma_f32 v[104:105], v[42:43], v[42:43], v[104:105]
  v_pk_fma_f32 v[108:109], v[58:59], v[58:59], v[108:109]
  v_pk_fma_f32 v[112:113], v[74:75], v[74:75], v[112:113]
  v_pk_fma_f32 v[116:117], v[90:91], v[90:91], v[116:117]
  v_pk_fma_f32 v[104:105], v[44:45], v[44:45], v[104:105]
  v_pk_fma_f32 v[108:109], v[60:61], v[60:61], v[108:109]
  v_pk_fma_f32 v[112:113], v[76:77], v[76:77], v[112:113]
  v_pk_fma_f32 v[116:117], v[92:93], v[92:93], v[116:117]
  v_pk_fma_f32 v[104:105], v[46:47], v[46:47], v[104:105]
  v_pk_fma_f32 v[108:109], v[62:63], v[62:63], v[108:109]
  v_pk_fma_f32 v[112:113], v[78:79], v[78:79], v[112:113]
  v_pk_fma_f32 v[116:117], v[94:95], v[94:95], v[116:117]
  v_pk_fma_f32 v[104:105], v[48:49], v[48:49], v[104:105]
  v_pk_fma_f32 v[108:109], v[64:65], v[64:65], v[108:109]
  v_pk_fma_f32 v[112:113], v[80:81], v[80:81], v[112:113]
  v_pk_fma_f32 v[116:117], v[96:97], v[96:97], v[116:117]
  v_pk_fma_f32 v[104:105], v[50:51], v[50:51], v[104:105]
  v_pk_fma_f32 v[108:109], v[66:67], v[66:67], v[108:109]
  v_pk_fma_f32 v[112:113], v[82:83], v[82:83], v[112:113]
  v_pk_fma_f32 v[116:117], v[98:99], v[98:99], v[116:117]
  v_pk_fma_f32 v[104:105], v[52:53], v[52:53], v[104:105]
  v_pk_fma_f32 v[108:109], v[68:69], v[68:69], v[108:109]
  v_pk_fma_f32 v[112:113], v[84:85], v[84:85], v[112:113]
  v_pk_fma_f32 v[116:117], v[100:101], v[100:101], v[116:117]
  v_pk_fma_f32 v[104:105], v[54:55], v[54:55], v[104:105]
  v_pk_fma_f32 v[108:109], v[70:71], v[70:71], v[108:109]
  v_pk_fma_f32 v[112:113], v[86:87], v[86:87], v[112:113]
  v_pk_fma_f32 v[116:117], v[102:103], v[102:103], v[116:117]
  v_add_f32 v104, v104, v105
  v_add_f32 v108, v108, v109
  v_add_f32 v112, v112, v113
  v_add_f32 v116, v116, v117
  v_add_f32_dpp v104, v104, v104 row_ror:8 row_mask:0xf bank_mask:0xf
  v_add_f32_dpp v108, v108, v108 row_ror:8 row_mask:0xf bank_mask:0xf
  v_add_f32_dpp v112, v112, v112 row_ror:8 row_mask:0xf bank_mask:0xf
  v_add_f32_dpp v116, v116, v116 row_ror:8 row_mask:0xf bank_mask:0xf
  v_add_f32_dpp v104, v104, v104 row_ror:4 row_mask:0xf bank_mask:0xf
  v_add_f32_dpp v108, v108, v108 row_ror:4 row_mask:0xf bank_mask:0xf
  v_add_f32_dpp v112, v112, v112 row_ror:4 row_mask:0xf bank_mask:0xf
  v_add_f32_dpp v116, v116, v116 row_ror:4 row_mask:0xf bank_mask:0xf
  v_add_f32_dpp v104, v104, v104 row_ror:2 row_mask:0xf bank_mask:0xf
  v_add_f32_dpp v108, v108, v108 row_ror:2 row_mask:0xf bank_mask:0xf
  v_add_f32_dpp v112, v112, v112 row_ror:2 row_mask:0xf bank_mask:0xf
  v_add_f32_dpp v116, v116, v116 row_ror:2 row_mask:0xf bank_mask:0xf
  v_add_f32_dpp v104, v104, v104 row_ror:1 row_mask:0xf bank_mask:0xf
  v_add_f32_dpp v108, v108, v108 row_ror:1 row_mask:0xf bank_mask:0xf
  v_add_f32_dpp v112, v112, v112 row_ror:1 row_mask:0xf bank_mask:0xf
  v_add_f32_dpp v116, v116, v116 row_ror:1 row_mask:0xf bank_mask:0xf
  v_mov_b32 v105, v104
  v_mov_b32 v109, v108
  v_mov_b32 v113, v112
  v_mov_b32 v117, v116
  v_permlane16_swap_b32 v105, v104
  v_permlane16_swap_b32 v109, v108
  v_permlane16_swap_b32 v113, v112
  v_permlane16_swap_b32 v117, v116
  v_add_f32 v104, v104, v105
  v_add_f32 v108, v108, v109
  v_add_f32 v112, v112, v113
  v_add_f32 v116, v116, v117
  v_mov_b32 v105, v104
  v_mov_b32 v109, v108
  v_mov_b32 v113, v112
  v_mov_b32 v117, v116
  v_permlane32_swap_b32 v105, v104
  v_permlane32_swap_b32 v109, v108
  v_permlane32_swap_b32 v113, v112
  v_permlane32_swap_b32 v117, v116
  v_add_f32 v104, v104, v105
  v_add_f32 v108, v108, v109
  v_add_f32 v112, v112, v113
  v_add_f32 v116, v116, v117
  v_mul_f32 v104, 0x3a800000, v104
  v_mul_f32 v108, 0x3a800000, v108
  v_mul_f32 v112, 0x3a800000, v112
  v_mul_f32 v116, 0x3a800000, v116
  v_add_f32 v104, 0x3727c5ac, v104
  v_add_f32 v108, 0x3727c5ac, v108
  v_add_f32 v112, 0x3727c5ac, v112
  v_add_f32 v116, 0x3727c5ac, v116
  v_rsq_f32 v104, v104
  v_rsq_f32 v108, v108
  v_rsq_f32 v112, v112
  v_rsq_f32 v116, v116
  v_pk_mul_f32 v[40:41], v[40:41], v[104:105] op_sel_hi:[1,0]
  v_pk_mul_f32 v[56:57], v[56:57], v[108:109] op_sel_hi:[1,0]
  v_pk_mul_f32 v[72:73], v[72:73], v[112:113] op_sel_hi:[1,0]
  v_pk_mul_f32 v[88:89], v[88:89], v[116:117] op_sel_hi:[1,0]
  v_pk_mul_f32 v[42:43], v[42:43], v[104:105] op_sel_hi:[1,0]
  v_pk_mul_f32 v[58:59], v[58:59], v[108:109] op_sel_hi:[1,0]
  v_pk_mul_f32 v[74:75], v[74:75], v[112:113] op_sel_hi:[1,0]
  v_pk_mul_f32 v[90:91], v[90:91], v[116:117] op_sel_hi:[1,0]
  v_pk_mul_f32 v[44:45], v[44:45], v[104:105] op_sel_hi:[1,0]
  v_pk_mul_f32 v[60:61], v[60:61], v[108:109] op_sel_hi:[1,0]
  v_pk_mul_f32 v[76:77], v[76:77], v[112:113] op_sel_hi:[1,0]
  v_pk_mul_f32 v[92:93], v[92:93], v[116:117] op_sel_hi:[1,0]
  v_pk_mul_f32 v[46:47], v[46:47], v[104:105] op_sel_hi:[1,0]
  v_pk_mul_f32 v[62:63], v[62:63], v[108:109] op_sel_hi:[1,0]
  v_pk_mul_f32 v[78:79], v[78:79], v[112:113] op_sel_hi:[1,0]
  v_pk_mul_f32 v[94:95], v[94:95], v[116:117] op_sel_hi:[1,0]
  v_pk_mul_f32 v[48:49], v[48:49], v[104:105] op_sel_hi:[1,0]
  v_pk_mul_f32 v[64:65], v[64:65], v[108:109] op_sel_hi:[1,0]
  v_pk_mul_f32 v[80:81], v[80:81], v[112:113] op_sel_hi:[1,0]
  v_pk_mul_f32 v[96:97], v[96:97], v[116:117] op_sel_hi:[1,0]
  v_pk_mul_f32 v[50:51], v[50:51], v[104:105] op_sel_hi:[1,0]
  v_pk_mul_f32 v[66:67], v[66:67], v[108:109] op_sel_hi:[1,0]
  v_pk_mul_f32 v[82:83], v[82:83], v[112:113] op_sel_hi:[1,0]
  v_pk_mul_f32 v[98:99], v[98:99], v[116:117] op_sel_hi:[1,0]
  v_pk_mul_f32 v[52:53], v[52:53], v[104:105] op_sel_hi:[1,0]
  v_pk_mul_f32 v[68:69], v[68:69], v[108:109] op_sel_hi:[1,0]
  v_pk_mul_f32 v[84:85], v[84:85], v[112:113] op_sel_hi:[1,0]
  v_pk_mul_f32 v[100:101], v[100:101], v[116:117] op_sel_hi:[1,0]
  v_pk_mul_f32 v[54:55], v[54:55], v[104:105] op_sel_hi:[1,0]
  v_pk_mul_f32 v[70:71], v[70:71], v[108:109] op_sel_hi:[1,0]
  v_pk_mul_f32 v[86:87], v[86:87], v[112:113] op_sel_hi:[1,0]
  v_pk_mul_f32 v[102:103], v[102:103], v[116:117] op_sel_hi:[1,0]
  v_min_u32 v3, 31, v0
  v_lshlrev_b32 v3, 2, v3
  v_add_u32 v3, 128, v3
  s_nop 1
Lpoll_3:
  buffer_load_dword v4, v3, s[12:15], 0 offen sc1
  s_sub_u32 s24, s24, 1
  s_cbranch_scc1 L_FAIL
  s_waitcnt vmcnt(0)
  v_cmp_gt_i32 vcc, 1, v4
  s_cbranch_vccz Lpolld_4
  s_sleep 2
  s_branch Lpoll_3
Lpolld_4:
  v_min_u32 v3, 31, v0
  v_lshlrev_b32 v3, 7, v3
  v_add_u32 v3, 1376256, v3
  s_nop 1
Lpoll_5:
  buffer_load_dword v4, v3, s[4:7], 0 offen sc1
  s_sub_u32 s24, s24, 1
  s_cbranch_scc1 L_FAIL
  s_waitcnt vmcnt(0)
  v_cmp_gt_i32 vcc, 1, v4
  s_cbranch_vccz Lpolld_6
  s_sleep 2
  s_branch Lpoll_5
Lpolld_6:
  s_mov_b32 s40, 1572864
  buffer_load_dwordx4 v[136:139], v2, s[4:7], s40 offen offset:0 sc1
  buffer_load_dwordx4 v[140:143], v2, s[4:7], s40 offen offset:1024 sc1
  buffer_load_dwordx4 v[144:147], v2, s[4:7], s40 offen offset:2048 sc1
  buffer_load_dwordx4 v[148:151], v2, s[4:7], s40 offen offset:3072 sc1
  s_mov_b32 s40, 1576960
  buffer_load_dwordx4 v[120:123], v2, s[4:7], s40 offen offset:0 sc1
  buffer_load_dwordx4 v[124:127], v2, s[4:7], s40 offen offset:1024 sc1
  buffer_load_dwordx4 v[128:131], v2, s[4:7], s40 offen offset:2048 sc1
  buffer_load_dwordx4 v[132:135], v2, s[4:7], s40 offen offset:3072 sc1
  s_waitcnt vmcnt(0)
  v_add_f32 v120, 1.0, v120
  v_add_f32 v121, 1.0, v121
  v_add_f32 v122, 1.0, v122
  v_add_f32 v123, 1.0, v123
  v_add_f32 v124, 1.0, v124
  v_add_f32 v125, 1.0, v125
  v_add_f32 v126, 1.0, v126
  v_add_f32 v127, 1.0, v127
  v_add_f32 v128, 1.0, v128
  v_add_f32 v129, 1.0, v129
  v_add_f32 v130, 1.0, v130
  v_add_f32 v131, 1.0, v131
  v_add_f32 v132, 1.0, v132
  v_add_f32 v133, 1.0, v133
  v_add_f32 v134, 1.0, v134
  v_add_f32 v135, 1.0, v135
  s_add_u32 s44, s44, 6291456
  s_add_u32 s45, s45, 6291456
  v_pk_fma_f32 v[40:41], v[40:41], v[120:121], v[136:137]
  v_pk_fma_f32 v[42:43], v[42:43], v[122:123], v[138:139]
  v_pk_fma_f32 v[44:45], v[44:45], v[124:125], v[140:141]
  v_pk_fma_f32 v[46:47], v[46:47], v[126:127], v[142:143]
  v_pk_fma_f32 v[48:49], v[48:49], v[128:129], v[144:145]
  v_pk_fma_f32 v[50:51], v[50:51], v[130:131], v[146:147]
  v_pk_fma_f32 v[52:53], v[52:53], v[132:133], v[148:149]
  v_pk_fma_f32 v[54:55], v[54:55], v[134:135], v[150:151]
  v_cvt_pk_bf16_f32 v8, v40, v41
  v_cvt_pk_bf16_f32 v9, v42, v43
  v_cvt_pk_bf16_f32 v10, v44, v45
  v_cvt_pk_bf16_f32 v11, v46, v47
  v_cvt_pk_bf16_f32 v12, v48, v49
  v_cvt_pk_bf16_f32 v13, v50, v51
  v_cvt_pk_bf16_f32 v14, v52, v53
  v_cvt_pk_bf16_f32 v15, v54, v55
  buffer_store_dwordx4 v[8:11], v2, s[4:7], s44 offen offset:0 sc1
  buffer_store_dwordx4 v[12:15], v2, s[4:7], s44 offen offset:1024 sc1
  v_pk_fma_f32 v[56:57], v[56:57], v[120:121], v[136:137]
  v_pk_fma_f32 v[58:59], v[58:59], v[122:123], v[138:139]
  v_pk_fma_f32 v[60:61], v[60:61], v[124:125], v[140:141]
  v_pk_fma_f32 v[62:63], v[62:63], v[126:127], v[142:143]
  v_pk_fma_f32 v[64:65], v[64:65], v[128:129], v[144:145]
  v_pk_fma_f32 v[66:67], v[66:67], v[130:131], v[146:147]
  v_pk_fma_f32 v[68:69], v[68:69], v[132:133], v[148:149]
  v_pk_fma_f32 v[70:71], v[70:71], v[134:135], v[150:151]
  v_cvt_pk_bf16_f32 v16, v56, v57
  v_cvt_pk_bf16_f32 v17, v58, v59
  v_cvt_pk_bf16_f32 v18, v60, v61
  v_cvt_pk_bf16_f32 v19, v62, v63
  v_cvt_pk_bf16_f32 v20, v64, v65
  v_cvt_pk_bf16_f32 v21, v66, v67
  v_cvt_pk_bf16_f32 v22, v68, v69
  v_cvt_pk_bf16_f32 v23, v70, v71
  buffer_store_dwordx4 v[16:19], v2, s[4:7], s44 offen offset:2048 sc1
  buffer_store_dwordx4 v[20:23], v2, s[4:7], s44 offen offset:3072 sc1
  v_pk_fma_f32 v[72:73], v[72:73], v[120:121], v[136:137]
  v_pk_fma_f32 v[74:75], v[74:75], v[122:123], v[138:139]
  v_pk_fma_f32 v[76:77], v[76:77], v[124:125], v[140:141]
  v_pk_fma_f32 v[78:79], v[78:79], v[126:127], v[142:143]
  v_pk_fma_f32 v[80:81], v[80:81], v[128:129], v[144:145]
  v_pk_fma_f32 v[82:83], v[82:83], v[130:131], v[146:147]
  v_pk_fma_f32 v[84:85], v[84:85], v[132:133], v[148:149]
  v_pk_fma_f32 v[86:87], v[86:87], v[134:135], v[150:151]
  v_cvt_pk_bf16_f32 v24, v72, v73
  v_cvt_pk_bf16_f32 v25, v74, v75
  v_cvt_pk_bf16_f32 v26, v76, v77
  v_cvt_pk_bf16_f32 v27, v78, v79
  v_cvt_pk_bf16_f32 v28, v80, v81
  v_cvt_pk_bf16_f32 v29, v82, v83
  v_cvt_pk_bf16_f32 v30, v84, v85
  v_cvt_pk_bf16_f32 v31, v86, v87
  buffer_store_dwordx4 v[24:27], v2, s[4:7], s45 offen offset:0 sc1
  buffer_store_dwordx4 v[28:31], v2, s[4:7], s45 offen offset:1024 sc1
  v_pk_fma_f32 v[88:89], v[88:89], v[120:121], v[136:137]
  v_pk_fma_f32 v[90:91], v[90:91], v[122:123], v[138:139]
  v_pk_fma_f32 v[92:93], v[92:93], v[124:125], v[140:141]
  v_pk_fma_f32 v[94:95], v[94:95], v[126:127], v[142:143]
  v_pk_fma_f32 v[96:97], v[96:97], v[128:129], v[144:145]
  v_pk_fma_f32 v[98:99], v[98:99], v[130:131], v[146:147]
  v_pk_fma_f32 v[100:101], v[100:101], v[132:133], v[148:149]
  v_pk_fma_f32 v[102:103], v[102:103], v[134:135], v[150:151]
  v_cvt_pk_bf16_f32 v32, v88, v89
  v_cvt_pk_bf16_f32 v33, v90, v91
  v_cvt_pk_bf16_f32 v34, v92, v93
  v_cvt_pk_bf16_f32 v35, v94, v95
  v_cvt_pk_bf16_f32 v36, v96, v97
  v_cvt_pk_bf16_f32 v37, v98, v99
  v_cvt_pk_bf16_f32 v38, v100, v101
  v_cvt_pk_bf16_f32 v39, v102, v103
  buffer_store_dwordx4 v[32:35], v2, s[4:7], s45 offen offset:2048 sc1
  buffer_store_dwordx4 v[36:39], v2, s[4:7], s45 offen offset:3072 sc1
  s_lshr_b32 s40, s43, 3
  s_lshl_b32 s40, s40, 7
  s_and_b32 s41, s43, 7
  s_lshl_b32 s41, s41, 2
  s_add_u32 s40, s40, s41
  s_add_u32 s40, s40, 1388544
  v_mov_b32 v3, 2147483392
  s_mov_b64 exec, 1
  v_mov_b32 v3, s40
  s_mov_b64 exec, -1
  v_mov_b32 v4, 1
  s_waitcnt vmcnt(0)
  buffer_store_dword v4, v3, s[4:7], 0 offen sc1
  s_cmp_lg_u32 s20, 2
  s_cbranch_scc1 Lnotlb_7
  v_lshlrev_b32 v1, 21, v0
  s_mov_b32 s40, 0x1fff80
  buffer_load_dword v2, v1, s[4:7], s40 offen sc1
  s_add_u32 s40, s40, 134217728
  buffer_load_dword v2, v1, s[4:7], s40 offen sc1
  s_waitcnt vmcnt(0)
Lnotlb_7:
  s_mov_b32 s40, 1404928
  s_cmp_lt_u32 s22, 6
  s_cselect_b32 s40, 1404928, s40
  v_mov_b32 v1, s40
  s_nop 1
Lpoll_8:
  buffer_load_dword v2, v1, s[4:7], 0 offen sc1
  s_sub_u32 s24, s24, 1
  s_cbranch_scc1 L_FAIL
  s_waitcnt vmcnt(0)
  v_cmp_gt_i32 vcc, 0, v2
  s_cbranch_vccz Lpolld_9
  s_sleep 8
  s_branch Lpoll_8
Lpolld_9:
  s_sub_u32 s40, s22, 3
  s_lshl_b32 s40, s40, 5
  s_add_u32 s21, s40, s23
  s_cmp_lt_u32 s22, 6
  s_cbranch_scc1 L_MOD
L_ROLE:
  s_sub_u32 s21, s3, 128
  s_cmp_lt_u32 s3, 160
  s_cbranch_scc1 L_WO
  s_sub_u32 s21, s3, 160
  s_cmp_lt_u32 s3, 216
  s_cbranch_scc1 L_F1
  s_sub_u32 s21, s3, 216
  s_cmp_lt_u32 s3, 224
  s_cbranch_scc1 L_LN2
  s_sub_u32 s21, s3, 224
  s_cmp_lt_u32 s3, 248
  s_cbranch_scc1 L_F2
  s_sub_u32 s21, s3, 248
  s_branch L_FIN
L_FAIL:
  s_mov_b64 exec, -1
  s_lshl_b32 s40, s2, 8
  s_add_u32 s40, s40, s25
  s_add_u32 s40, s40, 0x70000000
  v_mov_b32 v1, 60
  v_mov_b32 v2, s40
  buffer_store_dword v2, v1, s[12:15], 0 offen
L_END:
  s_endpgm
L_LN2:
  s_load_dwordx2 s[16:17], s[0:1], 0
  s_mov_b32 s18, 4194304
  s_mov_b32 s19, 0x20000
  s_waitcnt lgkmcnt(0)
  s_mov_b32 s25, 0
  s_mov_b32 s29, 1
  s_mov_b32 s26, 0
  s_cmp_eq_u32 s20, 0
  s_cselect_b32 s31, 0, 2147483392
  s_lshl_b32 s40, s21, 8
  s_lshl_b32 s41, s20, 15
  s_add_u32 s40, s40, s41
  v_and_b32 v6, 15, v0
  v_lshl_add_u32 v1, v6, 4, s40
  v_lshrrev_b32 v6, 4, v0
  v_lshl_add_u32 v1, v6, 11, v1
  v_and_b32 v6, 3, v0
  v_lshrrev_b32 v7, 5, v0
  v_lshrrev_b32 v8, 2, v0
  s_lshl_b32 s40, s20, 10
  v_lshl_add_u32 v5, v8, 4, s40
  s_lshl_b32 s40, s21, 13
  s_lshl_b32 s41, s20, 9
  s_add_u32 s40, s40, s41
  v_and_b32 v9, 31, v0
  v_lshl_add_u32 v10, v9, 4, s40
  v_lshl_add_u32 v10, v7, 11, v10
  v_min_u32 v16, 63, v0
  v_lshlrev_b32 v16, 7, v16
  v_add_u32 v16, 1424384, v16
  s_nop 1
Lpoll_10:
  buffer_load_dword v17, v16, s[4:7], 0 offen sc1
  s_sub_u32 s24, s24, 1
  s_cbranch_scc1 L_FAIL
  s_waitcnt vmcnt(0)
  v_cmp_gt_i32 vcc, 0, v17
  s_cbranch_vccz Lpolld_11
  s_sleep 1
  s_branch Lpoll_10
Lpolld_11:
  v_lshrrev_b32 v17, 8, v17
  v_and_b32 v18, 3, v0
  v_lshl_or_b32 v17, v17, 2, v18
  s_nop 1
  v_min_u32_dpp v17, v17, v17 row_ror:8 row_mask:0xf bank_mask:0xf
  s_nop 1
  v_min_u32_dpp v17, v17, v17 row_ror:4 row_mask:0xf bank_mask:0xf
  v_mov_b32 v18, v17
  s_nop 1
  v_permlane16_swap_b32 v18, v17
  v_min_u32 v17, v17, v18
  v_mov_b32 v18, v17
  s_nop 1
  v_permlane32_swap_b32 v18, v17
  v_min_u32 v17, v17, v18
  s_nop 1
  v_min_u32_dpp v17, v17, v17 row_ror:2 row_mask:0xf bank_mask:0xf
  s_nop 1
  v_min_u32_dpp v17, v17, v17 row_ror:1 row_mask:0xf bank_mask:0xf
  s_nop 0
  v_readfirstlane_b32 s27, v17
  s_and_b32 s27, s27, 3
  s_lshl_b32 s27, s27, 13
  s_and_b32 s27, s27, 0x2000
  s_xor_b32 s27, s27, 20979712
  v_min_u32 v2, 63, v0
  v_lshlrev_b32 v2, 7, v2
  v_add_u32 v2, 1380352, v2
  s_nop 1
Lpoll_12:
  buffer_load_dword v3, v2, s[4:7], 0 offen sc1
  s_sub_u32 s24, s24, 1
  s_cbranch_scc1 L_FAIL
  s_waitcnt vmcnt(0)
  v_cmp_gt_i32 vcc, 1, v3
  s_cbranch_vccz Lpolld_13
  s_sleep 2
  s_branch Lpoll_12
Lpolld_13:
  s_mov_b32 s40, 1585152
  buffer_load_dwordx4 v[64:67], v5, s[4:7], s40 offen offset:0 sc1
  buffer_load_dwordx4 v[68:71], v5, s[4:7], s40 offen offset:256 sc1
  buffer_load_dwordx4 v[72:75], v5, s[4:7], s40 offen offset:512 sc1
  buffer_load_dwordx4 v[76:79], v5, s[4:7], s40 offen offset:768 sc1
  s_mov_b32 s40, 1589248
  buffer_load_dwordx4 v[80:83], v5, s[4:7], s40 offen offset:0 sc1
  buffer_load_dwordx4 v[84:87], v5, s[4:7], s40 offen offset:256 sc1
  buffer_load_dwordx4 v[88:91], v5, s[4:7], s40 offen offset:512 sc1
  buffer_load_dwordx4 v[92:95], v5, s[4:7], s40 offen offset:768 sc1
  s_mov_b32 s40, 1581056
  buffer_load_dwordx4 v[48:51], v5, s[4:7], s40 offen offset:0 sc1
  buffer_load_dwordx4 v[52:55], v5, s[4:7], s40 offen offset:256 sc1
  buffer_load_dwordx4 v[56:59], v5, s[4:7], s40 offen offset:512 sc1
  buffer_load_dwordx4 v[60:63], v5, s[4:7], s40 offen offset:768 sc1
  s_waitcnt vmcnt(0)
  v_lshrrev_b32 v48, 16, v48
  v_lshrrev_b32 v50, 16, v50
  v_lshrrev_b32 v52, 16, v52
  v_lshrrev_b32 v54, 16, v54
  v_lshrrev_b32 v56, 16, v56
  v_lshrrev_b32 v58, 16, v58
  v_lshrrev_b32 v60, 16, v60
  v_lshrrev_b32 v62, 16, v62
  v_add_f32 v80, 1.0, v80
  v_add_f32 v81, 1.0, v81
  v_add_f32 v82, 1.0, v82
  v_add_f32 v83, 1.0, v83
  v_add_f32 v84, 1.0, v84
  v_add_f32 v85, 1.0, v85
  v_add_f32 v86, 1.0, v86
  v_add_f32 v87, 1.0, v87
  v_add_f32 v88, 1.0, v88
  v_add_f32 v89, 1.0, v89
  v_add_f32 v90, 1.0, v90
  v_add_f32 v91, 1.0, v91
  v_add_f32 v92, 1.0, v92
  v_add_f32 v93, 1.0, v93
  v_add_f32 v94, 1.0, v94
  v_add_f32 v95, 1.0, v95
  v_min_u32 v2, 31, v0
  v_lshlrev_b32 v2, 7, v2
  v_add_u32 v2, 1409024, v2
  s_lshl_b32 s62, s21, 7
  s_add_u32 s62, s62, 1413120
  s_lshl_b32 s30, s20, 11
  v_lshl_add_u32 v11, v6, 9, s30
  v_lshl_add_u32 v11, v8, 3, v11
  s_lshl_b32 s40, s20, 5
  s_add_u32 s40, s40, 8192
  v_lshl_add_u32 v12, v6, 3, s40
  v_lshlrev_b32 v13, 3, v6
  v_add_u32 v13, 8192, v13
  s_add_u32 m0, s30, 0
  s_add_u32 s40, s26, 0
  buffer_load_dwordx4 v10, s[16:19], s40 offen nt lds
  s_add_u32 m0, s30, 1024
  s_add_u32 s40, s26, 4096
  buffer_load_dwordx4 v10, s[16:19], s40 offen nt lds
  buffer_load_dword v3, v2, s[4:7], s31 offen sc1
  s_waitcnt vmcnt(1)
  ds_read_b64 v[24:25], v11 offset:0
  ds_read_b64 v[26:27], v11 offset:128
  ds_read_b64 v[28:29], v11 offset:256
  ds_read_b64 v[30:31], v11 offset:384
  s_waitcnt lgkmcnt(0)
L_LN2_top:
  v_lshlrev_b32 v96, 16, v24
  v_and_b32 v97, 0xffff0000, v24
  v_lshlrev_b32 v98, 16, v25
  v_and_b32 v99, 0xffff0000, v25
  v_lshlrev_b32 v100, 16, v26
  v_and_b32 v101, 0xffff0000, v26
  v_lshlrev_b32 v102, 16, v27
  v_and_b32 v103, 0xffff0000, v27
  v_lshlrev_b32 v104, 16, v28
  v_and_b32 v105, 0xffff0000, v28
  v_lshlrev_b32 v106, 16, v29
  v_and_b32 v107, 0xffff0000, v29
  v_lshlrev_b32 v108, 16, v30
  v_and_b32 v109, 0xffff0000, v30
  v_lshlrev_b32 v110, 16, v31
  v_and_b32 v111, 0xffff0000, v31
  s_cmp_lg_u32 s20, 0
  s_cbranch_scc1 Lgo_14
  s_waitcnt vmcnt(0)
  v_cmp_gt_i32 vcc, s29, v3
  s_cbranch_vccz Lgo_14
  s_nop 3
Lpoll_15:
  buffer_load_dword v3, v2, s[4:7], 0 offen sc1
  s_sub_u32 s24, s24, 1
  s_cbranch_scc1 L_FAIL
  s_waitcnt vmcnt(0)
  v_cmp_gt_i32 vcc, s29, v3
  s_cbranch_vccz Lpolld_16
  s_sleep 1
  s_branch Lpoll_15
Lpolld_16:
Lgo_14:
  s_barrier
  s_add_u32 s40, s27, 0
  buffer_load_dwordx4 v[112:115], v1, s[4:7], s40 offen sc1
  s_add_u32 s40, s27, 16384
  buffer_load_dwordx4 v[116:119], v1, s[4:7], s40 offen sc1
  s_add_u32 s40, s27, 131072
  buffer_load_dwordx4 v[120:123], v1, s[4:7], s40 offen sc1
  s_add_u32 s40, s27, 147456
  buffer_load_dwordx4 v[124:127], v1, s[4:7], s40 offen sc1
  s_add_u32 s40, s27, 262144
  buffer_load_dwordx4 v[128:131], v1, s[4:7], s40 offen sc1
  s_add_u32 s40, s27, 278528
  buffer_load_dwordx4 v[132:135], v1, s[4:7], s40 offen sc1
  s_add_u32 s40, s27, 393216
  buffer_load_dwordx4 v[136:139], v1, s[4:7], s40 offen sc1
  s_add_u32 s40, s27, 409600
  buffer_load_dwordx4 v[140:143], v1, s[4:7], s40 offen sc1
  s_add_u32 m0, s30, 0
  s_add_u32 s40, s26, 65536
  buffer_load_dwordx4 v10, s[16:19], s40 offen nt lds
  s_add_u32 m0, s30, 1024
  s_add_u32 s40, s26, 69632
  buffer_load_dwordx4 v10, s[16:19], s40 offen nt lds
  s_waitcnt vmcnt(9)
  v_dot2c_f32_bf16 v96, v112, v48
  v_dot2c_f32_bf16 v97, v112, v49
  v_dot2c_f32_bf16 v98, v113, v50
  v_dot2c_f32_bf16 v99, v113, v51
  v_dot2c_f32_bf16 v100, v114, v52
  v_dot2c_f32_bf16 v101, v114, v53
  v_dot2c_f32_bf16 v102, v115, v54
  v_dot2c_f32_bf16 v103, v115, v55
  s_waitcnt vmcnt(8)
  v_dot2c_f32_bf16 v104, v116, v56
  v_dot2c_f32_bf16 v105, v116, v57
  v_dot2c_f32_bf16 v106, v117, v58
  v_dot2c_f32_bf16 v107, v117, v59
  v_dot2c_f32_bf16 v108, v118, v60
  v_dot2c_f32_bf16 v109, v118, v61
  v_dot2c_f32_bf16 v110, v119, v62
  v_dot2c_f32_bf16 v111, v119, v63
  s_waitcnt vmcnt(7)
  v_dot2c_f32_bf16 v96, v120, v48
  v_dot2c_f32_bf16 v97, v120, v49
  v_dot2c_f32_bf16 v98, v121, v50
  v_dot2c_f32_bf16 v99, v121, v51
  v_dot2c_f32_bf16 v100, v122, v52
  v_dot2c_f32_bf16 v101, v122, v53
  v_dot2c_f32_bf16 v102, v123, v54
  v_dot2c_f32_bf16 v103, v123, v55
  s_waitcnt vmcnt(6)
  v_dot2c_f32_bf16 v104, v124, v56
  v_dot2c_f32_bf16 v105, v124, v57
  v_dot2c_f32_bf16 v106, v125, v58
  v_dot2c_f32_bf16 v107, v125, v59
  v_dot2c_f32_bf16 v108, v126, v60
  v_dot2c_f32_bf16 v109, v126, v61
  v_dot2c_f32_bf16 v110, v127, v62
  v_dot2c_f32_bf16 v111, v127, v63
  s_waitcnt vmcnt(5)
  v_dot2c_f32_bf16 v96, v128, v48
  v_dot2c_f32_bf16 v97, v128, v49
  v_dot2c_f32_bf16 v98, v129, v50
  v_dot2c_f32_bf16 v99, v129, v51
  v_dot2c_f32_bf16 v100, v130, v52
  v_dot2c_f32_bf16 v101, v130, v53
  v_dot2c_f32_bf16 v102, v131, v54
  v_dot2c_f32_bf16 v103, v131, v55
  s_waitcnt vmcnt(4)
  v_dot2c_f32_bf16 v104, v132, v56
  v_dot2c_f32_bf16 v105, v132, v57
  v_dot2c_f32_bf16 v106, v133, v58
  v_dot2c_f32_bf16 v107, v133, v59
  v_dot2c_f32_bf16 v108, v134, v60
  v_dot2c_f32_bf16 v109, v134, v61
  v_dot2c_f32_bf16 v110, v135, v62
  v_dot2c_f32_bf16 v111, v135, v63
  s_waitcnt vmcnt(3)
  v_dot2c_f32_bf16 v96, v136, v48
  v_dot2c_f32_bf16 v97, v136, v49
  v_dot2c_f32_bf16 v98, v137, v50
  v_dot2c_f32_bf16 v99, v137, v51
  v_dot2c_f32_bf16 v100, v138, v52
  v_dot2c_f32_bf16 v101, v138, v53
  v_dot2c_f32_bf16 v102, v139, v54
  v_dot2c_f32_bf16 v103, v139, v55
  s_waitcnt vmcnt(2)
  v_dot2c_f32_bf16 v104, v140, v56
  v_dot2c_f32_bf16 v105, v140, v57
  v_dot2c_f32_bf16 v106, v141, v58
  v_dot2c_f32_bf16 v107, v141, v59
  v_dot2c_f32_bf16 v108, v142, v60
  v_dot2c_f32_bf16 v109, v142, v61
  v_dot2c_f32_bf16 v110, v143, v62
  v_dot2c_f32_bf16 v111, v143, v63
  s_nop 2
  v_pk_add_f32 v[32:33], v[96:97], v[98:99]
  v_pk_add_f32 v[32:33], v[32:33], v[100:101]
  v_pk_add_f32 v[32:33], v[32:33], v[102:103]
  v_pk_add_f32 v[32:33], v[32:33], v[104:105]
  v_pk_add_f32 v[32:33], v[32:33], v[106:107]
  v_pk_add_f32 v[32:33], v[32:33], v[108:109]
  v_pk_add_f32 v[32:33], v[32:33], v[110:111]
  v_add_f32 v32, v32, v33
  s_nop 1
  v_add_f32_dpp v32, v32, v32 row_ror:4 row_mask:0xf bank_mask:0xf
  s_nop 1
  v_add_f32_dpp v32, v32, v32 row_ror:8 row_mask:0xf bank_mask:0xf
  v_mov_b32 v33, v32
  s_nop 1
  v_permlane16_swap_b32 v33, v32
  v_add_f32 v32, v32, v33
  v_mov_b32 v33, v32
  s_nop 1
  v_permlane32_swap_b32 v33, v32
  v_add_f32 v32, v32, v33
  v_mul_f32 v32, 0x3b800000, v32
  v_pk_add_f32 v[112:113], v[96:97], v[32:33] op_sel_hi:[1,0] neg_lo:[0,1] neg_hi:[0,1]
  v_pk_add_f32 v[114:115], v[98:99], v[32:33] op_sel_hi:[1,0] neg_lo:[0,1] neg_hi:[0,1]
  v_pk_add_f32 v[116:117], v[100:101], v[32:33] op_sel_hi:[1,0] neg_lo:[0,1] neg_hi:[0,1]
  v_pk_add_f32 v[118:119], v[102:103], v[32:33] op_sel_hi:[1,0] neg_lo:[0,1] neg_hi:[0,1]
  v_pk_add_f32 v[120:121], v[104:105], v[32:33] op_sel_hi:[1,0] neg_lo:[0,1] neg_hi:[0,1]
  v_pk_add_f32 v[122:123], v[106:107], v[32:33] op_sel_hi:[1,0] neg_lo:[0,1] neg_hi:[0,1]
  v_pk_add_f32 v[124:125], v[108:109], v[32:33] op_sel_hi:[1,0] neg_lo:[0,1] neg_hi:[0,1]
  v_pk_add_f32 v[126:127], v[110:111], v[32:33] op_sel_hi:[1,0] neg_lo:[0,1] neg_hi:[0,1]
  v_pk_mul_f32 v[34:35], v[112:113], v[112:113]
  v_pk_fma_f32 v[34:35], v[114:115], v[114:115], v[34:35]
  v_pk_fma_f32 v[34:35], v[116:117], v[116:117], v[34:35]
  v_pk_fma_f32 v[34:35], v[118:119], v[118:119], v[34:35]
  v_pk_fma_f32 v[34:35], v[120:121], v[120:121], v[34:35]
  v_pk_fma_f32 v[34:35], v[122:123], v[122:123], v[34:35]
  v_pk_fma_f32 v[34:35], v[124:125], v[124:125], v[34:35]
  v_pk_fma_f32 v[34:35], v[126:127], v[126:127], v[34:35]
  v_add_f32 v34, v34, v35
  s_nop 1
  v_add_f32_dpp v34, v34, v34 row_ror:4 row_mask:0xf bank_mask:0xf
  s_nop 1
  v_add_f32_dpp v34, v34, v34 row_ror:8 row_mask:0xf bank_mask:0xf
  v_mov_b32 v35, v34
  s_nop 1
  v_permlane16_swap_b32 v35, v34
  v_add_f32 v34, v34, v35
  v_mov_b32 v35, v34
  s_nop 1
  v_permlane32_swap_b32 v35, v34
  v_add_f32 v34, v34, v35
  v_mov_b32 v33, v34
  ds_write_b64 v12, v[32:33]
  v_cvt_pk_bf16_f32 v16, v96, v97
  v_cvt_pk_bf16_f32 v17, v98, v99
  v_cvt_pk_bf16_f32 v18, v100, v101
  v_cvt_pk_bf16_f32 v19, v102, v103
  v_cvt_pk_bf16_f32 v20, v104, v105
  v_cvt_pk_bf16_f32 v21, v106, v107
  v_cvt_pk_bf16_f32 v22, v108, v109
  v_cvt_pk_bf16_f32 v23, v110, v111
  s_waitcnt lgkmcnt(0)
  s_barrier
  ds_read2_b64 v[36:39], v13 offset0:0 offset1:4
  ds_read2_b64 v[40:43], v13 offset0:8 offset1:12
  s_add_u32 s40, s27, 1048576
  buffer_store_dwordx4 v[16:19], v1, s[4:7], s40 offen sc1
  s_add_u32 s40, s27, 1064960
  buffer_store_dwordx4 v[20:23], v1, s[4:7], s40 offen sc1
  s_waitcnt lgkmcnt(0)
  v_pk_add_f32 v[34:35], v[36:37], v[38:39]
  v_pk_add_f32 v[44:45], v[40:41], v[42:43]
  v_pk_add_f32 v[34:35], v[34:35], v[44:45]
  v_mul_f32 v34, 0x3e800000, v34
  v_mul_f32 v35, 0x3b800000, v35
  v_sub_f32 v36, v36, v34
  v_sub_f32 v38, v38, v34
  v_sub_f32 v40, v40, v34
  v_sub_f32 v42, v42, v34
  v_fmac_f32 v35, v36, v36
  v_fmac_f32 v35, v38, v38
  v_fmac_f32 v35, v40, v40
  v_fmac_f32 v35, v42, v42
  v_mul_f32 v35, 0x3e800000, v35
  v_add_f32 v35, 0x3727c5ac, v35
  v_rsq_f32 v44, v35
  v_sub_f32 v32, v32, v34
  v_mul_f32 v32, v32, v44
  v_pk_fma_f32 v[112:113], v[112:113], v[44:45], v[32:33] op_sel_hi:[1,0,0]
  v_pk_fma_f32 v[114:115], v[114:115], v[44:45], v[32:33] op_sel_hi:[1,0,0]
  v_pk_fma_f32 v[116:117], v[116:117], v[44:45], v[32:33] op_sel_hi:[1,0,0]
  v_pk_fma_f32 v[118:119], v[118:119], v[44:45], v[32:33] op_sel_hi:[1,0,0]
  v_pk_fma_f32 v[112:113], v[112:113], v[80:81], v[64:65]
  v_pk_fma_f32 v[114:115], v[114:115], v[82:83], v[66:67]
  v_pk_fma_f32 v[116:117], v[116:117], v[84:85], v[68:69]
  v_pk_fma_f32 v[118:119], v[118:119], v[86:87], v[70:71]
  v_cvt_pk_bf16_f32 v128, v112, v113
  v_cvt_pk_bf16_f32 v129, v114, v115
  v_cvt_pk_bf16_f32 v130, v116, v117
  v_cvt_pk_bf16_f32 v131, v118, v119
  s_add_u32 s40, s27, 917504
  buffer_store_dwordx4 v[128:131], v1, s[4:7], s40 offen sc1
  v_pk_fma_f32 v[120:121], v[120:121], v[44:45], v[32:33] op_sel_hi:[1,0,0]
  v_pk_fma_f32 v[122:123], v[122:123], v[44:45], v[32:33] op_sel_hi:[1,0,0]
  v_pk_fma_f32 v[124:125], v[124:125], v[44:45], v[32:33] op_sel_hi:[1,0,0]
  v_pk_fma_f32 v[126:127], v[126:127], v[44:45], v[32:33] op_sel_hi:[1,0,0]
  v_pk_fma_f32 v[120:121], v[120:121], v[88:89], v[72:73]
  v_pk_fma_f32 v[122:123], v[122:123], v[90:91], v[74:75]
  v_pk_fma_f32 v[124:125], v[124:125], v[92:93], v[76:77]
  v_pk_fma_f32 v[126:127], v[126:127], v[94:95], v[78:79]
  v_cvt_pk_bf16_f32 v132, v120, v121
  v_cvt_pk_bf16_f32 v133, v122, v123
  v_cvt_pk_bf16_f32 v134, v124, v125
  v_cvt_pk_bf16_f32 v135, v126, v127
  s_add_u32 s40, s27, 933888
  buffer_store_dwordx4 v[132:135], v1, s[4:7], s40 offen sc1
  buffer_load_dword v3, v2, s[4:7], s31 offen sc1
  s_waitcnt vmcnt(5)
  ds_read_b64 v[24:25], v11 offset:0
  ds_read_b64 v[26:27], v11 offset:128
  ds_read_b64 v[28:29], v11 offset:256
  ds_read_b64 v[30:31], v11 offset:384
  s_waitcnt vmcnt(1) lgkmcnt(0)
  s_barrier
  s_cmp_lg_u32 s20, 0
  s_cbranch_scc1 Lnosig_17
  s_mov_b32 s63, s29
  s_atomic_smax s63, s[4:5], s62 glc
Lnosig_17:
  s_add_u32 s25, s25, 1
  s_add_u32 s29, s29, 1
  s_add_u32 s26, s26, 65536
  s_add_u32 s27, s27, 2097152
  s_xor_b32 s27, s27, 0x2000
  s_cmp_lt_u32 s25, 64
  s_cbranch_scc1 L_LN2_top
  s_branch L_END
L_FIN:
  s_load_dwordx2 s[16:17], s[0:1], 104
  s_mov_b32 s18, 4194304
  s_mov_b32 s19, 0x20000
  s_waitcnt lgkmcnt(0)
  s_mov_b32 s25, 0
  s_mov_b32 s29, 1
  s_mov_b32 s26, 0
  s_cmp_eq_u32 s20, 0
  s_cselect_b32 s31, 0, 2147483392
  s_lshl_b32 s40, s21, 8
  s_lshl_b32 s41, s20, 15
  s_add_u32 s40, s40, s41
  v_and_b32 v6, 15, v0
  v_lshl_add_u32 v1, v6, 4, s40
  v_lshrrev_b32 v6, 4, v0
  v_lshl_add_u32 v1, v6, 11, v1
  v_and_b32 v6, 3, v0
  v_lshrrev_b32 v7, 5, v0
  v_lshrrev_b32 v8, 2, v0
  s_lshl_b32 s40, s20, 10
  v_lshl_add_u32 v5, v8, 4, s40
  s_lshl_b32 s40, s21, 13
  s_lshl_b32 s41, s20, 9
  s_add_u32 s40, s40, s41
  v_and_b32 v9, 31, v0
  v_lshl_add_u32 v10, v9, 4, s40
  v_lshl_add_u32 v10, v7, 11, v10
  v_min_u32 v16, 63, v0
  v_lshlrev_b32 v16, 7, v16
  v_add_u32 v16, 1424384, v16
  s_nop 1
Lpoll_18:
  buffer_load_dword v17, v16, s[4:7], 0 offen sc1
  s_sub_u32 s24, s24, 1
  s_cbranch_scc1 L_FAIL
  s_waitcnt vmcnt(0)
  v_cmp_gt_i32 vcc, 0, v17
  s_cbranch_vccz Lpolld_19
  s_sleep 1
  s_branch Lpoll_18
Lpolld_19:
  v_lshrrev_b32 v17, 8, v17
  v_and_b32 v18, 3, v0
  v_lshl_or_b32 v17, v17, 2, v18
  s_nop 1
  v_min_u32_dpp v17, v17, v17 row_ror:8 row_mask:0xf bank_mask:0xf
  s_nop 1
  v_min_u32_dpp v17, v17, v17 row_ror:4 row_mask:0xf bank_mask:0xf
  v_mov_b32 v18, v17
  s_nop 1
  v_permlane16_swap_b32 v18, v17
  v_min_u32 v17, v17, v18
  v_mov_b32 v18, v17
  s_nop 1
  v_permlane32_swap_b32 v18, v17
  v_min_u32 v17, v17, v18
  s_nop 1
  v_min_u32_dpp v17, v17, v17 row_ror:2 row_mask:0xf bank_mask:0xf
  s_nop 1
  v_min_u32_dpp v17, v17, v17 row_ror:1 row_mask:0xf bank_mask:0xf
  s_nop 0
  v_readfirstlane_b32 s27, v17
  s_and_b32 s27, s27, 3
  s_lshl_b32 s27, s27, 13
  s_and_b32 s27, s27, 0x2000
  s_xor_b32 s27, s27, 20979712
  v_min_u32 v2, 63, v0
  v_lshlrev_b32 v2, 7, v2
  v_add_u32 v2, 1380352, v2
  s_nop 1
Lpoll_20:
  buffer_load_dword v3, v2, s[4:7], 0 offen sc1
  s_sub_u32 s24, s24, 1
  s_cbranch_scc1 L_FAIL
  s_waitcnt vmcnt(0)
  v_cmp_gt_i32 vcc, 1, v3
  s_cbranch_vccz Lpolld_21
  s_sleep 2
  s_branch Lpoll_20
Lpolld_21:
  s_mov_b32 s40, 1593344
  buffer_load_dwordx4 v[48:51], v5, s[4:7], s40 offen offset:0 sc1
  buffer_load_dwordx4 v[52:55], v5, s[4:7], s40 offen offset:256 sc1
  buffer_load_dwordx4 v[56:59], v5, s[4:7], s40 offen offset:512 sc1
  buffer_load_dwordx4 v[60:63], v5, s[4:7], s40 offen offset:768 sc1
  s_waitcnt vmcnt(0)
  v_lshrrev_b32 v48, 16, v48
  v_lshrrev_b32 v50, 16, v50
  v_lshrrev_b32 v52, 16, v52
  v_lshrrev_b32 v54, 16, v54
  v_lshrrev_b32 v56, 16, v56
  v_lshrrev_b32 v58, 16, v58
  v_lshrrev_b32 v60, 16, v60
  v_lshrrev_b32 v62, 16, v62
  v_min_u32 v2, 23, v0
  v_lshlrev_b32 v2, 7, v2
  v_add_u32 v2, 1421312, v2
  s_mul_i32 s30, s20, 2176
  v_mul_u32_u24 v11, 544, v6
  v_lshl_add_u32 v11, v8, 3, v11
  v_add_u32 v11, s30, v11
  v_mul_u32_u24 v12, 544, v7
  v_lshl_add_u32 v12, v9, 4, v12
  v_add_u32 v12, s30, v12
  buffer_load_dword v3, v2, s[4:7], s31 offen sc1
  s_nop 0
L_FIN_top:
  s_cmp_lg_u32 s20, 0
  s_cbranch_scc1 Lgo_22
  s_waitcnt vmcnt(0)
  v_cmp_gt_i32 vcc, s29, v3
  s_cbranch_vccz Lgo_22
  s_nop 3
Lpoll_23:
  buffer_load_dword v3, v2, s[4:7], 0 offen sc1
  s_sub_u32 s24, s24, 1
  s_cbranch_scc1 L_FAIL
  s_waitcnt vmcnt(0)
  v_cmp_gt_i32 vcc, s29, v3
  s_cbranch_vccz Lpolld_24
  s_sleep 1
  s_branch Lpoll_23
Lpolld_24:
Lgo_22:
  s_barrier
  s_add_u32 s40, s27, 1048576
  buffer_load_dwordx4 v[16:19], v1, s[4:7], s40 offen sc1
  s_add_u32 s40, s27, 1064960
  buffer_load_dwordx4 v[20:23], v1, s[4:7], s40 offen sc1
  s_add_u32 s40, s27, 524288
  buffer_load_dwordx4 v[112:115], v1, s[4:7], s40 offen sc1
  s_add_u32 s40, s27, 540672
  buffer_load_dwordx4 v[116:119], v1, s[4:7], s40 offen sc1
  s_add_u32 s40, s27, 655360
  buffer_load_dwordx4 v[120:123], v1, s[4:7], s40 offen sc1
  s_add_u32 s40, s27, 671744
  buffer_load_dwordx4 v[124:127], v1, s[4:7], s40 offen sc1
  s_add_u32 s40, s27, 786432
  buffer_load_dwordx4 v[128:131], v1, s[4:7], s40 offen sc1
  s_add_u32 s40, s27, 802816
  buffer_load_dwordx4 v[132:135], v1, s[4:7], s40 offen sc1
  s_waitcnt vmcnt(6)
  v_lshlrev_b32 v96, 16, v16
  v_and_b32 v97, 0xffff0000, v16
  v_lshlrev_b32 v98, 16, v17
  v_and_b32 v99, 0xffff0000, v17
  v_lshlrev_b32 v100, 16, v18
  v_and_b32 v101, 0xffff0000, v18
  v_lshlrev_b32 v102, 16, v19
  v_and_b32 v103, 0xffff0000, v19
  v_lshlrev_b32 v104, 16, v20
  v_and_b32 v105, 0xffff0000, v20
  v_lshlrev_b32 v106, 16, v21
  v_and_b32 v107, 0xffff0000, v21
  v_lshlrev_b32 v108, 16, v22
  v_and_b32 v109, 0xffff0000, v22
  v_lshlrev_b32 v110, 16, v23
  v_and_b32 v111, 0xffff0000, v23
  s_waitcnt vmcnt(5)
  v_dot2c_f32_bf16 v96, v112, v48
  v_dot2c_f32_bf16 v97, v112, v49
  v_dot2c_f32_bf16 v98, v113, v50
  v_dot2c_f32_bf16 v99, v113, v51
  v_dot2c_f32_bf16 v100, v114, v52
  v_dot2c_f32_bf16 v101, v114, v53
  v_dot2c_f32_bf16 v102, v115, v54
  v_dot2c_f32_bf16 v103, v115, v55
  s_waitcnt vmcnt(4)
  v_dot2c_f32_bf16 v104, v116, v56
  v_dot2c_f32_bf16 v105, v116, v57
  v_dot2c_f32_bf16 v106, v117, v58
  v_dot2c_f32_bf16 v107, v117, v59
  v_dot2c_f32_bf16 v108, v118, v60
  v_dot2c_f32_bf16 v109, v118, v61
  v_dot2c_f32_bf16 v110, v119, v62
  v_dot2c_f32_bf16 v111, v119, v63
  s_waitcnt vmcnt(3)
  v_dot2c_f32_bf16 v96, v120, v48
  v_dot2c_f32_bf16 v97, v120, v49
  v_dot2c_f32_bf16 v98, v121, v50
  v_dot2c_f32_bf16 v99, v121, v51
  v_dot2c_f32_bf16 v100, v122, v52
  v_dot2c_f32_bf16 v101, v122, v53
  v_dot2c_f32_bf16 v102, v123, v54
  v_dot2c_f32_bf16 v103, v123, v55
  s_waitcnt vmcnt(2)
  v_dot2c_f32_bf16 v104, v124, v56
  v_dot2c_f32_bf16 v105, v124, v57
  v_dot2c_f32_bf16 v106, v125, v58
  v_dot2c_f32_bf16 v107, v125, v59
  v_dot2c_f32_bf16 v108, v126, v60
  v_dot2c_f32_bf16 v109, v126, v61
  v_dot2c_f32_bf16 v110, v127, v62
  v_dot2c_f32_bf16 v111, v127, v63
  s_waitcnt vmcnt(1)
  v_dot2c_f32_bf16 v96, v128, v48
  v_dot2c_f32_bf16 v97, v128, v49
  v_dot2c_f32_bf16 v98, v129, v50
  v_dot2c_f32_bf16 v99, v129, v51
  v_dot2c_f32_bf16 v100, v130, v52
  v_dot2c_f32_bf16 v101, v130, v53
  v_dot2c_f32_bf16 v102, v131, v54
  v_dot2c_f32_bf16 v103, v131, v55
  s_waitcnt vmcnt(0)
  v_dot2c_f32_bf16 v104, v132, v56
  v_dot2c_f32_bf16 v105, v132, v57
  v_dot2c_f32_bf16 v106, v133, v58
  v_dot2c_f32_bf16 v107, v133, v59
  v_dot2c_f32_bf16 v108, v134, v60
  v_dot2c_f32_bf16 v109, v134, v61
  v_dot2c_f32_bf16 v110, v135, v62
  v_dot2c_f32_bf16 v111, v135, v63
  s_nop 2
  buffer_load_dword v3, v2, s[4:7], s31 offen sc1
  v_cvt_pk_bf16_f32 v16, v96, v97
  v_cvt_pk_bf16_f32 v17, v98, v99
  v_cvt_pk_bf16_f32 v18, v100, v101
  v_cvt_pk_bf16_f32 v19, v102, v103
  v_cvt_pk_bf16_f32 v20, v104, v105
  v_cvt_pk_bf16_f32 v21, v106, v107
  v_cvt_pk_bf16_f32 v22, v108, v109
  v_cvt_pk_bf16_f32 v23, v110, v111
  ds_write_b64 v11, v[16:17] offset:0
  ds_write_b64 v11, v[18:19] offset:128
  ds_write_b64 v11, v[20:21] offset:256
  ds_write_b64 v11, v[22:23] offset:384
  ds_read_b128 v[112:115], v12 offset:0
  ds_read_b128 v[116:119], v12 offset:1088
  s_add_u32 s40, s26, 0
  s_waitcnt lgkmcnt(1)
  buffer_store_dwordx4 v[112:115], v10, s[16:19], s40 offen
  s_add_u32 s40, s26, 4096
  s_waitcnt lgkmcnt(0)
  buffer_store_dwordx4 v[116:119], v10, s[16:19], s40 offen
  s_add_u32 s25, s25, 1
  s_add_u32 s29, s29, 1
  s_add_u32 s26, s26, 65536
  s_add_u32 s27, s27, 2097152
  s_xor_b32 s27, s27, 0x2000
  s_cmp_lt_u32 s25, 64
  s_cbranch_scc1 L_FIN_top
  s_branch L_END
L_QKV:
  v_lshrrev_b32 v60, 3, v0
  v_and_b32 v61, 6, v60
  v_xor_b32 v61, v61, v0
  v_and_b32 v61, 7, v61
  v_lshlrev_b32 v61, 4, v61
  v_lshl_add_u32 v1, v60, 11, v61
  s_lshl_b32 s40, s20, 14
  v_add_u32 v1, s40, v1
  s_lshl_b32 s32, s20, 10
  v_and_b32 v60, 6, v0
  v_lshrrev_b32 v61, 4, v0
  v_xor_b32 v60, v60, v61
  v_lshlrev_b32 v60, 4, v60
  v_and_b32 v61, 15, v0
  v_lshl_add_u32 v77, v61, 7, v60
  v_xor_b32 v78, 64, v77
  s_and_b32 s43, s21, 1
  s_lshr_b32 s44, s21, 1
  s_lshl_b32 s44, s44, 8
  s_add_u32 s45, s44, 128
  s_lshl_b32 s46, s43, 7
  s_add_u32 s46, s46, s44
  s_load_dwordx4 s[48:51], s[0:1], 16
  s_waitcnt lgkmcnt(0)
  s_cmp_eq_u32 s43, 0
  s_cselect_b32 s8, s48, s50
  s_cselect_b32 s9, s49, s51
  s_mov_b32 s10, 8388608
  s_mov_b32 s11, 0x20000
  v_bfe_u32 v4, v0, 5, 1
  v_mul_u32_u24 v4, 32768, v4
  v_bfe_u32 v5, v0, 4, 1
  v_mul_u32_u24 v5, 16384, v5
  v_add_u32 v4, v4, v5
  v_bfe_u32 v5, v0, 3, 1
  v_mul_u32_u24 v5, 8192, v5
  v_add_u32 v4, v4, v5
  v_lshrrev_b32 v5, 3, v0
  v_and_b32 v5, 6, v5
  v_xor_b32 v5, v5, v0
  v_and_b32 v5, 7, v5
  v_lshl_add_u32 v4, v5, 4, v4
  s_lshr_b32 s40, s20, 1
  s_mul_i32 s40, s40, 2097152
  s_and_b32 s41, s20, 1
  s_mul_i32 s41, s41, 65536
  s_add_u32 s40, s40, s41
  v_add_u32 v4, s40, v4
  v_bfe_u32 v5, v0, 3, 2
  v_xor_b32 v5, s20, v5
  v_lshlrev_b32 v5, 5, v5
  v_lshrrev_b32 v6, 2, v0
  v_lshl_add_u32 v6, v6, 7, v5
  v_and_b32 v5, 3, v0
  v_lshl_add_u32 v6, v5, 3, v6
  v_add_u32 v7, 0x10000, v6
  v_add_u32 v8, s44, v4
  v_add_u32 v9, s45, v4
  v_add_u32 v10, s46, v4
  s_lshl_b32 s41, s20, 10
  s_add_u32 m0, s41, 0
  s_mov_b32 s42, 0
  buffer_load_dwordx4 v8, s[8:11], s42 offen lds
  s_add_u32 m0, s41, 4096
  s_mov_b32 s42, 0
  buffer_load_dwordx4 v9, s[8:11], s42 offen lds
  s_add_u32 m0, s41, 8192
  s_mov_b32 s42, 131072
  buffer_load_dwordx4 v8, s[8:11], s42 offen lds
  s_add_u32 m0, s41, 12288
  s_mov_b32 s42, 131072
  buffer_load_dwordx4 v9, s[8:11], s42 offen lds
  s_add_u32 m0, s41, 16384
  s_mov_b32 s42, 262144
  buffer_load_dwordx4 v8, s[8:11], s42 offen lds
  s_add_u32 m0, s41, 20480
  s_mov_b32 s42, 262144
  buffer_load_dwordx4 v9, s[8:11], s42 offen lds
  s_add_u32 m0, s41, 24576
  s_mov_b32 s42, 393216
  buffer_load_dwordx4 v8, s[8:11], s42 offen lds
  s_add_u32 m0, s41, 28672
  s_mov_b32 s42, 393216
  buffer_load_dwordx4 v9, s[8:11], s42 offen lds
  s_add_u32 m0, s41, 32768
  s_mov_b32 s42, 524288
  buffer_load_dwordx4 v8, s[8:11], s42 offen lds
  s_add_u32 m0, s41, 36864
  s_mov_b32 s42, 524288
  buffer_load_dwordx4 v9, s[8:11], s42 offen lds
  s_add_u32 m0, s41, 40960
  s_mov_b32 s42, 655360
  buffer_load_dwordx4 v8, s[8:11], s42 offen lds
  s_add_u32 m0, s41, 45056
  s_mov_b32 s42, 655360
  buffer_load_dwordx4 v9, s[8:11], s42 offen lds
  s_add_u32 m0, s41, 49152
  s_mov_b32 s42, 786432
  buffer_load_dwordx4 v8, s[8:11], s42 offen lds
  s_add_u32 m0, s41, 53248
  s_mov_b32 s42, 786432
  buffer_load_dwordx4 v9, s[8:11], s42 offen lds
  s_add_u32 m0, s41, 57344
  s_mov_b32 s42, 917504
  buffer_load_dwordx4 v8, s[8:11], s42 offen lds
  s_add_u32 m0, s41, 61440
  s_mov_b32 s42, 917504
  buffer_load_dwordx4 v9, s[8:11], s42 offen lds
  s_add_u32 m0, s41, 65536
  s_mov_b32 s42, 1048576
  buffer_load_dwordx4 v8, s[8:11], s42 offen lds
  s_add_u32 m0, s41, 69632
  s_mov_b32 s42, 1048576
  buffer_load_dwordx4 v9, s[8:11], s42 offen lds
  s_add_u32 m0, s41, 73728
  s_mov_b32 s42, 1179648
  buffer_load_dwordx4 v8, s[8:11], s42 offen lds
  s_add_u32 m0, s41, 77824
  s_mov_b32 s42, 1179648
  buffer_load_dwordx4 v9, s[8:11], s42 offen lds
  s_add_u32 m0, s41, 81920
  s_mov_b32 s42, 1310720
  buffer_load_dwordx4 v8, s[8:11], s42 offen lds
  s_add_u32 m0, s41, 86016
  s_mov_b32 s42, 1310720
  buffer_load_dwordx4 v9, s[8:11], s42 offen lds
  s_add_u32 m0, s41, 90112
  s_mov_b32 s42, 1441792
  buffer_load_dwordx4 v8, s[8:11], s42 offen lds
  s_add_u32 m0, s41, 94208
  s_mov_b32 s42, 1441792
  buffer_load_dwordx4 v9, s[8:11], s42 offen lds
  s_add_u32 m0, s41, 98304
  s_mov_b32 s42, 1572864
  buffer_load_dwordx4 v8, s[8:11], s42 offen lds
  s_add_u32 m0, s41, 102400
  s_mov_b32 s42, 1572864
  buffer_load_dwordx4 v9, s[8:11], s42 offen lds
  s_add_u32 m0, s41, 106496
  s_mov_b32 s42, 1703936
  buffer_load_dwordx4 v8, s[8:11], s42 offen lds
  s_add_u32 m0, s41, 110592
  s_mov_b32 s42, 1703936
  buffer_load_dwordx4 v9, s[8:11], s42 offen lds
  s_waitcnt vmcnt(24) lgkmcnt(0)
  s_barrier
  s_add_u32 m0, s41, 114688
  s_mov_b32 s42, 1835008
  buffer_load_dwordx4 v8, s[8:11], s42 offen lds
  s_add_u32 m0, s41, 118784
  s_mov_b32 s42, 1835008
  buffer_load_dwordx4 v9, s[8:11], s42 offen lds
  s_add_u32 m0, s41, 122880
  s_mov_b32 s42, 1966080
  buffer_load_dwordx4 v8, s[8:11], s42 offen lds
  s_add_u32 m0, s41, 126976
  s_mov_b32 s42, 1966080
  buffer_load_dwordx4 v9, s[8:11], s42 offen lds
  ds_read_b64_tr_b16 a[0:1], v6 offset:0
  ds_read_b64_tr_b16 a[2:3], v6 offset:2048
  ds_read_b64_tr_b16 a[128:129], v6 offset:4096
  ds_read_b64_tr_b16 a[130:131], v6 offset:6144
  ds_read_b64_tr_b16 a[4:5], v6 offset:8192
  ds_read_b64_tr_b16 a[6:7], v6 offset:10240
  ds_read_b64_tr_b16 a[132:133], v6 offset:12288
  ds_read_b64_tr_b16 a[134:135], v6 offset:14336
  s_waitcnt vmcnt(24) lgkmcnt(0)
  s_barrier
  s_add_u32 m0, s41, 0
  s_mov_b32 s42, 4194304
  buffer_load_dwordx4 v8, s[8:11], s42 offen lds
  s_add_u32 m0, s41, 4096
  s_mov_b32 s42, 4194304
  buffer_load_dwordx4 v9, s[8:11], s42 offen lds
  s_add_u32 m0, s41, 8192
  s_mov_b32 s42, 4325376
  buffer_load_dwordx4 v8, s[8:11], s42 offen lds
  s_add_u32 m0, s41, 12288
  s_mov_b32 s42, 4325376
  buffer_load_dwordx4 v9, s[8:11], s42 offen lds
  ds_read_b64_tr_b16 a[8:9], v6 offset:16384
  ds_read_b64_tr_b16 a[10:11], v6 offset:18432
  ds_read_b64_tr_b16 a[136:137], v6 offset:20480
  ds_read_b64_tr_b16 a[138:139], v6 offset:22528
  ds_read_b64_tr_b16 a[12:13], v6 offset:24576
  ds_read_b64_tr_b16 a[14:15], v6 offset:26624
  ds_read_b64_tr_b16 a[140:141], v6 offset:28672
  ds_read_b64_tr_b16 a[142:143], v6 offset:30720
  s_waitcnt vmcnt(24) lgkmcnt(0)
  s_barrier
  s_add_u32 m0, s41, 16384
  s_mov_b32 s42, 4456448
  buffer_load_dwordx4 v8, s[8:11], s42 offen lds
  s_add_u32 m0, s41, 20480
  s_mov_b32 s42, 4456448
  buffer_load_dwordx4 v9, s[8:11], s42 offen lds
  s_add_u32 m0, s41, 24576
  s_mov_b32 s42, 4587520
  buffer_load_dwordx4 v8, s[8:11], s42 offen lds
  s_add_u32 m0, s41, 28672
  s_mov_b32 s42, 4587520
  buffer_load_dwordx4 v9, s[8:11], s42 offen lds
  ds_read_b64_tr_b16 a[16:17], v6 offset:32768
  ds_read_b64_tr_b16 a[18:19], v6 offset:34816
  ds_read_b64_tr_b16 a[144:145], v6 offset:36864
  ds_read_b64_tr_b16 a[146:147], v6 offset:38912
  ds_read_b64_tr_b16 a[20:21], v6 offset:40960
  ds_read_b64_tr_b16 a[22:23], v6 offset:43008
  ds_read_b64_tr_b16 a[148:149], v6 offset:45056
  ds_read_b64_tr_b16 a[150:151], v6 offset:47104
  s_waitcnt vmcnt(24) lgkmcnt(0)
  s_barrier
  s_add_u32 m0, s41, 32768
  s_mov_b32 s42, 4718592
  buffer_load_dwordx4 v8, s[8:11], s42 offen lds
  s_add_u32 m0, s41, 36864
  s_mov_b32 s42, 4718592
  buffer_load_dwordx4 v9, s[8:11], s42 offen lds
  s_add_u32 m0, s41, 40960
  s_mov_b32 s42, 4849664
  buffer_load_dwordx4 v8, s[8:11], s42 offen lds
  s_add_u32 m0, s41, 45056
  s_mov_b32 s42, 4849664
  buffer_load_dwordx4 v9, s[8:11], s42 offen lds
  ds_read_b64_tr_b16 a[24:25], v6 offset:49152
  ds_read_b64_tr_b16 a[26:27], v6 offset:51200
  ds_read_b64_tr_b16 a[152:153], v6 offset:53248
  ds_read_b64_tr_b16 a[154:155], v6 offset:55296
  ds_read_b64_tr_b16 a[28:29], v6 offset:57344
  ds_read_b64_tr_b16 a[30:31], v6 offset:59392
  ds_read_b64_tr_b16 a[156:157], v6 offset:61440
  ds_read_b64_tr_b16 a[158:159], v6 offset:63488
  s_waitcnt vmcnt(24) lgkmcnt(0)
  s_barrier
  s_add_u32 m0, s41, 49152
  s_mov_b32 s42, 4980736
  buffer_load_dwordx4 v8, s[8:11], s42 offen lds
  s_add_u32 m0, s41, 53248
  s_mov_b32 s42, 4980736
  buffer_load_dwordx4 v9, s[8:11], s42 offen lds
  s_add_u32 m0, s41, 57344
  s_mov_b32 s42, 5111808
  buffer_load_dwordx4 v8, s[8:11], s42 offen lds
  s_add_u32 m0, s41, 61440
  s_mov_b32 s42, 5111808
  buffer_load_dwordx4 v9, s[8:11], s42 offen lds
  ds_read_b64_tr_b16 a[32:33], v7 offset:0
  ds_read_b64_tr_b16 a[34:35], v7 offset:2048
  ds_read_b64_tr_b16 a[160:161], v7 offset:4096
  ds_read_b64_tr_b16 a[162:163], v7 offset:6144
  ds_read_b64_tr_b16 a[36:37], v7 offset:8192
  ds_read_b64_tr_b16 a[38:39], v7 offset:10240
  ds_read_b64_tr_b16 a[164:165], v7 offset:12288
  ds_read_b64_tr_b16 a[166:167], v7 offset:14336
  s_waitcnt vmcnt(24) lgkmcnt(0)
  s_barrier
  s_add_u32 m0, s41, 65536
  s_mov_b32 s42, 5242880
  buffer_load_dwordx4 v8, s[8:11], s42 offen lds
  s_add_u32 m0, s41, 69632
  s_mov_b32 s42, 5242880
  buffer_load_dwordx4 v9, s[8:11], s42 offen lds
  s_add_u32 m0, s41, 73728
  s_mov_b32 s42, 5373952
  buffer_load_dwordx4 v8, s[8:11], s42 offen lds
  s_add_u32 m0, s41, 77824
  s_mov_b32 s42, 5373952
  buffer_load_dwordx4 v9, s[8:11], s42 offen lds
  ds_read_b64_tr_b16 a[40:41], v7 offset:16384
  ds_read_b64_tr_b16 a[42:43], v7 offset:18432
  ds_read_b64_tr_b16 a[168:169], v7 offset:20480
  ds_read_b64_tr_b16 a[170:171], v7 offset:22528
  ds_read_b64_tr_b16 a[44:45], v7 offset:24576
  ds_read_b64_tr_b16 a[46:47], v7 offset:26624
  ds_read_b64_tr_b16 a[172:173], v7 offset:28672
  ds_read_b64_tr_b16 a[174:175], v7 offset:30720
  s_waitcnt vmcnt(24) lgkmcnt(0)
  s_barrier
  s_add_u32 m0, s41, 81920
  s_mov_b32 s42, 5505024
  buffer_load_dwordx4 v8, s[8:11], s42 offen lds
  s_add_u32 m0, s41, 86016
  s_mov_b32 s42, 5505024
  buffer_load_dwordx4 v9, s[8:11], s42 offen lds
  s_add_u32 m0, s41, 90112
  s_mov_b32 s42, 5636096
  buffer_load_dwordx4 v8, s[8:11], s42 offen lds
  s_add_u32 m0, s41, 94208
  s_mov_b32 s42, 5636096
  buffer_load_dwordx4 v9, s[8:11], s42 offen lds
  ds_read_b64_tr_b16 a[48:49], v7 offset:32768
  ds_read_b64_tr_b16 a[50:51], v7 offset:34816
  ds_read_b64_tr_b16 a[176:177], v7 offset:36864
  ds_read_b64_tr_b16 a[178:179], v7 offset:38912
  ds_read_b64_tr_b16 a[52:53], v7 offset:40960
  ds_read_b64_tr_b16 a[54:55], v7 offset:43008
  ds_read_b64_tr_b16 a[180:181], v7 offset:45056
  ds_read_b64_tr_b16 a[182:183], v7 offset:47104
  s_waitcnt vmcnt(24) lgkmcnt(0)
  s_barrier
  s_add_u32 m0, s41, 98304
  s_mov_b32 s42, 5767168
  buffer_load_dwordx4 v8, s[8:11], s42 offen lds
  s_add_u32 m0, s41, 102400
  s_mov_b32 s42, 5767168
  buffer_load_dwordx4 v9, s[8:11], s42 offen lds
  s_add_u32 m0, s41, 106496
  s_mov_b32 s42, 5898240
  buffer_load_dwordx4 v8, s[8:11], s42 offen lds
  s_add_u32 m0, s41, 110592
  s_mov_b32 s42, 5898240
  buffer_load_dwordx4 v9, s[8:11], s42 offen lds
  ds_read_b64_tr_b16 a[56:57], v7 offset:49152
  ds_read_b64_tr_b16 a[58:59], v7 offset:51200
  ds_read_b64_tr_b16 a[184:185], v7 offset:53248
  ds_read_b64_tr_b16 a[186:187], v7 offset:55296
  ds_read_b64_tr_b16 a[60:61], v7 offset:57344
  ds_read_b64_tr_b16 a[62:63], v7 offset:59392
  ds_read_b64_tr_b16 a[188:189], v7 offset:61440
  ds_read_b64_tr_b16 a[190:191], v7 offset:63488
  s_waitcnt vmcnt(24) lgkmcnt(0)
  s_barrier
  s_add_u32 m0, s41, 114688
  s_mov_b32 s42, 6029312
  buffer_load_dwordx4 v8, s[8:11], s42 offen lds
  s_add_u32 m0, s41, 118784
  s_mov_b32 s42, 6029312
  buffer_load_dwordx4 v9, s[8:11], s42 offen lds
  s_add_u32 m0, s41, 122880
  s_mov_b32 s42, 6160384
  buffer_load_dwordx4 v8, s[8:11], s42 offen lds
  s_add_u32 m0, s41, 126976
  s_mov_b32 s42, 6160384
  buffer_load_dwordx4 v9, s[8:11], s42 offen lds
  ds_read_b64_tr_b16 a[64:65], v6 offset:0
  ds_read_b64_tr_b16 a[66:67], v6 offset:2048
  ds_read_b64_tr_b16 a[192:193], v6 offset:4096
  ds_read_b64_tr_b16 a[194:195], v6 offset:6144
  ds_read_b64_tr_b16 a[68:69], v6 offset:8192
  ds_read_b64_tr_b16 a[70:71], v6 offset:10240
  ds_read_b64_tr_b16 a[196:197], v6 offset:12288
  ds_read_b64_tr_b16 a[198:199], v6 offset:14336
  s_waitcnt vmcnt(24) lgkmcnt(0)
  s_barrier
  s_load_dwordx2 s[8:9], s[0:1], 32
  s_mov_b32 s10, 8388608
  s_mov_b32 s11, 0x20000
  s_waitcnt lgkmcnt(0)
  s_add_u32 m0, s41, 0
  s_mov_b32 s42, 0
  buffer_load_dwordx4 v10, s[8:11], s42 offen lds
  s_add_u32 m0, s41, 4096
  s_mov_b32 s42, 131072
  buffer_load_dwordx4 v10, s[8:11], s42 offen lds
  s_add_u32 m0, s41, 8192
  s_mov_b32 s42, 262144
  buffer_load_dwordx4 v10, s[8:11], s42 offen lds
  s_add_u32 m0, s41, 12288
  s_mov_b32 s42, 393216
  buffer_load_dwordx4 v10, s[8:11], s42 offen lds
  ds_read_b64_tr_b16 a[72:73], v6 offset:16384
  ds_read_b64_tr_b16 a[74:75], v6 offset:18432
  ds_read_b64_tr_b16 a[200:201], v6 offset:20480
  ds_read_b64_tr_b16 a[202:203], v6 offset:22528
  ds_read_b64_tr_b16 a[76:77], v6 offset:24576
  ds_read_b64_tr_b16 a[78:79], v6 offset:26624
  ds_read_b64_tr_b16 a[204:205], v6 offset:28672
  ds_read_b64_tr_b16 a[206:207], v6 offset:30720
  s_waitcnt vmcnt(24) lgkmcnt(0)
  s_barrier
  s_add_u32 m0, s41, 16384
  s_mov_b32 s42, 524288
  buffer_load_dwordx4 v10, s[8:11], s42 offen lds
  s_add_u32 m0, s41, 20480
  s_mov_b32 s42, 655360
  buffer_load_dwordx4 v10, s[8:11], s42 offen lds
  s_add_u32 m0, s41, 24576
  s_mov_b32 s42, 786432
  buffer_load_dwordx4 v10, s[8:11], s42 offen lds
  s_add_u32 m0, s41, 28672
  s_mov_b32 s42, 917504
  buffer_load_dwordx4 v10, s[8:11], s42 offen lds
  ds_read_b64_tr_b16 a[80:81], v6 offset:32768
  ds_read_b64_tr_b16 a[82:83], v6 offset:34816
  ds_read_b64_tr_b16 a[208:209], v6 offset:36864
  ds_read_b64_tr_b16 a[210:211], v6 offset:38912
  ds_read_b64_tr_b16 a[84:85], v6 offset:40960
  ds_read_b64_tr_b16 a[86:87], v6 offset:43008
  ds_read_b64_tr_b16 a[212:213], v6 offset:45056
  ds_read_b64_tr_b16 a[214:215], v6 offset:47104
  s_cmp_lg_u32 s20, 0
  s_cbranch_scc1 L_QKV_noinit
Lini_25:
  s_load_dwordx16 s[64:79], s[12:13], 128 glc
  s_load_dwordx16 s[80:95], s[12:13], 192 glc
  s_sub_u32 s24, s24, 1
  s_cbranch_scc1 L_FAIL
  s_waitcnt lgkmcnt(0)
  s_and_b64 s[64:65], s[64:65], s[66:67]
  s_and_b64 s[64:65], s[64:65], s[68:69]
  s_and_b64 s[64:65], s[64:65], s[70:71]
  s_and_b64 s[64:65], s[64:65], s[72:73]
  s_and_b64 s[64:65], s[64:65], s[74:75]
  s_and_b64 s[64:65], s[64:65], s[76:77]
  s_and_b64 s[64:65], s[64:65], s[78:79]
  s_and_b64 s[64:65], s[64:65], s[80:81]
  s_and_b64 s[64:65], s[64:65], s[82:83]
  s_and_b64 s[64:65], s[64:65], s[84:85]
  s_and_b64 s[64:65], s[64:65], s[86:87]
  s_and_b64 s[64:65], s[64:65], s[88:89]
  s_and_b64 s[64:65], s[64:65], s[90:91]
  s_and_b64 s[64:65], s[64:65], s[92:93]
  s_and_b64 s[64:65], s[64:65], s[94:95]
  s_and_b32 s64, s64, s65
  s_cbranch_scc0 Lini_25
L_QKV_noinit:
  s_waitcnt vmcnt(24) lgkmcnt(0)
  s_barrier
  s_add_u32 m0, s41, 32768
  s_mov_b32 s42, 1048576
  buffer_load_dwordx4 v10, s[8:11], s42 offen lds
  s_add_u32 m0, s41, 36864
  s_mov_b32 s42, 1179648
  buffer_load_dwordx4 v10, s[8:11], s42 offen lds
  s_add_u32 m0, s41, 40960
  s_mov_b32 s42, 1310720
  buffer_load_dwordx4 v10, s[8:11], s42 offen lds
  s_add_u32 m0, s41, 45056
  s_mov_b32 s42, 1441792
  buffer_load_dwordx4 v10, s[8:11], s42 offen lds
  ds_read_b64_tr_b16 a[88:89], v6 offset:49152
  ds_read_b64_tr_b16 a[90:91], v6 offset:51200
  ds_read_b64_tr_b16 a[216:217], v6 offset:53248
  ds_read_b64_tr_b16 a[218:219], v6 offset:55296
  ds_read_b64_tr_b16 a[92:93], v6 offset:57344
  ds_read_b64_tr_b16 a[94:95], v6 offset:59392
  ds_read_b64_tr_b16 a[220:221], v6 offset:61440
  ds_read_b64_tr_b16 a[222:223], v6 offset:63488
  s_waitcnt vmcnt(24) lgkmcnt(0)
  s_barrier
  s_add_u32 m0, s41, 49152
  s_mov_b32 s42, 1572864
  buffer_load_dwordx4 v10, s[8:11], s42 offen lds
  s_add_u32 m0, s41, 53248
  s_mov_b32 s42, 1703936
  buffer_load_dwordx4 v10, s[8:11], s42 offen lds
  s_add_u32 m0, s41, 57344
  s_mov_b32 s42, 1835008
  buffer_load_dwordx4 v10, s[8:11], s42 offen lds
  s_add_u32 m0, s41, 61440
  s_mov_b32 s42, 1966080
  buffer_load_dwordx4 v10, s[8:11], s42 offen lds
  ds_read_b64_tr_b16 a[96:97], v7 offset:0
  ds_read_b64_tr_b16 a[98:99], v7 offset:2048
  ds_read_b64_tr_b16 a[224:225], v7 offset:4096
  ds_read_b64_tr_b16 a[226:227], v7 offset:6144
  ds_read_b64_tr_b16 a[100:101], v7 offset:8192
  ds_read_b64_tr_b16 a[102:103], v7 offset:10240
  ds_read_b64_tr_b16 a[228:229], v7 offset:12288
  ds_read_b64_tr_b16 a[230:231], v7 offset:14336
  s_waitcnt vmcnt(24) lgkmcnt(0)
  s_barrier
  s_add_u32 m0, s41, 65536
  s_mov_b32 s42, 4194304
  buffer_load_dwordx4 v10, s[8:11], s42 offen lds
  s_add_u32 m0, s41, 69632
  s_mov_b32 s42, 4325376
  buffer_load_dwordx4 v10, s[8:11], s42 offen lds
  s_add_u32 m0, s41, 73728
  s_mov_b32 s42, 4456448
  buffer_load_dwordx4 v10, s[8:11], s42 offen lds
  s_add_u32 m0, s41, 77824
  s_mov_b32 s42, 4587520
  buffer_load_dwordx4 v10, s[8:11], s42 offen lds
  ds_read_b64_tr_b16 a[104:105], v7 offset:16384
  ds_read_b64_tr_b16 a[106:107], v7 offset:18432
  ds_read_b64_tr_b16 a[232:233], v7 offset:20480
  ds_read_b64_tr_b16 a[234:235], v7 offset:22528
  ds_read_b64_tr_b16 a[108:109], v7 offset:24576
  ds_read_b64_tr_b16 a[110:111], v7 offset:26624
  ds_read_b64_tr_b16 a[236:237], v7 offset:28672
  ds_read_b64_tr_b16 a[238:239], v7 offset:30720
  s_waitcnt vmcnt(24) lgkmcnt(0)
  s_barrier
  s_add_u32 m0, s41, 81920
  s_mov_b32 s42, 4718592
  buffer_load_dwordx4 v10, s[8:11], s42 offen lds
  s_add_u32 m0, s41, 86016
  s_mov_b32 s42, 4849664
  buffer_load_dwordx4 v10, s[8:11], s42 offen lds
  s_add_u32 m0, s41, 90112
  s_mov_b32 s42, 4980736
  buffer_load_dwordx4 v10, s[8:11], s42 offen lds
  s_add_u32 m0, s41, 94208
  s_mov_b32 s42, 5111808
  buffer_load_dwordx4 v10, s[8:11], s42 offen lds
  ds_read_b64_tr_b16 a[112:113], v7 offset:32768
  ds_read_b64_tr_b16 a[114:115], v7 offset:34816
  ds_read_b64_tr_b16 a[240:241], v7 offset:36864
  ds_read_b64_tr_b16 a[242:243], v7 offset:38912
  ds_read_b64_tr_b16 a[116:117], v7 offset:40960
  ds_read_b64_tr_b16 a[118:119], v7 offset:43008
  ds_read_b64_tr_b16 a[244:245], v7 offset:45056
  ds_read_b64_tr_b16 a[246:247], v7 offset:47104
  s_waitcnt vmcnt(24) lgkmcnt(0)
  s_barrier
  s_add_u32 m0, s41, 98304
  s_mov_b32 s42, 5242880
  buffer_load_dwordx4 v10, s[8:11], s42 offen lds
  s_add_u32 m0, s41, 102400
  s_mov_b32 s42, 5373952
  buffer_load_dwordx4 v10, s[8:11], s42 offen lds
  s_add_u32 m0, s41, 106496
  s_mov_b32 s42, 5505024
  buffer_load_dwordx4 v10, s[8:11], s42 offen lds
  s_add_u32 m0, s41, 110592
  s_mov_b32 s42, 5636096
  buffer_load_dwordx4 v10, s[8:11], s42 offen lds
  ds_read_b64_tr_b16 a[120:121], v7 offset:49152
  ds_read_b64_tr_b16 a[122:123], v7 offset:51200
  ds_read_b64_tr_b16 a[248:249], v7 offset:53248
  ds_read_b64_tr_b16 a[250:251], v7 offset:55296
  ds_read_b64_tr_b16 a[124:125], v7 offset:57344
  ds_read_b64_tr_b16 a[126:127], v7 offset:59392
  ds_read_b64_tr_b16 a[252:253], v7 offset:61440
  ds_read_b64_tr_b16 a[254:255], v7 offset:63488
  s_waitcnt vmcnt(24) lgkmcnt(0)
  s_barrier
  s_add_u32 m0, s41, 114688
  s_mov_b32 s42, 5767168
  buffer_load_dwordx4 v10, s[8:11], s42 offen lds
  s_add_u32 m0, s41, 118784
  s_mov_b32 s42, 5898240
  buffer_load_dwordx4 v10, s[8:11], s42 offen lds
  s_add_u32 m0, s41, 122880
  s_mov_b32 s42, 6029312
  buffer_load_dwordx4 v10, s[8:11], s42 offen lds
  s_add_u32 m0, s41, 126976
  s_mov_b32 s42, 6160384
  buffer_load_dwordx4 v10, s[8:11], s42 offen lds
  ds_read_b64_tr_b16 v[128:129], v6 offset:0
  ds_read_b64_tr_b16 v[130:131], v6 offset:2048
  ds_read_b64_tr_b16 v[132:133], v6 offset:4096
  ds_read_b64_tr_b16 v[134:135], v6 offset:6144
  ds_read_b64_tr_b16 v[136:137], v6 offset:8192
  ds_read_b64_tr_b16 v[138:139], v6 offset:10240
  ds_read_b64_tr_b16 v[140:141], v6 offset:12288
  ds_read_b64_tr_b16 v[142:143], v6 offset:14336
  s_waitcnt vmcnt(24) lgkmcnt(0)
  s_barrier
  ds_read_b64_tr_b16 v[144:145], v6 offset:16384
  ds_read_b64_tr_b16 v[146:147], v6 offset:18432
  ds_read_b64_tr_b16 v[148:149], v6 offset:20480
  ds_read_b64_tr_b16 v[150:151], v6 offset:22528
  ds_read_b64_tr_b16 v[152:153], v6 offset:24576
  ds_read_b64_tr_b16 v[154:155], v6 offset:26624
  ds_read_b64_tr_b16 v[156:157], v6 offset:28672
  ds_read_b64_tr_b16 v[158:159], v6 offset:30720
  s_waitcnt vmcnt(20) lgkmcnt(0)
  s_barrier
  ds_read_b64_tr_b16 v[160:161], v6 offset:32768
  ds_read_b64_tr_b16 v[162:163], v6 offset:34816
  ds_read_b64_tr_b16 v[164:165], v6 offset:36864
  ds_read_b64_tr_b16 v[166:167], v6 offset:38912
  ds_read_b64_tr_b16 v[168:169], v6 offset:40960
  ds_read_b64_tr_b16 v[170:171], v6 offset:43008
  ds_read_b64_tr_b16 v[172:173], v6 offset:45056
  ds_read_b64_tr_b16 v[174:175], v6 offset:47104
  s_waitcnt vmcnt(16) lgkmcnt(0)
  s_barrier
  ds_read_b64_tr_b16 v[176:177], v6 offset:49152
  ds_read_b64_tr_b16 v[178:179], v6 offset:51200
  ds_read_b64_tr_b16 v[180:181], v6 offset:53248
  ds_read_b64_tr_b16 v[182:183], v6 offset:55296
  ds_read_b64_tr_b16 v[184:185], v6 offset:57344
  ds_read_b64_tr_b16 v[186:187], v6 offset:59392
  ds_read_b64_tr_b16 v[188:189], v6 offset:61440
  ds_read_b64_tr_b16 v[190:191], v6 offset:63488
  s_waitcnt vmcnt(12) lgkmcnt(0)
  s_barrier
  ds_read_b64_tr_b16 v[192:193], v7 offset:0
  ds_read_b64_tr_b16 v[194:195], v7 offset:2048
  ds_read_b64_tr_b16 v[196:197], v7 offset:4096
  ds_read_b64_tr_b16 v[198:199], v7 offset:6144
  ds_read_b64_tr_b16 v[200:201], v7 offset:8192
  ds_read_b64_tr_b16 v[202:203], v7 offset:10240
  ds_read_b64_tr_b16 v[204:205], v7 offset:12288
  ds_read_b64_tr_b16 v[206:207], v7 offset:14336
  s_waitcnt vmcnt(8) lgkmcnt(0)
  s_barrier
  ds_read_b64_tr_b16 v[208:209], v7 offset:16384
  ds_read_b64_tr_b16 v[210:211], v7 offset:18432
  ds_read_b64_tr_b16 v[212:213], v7 offset:20480
  ds_read_b64_tr_b16 v[214:215], v7 offset:22528
  ds_read_b64_tr_b16 v[216:217], v7 offset:24576
  ds_read_b64_tr_b16 v[218:219], v7 offset:26624
  ds_read_b64_tr_b16 v[220:221], v7 offset:28672
  ds_read_b64_tr_b16 v[222:223], v7 offset:30720
  s_waitcnt vmcnt(4) lgkmcnt(0)
  s_barrier
  ds_read_b64_tr_b16 v[224:225], v7 offset:32768
  ds_read_b64_tr_b16 v[226:227], v7 offset:34816
  ds_read_b64_tr_b16 v[228:229], v7 offset:36864
  ds_read_b64_tr_b16 v[230:231], v7 offset:38912
  ds_read_b64_tr_b16 v[232:233], v7 offset:40960
  ds_read_b64_tr_b16 v[234:235], v7 offset:43008
  ds_read_b64_tr_b16 v[236:237], v7 offset:45056
  ds_read_b64_tr_b16 v[238:239], v7 offset:47104
  s_waitcnt vmcnt(0) lgkmcnt(0)
  s_barrier
  ds_read_b64_tr_b16 v[240:241], v7 offset:49152
  ds_read_b64_tr_b16 v[242:243], v7 offset:51200
  ds_read_b64_tr_b16 v[244:245], v7 offset:53248
  ds_read_b64_tr_b16 v[246:247], v7 offset:55296
  ds_read_b64_tr_b16 v[248:249], v7 offset:57344
  ds_read_b64_tr_b16 v[250:251], v7 offset:59392
  ds_read_b64_tr_b16 v[252:253], v7 offset:61440
  ds_read_b64_tr_b16 v[254:255], v7 offset:63488
  s_waitcnt lgkmcnt(0)
  s_barrier
  s_lshr_b32 s62, s21, 1
  s_lshl_b32 s62, s62, 7
  s_and_b32 s40, s21, 1
  s_lshl_b32 s40, s40, 2
  s_add_u32 s62, s62, s40
  s_add_u32 s62, s62, 1396736
  s_mov_b32 s27, 6291456
  s_lshr_b32 s40, s21, 1
  s_mul_i32 s31, s40, 65536
  s_and_b32 s41, s21, 1
  s_lshl_b32 s42, s20, 11
  s_lshl_b32 s40, s41, 14
  s_add_u32 s40, s40, s42
  v_lshl_add_u32 v76, v0, 4, s40
  s_lshl_b32 s40, s41, 10
  s_add_u32 s40, s40, s42
  s_add_u32 s40, s40, 32768
  v_lshl_add_u32 v83, v0, 4, s40
  v_lshrrev_b32 v2, 3, v0
  v_lshlrev_b32 v2, 7, v2
  v_and_b32 v3, 7, v0
  v_lshl_add_u32 v2, v3, 2, v2
  v_add_u32 v2, 1388544, v2
  s_mov_b32 s25, 0
  s_mov_b32 s37, 2147483392
  s_mov_b32 s30, 0
  s_mov_b32 s34, s32
  s_mov_b32 s35, s27
  v_mov_b32 v81, v77
  v_mov_b32 v82, v78
  s_nop 1
Lpoll_26:
  buffer_load_dword v3, v2, s[4:7], 0 offen sc1
  s_sub_u32 s24, s24, 1
  s_cbranch_scc1 L_FAIL
  s_waitcnt vmcnt(0)
  v_cmp_gt_i32 vcc, 1, v3
  s_cbranch_vccz Lpolld_27
  s_sleep 1
  s_branch Lpoll_26
Lpolld_27:
  s_add_u32 m0, s34, 0
  s_nop 0
  buffer_load_dwordx4 v1, s[4:7], s35 offen offset:0 sc1 lds
  s_add_u32 m0, s34, 3968
  s_nop 0
  buffer_load_dwordx4 v1, s[4:7], s35 offen offset:128 sc1 lds
  s_add_u32 m0, s34, 7936
  s_nop 0
  buffer_load_dwordx4 v1, s[4:7], s35 offen offset:256 sc1 lds
  s_add_u32 m0, s34, 11904
  s_nop 0
  buffer_load_dwordx4 v1, s[4:7], s35 offen offset:384 sc1 lds
  s_add_u32 m0, s34, 15872
  s_nop 0
  buffer_load_dwordx4 v1, s[4:7], s35 offen offset:512 sc1 lds
  s_add_u32 m0, s34, 19840
  s_nop 0
  buffer_load_dwordx4 v1, s[4:7], s35 offen offset:640 sc1 lds
  s_add_u32 m0, s34, 23808
  s_nop 0
  buffer_load_dwordx4 v1, s[4:7], s35 offen offset:768 sc1 lds
  s_add_u32 m0, s34, 27776
  s_nop 0
  buffer_load_dwordx4 v1, s[4:7], s35 offen offset:896 sc1 lds
  s_add_u32 m0, s34, 31744
  s_nop 0
  buffer_load_dwordx4 v1, s[4:7], s35 offen offset:1024 sc1 lds
  s_add_u32 m0, s34, 35712
  s_nop 0
  buffer_load_dwordx4 v1, s[4:7], s35 offen offset:1152 sc1 lds
  s_add_u32 m0, s34, 39680
  s_nop 0
  buffer_load_dwordx4 v1, s[4:7], s35 offen offset:1280 sc1 lds
  s_add_u32 m0, s34, 43648
  s_nop 0
  buffer_load_dwordx4 v1, s[4:7], s35 offen offset:1408 sc1 lds
  s_add_u32 m0, s34, 47616
  s_nop 0
  buffer_load_dwordx4 v1, s[4:7], s35 offen offset:1536 sc1 lds
  s_add_u32 m0, s34, 51584
  s_nop 0
  buffer_load_dwordx4 v1, s[4:7], s35 offen offset:1664 sc1 lds
  s_add_u32 m0, s34, 55552
  s_nop 0
  buffer_load_dwordx4 v1, s[4:7], s35 offen offset:1792 sc1 lds
  s_add_u32 m0, s34, 59520
  s_nop 0
  buffer_load_dwordx4 v1, s[4:7], s35 offen offset:1920 sc1 lds
  v_min_u32 v60, 63, v0
  v_lshlrev_b32 v60, 7, v60
  v_add_u32 v60, 1424384, v60
  s_nop 1
Lpoll_28:
  buffer_load_dword v61, v60, s[4:7], 0 offen sc1
  s_sub_u32 s24, s24, 1
  s_cbranch_scc1 L_FAIL
  s_waitcnt vmcnt(0)
  v_cmp_gt_i32 vcc, 0, v61
  s_cbranch_vccz Lpolld_29
  s_sleep 1
  s_branch Lpoll_28
Lpolld_29:
  v_lshrrev_b32 v61, 8, v61
  v_and_b32 v62, 3, v0
  v_lshl_or_b32 v61, v61, 2, v62
  s_nop 1
  v_min_u32_dpp v61, v61, v61 row_ror:8 row_mask:0xf bank_mask:0xf
  s_nop 1
  v_min_u32_dpp v61, v61, v61 row_ror:4 row_mask:0xf bank_mask:0xf
  v_mov_b32 v62, v61
  s_nop 1
  v_permlane16_swap_b32 v62, v61
  v_min_u32 v61, v61, v62
  v_mov_b32 v62, v61
  s_nop 1
  v_permlane32_swap_b32 v62, v61
  v_min_u32 v61, v61, v62
  s_nop 1
  v_min_u32_dpp v61, v61, v61 row_ror:2 row_mask:0xf bank_mask:0xf
  s_nop 1
  v_min_u32_dpp v61, v61, v61 row_ror:1 row_mask:0xf bank_mask:0xf
  s_nop 0
  v_readfirstlane_b32 s40, v61
  s_and_b32 s40, s40, 3
  s_lshl_b32 s40, s40, 13
  s_and_b32 s40, s40, 0x2000
  s_xor_b32 s40, s40, 20971520
  s_add_u32 s31, s31, s40
  s_barrier
  ds_read_b128 v[4:7], v81 offset:0
  ds_read_b128 v[8:11], v81 offset:2048
  ds_read_b128 v[12:15], v82 offset:0
  ds_read_b128 v[16:19], v82 offset:2048
  ds_read_b128 v[20:23], v81 offset:4096
  ds_read_b128 v[24:27], v81 offset:6144
L_QKV_top:
  s_waitcnt lgkmcnt(4)
  v_cvt_pk_bf16_f32 v60, v36, v37
  v_cvt_pk_bf16_f32 v61, v38, v39
  v_mfma_f32_16x16x32_bf16 v[36:39], a[0:3], v[4:7], 0
  v_cvt_pk_bf16_f32 v62, v44, v45
  v_cvt_pk_bf16_f32 v63, v46, v47
  v_mfma_f32_16x16x32_bf16 v[44:47], a[128:131], v[4:7], 0
  v_cvt_pk_bf16_f32 v64, v40, v41
  v_cvt_pk_bf16_f32 v65, v42, v43
  v_mfma_f32_16x16x32_bf16 v[40:43], a[0:3], v[8:11], 0
  v_cvt_pk_bf16_f32 v66, v48, v49
  v_cvt_pk_bf16_f32 v67, v50, v51
  v_mfma_f32_16x16x32_bf16 v[48:51], a[128:131], v[8:11], 0
  v_cvt_pk_bf16_f32 v68, v52, v53
  v_cvt_pk_bf16_f32 v69, v54, v55
  v_mfma_f32_16x16x32_bf16 v[52:55], v[4:7], v[128:131], 0
  ds_read_b128 v[28:31], v82 offset:4096
  v_cvt_pk_bf16_f32 v70, v56, v57
  v_cvt_pk_bf16_f32 v71, v58, v59
  v_mfma_f32_16x16x32_bf16 v[56:59], v[8:11], v[128:131], 0
  ds_read_b128 v[32:35], v82 offset:6144
  s_waitcnt lgkmcnt(4)
  v_mfma_f32_16x16x32_bf16 v[36:39], a[4:7], v[12:15], v[36:39]
  ds_read_b128 v[4:7], v81 offset:8192
  v_mfma_f32_16x16x32_bf16 v[44:47], a[132:135], v[12:15], v[44:47]
  ds_read_b128 v[8:11], v81 offset:10240
  v_mfma_f32_16x16x32_bf16 v[40:43], a[4:7], v[16:19], v[40:43]
  buffer_store_dwordx4 v[60:63], v76, s[4:7], s37 offen offset:0 sc1
  v_mfma_f32_16x16x32_bf16 v[48:51], a[132:135], v[16:19], v[48:51]
  buffer_store_dwordx4 v[64:67], v76, s[4:7], s37 offen offset:1024 sc1
  v_mfma_f32_16x16x32_bf16 v[52:55], v[12:15], v[132:135], v[52:55]
  v_mfma_f32_16x16x32_bf16 v[56:59], v[16:19], v[132:135], v[56:59]
  s_waitcnt lgkmcnt(4)
  v_mfma_f32_16x16x32_bf16 v[36:39], a[8:11], v[20:23], v[36:39]
  ds_read_b128 v[12:15], v82 offset:8192
  v_mfma_f32_16x16x32_bf16 v[44:47], a[136:139], v[20:23], v[44:47]
  ds_read_b128 v[16:19], v82 offset:10240
  v_mfma_f32_16x16x32_bf16 v[40:43], a[8:11], v[24:27], v[40:43]
  buffer_store_dwordx4 v[68:71], v83, s[4:7], s37 offen sc1
  v_mfma_f32_16x16x32_bf16 v[48:51], a[136:139], v[24:27], v[48:51]
  v_cmp_gt_i32 vcc, 1, v3
  v_mfma_f32_16x16x32_bf16 v[52:55], v[20:23], v[136:139], v[52:55]
  v_mfma_f32_16x16x32_bf16 v[56:59], v[24:27], v[136:139], v[56:59]
  s_xor_b32 s34, s34, 0x10000
  s_add_u32 s35, s35, 65536
  s_cbranch_vccz L_QKV_have
  s_nop 4
Lpoll_30:
  buffer_load_dword v3, v2, s[4:7], s30 offen sc1
  s_sub_u32 s24, s24, 1
  s_cbranch_scc1 L_FAIL
  s_waitcnt vmcnt(0)
  v_cmp_gt_i32 vcc, 1, v3
  s_cbranch_vccz Lpolld_31
  s_sleep 1
  s_branch Lpoll_30
Lpolld_31:
L_QKV_have:
  s_barrier
  s_waitcnt lgkmcnt(4)
  v_mfma_f32_16x16x32_bf16 v[36:39], a[12:15], v[28:31], v[36:39]
  ds_read_b128 v[20:23], v81 offset:12288
  v_mfma_f32_16x16x32_bf16 v[44:47], a[140:143], v[28:31], v[44:47]
  ds_read_b128 v[24:27], v81 offset:14336
  v_mfma_f32_16x16x32_bf16 v[40:43], a[12:15], v[32:35], v[40:43]
  s_add_u32 m0, s34, 0
  s_nop 0
  buffer_load_dwordx4 v1, s[4:7], s35 offen offset:0 sc1 lds
  v_mfma_f32_16x16x32_bf16 v[48:51], a[140:143], v[32:35], v[48:51]
  v_mfma_f32_16x16x32_bf16 v[52:55], v[28:31], v[140:143], v[52:55]
  v_mfma_f32_16x16x32_bf16 v[56:59], v[32:35], v[140:143], v[56:59]
  s_waitcnt lgkmcnt(4)
  v_mfma_f32_16x16x32_bf16 v[36:39], a[16:19], v[4:7], v[36:39]
  ds_read_b128 v[28:31], v82 offset:12288
  v_mfma_f32_16x16x32_bf16 v[44:47], a[144:147], v[4:7], v[44:47]
  ds_read_b128 v[32:35], v82 offset:14336
  v_mfma_f32_16x16x32_bf16 v[40:43], a[16:19], v[8:11], v[40:43]
  s_add_u32 m0, s34, 3968
  s_nop 0
  buffer_load_dwordx4 v1, s[4:7], s35 offen offset:128 sc1 lds
  v_mfma_f32_16x16x32_bf16 v[48:51], a[144:147], v[8:11], v[48:51]
  v_mfma_f32_16x16x32_bf16 v[52:55], v[4:7], v[144:147], v[52:55]
  v_mfma_f32_16x16x32_bf16 v[56:59], v[8:11], v[144:147], v[56:59]
  s_waitcnt lgkmcnt(4)
  v_mfma_f32_16x16x32_bf16 v[36:39], a[20:23], v[12:15], v[36:39]
  ds_read_b128 v[4:7], v81 offset:16384
  v_mfma_f32_16x16x32_bf16 v[44:47], a[148:151], v[12:15], v[44:47]
  ds_read_b128 v[8:11], v81 offset:18432
  v_mfma_f32_16x16x32_bf16 v[40:43], a[20:23], v[16:19], v[40:43]
  s_add_u32 m0, s34, 7936
  s_nop 0
  buffer_load_dwordx4 v1, s[4:7], s35 offen offset:256 sc1 lds
  v_mfma_f32_16x16x32_bf16 v[48:51], a[148:151], v[16:19], v[48:51]
  v_mfma_f32_16x16x32_bf16 v[52:55], v[12:15], v[148:151], v[52:55]
  v_mfma_f32_16x16x32_bf16 v[56:59], v[16:19], v[148:151], v[56:59]
  s_waitcnt lgkmcnt(4)
  v_mfma_f32_16x16x32_bf16 v[36:39], a[24:27], v[20:23], v[36:39]
  ds_read_b128 v[12:15], v82 offset:16384
  v_mfma_f32_16x16x32_bf16 v[44:47], a[152:155], v[20:23], v[44:47]
  ds_read_b128 v[16:19], v82 offset:18432
  v_mfma_f32_16x16x32_bf16 v[40:43], a[24:27], v[24:27], v[40:43]
  s_add_u32 m0, s34, 11904
  s_nop 0
  buffer_load_dwordx4 v1, s[4:7], s35 offen offset:384 sc1 lds
  v_mfma_f32_16x16x32_bf16 v[48:51], a[152:155], v[24:27], v[48:51]
  v_mfma_f32_16x16x32_bf16 v[52:55], v[20:23], v[152:155], v[52:55]
  v_mfma_f32_16x16x32_bf16 v[56:59], v[24:27], v[152:155], v[56:59]
  s_waitcnt lgkmcnt(4)
  v_mfma_f32_16x16x32_bf16 v[36:39], a[28:31], v[28:31], v[36:39]
  ds_read_b128 v[20:23], v81 offset:20480
  v_mfma_f32_16x16x32_bf16 v[44:47], a[156:159], v[28:31], v[44:47]
  ds_read_b128 v[24:27], v81 offset:22528
  v_mfma_f32_16x16x32_bf16 v[40:43], a[28:31], v[32:35], v[40:43]
  s_add_u32 m0, s34, 15872
  s_nop 0
  buffer_load_dwordx4 v1, s[4:7], s35 offen offset:512 sc1 lds
  v_mfma_f32_16x16x32_bf16 v[48:51], a[156:159], v[32:35], v[48:51]
  v_mfma_f32_16x16x32_bf16 v[52:55], v[28:31], v[156:159], v[52:55]
  v_mfma_f32_16x16x32_bf16 v[56:59], v[32:35], v[156:159], v[56:59]
  s_waitcnt lgkmcnt(4)
  v_mfma_f32_16x16x32_bf16 v[36:39], a[32:35], v[4:7], v[36:39]
  ds_read_b128 v[28:31], v82 offset:20480
  v_mfma_f32_16x16x32_bf16 v[44:47], a[160:163], v[4:7], v[44:47]
  ds_read_b128 v[32:35], v82 offset:22528
  v_mfma_f32_16x16x32_bf16 v[40:43], a[32:35], v[8:11], v[40:43]
  s_add_u32 m0, s34, 19840
  s_nop 0
  buffer_load_dwordx4 v1, s[4:7], s35 offen offset:640 sc1 lds
  v_mfma_f32_16x16x32_bf16 v[48:51], a[160:163], v[8:11], v[48:51]
  v_mfma_f32_16x16x32_bf16 v[52:55], v[4:7], v[160:163], v[52:55]
  v_mfma_f32_16x16x32_bf16 v[56:59], v[8:11], v[160:163], v[56:59]
  s_waitcnt lgkmcnt(4)
  v_mfma_f32_16x16x32_bf16 v[36:39], a[36:39], v[12:15], v[36:39]
  ds_read_b128 v[4:7], v81 offset:24576
  v_mfma_f32_16x16x32_bf16 v[44:47], a[164:167], v[12:15], v[44:47]
  ds_read_b128 v[8:11], v81 offset:26624
  v_mfma_f32_16x16x32_bf16 v[40:43], a[36:39], v[16:19], v[40:43]
  s_add_u32 m0, s34, 23808
  s_nop 0
  buffer_load_dwordx4 v1, s[4:7], s35 offen offset:768 sc1 lds
  v_mfma_f32_16x16x32_bf16 v[48:51], a[164:167], v[16:19], v[48:51]
  v_mfma_f32_16x16x32_bf16 v[52:55], v[12:15], v[164:167], v[52:55]
  v_mfma_f32_16x16x32_bf16 v[56:59], v[16:19], v[164:167], v[56:59]
  s_waitcnt lgkmcnt(4)
  v_mfma_f32_16x16x32_bf16 v[36:39], a[40:43], v[20:23], v[36:39]
  ds_read_b128 v[12:15], v82 offset:24576
  v_mfma_f32_16x16x32_bf16 v[44:47], a[168:171], v[20:23], v[44:47]
  ds_read_b128 v[16:19], v82 offset:26624
  v_mfma_f32_16x16x32_bf16 v[40:43], a[40:43], v[24:27], v[40:43]
  s_add_u32 m0, s34, 27776
  s_nop 0
  buffer_load_dwordx4 v1, s[4:7], s35 offen offset:896 sc1 lds
  v_mfma_f32_16x16x32_bf16 v[48:51], a[168:171], v[24:27], v[48:51]
  v_mfma_f32_16x16x32_bf16 v[52:55], v[20:23], v[168:171], v[52:55]
  v_mfma_f32_16x16x32_bf16 v[56:59], v[24:27], v[168:171], v[56:59]
  s_waitcnt lgkmcnt(4)
  v_mfma_f32_16x16x32_bf16 v[36:39], a[44:47], v[28:31], v[36:39]
  ds_read_b128 v[20:23], v81 offset:28672
  v_mfma_f32_16x16x32_bf16 v[44:47], a[172:175], v[28:31], v[44:47]
  ds_read_b128 v[24:27], v81 offset:30720
  v_mfma_f32_16x16x32_bf16 v[40:43], a[44:47], v[32:35], v[40:43]
  s_add_u32 m0, s34, 31744
  s_nop 0
  buffer_load_dwordx4 v1, s[4:7], s35 offen offset:1024 sc1 lds
  v_mfma_f32_16x16x32_bf16 v[48:51], a[172:175], v[32:35], v[48:51]
  v_mfma_f32_16x16x32_bf16 v[52:55], v[28:31], v[172:175], v[52:55]
  v_mfma_f32_16x16x32_bf16 v[56:59], v[32:35], v[172:175], v[56:59]
  s_waitcnt vmcnt(9)
  s_barrier
  s_cmp_lg_u32 s20, 0
  s_cbranch_scc1 Lnosig_32
  s_mov_b32 s63, s25
  s_atomic_smax s63, s[4:5], s62 glc
Lnosig_32:
  s_waitcnt lgkmcnt(4)
  v_mfma_f32_16x16x32_bf16 v[36:39], a[48:51], v[4:7], v[36:39]
  ds_read_b128 v[28:31], v82 offset:28672
  v_mfma_f32_16x16x32_bf16 v[44:47], a[176:179], v[4:7], v[44:47]
  ds_read_b128 v[32:35], v82 offset:30720
  v_mfma_f32_16x16x32_bf16 v[40:43], a[48:51], v[8:11], v[40:43]
  s_add_u32 m0, s34, 35712
  s_nop 0
  buffer_load_dwordx4 v1, s[4:7], s35 offen offset:1152 sc1 lds
  v_mfma_f32_16x16x32_bf16 v[48:51], a[176:179], v[8:11], v[48:51]
  v_mfma_f32_16x16x32_bf16 v[52:55], v[4:7], v[176:179], v[52:55]
  v_mfma_f32_16x16x32_bf16 v[56:59], v[8:11], v[176:179], v[56:59]
  s_waitcnt lgkmcnt(4)
  v_mfma_f32_16x16x32_bf16 v[36:39], a[52:55], v[12:15], v[36:39]
  ds_read_b128 v[4:7], v81 offset:32768
  v_mfma_f32_16x16x32_bf16 v[44:47], a[180:183], v[12:15], v[44:47]
  ds_read_b128 v[8:11], v81 offset:34816
  v_mfma_f32_16x16x32_bf16 v[40:43], a[52:55], v[16:19], v[40:43]
  s_add_u32 m0, s34, 39680
  s_nop 0
  buffer_load_dwordx4 v1, s[4:7], s35 offen offset:1280 sc1 lds
  v_mfma_f32_16x16x32_bf16 v[48:51], a[180:183], v[16:19], v[48:51]
  v_mfma_f32_16x16x32_bf16 v[52:55], v[12:15], v[180:183], v[52:55]
  v_mfma_f32_16x16x32_bf16 v[56:59], v[16:19], v[180:183], v[56:59]
  s_waitcnt lgkmcnt(4)
  v_mfma_f32_16x16x32_bf16 v[36:39], a[56:59], v[20:23], v[36:39]
  ds_read_b128 v[12:15], v82 offset:32768
  v_mfma_f32_16x16x32_bf16 v[44:47], a[184:187], v[20:23], v[44:47]
  ds_read_b128 v[16:19], v82 offset:34816
  v_mfma_f32_16x16x32_bf16 v[40:43], a[56:59], v[24:27], v[40:43]
  s_add_u32 m0, s34, 43648
  s_nop 0
  buffer_load_dwordx4 v1, s[4:7], s35 offen offset:1408 sc1 lds
  v_mfma_f32_16x16x32_bf16 v[48:51], a[184:187], v[24:27], v[48:51]
  v_mfma_f32_16x16x32_bf16 v[52:55], v[20:23], v[184:187], v[52:55]
  v_mfma_f32_16x16x32_bf16 v[56:59], v[24:27], v[184:187], v[56:59]
  s_waitcnt lgkmcnt(4)
  v_mfma_f32_16x16x32_bf16 v[36:39], a[60:63], v[28:31], v[36:39]
  ds_read_b128 v[20:23], v81 offset:36864
  v_mfma_f32_16x16x32_bf16 v[44:47], a[188:191], v[28:31], v[44:47]
  ds_read_b128 v[24:27], v81 offset:38912
  v_mfma_f32_16x16x32_bf16 v[40:43], a[60:63], v[32:35], v[40:43]
  s_add_u32 m0, s34, 47616
  s_nop 0
  buffer_load_dwordx4 v1, s[4:7], s35 offen offset:1536 sc1 lds
  v_mfma_f32_16x16x32_bf16 v[48:51], a[188:191], v[32:35], v[48:51]
  v_mfma_f32_16x16x32_bf16 v[52:55], v[28:31], v[188:191], v[52:55]
  v_mfma_f32_16x16x32_bf16 v[56:59], v[32:35], v[188:191], v[56:59]
  s_waitcnt lgkmcnt(4)
  v_mfma_f32_16x16x32_bf16 v[36:39], a[64:67], v[4:7], v[36:39]
  ds_read_b128 v[28:31], v82 offset:36864
  v_mfma_f32_16x16x32_bf16 v[44:47], a[192:195], v[4:7], v[44:47]
  ds_read_b128 v[32:35], v82 offset:38912
  v_mfma_f32_16x16x32_bf16 v[40:43], a[64:67], v[8:11], v[40:43]
  s_add_u32 m0, s34, 51584
  s_nop 0
  buffer_load_dwordx4 v1, s[4:7], s35 offen offset:1664 sc1 lds
  v_mfma_f32_16x16x32_bf16 v[48:51], a[192:195], v[8:11], v[48:51]
  v_mfma_f32_16x16x32_bf16 v[52:55], v[4:7], v[192:195], v[52:55]
  v_mfma_f32_16x16x32_bf16 v[56:59], v[8:11], v[192:195], v[56:59]
  s_waitcnt lgkmcnt(4)
  v_mfma_f32_16x16x32_bf16 v[36:39], a[68:71], v[12:15], v[36:39]
  ds_read_b128 v[4:7], v81 offset:40960
  v_mfma_f32_16x16x32_bf16 v[44:47], a[196:199], v[12:15], v[44:47]
  ds_read_b128 v[8:11], v81 offset:43008
  v_mfma_f32_16x16x32_bf16 v[40:43], a[68:71], v[16:19], v[40:43]
  s_add_u32 m0, s34, 55552
  s_nop 0
  buffer_load_dwordx4 v1, s[4:7], s35 offen offset:1792 sc1 lds
  v_mfma_f32_16x16x32_bf16 v[48:51], a[196:199], v[16:19], v[48:51]
  v_mfma_f32_16x16x32_bf16 v[52:55], v[12:15], v[196:199], v[52:55]
  v_mfma_f32_16x16x32_bf16 v[56:59], v[16:19], v[196:199], v[56:59]
  s_waitcnt lgkmcnt(4)
  v_mfma_f32_16x16x32_bf16 v[36:39], a[72:75], v[20:23], v[36:39]
  ds_read_b128 v[12:15], v82 offset:40960
  v_mfma_f32_16x16x32_bf16 v[44:47], a[200:203], v[20:23], v[44:47]
  ds_read_b128 v[16:19], v82 offset:43008
  v_mfma_f32_16x16x32_bf16 v[40:43], a[72:75], v[24:27], v[40:43]
  s_add_u32 m0, s34, 59520
  s_nop 0
  buffer_load_dwordx4 v1, s[4:7], s35 offen offset:1920 sc1 lds
  v_mfma_f32_16x16x32_bf16 v[48:51], a[200:203], v[24:27], v[48:51]
  v_mfma_f32_16x16x32_bf16 v[52:55], v[20:23], v[200:203], v[52:55]
  v_mfma_f32_16x16x32_bf16 v[56:59], v[24:27], v[200:203], v[56:59]
  s_waitcnt lgkmcnt(4)
  v_mfma_f32_16x16x32_bf16 v[36:39], a[76:79], v[28:31], v[36:39]
  ds_read_b128 v[20:23], v81 offset:45056
  v_mfma_f32_16x16x32_bf16 v[44:47], a[204:207], v[28:31], v[44:47]
  ds_read_b128 v[24:27], v81 offset:47104
  v_mfma_f32_16x16x32_bf16 v[40:43], a[76:79], v[32:35], v[40:43]
  v_mfma_f32_16x16x32_bf16 v[48:51], a[204:207], v[32:35], v[48:51]
  v_mfma_f32_16x16x32_bf16 v[52:55], v[28:31], v[204:207], v[52:55]
  v_mfma_f32_16x16x32_bf16 v[56:59], v[32:35], v[204:207], v[56:59]
  s_waitcnt lgkmcnt(4)
  v_mfma_f32_16x16x32_bf16 v[36:39], a[80:83], v[4:7], v[36:39]
  ds_read_b128 v[28:31], v82 offset:45056
  v_mfma_f32_16x16x32_bf16 v[44:47], a[208:211], v[4:7], v[44:47]
  ds_read_b128 v[32:35], v82 offset:47104
  v_mfma_f32_16x16x32_bf16 v[40:43], a[80:83], v[8:11], v[40:43]
  s_add_u32 s30, s25, 2
  s_and_b32 s30, s30, 56
  s_lshl_b32 s30, s30, 7
  buffer_load_dword v3, v2, s[4:7], s30 offen sc1
  v_mfma_f32_16x16x32_bf16 v[48:51], a[208:211], v[8:11], v[48:51]
  v_mfma_f32_16x16x32_bf16 v[52:55], v[4:7], v[208:211], v[52:55]
  v_mfma_f32_16x16x32_bf16 v[56:59], v[8:11], v[208:211], v[56:59]
  s_waitcnt lgkmcnt(4)
  v_mfma_f32_16x16x32_bf16 v[36:39], a[84:87], v[12:15], v[36:39]
  ds_read_b128 v[4:7], v81 offset:49152
  v_mfma_f32_16x16x32_bf16 v[44:47], a[212:215], v[12:15], v[44:47]
  ds_read_b128 v[8:11], v81 offset:51200
  v_mfma_f32_16x16x32_bf16 v[40:43], a[84:87], v[16:19], v[40:43]
  v_mfma_f32_16x16x32_bf16 v[48:51], a[212:215], v[16:19], v[48:51]
  v_mfma_f32_16x16x32_bf16 v[52:55], v[12:15], v[212:215], v[52:55]
  v_mfma_f32_16x16x32_bf16 v[56:59], v[16:19], v[212:215], v[56:59]
  s_waitcnt lgkmcnt(4)
  v_mfma_f32_16x16x32_bf16 v[36:39], a[88:91], v[20:23], v[36:39]
  ds_read_b128 v[12:15], v82 offset:49152
  v_mfma_f32_16x16x32_bf16 v[44:47], a[216:219], v[20:23], v[44:47]
  ds_read_b128 v[16:19], v82 offset:51200
  v_mfma_f32_16x16x32_bf16 v[40:43], a[88:91], v[24:27], v[40:43]
  v_mfma_f32_16x16x32_bf16 v[48:51], a[216:219], v[24:27], v[48:51]
  v_mfma_f32_16x16x32_bf16 v[52:55], v[20:23], v[216:219], v[52:55]
  v_mfma_f32_16x16x32_bf16 v[56:59], v[24:27], v[216:219], v[56:59]
  s_waitcnt lgkmcnt(4)
  v_mfma_f32_16x16x32_bf16 v[36:39], a[92:95], v[28:31], v[36:39]
  ds_read_b128 v[20:23], v81 offset:53248
  v_mfma_f32_16x16x32_bf16 v[44:47], a[220:223], v[28:31], v[44:47]
  ds_read_b128 v[24:27], v81 offset:55296
  v_mfma_f32_16x16x32_bf16 v[40:43], a[92:95], v[32:35], v[40:43]
  v_mfma_f32_16x16x32_bf16 v[48:51], a[220:223], v[32:35], v[48:51]
  v_mfma_f32_16x16x32_bf16 v[52:55], v[28:31], v[220:223], v[52:55]
  v_mfma_f32_16x16x32_bf16 v[56:59], v[32:35], v[220:223], v[56:59]
  s_waitcnt lgkmcnt(4)
  v_mfma_f32_16x16x32_bf16 v[36:39], a[96:99], v[4:7], v[36:39]
  ds_read_b128 v[28:31], v82 offset:53248
  v_mfma_f32_16x16x32_bf16 v[44:47], a[224:227], v[4:7], v[44:47]
  ds_read_b128 v[32:35], v82 offset:55296
  v_mfma_f32_16x16x32_bf16 v[40:43], a[96:99], v[8:11], v[40:43]
  v_mfma_f32_16x16x32_bf16 v[48:51], a[224:227], v[8:11], v[48:51]
  v_mfma_f32_16x16x32_bf16 v[52:55], v[4:7], v[224:227], v[52:55]
  v_mfma_f32_16x16x32_bf16 v[56:59], v[8:11], v[224:227], v[56:59]
  s_waitcnt lgkmcnt(4)
  v_mfma_f32_16x16x32_bf16 v[36:39], a[100:103], v[12:15], v[36:39]
  ds_read_b128 v[4:7], v81 offset:57344
  v_mfma_f32_16x16x32_bf16 v[44:47], a[228:231], v[12:15], v[44:47]
  ds_read_b128 v[8:11], v81 offset:59392
  v_mfma_f32_16x16x32_bf16 v[40:43], a[100:103], v[16:19], v[40:43]
  v_mfma_f32_16x16x32_bf16 v[48:51], a[228:231], v[16:19], v[48:51]
  v_mfma_f32_16x16x32_bf16 v[52:55], v[12:15], v[228:231], v[52:55]
  v_mfma_f32_16x16x32_bf16 v[56:59], v[16:19], v[228:231], v[56:59]
  s_waitcnt lgkmcnt(4)
  v_mfma_f32_16x16x32_bf16 v[36:39], a[104:107], v[20:23], v[36:39]
  ds_read_b128 v[12:15], v82 offset:57344
  v_mfma_f32_16x16x32_bf16 v[44:47], a[232:235], v[20:23], v[44:47]
  ds_read_b128 v[16:19], v82 offset:59392
  v_mfma_f32_16x16x32_bf16 v[40:43], a[104:107], v[24:27], v[40:43]
  v_mfma_f32_16x16x32_bf16 v[48:51], a[232:235], v[24:27], v[48:51]
  v_mfma_f32_16x16x32_bf16 v[52:55], v[20:23], v[232:235], v[52:55]
  v_mfma_f32_16x16x32_bf16 v[56:59], v[24:27], v[232:235], v[56:59]
  s_waitcnt lgkmcnt(4)
  v_mfma_f32_16x16x32_bf16 v[36:39], a[108:111], v[28:31], v[36:39]
  ds_read_b128 v[20:23], v81 offset:61440
  v_mfma_f32_16x16x32_bf16 v[44:47], a[236:239], v[28:31], v[44:47]
  ds_read_b128 v[24:27], v81 offset:63488
  v_mfma_f32_16x16x32_bf16 v[40:43], a[108:111], v[32:35], v[40:43]
  v_mfma_f32_16x16x32_bf16 v[48:51], a[236:239], v[32:35], v[48:51]
  v_mfma_f32_16x16x32_bf16 v[52:55], v[28:31], v[236:239], v[52:55]
  v_mfma_f32_16x16x32_bf16 v[56:59], v[32:35], v[236:239], v[56:59]
  s_waitcnt lgkmcnt(4)
  v_mfma_f32_16x16x32_bf16 v[36:39], a[112:115], v[4:7], v[36:39]
  ds_read_b128 v[28:31], v82 offset:61440
  v_mfma_f32_16x16x32_bf16 v[44:47], a[240:243], v[4:7], v[44:47]
  ds_read_b128 v[32:35], v82 offset:63488
  v_mfma_f32_16x16x32_bf16 v[40:43], a[112:115], v[8:11], v[40:43]
  v_mfma_f32_16x16x32_bf16 v[48:51], a[240:243], v[8:11], v[48:51]
  v_mfma_f32_16x16x32_bf16 v[52:55], v[4:7], v[240:243], v[52:55]
  v_mfma_f32_16x16x32_bf16 v[56:59], v[8:11], v[240:243], v[56:59]
  s_waitcnt vmcnt(0)
  s_barrier
  v_xor_b32 v81, 0x10000, v81
  v_xor_b32 v82, 0x10000, v82
  s_waitcnt lgkmcnt(4)
  v_mfma_f32_16x16x32_bf16 v[36:39], a[116:119], v[12:15], v[36:39]
  ds_read_b128 v[4:7], v81 offset:0
  v_mfma_f32_16x16x32_bf16 v[44:47], a[244:247], v[12:15], v[44:47]
  ds_read_b128 v[8:11], v81 offset:2048
  v_mfma_f32_16x16x32_bf16 v[40:43], a[116:119], v[16:19], v[40:43]
  v_mfma_f32_16x16x32_bf16 v[48:51], a[244:247], v[16:19], v[48:51]
  v_mfma_f32_16x16x32_bf16 v[52:55], v[12:15], v[244:247], v[52:55]
  v_mfma_f32_16x16x32_bf16 v[56:59], v[16:19], v[244:247], v[56:59]
  s_waitcnt lgkmcnt(4)
  v_mfma_f32_16x16x32_bf16 v[36:39], a[120:123], v[20:23], v[36:39]
  ds_read_b128 v[12:15], v82 offset:0
  v_mfma_f32_16x16x32_bf16 v[44:47], a[248:251], v[20:23], v[44:47]
  ds_read_b128 v[16:19], v82 offset:2048
  v_mfma_f32_16x16x32_bf16 v[40:43], a[120:123], v[24:27], v[40:43]
  v_mfma_f32_16x16x32_bf16 v[48:51], a[248:251], v[24:27], v[48:51]
  v_mfma_f32_16x16x32_bf16 v[52:55], v[20:23], v[248:251], v[52:55]
  v_mfma_f32_16x16x32_bf16 v[56:59], v[24:27], v[248:251], v[56:59]
  s_waitcnt lgkmcnt(4)
  v_mfma_f32_16x16x32_bf16 v[36:39], a[124:127], v[28:31], v[36:39]
  ds_read_b128 v[20:23], v81 offset:4096
  v_mfma_f32_16x16x32_bf16 v[44:47], a[252:255], v[28:31], v[44:47]
  ds_read_b128 v[24:27], v81 offset:6144
  v_mfma_f32_16x16x32_bf16 v[40:43], a[124:127], v[32:35], v[40:43]
  v_mfma_f32_16x16x32_bf16 v[48:51], a[252:255], v[32:35], v[48:51]
  v_mfma_f32_16x16x32_bf16 v[52:55], v[28:31], v[252:255], v[52:55]
  v_mfma_f32_16x16x32_bf16 v[56:59], v[32:35], v[252:255], v[56:59]
  s_mov_b32 s37, s31
  s_add_u32 s31, s31, 2097152
  s_xor_b32 s31, s31, 0x2000
  s_add_u32 s25, s25, 1
  s_cmp_lt_u32 s25, 64
  s_cbranch_scc1 L_QKV_top
  v_cvt_pk_bf16_f32 v60, v36, v37
  v_cvt_pk_bf16_f32 v61, v38, v39
  v_cvt_pk_bf16_f32 v62, v44, v45
  v_cvt_pk_bf16_f32 v63, v46, v47
  v_cvt_pk_bf16_f32 v64, v40, v41
  v_cvt_pk_bf16_f32 v65, v42, v43
  v_cvt_pk_bf16_f32 v66, v48, v49
  v_cvt_pk_bf16_f32 v67, v50, v51
  v_cvt_pk_bf16_f32 v68, v52, v53
  v_cvt_pk_bf16_f32 v69, v54, v55
  v_cvt_pk_bf16_f32 v70, v56, v57
  v_cvt_pk_bf16_f32 v71, v58, v59
  buffer_store_dwordx4 v[60:63], v76, s[4:7], s37 offen offset:0 sc1
  buffer_store_dwordx4 v[64:67], v76, s[4:7], s37 offen offset:1024 sc1
  buffer_store_dwordx4 v[68:71], v83, s[4:7], s37 offen sc1
  s_waitcnt vmcnt(0) lgkmcnt(0)
  s_barrier
  s_cmp_lg_u32 s20, 0
  s_cbranch_scc1 Lnosig_33
  s_mov_b32 s63, s25
  s_atomic_smax s63, s[4:5], s62 glc
Lnosig_33:
  s_branch L_END
L_WO:
  v_lshlrev_b32 v1, 4, v0
  s_lshl_b32 s32, s20, 12
  s_min_u32 s33, s32, 0x2000
  v_mov_b32 v69, v1
  v_add_u32 v70, 0x10000, v69
  s_load_dwordx2 s[8:9], s[0:1], 40
  s_mov_b32 s10, 8388608
  s_mov_b32 s11, 0x20000
  s_waitcnt lgkmcnt(0)
  s_lshr_b32 s44, s21, 3
  s_mul_i32 s44, s44, 2097152
  s_and_b32 s45, s21, 7
  s_lshl_b32 s45, s45, 8
  s_add_u32 s44, s44, s45
  s_add_u32 s45, s44, 128
  v_bfe_u32 v4, v0, 5, 1
  v_mul_u32_u24 v4, 8192, v4
  v_bfe_u32 v5, v0, 4, 1
  v_mul_u32_u24 v5, 4096, v5
  v_add_u32 v4, v4, v5
  v_bfe_u32 v5, v0, 3, 1
  v_mul_u32_u24 v5, 2048, v5
  v_add_u32 v4, v4, v5
  v_lshrrev_b32 v5, 3, v0
  v_and_b32 v5, 6, v5
  v_xor_b32 v5, v5, v0
  v_and_b32 v5, 7, v5
  v_lshl_add_u32 v4, v5, 4, v4
  s_lshr_b32 s40, s20, 1
  s_mul_i32 s40, s40, 131072
  s_and_b32 s41, s20, 1
  s_mul_i32 s41, s41, 16384
  s_add_u32 s40, s40, s41
  v_add_u32 v4, s40, v4
  v_bfe_u32 v5, v0, 3, 2
  v_xor_b32 v5, s20, v5
  v_lshlrev_b32 v5, 5, v5
  v_lshrrev_b32 v6, 2, v0
  v_lshl_add_u32 v6, v6, 7, v5
  v_and_b32 v5, 3, v0
  v_lshl_add_u32 v6, v5, 3, v6
  v_add_u32 v7, 0x10000, v6
  v_add_u32 v8, s44, v4
  v_add_u32 v9, s45, v4
  s_lshl_b32 s41, s20, 10
  s_add_u32 m0, s41, 0
  s_mov_b32 s42, 0
  buffer_load_dwordx4 v8, s[8:11], s42 offen nt lds
  s_add_u32 m0, s41, 4096
  s_mov_b32 s42, 0
  buffer_load_dwordx4 v9, s[8:11], s42 offen nt lds
  s_add_u32 m0, s41, 8192
  s_mov_b32 s42, 32768
  buffer_load_dwordx4 v8, s[8:11], s42 offen nt lds
  s_add_u32 m0, s41, 12288
  s_mov_b32 s42, 32768
  buffer_load_dwordx4 v9, s[8:11], s42 offen nt lds
  s_add_u32 m0, s41, 16384
  s_mov_b32 s42, 65536
  buffer_load_dwordx4 v8, s[8:11], s42 offen nt lds
  s_add_u32 m0, s41, 20480
  s_mov_b32 s42, 65536
  buffer_load_dwordx4 v9, s[8:11], s42 offen nt lds
  s_add_u32 m0, s41, 24576
  s_mov_b32 s42, 98304
  buffer_load_dwordx4 v8, s[8:11], s42 offen nt lds
  s_add_u32 m0, s41, 28672
  s_mov_b32 s42, 98304
  buffer_load_dwordx4 v9, s[8:11], s42 offen nt lds
  s_add_u32 m0, s41, 32768
  s_mov_b32 s42, 262144
  buffer_load_dwordx4 v8, s[8:11], s42 offen nt lds
  s_add_u32 m0, s41, 36864
  s_mov_b32 s42, 262144
  buffer_load_dwordx4 v9, s[8:11], s42 offen nt lds
  s_add_u32 m0, s41, 40960
  s_mov_b32 s42, 294912
  buffer_load_dwordx4 v8, s[8:11], s42 offen nt lds
  s_add_u32 m0, s41, 45056
  s_mov_b32 s42, 294912
  buffer_load_dwordx4 v9, s[8:11], s42 offen nt lds
  s_add_u32 m0, s41, 49152
  s_mov_b32 s42, 327680
  buffer_load_dwordx4 v8, s[8:11], s42 offen nt lds
  s_add_u32 m0, s41, 53248
  s_mov_b32 s42, 327680
  buffer_load_dwordx4 v9, s[8:11], s42 offen nt lds
  s_add_u32 m0, s41, 57344
  s_mov_b32 s42, 360448
  buffer_load_dwordx4 v8, s[8:11], s42 offen nt lds
  s_add_u32 m0, s41, 61440
  s_mov_b32 s42, 360448
  buffer_load_dwordx4 v9, s[8:11], s42 offen nt lds
  s_add_u32 m0, s41, 65536
  s_mov_b32 s42, 524288
  buffer_load_dwordx4 v8, s[8:11], s42 offen nt lds
  s_add_u32 m0, s41, 69632
  s_mov_b32 s42, 524288
  buffer_load_dwordx4 v9, s[8:11], s42 offen nt lds
  s_add_u32 m0, s41, 73728
  s_mov_b32 s42, 557056
  buffer_load_dwordx4 v8, s[8:11], s42 offen nt lds
  s_add_u32 m0, s41, 77824
  s_mov_b32 s42, 557056
  buffer_load_dwordx4 v9, s[8:11], s42 offen nt lds
  s_add_u32 m0, s41, 81920
  s_mov_b32 s42, 589824
  buffer_load_dwordx4 v8, s[8:11], s42 offen nt lds
  s_add_u32 m0, s41, 86016
  s_mov_b32 s42, 589824
  buffer_load_dwordx4 v9, s[8:11], s42 offen nt lds
  s_add_u32 m0, s41, 90112
  s_mov_b32 s42, 622592
  buffer_load_dwordx4 v8, s[8:11], s42 offen nt lds
  s_add_u32 m0, s41, 94208
  s_mov_b32 s42, 622592
  buffer_load_dwordx4 v9, s[8:11], s42 offen nt lds
  s_add_u32 m0, s41, 98304
  s_mov_b32 s42, 786432
  buffer_load_dwordx4 v8, s[8:11], s42 offen nt lds
  s_add_u32 m0, s41, 102400
  s_mov_b32 s42, 786432
  buffer_load_dwordx4 v9, s[8:11], s42 offen nt lds
  s_add_u32 m0, s41, 106496
  s_mov_b32 s42, 819200
  buffer_load_dwordx4 v8, s[8:11], s42 offen nt lds
  s_add_u32 m0, s41, 110592
  s_mov_b32 s42, 819200
  buffer_load_dwordx4 v9, s[8:11], s42 offen nt lds
  s_waitcnt vmcnt(24) lgkmcnt(0)
  s_barrier
  s_add_u32 m0, s41, 114688
  s_mov_b32 s42, 851968
  buffer_load_dwordx4 v8, s[8:11], s42 offen nt lds
  s_add_u32 m0, s41, 118784
  s_mov_b32 s42, 851968
  buffer_load_dwordx4 v9, s[8:11], s42 offen nt lds
  s_add_u32 m0, s41, 122880
  s_mov_b32 s42, 884736
  buffer_load_dwordx4 v8, s[8:11], s42 offen nt lds
  s_add_u32 m0, s41, 126976
  s_mov_b32 s42, 884736
  buffer_load_dwordx4 v9, s[8:11], s42 offen nt lds
  ds_read_b64_tr_b16 a[0:1], v6 offset:0
  ds_read_b64_tr_b16 a[2:3], v6 offset:2048
  ds_read_b64_tr_b16 a[128:129], v6 offset:4096
  ds_read_b64_tr_b16 a[130:131], v6 offset:6144
  ds_read_b64_tr_b16 a[4:5], v6 offset:8192
  ds_read_b64_tr_b16 a[6:7], v6 offset:10240
  ds_read_b64_tr_b16 a[132:133], v6 offset:12288
  ds_read_b64_tr_b16 a[134:135], v6 offset:14336
  s_waitcnt vmcnt(24) lgkmcnt(0)
  s_barrier
  s_add_u32 m0, s41, 0
  s_mov_b32 s42, 1048576
  buffer_load_dwordx4 v8, s[8:11], s42 offen nt lds
  s_add_u32 m0, s41, 4096
  s_mov_b32 s42, 1048576
  buffer_load_dwordx4 v9, s[8:11], s42 offen nt lds
  s_add_u32 m0, s41, 8192
  s_mov_b32 s42, 1081344
  buffer_load_dwordx4 v8, s[8:11], s42 offen nt lds
  s_add_u32 m0, s41, 12288
  s_mov_b32 s42, 1081344
  buffer_load_dwordx4 v9, s[8:11], s42 offen nt lds
  ds_read_b64_tr_b16 a[8:9], v6 offset:16384
  ds_read_b64_tr_b16 a[10:11], v6 offset:18432
  ds_read_b64_tr_b16 a[136:137], v6 offset:20480
  ds_read_b64_tr_b16 a[138:139], v6 offset:22528
  ds_read_b64_tr_b16 a[12:13], v6 offset:24576
  ds_read_b64_tr_b16 a[14:15], v6 offset:26624
  ds_read_b64_tr_b16 a[140:141], v6 offset:28672
  ds_read_b64_tr_b16 a[142:143], v6 offset:30720
  s_waitcnt vmcnt(24) lgkmcnt(0)
  s_barrier
  s_add_u32 m0, s41, 16384
  s_mov_b32 s42, 1114112
  buffer_load_dwordx4 v8, s[8:11], s42 offen nt lds
  s_add_u32 m0, s41, 20480
  s_mov_b32 s42, 1114112
  buffer_load_dwordx4 v9, s[8:11], s42 offen nt lds
  s_add_u32 m0, s41, 24576
  s_mov_b32 s42, 1146880
  buffer_load_dwordx4 v8, s[8:11], s42 offen nt lds
  s_add_u32 m0, s41, 28672
  s_mov_b32 s42, 1146880
  buffer_load_dwordx4 v9, s[8:11], s42 offen nt lds
  ds_read_b64_tr_b16 a[16:17], v6 offset:32768
  ds_read_b64_tr_b16 a[18:19], v6 offset:34816
  ds_read_b64_tr_b16 a[144:145], v6 offset:36864
  ds_read_b64_tr_b16 a[146:147], v6 offset:38912
  ds_read_b64_tr_b16 a[20:21], v6 offset:40960
  ds_read_b64_tr_b16 a[22:23], v6 offset:43008
  ds_read_b64_tr_b16 a[148:149], v6 offset:45056
  ds_read_b64_tr_b16 a[150:151], v6 offset:47104
  s_waitcnt vmcnt(24) lgkmcnt(0)
  s_barrier
  s_add_u32 m0, s41, 32768
  s_mov_b32 s42, 1310720
  buffer_load_dwordx4 v8, s[8:11], s42 offen nt lds
  s_add_u32 m0, s41, 36864
  s_mov_b32 s42, 1310720
  buffer_load_dwordx4 v9, s[8:11], s42 offen nt lds
  s_add_u32 m0, s41, 40960
  s_mov_b32 s42, 1343488
  buffer_load_dwordx4 v8, s[8:11], s42 offen nt lds
  s_add_u32 m0, s41, 45056
  s_mov_b32 s42, 1343488
  buffer_load_dwordx4 v9, s[8:11], s42 offen nt lds
  ds_read_b64_tr_b16 a[24:25], v6 offset:49152
  ds_read_b64_tr_b16 a[26:27], v6 offset:51200
  ds_read_b64_tr_b16 a[152:153], v6 offset:53248
  ds_read_b64_tr_b16 a[154:155], v6 offset:55296
  ds_read_b64_tr_b16 a[28:29], v6 offset:57344
  ds_read_b64_tr_b16 a[30:31], v6 offset:59392
  ds_read_b64_tr_b16 a[156:157], v6 offset:61440
  ds_read_b64_tr_b16 a[158:159], v6 offset:63488
  s_waitcnt vmcnt(24) lgkmcnt(0)
  s_barrier
  s_add_u32 m0, s41, 49152
  s_mov_b32 s42, 1376256
  buffer_load_dwordx4 v8, s[8:11], s42 offen nt lds
  s_add_u32 m0, s41, 53248
  s_mov_b32 s42, 1376256
  buffer_load_dwordx4 v9, s[8:11], s42 offen nt lds
  s_add_u32 m0, s41, 57344
  s_mov_b32 s42, 1409024
  buffer_load_dwordx4 v8, s[8:11], s42 offen nt lds
  s_add_u32 m0, s41, 61440
  s_mov_b32 s42, 1409024
  buffer_load_dwordx4 v9, s[8:11], s42 offen nt lds
  ds_read_b64_tr_b16 a[32:33], v7 offset:0
  ds_read_b64_tr_b16 a[34:35], v7 offset:2048
  ds_read_b64_tr_b16 a[160:161], v7 offset:4096
  ds_read_b64_tr_b16 a[162:163], v7 offset:6144
  ds_read_b64_tr_b16 a[36:37], v7 offset:8192
  ds_read_b64_tr_b16 a[38:39], v7 offset:10240
  ds_read_b64_tr_b16 a[164:165], v7 offset:12288
  ds_read_b64_tr_b16 a[166:167], v7 offset:14336
  s_waitcnt vmcnt(24) lgkmcnt(0)
  s_barrier
  s_add_u32 m0, s41, 65536
  s_mov_b32 s42, 1572864
  buffer_load_dwordx4 v8, s[8:11], s42 offen nt lds
  s_add_u32 m0, s41, 69632
  s_mov_b32 s42, 1572864
  buffer_load_dwordx4 v9, s[8:11], s42 offen nt lds
  s_add_u32 m0, s41, 73728
  s_mov_b32 s42, 1605632
  buffer_load_dwordx4 v8, s[8:11], s42 offen nt lds
  s_add_u32 m0, s41, 77824
  s_mov_b32 s42, 1605632
  buffer_load_dwordx4 v9, s[8:11], s42 offen nt lds
  ds_read_b64_tr_b16 a[40:41], v7 offset:16384
  ds_read_b64_tr_b16 a[42:43], v7 offset:18432
  ds_read_b64_tr_b16 a[168:169], v7 offset:20480
  ds_read_b64_tr_b16 a[170:171], v7 offset:22528
  ds_read_b64_tr_b16 a[44:45], v7 offset:24576
  ds_read_b64_tr_b16 a[46:47], v7 offset:26624
  ds_read_b64_tr_b16 a[172:173], v7 offset:28672
  ds_read_b64_tr_b16 a[174:175], v7 offset:30720
  s_waitcnt vmcnt(24) lgkmcnt(0)
  s_barrier
  s_add_u32 m0, s41, 81920
  s_mov_b32 s42, 1638400
  buffer_load_dwordx4 v8, s[8:11], s42 offen nt lds
  s_add_u32 m0, s41, 86016
  s_mov_b32 s42, 1638400
  buffer_load_dwordx4 v9, s[8:11], s42 offen nt lds
  s_add_u32 m0, s41, 90112
  s_mov_b32 s42, 1671168
  buffer_load_dwordx4 v8, s[8:11], s42 offen nt lds
  s_add_u32 m0, s41, 94208
  s_mov_b32 s42, 1671168
  buffer_load_dwordx4 v9, s[8:11], s42 offen nt lds
  ds_read_b64_tr_b16 a[48:49], v7 offset:32768
  ds_read_b64_tr_b16 a[50:51], v7 offset:34816
  ds_read_b64_tr_b16 a[176:177], v7 offset:36864
  ds_read_b64_tr_b16 a[178:179], v7 offset:38912
  ds_read_b64_tr_b16 a[52:53], v7 offset:40960
  ds_read_b64_tr_b16 a[54:55], v7 offset:43008
  ds_read_b64_tr_b16 a[180:181], v7 offset:45056
  ds_read_b64_tr_b16 a[182:183], v7 offset:47104
  s_waitcnt vmcnt(24) lgkmcnt(0)
  s_barrier
  s_add_u32 m0, s41, 98304
  s_mov_b32 s42, 1835008
  buffer_load_dwordx4 v8, s[8:11], s42 offen nt lds
  s_add_u32 m0, s41, 102400
  s_mov_b32 s42, 1835008
  buffer_load_dwordx4 v9, s[8:11], s42 offen nt lds
  s_add_u32 m0, s41, 106496
  s_mov_b32 s42, 1867776
  buffer_load_dwordx4 v8, s[8:11], s42 offen nt lds
  s_add_u32 m0, s41, 110592
  s_mov_b32 s42, 1867776
  buffer_load_dwordx4 v9, s[8:11], s42 offen nt lds
  ds_read_b64_tr_b16 a[56:57], v7 offset:49152
  ds_read_b64_tr_b16 a[58:59], v7 offset:51200
  ds_read_b64_tr_b16 a[184:185], v7 offset:53248
  ds_read_b64_tr_b16 a[186:187], v7 offset:55296
  ds_read_b64_tr_b16 a[60:61], v7 offset:57344
  ds_read_b64_tr_b16 a[62:63], v7 offset:59392
  ds_read_b64_tr_b16 a[188:189], v7 offset:61440
  ds_read_b64_tr_b16 a[190:191], v7 offset:63488
  s_waitcnt vmcnt(24) lgkmcnt(0)
  s_barrier
  s_add_u32 m0, s41, 114688
  s_mov_b32 s42, 1900544
  buffer_load_dwordx4 v8, s[8:11], s42 offen nt lds
  s_add_u32 m0, s41, 118784
  s_mov_b32 s42, 1900544
  buffer_load_dwordx4 v9, s[8:11], s42 offen nt lds
  s_add_u32 m0, s41, 122880
  s_mov_b32 s42, 1933312
  buffer_load_dwordx4 v8, s[8:11], s42 offen nt lds
  s_add_u32 m0, s41, 126976
  s_mov_b32 s42, 1933312
  buffer_load_dwordx4 v9, s[8:11], s42 offen nt lds
  ds_read_b64_tr_b16 a[64:65], v6 offset:0
  ds_read_b64_tr_b16 a[66:67], v6 offset:2048
  ds_read_b64_tr_b16 a[192:193], v6 offset:4096
  ds_read_b64_tr_b16 a[194:195], v6 offset:6144
  ds_read_b64_tr_b16 a[68:69], v6 offset:8192
  ds_read_b64_tr_b16 a[70:71], v6 offset:10240
  ds_read_b64_tr_b16 a[196:197], v6 offset:12288
  ds_read_b64_tr_b16 a[198:199], v6 offset:14336
  s_waitcnt vmcnt(24) lgkmcnt(0)
  s_barrier
  ds_read_b64_tr_b16 a[72:73], v6 offset:16384
  ds_read_b64_tr_b16 a[74:75], v6 offset:18432
  ds_read_b64_tr_b16 a[200:201], v6 offset:20480
  ds_read_b64_tr_b16 a[202:203], v6 offset:22528
  ds_read_b64_tr_b16 a[76:77], v6 offset:24576
  ds_read_b64_tr_b16 a[78:79], v6 offset:26624
  ds_read_b64_tr_b16 a[204:205], v6 offset:28672
  ds_read_b64_tr_b16 a[206:207], v6 offset:30720
  s_waitcnt vmcnt(20) lgkmcnt(0)
  s_barrier
  ds_read_b64_tr_b16 a[80:81], v6 offset:32768
  ds_read_b64_tr_b16 a[82:83], v6 offset:34816
  ds_read_b64_tr_b16 a[208:209], v6 offset:36864
  ds_read_b64_tr_b16 a[210:211], v6 offset:38912
  ds_read_b64_tr_b16 a[84:85], v6 offset:40960
  ds_read_b64_tr_b16 a[86:87], v6 offset:43008
  ds_read_b64_tr_b16 a[212:213], v6 offset:45056
  ds_read_b64_tr_b16 a[214:215], v6 offset:47104
  s_waitcnt vmcnt(16) lgkmcnt(0)
  s_barrier
  ds_read_b64_tr_b16 a[88:89], v6 offset:49152
  ds_read_b64_tr_b16 a[90:91], v6 offset:51200
  ds_read_b64_tr_b16 a[216:217], v6 offset:53248
  ds_read_b64_tr_b16 a[218:219], v6 offset:55296
  ds_read_b64_tr_b16 a[92:93], v6 offset:57344
  ds_read_b64_tr_b16 a[94:95], v6 offset:59392
  ds_read_b64_tr_b16 a[220:221], v6 offset:61440
  ds_read_b64_tr_b16 a[222:223], v6 offset:63488
  s_waitcnt vmcnt(12) lgkmcnt(0)
  s_barrier
  ds_read_b64_tr_b16 a[96:97], v7 offset:0
  ds_read_b64_tr_b16 a[98:99], v7 offset:2048
  ds_read_b64_tr_b16 a[224:225], v7 offset:4096
  ds_read_b64_tr_b16 a[226:227], v7 offset:6144
  ds_read_b64_tr_b16 a[100:101], v7 offset:8192
  ds_read_b64_tr_b16 a[102:103], v7 offset:10240
  ds_read_b64_tr_b16 a[228:229], v7 offset:12288
  ds_read_b64_tr_b16 a[230:231], v7 offset:14336
  s_waitcnt vmcnt(8) lgkmcnt(0)
  s_barrier
  ds_read_b64_tr_b16 a[104:105], v7 offset:16384
  ds_read_b64_tr_b16 a[106:107], v7 offset:18432
  ds_read_b64_tr_b16 a[232:233], v7 offset:20480
  ds_read_b64_tr_b16 a[234:235], v7 offset:22528
  ds_read_b64_tr_b16 a[108:109], v7 offset:24576
  ds_read_b64_tr_b16 a[110:111], v7 offset:26624
  ds_read_b64_tr_b16 a[236:237], v7 offset:28672
  ds_read_b64_tr_b16 a[238:239], v7 offset:30720
  s_waitcnt vmcnt(4) lgkmcnt(0)
  s_barrier
  ds_read_b64_tr_b16 a[112:113], v7 offset:32768
  ds_read_b64_tr_b16 a[114:115], v7 offset:34816
  ds_read_b64_tr_b16 a[240:241], v7 offset:36864
  ds_read_b64_tr_b16 a[242:243], v7 offset:38912
  ds_read_b64_tr_b16 a[116:117], v7 offset:40960
  ds_read_b64_tr_b16 a[118:119], v7 offset:43008
  ds_read_b64_tr_b16 a[244:245], v7 offset:45056
  ds_read_b64_tr_b16 a[246:247], v7 offset:47104
  s_waitcnt vmcnt(0) lgkmcnt(0)
  s_barrier
  ds_read_b64_tr_b16 a[120:121], v7 offset:49152
  ds_read_b64_tr_b16 a[122:123], v7 offset:51200
  ds_read_b64_tr_b16 a[248:249], v7 offset:53248
  ds_read_b64_tr_b16 a[250:251], v7 offset:55296
  ds_read_b64_tr_b16 a[124:125], v7 offset:57344
  ds_read_b64_tr_b16 a[126:127], v7 offset:59392
  ds_read_b64_tr_b16 a[252:253], v7 offset:61440
  ds_read_b64_tr_b16 a[254:255], v7 offset:63488
  s_waitcnt lgkmcnt(0)
  s_barrier
  s_and_b32 s43, s21, 24
  v_min_u32 v2, 7, v0
  v_add_u32 v2, s43, v2
  v_lshlrev_b32 v2, 7, v2
  v_add_u32 v2, 1404928, v2
  s_lshl_b32 s62, s21, 7
  s_add_u32 s62, s62, 1409024
  v_min_u32 v52, 63, v0
  v_lshlrev_b32 v52, 7, v52
  v_add_u32 v52, 1424384, v52
  s_nop 1
Lpoll_34:
  buffer_load_dword v53, v52, s[4:7], 0 offen sc1
  s_sub_u32 s24, s24, 1
  s_cbranch_scc1 L_FAIL
  s_waitcnt vmcnt(0)
  v_cmp_gt_i32 vcc, 0, v53
  s_cbranch_vccz Lpolld_35
  s_sleep 1
  s_branch Lpoll_34
Lpolld_35:
  v_lshrrev_b32 v53, 8, v53
  v_and_b32 v54, 3, v0
  v_lshl_or_b32 v53, v53, 2, v54
  s_nop 1
  v_min_u32_dpp v53, v53, v53 row_ror:8 row_mask:0xf bank_mask:0xf
  s_nop 1
  v_min_u32_dpp v53, v53, v53 row_ror:4 row_mask:0xf bank_mask:0xf
  v_mov_b32 v54, v53
  s_nop 1
  v_permlane16_swap_b32 v54, v53
  v_min_u32 v53, v53, v54
  v_mov_b32 v54, v53
  s_nop 1
  v_permlane32_swap_b32 v54, v53
  v_min_u32 v53, v53, v54
  s_nop 1
  v_min_u32_dpp v53, v53, v53 row_ror:2 row_mask:0xf bank_mask:0xf
  s_nop 1
  v_min_u32_dpp v53, v53, v53 row_ror:1 row_mask:0xf bank_mask:0xf
  s_nop 0
  v_readfirstlane_b32 s38, v53
  s_and_b32 s38, s38, 3
  s_lshl_b32 s38, s38, 13
  s_and_b32 s38, s38, 0x2000
  s_xor_b32 s38, s38, 20979712
  s_xor_b32 s27, s38, 0x2000
  s_lshr_b32 s40, s20, 1
  s_add_u32 s40, s40, s43
  s_mul_i32 s40, s40, 65536
  s_and_b32 s41, s20, 1
  s_lshl_b32 s41, s41, 12
  s_add_u32 s40, s40, s41
  s_add_u32 s40, s40, 49152
  s_add_u32 s27, s27, s40
  s_lshl_b32 s40, s21, 14
  s_add_u32 s40, s40, s38
  s_add_u32 s31, s40, 0
  s_lshl_b32 s40, s20, 11
  v_and_b32 v68, 3, v0
  v_lshlrev_b32 v68, 4, v68
  v_lshrrev_b32 v52, 4, v0
  v_lshl_add_u32 v68, v52, 6, v68
  v_bfe_u32 v52, v0, 2, 2
  v_lshl_add_u32 v68, v52, 8, v68
  v_add_u32 v68, s40, v68
  v_lshlrev_b32 v71, 2, v0
  v_add_u32 v71, 131072, v71
  s_mov_b32 s25, 0
  s_mov_b32 s26, 0
  s_mov_b32 s29, 1
  s_mov_b32 s30, 0
  s_mov_b32 s28, 0
L_WO_top:
  s_cmp_eq_u32 s28, 1
  s_cbranch_scc1 L_WO_go
  s_cmp_eq_u32 s28, 2
  s_cbranch_scc1 L_WO_mid
  s_cmp_lg_u32 s20, 0
  s_cbranch_scc1 L_WO_park
  buffer_load_dword v3, v2, s[4:7], s30 offen sc1
  s_waitcnt vmcnt(1)
  s_barrier
  s_mov_b32 s63, s25
  s_atomic_smax s63, s[4:5], s62 glc
Lnosig_36:
  s_cmp_ge_u32 s25, 64
  s_cbranch_scc1 L_END
  s_waitcnt vmcnt(0)
  v_cmp_gt_i32 vcc, s29, v3
  s_cbranch_vccz L_WO_issue
  s_nop 3
Lpoll_37:
  buffer_load_dword v3, v2, s[4:7], s30 offen sc1
  s_sub_u32 s24, s24, 1
  s_cbranch_scc1 L_FAIL
  s_waitcnt vmcnt(0)
  v_cmp_gt_i32 vcc, s29, v3
  s_cbranch_vccz Lpolld_38
  s_sleep 1
  s_branch Lpoll_37
Lpolld_38:
  s_branch L_WO_issue
L_WO_park:
  s_waitcnt vmcnt(0)
  s_barrier
  s_cmp_ge_u32 s25, 64
  s_cbranch_scc1 L_END
L_WO_issue:
  s_barrier
L_WO_mid:
  s_mov_b32 s34, s26
  s_mov_b32 s35, s27
  s_add_u32 s36, s32, 0
  s_add_u32 m0, s34, s36
  s_add_u32 s36, s35, 0
  buffer_load_dwordx4 v1, s[4:7], s36 offen offset:0 sc1 lds
  s_nop 0
  buffer_load_dwordx4 v1, s[4:7], s36 offen offset:1024 sc1 lds
  s_nop 0
  buffer_load_dwordx4 v1, s[4:7], s36 offen offset:2048 sc1 lds
  s_nop 0
  buffer_load_dwordx4 v1, s[4:7], s36 offen offset:3072 sc1 lds
  s_nop 0
  s_add_u32 s36, s32, 16384
  s_add_u32 m0, s34, s36
  s_add_u32 s36, s35, 131072
  buffer_load_dwordx4 v1, s[4:7], s36 offen offset:0 sc1 lds
  s_nop 0
  buffer_load_dwordx4 v1, s[4:7], s36 offen offset:1024 sc1 lds
  s_nop 0
  buffer_load_dwordx4 v1, s[4:7], s36 offen offset:2048 sc1 lds
  s_nop 0
  buffer_load_dwordx4 v1, s[4:7], s36 offen offset:3072 sc1 lds
  s_nop 0
  s_add_u32 s36, s32, 32768
  s_add_u32 m0, s34, s36
  s_add_u32 s36, s35, 262144
  buffer_load_dwordx4 v1, s[4:7], s36 offen offset:0 sc1 lds
  s_nop 0
  buffer_load_dwordx4 v1, s[4:7], s36 offen offset:1024 sc1 lds
  s_nop 0
  buffer_load_dwordx4 v1, s[4:7], s36 offen offset:2048 sc1 lds
  s_nop 0
  buffer_load_dwordx4 v1, s[4:7], s36 offen offset:3072 sc1 lds
  s_nop 0
  s_cmp_eq_u32 s28, 0
  s_cbranch_scc1 L_WO_go
  s_mov_b32 s28, 0
  s_waitcnt vmcnt(12)
  s_barrier
  s_cmp_lg_u32 s20, 0
  s_cbranch_scc1 Lnosig_39
  s_mov_b32 s63, s25
  s_atomic_smax s63, s[4:5], s62 glc
Lnosig_39:
L_WO_go:
  v_add_u32 v73, s26, v69
  v_add_u32 v74, s26, v70
  s_sub_u32 s26, 65536, s26
  s_add_u32 s27, s27, 2097152
  s_xor_b32 s27, s27, 0x2000
  s_add_u32 s29, s29, 1
  s_waitcnt vmcnt(8)
  s_barrier
  ds_read_b128 v[4:7], v73 offset:0
  ds_read_b128 v[8:11], v73 offset:1024
  ds_read_b128 v[12:15], v73 offset:2048
  ds_read_b128 v[16:19], v73 offset:3072
  ds_read_b128 v[20:23], v73 offset:4096
  ds_read_b128 v[24:27], v73 offset:5120
  s_waitcnt lgkmcnt(4)
  v_mfma_f32_16x16x32_bf16 v[36:39], a[0:3], v[4:7], 0
  ds_read_b128 v[28:31], v73 offset:6144
  v_mfma_f32_16x16x32_bf16 v[40:43], a[0:3], v[8:11], 0
  ds_read_b128 v[32:35], v73 offset:7168
  v_mfma_f32_16x16x32_bf16 v[44:47], a[128:131], v[4:7], 0
  s_add_u32 s36, s32, 49152
  s_add_u32 m0, s34, s36
  s_add_u32 s36, s35, 393216
  buffer_load_dwordx4 v1, s[4:7], s36 offen offset:0 sc1 lds
  v_mfma_f32_16x16x32_bf16 v[48:51], a[128:131], v[8:11], 0
  s_waitcnt lgkmcnt(4)
  v_mfma_f32_16x16x32_bf16 v[36:39], a[4:7], v[12:15], v[36:39]
  ds_read_b128 v[4:7], v73 offset:8192
  v_mfma_f32_16x16x32_bf16 v[40:43], a[4:7], v[16:19], v[40:43]
  ds_read_b128 v[8:11], v73 offset:9216
  v_mfma_f32_16x16x32_bf16 v[44:47], a[132:135], v[12:15], v[44:47]
  buffer_load_dwordx4 v1, s[4:7], s36 offen offset:1024 sc1 lds
  v_mfma_f32_16x16x32_bf16 v[48:51], a[132:135], v[16:19], v[48:51]
  s_waitcnt lgkmcnt(4)
  v_mfma_f32_16x16x32_bf16 v[36:39], a[8:11], v[20:23], v[36:39]
  ds_read_b128 v[12:15], v73 offset:10240
  v_mfma_f32_16x16x32_bf16 v[40:43], a[8:11], v[24:27], v[40:43]
  ds_read_b128 v[16:19], v73 offset:11264
  v_mfma_f32_16x16x32_bf16 v[44:47], a[136:139], v[20:23], v[44:47]
  buffer_load_dwordx4 v1, s[4:7], s36 offen offset:2048 sc1 lds
  v_mfma_f32_16x16x32_bf16 v[48:51], a[136:139], v[24:27], v[48:51]
  s_waitcnt lgkmcnt(4)
  v_mfma_f32_16x16x32_bf16 v[36:39], a[12:15], v[28:31], v[36:39]
  ds_read_b128 v[20:23], v73 offset:12288
  v_mfma_f32_16x16x32_bf16 v[40:43], a[12:15], v[32:35], v[40:43]
  ds_read_b128 v[24:27], v73 offset:13312
  v_mfma_f32_16x16x32_bf16 v[44:47], a[140:143], v[28:31], v[44:47]
  buffer_load_dwordx4 v1, s[4:7], s36 offen offset:3072 sc1 lds
  v_mfma_f32_16x16x32_bf16 v[48:51], a[140:143], v[32:35], v[48:51]
  s_waitcnt lgkmcnt(4)
  v_mfma_f32_16x16x32_bf16 v[36:39], a[16:19], v[4:7], v[36:39]
  ds_read_b128 v[28:31], v73 offset:14336
  v_mfma_f32_16x16x32_bf16 v[40:43], a[16:19], v[8:11], v[40:43]
  ds_read_b128 v[32:35], v73 offset:15360
  v_mfma_f32_16x16x32_bf16 v[44:47], a[144:147], v[4:7], v[44:47]
  v_mfma_f32_16x16x32_bf16 v[48:51], a[144:147], v[8:11], v[48:51]
  s_waitcnt vmcnt(8)
  s_barrier
  s_mov_b32 s34, s26
  s_mov_b32 s35, s27
  s_waitcnt lgkmcnt(4)
  v_mfma_f32_16x16x32_bf16 v[36:39], a[20:23], v[12:15], v[36:39]
  ds_read_b128 v[4:7], v73 offset:16384
  v_mfma_f32_16x16x32_bf16 v[40:43], a[20:23], v[16:19], v[40:43]
  ds_read_b128 v[8:11], v73 offset:17408
  v_mfma_f32_16x16x32_bf16 v[44:47], a[148:151], v[12:15], v[44:47]
  v_mfma_f32_16x16x32_bf16 v[48:51], a[148:151], v[16:19], v[48:51]
  s_waitcnt lgkmcnt(4)
  v_mfma_f32_16x16x32_bf16 v[36:39], a[24:27], v[20:23], v[36:39]
  ds_read_b128 v[12:15], v73 offset:18432
  v_mfma_f32_16x16x32_bf16 v[40:43], a[24:27], v[24:27], v[40:43]
  ds_read_b128 v[16:19], v73 offset:19456
  v_mfma_f32_16x16x32_bf16 v[44:47], a[152:155], v[20:23], v[44:47]
  v_mfma_f32_16x16x32_bf16 v[48:51], a[152:155], v[24:27], v[48:51]
  s_waitcnt lgkmcnt(4)
  v_mfma_f32_16x16x32_bf16 v[36:39], a[28:31], v[28:31], v[36:39]
  ds_read_b128 v[20:23], v73 offset:20480
  v_mfma_f32_16x16x32_bf16 v[40:43], a[28:31], v[32:35], v[40:43]
  ds_read_b128 v[24:27], v73 offset:21504
  v_mfma_f32_16x16x32_bf16 v[44:47], a[156:159], v[28:31], v[44:47]
  v_mfma_f32_16x16x32_bf16 v[48:51], a[156:159], v[32:35], v[48:51]
  s_waitcnt lgkmcnt(4)
  v_mfma_f32_16x16x32_bf16 v[36:39], a[32:35], v[4:7], v[36:39]
  ds_read_b128 v[28:31], v73 offset:22528
  v_mfma_f32_16x16x32_bf16 v[40:43], a[32:35], v[8:11], v[40:43]
  ds_read_b128 v[32:35], v73 offset:23552
  v_mfma_f32_16x16x32_bf16 v[44:47], a[160:163], v[4:7], v[44:47]
  v_mfma_f32_16x16x32_bf16 v[48:51], a[160:163], v[8:11], v[48:51]
  s_waitcnt lgkmcnt(4)
  v_mfma_f32_16x16x32_bf16 v[36:39], a[36:39], v[12:15], v[36:39]
  ds_read_b128 v[4:7], v73 offset:24576
  v_mfma_f32_16x16x32_bf16 v[40:43], a[36:39], v[16:19], v[40:43]
  ds_read_b128 v[8:11], v73 offset:25600
  v_mfma_f32_16x16x32_bf16 v[44:47], a[164:167], v[12:15], v[44:47]
  v_mfma_f32_16x16x32_bf16 v[48:51], a[164:167], v[16:19], v[48:51]
  s_waitcnt lgkmcnt(4)
  v_mfma_f32_16x16x32_bf16 v[36:39], a[40:43], v[20:23], v[36:39]
  ds_read_b128 v[12:15], v73 offset:26624
  v_mfma_f32_16x16x32_bf16 v[40:43], a[40:43], v[24:27], v[40:43]
  ds_read_b128 v[16:19], v73 offset:27648
  v_mfma_f32_16x16x32_bf16 v[44:47], a[168:171], v[20:23], v[44:47]
  v_mfma_f32_16x16x32_bf16 v[48:51], a[168:171], v[24:27], v[48:51]
  s_waitcnt lgkmcnt(4)
  v_mfma_f32_16x16x32_bf16 v[36:39], a[44:47], v[28:31], v[36:39]
  ds_read_b128 v[20:23], v73 offset:28672
  v_mfma_f32_16x16x32_bf16 v[40:43], a[44:47], v[32:35], v[40:43]
  ds_read_b128 v[24:27], v73 offset:29696
  v_mfma_f32_16x16x32_bf16 v[44:47], a[172:175], v[28:31], v[44:47]
  v_mfma_f32_16x16x32_bf16 v[48:51], a[172:175], v[32:35], v[48:51]
  s_lshl_b32 s40, s20, 8
  s_add_u32 m0, s40, 131072
  s_cmp_eq_u32 s20, 0
  s_cselect_b32 s40, s30, 2147483392
  buffer_load_dword v2, s[4:7], s40 offen sc1 lds
  s_waitcnt lgkmcnt(4)
  v_mfma_f32_16x16x32_bf16 v[36:39], a[48:51], v[4:7], v[36:39]
  ds_read_b128 v[28:31], v73 offset:30720
  v_mfma_f32_16x16x32_bf16 v[40:43], a[48:51], v[8:11], v[40:43]
  ds_read_b128 v[32:35], v73 offset:31744
  v_mfma_f32_16x16x32_bf16 v[44:47], a[176:179], v[4:7], v[44:47]
  v_mfma_f32_16x16x32_bf16 v[48:51], a[176:179], v[8:11], v[48:51]
  s_waitcnt vmcnt(5)
  s_barrier
  s_lshl_b32 s40, s20, 1
  s_add_u32 s40, s40, 1
  s_cmp_lg_u32 s40, s28
  s_cbranch_scc1 L_WO_s2
  s_mov_b32 s63, s25
  s_atomic_smax s63, s[4:5], s62 glc
Lnosig_40:
L_WO_s2:
  s_waitcnt lgkmcnt(4)
  v_mfma_f32_16x16x32_bf16 v[36:39], a[52:55], v[12:15], v[36:39]
  ds_read_b128 v[4:7], v73 offset:32768
  v_mfma_f32_16x16x32_bf16 v[40:43], a[52:55], v[16:19], v[40:43]
  ds_read_b128 v[8:11], v73 offset:33792
  v_mfma_f32_16x16x32_bf16 v[44:47], a[180:183], v[12:15], v[44:47]
  v_mfma_f32_16x16x32_bf16 v[48:51], a[180:183], v[16:19], v[48:51]
  s_waitcnt lgkmcnt(4)
  v_mfma_f32_16x16x32_bf16 v[36:39], a[56:59], v[20:23], v[36:39]
  ds_read_b128 v[12:15], v73 offset:34816
  v_mfma_f32_16x16x32_bf16 v[40:43], a[56:59], v[24:27], v[40:43]
  ds_read_b128 v[16:19], v73 offset:35840
  v_mfma_f32_16x16x32_bf16 v[44:47], a[184:187], v[20:23], v[44:47]
  v_mfma_f32_16x16x32_bf16 v[48:51], a[184:187], v[24:27], v[48:51]
  s_waitcnt lgkmcnt(4)
  v_mfma_f32_16x16x32_bf16 v[36:39], a[60:63], v[28:31], v[36:39]
  ds_read_b128 v[20:23], v73 offset:36864
  v_mfma_f32_16x16x32_bf16 v[40:43], a[60:63], v[32:35], v[40:43]
  ds_read_b128 v[24:27], v73 offset:37888
  v_mfma_f32_16x16x32_bf16 v[44:47], a[188:191], v[28:31], v[44:47]
  v_mfma_f32_16x16x32_bf16 v[48:51], a[188:191], v[32:35], v[48:51]
  s_waitcnt lgkmcnt(4)
  v_mfma_f32_16x16x32_bf16 v[36:39], a[64:67], v[4:7], v[36:39]
  ds_read_b128 v[28:31], v73 offset:38912
  v_mfma_f32_16x16x32_bf16 v[40:43], a[64:67], v[8:11], v[40:43]
  ds_read_b128 v[32:35], v73 offset:39936
  v_mfma_f32_16x16x32_bf16 v[44:47], a[192:195], v[4:7], v[44:47]
  v_mfma_f32_16x16x32_bf16 v[48:51], a[192:195], v[8:11], v[48:51]
  s_waitcnt lgkmcnt(4)
  v_mfma_f32_16x16x32_bf16 v[36:39], a[68:71], v[12:15], v[36:39]
  ds_read_b128 v[4:7], v73 offset:40960
  v_mfma_f32_16x16x32_bf16 v[40:43], a[68:71], v[16:19], v[40:43]
  ds_read_b128 v[8:11], v73 offset:41984
  v_mfma_f32_16x16x32_bf16 v[44:47], a[196:199], v[12:15], v[44:47]
  v_mfma_f32_16x16x32_bf16 v[48:51], a[196:199], v[16:19], v[48:51]
  s_waitcnt lgkmcnt(4)
  v_mfma_f32_16x16x32_bf16 v[36:39], a[72:75], v[20:23], v[36:39]
  ds_read_b128 v[12:15], v73 offset:43008
  v_mfma_f32_16x16x32_bf16 v[40:43], a[72:75], v[24:27], v[40:43]
  ds_read_b128 v[16:19], v73 offset:44032
  v_mfma_f32_16x16x32_bf16 v[44:47], a[200:203], v[20:23], v[44:47]
  v_mfma_f32_16x16x32_bf16 v[48:51], a[200:203], v[24:27], v[48:51]
  s_waitcnt vmcnt(0)
  s_barrier
  ds_read_b32 v3, v71
  s_waitcnt lgkmcnt(4)
  v_mfma_f32_16x16x32_bf16 v[36:39], a[76:79], v[28:31], v[36:39]
  ds_read_b128 v[20:23], v73 offset:45056
  v_mfma_f32_16x16x32_bf16 v[40:43], a[76:79], v[32:35], v[40:43]
  ds_read_b128 v[24:27], v73 offset:46080
  v_mfma_f32_16x16x32_bf16 v[44:47], a[204:207], v[28:31], v[44:47]
  v_mfma_f32_16x16x32_bf16 v[48:51], a[204:207], v[32:35], v[48:51]
  s_waitcnt lgkmcnt(4)
  v_mfma_f32_16x16x32_bf16 v[36:39], a[80:83], v[4:7], v[36:39]
  ds_read_b128 v[28:31], v73 offset:47104
  v_mfma_f32_16x16x32_bf16 v[40:43], a[80:83], v[8:11], v[40:43]
  ds_read_b128 v[32:35], v73 offset:48128
  v_mfma_f32_16x16x32_bf16 v[44:47], a[208:211], v[4:7], v[44:47]
  v_mfma_f32_16x16x32_bf16 v[48:51], a[208:211], v[8:11], v[48:51]
  s_waitcnt lgkmcnt(4)
  v_cmp_gt_i32 vcc, s29, v3
  s_mov_b32 s28, 0
  s_cbranch_vccnz L_WO_nopf
  s_cmp_ge_u32 s25, 63
  s_cbranch_scc1 L_WO_nopf
  s_mov_b32 s28, 1
  s_waitcnt lgkmcnt(4)
  v_mfma_f32_16x16x32_bf16 v[36:39], a[84:87], v[12:15], v[36:39]
  ds_read_b128 v[4:7], v73 offset:49152
  v_mfma_f32_16x16x32_bf16 v[40:43], a[84:87], v[16:19], v[40:43]
  ds_read_b128 v[8:11], v73 offset:50176
  v_mfma_f32_16x16x32_bf16 v[44:47], a[212:215], v[12:15], v[44:47]
  s_add_u32 s36, s32, 0
  s_add_u32 m0, s34, s36
  s_add_u32 s36, s35, 0
  buffer_load_dwordx4 v1, s[4:7], s36 offen offset:0 sc1 lds
  v_mfma_f32_16x16x32_bf16 v[48:51], a[212:215], v[16:19], v[48:51]
  buffer_load_dwordx4 v1, s[4:7], s36 offen offset:1024 sc1 lds
  s_waitcnt lgkmcnt(4)
  v_mfma_f32_16x16x32_bf16 v[36:39], a[88:91], v[20:23], v[36:39]
  ds_read_b128 v[12:15], v73 offset:51200
  v_mfma_f32_16x16x32_bf16 v[40:43], a[88:91], v[24:27], v[40:43]
  ds_read_b128 v[16:19], v73 offset:52224
  v_mfma_f32_16x16x32_bf16 v[44:47], a[216:219], v[20:23], v[44:47]
  buffer_load_dwordx4 v1, s[4:7], s36 offen offset:2048 sc1 lds
  v_mfma_f32_16x16x32_bf16 v[48:51], a[216:219], v[24:27], v[48:51]
  buffer_load_dwordx4 v1, s[4:7], s36 offen offset:3072 sc1 lds
  s_waitcnt lgkmcnt(4)
  v_mfma_f32_16x16x32_bf16 v[36:39], a[92:95], v[28:31], v[36:39]
  ds_read_b128 v[20:23], v73 offset:53248
  v_mfma_f32_16x16x32_bf16 v[40:43], a[92:95], v[32:35], v[40:43]
  ds_read_b128 v[24:27], v73 offset:54272
  v_mfma_f32_16x16x32_bf16 v[44:47], a[220:223], v[28:31], v[44:47]
  s_add_u32 s36, s32, 16384
  s_add_u32 m0, s34, s36
  s_add_u32 s36, s35, 131072
  buffer_load_dwordx4 v1, s[4:7], s36 offen offset:0 sc1 lds
  v_mfma_f32_16x16x32_bf16 v[48:51], a[220:223], v[32:35], v[48:51]
  buffer_load_dwordx4 v1, s[4:7], s36 offen offset:1024 sc1 lds
  s_waitcnt lgkmcnt(4)
  v_mfma_f32_16x16x32_bf16 v[36:39], a[96:99], v[4:7], v[36:39]
  ds_read_b128 v[28:31], v73 offset:55296
  v_mfma_f32_16x16x32_bf16 v[40:43], a[96:99], v[8:11], v[40:43]
  ds_read_b128 v[32:35], v73 offset:56320
  v_mfma_f32_16x16x32_bf16 v[44:47], a[224:227], v[4:7], v[44:47]
  buffer_load_dwordx4 v1, s[4:7], s36 offen offset:2048 sc1 lds
  v_mfma_f32_16x16x32_bf16 v[48:51], a[224:227], v[8:11], v[48:51]
  buffer_load_dwordx4 v1, s[4:7], s36 offen offset:3072 sc1 lds
  s_waitcnt lgkmcnt(4)
  v_mfma_f32_16x16x32_bf16 v[36:39], a[100:103], v[12:15], v[36:39]
  ds_read_b128 v[4:7], v73 offset:57344
  v_mfma_f32_16x16x32_bf16 v[40:43], a[100:103], v[16:19], v[40:43]
  ds_read_b128 v[8:11], v73 offset:58368
  v_mfma_f32_16x16x32_bf16 v[44:47], a[228:231], v[12:15], v[44:47]
  s_add_u32 s36, s32, 32768
  s_add_u32 m0, s34, s36
  s_add_u32 s36, s35, 262144
  buffer_load_dwordx4 v1, s[4:7], s36 offen offset:0 sc1 lds
  v_mfma_f32_16x16x32_bf16 v[48:51], a[228:231], v[16:19], v[48:51]
  buffer_load_dwordx4 v1, s[4:7], s36 offen offset:1024 sc1 lds
  s_waitcnt lgkmcnt(4)
  v_mfma_f32_16x16x32_bf16 v[36:39], a[104:107], v[20:23], v[36:39]
  ds_read_b128 v[12:15], v73 offset:59392
  v_mfma_f32_16x16x32_bf16 v[40:43], a[104:107], v[24:27], v[40:43]
  ds_read_b128 v[16:19], v73 offset:60416
  v_mfma_f32_16x16x32_bf16 v[44:47], a[232:235], v[20:23], v[44:47]
  buffer_load_dwordx4 v1, s[4:7], s36 offen offset:2048 sc1 lds
  v_mfma_f32_16x16x32_bf16 v[48:51], a[232:235], v[24:27], v[48:51]
  buffer_load_dwordx4 v1, s[4:7], s36 offen offset:3072 sc1 lds
  s_waitcnt lgkmcnt(4)
  v_mfma_f32_16x16x32_bf16 v[36:39], a[108:111], v[28:31], v[36:39]
  ds_read_b128 v[20:23], v73 offset:61440
  v_mfma_f32_16x16x32_bf16 v[40:43], a[108:111], v[32:35], v[40:43]
  ds_read_b128 v[24:27], v73 offset:62464
  v_mfma_f32_16x16x32_bf16 v[44:47], a[236:239], v[28:31], v[44:47]
  v_mfma_f32_16x16x32_bf16 v[48:51], a[236:239], v[32:35], v[48:51]
  s_waitcnt lgkmcnt(4)
  v_mfma_f32_16x16x32_bf16 v[36:39], a[112:115], v[4:7], v[36:39]
  ds_read_b128 v[28:31], v73 offset:63488
  v_mfma_f32_16x16x32_bf16 v[40:43], a[112:115], v[8:11], v[40:43]
  ds_read_b128 v[32:35], v73 offset:64512
  v_mfma_f32_16x16x32_bf16 v[44:47], a[240:243], v[4:7], v[44:47]
  v_mfma_f32_16x16x32_bf16 v[48:51], a[240:243], v[8:11], v[48:51]
  s_waitcnt lgkmcnt(4)
  v_mfma_f32_16x16x32_bf16 v[36:39], a[116:119], v[12:15], v[36:39]
  v_mfma_f32_16x16x32_bf16 v[40:43], a[116:119], v[16:19], v[40:43]
  v_mfma_f32_16x16x32_bf16 v[44:47], a[244:247], v[12:15], v[44:47]
  v_mfma_f32_16x16x32_bf16 v[48:51], a[244:247], v[16:19], v[48:51]
  s_waitcnt lgkmcnt(2)
  v_mfma_f32_16x16x32_bf16 v[36:39], a[120:123], v[20:23], v[36:39]
  v_mfma_f32_16x16x32_bf16 v[40:43], a[120:123], v[24:27], v[40:43]
  v_mfma_f32_16x16x32_bf16 v[44:47], a[248:251], v[20:23], v[44:47]
  v_mfma_f32_16x16x32_bf16 v[48:51], a[248:251], v[24:27], v[48:51]
  s_waitcnt lgkmcnt(0)
  v_mfma_f32_16x16x32_bf16 v[36:39], a[124:127], v[28:31], v[36:39]
  v_mfma_f32_16x16x32_bf16 v[40:43], a[124:127], v[32:35], v[40:43]
  v_mfma_f32_16x16x32_bf16 v[44:47], a[252:255], v[28:31], v[44:47]
  v_mfma_f32_16x16x32_bf16 v[48:51], a[252:255], v[32:35], v[48:51]
  s_nop 7
  s_branch L_WO_epi
L_WO_nopf:
  s_waitcnt lgkmcnt(4)
  v_mfma_f32_16x16x32_bf16 v[36:39], a[84:87], v[12:15], v[36:39]
  ds_read_b128 v[4:7], v73 offset:49152
  v_mfma_f32_16x16x32_bf16 v[40:43], a[84:87], v[16:19], v[40:43]
  ds_read_b128 v[8:11], v73 offset:50176
  v_mfma_f32_16x16x32_bf16 v[44:47], a[212:215], v[12:15], v[44:47]
  v_mfma_f32_16x16x32_bf16 v[48:51], a[212:215], v[16:19], v[48:51]
  s_waitcnt lgkmcnt(4)
  v_mfma_f32_16x16x32_bf16 v[36:39], a[88:91], v[20:23], v[36:39]
  ds_read_b128 v[12:15], v73 offset:51200
  v_mfma_f32_16x16x32_bf16 v[40:43], a[88:91], v[24:27], v[40:43]
  ds_read_b128 v[16:19], v73 offset:52224
  v_mfma_f32_16x16x32_bf16 v[44:47], a[216:219], v[20:23], v[44:47]
  v_mfma_f32_16x16x32_bf16 v[48:51], a[216:219], v[24:27], v[48:51]
  s_waitcnt lgkmcnt(4)
  v_mfma_f32_16x16x32_bf16 v[36:39], a[92:95], v[28:31], v[36:39]
  ds_read_b128 v[20:23], v73 offset:53248
  v_mfma_f32_16x16x32_bf16 v[40:43], a[92:95], v[32:35], v[40:43]
  ds_read_b128 v[24:27], v73 offset:54272
  v_mfma_f32_16x16x32_bf16 v[44:47], a[220:223], v[28:31], v[44:47]
  v_mfma_f32_16x16x32_bf16 v[48:51], a[220:223], v[32:35], v[48:51]
  s_barrier
  s_lshl_b32 s40, s20, 8
  s_add_u32 m0, s40, 131072
  s_cmp_eq_u32 s20, 0
  s_cselect_b32 s40, s30, 2147483392
  buffer_load_dword v2, s[4:7], s40 offen sc1 lds
  s_waitcnt lgkmcnt(4)
  v_mfma_f32_16x16x32_bf16 v[36:39], a[96:99], v[4:7], v[36:39]
  ds_read_b128 v[28:31], v73 offset:55296
  v_mfma_f32_16x16x32_bf16 v[40:43], a[96:99], v[8:11], v[40:43]
  ds_read_b128 v[32:35], v73 offset:56320
  v_mfma_f32_16x16x32_bf16 v[44:47], a[224:227], v[4:7], v[44:47]
  v_mfma_f32_16x16x32_bf16 v[48:51], a[224:227], v[8:11], v[48:51]
  s_waitcnt lgkmcnt(4)
  v_mfma_f32_16x16x32_bf16 v[36:39], a[100:103], v[12:15], v[36:39]
  ds_read_b128 v[4:7], v73 offset:57344
  v_mfma_f32_16x16x32_bf16 v[40:43], a[100:103], v[16:19], v[40:43]
  ds_read_b128 v[8:11], v73 offset:58368
  v_mfma_f32_16x16x32_bf16 v[44:47], a[228:231], v[12:15], v[44:47]
  v_mfma_f32_16x16x32_bf16 v[48:51], a[228:231], v[16:19], v[48:51]
  s_waitcnt lgkmcnt(4)
  v_mfma_f32_16x16x32_bf16 v[36:39], a[104:107], v[20:23], v[36:39]
  ds_read_b128 v[12:15], v73 offset:59392
  v_mfma_f32_16x16x32_bf16 v[40:43], a[104:107], v[24:27], v[40:43]
  ds_read_b128 v[16:19], v73 offset:60416
  v_mfma_f32_16x16x32_bf16 v[44:47], a[232:235], v[20:23], v[44:47]
  v_mfma_f32_16x16x32_bf16 v[48:51], a[232:235], v[24:27], v[48:51]
  s_waitcnt lgkmcnt(4)
  v_mfma_f32_16x16x32_bf16 v[36:39], a[108:111], v[28:31], v[36:39]
  ds_read_b128 v[20:23], v73 offset:61440
  v_mfma_f32_16x16x32_bf16 v[40:43], a[108:111], v[32:35], v[40:43]
  ds_read_b128 v[24:27], v73 offset:62464
  v_mfma_f32_16x16x32_bf16 v[44:47], a[236:239], v[28:31], v[44:47]
  v_mfma_f32_16x16x32_bf16 v[48:51], a[236:239], v[32:35], v[48:51]
  s_waitcnt lgkmcnt(4)
  v_mfma_f32_16x16x32_bf16 v[36:39], a[112:115], v[4:7], v[36:39]
  ds_read_b128 v[28:31], v73 offset:63488
  v_mfma_f32_16x16x32_bf16 v[40:43], a[112:115], v[8:11], v[40:43]
  ds_read_b128 v[32:35], v73 offset:64512
  v_mfma_f32_16x16x32_bf16 v[44:47], a[240:243], v[4:7], v[44:47]
  v_mfma_f32_16x16x32_bf16 v[48:51], a[240:243], v[8:11], v[48:51]
  s_waitcnt lgkmcnt(4)
  v_mfma_f32_16x16x32_bf16 v[36:39], a[116:119], v[12:15], v[36:39]
  v_mfma_f32_16x16x32_bf16 v[40:43], a[116:119], v[16:19], v[40:43]
  v_mfma_f32_16x16x32_bf16 v[44:47], a[244:247], v[12:15], v[44:47]
  v_mfma_f32_16x16x32_bf16 v[48:51], a[244:247], v[16:19], v[48:51]
  s_waitcnt vmcnt(0)
  s_barrier
  ds_read_b32 v3, v71
  s_waitcnt lgkmcnt(2)
  v_mfma_f32_16x16x32_bf16 v[36:39], a[120:123], v[20:23], v[36:39]
  v_mfma_f32_16x16x32_bf16 v[40:43], a[120:123], v[24:27], v[40:43]
  v_mfma_f32_16x16x32_bf16 v[44:47], a[248:251], v[20:23], v[44:47]
  v_mfma_f32_16x16x32_bf16 v[48:51], a[248:251], v[24:27], v[48:51]
  s_waitcnt lgkmcnt(0)
  v_mfma_f32_16x16x32_bf16 v[36:39], a[124:127], v[28:31], v[36:39]
  v_mfma_f32_16x16x32_bf16 v[40:43], a[124:127], v[32:35], v[40:43]
  v_mfma_f32_16x16x32_bf16 v[44:47], a[252:255], v[28:31], v[44:47]
  v_mfma_f32_16x16x32_bf16 v[48:51], a[252:255], v[32:35], v[48:51]
  v_cmp_gt_i32 vcc, s29, v3
  s_cmp_eq_u64 vcc, 0
  s_cselect_b32 s28, 2, 0
  s_cmp_lt_u32 s25, 63
  s_cselect_b32 s28, s28, 0
L_WO_epi:
  v_cvt_pk_bf16_f32 v52, v36, v37
  v_cvt_pk_bf16_f32 v53, v38, v39
  v_cvt_pk_bf16_f32 v54, v44, v45
  v_cvt_pk_bf16_f32 v55, v46, v47
  buffer_store_dwordx4 v[52:55], v68, s[4:7], s31 offen offset:0 sc1
  v_cvt_pk_bf16_f32 v56, v40, v41
  v_cvt_pk_bf16_f32 v57, v42, v43
  v_cvt_pk_bf16_f32 v58, v48, v49
  v_cvt_pk_bf16_f32 v59, v50, v51
  buffer_store_dwordx4 v[56:59], v68, s[4:7], s31 offen offset:1024 sc1
  s_add_u32 s25, s25, 1
  s_add_u32 s31, s31, 2097152
  s_xor_b32 s31, s31, 0x2000
  s_branch L_WO_top
L_F1:
  v_lshlrev_b32 v1, 4, v0
  s_lshl_b32 s32, s20, 12
  s_min_u32 s33, s32, 0x2000
  v_mov_b32 v69, v1
  v_add_u32 v70, 0x10000, v69
  v_and_b32 v1, 3, v0
  v_lshlrev_b32 v1, 4, v1
  v_lshrrev_b32 v52, 4, v0
  v_lshl_add_u32 v1, v52, 6, v1
  v_bfe_u32 v52, v0, 2, 2
  v_lshl_add_u32 v1, v52, 8, v1
  s_load_dwordx2 s[8:9], s[0:1], 64
  s_mov_b32 s10, 7340032
  s_mov_b32 s11, 0x20000
  s_waitcnt lgkmcnt(0)
  s_lshl_b32 s44, s21, 7
  v_bfe_u32 v4, v0, 5, 1
  v_mul_u32_u24 v4, 28672, v4
  v_bfe_u32 v5, v0, 4, 1
  v_mul_u32_u24 v5, 14336, v5
  v_add_u32 v4, v4, v5
  v_bfe_u32 v5, v0, 3, 1
  v_mul_u32_u24 v5, 7168, v5
  v_add_u32 v4, v4, v5
  v_lshrrev_b32 v5, 3, v0
  v_and_b32 v5, 6, v5
  v_xor_b32 v5, v5, v0
  v_and_b32 v5, 7, v5
  v_lshl_add_u32 v4, v5, 4, v4
  s_lshr_b32 s40, s20, 1
  s_mul_i32 s40, s40, 458752
  s_and_b32 s41, s20, 1
  s_mul_i32 s41, s41, 57344
  s_add_u32 s40, s40, s41
  v_add_u32 v4, s40, v4
  v_bfe_u32 v5, v0, 3, 2
  v_xor_b32 v5, s20, v5
  v_lshlrev_b32 v5, 5, v5
  v_lshrrev_b32 v6, 2, v0
  v_lshl_add_u32 v6, v6, 7, v5
  v_and_b32 v5, 3, v0
  v_lshl_add_u32 v6, v5, 3, v6
  v_add_u32 v7, 0x10000, v6
  v_add_u32 v8, s44, v4
  v_add_u32 v9, s44, v4
  s_lshl_b32 s41, s20, 10
  s_add_u32 m0, s41, 0
  s_mov_b32 s42, 0
  buffer_load_dwordx4 v8, s[8:11], s42 offen nt lds
  s_add_u32 m0, s41, 4096
  s_mov_b32 s42, 114688
  buffer_load_dwordx4 v8, s[8:11], s42 offen nt lds
  s_add_u32 m0, s41, 8192
  s_mov_b32 s42, 229376
  buffer_load_dwordx4 v8, s[8:11], s42 offen nt lds
  s_add_u32 m0, s41, 12288
  s_mov_b32 s42, 344064
  buffer_load_dwordx4 v8, s[8:11], s42 offen nt lds
  s_add_u32 m0, s41, 16384
  s_mov_b32 s42, 917504
  buffer_load_dwordx4 v8, s[8:11], s42 offen nt lds
  s_add_u32 m0, s41, 20480
  s_mov_b32 s42, 1032192
  buffer_load_dwordx4 v8, s[8:11], s42 offen nt lds
  s_add_u32 m0, s41, 24576
  s_mov_b32 s42, 1146880
  buffer_load_dwordx4 v8, s[8:11], s42 offen nt lds
  s_add_u32 m0, s41, 28672
  s_mov_b32 s42, 1261568
  buffer_load_dwordx4 v8, s[8:11], s42 offen nt lds
  s_add_u32 m0, s41, 32768
  s_mov_b32 s42, 1835008
  buffer_load_dwordx4 v8, s[8:11], s42 offen nt lds
  s_add_u32 m0, s41, 36864
  s_mov_b32 s42, 1949696
  buffer_load_dwordx4 v8, s[8:11], s42 offen nt lds
  s_add_u32 m0, s41, 40960
  s_mov_b32 s42, 2064384
  buffer_load_dwordx4 v8, s[8:11], s42 offen nt lds
  s_add_u32 m0, s41, 45056
  s_mov_b32 s42, 2179072
  buffer_load_dwordx4 v8, s[8:11], s42 offen nt lds
  s_add_u32 m0, s41, 49152
  s_mov_b32 s42, 2752512
  buffer_load_dwordx4 v8, s[8:11], s42 offen nt lds
  s_add_u32 m0, s41, 53248
  s_mov_b32 s42, 2867200
  buffer_load_dwordx4 v8, s[8:11], s42 offen nt lds
  s_add_u32 m0, s41, 57344
  s_mov_b32 s42, 2981888
  buffer_load_dwordx4 v8, s[8:11], s42 offen nt lds
  s_add_u32 m0, s41, 61440
  s_mov_b32 s42, 3096576
  buffer_load_dwordx4 v8, s[8:11], s42 offen nt lds
  s_add_u32 m0, s41, 65536
  s_mov_b32 s42, 3670016
  buffer_load_dwordx4 v8, s[8:11], s42 offen nt lds
  s_add_u32 m0, s41, 69632
  s_mov_b32 s42, 3784704
  buffer_load_dwordx4 v8, s[8:11], s42 offen nt lds
  s_add_u32 m0, s41, 73728
  s_mov_b32 s42, 3899392
  buffer_load_dwordx4 v8, s[8:11], s42 offen nt lds
  s_add_u32 m0, s41, 77824
  s_mov_b32 s42, 4014080
  buffer_load_dwordx4 v8, s[8:11], s42 offen nt lds
  s_add_u32 m0, s41, 81920
  s_mov_b32 s42, 4587520
  buffer_load_dwordx4 v8, s[8:11], s42 offen nt lds
  s_add_u32 m0, s41, 86016
  s_mov_b32 s42, 4702208
  buffer_load_dwordx4 v8, s[8:11], s42 offen nt lds
  s_add_u32 m0, s41, 90112
  s_mov_b32 s42, 4816896
  buffer_load_dwordx4 v8, s[8:11], s42 offen nt lds
  s_add_u32 m0, s41, 94208
  s_mov_b32 s42, 4931584
  buffer_load_dwordx4 v8, s[8:11], s42 offen nt lds
  s_add_u32 m0, s41, 98304
  s_mov_b32 s42, 5505024
  buffer_load_dwordx4 v8, s[8:11], s42 offen nt lds
  s_add_u32 m0, s41, 102400
  s_mov_b32 s42, 5619712
  buffer_load_dwordx4 v8, s[8:11], s42 offen nt lds
  s_add_u32 m0, s41, 106496
  s_mov_b32 s42, 5734400
  buffer_load_dwordx4 v8, s[8:11], s42 offen nt lds
  s_add_u32 m0, s41, 110592
  s_mov_b32 s42, 5849088
  buffer_load_dwordx4 v8, s[8:11], s42 offen nt lds
  s_waitcnt vmcnt(24) lgkmcnt(0)
  s_barrier
  s_add_u32 m0, s41, 114688
  s_mov_b32 s42, 6422528
  buffer_load_dwordx4 v8, s[8:11], s42 offen nt lds
  s_add_u32 m0, s41, 118784
  s_mov_b32 s42, 6537216
  buffer_load_dwordx4 v8, s[8:11], s42 offen nt lds
  s_add_u32 m0, s41, 122880
  s_mov_b32 s42, 6651904
  buffer_load_dwordx4 v8, s[8:11], s42 offen nt lds
  s_add_u32 m0, s41, 126976
  s_mov_b32 s42, 6766592
  buffer_load_dwordx4 v8, s[8:11], s42 offen nt lds
  ds_read_b64_tr_b16 a[0:1], v6 offset:0
  ds_read_b64_tr_b16 a[2:3], v6 offset:2048
  ds_read_b64_tr_b16 a[4:5], v6 offset:4096
  ds_read_b64_tr_b16 a[6:7], v6 offset:6144
  ds_read_b64_tr_b16 a[8:9], v6 offset:8192
  ds_read_b64_tr_b16 a[10:11], v6 offset:10240
  ds_read_b64_tr_b16 a[12:13], v6 offset:12288
  ds_read_b64_tr_b16 a[14:15], v6 offset:14336
  s_waitcnt vmcnt(24) lgkmcnt(0)
  s_barrier
  s_load_dwordx2 s[8:9], s[0:1], 72
  s_mov_b32 s10, 7340032
  s_mov_b32 s11, 0x20000
  s_waitcnt lgkmcnt(0)
  s_add_u32 m0, s41, 0
  s_mov_b32 s42, 0
  buffer_load_dwordx4 v9, s[8:11], s42 offen nt lds
  s_add_u32 m0, s41, 4096
  s_mov_b32 s42, 114688
  buffer_load_dwordx4 v9, s[8:11], s42 offen nt lds
  s_add_u32 m0, s41, 8192
  s_mov_b32 s42, 229376
  buffer_load_dwordx4 v9, s[8:11], s42 offen nt lds
  s_add_u32 m0, s41, 12288
  s_mov_b32 s42, 344064
  buffer_load_dwordx4 v9, s[8:11], s42 offen nt lds
  ds_read_b64_tr_b16 a[16:17], v6 offset:16384
  ds_read_b64_tr_b16 a[18:19], v6 offset:18432
  ds_read_b64_tr_b16 a[20:21], v6 offset:20480
  ds_read_b64_tr_b16 a[22:23], v6 offset:22528
  ds_read_b64_tr_b16 a[24:25], v6 offset:24576
  ds_read_b64_tr_b16 a[26:27], v6 offset:26624
  ds_read_b64_tr_b16 a[28:29], v6 offset:28672
  ds_read_b64_tr_b16 a[30:31], v6 offset:30720
  s_waitcnt vmcnt(24) lgkmcnt(0)
  s_barrier
  s_add_u32 m0, s41, 16384
  s_mov_b32 s42, 917504
  buffer_load_dwordx4 v9, s[8:11], s42 offen nt lds
  s_add_u32 m0, s41, 20480
  s_mov_b32 s42, 1032192
  buffer_load_dwordx4 v9, s[8:11], s42 offen nt lds
  s_add_u32 m0, s41, 24576
  s_mov_b32 s42, 1146880
  buffer_load_dwordx4 v9, s[8:11], s42 offen nt lds
  s_add_u32 m0, s41, 28672
  s_mov_b32 s42, 1261568
  buffer_load_dwordx4 v9, s[8:11], s42 offen nt lds
  ds_read_b64_tr_b16 a[32:33], v6 offset:32768
  ds_read_b64_tr_b16 a[34:35], v6 offset:34816
  ds_read_b64_tr_b16 a[36:37], v6 offset:36864
  ds_read_b64_tr_b16 a[38:39], v6 offset:38912
  ds_read_b64_tr_b16 a[40:41], v6 offset:40960
  ds_read_b64_tr_b16 a[42:43], v6 offset:43008
  ds_read_b64_tr_b16 a[44:45], v6 offset:45056
  ds_read_b64_tr_b16 a[46:47], v6 offset:47104
  s_waitcnt vmcnt(24) lgkmcnt(0)
  s_barrier
  s_add_u32 m0, s41, 32768
  s_mov_b32 s42, 1835008
  buffer_load_dwordx4 v9, s[8:11], s42 offen nt lds
  s_add_u32 m0, s41, 36864
  s_mov_b32 s42, 1949696
  buffer_load_dwordx4 v9, s[8:11], s42 offen nt lds
  s_add_u32 m0, s41, 40960
  s_mov_b32 s42, 2064384
  buffer_load_dwordx4 v9, s[8:11], s42 offen nt lds
  s_add_u32 m0, s41, 45056
  s_mov_b32 s42, 2179072
  buffer_load_dwordx4 v9, s[8:11], s42 offen nt lds
  ds_read_b64_tr_b16 a[48:49], v6 offset:49152
  ds_read_b64_tr_b16 a[50:51], v6 offset:51200
  ds_read_b64_tr_b16 a[52:53], v6 offset:53248
  ds_read_b64_tr_b16 a[54:55], v6 offset:55296
  ds_read_b64_tr_b16 a[56:57], v6 offset:57344
  ds_read_b64_tr_b16 a[58:59], v6 offset:59392
  ds_read_b64_tr_b16 a[60:61], v6 offset:61440
  ds_read_b64_tr_b16 a[62:63], v6 offset:63488
  s_waitcnt vmcnt(24) lgkmcnt(0)
  s_barrier
  s_add_u32 m0, s41, 49152
  s_mov_b32 s42, 2752512
  buffer_load_dwordx4 v9, s[8:11], s42 offen nt lds
  s_add_u32 m0, s41, 53248
  s_mov_b32 s42, 2867200
  buffer_load_dwordx4 v9, s[8:11], s42 offen nt lds
  s_add_u32 m0, s41, 57344
  s_mov_b32 s42, 2981888
  buffer_load_dwordx4 v9, s[8:11], s42 offen nt lds
  s_add_u32 m0, s41, 61440
  s_mov_b32 s42, 3096576
  buffer_load_dwordx4 v9, s[8:11], s42 offen nt lds
  ds_read_b64_tr_b16 a[64:65], v7 offset:0
  ds_read_b64_tr_b16 a[66:67], v7 offset:2048
  ds_read_b64_tr_b16 a[68:69], v7 offset:4096
  ds_read_b64_tr_b16 a[70:71], v7 offset:6144
  ds_read_b64_tr_b16 a[72:73], v7 offset:8192
  ds_read_b64_tr_b16 a[74:75], v7 offset:10240
  ds_read_b64_tr_b16 a[76:77], v7 offset:12288
  ds_read_b64_tr_b16 a[78:79], v7 offset:14336
  s_waitcnt vmcnt(24) lgkmcnt(0)
  s_barrier
  s_add_u32 m0, s41, 65536
  s_mov_b32 s42, 3670016
  buffer_load_dwordx4 v9, s[8:11], s42 offen nt lds
  s_add_u32 m0, s41, 69632
  s_mov_b32 s42, 3784704
  buffer_load_dwordx4 v9, s[8:11], s42 offen nt lds
  s_add_u32 m0, s41, 73728
  s_mov_b32 s42, 3899392
  buffer_load_dwordx4 v9, s[8:11], s42 offen nt lds
  s_add_u32 m0, s41, 77824
  s_mov_b32 s42, 4014080
  buffer_load_dwordx4 v9, s[8:11], s42 offen nt lds
  ds_read_b64_tr_b16 a[80:81], v7 offset:16384
  ds_read_b64_tr_b16 a[82:83], v7 offset:18432
  ds_read_b64_tr_b16 a[84:85], v7 offset:20480
  ds_read_b64_tr_b16 a[86:87], v7 offset:22528
  ds_read_b64_tr_b16 a[88:89], v7 offset:24576
  ds_read_b64_tr_b16 a[90:91], v7 offset:26624
  ds_read_b64_tr_b16 a[92:93], v7 offset:28672
  ds_read_b64_tr_b16 a[94:95], v7 offset:30720
  s_waitcnt vmcnt(24) lgkmcnt(0)
  s_barrier
  s_add_u32 m0, s41, 81920
  s_mov_b32 s42, 4587520
  buffer_load_dwordx4 v9, s[8:11], s42 offen nt lds
  s_add_u32 m0, s41, 86016
  s_mov_b32 s42, 4702208
  buffer_load_dwordx4 v9, s[8:11], s42 offen nt lds
  s_add_u32 m0, s41, 90112
  s_mov_b32 s42, 4816896
  buffer_load_dwordx4 v9, s[8:11], s42 offen nt lds
  s_add_u32 m0, s41, 94208
  s_mov_b32 s42, 4931584
  buffer_load_dwordx4 v9, s[8:11], s42 offen nt lds
  ds_read_b64_tr_b16 a[96:97], v7 offset:32768
  ds_read_b64_tr_b16 a[98:99], v7 offset:34816
  ds_read_b64_tr_b16 a[100:101], v7 offset:36864
  ds_read_b64_tr_b16 a[102:103], v7 offset:38912
  ds_read_b64_tr_b16 a[104:105], v7 offset:40960
  ds_read_b64_tr_b16 a[106:107], v7 offset:43008
  ds_read_b64_tr_b16 a[108:109], v7 offset:45056
  ds_read_b64_tr_b16 a[110:111], v7 offset:47104
  s_waitcnt vmcnt(24) lgkmcnt(0)
  s_barrier
  s_add_u32 m0, s41, 98304
  s_mov_b32 s42, 5505024
  buffer_load_dwordx4 v9, s[8:11], s42 offen nt lds
  s_add_u32 m0, s41, 102400
  s_mov_b32 s42, 5619712
  buffer_load_dwordx4 v9, s[8:11], s42 offen nt lds
  s_add_u32 m0, s41, 106496
  s_mov_b32 s42, 5734400
  buffer_load_dwordx4 v9, s[8:11], s42 offen nt lds
  s_add_u32 m0, s41, 110592
  s_mov_b32 s42, 5849088
  buffer_load_dwordx4 v9, s[8:11], s42 offen nt lds
  ds_read_b64_tr_b16 a[112:113], v7 offset:49152
  ds_read_b64_tr_b16 a[114:115], v7 offset:51200
  ds_read_b64_tr_b16 a[116:117], v7 offset:53248
  ds_read_b64_tr_b16 a[118:119], v7 offset:55296
  ds_read_b64_tr_b16 a[120:121], v7 offset:57344
  ds_read_b64_tr_b16 a[122:123], v7 offset:59392
  ds_read_b64_tr_b16 a[124:125], v7 offset:61440
  ds_read_b64_tr_b16 a[126:127], v7 offset:63488
  s_waitcnt vmcnt(24) lgkmcnt(0)
  s_barrier
  s_add_u32 m0, s41, 114688
  s_mov_b32 s42, 6422528
  buffer_load_dwordx4 v9, s[8:11], s42 offen nt lds
  s_add_u32 m0, s41, 118784
  s_mov_b32 s42, 6537216
  buffer_load_dwordx4 v9, s[8:11], s42 offen nt lds
  s_add_u32 m0, s41, 122880
  s_mov_b32 s42, 6651904
  buffer_load_dwordx4 v9, s[8:11], s42 offen nt lds
  s_add_u32 m0, s41, 126976
  s_mov_b32 s42, 6766592
  buffer_load_dwordx4 v9, s[8:11], s42 offen nt lds
  ds_read_b64_tr_b16 a[128:129], v6 offset:0
  ds_read_b64_tr_b16 a[130:131], v6 offset:2048
  ds_read_b64_tr_b16 a[132:133], v6 offset:4096
  ds_read_b64_tr_b16 a[134:135], v6 offset:6144
  ds_read_b64_tr_b16 a[136:137], v6 offset:8192
  ds_read_b64_tr_b16 a[138:139], v6 offset:10240
  ds_read_b64_tr_b16 a[140:141], v6 offset:12288
  ds_read_b64_tr_b16 a[142:143], v6 offset:14336
  s_waitcnt vmcnt(24) lgkmcnt(0)
  s_barrier
  ds_read_b64_tr_b16 a[144:145], v6 offset:16384
  ds_read_b64_tr_b16 a[146:147], v6 offset:18432
  ds_read_b64_tr_b16 a[148:149], v6 offset:20480
  ds_read_b64_tr_b16 a[150:151], v6 offset:22528
  ds_read_b64_tr_b16 a[152:153], v6 offset:24576
  ds_read_b64_tr_b16 a[154:155], v6 offset:26624
  ds_read_b64_tr_b16 a[156:157], v6 offset:28672
  ds_read_b64_tr_b16 a[158:159], v6 offset:30720
  s_waitcnt vmcnt(20) lgkmcnt(0)
  s_barrier
  ds_read_b64_tr_b16 a[160:161], v6 offset:32768
  ds_read_b64_tr_b16 a[162:163], v6 offset:34816
  ds_read_b64_tr_b16 a[164:165], v6 offset:36864
  ds_read_b64_tr_b16 a[166:167], v6 offset:38912
  ds_read_b64_tr_b16 a[168:169], v6 offset:40960
  ds_read_b64_tr_b16 a[170:171], v6 offset:43008
  ds_read_b64_tr_b16 a[172:173], v6 offset:45056
  ds_read_b64_tr_b16 a[174:175], v6 offset:47104
  s_waitcnt vmcnt(16) lgkmcnt(0)
  s_barrier
  ds_read_b64_tr_b16 a[176:177], v6 offset:49152
  ds_read_b64_tr_b16 a[178:179], v6 offset:51200
  ds_read_b64_tr_b16 a[180:181], v6 offset:53248
  ds_read_b64_tr_b16 a[182:183], v6 offset:55296
  ds_read_b64_tr_b16 a[184:185], v6 offset:57344
  ds_read_b64_tr_b16 a[186:187], v6 offset:59392
  ds_read_b64_tr_b16 a[188:189], v6 offset:61440
  ds_read_b64_tr_b16 a[190:191], v6 offset:63488
  s_waitcnt vmcnt(12) lgkmcnt(0)
  s_barrier
  ds_read_b64_tr_b16 a[192:193], v7 offset:0
  ds_read_b64_tr_b16 a[194:195], v7 offset:2048
  ds_read_b64_tr_b16 a[196:197], v7 offset:4096
  ds_read_b64_tr_b16 a[198:199], v7 offset:6144
  ds_read_b64_tr_b16 a[200:201], v7 offset:8192
  ds_read_b64_tr_b16 a[202:203], v7 offset:10240
  ds_read_b64_tr_b16 a[204:205], v7 offset:12288
  ds_read_b64_tr_b16 a[206:207], v7 offset:14336
  s_waitcnt vmcnt(8) lgkmcnt(0)
  s_barrier
  ds_read_b64_tr_b16 a[208:209], v7 offset:16384
  ds_read_b64_tr_b16 a[210:211], v7 offset:18432
  ds_read_b64_tr_b16 a[212:213], v7 offset:20480
  ds_read_b64_tr_b16 a[214:215], v7 offset:22528
  ds_read_b64_tr_b16 a[216:217], v7 offset:24576
  ds_read_b64_tr_b16 a[218:219], v7 offset:26624
  ds_read_b64_tr_b16 a[220:221], v7 offset:28672
  ds_read_b64_tr_b16 a[222:223], v7 offset:30720
  s_waitcnt vmcnt(4) lgkmcnt(0)
  s_barrier
  ds_read_b64_tr_b16 a[224:225], v7 offset:32768
  ds_read_b64_tr_b16 a[226:227], v7 offset:34816
  ds_read_b64_tr_b16 a[228:229], v7 offset:36864
  ds_read_b64_tr_b16 a[230:231], v7 offset:38912
  ds_read_b64_tr_b16 a[232:233], v7 offset:40960
  ds_read_b64_tr_b16 a[234:235], v7 offset:43008
  ds_read_b64_tr_b16 a[236:237], v7 offset:45056
  ds_read_b64_tr_b16 a[238:239], v7 offset:47104
  s_waitcnt vmcnt(0) lgkmcnt(0)
  s_barrier
  ds_read_b64_tr_b16 a[240:241], v7 offset:49152
  ds_read_b64_tr_b16 a[242:243], v7 offset:51200
  ds_read_b64_tr_b16 a[244:245], v7 offset:53248
  ds_read_b64_tr_b16 a[246:247], v7 offset:55296
  ds_read_b64_tr_b16 a[248:249], v7 offset:57344
  ds_read_b64_tr_b16 a[250:251], v7 offset:59392
  ds_read_b64_tr_b16 a[252:253], v7 offset:61440
  ds_read_b64_tr_b16 a[254:255], v7 offset:63488
  s_waitcnt lgkmcnt(0)
  s_barrier
  v_min_u32 v2, 7, v0
  v_lshlrev_b32 v2, 7, v2
  v_add_u32 v2, 1413120, v2
  s_lshl_b32 s62, s21, 7
  s_add_u32 s62, s62, 1414144
  v_min_u32 v52, 63, v0
  v_lshlrev_b32 v52, 7, v52
  v_add_u32 v52, 1424384, v52
  s_nop 1
Lpoll_41:
  buffer_load_dword v53, v52, s[4:7], 0 offen sc1
  s_sub_u32 s24, s24, 1
  s_cbranch_scc1 L_FAIL
  s_waitcnt vmcnt(0)
  v_cmp_gt_i32 vcc, 0, v53
  s_cbranch_vccz Lpolld_42
  s_sleep 1
  s_branch Lpoll_41
Lpolld_42:
  v_lshrrev_b32 v53, 8, v53
  v_and_b32 v54, 3, v0
  v_lshl_or_b32 v53, v53, 2, v54
  s_nop 1
  v_min_u32_dpp v53, v53, v53 row_ror:8 row_mask:0xf bank_mask:0xf
  s_nop 1
  v_min_u32_dpp v53, v53, v53 row_ror:4 row_mask:0xf bank_mask:0xf
  v_mov_b32 v54, v53
  s_nop 1
  v_permlane16_swap_b32 v54, v53
  v_min_u32 v53, v53, v54
  v_mov_b32 v54, v53
  s_nop 1
  v_permlane32_swap_b32 v54, v53
  v_min_u32 v53, v53, v54
  s_nop 1
  v_min_u32_dpp v53, v53, v53 row_ror:2 row_mask:0xf bank_mask:0xf
  s_nop 1
  v_min_u32_dpp v53, v53, v53 row_ror:1 row_mask:0xf bank_mask:0xf
  s_nop 0
  v_readfirstlane_b32 s38, v53
  s_and_b32 s38, s38, 3
  s_lshl_b32 s38, s38, 13
  s_and_b32 s38, s38, 0x2000
  s_xor_b32 s38, s38, 20979712
  s_lshr_b32 s40, s20, 1
  s_lshl_b32 s40, s40, 14
  s_and_b32 s41, s20, 1
  s_lshl_b32 s41, s41, 12
  s_add_u32 s27, s40, s41
  s_lshr_b32 s40, s21, 1
  s_lshl_b32 s40, s40, 14
  s_and_b32 s41, s21, 1
  s_lshl_b32 s41, s41, 12
  s_add_u32 s31, s40, s41
  s_add_u32 s27, s27, s38
  s_add_u32 s27, s27, 917504
  s_add_u32 s31, s31, s38
  s_add_u32 s31, s31, 1179648
  s_lshr_b32 s40, s20, 1
  s_lshl_b32 s40, s40, 11
  s_and_b32 s41, s20, 1
  s_lshl_b32 s41, s41, 9
  s_add_u32 s40, s40, s41
  v_and_b32 v52, 31, v0
  v_lshl_add_u32 v68, v52, 4, s40
  v_lshrrev_b32 v52, 5, v0
  v_lshl_add_u32 v68, v52, 10, v68
  s_mov_b32 s37, 0xbfb8aa3b
  v_lshlrev_b32 v71, 2, v0
  v_add_u32 v71, 131072, v71
  s_mov_b32 s25, 0
  s_mov_b32 s26, 0
  s_mov_b32 s29, 1
  s_mov_b32 s30, 0
  s_mov_b32 s28, 0
L_F1_top:
  s_cmp_eq_u32 s28, 1
  s_cbranch_scc1 L_F1_go
  s_cmp_eq_u32 s28, 2
  s_cbranch_scc1 L_F1_mid
  s_cmp_lg_u32 s20, 0
  s_cbranch_scc1 L_F1_park
  buffer_load_dword v3, v2, s[4:7], s30 offen sc1
  s_waitcnt vmcnt(1)
  s_barrier
  s_mov_b32 s63, s25
  s_atomic_smax s63, s[4:5], s62 glc
Lnosig_43:
  s_cmp_ge_u32 s25, 64
  s_cbranch_scc1 L_END
  s_waitcnt vmcnt(0)
  v_cmp_gt_i32 vcc, s29, v3
  s_cbranch_vccz L_F1_issue
  s_nop 3
Lpoll_44:
  buffer_load_dword v3, v2, s[4:7], s30 offen sc1
  s_sub_u32 s24, s24, 1
  s_cbranch_scc1 L_FAIL
  s_waitcnt vmcnt(0)
  v_cmp_gt_i32 vcc, s29, v3
  s_cbranch_vccz Lpolld_45
  s_sleep 1
  s_branch Lpoll_44
Lpolld_45:
  s_branch L_F1_issue
L_F1_park:
  s_waitcnt vmcnt(0)
  s_barrier
  s_cmp_ge_u32 s25, 64
  s_cbranch_scc1 L_END
L_F1_issue:
  s_barrier
L_F1_mid:
  s_mov_b32 s34, s26
  s_mov_b32 s35, s27
  s_add_u32 s36, s32, 0
  s_add_u32 m0, s34, s36
  s_add_u32 s36, s35, 0
  buffer_load_dwordx4 v1, s[4:7], s36 offen offset:0 sc1 lds
  s_nop 0
  buffer_load_dwordx4 v1, s[4:7], s36 offen offset:1024 sc1 lds
  s_nop 0
  buffer_load_dwordx4 v1, s[4:7], s36 offen offset:2048 sc1 lds
  s_nop 0
  buffer_load_dwordx4 v1, s[4:7], s36 offen offset:3072 sc1 lds
  s_nop 0
  s_add_u32 s36, s32, 16384
  s_add_u32 m0, s34, s36
  s_add_u32 s36, s35, 32768
  buffer_load_dwordx4 v1, s[4:7], s36 offen offset:0 sc1 lds
  s_nop 0
  buffer_load_dwordx4 v1, s[4:7], s36 offen offset:1024 sc1 lds
  s_nop 0
  buffer_load_dwordx4 v1, s[4:7], s36 offen offset:2048 sc1 lds
  s_nop 0
  buffer_load_dwordx4 v1, s[4:7], s36 offen offset:3072 sc1 lds
  s_nop 0
  s_add_u32 s36, s32, 32768
  s_add_u32 m0, s34, s36
  s_add_u32 s36, s35, 65536
  buffer_load_dwordx4 v1, s[4:7], s36 offen offset:0 sc1 lds
  s_nop 0
  buffer_load_dwordx4 v1, s[4:7], s36 offen offset:1024 sc1 lds
  s_nop 0
  buffer_load_dwordx4 v1, s[4:7], s36 offen offset:2048 sc1 lds
  s_nop 0
  buffer_load_dwordx4 v1, s[4:7], s36 offen offset:3072 sc1 lds
  s_nop 0
  s_cmp_eq_u32 s28, 0
  s_cbranch_scc1 L_F1_go
  s_mov_b32 s28, 0
  s_waitcnt vmcnt(12)
  s_barrier
  s_cmp_lg_u32 s20, 0
  s_cbranch_scc1 Lnosig_46
  s_mov_b32 s63, s25
  s_atomic_smax s63, s[4:5], s62 glc
Lnosig_46:
L_F1_go:
  v_add_u32 v73, s26, v69
  v_add_u32 v74, s26, v70
  s_sub_u32 s26, 65536, s26
  s_add_u32 s27, s27, 2097152
  s_xor_b32 s27, s27, 0x2000
  s_add_u32 s29, s29, 1
  s_waitcnt vmcnt(8)
  s_barrier
  ds_read_b128 v[4:7], v73 offset:0
  ds_read_b128 v[8:11], v73 offset:1024
  ds_read_b128 v[12:15], v73 offset:2048
  ds_read_b128 v[16:19], v73 offset:3072
  ds_read_b128 v[20:23], v73 offset:4096
  ds_read_b128 v[24:27], v73 offset:5120
  s_waitcnt lgkmcnt(4)
  v_mfma_f32_16x16x32_bf16 v[36:39], a[0:3], v[4:7], 0
  ds_read_b128 v[28:31], v73 offset:6144
  v_mfma_f32_16x16x32_bf16 v[40:43], a[0:3], v[8:11], 0
  ds_read_b128 v[32:35], v73 offset:7168
  v_mfma_f32_16x16x32_bf16 v[44:47], a[128:131], v[4:7], 0
  s_add_u32 s36, s32, 49152
  s_add_u32 m0, s34, s36
  s_add_u32 s36, s35, 98304
  buffer_load_dwordx4 v1, s[4:7], s36 offen offset:0 sc1 lds
  v_mfma_f32_16x16x32_bf16 v[48:51], a[128:131], v[8:11], 0
  s_waitcnt lgkmcnt(4)
  v_mfma_f32_16x16x32_bf16 v[36:39], a[4:7], v[12:15], v[36:39]
  ds_read_b128 v[4:7], v73 offset:8192
  v_mfma_f32_16x16x32_bf16 v[40:43], a[4:7], v[16:19], v[40:43]
  ds_read_b128 v[8:11], v73 offset:9216
  v_mfma_f32_16x16x32_bf16 v[44:47], a[132:135], v[12:15], v[44:47]
  buffer_load_dwordx4 v1, s[4:7], s36 offen offset:1024 sc1 lds
  v_mfma_f32_16x16x32_bf16 v[48:51], a[132:135], v[16:19], v[48:51]
  s_waitcnt lgkmcnt(4)
  v_mfma_f32_16x16x32_bf16 v[36:39], a[8:11], v[20:23], v[36:39]
  ds_read_b128 v[12:15], v73 offset:10240
  v_mfma_f32_16x16x32_bf16 v[40:43], a[8:11], v[24:27], v[40:43]
  ds_read_b128 v[16:19], v73 offset:11264
  v_mfma_f32_16x16x32_bf16 v[44:47], a[136:139], v[20:23], v[44:47]
  buffer_load_dwordx4 v1, s[4:7], s36 offen offset:2048 sc1 lds
  v_mfma_f32_16x16x32_bf16 v[48:51], a[136:139], v[24:27], v[48:51]
  s_waitcnt lgkmcnt(4)
  v_mfma_f32_16x16x32_bf16 v[36:39], a[12:15], v[28:31], v[36:39]
  ds_read_b128 v[20:23], v73 offset:12288
  v_mfma_f32_16x16x32_bf16 v[40:43], a[12:15], v[32:35], v[40:43]
  ds_read_b128 v[24:27], v73 offset:13312
  v_mfma_f32_16x16x32_bf16 v[44:47], a[140:143], v[28:31], v[44:47]
  buffer_load_dwordx4 v1, s[4:7], s36 offen offset:3072 sc1 lds
  v_mfma_f32_16x16x32_bf16 v[48:51], a[140:143], v[32:35], v[48:51]
  s_waitcnt lgkmcnt(4)
  v_mfma_f32_16x16x32_bf16 v[36:39], a[16:19], v[4:7], v[36:39]
  ds_read_b128 v[28:31], v73 offset:14336
  v_mfma_f32_16x16x32_bf16 v[40:43], a[16:19], v[8:11], v[40:43]
  ds_read_b128 v[32:35], v73 offset:15360
  v_mfma_f32_16x16x32_bf16 v[44:47], a[144:147], v[4:7], v[44:47]
  v_mfma_f32_16x16x32_bf16 v[48:51], a[144:147], v[8:11], v[48:51]
  s_waitcnt vmcnt(8)
  s_barrier
  s_mov_b32 s34, s26
  s_mov_b32 s35, s27
  s_waitcnt lgkmcnt(4)
  v_mfma_f32_16x16x32_bf16 v[36:39], a[20:23], v[12:15], v[36:39]
  ds_read_b128 v[4:7], v73 offset:16384
  v_mfma_f32_16x16x32_bf16 v[40:43], a[20:23], v[16:19], v[40:43]
  ds_read_b128 v[8:11], v73 offset:17408
  v_mfma_f32_16x16x32_bf16 v[44:47], a[148:151], v[12:15], v[44:47]
  v_mfma_f32_16x16x32_bf16 v[48:51], a[148:151], v[16:19], v[48:51]
  s_waitcnt lgkmcnt(4)
  v_mfma_f32_16x16x32_bf16 v[36:39], a[24:27], v[20:23], v[36:39]
  ds_read_b128 v[12:15], v73 offset:18432
  v_mfma_f32_16x16x32_bf16 v[40:43], a[24:27], v[24:27], v[40:43]
  ds_read_b128 v[16:19], v73 offset:19456
  v_mfma_f32_16x16x32_bf16 v[44:47], a[152:155], v[20:23], v[44:47]
  v_mfma_f32_16x16x32_bf16 v[48:51], a[152:155], v[24:27], v[48:51]
  s_waitcnt lgkmcnt(4)
  v_mfma_f32_16x16x32_bf16 v[36:39], a[28:31], v[28:31], v[36:39]
  ds_read_b128 v[20:23], v73 offset:20480
  v_mfma_f32_16x16x32_bf16 v[40:43], a[28:31], v[32:35], v[40:43]
  ds_read_b128 v[24:27], v73 offset:21504
  v_mfma_f32_16x16x32_bf16 v[44:47], a[156:159], v[28:31], v[44:47]
  v_mfma_f32_16x16x32_bf16 v[48:51], a[156:159], v[32:35], v[48:51]
  s_waitcnt lgkmcnt(4)
  v_mfma_f32_16x16x32_bf16 v[36:39], a[32:35], v[4:7], v[36:39]
  ds_read_b128 v[28:31], v73 offset:22528
  v_mfma_f32_16x16x32_bf16 v[40:43], a[32:35], v[8:11], v[40:43]
  ds_read_b128 v[32:35], v73 offset:23552
  v_mfma_f32_16x16x32_bf16 v[44:47], a[160:163], v[4:7], v[44:47]
  v_mfma_f32_16x16x32_bf16 v[48:51], a[160:163], v[8:11], v[48:51]
  s_waitcnt lgkmcnt(4)
  v_mfma_f32_16x16x32_bf16 v[36:39], a[36:39], v[12:15], v[36:39]
  ds_read_b128 v[4:7], v73 offset:24576
  v_mfma_f32_16x16x32_bf16 v[40:43], a[36:39], v[16:19], v[40:43]
  ds_read_b128 v[8:11], v73 offset:25600
  v_mfma_f32_16x16x32_bf16 v[44:47], a[164:167], v[12:15], v[44:47]
  v_mfma_f32_16x16x32_bf16 v[48:51], a[164:167], v[16:19], v[48:51]
  s_waitcnt lgkmcnt(4)
  v_mfma_f32_16x16x32_bf16 v[36:39], a[40:43], v[20:23], v[36:39]
  ds_read_b128 v[12:15], v73 offset:26624
  v_mfma_f32_16x16x32_bf16 v[40:43], a[40:43], v[24:27], v[40:43]
  ds_read_b128 v[16:19], v73 offset:27648
  v_mfma_f32_16x16x32_bf16 v[44:47], a[168:171], v[20:23], v[44:47]
  v_mfma_f32_16x16x32_bf16 v[48:51], a[168:171], v[24:27], v[48:51]
  s_waitcnt lgkmcnt(4)
  v_mfma_f32_16x16x32_bf16 v[36:39], a[44:47], v[28:31], v[36:39]
  ds_read_b128 v[20:23], v73 offset:28672
  v_mfma_f32_16x16x32_bf16 v[40:43], a[44:47], v[32:35], v[40:43]
  ds_read_b128 v[24:27], v73 offset:29696
  v_mfma_f32_16x16x32_bf16 v[44:47], a[172:175], v[28:31], v[44:47]
  v_mfma_f32_16x16x32_bf16 v[48:51], a[172:175], v[32:35], v[48:51]
  s_lshl_b32 s40, s20, 8
  s_add_u32 m0, s40, 131072
  s_cmp_eq_u32 s20, 0
  s_cselect_b32 s40, s30, 2147483392
  buffer_load_dword v2, s[4:7], s40 offen sc1 lds
  s_waitcnt lgkmcnt(4)
  v_mfma_f32_16x16x32_bf16 v[36:39], a[48:51], v[4:7], v[36:39]
  ds_read_b128 v[28:31], v73 offset:30720
  v_mfma_f32_16x16x32_bf16 v[40:43], a[48:51], v[8:11], v[40:43]
  ds_read_b128 v[32:35], v73 offset:31744
  v_mfma_f32_16x16x32_bf16 v[44:47], a[176:179], v[4:7], v[44:47]
  v_mfma_f32_16x16x32_bf16 v[48:51], a[176:179], v[8:11], v[48:51]
  s_waitcnt vmcnt(5)
  s_barrier
  s_lshl_b32 s40, s20, 1
  s_add_u32 s40, s40, 1
  s_cmp_lg_u32 s40, s28
  s_cbranch_scc1 L_F1_s2
  s_mov_b32 s63, s25
  s_atomic_smax s63, s[4:5], s62 glc
Lnosig_47:
L_F1_s2:
  s_waitcnt lgkmcnt(4)
  v_mfma_f32_16x16x32_bf16 v[36:39], a[52:55], v[12:15], v[36:39]
  ds_read_b128 v[4:7], v73 offset:32768
  v_mfma_f32_16x16x32_bf16 v[40:43], a[52:55], v[16:19], v[40:43]
  ds_read_b128 v[8:11], v73 offset:33792
  v_mfma_f32_16x16x32_bf16 v[44:47], a[180:183], v[12:15], v[44:47]
  v_mfma_f32_16x16x32_bf16 v[48:51], a[180:183], v[16:19], v[48:51]
  s_waitcnt lgkmcnt(4)
  v_mfma_f32_16x16x32_bf16 v[36:39], a[56:59], v[20:23], v[36:39]
  ds_read_b128 v[12:15], v73 offset:34816
  v_mfma_f32_16x16x32_bf16 v[40:43], a[56:59], v[24:27], v[40:43]
  ds_read_b128 v[16:19], v73 offset:35840
  v_mfma_f32_16x16x32_bf16 v[44:47], a[184:187], v[20:23], v[44:47]
  v_mfma_f32_16x16x32_bf16 v[48:51], a[184:187], v[24:27], v[48:51]
  s_waitcnt lgkmcnt(4)
  v_mfma_f32_16x16x32_bf16 v[36:39], a[60:63], v[28:31], v[36:39]
  ds_read_b128 v[20:23], v73 offset:36864
  v_mfma_f32_16x16x32_bf16 v[40:43], a[60:63], v[32:35], v[40:43]
  ds_read_b128 v[24:27], v73 offset:37888
  v_mfma_f32_16x16x32_bf16 v[44:47], a[188:191], v[28:31], v[44:47]
  v_mfma_f32_16x16x32_bf16 v[48:51], a[188:191], v[32:35], v[48:51]
  s_waitcnt lgkmcnt(4)
  v_mfma_f32_16x16x32_bf16 v[36:39], a[64:67], v[4:7], v[36:39]
  ds_read_b128 v[28:31], v73 offset:38912
  v_mfma_f32_16x16x32_bf16 v[40:43], a[64:67], v[8:11], v[40:43]
  ds_read_b128 v[32:35], v73 offset:39936
  v_mfma_f32_16x16x32_bf16 v[44:47], a[192:195], v[4:7], v[44:47]
  v_mfma_f32_16x16x32_bf16 v[48:51], a[192:195], v[8:11], v[48:51]
  s_waitcnt lgkmcnt(4)
  v_mfma_f32_16x16x32_bf16 v[36:39], a[68:71], v[12:15], v[36:39]
  ds_read_b128 v[4:7], v73 offset:40960
  v_mfma_f32_16x16x32_bf16 v[40:43], a[68:71], v[16:19], v[40:43]
  ds_read_b128 v[8:11], v73 offset:41984
  v_mfma_f32_16x16x32_bf16 v[44:47], a[196:199], v[12:15], v[44:47]
  v_mfma_f32_16x16x32_bf16 v[48:51], a[196:199], v[16:19], v[48:51]
  s_waitcnt lgkmcnt(4)
  v_mfma_f32_16x16x32_bf16 v[36:39], a[72:75], v[20:23], v[36:39]
  ds_read_b128 v[12:15], v73 offset:43008
  v_mfma_f32_16x16x32_bf16 v[40:43], a[72:75], v[24:27], v[40:43]
  ds_read_b128 v[16:19], v73 offset:44032
  v_mfma_f32_16x16x32_bf16 v[44:47], a[200:203], v[20:23], v[44:47]
  v_mfma_f32_16x16x32_bf16 v[48:51], a[200:203], v[24:27], v[48:51]
  s_waitcnt vmcnt(0)
  s_barrier
  ds_read_b32 v3, v71
  s_waitcnt lgkmcnt(4)
  v_mfma_f32_16x16x32_bf16 v[36:39], a[76:79], v[28:31], v[36:39]
  ds_read_b128 v[20:23], v73 offset:45056
  v_mfma_f32_16x16x32_bf16 v[40:43], a[76:79], v[32:35], v[40:43]
  ds_read_b128 v[24:27], v73 offset:46080
  v_mfma_f32_16x16x32_bf16 v[44:47], a[204:207], v[28:31], v[44:47]
  v_mfma_f32_16x16x32_bf16 v[48:51], a[204:207], v[32:35], v[48:51]
  s_waitcnt lgkmcnt(4)
  v_mfma_f32_16x16x32_bf16 v[36:39], a[80:83], v[4:7], v[36:39]
  ds_read_b128 v[28:31], v73 offset:47104
  v_mfma_f32_16x16x32_bf16 v[40:43], a[80:83], v[8:11], v[40:43]
  ds_read_b128 v[32:35], v73 offset:48128
  v_mfma_f32_16x16x32_bf16 v[44:47], a[208:211], v[4:7], v[44:47]
  v_mfma_f32_16x16x32_bf16 v[48:51], a[208:211], v[8:11], v[48:51]
  s_waitcnt lgkmcnt(4)
  v_cmp_gt_i32 vcc, s29, v3
  s_mov_b32 s28, 0
  s_cbranch_vccnz L_F1_nopf
  s_cmp_ge_u32 s25, 63
  s_cbranch_scc1 L_F1_nopf
  s_mov_b32 s28, 1
  s_waitcnt lgkmcnt(4)
  v_mfma_f32_16x16x32_bf16 v[36:39], a[84:87], v[12:15], v[36:39]
  ds_read_b128 v[4:7], v73 offset:49152
  v_mfma_f32_16x16x32_bf16 v[40:43], a[84:87], v[16:19], v[40:43]
  ds_read_b128 v[8:11], v73 offset:50176
  v_mfma_f32_16x16x32_bf16 v[44:47], a[212:215], v[12:15], v[44:47]
  s_add_u32 s36, s32, 0
  s_add_u32 m0, s34, s36
  s_add_u32 s36, s35, 0
  buffer_load_dwordx4 v1, s[4:7], s36 offen offset:0 sc1 lds
  v_mfma_f32_16x16x32_bf16 v[48:51], a[212:215], v[16:19], v[48:51]
  buffer_load_dwordx4 v1, s[4:7], s36 offen offset:1024 sc1 lds
  s_waitcnt lgkmcnt(4)
  v_mfma_f32_16x16x32_bf16 v[36:39], a[88:91], v[20:23], v[36:39]
  ds_read_b128 v[12:15], v73 offset:51200
  v_mfma_f32_16x16x32_bf16 v[40:43], a[88:91], v[24:27], v[40:43]
  ds_read_b128 v[16:19], v73 offset:52224
  v_mfma_f32_16x16x32_bf16 v[44:47], a[216:219], v[20:23], v[44:47]
  buffer_load_dwordx4 v1, s[4:7], s36 offen offset:2048 sc1 lds
  v_mfma_f32_16x16x32_bf16 v[48:51], a[216:219], v[24:27], v[48:51]
  buffer_load_dwordx4 v1, s[4:7], s36 offen offset:3072 sc1 lds
  s_waitcnt lgkmcnt(4)
  v_mfma_f32_16x16x32_bf16 v[36:39], a[92:95], v[28:31], v[36:39]
  ds_read_b128 v[20:23], v73 offset:53248
  v_mfma_f32_16x16x32_bf16 v[40:43], a[92:95], v[32:35], v[40:43]
  ds_read_b128 v[24:27], v73 offset:54272
  v_mfma_f32_16x16x32_bf16 v[44:47], a[220:223], v[28:31], v[44:47]
  s_add_u32 s36, s32, 16384
  s_add_u32 m0, s34, s36
  s_add_u32 s36, s35, 32768
  buffer_load_dwordx4 v1, s[4:7], s36 offen offset:0 sc1 lds
  v_mfma_f32_16x16x32_bf16 v[48:51], a[220:223], v[32:35], v[48:51]
  buffer_load_dwordx4 v1, s[4:7], s36 offen offset:1024 sc1 lds
  s_waitcnt lgkmcnt(4)
  v_mfma_f32_16x16x32_bf16 v[36:39], a[96:99], v[4:7], v[36:39]
  ds_read_b128 v[28:31], v73 offset:55296
  v_mfma_f32_16x16x32_bf16 v[40:43], a[96:99], v[8:11], v[40:43]
  ds_read_b128 v[32:35], v73 offset:56320
  v_mfma_f32_16x16x32_bf16 v[44:47], a[224:227], v[4:7], v[44:47]
  buffer_load_dwordx4 v1, s[4:7], s36 offen offset:2048 sc1 lds
  v_mfma_f32_16x16x32_bf16 v[48:51], a[224:227], v[8:11], v[48:51]
  buffer_load_dwordx4 v1, s[4:7], s36 offen offset:3072 sc1 lds
  s_waitcnt lgkmcnt(4)
  v_mfma_f32_16x16x32_bf16 v[36:39], a[100:103], v[12:15], v[36:39]
  ds_read_b128 v[4:7], v73 offset:57344
  v_mfma_f32_16x16x32_bf16 v[40:43], a[100:103], v[16:19], v[40:43]
  ds_read_b128 v[8:11], v73 offset:58368
  v_mfma_f32_16x16x32_bf16 v[44:47], a[228:231], v[12:15], v[44:47]
  s_add_u32 s36, s32, 32768
  s_add_u32 m0, s34, s36
  s_add_u32 s36, s35, 65536
  buffer_load_dwordx4 v1, s[4:7], s36 offen offset:0 sc1 lds
  v_mfma_f32_16x16x32_bf16 v[48:51], a[228:231], v[16:19], v[48:51]
  buffer_load_dwordx4 v1, s[4:7], s36 offen offset:1024 sc1 lds
  s_waitcnt lgkmcnt(4)
  v_mfma_f32_16x16x32_bf16 v[36:39], a[104:107], v[20:23], v[36:39]
  ds_read_b128 v[12:15], v73 offset:59392
  v_mfma_f32_16x16x32_bf16 v[40:43], a[104:107], v[24:27], v[40:43]
  ds_read_b128 v[16:19], v73 offset:60416
  v_mfma_f32_16x16x32_bf16 v[44:47], a[232:235], v[20:23], v[44:47]
  buffer_load_dwordx4 v1, s[4:7], s36 offen offset:2048 sc1 lds
  v_mfma_f32_16x16x32_bf16 v[48:51], a[232:235], v[24:27], v[48:51]
  buffer_load_dwordx4 v1, s[4:7], s36 offen offset:3072 sc1 lds
  s_waitcnt lgkmcnt(4)
  v_mfma_f32_16x16x32_bf16 v[36:39], a[108:111], v[28:31], v[36:39]
  ds_read_b128 v[20:23], v73 offset:61440
  v_mfma_f32_16x16x32_bf16 v[40:43], a[108:111], v[32:35], v[40:43]
  ds_read_b128 v[24:27], v73 offset:62464
  v_mfma_f32_16x16x32_bf16 v[44:47], a[236:239], v[28:31], v[44:47]
  v_mfma_f32_16x16x32_bf16 v[48:51], a[236:239], v[32:35], v[48:51]
  s_waitcnt lgkmcnt(4)
  v_mfma_f32_16x16x32_bf16 v[36:39], a[112:115], v[4:7], v[36:39]
  ds_read_b128 v[28:31], v73 offset:63488
  v_mfma_f32_16x16x32_bf16 v[40:43], a[112:115], v[8:11], v[40:43]
  ds_read_b128 v[32:35], v73 offset:64512
  v_mfma_f32_16x16x32_bf16 v[44:47], a[240:243], v[4:7], v[44:47]
  v_mfma_f32_16x16x32_bf16 v[48:51], a[240:243], v[8:11], v[48:51]
  s_waitcnt lgkmcnt(4)
  v_mfma_f32_16x16x32_bf16 v[36:39], a[116:119], v[12:15], v[36:39]
  v_mfma_f32_16x16x32_bf16 v[40:43], a[116:119], v[16:19], v[40:43]
  v_mfma_f32_16x16x32_bf16 v[44:47], a[244:247], v[12:15], v[44:47]
  v_mfma_f32_16x16x32_bf16 v[48:51], a[244:247], v[16:19], v[48:51]
  s_waitcnt lgkmcnt(2)
  v_mfma_f32_16x16x32_bf16 v[36:39], a[120:123], v[20:23], v[36:39]
  v_mfma_f32_16x16x32_bf16 v[40:43], a[120:123], v[24:27], v[40:43]
  v_mfma_f32_16x16x32_bf16 v[44:47], a[248:251], v[20:23], v[44:47]
  v_mfma_f32_16x16x32_bf16 v[48:51], a[248:251], v[24:27], v[48:51]
  s_waitcnt lgkmcnt(0)
  v_mfma_f32_16x16x32_bf16 v[36:39], a[124:127], v[28:31], v[36:39]
  v_mfma_f32_16x16x32_bf16 v[40:43], a[124:127], v[32:35], v[40:43]
  v_mfma_f32_16x16x32_bf16 v[44:47], a[252:255], v[28:31], v[44:47]
  v_mfma_f32_16x16x32_bf16 v[48:51], a[252:255], v[32:35], v[48:51]
  s_nop 7
  s_branch L_F1_epi
L_F1_nopf:
  s_waitcnt lgkmcnt(4)
  v_mfma_f32_16x16x32_bf16 v[36:39], a[84:87], v[12:15], v[36:39]
  ds_read_b128 v[4:7], v73 offset:49152
  v_mfma_f32_16x16x32_bf16 v[40:43], a[84:87], v[16:19], v[40:43]
  ds_read_b128 v[8:11], v73 offset:50176
  v_mfma_f32_16x16x32_bf16 v[44:47], a[212:215], v[12:15], v[44:47]
  v_mfma_f32_16x16x32_bf16 v[48:51], a[212:215], v[16:19], v[48:51]
  s_waitcnt lgkmcnt(4)
  v_mfma_f32_16x16x32_bf16 v[36:39], a[88:91], v[20:23], v[36:39]
  ds_read_b128 v[12:15], v73 offset:51200
  v_mfma_f32_16x16x32_bf16 v[40:43], a[88:91], v[24:27], v[40:43]
  ds_read_b128 v[16:19], v73 offset:52224
  v_mfma_f32_16x16x32_bf16 v[44:47], a[216:219], v[20:23], v[44:47]
  v_mfma_f32_16x16x32_bf16 v[48:51], a[216:219], v[24:27], v[48:51]
  s_waitcnt lgkmcnt(4)
  v_mfma_f32_16x16x32_bf16 v[36:39], a[92:95], v[28:31], v[36:39]
  ds_read_b128 v[20:23], v73 offset:53248
  v_mfma_f32_16x16x32_bf16 v[40:43], a[92:95], v[32:35], v[40:43]
  ds_read_b128 v[24:27], v73 offset:54272
  v_mfma_f32_16x16x32_bf16 v[44:47], a[220:223], v[28:31], v[44:47]
  v_mfma_f32_16x16x32_bf16 v[48:51], a[220:223], v[32:35], v[48:51]
  s_barrier
  s_lshl_b32 s40, s20, 8
  s_add_u32 m0, s40, 131072
  s_cmp_eq_u32 s20, 0
  s_cselect_b32 s40, s30, 2147483392
  buffer_load_dword v2, s[4:7], s40 offen sc1 lds
  s_waitcnt lgkmcnt(4)
  v_mfma_f32_16x16x32_bf16 v[36:39], a[96:99], v[4:7], v[36:39]
  ds_read_b128 v[28:31], v73 offset:55296
  v_mfma_f32_16x16x32_bf16 v[40:43], a[96:99], v[8:11], v[40:43]
  ds_read_b128 v[32:35], v73 offset:56320
  v_mfma_f32_16x16x32_bf16 v[44:47], a[224:227], v[4:7], v[44:47]
  v_mfma_f32_16x16x32_bf16 v[48:51], a[224:227], v[8:11], v[48:51]
  s_waitcnt lgkmcnt(4)
  v_mfma_f32_16x16x32_bf16 v[36:39], a[100:103], v[12:15], v[36:39]
  ds_read_b128 v[4:7], v73 offset:57344
  v_mfma_f32_16x16x32_bf16 v[40:43], a[100:103], v[16:19], v[40:43]
  ds_read_b128 v[8:11], v73 offset:58368
  v_mfma_f32_16x16x32_bf16 v[44:47], a[228:231], v[12:15], v[44:47]
  v_mfma_f32_16x16x32_bf16 v[48:51], a[228:231], v[16:19], v[48:51]
  s_waitcnt lgkmcnt(4)
  v_mfma_f32_16x16x32_bf16 v[36:39], a[104:107], v[20:23], v[36:39]
  ds_read_b128 v[12:15], v73 offset:59392
  v_mfma_f32_16x16x32_bf16 v[40:43], a[104:107], v[24:27], v[40:43]
  ds_read_b128 v[16:19], v73 offset:60416
  v_mfma_f32_16x16x32_bf16 v[44:47], a[232:235], v[20:23], v[44:47]
  v_mfma_f32_16x16x32_bf16 v[48:51], a[232:235], v[24:27], v[48:51]
  s_waitcnt lgkmcnt(4)
  v_mfma_f32_16x16x32_bf16 v[36:39], a[108:111], v[28:31], v[36:39]
  ds_read_b128 v[20:23], v73 offset:61440
  v_mfma_f32_16x16x32_bf16 v[40:43], a[108:111], v[32:35], v[40:43]
  ds_read_b128 v[24:27], v73 offset:62464
  v_mfma_f32_16x16x32_bf16 v[44:47], a[236:239], v[28:31], v[44:47]
  v_mfma_f32_16x16x32_bf16 v[48:51], a[236:239], v[32:35], v[48:51]
  s_waitcnt lgkmcnt(4)
  v_mfma_f32_16x16x32_bf16 v[36:39], a[112:115], v[4:7], v[36:39]
  ds_read_b128 v[28:31], v73 offset:63488
  v_mfma_f32_16x16x32_bf16 v[40:43], a[112:115], v[8:11], v[40:43]
  ds_read_b128 v[32:35], v73 offset:64512
  v_mfma_f32_16x16x32_bf16 v[44:47], a[240:243], v[4:7], v[44:47]
  v_mfma_f32_16x16x32_bf16 v[48:51], a[240:243], v[8:11], v[48:51]
  s_waitcnt lgkmcnt(4)
  v_mfma_f32_16x16x32_bf16 v[36:39], a[116:119], v[12:15], v[36:39]
  v_mfma_f32_16x16x32_bf16 v[40:43], a[116:119], v[16:19], v[40:43]
  v_mfma_f32_16x16x32_bf16 v[44:47], a[244:247], v[12:15], v[44:47]
  v_mfma_f32_16x16x32_bf16 v[48:51], a[244:247], v[16:19], v[48:51]
  s_waitcnt vmcnt(0)
  s_barrier
  ds_read_b32 v3, v71
  s_waitcnt lgkmcnt(2)
  v_mfma_f32_16x16x32_bf16 v[36:39], a[120:123], v[20:23], v[36:39]
  v_mfma_f32_16x16x32_bf16 v[40:43], a[120:123], v[24:27], v[40:43]
  v_mfma_f32_16x16x32_bf16 v[44:47], a[248:251], v[20:23], v[44:47]
  v_mfma_f32_16x16x32_bf16 v[48:51], a[248:251], v[24:27], v[48:51]
  s_waitcnt lgkmcnt(0)
  v_mfma_f32_16x16x32_bf16 v[36:39], a[124:127], v[28:31], v[36:39]
  v_mfma_f32_16x16x32_bf16 v[40:43], a[124:127], v[32:35], v[40:43]
  v_mfma_f32_16x16x32_bf16 v[44:47], a[252:255], v[28:31], v[44:47]
  v_mfma_f32_16x16x32_bf16 v[48:51], a[252:255], v[32:35], v[48:51]
  v_cmp_gt_i32 vcc, s29, v3
  s_cmp_eq_u64 vcc, 0
  s_cselect_b32 s28, 2, 0
  s_cmp_lt_u32 s25, 63
  s_cselect_b32 s28, s28, 0
L_F1_epi:
  v_mul_f32 v52, s37, v36
  v_mul_f32 v53, s37, v37
  v_mul_f32 v54, s37, v38
  v_mul_f32 v55, s37, v39
  v_mul_f32 v56, s37, v40
  v_mul_f32 v57, s37, v41
  v_mul_f32 v58, s37, v42
  v_mul_f32 v59, s37, v43
  v_exp_f32 v52, v52
  v_exp_f32 v53, v53
  v_exp_f32 v54, v54
  v_exp_f32 v55, v55
  v_exp_f32 v56, v56
  v_exp_f32 v57, v57
  v_exp_f32 v58, v58
  v_exp_f32 v59, v59
  v_pk_mul_f32 v[36:37], v[36:37], v[44:45]
  v_pk_mul_f32 v[38:39], v[38:39], v[46:47]
  v_pk_mul_f32 v[40:41], v[40:41], v[48:49]
  v_pk_mul_f32 v[42:43], v[42:43], v[50:51]
  v_add_f32 v52, 1.0, v52
  v_add_f32 v53, 1.0, v53
  v_add_f32 v54, 1.0, v54
  v_add_f32 v55, 1.0, v55
  v_add_f32 v56, 1.0, v56
  v_add_f32 v57, 1.0, v57
  v_add_f32 v58, 1.0, v58
  v_add_f32 v59, 1.0, v59
  v_rcp_f32 v52, v52
  v_rcp_f32 v53, v53
  v_rcp_f32 v54, v54
  v_rcp_f32 v55, v55
  v_rcp_f32 v56, v56
  v_rcp_f32 v57, v57
  v_rcp_f32 v58, v58
  v_rcp_f32 v59, v59
  v_pk_mul_f32 v[36:37], v[36:37], v[52:53]
  v_pk_mul_f32 v[38:39], v[38:39], v[54:55]
  v_pk_mul_f32 v[40:41], v[40:41], v[56:57]
  v_pk_mul_f32 v[42:43], v[42:43], v[58:59]
  v_cvt_pk_bf16_f32 v60, v36, v37
  v_cvt_pk_bf16_f32 v61, v38, v39
  v_cvt_pk_bf16_f32 v62, v40, v41
  v_cvt_pk_bf16_f32 v63, v42, v43
  s_nop 0
  v_permlane32_swap_b32 v60, v62
  v_permlane32_swap_b32 v61, v63
  buffer_store_dwordx4 v[60:63], v68, s[4:7], s31 offen sc1
  s_add_u32 s25, s25, 1
  s_add_u32 s31, s31, 2097152
  s_xor_b32 s31, s31, 0x2000
  s_branch L_F1_top
L_F2:
  v_lshlrev_b32 v1, 4, v0
  s_lshl_b32 s32, s20, 12
  s_min_u32 s33, s32, 0x2000
  v_mov_b32 v69, v1
  v_add_u32 v70, 0x10000, v69
  s_load_dwordx2 s[8:9], s[0:1], 80
  s_mov_b32 s10, 7340032
  s_mov_b32 s11, 0x20000
  s_waitcnt lgkmcnt(0)
  s_lshr_b32 s44, s21, 3
  s_mul_i32 s44, s44, 2490368
  s_and_b32 s45, s21, 7
  s_lshl_b32 s45, s45, 8
  s_add_u32 s44, s44, s45
  s_add_u32 s45, s44, 128
  s_cmp_ge_u32 s21, 16
  s_cselect_b32 s40, 131072, 0
  s_sub_u32 s44, s44, s40
  s_sub_u32 s45, s45, s40
  v_bfe_u32 v4, v0, 5, 1
  v_mul_u32_u24 v4, 8192, v4
  v_bfe_u32 v5, v0, 4, 1
  v_mul_u32_u24 v5, 4096, v5
  v_add_u32 v4, v4, v5
  v_bfe_u32 v5, v0, 3, 1
  v_mul_u32_u24 v5, 2048, v5
  v_add_u32 v4, v4, v5
  v_lshrrev_b32 v5, 3, v0
  v_and_b32 v5, 6, v5
  v_xor_b32 v5, v5, v0
  v_and_b32 v5, 7, v5
  v_lshl_add_u32 v4, v5, 4, v4
  s_lshr_b32 s40, s20, 1
  s_mul_i32 s40, s40, 16384
  s_and_b32 s41, s20, 1
  s_mul_i32 s41, s41, 32768
  s_add_u32 s40, s40, s41
  v_add_u32 v4, s40, v4
  v_bfe_u32 v5, v0, 3, 2
  v_xor_b32 v5, s20, v5
  v_lshlrev_b32 v5, 5, v5
  v_lshrrev_b32 v6, 2, v0
  v_lshl_add_u32 v6, v6, 7, v5
  v_and_b32 v5, 3, v0
  v_lshl_add_u32 v6, v5, 3, v6
  v_add_u32 v7, 0x10000, v6
  v_add_u32 v8, s44, v4
  v_add_u32 v9, s45, v4
  s_lshl_b32 s41, s20, 10
  s_add_u32 m0, s41, 0
  s_mov_b32 s42, 0
  buffer_load_dwordx4 v8, s[8:11], s42 offen nt lds
  s_add_u32 m0, s41, 4096
  s_mov_b32 s42, 0
  buffer_load_dwordx4 v9, s[8:11], s42 offen nt lds
  s_add_u32 m0, s41, 8192
  s_mov_b32 s42, 65536
  buffer_load_dwordx4 v8, s[8:11], s42 offen nt lds
  s_add_u32 m0, s41, 12288
  s_mov_b32 s42, 65536
  buffer_load_dwordx4 v9, s[8:11], s42 offen nt lds
  s_add_u32 m0, s41, 16384
  s_mov_b32 s42, 131072
  buffer_load_dwordx4 v8, s[8:11], s42 offen nt lds
  s_add_u32 m0, s41, 20480
  s_mov_b32 s42, 131072
  buffer_load_dwordx4 v9, s[8:11], s42 offen nt lds
  s_add_u32 m0, s41, 24576
  s_mov_b32 s42, 196608
  buffer_load_dwordx4 v8, s[8:11], s42 offen nt lds
  s_add_u32 m0, s41, 28672
  s_mov_b32 s42, 196608
  buffer_load_dwordx4 v9, s[8:11], s42 offen nt lds
  s_add_u32 m0, s41, 32768
  s_mov_b32 s42, 262144
  buffer_load_dwordx4 v8, s[8:11], s42 offen nt lds
  s_add_u32 m0, s41, 36864
  s_mov_b32 s42, 262144
  buffer_load_dwordx4 v9, s[8:11], s42 offen nt lds
  s_add_u32 m0, s41, 40960
  s_mov_b32 s42, 327680
  buffer_load_dwordx4 v8, s[8:11], s42 offen nt lds
  s_add_u32 m0, s41, 45056
  s_mov_b32 s42, 327680
  buffer_load_dwordx4 v9, s[8:11], s42 offen nt lds
  s_add_u32 m0, s41, 49152
  s_mov_b32 s42, 393216
  buffer_load_dwordx4 v8, s[8:11], s42 offen nt lds
  s_add_u32 m0, s41, 53248
  s_mov_b32 s42, 393216
  buffer_load_dwordx4 v9, s[8:11], s42 offen nt lds
  s_add_u32 m0, s41, 57344
  s_mov_b32 s42, 458752
  buffer_load_dwordx4 v8, s[8:11], s42 offen nt lds
  s_add_u32 m0, s41, 61440
  s_mov_b32 s42, 458752
  buffer_load_dwordx4 v9, s[8:11], s42 offen nt lds
  s_add_u32 m0, s41, 65536
  s_mov_b32 s42, 524288
  buffer_load_dwordx4 v8, s[8:11], s42 offen nt lds
  s_add_u32 m0, s41, 69632
  s_mov_b32 s42, 524288
  buffer_load_dwordx4 v9, s[8:11], s42 offen nt lds
  s_add_u32 m0, s41, 73728
  s_mov_b32 s42, 589824
  buffer_load_dwordx4 v8, s[8:11], s42 offen nt lds
  s_add_u32 m0, s41, 77824
  s_mov_b32 s42, 589824
  buffer_load_dwordx4 v9, s[8:11], s42 offen nt lds
  s_add_u32 m0, s41, 81920
  s_mov_b32 s42, 655360
  buffer_load_dwordx4 v8, s[8:11], s42 offen nt lds
  s_add_u32 m0, s41, 86016
  s_mov_b32 s42, 655360
  buffer_load_dwordx4 v9, s[8:11], s42 offen nt lds
  s_add_u32 m0, s41, 90112
  s_mov_b32 s42, 720896
  buffer_load_dwordx4 v8, s[8:11], s42 offen nt lds
  s_add_u32 m0, s41, 94208
  s_mov_b32 s42, 720896
  buffer_load_dwordx4 v9, s[8:11], s42 offen nt lds
  s_add_u32 m0, s41, 98304
  s_mov_b32 s42, 786432
  buffer_load_dwordx4 v8, s[8:11], s42 offen nt lds
  s_add_u32 m0, s41, 102400
  s_mov_b32 s42, 786432
  buffer_load_dwordx4 v9, s[8:11], s42 offen nt lds
  s_add_u32 m0, s41, 106496
  s_mov_b32 s42, 851968
  buffer_load_dwordx4 v8, s[8:11], s42 offen nt lds
  s_add_u32 m0, s41, 110592
  s_mov_b32 s42, 851968
  buffer_load_dwordx4 v9, s[8:11], s42 offen nt lds
  s_waitcnt vmcnt(24) lgkmcnt(0)
  s_barrier
  s_add_u32 m0, s41, 114688
  s_mov_b32 s42, 917504
  buffer_load_dwordx4 v8, s[8:11], s42 offen nt lds
  s_add_u32 m0, s41, 118784
  s_mov_b32 s42, 917504
  buffer_load_dwordx4 v9, s[8:11], s42 offen nt lds
  s_add_u32 m0, s41, 122880
  s_mov_b32 s42, 983040
  buffer_load_dwordx4 v8, s[8:11], s42 offen nt lds
  s_add_u32 m0, s41, 126976
  s_mov_b32 s42, 983040
  buffer_load_dwordx4 v9, s[8:11], s42 offen nt lds
  ds_read_b64_tr_b16 a[0:1], v6 offset:0
  ds_read_b64_tr_b16 a[2:3], v6 offset:2048
  ds_read_b64_tr_b16 a[152:153], v6 offset:4096
  ds_read_b64_tr_b16 a[154:155], v6 offset:6144
  ds_read_b64_tr_b16 a[4:5], v6 offset:8192
  ds_read_b64_tr_b16 a[6:7], v6 offset:10240
  ds_read_b64_tr_b16 a[156:157], v6 offset:12288
  ds_read_b64_tr_b16 a[158:159], v6 offset:14336
  s_waitcnt vmcnt(24) lgkmcnt(0)
  s_barrier
  s_add_u32 m0, s41, 0
  s_mov_b32 s42, 1048576
  buffer_load_dwordx4 v8, s[8:11], s42 offen nt lds
  s_add_u32 m0, s41, 4096
  s_mov_b32 s42, 1048576
  buffer_load_dwordx4 v9, s[8:11], s42 offen nt lds
  s_add_u32 m0, s41, 8192
  s_mov_b32 s42, 1114112
  buffer_load_dwordx4 v8, s[8:11], s42 offen nt lds
  s_add_u32 m0, s41, 12288
  s_mov_b32 s42, 1114112
  buffer_load_dwordx4 v9, s[8:11], s42 offen nt lds
  ds_read_b64_tr_b16 a[8:9], v6 offset:16384
  ds_read_b64_tr_b16 a[10:11], v6 offset:18432
  ds_read_b64_tr_b16 a[160:161], v6 offset:20480
  ds_read_b64_tr_b16 a[162:163], v6 offset:22528
  ds_read_b64_tr_b16 a[12:13], v6 offset:24576
  ds_read_b64_tr_b16 a[14:15], v6 offset:26624
  ds_read_b64_tr_b16 a[164:165], v6 offset:28672
  ds_read_b64_tr_b16 a[166:167], v6 offset:30720
  s_waitcnt vmcnt(24) lgkmcnt(0)
  s_barrier
  s_add_u32 m0, s41, 16384
  s_mov_b32 s42, 1179648
  buffer_load_dwordx4 v8, s[8:11], s42 offen nt lds
  s_add_u32 m0, s41, 20480
  s_mov_b32 s42, 1179648
  buffer_load_dwordx4 v9, s[8:11], s42 offen nt lds
  s_add_u32 m0, s41, 24576
  s_mov_b32 s42, 1245184
  buffer_load_dwordx4 v8, s[8:11], s42 offen nt lds
  s_add_u32 m0, s41, 28672
  s_mov_b32 s42, 1245184
  buffer_load_dwordx4 v9, s[8:11], s42 offen nt lds
  ds_read_b64_tr_b16 a[16:17], v6 offset:32768
  ds_read_b64_tr_b16 a[18:19], v6 offset:34816
  ds_read_b64_tr_b16 a[168:169], v6 offset:36864
  ds_read_b64_tr_b16 a[170:171], v6 offset:38912
  ds_read_b64_tr_b16 a[20:21], v6 offset:40960
  ds_read_b64_tr_b16 a[22:23], v6 offset:43008
  ds_read_b64_tr_b16 a[172:173], v6 offset:45056
  ds_read_b64_tr_b16 a[174:175], v6 offset:47104
  s_waitcnt vmcnt(24) lgkmcnt(0)
  s_barrier
  s_add_u32 m0, s41, 32768
  s_mov_b32 s42, 1310720
  buffer_load_dwordx4 v8, s[8:11], s42 offen nt lds
  s_add_u32 m0, s41, 36864
  s_mov_b32 s42, 1310720
  buffer_load_dwordx4 v9, s[8:11], s42 offen nt lds
  s_add_u32 m0, s41, 40960
  s_mov_b32 s42, 1376256
  buffer_load_dwordx4 v8, s[8:11], s42 offen nt lds
  s_add_u32 m0, s41, 45056
  s_mov_b32 s42, 1376256
  buffer_load_dwordx4 v9, s[8:11], s42 offen nt lds
  ds_read_b64_tr_b16 a[24:25], v6 offset:49152
  ds_read_b64_tr_b16 a[26:27], v6 offset:51200
  ds_read_b64_tr_b16 a[176:177], v6 offset:53248
  ds_read_b64_tr_b16 a[178:179], v6 offset:55296
  ds_read_b64_tr_b16 a[28:29], v6 offset:57344
  ds_read_b64_tr_b16 a[30:31], v6 offset:59392
  ds_read_b64_tr_b16 a[180:181], v6 offset:61440
  ds_read_b64_tr_b16 a[182:183], v6 offset:63488
  s_waitcnt vmcnt(24) lgkmcnt(0)
  s_barrier
  s_add_u32 m0, s41, 49152
  s_mov_b32 s42, 1441792
  buffer_load_dwordx4 v8, s[8:11], s42 offen nt lds
  s_add_u32 m0, s41, 53248
  s_mov_b32 s42, 1441792
  buffer_load_dwordx4 v9, s[8:11], s42 offen nt lds
  s_add_u32 m0, s41, 57344
  s_mov_b32 s42, 1507328
  buffer_load_dwordx4 v8, s[8:11], s42 offen nt lds
  s_add_u32 m0, s41, 61440
  s_mov_b32 s42, 1507328
  buffer_load_dwordx4 v9, s[8:11], s42 offen nt lds
  ds_read_b64_tr_b16 a[32:33], v7 offset:0
  ds_read_b64_tr_b16 a[34:35], v7 offset:2048
  ds_read_b64_tr_b16 a[184:185], v7 offset:4096
  ds_read_b64_tr_b16 a[186:187], v7 offset:6144
  ds_read_b64_tr_b16 a[36:37], v7 offset:8192
  ds_read_b64_tr_b16 a[38:39], v7 offset:10240
  ds_read_b64_tr_b16 a[188:189], v7 offset:12288
  ds_read_b64_tr_b16 a[190:191], v7 offset:14336
  s_waitcnt vmcnt(24) lgkmcnt(0)
  s_barrier
  s_add_u32 m0, s41, 65536
  s_mov_b32 s42, 1572864
  buffer_load_dwordx4 v8, s[8:11], s42 offen nt lds
  s_add_u32 m0, s41, 69632
  s_mov_b32 s42, 1572864
  buffer_load_dwordx4 v9, s[8:11], s42 offen nt lds
  s_add_u32 m0, s41, 73728
  s_mov_b32 s42, 1638400
  buffer_load_dwordx4 v8, s[8:11], s42 offen nt lds
  s_add_u32 m0, s41, 77824
  s_mov_b32 s42, 1638400
  buffer_load_dwordx4 v9, s[8:11], s42 offen nt lds
  ds_read_b64_tr_b16 a[40:41], v7 offset:16384
  ds_read_b64_tr_b16 a[42:43], v7 offset:18432
  ds_read_b64_tr_b16 a[192:193], v7 offset:20480
  ds_read_b64_tr_b16 a[194:195], v7 offset:22528
  ds_read_b64_tr_b16 a[44:45], v7 offset:24576
  ds_read_b64_tr_b16 a[46:47], v7 offset:26624
  ds_read_b64_tr_b16 a[196:197], v7 offset:28672
  ds_read_b64_tr_b16 a[198:199], v7 offset:30720
  s_waitcnt vmcnt(24) lgkmcnt(0)
  s_barrier
  s_add_u32 m0, s41, 81920
  s_mov_b32 s42, 1703936
  buffer_load_dwordx4 v8, s[8:11], s42 offen nt lds
  s_add_u32 m0, s41, 86016
  s_mov_b32 s42, 1703936
  buffer_load_dwordx4 v9, s[8:11], s42 offen nt lds
  s_add_u32 m0, s41, 90112
  s_mov_b32 s42, 1769472
  buffer_load_dwordx4 v8, s[8:11], s42 offen nt lds
  s_add_u32 m0, s41, 94208
  s_mov_b32 s42, 1769472
  buffer_load_dwordx4 v9, s[8:11], s42 offen nt lds
  ds_read_b64_tr_b16 a[48:49], v7 offset:32768
  ds_read_b64_tr_b16 a[50:51], v7 offset:34816
  ds_read_b64_tr_b16 a[200:201], v7 offset:36864
  ds_read_b64_tr_b16 a[202:203], v7 offset:38912
  ds_read_b64_tr_b16 a[52:53], v7 offset:40960
  ds_read_b64_tr_b16 a[54:55], v7 offset:43008
  ds_read_b64_tr_b16 a[204:205], v7 offset:45056
  ds_read_b64_tr_b16 a[206:207], v7 offset:47104
  s_waitcnt vmcnt(24) lgkmcnt(0)
  s_barrier
  s_add_u32 m0, s41, 98304
  s_mov_b32 s42, 1835008
  buffer_load_dwordx4 v8, s[8:11], s42 offen nt lds
  s_add_u32 m0, s41, 102400
  s_mov_b32 s42, 1835008
  buffer_load_dwordx4 v9, s[8:11], s42 offen nt lds
  s_add_u32 m0, s41, 106496
  s_mov_b32 s42, 1900544
  buffer_load_dwordx4 v8, s[8:11], s42 offen nt lds
  s_add_u32 m0, s41, 110592
  s_mov_b32 s42, 1900544
  buffer_load_dwordx4 v9, s[8:11], s42 offen nt lds
  ds_read_b64_tr_b16 a[56:57], v7 offset:49152
  ds_read_b64_tr_b16 a[58:59], v7 offset:51200
  ds_read_b64_tr_b16 a[208:209], v7 offset:53248
  ds_read_b64_tr_b16 a[210:211], v7 offset:55296
  ds_read_b64_tr_b16 a[60:61], v7 offset:57344
  ds_read_b64_tr_b16 a[62:63], v7 offset:59392
  ds_read_b64_tr_b16 a[212:213], v7 offset:61440
  ds_read_b64_tr_b16 a[214:215], v7 offset:63488
  s_waitcnt vmcnt(24) lgkmcnt(0)
  s_barrier
  s_add_u32 m0, s41, 114688
  s_mov_b32 s42, 1966080
  buffer_load_dwordx4 v8, s[8:11], s42 offen nt lds
  s_add_u32 m0, s41, 118784
  s_mov_b32 s42, 1966080
  buffer_load_dwordx4 v9, s[8:11], s42 offen nt lds
  s_add_u32 m0, s41, 122880
  s_mov_b32 s42, 2031616
  buffer_load_dwordx4 v8, s[8:11], s42 offen nt lds
  s_add_u32 m0, s41, 126976
  s_mov_b32 s42, 2031616
  buffer_load_dwordx4 v9, s[8:11], s42 offen nt lds
  ds_read_b64_tr_b16 a[64:65], v6 offset:0
  ds_read_b64_tr_b16 a[66:67], v6 offset:2048
  ds_read_b64_tr_b16 a[216:217], v6 offset:4096
  ds_read_b64_tr_b16 a[218:219], v6 offset:6144
  ds_read_b64_tr_b16 a[68:69], v6 offset:8192
  ds_read_b64_tr_b16 a[70:71], v6 offset:10240
  ds_read_b64_tr_b16 a[220:221], v6 offset:12288
  ds_read_b64_tr_b16 a[222:223], v6 offset:14336
  s_waitcnt vmcnt(24) lgkmcnt(0)
  s_barrier
  s_add_u32 m0, s41, 0
  s_mov_b32 s42, 2097152
  buffer_load_dwordx4 v8, s[8:11], s42 offen nt lds
  s_add_u32 m0, s41, 4096
  s_mov_b32 s42, 2097152
  buffer_load_dwordx4 v9, s[8:11], s42 offen nt lds
  s_add_u32 m0, s41, 8192
  s_mov_b32 s42, 2162688
  buffer_load_dwordx4 v8, s[8:11], s42 offen nt lds
  s_add_u32 m0, s41, 12288
  s_mov_b32 s42, 2162688
  buffer_load_dwordx4 v9, s[8:11], s42 offen nt lds
  ds_read_b64_tr_b16 a[72:73], v6 offset:16384
  ds_read_b64_tr_b16 a[74:75], v6 offset:18432
  ds_read_b64_tr_b16 a[224:225], v6 offset:20480
  ds_read_b64_tr_b16 a[226:227], v6 offset:22528
  ds_read_b64_tr_b16 a[76:77], v6 offset:24576
  ds_read_b64_tr_b16 a[78:79], v6 offset:26624
  ds_read_b64_tr_b16 a[228:229], v6 offset:28672
  ds_read_b64_tr_b16 a[230:231], v6 offset:30720
  s_waitcnt vmcnt(24) lgkmcnt(0)
  s_barrier
  s_add_u32 m0, s41, 16384
  s_mov_b32 s42, 2228224
  buffer_load_dwordx4 v8, s[8:11], s42 offen nt lds
  s_add_u32 m0, s41, 20480
  s_mov_b32 s42, 2228224
  buffer_load_dwordx4 v9, s[8:11], s42 offen nt lds
  s_add_u32 m0, s41, 24576
  s_mov_b32 s42, 2293760
  buffer_load_dwordx4 v8, s[8:11], s42 offen nt lds
  s_add_u32 m0, s41, 28672
  s_mov_b32 s42, 2293760
  buffer_load_dwordx4 v9, s[8:11], s42 offen nt lds
  ds_read_b64_tr_b16 a[80:81], v6 offset:32768
  ds_read_b64_tr_b16 a[82:83], v6 offset:34816
  ds_read_b64_tr_b16 a[232:233], v6 offset:36864
  ds_read_b64_tr_b16 a[234:235], v6 offset:38912
  ds_read_b64_tr_b16 a[84:85], v6 offset:40960
  ds_read_b64_tr_b16 a[86:87], v6 offset:43008
  ds_read_b64_tr_b16 a[236:237], v6 offset:45056
  ds_read_b64_tr_b16 a[238:239], v6 offset:47104
  s_waitcnt vmcnt(24) lgkmcnt(0)
  s_barrier
  s_add_u32 m0, s41, 32768
  s_mov_b32 s42, 2359296
  buffer_load_dwordx4 v8, s[8:11], s42 offen nt lds
  s_add_u32 m0, s41, 36864
  s_mov_b32 s42, 2359296
  buffer_load_dwordx4 v9, s[8:11], s42 offen nt lds
  s_add_u32 m0, s41, 40960
  s_mov_b32 s42, 2424832
  buffer_load_dwordx4 v8, s[8:11], s42 offen nt lds
  s_add_u32 m0, s41, 45056
  s_mov_b32 s42, 2424832
  buffer_load_dwordx4 v9, s[8:11], s42 offen nt lds
  ds_read_b64_tr_b16 a[88:89], v6 offset:49152
  ds_read_b64_tr_b16 a[90:91], v6 offset:51200
  ds_read_b64_tr_b16 a[240:241], v6 offset:53248
  ds_read_b64_tr_b16 a[242:243], v6 offset:55296
  ds_read_b64_tr_b16 a[92:93], v6 offset:57344
  ds_read_b64_tr_b16 a[94:95], v6 offset:59392
  ds_read_b64_tr_b16 a[244:245], v6 offset:61440
  ds_read_b64_tr_b16 a[246:247], v6 offset:63488
  s_waitcnt vmcnt(24) lgkmcnt(0)
  s_barrier
  ds_read_b64_tr_b16 a[96:97], v7 offset:0
  ds_read_b64_tr_b16 a[98:99], v7 offset:2048
  ds_read_b64_tr_b16 a[248:249], v7 offset:4096
  ds_read_b64_tr_b16 a[250:251], v7 offset:6144
  ds_read_b64_tr_b16 a[100:101], v7 offset:8192
  ds_read_b64_tr_b16 a[102:103], v7 offset:10240
  ds_read_b64_tr_b16 a[252:253], v7 offset:12288
  ds_read_b64_tr_b16 a[254:255], v7 offset:14336
  s_waitcnt vmcnt(20) lgkmcnt(0)
  s_barrier
  ds_read_b64_tr_b16 a[104:105], v7 offset:16384
  ds_read_b64_tr_b16 a[106:107], v7 offset:18432
  ds_read_b64_tr_b16 v[128:129], v7 offset:20480
  ds_read_b64_tr_b16 v[130:131], v7 offset:22528
  ds_read_b64_tr_b16 a[108:109], v7 offset:24576
  ds_read_b64_tr_b16 a[110:111], v7 offset:26624
  ds_read_b64_tr_b16 v[132:133], v7 offset:28672
  ds_read_b64_tr_b16 v[134:135], v7 offset:30720
  s_waitcnt vmcnt(16) lgkmcnt(0)
  s_barrier
  ds_read_b64_tr_b16 a[112:113], v7 offset:32768
  ds_read_b64_tr_b16 a[114:115], v7 offset:34816
  ds_read_b64_tr_b16 v[136:137], v7 offset:36864
  ds_read_b64_tr_b16 v[138:139], v7 offset:38912
  ds_read_b64_tr_b16 a[116:117], v7 offset:40960
  ds_read_b64_tr_b16 a[118:119], v7 offset:43008
  ds_read_b64_tr_b16 v[140:141], v7 offset:45056
  ds_read_b64_tr_b16 v[142:143], v7 offset:47104
  s_waitcnt vmcnt(12) lgkmcnt(0)
  s_barrier
  ds_read_b64_tr_b16 a[120:121], v7 offset:49152
  ds_read_b64_tr_b16 a[122:123], v7 offset:51200
  ds_read_b64_tr_b16 v[144:145], v7 offset:53248
  ds_read_b64_tr_b16 v[146:147], v7 offset:55296
  ds_read_b64_tr_b16 a[124:125], v7 offset:57344
  ds_read_b64_tr_b16 a[126:127], v7 offset:59392
  ds_read_b64_tr_b16 v[148:149], v7 offset:61440
  ds_read_b64_tr_b16 v[150:151], v7 offset:63488
  s_waitcnt vmcnt(8) lgkmcnt(0)
  s_barrier
  ds_read_b64_tr_b16 a[128:129], v6 offset:0
  ds_read_b64_tr_b16 a[130:131], v6 offset:2048
  ds_read_b64_tr_b16 v[152:153], v6 offset:4096
  ds_read_b64_tr_b16 v[154:155], v6 offset:6144
  ds_read_b64_tr_b16 a[132:133], v6 offset:8192
  ds_read_b64_tr_b16 a[134:135], v6 offset:10240
  ds_read_b64_tr_b16 v[156:157], v6 offset:12288
  ds_read_b64_tr_b16 v[158:159], v6 offset:14336
  s_waitcnt vmcnt(4) lgkmcnt(0)
  s_barrier
  ds_read_b64_tr_b16 a[136:137], v6 offset:16384
  ds_read_b64_tr_b16 a[138:139], v6 offset:18432
  ds_read_b64_tr_b16 v[160:161], v6 offset:20480
  ds_read_b64_tr_b16 v[162:163], v6 offset:22528
  ds_read_b64_tr_b16 a[140:141], v6 offset:24576
  ds_read_b64_tr_b16 a[142:143], v6 offset:26624
  ds_read_b64_tr_b16 v[164:165], v6 offset:28672
  ds_read_b64_tr_b16 v[166:167], v6 offset:30720
  s_waitcnt vmcnt(0) lgkmcnt(0)
  s_barrier
  ds_read_b64_tr_b16 a[144:145], v6 offset:32768
  ds_read_b64_tr_b16 a[146:147], v6 offset:34816
  ds_read_b64_tr_b16 v[168:169], v6 offset:36864
  ds_read_b64_tr_b16 v[170:171], v6 offset:38912
  ds_read_b64_tr_b16 a[148:149], v6 offset:40960
  ds_read_b64_tr_b16 a[150:151], v6 offset:43008
  ds_read_b64_tr_b16 v[172:173], v6 offset:45056
  ds_read_b64_tr_b16 v[174:175], v6 offset:47104
  s_waitcnt lgkmcnt(0)
  s_barrier
  s_cmp_lt_u32 s21, 16
  s_cbranch_scc1 L_F2_keep
  v_accvgpr_write_b32 a0, 0
  v_accvgpr_write_b32 a1, 0
  v_accvgpr_write_b32 a2, 0
  v_accvgpr_write_b32 a3, 0
  v_accvgpr_write_b32 a4, 0
  v_accvgpr_write_b32 a5, 0
  v_accvgpr_write_b32 a6, 0
  v_accvgpr_write_b32 a7, 0
  v_accvgpr_write_b32 a152, 0
  v_accvgpr_write_b32 a153, 0
  v_accvgpr_write_b32 a154, 0
  v_accvgpr_write_b32 a155, 0
  v_accvgpr_write_b32 a156, 0
  v_accvgpr_write_b32 a157, 0
  v_accvgpr_write_b32 a158, 0
  v_accvgpr_write_b32 a159, 0
  s_nop 1
L_F2_keep:
  v_min_u32 v52, 63, v0
  v_lshlrev_b32 v52, 7, v52
  v_add_u32 v52, 1424384, v52
  s_nop 1
Lpoll_48:
  buffer_load_dword v53, v52, s[4:7], 0 offen sc1
  s_sub_u32 s24, s24, 1
  s_cbranch_scc1 L_FAIL
  s_waitcnt vmcnt(0)
  v_cmp_gt_i32 vcc, 0, v53
  s_cbranch_vccz Lpolld_49
  s_sleep 1
  s_branch Lpoll_48
Lpolld_49:
  v_lshrrev_b32 v53, 8, v53
  v_and_b32 v54, 3, v0
  v_lshl_or_b32 v53, v53, 2, v54
  s_nop 1
  v_min_u32_dpp v53, v53, v53 row_ror:8 row_mask:0xf bank_mask:0xf
  s_nop 1
  v_min_u32_dpp v53, v53, v53 row_ror:4 row_mask:0xf bank_mask:0xf
  v_mov_b32 v54, v53
  s_nop 1
  v_permlane16_swap_b32 v54, v53
  v_min_u32 v53, v53, v54
  v_mov_b32 v54, v53
  s_nop 1
  v_permlane32_swap_b32 v54, v53
  v_min_u32 v53, v53, v54
  s_nop 1
  v_min_u32_dpp v53, v53, v53 row_ror:2 row_mask:0xf bank_mask:0xf
  s_nop 1
  v_min_u32_dpp v53, v53, v53 row_ror:1 row_mask:0xf bank_mask:0xf
  s_nop 0
  v_readfirstlane_b32 s38, v53
  s_and_b32 s38, s38, 3
  s_lshl_b32 s38, s38, 13
  s_and_b32 s38, s38, 0x2000
  s_xor_b32 s38, s38, 20979712
  s_lshr_b32 s43, s21, 3
  s_mul_i32 s43, s43, 19
  s_min_u32 s43, s43, 37
  v_min_u32 v2, 18, v0
  v_add_u32 v2, s43, v2
  v_lshlrev_b32 v2, 7, v2
  v_add_u32 v2, 1414144, v2
  s_add_u32 s44, s43, s20
  s_min_u32 s45, s20, 2
  s_add_u32 s45, s45, s43
  s_lshr_b32 s40, s44, 1
  s_lshl_b32 s40, s40, 14
  s_and_b32 s41, s44, 1
  s_lshl_b32 s41, s41, 12
  s_add_u32 s27, s40, s41
  s_lshr_b32 s40, s45, 1
  s_lshl_b32 s40, s40, 14
  s_and_b32 s41, s45, 1
  s_lshl_b32 s41, s41, 12
  s_add_u32 s39, s40, s41
  s_sub_u32 s39, s39, s27
  s_add_u32 s27, s27, s38
  s_add_u32 s27, s27, 1179648
  s_lshl_b32 s62, s21, 7
  s_add_u32 s62, s62, 1421312
  s_lshl_b32 s40, s21, 14
  s_add_u32 s40, s40, s38
  s_add_u32 s31, s40, 524288
  s_lshl_b32 s40, s20, 11
  v_and_b32 v68, 3, v0
  v_lshlrev_b32 v68, 4, v68
  v_lshrrev_b32 v52, 4, v0
  v_lshl_add_u32 v68, v52, 6, v68
  v_bfe_u32 v52, v0, 2, 2
  v_lshl_add_u32 v68, v52, 8, v68
  v_add_u32 v68, s40, v68
  v_lshlrev_b32 v71, 2, v0
  v_add_u32 v71, 155648, v71
  s_mov_b32 s25, 0
  s_mov_b32 s26, 0
  s_mov_b32 s29, 1
  s_mov_b32 s30, 0
  s_mov_b32 s28, 0
L_F2_top:
  s_cmp_eq_u32 s28, 1
  s_cbranch_scc1 L_F2_go
  s_cmp_eq_u32 s28, 2
  s_cbranch_scc1 L_F2_mid
  s_cmp_lg_u32 s20, 0
  s_cbranch_scc1 L_F2_park
  buffer_load_dword v3, v2, s[4:7], s30 offen sc1
  s_waitcnt vmcnt(1)
  s_barrier
  s_mov_b32 s63, s25
  s_atomic_smax s63, s[4:5], s62 glc
Lnosig_50:
  s_cmp_ge_u32 s25, 64
  s_cbranch_scc1 L_END
  s_waitcnt vmcnt(0)
  v_cmp_gt_i32 vcc, s29, v3
  s_cbranch_vccz L_F2_issue
  s_nop 3
Lpoll_51:
  buffer_load_dword v3, v2, s[4:7], s30 offen sc1
  s_sub_u32 s24, s24, 1
  s_cbranch_scc1 L_FAIL
  s_waitcnt vmcnt(0)
  v_cmp_gt_i32 vcc, s29, v3
  s_cbranch_vccz Lpolld_52
  s_sleep 1
  s_branch Lpoll_51
Lpolld_52:
  s_branch L_F2_issue
L_F2_park:
  s_waitcnt vmcnt(0)
  s_barrier
  s_cmp_ge_u32 s25, 64
  s_cbranch_scc1 L_END
L_F2_issue:
  s_barrier
L_F2_mid:
  s_mov_b32 s34, s26
  s_mov_b32 s35, s27
  s_add_u32 s36, s32, 0
  s_add_u32 m0, s34, s36
  s_add_u32 s36, s35, 0
  buffer_load_dwordx4 v1, s[4:7], s36 offen offset:0 sc1 lds
  s_nop 0
  buffer_load_dwordx4 v1, s[4:7], s36 offen offset:1024 sc1 lds
  s_nop 0
  buffer_load_dwordx4 v1, s[4:7], s36 offen offset:2048 sc1 lds
  s_nop 0
  buffer_load_dwordx4 v1, s[4:7], s36 offen offset:3072 sc1 lds
  s_nop 0
  s_add_u32 s36, s32, 16384
  s_add_u32 m0, s34, s36
  s_add_u32 s36, s35, 32768
  buffer_load_dwordx4 v1, s[4:7], s36 offen offset:0 sc1 lds
  s_nop 0
  buffer_load_dwordx4 v1, s[4:7], s36 offen offset:1024 sc1 lds
  s_nop 0
  buffer_load_dwordx4 v1, s[4:7], s36 offen offset:2048 sc1 lds
  s_nop 0
  buffer_load_dwordx4 v1, s[4:7], s36 offen offset:3072 sc1 lds
  s_nop 0
  s_add_u32 s36, s32, 32768
  s_add_u32 m0, s34, s36
  s_add_u32 s36, s35, 65536
  buffer_load_dwordx4 v1, s[4:7], s36 offen offset:0 sc1 lds
  s_nop 0
  buffer_load_dwordx4 v1, s[4:7], s36 offen offset:1024 sc1 lds
  s_nop 0
  buffer_load_dwordx4 v1, s[4:7], s36 offen offset:2048 sc1 lds
  s_nop 0
  buffer_load_dwordx4 v1, s[4:7], s36 offen offset:3072 sc1 lds
  s_nop 0
  s_cmp_eq_u32 s28, 0
  s_cbranch_scc1 L_F2_go
  s_mov_b32 s28, 0
  s_waitcnt vmcnt(12)
  s_barrier
  s_cmp_lg_u32 s20, 0
  s_cbranch_scc1 Lnosig_53
  s_mov_b32 s63, s25
  s_atomic_smax s63, s[4:5], s62 glc
Lnosig_53:
L_F2_go:
  v_add_u32 v73, s26, v69
  v_add_u32 v74, s26, v70
  s_sub_u32 s26, 77824, s26
  s_add_u32 s27, s27, 2097152
  s_xor_b32 s27, s27, 0x2000
  s_add_u32 s29, s29, 1
  s_waitcnt vmcnt(8)
  s_barrier
  ds_read_b128 v[4:7], v73 offset:0
  ds_read_b128 v[8:11], v73 offset:1024
  ds_read_b128 v[12:15], v73 offset:2048
  ds_read_b128 v[16:19], v73 offset:3072
  ds_read_b128 v[20:23], v73 offset:4096
  ds_read_b128 v[24:27], v73 offset:5120
  s_waitcnt lgkmcnt(4)
  v_mfma_f32_16x16x32_bf16 v[36:39], a[0:3], v[4:7], 0
  ds_read_b128 v[28:31], v73 offset:6144
  v_mfma_f32_16x16x32_bf16 v[40:43], a[0:3], v[8:11], 0
  ds_read_b128 v[32:35], v73 offset:7168
  v_mfma_f32_16x16x32_bf16 v[44:47], a[152:155], v[4:7], 0
  s_add_u32 s36, s32, 49152
  s_add_u32 m0, s34, s36
  s_add_u32 s36, s35, 98304
  buffer_load_dwordx4 v1, s[4:7], s36 offen offset:0 sc1 lds
  v_mfma_f32_16x16x32_bf16 v[48:51], a[152:155], v[8:11], 0
  buffer_load_dwordx4 v1, s[4:7], s36 offen offset:1024 sc1 lds
  s_waitcnt lgkmcnt(4)
  v_mfma_f32_16x16x32_bf16 v[36:39], a[4:7], v[12:15], v[36:39]
  ds_read_b128 v[4:7], v73 offset:8192
  v_mfma_f32_16x16x32_bf16 v[40:43], a[4:7], v[16:19], v[40:43]
  ds_read_b128 v[8:11], v73 offset:9216
  v_mfma_f32_16x16x32_bf16 v[44:47], a[156:159], v[12:15], v[44:47]
  buffer_load_dwordx4 v1, s[4:7], s36 offen offset:2048 sc1 lds
  v_mfma_f32_16x16x32_bf16 v[48:51], a[156:159], v[16:19], v[48:51]
  buffer_load_dwordx4 v1, s[4:7], s36 offen offset:3072 sc1 lds
  s_waitcnt lgkmcnt(4)
  v_mfma_f32_16x16x32_bf16 v[36:39], a[8:11], v[20:23], v[36:39]
  ds_read_b128 v[12:15], v73 offset:10240
  v_mfma_f32_16x16x32_bf16 v[40:43], a[8:11], v[24:27], v[40:43]
  ds_read_b128 v[16:19], v73 offset:11264
  v_mfma_f32_16x16x32_bf16 v[44:47], a[160:163], v[20:23], v[44:47]
  s_add_u32 s36, s33, 65536
  s_add_u32 m0, s34, s36
  s_add_u32 s36, s35, 131072
  s_add_u32 s36, s36, s39
  buffer_load_dwordx4 v1, s[4:7], s36 offen offset:0 sc1 lds
  v_mfma_f32_16x16x32_bf16 v[48:51], a[160:163], v[24:27], v[48:51]
  buffer_load_dwordx4 v1, s[4:7], s36 offen offset:1024 sc1 lds
  s_waitcnt lgkmcnt(4)
  v_mfma_f32_16x16x32_bf16 v[36:39], a[12:15], v[28:31], v[36:39]
  ds_read_b128 v[20:23], v73 offset:12288
  v_mfma_f32_16x16x32_bf16 v[40:43], a[12:15], v[32:35], v[40:43]
  ds_read_b128 v[24:27], v73 offset:13312
  v_mfma_f32_16x16x32_bf16 v[44:47], a[164:167], v[28:31], v[44:47]
  buffer_load_dwordx4 v1, s[4:7], s36 offen offset:2048 sc1 lds
  v_mfma_f32_16x16x32_bf16 v[48:51], a[164:167], v[32:35], v[48:51]
  buffer_load_dwordx4 v1, s[4:7], s36 offen offset:3072 sc1 lds
  s_waitcnt lgkmcnt(4)
  v_mfma_f32_16x16x32_bf16 v[36:39], a[16:19], v[4:7], v[36:39]
  ds_read_b128 v[28:31], v73 offset:14336
  v_mfma_f32_16x16x32_bf16 v[40:43], a[16:19], v[8:11], v[40:43]
  ds_read_b128 v[32:35], v73 offset:15360
  v_mfma_f32_16x16x32_bf16 v[44:47], a[168:171], v[4:7], v[44:47]
  v_mfma_f32_16x16x32_bf16 v[48:51], a[168:171], v[8:11], v[48:51]
  s_waitcnt vmcnt(12)
  s_barrier
  s_mov_b32 s34, s26
  s_mov_b32 s35, s27
  s_waitcnt lgkmcnt(4)
  v_mfma_f32_16x16x32_bf16 v[36:39], a[20:23], v[12:15], v[36:39]
  ds_read_b128 v[4:7], v73 offset:16384
  v_mfma_f32_16x16x32_bf16 v[40:43], a[20:23], v[16:19], v[40:43]
  ds_read_b128 v[8:11], v73 offset:17408
  v_mfma_f32_16x16x32_bf16 v[44:47], a[172:175], v[12:15], v[44:47]
  v_mfma_f32_16x16x32_bf16 v[48:51], a[172:175], v[16:19], v[48:51]
  s_waitcnt lgkmcnt(4)
  v_mfma_f32_16x16x32_bf16 v[36:39], a[24:27], v[20:23], v[36:39]
  ds_read_b128 v[12:15], v73 offset:18432
  v_mfma_f32_16x16x32_bf16 v[40:43], a[24:27], v[24:27], v[40:43]
  ds_read_b128 v[16:19], v73 offset:19456
  v_mfma_f32_16x16x32_bf16 v[44:47], a[176:179], v[20:23], v[44:47]
  v_mfma_f32_16x16x32_bf16 v[48:51], a[176:179], v[24:27], v[48:51]
  s_waitcnt lgkmcnt(4)
  v_mfma_f32_16x16x32_bf16 v[36:39], a[28:31], v[28:31], v[36:39]
  ds_read_b128 v[20:23], v73 offset:20480
  v_mfma_f32_16x16x32_bf16 v[40:43], a[28:31], v[32:35], v[40:43]
  ds_read_b128 v[24:27], v73 offset:21504
  v_mfma_f32_16x16x32_bf16 v[44:47], a[180:183], v[28:31], v[44:47]
  v_mfma_f32_16x16x32_bf16 v[48:51], a[180:183], v[32:35], v[48:51]
  s_waitcnt lgkmcnt(4)
  v_mfma_f32_16x16x32_bf16 v[36:39], a[32:35], v[4:7], v[36:39]
  ds_read_b128 v[28:31], v73 offset:22528
  v_mfma_f32_16x16x32_bf16 v[40:43], a[32:35], v[8:11], v[40:43]
  ds_read_b128 v[32:35], v73 offset:23552
  v_mfma_f32_16x16x32_bf16 v[44:47], a[184:187], v[4:7], v[44:47]
  v_mfma_f32_16x16x32_bf16 v[48:51], a[184:187], v[8:11], v[48:51]
  s_waitcnt lgkmcnt(4)
  v_mfma_f32_16x16x32_bf16 v[36:39], a[36:39], v[12:15], v[36:39]
  ds_read_b128 v[4:7], v73 offset:24576
  v_mfma_f32_16x16x32_bf16 v[40:43], a[36:39], v[16:19], v[40:43]
  ds_read_b128 v[8:11], v73 offset:25600
  v_mfma_f32_16x16x32_bf16 v[44:47], a[188:191], v[12:15], v[44:47]
  v_mfma_f32_16x16x32_bf16 v[48:51], a[188:191], v[16:19], v[48:51]
  s_waitcnt lgkmcnt(4)
  v_mfma_f32_16x16x32_bf16 v[36:39], a[40:43], v[20:23], v[36:39]
  ds_read_b128 v[12:15], v73 offset:26624
  v_mfma_f32_16x16x32_bf16 v[40:43], a[40:43], v[24:27], v[40:43]
  ds_read_b128 v[16:19], v73 offset:27648
  v_mfma_f32_16x16x32_bf16 v[44:47], a[192:195], v[20:23], v[44:47]
  v_mfma_f32_16x16x32_bf16 v[48:51], a[192:195], v[24:27], v[48:51]
  s_waitcnt lgkmcnt(4)
  v_mfma_f32_16x16x32_bf16 v[36:39], a[44:47], v[28:31], v[36:39]
  ds_read_b128 v[20:23], v73 offset:28672
  v_mfma_f32_16x16x32_bf16 v[40:43], a[44:47], v[32:35], v[40:43]
  ds_read_b128 v[24:27], v73 offset:29696
  v_mfma_f32_16x16x32_bf16 v[44:47], a[196:199], v[28:31], v[44:47]
  v_mfma_f32_16x16x32_bf16 v[48:51], a[196:199], v[32:35], v[48:51]
  s_lshl_b32 s40, s20, 8
  s_add_u32 m0, s40, 155648
  s_cmp_eq_u32 s20, 0
  s_cselect_b32 s40, s30, 2147483392
  buffer_load_dword v2, s[4:7], s40 offen sc1 lds
  s_waitcnt lgkmcnt(4)
  v_mfma_f32_16x16x32_bf16 v[36:39], a[48:51], v[4:7], v[36:39]
  ds_read_b128 v[28:31], v73 offset:30720
  v_mfma_f32_16x16x32_bf16 v[40:43], a[48:51], v[8:11], v[40:43]
  ds_read_b128 v[32:35], v73 offset:31744
  v_mfma_f32_16x16x32_bf16 v[44:47], a[200:203], v[4:7], v[44:47]
  v_mfma_f32_16x16x32_bf16 v[48:51], a[200:203], v[8:11], v[48:51]
  s_waitcnt vmcnt(9)
  s_barrier
  s_lshl_b32 s40, s20, 1
  s_add_u32 s40, s40, 1
  s_cmp_lg_u32 s40, s28
  s_cbranch_scc1 L_F2_s2
  s_mov_b32 s63, s25
  s_atomic_smax s63, s[4:5], s62 glc
Lnosig_54:
L_F2_s2:
  s_waitcnt lgkmcnt(4)
  v_mfma_f32_16x16x32_bf16 v[36:39], a[52:55], v[12:15], v[36:39]
  ds_read_b128 v[4:7], v73 offset:32768
  v_mfma_f32_16x16x32_bf16 v[40:43], a[52:55], v[16:19], v[40:43]
  ds_read_b128 v[8:11], v73 offset:33792
  v_mfma_f32_16x16x32_bf16 v[44:47], a[204:207], v[12:15], v[44:47]
  v_mfma_f32_16x16x32_bf16 v[48:51], a[204:207], v[16:19], v[48:51]
  s_waitcnt lgkmcnt(4)
  v_mfma_f32_16x16x32_bf16 v[36:39], a[56:59], v[20:23], v[36:39]
  ds_read_b128 v[12:15], v73 offset:34816
  v_mfma_f32_16x16x32_bf16 v[40:43], a[56:59], v[24:27], v[40:43]
  ds_read_b128 v[16:19], v73 offset:35840
  v_mfma_f32_16x16x32_bf16 v[44:47], a[208:211], v[20:23], v[44:47]
  v_mfma_f32_16x16x32_bf16 v[48:51], a[208:211], v[24:27], v[48:51]
  s_waitcnt lgkmcnt(4)
  v_mfma_f32_16x16x32_bf16 v[36:39], a[60:63], v[28:31], v[36:39]
  ds_read_b128 v[20:23], v73 offset:36864
  v_mfma_f32_16x16x32_bf16 v[40:43], a[60:63], v[32:35], v[40:43]
  ds_read_b128 v[24:27], v73 offset:37888
  v_mfma_f32_16x16x32_bf16 v[44:47], a[212:215], v[28:31], v[44:47]
  v_mfma_f32_16x16x32_bf16 v[48:51], a[212:215], v[32:35], v[48:51]
  s_waitcnt lgkmcnt(4)
  v_mfma_f32_16x16x32_bf16 v[36:39], a[64:67], v[4:7], v[36:39]
  ds_read_b128 v[28:31], v73 offset:38912
  v_mfma_f32_16x16x32_bf16 v[40:43], a[64:67], v[8:11], v[40:43]
  ds_read_b128 v[32:35], v73 offset:39936
  v_mfma_f32_16x16x32_bf16 v[44:47], a[216:219], v[4:7], v[44:47]
  v_mfma_f32_16x16x32_bf16 v[48:51], a[216:219], v[8:11], v[48:51]
  s_waitcnt lgkmcnt(4)
  v_mfma_f32_16x16x32_bf16 v[36:39], a[68:71], v[12:15], v[36:39]
  ds_read_b128 v[4:7], v73 offset:40960
  v_mfma_f32_16x16x32_bf16 v[40:43], a[68:71], v[16:19], v[40:43]
  ds_read_b128 v[8:11], v73 offset:41984
  v_mfma_f32_16x16x32_bf16 v[44:47], a[220:223], v[12:15], v[44:47]
  v_mfma_f32_16x16x32_bf16 v[48:51], a[220:223], v[16:19], v[48:51]
  s_waitcnt lgkmcnt(4)
  v_mfma_f32_16x16x32_bf16 v[36:39], a[72:75], v[20:23], v[36:39]
  ds_read_b128 v[12:15], v73 offset:43008
  v_mfma_f32_16x16x32_bf16 v[40:43], a[72:75], v[24:27], v[40:43]
  ds_read_b128 v[16:19], v73 offset:44032
  v_mfma_f32_16x16x32_bf16 v[44:47], a[224:227], v[20:23], v[44:47]
  v_mfma_f32_16x16x32_bf16 v[48:51], a[224:227], v[24:27], v[48:51]
  s_waitcnt vmcnt(0)
  s_barrier
  ds_read_b32 v3, v71
  s_waitcnt lgkmcnt(4)
  v_mfma_f32_16x16x32_bf16 v[36:39], a[76:79], v[28:31], v[36:39]
  ds_read_b128 v[20:23], v73 offset:45056
  v_mfma_f32_16x16x32_bf16 v[40:43], a[76:79], v[32:35], v[40:43]
  ds_read_b128 v[24:27], v73 offset:46080
  v_mfma_f32_16x16x32_bf16 v[44:47], a[228:231], v[28:31], v[44:47]
  v_mfma_f32_16x16x32_bf16 v[48:51], a[228:231], v[32:35], v[48:51]
  s_waitcnt lgkmcnt(4)
  v_mfma_f32_16x16x32_bf16 v[36:39], a[80:83], v[4:7], v[36:39]
  ds_read_b128 v[28:31], v73 offset:47104
  v_mfma_f32_16x16x32_bf16 v[40:43], a[80:83], v[8:11], v[40:43]
  ds_read_b128 v[32:35], v73 offset:48128
  v_mfma_f32_16x16x32_bf16 v[44:47], a[232:235], v[4:7], v[44:47]
  v_mfma_f32_16x16x32_bf16 v[48:51], a[232:235], v[8:11], v[48:51]
  s_waitcnt lgkmcnt(4)
  v_cmp_gt_i32 vcc, s29, v3
  s_mov_b32 s28, 0
  s_cbranch_vccnz L_F2_nopf
  s_cmp_ge_u32 s25, 63
  s_cbranch_scc1 L_F2_nopf
  s_mov_b32 s28, 1
  s_waitcnt lgkmcnt(4)
  v_mfma_f32_16x16x32_bf16 v[36:39], a[84:87], v[12:15], v[36:39]
  ds_read_b128 v[4:7], v73 offset:49152
  v_mfma_f32_16x16x32_bf16 v[40:43], a[84:87], v[16:19], v[40:43]
  ds_read_b128 v[8:11], v73 offset:50176
  v_mfma_f32_16x16x32_bf16 v[44:47], a[236:239], v[12:15], v[44:47]
  s_add_u32 s36, s32, 0
  s_add_u32 m0, s34, s36
  s_add_u32 s36, s35, 0
  buffer_load_dwordx4 v1, s[4:7], s36 offen offset:0 sc1 lds
  v_mfma_f32_16x16x32_bf16 v[48:51], a[236:239], v[16:19], v[48:51]
  s_waitcnt lgkmcnt(4)
  v_mfma_f32_16x16x32_bf16 v[36:39], a[88:91], v[20:23], v[36:39]
  ds_read_b128 v[12:15], v73 offset:51200
  v_mfma_f32_16x16x32_bf16 v[40:43], a[88:91], v[24:27], v[40:43]
  ds_read_b128 v[16:19], v73 offset:52224
  v_mfma_f32_16x16x32_bf16 v[44:47], a[240:243], v[20:23], v[44:47]
  buffer_load_dwordx4 v1, s[4:7], s36 offen offset:1024 sc1 lds
  v_mfma_f32_16x16x32_bf16 v[48:51], a[240:243], v[24:27], v[48:51]
  s_waitcnt lgkmcnt(4)
  v_mfma_f32_16x16x32_bf16 v[36:39], a[92:95], v[28:31], v[36:39]
  ds_read_b128 v[20:23], v73 offset:53248
  v_mfma_f32_16x16x32_bf16 v[40:43], a[92:95], v[32:35], v[40:43]
  ds_read_b128 v[24:27], v73 offset:54272
  v_mfma_f32_16x16x32_bf16 v[44:47], a[244:247], v[28:31], v[44:47]
  buffer_load_dwordx4 v1, s[4:7], s36 offen offset:2048 sc1 lds
  v_mfma_f32_16x16x32_bf16 v[48:51], a[244:247], v[32:35], v[48:51]
  s_waitcnt lgkmcnt(4)
  v_mfma_f32_16x16x32_bf16 v[36:39], a[96:99], v[4:7], v[36:39]
  ds_read_b128 v[28:31], v73 offset:55296
  v_mfma_f32_16x16x32_bf16 v[40:43], a[96:99], v[8:11], v[40:43]
  ds_read_b128 v[32:35], v73 offset:56320
  v_mfma_f32_16x16x32_bf16 v[44:47], a[248:251], v[4:7], v[44:47]
  buffer_load_dwordx4 v1, s[4:7], s36 offen offset:3072 sc1 lds
  v_mfma_f32_16x16x32_bf16 v[48:51], a[248:251], v[8:11], v[48:51]
  s_waitcnt lgkmcnt(4)
  v_mfma_f32_16x16x32_bf16 v[36:39], a[100:103], v[12:15], v[36:39]
  ds_read_b128 v[4:7], v73 offset:57344
  v_mfma_f32_16x16x32_bf16 v[40:43], a[100:103], v[16:19], v[40:43]
  ds_read_b128 v[8:11], v73 offset:58368
  v_mfma_f32_16x16x32_bf16 v[44:47], a[252:255], v[12:15], v[44:47]
  s_add_u32 s36, s32, 16384
  s_add_u32 m0, s34, s36
  s_add_u32 s36, s35, 32768
  buffer_load_dwordx4 v1, s[4:7], s36 offen offset:0 sc1 lds
  v_mfma_f32_16x16x32_bf16 v[48:51], a[252:255], v[16:19], v[48:51]
  s_waitcnt lgkmcnt(4)
  v_mfma_f32_16x16x32_bf16 v[36:39], a[104:107], v[20:23], v[36:39]
  ds_read_b128 v[12:15], v73 offset:59392
  v_mfma_f32_16x16x32_bf16 v[40:43], a[104:107], v[24:27], v[40:43]
  ds_read_b128 v[16:19], v73 offset:60416
  v_mfma_f32_16x16x32_bf16 v[44:47], v[128:131], v[20:23], v[44:47]
  buffer_load_dwordx4 v1, s[4:7], s36 offen offset:1024 sc1 lds
  v_mfma_f32_16x16x32_bf16 v[48:51], v[128:131], v[24:27], v[48:51]
  s_waitcnt lgkmcnt(4)
  v_mfma_f32_16x16x32_bf16 v[36:39], a[108:111], v[28:31], v[36:39]
  ds_read_b128 v[20:23], v73 offset:61440
  v_mfma_f32_16x16x32_bf16 v[40:43], a[108:111], v[32:35], v[40:43]
  ds_read_b128 v[24:27], v73 offset:62464
  v_mfma_f32_16x16x32_bf16 v[44:47], v[132:135], v[28:31], v[44:47]
  buffer_load_dwordx4 v1, s[4:7], s36 offen offset:2048 sc1 lds
  v_mfma_f32_16x16x32_bf16 v[48:51], v[132:135], v[32:35], v[48:51]
  s_waitcnt lgkmcnt(4)
  v_mfma_f32_16x16x32_bf16 v[36:39], a[112:115], v[4:7], v[36:39]
  ds_read_b128 v[28:31], v73 offset:63488
  v_mfma_f32_16x16x32_bf16 v[40:43], a[112:115], v[8:11], v[40:43]
  ds_read_b128 v[32:35], v73 offset:64512
  v_mfma_f32_16x16x32_bf16 v[44:47], v[136:139], v[4:7], v[44:47]
  buffer_load_dwordx4 v1, s[4:7], s36 offen offset:3072 sc1 lds
  v_mfma_f32_16x16x32_bf16 v[48:51], v[136:139], v[8:11], v[48:51]
  s_waitcnt lgkmcnt(4)
  v_mfma_f32_16x16x32_bf16 v[36:39], a[116:119], v[12:15], v[36:39]
  ds_read_b128 v[4:7], v74 offset:0
  v_mfma_f32_16x16x32_bf16 v[40:43], a[116:119], v[16:19], v[40:43]
  ds_read_b128 v[8:11], v74 offset:1024
  v_mfma_f32_16x16x32_bf16 v[44:47], v[140:143], v[12:15], v[44:47]
  s_add_u32 s36, s32, 32768
  s_add_u32 m0, s34, s36
  s_add_u32 s36, s35, 65536
  buffer_load_dwordx4 v1, s[4:7], s36 offen offset:0 sc1 lds
  v_mfma_f32_16x16x32_bf16 v[48:51], v[140:143], v[16:19], v[48:51]
  s_waitcnt lgkmcnt(4)
  v_mfma_f32_16x16x32_bf16 v[36:39], a[120:123], v[20:23], v[36:39]
  ds_read_b128 v[12:15], v74 offset:2048
  v_mfma_f32_16x16x32_bf16 v[40:43], a[120:123], v[24:27], v[40:43]
  ds_read_b128 v[16:19], v74 offset:3072
  v_mfma_f32_16x16x32_bf16 v[44:47], v[144:147], v[20:23], v[44:47]
  buffer_load_dwordx4 v1, s[4:7], s36 offen offset:1024 sc1 lds
  v_mfma_f32_16x16x32_bf16 v[48:51], v[144:147], v[24:27], v[48:51]
  s_waitcnt lgkmcnt(4)
  v_mfma_f32_16x16x32_bf16 v[36:39], a[124:127], v[28:31], v[36:39]
  ds_read_b128 v[20:23], v74 offset:4096
  v_mfma_f32_16x16x32_bf16 v[40:43], a[124:127], v[32:35], v[40:43]
  ds_read_b128 v[24:27], v74 offset:5120
  v_mfma_f32_16x16x32_bf16 v[44:47], v[148:151], v[28:31], v[44:47]
  buffer_load_dwordx4 v1, s[4:7], s36 offen offset:2048 sc1 lds
  v_mfma_f32_16x16x32_bf16 v[48:51], v[148:151], v[32:35], v[48:51]
  s_waitcnt lgkmcnt(4)
  v_mfma_f32_16x16x32_bf16 v[36:39], a[128:131], v[4:7], v[36:39]
  ds_read_b128 v[28:31], v74 offset:6144
  v_mfma_f32_16x16x32_bf16 v[40:43], a[128:131], v[8:11], v[40:43]
  ds_read_b128 v[32:35], v74 offset:7168
  v_mfma_f32_16x16x32_bf16 v[44:47], v[152:155], v[4:7], v[44:47]
  buffer_load_dwordx4 v1, s[4:7], s36 offen offset:3072 sc1 lds
  v_mfma_f32_16x16x32_bf16 v[48:51], v[152:155], v[8:11], v[48:51]
  s_waitcnt lgkmcnt(4)
  v_mfma_f32_16x16x32_bf16 v[36:39], a[132:135], v[12:15], v[36:39]
  ds_read_b128 v[4:7], v74 offset:8192
  v_mfma_f32_16x16x32_bf16 v[40:43], a[132:135], v[16:19], v[40:43]
  ds_read_b128 v[8:11], v74 offset:9216
  v_mfma_f32_16x16x32_bf16 v[44:47], v[156:159], v[12:15], v[44:47]
  v_mfma_f32_16x16x32_bf16 v[48:51], v[156:159], v[16:19], v[48:51]
  s_waitcnt lgkmcnt(4)
  v_mfma_f32_16x16x32_bf16 v[36:39], a[136:139], v[20:23], v[36:39]
  ds_read_b128 v[12:15], v74 offset:10240
  v_mfma_f32_16x16x32_bf16 v[40:43], a[136:139], v[24:27], v[40:43]
  ds_read_b128 v[16:19], v74 offset:11264
  v_mfma_f32_16x16x32_bf16 v[44:47], v[160:163], v[20:23], v[44:47]
  v_mfma_f32_16x16x32_bf16 v[48:51], v[160:163], v[24:27], v[48:51]
  s_waitcnt lgkmcnt(4)
  v_mfma_f32_16x16x32_bf16 v[36:39], a[140:143], v[28:31], v[36:39]
  v_mfma_f32_16x16x32_bf16 v[40:43], a[140:143], v[32:35], v[40:43]
  v_mfma_f32_16x16x32_bf16 v[44:47], v[164:167], v[28:31], v[44:47]
  v_mfma_f32_16x16x32_bf16 v[48:51], v[164:167], v[32:35], v[48:51]
  s_waitcnt lgkmcnt(2)
  v_mfma_f32_16x16x32_bf16 v[36:39], a[144:147], v[4:7], v[36:39]
  v_mfma_f32_16x16x32_bf16 v[40:43], a[144:147], v[8:11], v[40:43]
  v_mfma_f32_16x16x32_bf16 v[44:47], v[168:171], v[4:7], v[44:47]
  v_mfma_f32_16x16x32_bf16 v[48:51], v[168:171], v[8:11], v[48:51]
  s_waitcnt lgkmcnt(0)
  v_mfma_f32_16x16x32_bf16 v[36:39], a[148:151], v[12:15], v[36:39]
  v_mfma_f32_16x16x32_bf16 v[40:43], a[148:151], v[16:19], v[40:43]
  v_mfma_f32_16x16x32_bf16 v[44:47], v[172:175], v[12:15], v[44:47]
  v_mfma_f32_16x16x32_bf16 v[48:51], v[172:175], v[16:19], v[48:51]
  s_nop 7
  s_branch L_F2_epi
L_F2_nopf:
  s_waitcnt lgkmcnt(4)
  v_mfma_f32_16x16x32_bf16 v[36:39], a[84:87], v[12:15], v[36:39]
  ds_read_b128 v[4:7], v73 offset:49152
  v_mfma_f32_16x16x32_bf16 v[40:43], a[84:87], v[16:19], v[40:43]
  ds_read_b128 v[8:11], v73 offset:50176
  v_mfma_f32_16x16x32_bf16 v[44:47], a[236:239], v[12:15], v[44:47]
  v_mfma_f32_16x16x32_bf16 v[48:51], a[236:239], v[16:19], v[48:51]
  s_waitcnt lgkmcnt(4)
  v_mfma_f32_16x16x32_bf16 v[36:39], a[88:91], v[20:23], v[36:39]
  ds_read_b128 v[12:15], v73 offset:51200
  v_mfma_f32_16x16x32_bf16 v[40:43], a[88:91], v[24:27], v[40:43]
  ds_read_b128 v[16:19], v73 offset:52224
  v_mfma_f32_16x16x32_bf16 v[44:47], a[240:243], v[20:23], v[44:47]
  v_mfma_f32_16x16x32_bf16 v[48:51], a[240:243], v[24:27], v[48:51]
  s_waitcnt lgkmcnt(4)
  v_mfma_f32_16x16x32_bf16 v[36:39], a[92:95], v[28:31], v[36:39]
  ds_read_b128 v[20:23], v73 offset:53248
  v_mfma_f32_16x16x32_bf16 v[40:43], a[92:95], v[32:35], v[40:43]
  ds_read_b128 v[24:27], v73 offset:54272
  v_mfma_f32_16x16x32_bf16 v[44:47], a[244:247], v[28:31], v[44:47]
  v_mfma_f32_16x16x32_bf16 v[48:51], a[244:247], v[32:35], v[48:51]
  s_waitcnt lgkmcnt(4)
  v_mfma_f32_16x16x32_bf16 v[36:39], a[96:99], v[4:7], v[36:39]
  ds_read_b128 v[28:31], v73 offset:55296
  v_mfma_f32_16x16x32_bf16 v[40:43], a[96:99], v[8:11], v[40:43]
  ds_read_b128 v[32:35], v73 offset:56320
  v_mfma_f32_16x16x32_bf16 v[44:47], a[248:251], v[4:7], v[44:47]
  v_mfma_f32_16x16x32_bf16 v[48:51], a[248:251], v[8:11], v[48:51]
  s_waitcnt lgkmcnt(4)
  v_mfma_f32_16x16x32_bf16 v[36:39], a[100:103], v[12:15], v[36:39]
  ds_read_b128 v[4:7], v73 offset:57344
  v_mfma_f32_16x16x32_bf16 v[40:43], a[100:103], v[16:19], v[40:43]
  ds_read_b128 v[8:11], v73 offset:58368
  v_mfma_f32_16x16x32_bf16 v[44:47], a[252:255], v[12:15], v[44:47]
  v_mfma_f32_16x16x32_bf16 v[48:51], a[252:255], v[16:19], v[48:51]
  s_waitcnt lgkmcnt(4)
  v_mfma_f32_16x16x32_bf16 v[36:39], a[104:107], v[20:23], v[36:39]
  ds_read_b128 v[12:15], v73 offset:59392
  v_mfma_f32_16x16x32_bf16 v[40:43], a[104:107], v[24:27], v[40:43]
  ds_read_b128 v[16:19], v73 offset:60416
  v_mfma_f32_16x16x32_bf16 v[44:47], v[128:131], v[20:23], v[44:47]
  v_mfma_f32_16x16x32_bf16 v[48:51], v[128:131], v[24:27], v[48:51]
  s_waitcnt lgkmcnt(4)
  v_mfma_f32_16x16x32_bf16 v[36:39], a[108:111], v[28:31], v[36:39]
  ds_read_b128 v[20:23], v73 offset:61440
  v_mfma_f32_16x16x32_bf16 v[40:43], a[108:111], v[32:35], v[40:43]
  ds_read_b128 v[24:27], v73 offset:62464
  v_mfma_f32_16x16x32_bf16 v[44:47], v[132:135], v[28:31], v[44:47]
  v_mfma_f32_16x16x32_bf16 v[48:51], v[132:135], v[32:35], v[48:51]
  s_waitcnt lgkmcnt(4)
  v_mfma_f32_16x16x32_bf16 v[36:39], a[112:115], v[4:7], v[36:39]
  ds_read_b128 v[28:31], v73 offset:63488
  v_mfma_f32_16x16x32_bf16 v[40:43], a[112:115], v[8:11], v[40:43]
  ds_read_b128 v[32:35], v73 offset:64512
  v_mfma_f32_16x16x32_bf16 v[44:47], v[136:139], v[4:7], v[44:47]
  v_mfma_f32_16x16x32_bf16 v[48:51], v[136:139], v[8:11], v[48:51]
  s_waitcnt lgkmcnt(4)
  v_mfma_f32_16x16x32_bf16 v[36:39], a[116:119], v[12:15], v[36:39]
  ds_read_b128 v[4:7], v74 offset:0
  v_mfma_f32_16x16x32_bf16 v[40:43], a[116:119], v[16:19], v[40:43]
  ds_read_b128 v[8:11], v74 offset:1024
  v_mfma_f32_16x16x32_bf16 v[44:47], v[140:143], v[12:15], v[44:47]
  v_mfma_f32_16x16x32_bf16 v[48:51], v[140:143], v[16:19], v[48:51]
  s_barrier
  s_lshl_b32 s40, s20, 8
  s_add_u32 m0, s40, 155648
  s_cmp_eq_u32 s20, 0
  s_cselect_b32 s40, s30, 2147483392
  buffer_load_dword v2, s[4:7], s40 offen sc1 lds
  s_waitcnt lgkmcnt(4)
  v_mfma_f32_16x16x32_bf16 v[36:39], a[120:123], v[20:23], v[36:39]
  ds_read_b128 v[12:15], v74 offset:2048
  v_mfma_f32_16x16x32_bf16 v[40:43], a[120:123], v[24:27], v[40:43]
  ds_read_b128 v[16:19], v74 offset:3072
  v_mfma_f32_16x16x32_bf16 v[44:47], v[144:147], v[20:23], v[44:47]
  v_mfma_f32_16x16x32_bf16 v[48:51], v[144:147], v[24:27], v[48:51]
  s_waitcnt lgkmcnt(4)
  v_mfma_f32_16x16x32_bf16 v[36:39], a[124:127], v[28:31], v[36:39]
  ds_read_b128 v[20:23], v74 offset:4096
  v_mfma_f32_16x16x32_bf16 v[40:43], a[124:127], v[32:35], v[40:43]
  ds_read_b128 v[24:27], v74 offset:5120
  v_mfma_f32_16x16x32_bf16 v[44:47], v[148:151], v[28:31], v[44:47]
  v_mfma_f32_16x16x32_bf16 v[48:51], v[148:151], v[32:35], v[48:51]
  s_waitcnt lgkmcnt(4)
  v_mfma_f32_16x16x32_bf16 v[36:39], a[128:131], v[4:7], v[36:39]
  ds_read_b128 v[28:31], v74 offset:6144
  v_mfma_f32_16x16x32_bf16 v[40:43], a[128:131], v[8:11], v[40:43]
  ds_read_b128 v[32:35], v74 offset:7168
  v_mfma_f32_16x16x32_bf16 v[44:47], v[152:155], v[4:7], v[44:47]
  v_mfma_f32_16x16x32_bf16 v[48:51], v[152:155], v[8:11], v[48:51]
  s_waitcnt lgkmcnt(4)
  v_mfma_f32_16x16x32_bf16 v[36:39], a[132:135], v[12:15], v[36:39]
  ds_read_b128 v[4:7], v74 offset:8192
  v_mfma_f32_16x16x32_bf16 v[40:43], a[132:135], v[16:19], v[40:43]
  ds_read_b128 v[8:11], v74 offset:9216
  v_mfma_f32_16x16x32_bf16 v[44:47], v[156:159], v[12:15], v[44:47]
  v_mfma_f32_16x16x32_bf16 v[48:51], v[156:159], v[16:19], v[48:51]
  s_waitcnt lgkmcnt(4)
  v_mfma_f32_16x16x32_bf16 v[36:39], a[136:139], v[20:23], v[36:39]
  ds_read_b128 v[12:15], v74 offset:10240
  v_mfma_f32_16x16x32_bf16 v[40:43], a[136:139], v[24:27], v[40:43]
  ds_read_b128 v[16:19], v74 offset:11264
  v_mfma_f32_16x16x32_bf16 v[44:47], v[160:163], v[20:23], v[44:47]
  v_mfma_f32_16x16x32_bf16 v[48:51], v[160:163], v[24:27], v[48:51]
  s_waitcnt lgkmcnt(4)
  v_mfma_f32_16x16x32_bf16 v[36:39], a[140:143], v[28:31], v[36:39]
  v_mfma_f32_16x16x32_bf16 v[40:43], a[140:143], v[32:35], v[40:43]
  v_mfma_f32_16x16x32_bf16 v[44:47], v[164:167], v[28:31], v[44:47]
  v_mfma_f32_16x16x32_bf16 v[48:51], v[164:167], v[32:35], v[48:51]
  s_waitcnt vmcnt(0)
  s_barrier
  ds_read_b32 v3, v71
  s_waitcnt lgkmcnt(2)
  v_mfma_f32_16x16x32_bf16 v[36:39], a[144:147], v[4:7], v[36:39]
  v_mfma_f32_16x16x32_bf16 v[40:43], a[144:147], v[8:11], v[40:43]
  v_mfma_f32_16x16x32_bf16 v[44:47], v[168:171], v[4:7], v[44:47]
  v_mfma_f32_16x16x32_bf16 v[48:51], v[168:171], v[8:11], v[48:51]
  s_waitcnt lgkmcnt(0)
  v_mfma_f32_16x16x32_bf16 v[36:39], a[148:151], v[12:15], v[36:39]
  v_mfma_f32_16x16x32_bf16 v[40:43], a[148:151], v[16:19], v[40:43]
  v_mfma_f32_16x16x32_bf16 v[44:47], v[172:175], v[12:15], v[44:47]
  v_mfma_f32_16x16x32_bf16 v[48:51], v[172:175], v[16:19], v[48:51]
  v_cmp_gt_i32 vcc, s29, v3
  s_cmp_eq_u64 vcc, 0
  s_cselect_b32 s28, 2, 0
  s_cmp_lt_u32 s25, 63
  s_cselect_b32 s28, s28, 0
L_F2_epi:
  v_cvt_pk_bf16_f32 v52, v36, v37
  v_cvt_pk_bf16_f32 v53, v38, v39
  v_cvt_pk_bf16_f32 v54, v44, v45
  v_cvt_pk_bf16_f32 v55, v46, v47
  buffer_store_dwordx4 v[52:55], v68, s[4:7], s31 offen offset:0 sc1
  v_cvt_pk_bf16_f32 v56, v40, v41
  v_cvt_pk_bf16_f32 v57, v42, v43
  v_cvt_pk_bf16_f32 v58, v48, v49
  v_cvt_pk_bf16_f32 v59, v50, v51
  buffer_store_dwordx4 v[56:59], v68, s[4:7], s31 offen offset:1024 sc1
  s_add_u32 s25, s25, 1
  s_add_u32 s31, s31, 2097152
  s_xor_b32 s31, s31, 0x2000
  s_branch L_F2_top
L_WOF:
  s_load_dwordx2 s[8:9], s[0:1], 40
  s_mov_b32 s10, 8388608
  s_mov_b32 s11, 0x20000
  s_waitcnt lgkmcnt(0)
  v_bfe_u32 v1, v0, 5, 1
  v_mul_u32_u24 v1, 131072, v1
  v_bfe_u32 v2, v0, 4, 1
  v_mul_u32_u24 v2, 8192, v2
  v_add_u32 v1, v1, v2
  v_bfe_u32 v2, v0, 3, 1
  v_mul_u32_u24 v2, 2048, v2
  v_add_u32 v1, v1, v2
  v_lshrrev_b32 v2, 3, v0
  v_and_b32 v2, 6, v2
  v_xor_b32 v2, v2, v0
  v_and_b32 v2, 7, v2
  v_lshl_add_u32 v1, v2, 4, v1
  v_bfe_u32 v2, v0, 3, 2
  v_xor_b32 v2, 0, v2
  v_lshlrev_b32 v2, 5, v2
  v_lshrrev_b32 v4, 2, v0
  v_lshl_add_u32 v4, v4, 7, v2
  v_and_b32 v2, 3, v0
  v_lshl_add_u32 v4, v2, 3, v4
  s_and_b32 s43, s21, 3
  s_lshl_b32 s43, s43, 2
  s_add_u32 s43, s43, s20
  s_lshr_b32 s44, s21, 2
  s_lshl_b32 s40, s43, 19
  s_lshl_b32 s41, s44, 7
  s_add_u32 s40, s40, s41
  v_add_u32 v1, s40, v1
  s_lshl_b32 s41, s20, 15
  v_add_u32 v4, s41, v4
  s_lshl_b32 s40, s44, 19
  s_lshl_b32 s45, s43, 14
  s_add_u32 s40, s40, s45
  v_lshl_add_u32 v3, v0, 4, s40
  v_xor_b32 v5, 32, v4
  v_xor_b32 v6, 64, v4
  v_xor_b32 v7, 96, v4
  s_add_u32 m0, s41, 0
  s_mov_b32 s42, 0
  buffer_load_dwordx4 v1, s[8:11], s42 offen nt lds
  s_add_u32 m0, s41, 1024
  s_mov_b32 s42, 16384
  buffer_load_dwordx4 v1, s[8:11], s42 offen nt lds
  s_add_u32 m0, s41, 2048
  s_mov_b32 s42, 4096
  buffer_load_dwordx4 v1, s[8:11], s42 offen nt lds
  s_add_u32 m0, s41, 3072
  s_mov_b32 s42, 20480
  buffer_load_dwordx4 v1, s[8:11], s42 offen nt lds
  s_add_u32 m0, s41, 4096
  s_mov_b32 s42, 32768
  buffer_load_dwordx4 v1, s[8:11], s42 offen nt lds
  s_add_u32 m0, s41, 5120
  s_mov_b32 s42, 49152
  buffer_load_dwordx4 v1, s[8:11], s42 offen nt lds
  s_add_u32 m0, s41, 6144
  s_mov_b32 s42, 36864
  buffer_load_dwordx4 v1, s[8:11], s42 offen nt lds
  s_add_u32 m0, s41, 7168
  s_mov_b32 s42, 53248
  buffer_load_dwordx4 v1, s[8:11], s42 offen nt lds
  s_add_u32 m0, s41, 8192
  s_mov_b32 s42, 65536
  buffer_load_dwordx4 v1, s[8:11], s42 offen nt lds
  s_add_u32 m0, s41, 9216
  s_mov_b32 s42, 81920
  buffer_load_dwordx4 v1, s[8:11], s42 offen nt lds
  s_add_u32 m0, s41, 10240
  s_mov_b32 s42, 69632
  buffer_load_dwordx4 v1, s[8:11], s42 offen nt lds
  s_add_u32 m0, s41, 11264
  s_mov_b32 s42, 86016
  buffer_load_dwordx4 v1, s[8:11], s42 offen nt lds
  s_add_u32 m0, s41, 12288
  s_mov_b32 s42, 98304
  buffer_load_dwordx4 v1, s[8:11], s42 offen nt lds
  s_add_u32 m0, s41, 13312
  s_mov_b32 s42, 114688
  buffer_load_dwordx4 v1, s[8:11], s42 offen nt lds
  s_add_u32 m0, s41, 14336
  s_mov_b32 s42, 102400
  buffer_load_dwordx4 v1, s[8:11], s42 offen nt lds
  s_add_u32 m0, s41, 15360
  s_mov_b32 s42, 118784
  buffer_load_dwordx4 v1, s[8:11], s42 offen nt lds
  s_add_u32 m0, s41, 16384
  s_mov_b32 s42, 262144
  buffer_load_dwordx4 v1, s[8:11], s42 offen nt lds
  s_add_u32 m0, s41, 17408
  s_mov_b32 s42, 278528
  buffer_load_dwordx4 v1, s[8:11], s42 offen nt lds
  s_add_u32 m0, s41, 18432
  s_mov_b32 s42, 266240
  buffer_load_dwordx4 v1, s[8:11], s42 offen nt lds
  s_add_u32 m0, s41, 19456
  s_mov_b32 s42, 282624
  buffer_load_dwordx4 v1, s[8:11], s42 offen nt lds
  s_add_u32 m0, s41, 20480
  s_mov_b32 s42, 294912
  buffer_load_dwordx4 v1, s[8:11], s42 offen nt lds
  s_add_u32 m0, s41, 21504
  s_mov_b32 s42, 311296
  buffer_load_dwordx4 v1, s[8:11], s42 offen nt lds
  s_add_u32 m0, s41, 22528
  s_mov_b32 s42, 299008
  buffer_load_dwordx4 v1, s[8:11], s42 offen nt lds
  s_add_u32 m0, s41, 23552
  s_mov_b32 s42, 315392
  buffer_load_dwordx4 v1, s[8:11], s42 offen nt lds
  s_add_u32 m0, s41, 24576
  s_mov_b32 s42, 327680
  buffer_load_dwordx4 v1, s[8:11], s42 offen nt lds
  s_add_u32 m0, s41, 25600
  s_mov_b32 s42, 344064
  buffer_load_dwordx4 v1, s[8:11], s42 offen nt lds
  s_add_u32 m0, s41, 26624
  s_mov_b32 s42, 331776
  buffer_load_dwordx4 v1, s[8:11], s42 offen nt lds
  s_add_u32 m0, s41, 27648
  s_mov_b32 s42, 348160
  buffer_load_dwordx4 v1, s[8:11], s42 offen nt lds
  s_add_u32 m0, s41, 28672
  s_mov_b32 s42, 360448
  buffer_load_dwordx4 v1, s[8:11], s42 offen nt lds
  s_add_u32 m0, s41, 29696
  s_mov_b32 s42, 376832
  buffer_load_dwordx4 v1, s[8:11], s42 offen nt lds
  s_add_u32 m0, s41, 30720
  s_mov_b32 s42, 364544
  buffer_load_dwordx4 v1, s[8:11], s42 offen nt lds
  s_add_u32 m0, s41, 31744
  s_mov_b32 s42, 380928
  buffer_load_dwordx4 v1, s[8:11], s42 offen nt lds
  s_waitcnt vmcnt(24)
  ds_read_b64_tr_b16 v[8:9], v4 offset:0
  ds_read_b64_tr_b16 v[10:11], v4 offset:2048
  ds_read_b64_tr_b16 v[12:13], v4 offset:4096
  ds_read_b64_tr_b16 v[14:15], v4 offset:6144
  ds_read_b64_tr_b16 v[16:17], v5 offset:0
  ds_read_b64_tr_b16 v[18:19], v5 offset:2048
  ds_read_b64_tr_b16 v[20:21], v5 offset:4096
  ds_read_b64_tr_b16 v[22:23], v5 offset:6144
  ds_read_b64_tr_b16 v[24:25], v6 offset:0
  ds_read_b64_tr_b16 v[26:27], v6 offset:2048
  ds_read_b64_tr_b16 v[28:29], v6 offset:4096
  ds_read_b64_tr_b16 v[30:31], v6 offset:6144
  ds_read_b64_tr_b16 v[32:33], v7 offset:0
  ds_read_b64_tr_b16 v[34:35], v7 offset:2048
  ds_read_b64_tr_b16 v[36:37], v7 offset:4096
  ds_read_b64_tr_b16 v[38:39], v7 offset:6144
  s_mov_b32 s42, 10485760
  s_waitcnt lgkmcnt(12)
  buffer_store_dwordx4 v[8:11], v3, s[4:7], s42 offen offset:0 sc1
  buffer_store_dwordx4 v[12:15], v3, s[4:7], s42 offen offset:1024 sc1
  s_mov_b32 s42, 10485760
  s_waitcnt lgkmcnt(8)
  buffer_store_dwordx4 v[16:19], v3, s[4:7], s42 offen offset:2048 sc1
  buffer_store_dwordx4 v[20:23], v3, s[4:7], s42 offen offset:3072 sc1
  s_mov_b32 s42, 10747904
  s_waitcnt lgkmcnt(4)
  buffer_store_dwordx4 v[24:27], v3, s[4:7], s42 offen offset:0 sc1
  buffer_store_dwordx4 v[28:31], v3, s[4:7], s42 offen offset:1024 sc1
  s_mov_b32 s42, 10747904
  s_waitcnt lgkmcnt(0)
  buffer_store_dwordx4 v[32:35], v3, s[4:7], s42 offen offset:2048 sc1
  buffer_store_dwordx4 v[36:39], v3, s[4:7], s42 offen offset:3072 sc1
  s_waitcnt vmcnt(24)
  ds_read_b64_tr_b16 v[40:41], v4 offset:8192
  ds_read_b64_tr_b16 v[42:43], v4 offset:10240
  ds_read_b64_tr_b16 v[44:45], v4 offset:12288
  ds_read_b64_tr_b16 v[46:47], v4 offset:14336
  ds_read_b64_tr_b16 v[48:49], v5 offset:8192
  ds_read_b64_tr_b16 v[50:51], v5 offset:10240
  ds_read_b64_tr_b16 v[52:53], v5 offset:12288
  ds_read_b64_tr_b16 v[54:55], v5 offset:14336
  ds_read_b64_tr_b16 v[56:57], v6 offset:8192
  ds_read_b64_tr_b16 v[58:59], v6 offset:10240
  ds_read_b64_tr_b16 v[60:61], v6 offset:12288
  ds_read_b64_tr_b16 v[62:63], v6 offset:14336
  ds_read_b64_tr_b16 v[64:65], v7 offset:8192
  ds_read_b64_tr_b16 v[66:67], v7 offset:10240
  ds_read_b64_tr_b16 v[68:69], v7 offset:12288
  ds_read_b64_tr_b16 v[70:71], v7 offset:14336
  s_mov_b32 s42, 10489856
  s_waitcnt lgkmcnt(12)
  buffer_store_dwordx4 v[40:43], v3, s[4:7], s42 offen offset:0 sc1
  buffer_store_dwordx4 v[44:47], v3, s[4:7], s42 offen offset:1024 sc1
  s_mov_b32 s42, 10489856
  s_waitcnt lgkmcnt(8)
  buffer_store_dwordx4 v[48:51], v3, s[4:7], s42 offen offset:2048 sc1
  buffer_store_dwordx4 v[52:55], v3, s[4:7], s42 offen offset:3072 sc1
  s_mov_b32 s42, 10752000
  s_waitcnt lgkmcnt(4)
  buffer_store_dwordx4 v[56:59], v3, s[4:7], s42 offen offset:0 sc1
  buffer_store_dwordx4 v[60:63], v3, s[4:7], s42 offen offset:1024 sc1
  s_mov_b32 s42, 10752000
  s_waitcnt lgkmcnt(0)
  buffer_store_dwordx4 v[64:67], v3, s[4:7], s42 offen offset:2048 sc1
  buffer_store_dwordx4 v[68:71], v3, s[4:7], s42 offen offset:3072 sc1
  s_waitcnt vmcnt(24)
  ds_read_b64_tr_b16 v[72:73], v4 offset:16384
  ds_read_b64_tr_b16 v[74:75], v4 offset:18432
  ds_read_b64_tr_b16 v[76:77], v4 offset:20480
  ds_read_b64_tr_b16 v[78:79], v4 offset:22528
  ds_read_b64_tr_b16 v[80:81], v5 offset:16384
  ds_read_b64_tr_b16 v[82:83], v5 offset:18432
  ds_read_b64_tr_b16 v[84:85], v5 offset:20480
  ds_read_b64_tr_b16 v[86:87], v5 offset:22528
  ds_read_b64_tr_b16 v[88:89], v6 offset:16384
  ds_read_b64_tr_b16 v[90:91], v6 offset:18432
  ds_read_b64_tr_b16 v[92:93], v6 offset:20480
  ds_read_b64_tr_b16 v[94:95], v6 offset:22528
  ds_read_b64_tr_b16 v[96:97], v7 offset:16384
  ds_read_b64_tr_b16 v[98:99], v7 offset:18432
  ds_read_b64_tr_b16 v[100:101], v7 offset:20480
  ds_read_b64_tr_b16 v[102:103], v7 offset:22528
  s_mov_b32 s42, 10493952
  s_waitcnt lgkmcnt(12)
  buffer_store_dwordx4 v[72:75], v3, s[4:7], s42 offen offset:0 sc1
  buffer_store_dwordx4 v[76:79], v3, s[4:7], s42 offen offset:1024 sc1
  s_mov_b32 s42, 10493952
  s_waitcnt lgkmcnt(8)
  buffer_store_dwordx4 v[80:83], v3, s[4:7], s42 offen offset:2048 sc1
  buffer_store_dwordx4 v[84:87], v3, s[4:7], s42 offen offset:3072 sc1
  s_mov_b32 s42, 10756096
  s_waitcnt lgkmcnt(4)
  buffer_store_dwordx4 v[88:91], v3, s[4:7], s42 offen offset:0 sc1
  buffer_store_dwordx4 v[92:95], v3, s[4:7], s42 offen offset:1024 sc1
  s_mov_b32 s42, 10756096
  s_waitcnt lgkmcnt(0)
  buffer_store_dwordx4 v[96:99], v3, s[4:7], s42 offen offset:2048 sc1
  buffer_store_dwordx4 v[100:103], v3, s[4:7], s42 offen offset:3072 sc1
  s_waitcnt vmcnt(24)
  ds_read_b64_tr_b16 v[104:105], v4 offset:24576
  ds_read_b64_tr_b16 v[106:107], v4 offset:26624
  ds_read_b64_tr_b16 v[108:109], v4 offset:28672
  ds_read_b64_tr_b16 v[110:111], v4 offset:30720
  ds_read_b64_tr_b16 v[112:113], v5 offset:24576
  ds_read_b64_tr_b16 v[114:115], v5 offset:26624
  ds_read_b64_tr_b16 v[116:117], v5 offset:28672
  ds_read_b64_tr_b16 v[118:119], v5 offset:30720
  ds_read_b64_tr_b16 v[120:121], v6 offset:24576
  ds_read_b64_tr_b16 v[122:123], v6 offset:26624
  ds_read_b64_tr_b16 v[124:125], v6 offset:28672
  ds_read_b64_tr_b16 v[126:127], v6 offset:30720
  ds_read_b64_tr_b16 v[128:129], v7 offset:24576
  ds_read_b64_tr_b16 v[130:131], v7 offset:26624
  ds_read_b64_tr_b16 v[132:133], v7 offset:28672
  ds_read_b64_tr_b16 v[134:135], v7 offset:30720
  s_mov_b32 s42, 10498048
  s_waitcnt lgkmcnt(12)
  buffer_store_dwordx4 v[104:107], v3, s[4:7], s42 offen offset:0 sc1
  buffer_store_dwordx4 v[108:111], v3, s[4:7], s42 offen offset:1024 sc1
  s_mov_b32 s42, 10498048
  s_waitcnt lgkmcnt(8)
  buffer_store_dwordx4 v[112:115], v3, s[4:7], s42 offen offset:2048 sc1
  buffer_store_dwordx4 v[116:119], v3, s[4:7], s42 offen offset:3072 sc1
  s_mov_b32 s42, 10760192
  s_waitcnt lgkmcnt(4)
  buffer_store_dwordx4 v[120:123], v3, s[4:7], s42 offen offset:0 sc1
  buffer_store_dwordx4 v[124:127], v3, s[4:7], s42 offen offset:1024 sc1
  s_mov_b32 s42, 10760192
  s_waitcnt lgkmcnt(0)
  buffer_store_dwordx4 v[128:131], v3, s[4:7], s42 offen offset:2048 sc1
  buffer_store_dwordx4 v[132:135], v3, s[4:7], s42 offen offset:3072 sc1
  v_min_u32 v1, 31, v0
  v_lshlrev_b32 v1, 2, v1
  v_add_u32 v1, 128, v1
  s_nop 1
Lpoll_55:
  buffer_load_dword v2, v1, s[12:15], 0 offen sc1
  s_sub_u32 s24, s24, 1
  s_cbranch_scc1 L_FAIL
  s_waitcnt vmcnt(0)
  v_cmp_gt_i32 vcc, 1, v2
  s_cbranch_vccz Lpolld_56
  s_sleep 2
  s_branch Lpoll_55
Lpolld_56:
  s_barrier
  s_lshl_b32 s40, s21, 7
  s_add_u32 s40, s40, 1432576
  s_cmp_lg_u32 s20, 0
  s_cbranch_scc1 Lnosig_57
  s_mov_b32 s63, 1
  s_atomic_smax s63, s[4:5], s40 glc
Lnosig_57:
  s_branch L_LN1
L_QK:
  v_bfe_u32 v76, v0, 3, 2
  v_xor_b32 v76, s20, v76
  v_lshlrev_b32 v76, 5, v76
  v_lshrrev_b32 v4, 2, v0
  v_lshl_add_u32 v4, v4, 7, v76
  v_and_b32 v76, 3, v0
  v_lshl_add_u32 v4, v76, 3, v4
  s_lshl_b32 s40, s20, 15
  v_add_u32 v4, s40, v4
  v_lshl_add_u32 v85, v0, 4, s40
  s_lshl_b32 s40, s20, 12
  s_add_u32 s40, s40, 131072
  v_lshl_add_u32 v1, v0, 4, s40
  s_lshr_b32 s54, s21, 4
  s_lshl_b32 s52, s54, 22
  s_sub_u32 s53, 0, s52
  v_xor_b32 v5, 32768, v4
  v_xor_b32 v2, 4096, v1
  v_xor_b32 v6, 65536, v4
  v_xor_b32 v3, 8192, v1
  v_xor_b32 v7, 98304, v4
  v_xor_b32 v84, 12288, v1
  v_bfe_u32 v8, v0, 5, 1
  v_mul_u32_u24 v8, 16384, v8
  v_bfe_u32 v76, v0, 4, 1
  v_mul_u32_u24 v76, 32768, v76
  v_add_u32 v8, v8, v76
  v_bfe_u32 v76, v0, 3, 1
  v_mul_u32_u24 v76, 131072, v76
  v_add_u32 v8, v8, v76
  v_lshrrev_b32 v76, 3, v0
  v_and_b32 v76, 6, v76
  v_xor_b32 v76, v76, v0
  v_and_b32 v76, 7, v76
  v_lshl_add_u32 v8, v76, 4, v8
  s_lshl_b32 s40, s20, 19
  v_add_u32 v8, s40, v8
  s_lshl_b32 s44, s21, 8
  s_add_u32 s45, s44, 128
  s_load_dwordx2 s[8:9], s[0:1], 16
  s_mov_b32 s10, 8388608
  s_mov_b32 s11, 0x20000
  s_waitcnt lgkmcnt(0)
  v_add_u32 v9, s44, v8
  v_add_u32 v10, s45, v8
  v_add_u32 v11, s44, v8
  v_add_u32 v12, s45, v8
  s_lshl_b32 s41, s20, 15
  s_add_u32 m0, s41, 0
  s_add_u32 s42, s52, 0
  buffer_load_dwordx4 v9, s[8:11], s42 offen lds
  s_add_u32 m0, s41, 1024
  s_add_u32 s42, s52, 65536
  buffer_load_dwordx4 v9, s[8:11], s42 offen lds
  s_add_u32 m0, s41, 2048
  s_add_u32 s42, s52, 8192
  buffer_load_dwordx4 v9, s[8:11], s42 offen lds
  s_add_u32 m0, s41, 3072
  s_add_u32 s42, s52, 73728
  buffer_load_dwordx4 v9, s[8:11], s42 offen lds
  s_add_u32 m0, s41, 4096
  s_add_u32 s42, s52, 262144
  buffer_load_dwordx4 v9, s[8:11], s42 offen lds
  s_add_u32 m0, s41, 5120
  s_add_u32 s42, s52, 327680
  buffer_load_dwordx4 v9, s[8:11], s42 offen lds
  s_add_u32 m0, s41, 6144
  s_add_u32 s42, s52, 270336
  buffer_load_dwordx4 v9, s[8:11], s42 offen lds
  s_add_u32 m0, s41, 7168
  s_add_u32 s42, s52, 335872
  buffer_load_dwordx4 v9, s[8:11], s42 offen lds
  s_add_u32 m0, s41, 8192
  s_add_u32 s42, s52, 2097152
  buffer_load_dwordx4 v9, s[8:11], s42 offen lds
  s_add_u32 m0, s41, 9216
  s_add_u32 s42, s52, 2162688
  buffer_load_dwordx4 v9, s[8:11], s42 offen lds
  s_add_u32 m0, s41, 10240
  s_add_u32 s42, s52, 2105344
  buffer_load_dwordx4 v9, s[8:11], s42 offen lds
  s_add_u32 m0, s41, 11264
  s_add_u32 s42, s52, 2170880
  buffer_load_dwordx4 v9, s[8:11], s42 offen lds
  s_add_u32 m0, s41, 12288
  s_add_u32 s42, s52, 2359296
  buffer_load_dwordx4 v9, s[8:11], s42 offen lds
  s_add_u32 m0, s41, 13312
  s_add_u32 s42, s52, 2424832
  buffer_load_dwordx4 v9, s[8:11], s42 offen lds
  s_add_u32 m0, s41, 14336
  s_add_u32 s42, s52, 2367488
  buffer_load_dwordx4 v9, s[8:11], s42 offen lds
  s_add_u32 m0, s41, 15360
  s_add_u32 s42, s52, 2433024
  buffer_load_dwordx4 v9, s[8:11], s42 offen lds
  s_add_u32 m0, s41, 16384
  s_add_u32 s42, s53, 4194304
  buffer_load_dwordx4 v9, s[8:11], s42 offen lds
  s_add_u32 m0, s41, 17408
  s_add_u32 s42, s53, 4259840
  buffer_load_dwordx4 v9, s[8:11], s42 offen lds
  s_add_u32 m0, s41, 18432
  s_add_u32 s42, s53, 4202496
  buffer_load_dwordx4 v9, s[8:11], s42 offen lds
  s_add_u32 m0, s41, 19456
  s_add_u32 s42, s53, 4268032
  buffer_load_dwordx4 v9, s[8:11], s42 offen lds
  s_add_u32 m0, s41, 20480
  s_add_u32 s42, s53, 4456448
  buffer_load_dwordx4 v9, s[8:11], s42 offen lds
  s_add_u32 m0, s41, 21504
  s_add_u32 s42, s53, 4521984
  buffer_load_dwordx4 v9, s[8:11], s42 offen lds
  s_add_u32 m0, s41, 22528
  s_add_u32 s42, s53, 4464640
  buffer_load_dwordx4 v9, s[8:11], s42 offen lds
  s_add_u32 m0, s41, 23552
  s_add_u32 s42, s53, 4530176
  buffer_load_dwordx4 v9, s[8:11], s42 offen lds
  s_waitcnt vmcnt(16) lgkmcnt(0)
  s_barrier
  s_add_u32 m0, s41, 24576
  s_add_u32 s42, s53, 6291456
  buffer_load_dwordx4 v9, s[8:11], s42 offen lds
  s_add_u32 m0, s41, 25600
  s_add_u32 s42, s53, 6356992
  buffer_load_dwordx4 v9, s[8:11], s42 offen lds
  s_add_u32 m0, s41, 26624
  s_add_u32 s42, s53, 6299648
  buffer_load_dwordx4 v9, s[8:11], s42 offen lds
  s_add_u32 m0, s41, 27648
  s_add_u32 s42, s53, 6365184
  buffer_load_dwordx4 v9, s[8:11], s42 offen lds
  s_add_u32 m0, s41, 28672
  s_add_u32 s42, s53, 6553600
  buffer_load_dwordx4 v9, s[8:11], s42 offen lds
  s_add_u32 m0, s41, 29696
  s_add_u32 s42, s53, 6619136
  buffer_load_dwordx4 v9, s[8:11], s42 offen lds
  s_add_u32 m0, s41, 30720
  s_add_u32 s42, s53, 6561792
  buffer_load_dwordx4 v9, s[8:11], s42 offen lds
  s_add_u32 m0, s41, 31744
  s_add_u32 s42, s53, 6627328
  buffer_load_dwordx4 v9, s[8:11], s42 offen lds
  ds_read_b64_tr_b16 a[0:1], v4 offset:0
  ds_read_b64_tr_b16 a[2:3], v4 offset:2048
  ds_read_b64_tr_b16 a[4:5], v4 offset:4096
  ds_read_b64_tr_b16 a[6:7], v4 offset:6144
  ds_read_b64_tr_b16 a[16:17], v5 offset:0
  ds_read_b64_tr_b16 a[18:19], v5 offset:2048
  ds_read_b64_tr_b16 a[20:21], v5 offset:4096
  ds_read_b64_tr_b16 a[22:23], v5 offset:6144
  ds_read_b64_tr_b16 a[32:33], v6 offset:0
  ds_read_b64_tr_b16 a[34:35], v6 offset:2048
  ds_read_b64_tr_b16 a[36:37], v6 offset:4096
  ds_read_b64_tr_b16 a[38:39], v6 offset:6144
  ds_read_b64_tr_b16 a[48:49], v7 offset:0
  ds_read_b64_tr_b16 a[50:51], v7 offset:2048
  ds_read_b64_tr_b16 a[52:53], v7 offset:4096
  ds_read_b64_tr_b16 a[54:55], v7 offset:6144
  s_waitcnt vmcnt(16) lgkmcnt(0)
  s_barrier
  s_add_u32 m0, s41, 0
  s_add_u32 s42, s52, 0
  buffer_load_dwordx4 v10, s[8:11], s42 offen lds
  s_add_u32 m0, s41, 1024
  s_add_u32 s42, s52, 65536
  buffer_load_dwordx4 v10, s[8:11], s42 offen lds
  s_add_u32 m0, s41, 2048
  s_add_u32 s42, s52, 8192
  buffer_load_dwordx4 v10, s[8:11], s42 offen lds
  s_add_u32 m0, s41, 3072
  s_add_u32 s42, s52, 73728
  buffer_load_dwordx4 v10, s[8:11], s42 offen lds
  s_add_u32 m0, s41, 4096
  s_add_u32 s42, s52, 262144
  buffer_load_dwordx4 v10, s[8:11], s42 offen lds
  s_add_u32 m0, s41, 5120
  s_add_u32 s42, s52, 327680
  buffer_load_dwordx4 v10, s[8:11], s42 offen lds
  s_add_u32 m0, s41, 6144
  s_add_u32 s42, s52, 270336
  buffer_load_dwordx4 v10, s[8:11], s42 offen lds
  s_add_u32 m0, s41, 7168
  s_add_u32 s42, s52, 335872
  buffer_load_dwordx4 v10, s[8:11], s42 offen lds
  ds_read_b64_tr_b16 a[8:9], v4 offset:8192
  ds_read_b64_tr_b16 a[10:11], v4 offset:10240
  ds_read_b64_tr_b16 a[12:13], v4 offset:12288
  ds_read_b64_tr_b16 a[14:15], v4 offset:14336
  ds_read_b64_tr_b16 a[24:25], v5 offset:8192
  ds_read_b64_tr_b16 a[26:27], v5 offset:10240
  ds_read_b64_tr_b16 a[28:29], v5 offset:12288
  ds_read_b64_tr_b16 a[30:31], v5 offset:14336
  ds_read_b64_tr_b16 a[40:41], v6 offset:8192
  ds_read_b64_tr_b16 a[42:43], v6 offset:10240
  ds_read_b64_tr_b16 a[44:45], v6 offset:12288
  ds_read_b64_tr_b16 a[46:47], v6 offset:14336
  ds_read_b64_tr_b16 a[56:57], v7 offset:8192
  ds_read_b64_tr_b16 a[58:59], v7 offset:10240
  ds_read_b64_tr_b16 a[60:61], v7 offset:12288
  ds_read_b64_tr_b16 a[62:63], v7 offset:14336
  s_waitcnt vmcnt(16) lgkmcnt(0)
  s_barrier
  s_add_u32 m0, s41, 8192
  s_add_u32 s42, s52, 2097152
  buffer_load_dwordx4 v10, s[8:11], s42 offen lds
  s_add_u32 m0, s41, 9216
  s_add_u32 s42, s52, 2162688
  buffer_load_dwordx4 v10, s[8:11], s42 offen lds
  s_add_u32 m0, s41, 10240
  s_add_u32 s42, s52, 2105344
  buffer_load_dwordx4 v10, s[8:11], s42 offen lds
  s_add_u32 m0, s41, 11264
  s_add_u32 s42, s52, 2170880
  buffer_load_dwordx4 v10, s[8:11], s42 offen lds
  s_add_u32 m0, s41, 12288
  s_add_u32 s42, s52, 2359296
  buffer_load_dwordx4 v10, s[8:11], s42 offen lds
  s_add_u32 m0, s41, 13312
  s_add_u32 s42, s52, 2424832
  buffer_load_dwordx4 v10, s[8:11], s42 offen lds
  s_add_u32 m0, s41, 14336
  s_add_u32 s42, s52, 2367488
  buffer_load_dwordx4 v10, s[8:11], s42 offen lds
  s_add_u32 m0, s41, 15360
  s_add_u32 s42, s52, 2433024
  buffer_load_dwordx4 v10, s[8:11], s42 offen lds
  ds_read_b64_tr_b16 a[64:65], v4 offset:16384
  ds_read_b64_tr_b16 a[66:67], v4 offset:18432
  ds_read_b64_tr_b16 a[68:69], v4 offset:20480
  ds_read_b64_tr_b16 a[70:71], v4 offset:22528
  ds_read_b64_tr_b16 a[80:81], v5 offset:16384
  ds_read_b64_tr_b16 a[82:83], v5 offset:18432
  ds_read_b64_tr_b16 a[84:85], v5 offset:20480
  ds_read_b64_tr_b16 a[86:87], v5 offset:22528
  ds_read_b64_tr_b16 a[96:97], v6 offset:16384
  ds_read_b64_tr_b16 a[98:99], v6 offset:18432
  ds_read_b64_tr_b16 a[100:101], v6 offset:20480
  ds_read_b64_tr_b16 a[102:103], v6 offset:22528
  ds_read_b64_tr_b16 a[112:113], v7 offset:16384
  ds_read_b64_tr_b16 a[114:115], v7 offset:18432
  ds_read_b64_tr_b16 a[116:117], v7 offset:20480
  ds_read_b64_tr_b16 a[118:119], v7 offset:22528
  s_waitcnt vmcnt(16) lgkmcnt(0)
  s_barrier
  s_add_u32 m0, s41, 16384
  s_add_u32 s42, s53, 4194304
  buffer_load_dwordx4 v10, s[8:11], s42 offen lds
  s_add_u32 m0, s41, 17408
  s_add_u32 s42, s53, 4259840
  buffer_load_dwordx4 v10, s[8:11], s42 offen lds
  s_add_u32 m0, s41, 18432
  s_add_u32 s42, s53, 4202496
  buffer_load_dwordx4 v10, s[8:11], s42 offen lds
  s_add_u32 m0, s41, 19456
  s_add_u32 s42, s53, 4268032
  buffer_load_dwordx4 v10, s[8:11], s42 offen lds
  s_add_u32 m0, s41, 20480
  s_add_u32 s42, s53, 4456448
  buffer_load_dwordx4 v10, s[8:11], s42 offen lds
  s_add_u32 m0, s41, 21504
  s_add_u32 s42, s53, 4521984
  buffer_load_dwordx4 v10, s[8:11], s42 offen lds
  s_add_u32 m0, s41, 22528
  s_add_u32 s42, s53, 4464640
  buffer_load_dwordx4 v10, s[8:11], s42 offen lds
  s_add_u32 m0, s41, 23552
  s_add_u32 s42, s53, 4530176
  buffer_load_dwordx4 v10, s[8:11], s42 offen lds
  ds_read_b64_tr_b16 a[72:73], v4 offset:24576
  ds_read_b64_tr_b16 a[74:75], v4 offset:26624
  ds_read_b64_tr_b16 a[76:77], v4 offset:28672
  ds_read_b64_tr_b16 a[78:79], v4 offset:30720
  ds_read_b64_tr_b16 a[88:89], v5 offset:24576
  ds_read_b64_tr_b16 a[90:91], v5 offset:26624
  ds_read_b64_tr_b16 a[92:93], v5 offset:28672
  ds_read_b64_tr_b16 a[94:95], v5 offset:30720
  ds_read_b64_tr_b16 a[104:105], v6 offset:24576
  ds_read_b64_tr_b16 a[106:107], v6 offset:26624
  ds_read_b64_tr_b16 a[108:109], v6 offset:28672
  ds_read_b64_tr_b16 a[110:111], v6 offset:30720
  ds_read_b64_tr_b16 a[120:121], v7 offset:24576
  ds_read_b64_tr_b16 a[122:123], v7 offset:26624
  ds_read_b64_tr_b16 a[124:125], v7 offset:28672
  ds_read_b64_tr_b16 a[126:127], v7 offset:30720
  s_waitcnt vmcnt(16) lgkmcnt(0)
  s_barrier
  s_add_u32 m0, s41, 24576
  s_add_u32 s42, s53, 6291456
  buffer_load_dwordx4 v10, s[8:11], s42 offen lds
  s_add_u32 m0, s41, 25600
  s_add_u32 s42, s53, 6356992
  buffer_load_dwordx4 v10, s[8:11], s42 offen lds
  s_add_u32 m0, s41, 26624
  s_add_u32 s42, s53, 6299648
  buffer_load_dwordx4 v10, s[8:11], s42 offen lds
  s_add_u32 m0, s41, 27648
  s_add_u32 s42, s53, 6365184
  buffer_load_dwordx4 v10, s[8:11], s42 offen lds
  s_add_u32 m0, s41, 28672
  s_add_u32 s42, s53, 6553600
  buffer_load_dwordx4 v10, s[8:11], s42 offen lds
  s_add_u32 m0, s41, 29696
  s_add_u32 s42, s53, 6619136
  buffer_load_dwordx4 v10, s[8:11], s42 offen lds
  s_add_u32 m0, s41, 30720
  s_add_u32 s42, s53, 6561792
  buffer_load_dwordx4 v10, s[8:11], s42 offen lds
  s_add_u32 m0, s41, 31744
  s_add_u32 s42, s53, 6627328
  buffer_load_dwordx4 v10, s[8:11], s42 offen lds
  ds_read_b64_tr_b16 a[128:129], v4 offset:0
  ds_read_b64_tr_b16 a[130:131], v4 offset:2048
  ds_read_b64_tr_b16 a[132:133], v4 offset:4096
  ds_read_b64_tr_b16 a[134:135], v4 offset:6144
  ds_read_b64_tr_b16 a[144:145], v5 offset:0
  ds_read_b64_tr_b16 a[146:147], v5 offset:2048
  ds_read_b64_tr_b16 a[148:149], v5 offset:4096
  ds_read_b64_tr_b16 a[150:151], v5 offset:6144
  ds_read_b64_tr_b16 a[160:161], v6 offset:0
  ds_read_b64_tr_b16 a[162:163], v6 offset:2048
  ds_read_b64_tr_b16 a[164:165], v6 offset:4096
  ds_read_b64_tr_b16 a[166:167], v6 offset:6144
  ds_read_b64_tr_b16 a[176:177], v7 offset:0
  ds_read_b64_tr_b16 a[178:179], v7 offset:2048
  ds_read_b64_tr_b16 a[180:181], v7 offset:4096
  ds_read_b64_tr_b16 a[182:183], v7 offset:6144
  s_waitcnt vmcnt(16) lgkmcnt(0)
  s_barrier
  s_load_dwordx2 s[8:9], s[0:1], 24
  s_mov_b32 s10, 8388608
  s_mov_b32 s11, 0x20000
  s_waitcnt lgkmcnt(0)
  s_add_u32 m0, s41, 0
  s_add_u32 s42, s52, 0
  buffer_load_dwordx4 v11, s[8:11], s42 offen lds
  s_add_u32 m0, s41, 1024
  s_add_u32 s42, s52, 65536
  buffer_load_dwordx4 v11, s[8:11], s42 offen lds
  s_add_u32 m0, s41, 2048
  s_add_u32 s42, s52, 8192
  buffer_load_dwordx4 v11, s[8:11], s42 offen lds
  s_add_u32 m0, s41, 3072
  s_add_u32 s42, s52, 73728
  buffer_load_dwordx4 v11, s[8:11], s42 offen lds
  s_add_u32 m0, s41, 4096
  s_add_u32 s42, s52, 262144
  buffer_load_dwordx4 v11, s[8:11], s42 offen lds
  s_add_u32 m0, s41, 5120
  s_add_u32 s42, s52, 327680
  buffer_load_dwordx4 v11, s[8:11], s42 offen lds
  s_add_u32 m0, s41, 6144
  s_add_u32 s42, s52, 270336
  buffer_load_dwordx4 v11, s[8:11], s42 offen lds
  s_add_u32 m0, s41, 7168
  s_add_u32 s42, s52, 335872
  buffer_load_dwordx4 v11, s[8:11], s42 offen lds
  ds_read_b64_tr_b16 a[136:137], v4 offset:8192
  ds_read_b64_tr_b16 a[138:139], v4 offset:10240
  ds_read_b64_tr_b16 a[140:141], v4 offset:12288
  ds_read_b64_tr_b16 a[142:143], v4 offset:14336
  ds_read_b64_tr_b16 a[152:153], v5 offset:8192
  ds_read_b64_tr_b16 a[154:155], v5 offset:10240
  ds_read_b64_tr_b16 a[156:157], v5 offset:12288
  ds_read_b64_tr_b16 a[158:159], v5 offset:14336
  ds_read_b64_tr_b16 a[168:169], v6 offset:8192
  ds_read_b64_tr_b16 a[170:171], v6 offset:10240
  ds_read_b64_tr_b16 a[172:173], v6 offset:12288
  ds_read_b64_tr_b16 a[174:175], v6 offset:14336
  ds_read_b64_tr_b16 a[184:185], v7 offset:8192
  ds_read_b64_tr_b16 a[186:187], v7 offset:10240
  ds_read_b64_tr_b16 a[188:189], v7 offset:12288
  ds_read_b64_tr_b16 a[190:191], v7 offset:14336
  s_waitcnt vmcnt(16) lgkmcnt(0)
  s_barrier
  s_add_u32 m0, s41, 8192
  s_add_u32 s42, s52, 2097152
  buffer_load_dwordx4 v11, s[8:11], s42 offen lds
  s_add_u32 m0, s41, 9216
  s_add_u32 s42, s52, 2162688
  buffer_load_dwordx4 v11, s[8:11], s42 offen lds
  s_add_u32 m0, s41, 10240
  s_add_u32 s42, s52, 2105344
  buffer_load_dwordx4 v11, s[8:11], s42 offen lds
  s_add_u32 m0, s41, 11264
  s_add_u32 s42, s52, 2170880
  buffer_load_dwordx4 v11, s[8:11], s42 offen lds
  s_add_u32 m0, s41, 12288
  s_add_u32 s42, s52, 2359296
  buffer_load_dwordx4 v11, s[8:11], s42 offen lds
  s_add_u32 m0, s41, 13312
  s_add_u32 s42, s52, 2424832
  buffer_load_dwordx4 v11, s[8:11], s42 offen lds
  s_add_u32 m0, s41, 14336
  s_add_u32 s42, s52, 2367488
  buffer_load_dwordx4 v11, s[8:11], s42 offen lds
  s_add_u32 m0, s41, 15360
  s_add_u32 s42, s52, 2433024
  buffer_load_dwordx4 v11, s[8:11], s42 offen lds
  ds_read_b64_tr_b16 a[192:193], v4 offset:16384
  ds_read_b64_tr_b16 a[194:195], v4 offset:18432
  ds_read_b64_tr_b16 a[196:197], v4 offset:20480
  ds_read_b64_tr_b16 a[198:199], v4 offset:22528
  ds_read_b64_tr_b16 a[208:209], v5 offset:16384
  ds_read_b64_tr_b16 a[210:211], v5 offset:18432
  ds_read_b64_tr_b16 a[212:213], v5 offset:20480
  ds_read_b64_tr_b16 a[214:215], v5 offset:22528
  ds_read_b64_tr_b16 a[224:225], v6 offset:16384
  ds_read_b64_tr_b16 a[226:227], v6 offset:18432
  ds_read_b64_tr_b16 a[228:229], v6 offset:20480
  ds_read_b64_tr_b16 a[230:231], v6 offset:22528
  ds_read_b64_tr_b16 a[240:241], v7 offset:16384
  ds_read_b64_tr_b16 a[242:243], v7 offset:18432
  ds_read_b64_tr_b16 a[244:245], v7 offset:20480
  ds_read_b64_tr_b16 a[246:247], v7 offset:22528
  s_waitcnt vmcnt(16) lgkmcnt(0)
  s_barrier
  s_add_u32 m0, s41, 16384
  s_add_u32 s42, s53, 4194304
  buffer_load_dwordx4 v11, s[8:11], s42 offen lds
  s_add_u32 m0, s41, 17408
  s_add_u32 s42, s53, 4259840
  buffer_load_dwordx4 v11, s[8:11], s42 offen lds
  s_add_u32 m0, s41, 18432
  s_add_u32 s42, s53, 4202496
  buffer_load_dwordx4 v11, s[8:11], s42 offen lds
  s_add_u32 m0, s41, 19456
  s_add_u32 s42, s53, 4268032
  buffer_load_dwordx4 v11, s[8:11], s42 offen lds
  s_add_u32 m0, s41, 20480
  s_add_u32 s42, s53, 4456448
  buffer_load_dwordx4 v11, s[8:11], s42 offen lds
  s_add_u32 m0, s41, 21504
  s_add_u32 s42, s53, 4521984
  buffer_load_dwordx4 v11, s[8:11], s42 offen lds
  s_add_u32 m0, s41, 22528
  s_add_u32 s42, s53, 4464640
  buffer_load_dwordx4 v11, s[8:11], s42 offen lds
  s_add_u32 m0, s41, 23552
  s_add_u32 s42, s53, 4530176
  buffer_load_dwordx4 v11, s[8:11], s42 offen lds
  ds_read_b64_tr_b16 a[200:201], v4 offset:24576
  ds_read_b64_tr_b16 a[202:203], v4 offset:26624
  ds_read_b64_tr_b16 a[204:205], v4 offset:28672
  ds_read_b64_tr_b16 a[206:207], v4 offset:30720
  ds_read_b64_tr_b16 a[216:217], v5 offset:24576
  ds_read_b64_tr_b16 a[218:219], v5 offset:26624
  ds_read_b64_tr_b16 a[220:221], v5 offset:28672
  ds_read_b64_tr_b16 a[222:223], v5 offset:30720
  ds_read_b64_tr_b16 a[232:233], v6 offset:24576
  ds_read_b64_tr_b16 a[234:235], v6 offset:26624
  ds_read_b64_tr_b16 a[236:237], v6 offset:28672
  ds_read_b64_tr_b16 a[238:239], v6 offset:30720
  ds_read_b64_tr_b16 a[248:249], v7 offset:24576
  ds_read_b64_tr_b16 a[250:251], v7 offset:26624
  ds_read_b64_tr_b16 a[252:253], v7 offset:28672
  ds_read_b64_tr_b16 a[254:255], v7 offset:30720
  s_waitcnt vmcnt(16) lgkmcnt(0)
  s_barrier
  s_add_u32 m0, s41, 24576
  s_add_u32 s42, s53, 6291456
  buffer_load_dwordx4 v11, s[8:11], s42 offen lds
  s_add_u32 m0, s41, 25600
  s_add_u32 s42, s53, 6356992
  buffer_load_dwordx4 v11, s[8:11], s42 offen lds
  s_add_u32 m0, s41, 26624
  s_add_u32 s42, s53, 6299648
  buffer_load_dwordx4 v11, s[8:11], s42 offen lds
  s_add_u32 m0, s41, 27648
  s_add_u32 s42, s53, 6365184
  buffer_load_dwordx4 v11, s[8:11], s42 offen lds
  s_add_u32 m0, s41, 28672
  s_add_u32 s42, s53, 6553600
  buffer_load_dwordx4 v11, s[8:11], s42 offen lds
  s_add_u32 m0, s41, 29696
  s_add_u32 s42, s53, 6619136
  buffer_load_dwordx4 v11, s[8:11], s42 offen lds
  s_add_u32 m0, s41, 30720
  s_add_u32 s42, s53, 6561792
  buffer_load_dwordx4 v11, s[8:11], s42 offen lds
  s_add_u32 m0, s41, 31744
  s_add_u32 s42, s53, 6627328
  buffer_load_dwordx4 v11, s[8:11], s42 offen lds
  ds_read_b64_tr_b16 v[128:129], v4 offset:0
  ds_read_b64_tr_b16 v[130:131], v4 offset:2048
  ds_read_b64_tr_b16 v[132:133], v4 offset:4096
  ds_read_b64_tr_b16 v[134:135], v4 offset:6144
  ds_read_b64_tr_b16 v[144:145], v5 offset:0
  ds_read_b64_tr_b16 v[146:147], v5 offset:2048
  ds_read_b64_tr_b16 v[148:149], v5 offset:4096
  ds_read_b64_tr_b16 v[150:151], v5 offset:6144
  ds_read_b64_tr_b16 v[160:161], v6 offset:0
  ds_read_b64_tr_b16 v[162:163], v6 offset:2048
  ds_read_b64_tr_b16 v[164:165], v6 offset:4096
  ds_read_b64_tr_b16 v[166:167], v6 offset:6144
  ds_read_b64_tr_b16 v[176:177], v7 offset:0
  ds_read_b64_tr_b16 v[178:179], v7 offset:2048
  ds_read_b64_tr_b16 v[180:181], v7 offset:4096
  ds_read_b64_tr_b16 v[182:183], v7 offset:6144
  s_waitcnt vmcnt(16) lgkmcnt(0)
  s_barrier
  s_add_u32 m0, s41, 0
  s_add_u32 s42, s52, 0
  buffer_load_dwordx4 v12, s[8:11], s42 offen lds
  s_add_u32 m0, s41, 1024
  s_add_u32 s42, s52, 65536
  buffer_load_dwordx4 v12, s[8:11], s42 offen lds
  s_add_u32 m0, s41, 2048
  s_add_u32 s42, s52, 8192
  buffer_load_dwordx4 v12, s[8:11], s42 offen lds
  s_add_u32 m0, s41, 3072
  s_add_u32 s42, s52, 73728
  buffer_load_dwordx4 v12, s[8:11], s42 offen lds
  s_add_u32 m0, s41, 4096
  s_add_u32 s42, s52, 262144
  buffer_load_dwordx4 v12, s[8:11], s42 offen lds
  s_add_u32 m0, s41, 5120
  s_add_u32 s42, s52, 327680
  buffer_load_dwordx4 v12, s[8:11], s42 offen lds
  s_add_u32 m0, s41, 6144
  s_add_u32 s42, s52, 270336
  buffer_load_dwordx4 v12, s[8:11], s42 offen lds
  s_add_u32 m0, s41, 7168
  s_add_u32 s42, s52, 335872
  buffer_load_dwordx4 v12, s[8:11], s42 offen lds
  ds_read_b64_tr_b16 v[136:137], v4 offset:8192
  ds_read_b64_tr_b16 v[138:139], v4 offset:10240
  ds_read_b64_tr_b16 v[140:141], v4 offset:12288
  ds_read_b64_tr_b16 v[142:143], v4 offset:14336
  ds_read_b64_tr_b16 v[152:153], v5 offset:8192
  ds_read_b64_tr_b16 v[154:155], v5 offset:10240
  ds_read_b64_tr_b16 v[156:157], v5 offset:12288
  ds_read_b64_tr_b16 v[158:159], v5 offset:14336
  ds_read_b64_tr_b16 v[168:169], v6 offset:8192
  ds_read_b64_tr_b16 v[170:171], v6 offset:10240
  ds_read_b64_tr_b16 v[172:173], v6 offset:12288
  ds_read_b64_tr_b16 v[174:175], v6 offset:14336
  ds_read_b64_tr_b16 v[184:185], v7 offset:8192
  ds_read_b64_tr_b16 v[186:187], v7 offset:10240
  ds_read_b64_tr_b16 v[188:189], v7 offset:12288
  ds_read_b64_tr_b16 v[190:191], v7 offset:14336
  s_cmp_lg_u32 s20, 0
  s_cbranch_scc1 Lchore_58
Lini_59:
  s_load_dwordx16 s[64:79], s[12:13], 128 glc
  s_load_dwordx16 s[80:95], s[12:13], 192 glc
  s_sub_u32 s24, s24, 1
  s_cbranch_scc1 L_FAIL
  s_waitcnt lgkmcnt(0)
  s_and_b64 s[64:65], s[64:65], s[66:67]
  s_and_b64 s[64:65], s[64:65], s[68:69]
  s_and_b64 s[64:65], s[64:65], s[70:71]
  s_and_b64 s[64:65], s[64:65], s[72:73]
  s_and_b64 s[64:65], s[64:65], s[74:75]
  s_and_b64 s[64:65], s[64:65], s[76:77]
  s_and_b64 s[64:65], s[64:65], s[78:79]
  s_and_b64 s[64:65], s[64:65], s[80:81]
  s_and_b64 s[64:65], s[64:65], s[82:83]
  s_and_b64 s[64:65], s[64:65], s[84:85]
  s_and_b64 s[64:65], s[64:65], s[86:87]
  s_and_b64 s[64:65], s[64:65], s[88:89]
  s_and_b64 s[64:65], s[64:65], s[90:91]
  s_and_b64 s[64:65], s[64:65], s[92:93]
  s_and_b64 s[64:65], s[64:65], s[94:95]
  s_and_b32 s64, s64, s65
  s_cbranch_scc0 Lini_59
  s_mov_b32 s46, 0xffff
  s_and_b32 s40, s21, 3
  s_lshl_b32 s40, s40, 13
  s_lshr_b32 s43, s21, 2
  s_lshl_b32 s43, s43, 10
  s_add_u32 s43, s43, s40
  s_add_u32 s43, s43, 1343488
  s_waitcnt lgkmcnt(0)
  s_memtime s[64:65]
  s_waitcnt lgkmcnt(0)
  s_load_dword s68, s[4:5], s43 glc
  s_waitcnt lgkmcnt(0)
  s_memtime s[66:67]
  s_waitcnt lgkmcnt(0)
  s_sub_u32 s64, s66, s64
  s_min_u32 s46, s46, s64
Lchore_58:
  s_waitcnt vmcnt(16) lgkmcnt(0)
  s_barrier
  s_add_u32 m0, s41, 8192
  s_add_u32 s42, s52, 2097152
  buffer_load_dwordx4 v12, s[8:11], s42 offen lds
  s_add_u32 m0, s41, 9216
  s_add_u32 s42, s52, 2162688
  buffer_load_dwordx4 v12, s[8:11], s42 offen lds
  s_add_u32 m0, s41, 10240
  s_add_u32 s42, s52, 2105344
  buffer_load_dwordx4 v12, s[8:11], s42 offen lds
  s_add_u32 m0, s41, 11264
  s_add_u32 s42, s52, 2170880
  buffer_load_dwordx4 v12, s[8:11], s42 offen lds
  s_add_u32 m0, s41, 12288
  s_add_u32 s42, s52, 2359296
  buffer_load_dwordx4 v12, s[8:11], s42 offen lds
  s_add_u32 m0, s41, 13312
  s_add_u32 s42, s52, 2424832
  buffer_load_dwordx4 v12, s[8:11], s42 offen lds
  s_add_u32 m0, s41, 14336
  s_add_u32 s42, s52, 2367488
  buffer_load_dwordx4 v12, s[8:11], s42 offen lds
  s_add_u32 m0, s41, 15360
  s_add_u32 s42, s52, 2433024
  buffer_load_dwordx4 v12, s[8:11], s42 offen lds
  ds_read_b64_tr_b16 v[192:193], v4 offset:16384
  ds_read_b64_tr_b16 v[194:195], v4 offset:18432
  ds_read_b64_tr_b16 v[196:197], v4 offset:20480
  ds_read_b64_tr_b16 v[198:199], v4 offset:22528
  ds_read_b64_tr_b16 v[208:209], v5 offset:16384
  ds_read_b64_tr_b16 v[210:211], v5 offset:18432
  ds_read_b64_tr_b16 v[212:213], v5 offset:20480
  ds_read_b64_tr_b16 v[214:215], v5 offset:22528
  ds_read_b64_tr_b16 v[224:225], v6 offset:16384
  ds_read_b64_tr_b16 v[226:227], v6 offset:18432
  ds_read_b64_tr_b16 v[228:229], v6 offset:20480
  ds_read_b64_tr_b16 v[230:231], v6 offset:22528
  ds_read_b64_tr_b16 v[240:241], v7 offset:16384
  ds_read_b64_tr_b16 v[242:243], v7 offset:18432
  ds_read_b64_tr_b16 v[244:245], v7 offset:20480
  ds_read_b64_tr_b16 v[246:247], v7 offset:22528
  s_cmp_lg_u32 s20, 0
  s_cbranch_scc1 Lchore_60
  s_waitcnt lgkmcnt(0)
  s_memtime s[64:65]
  s_waitcnt lgkmcnt(0)
  s_load_dword s68, s[4:5], s43 glc
  s_waitcnt lgkmcnt(0)
  s_memtime s[66:67]
  s_waitcnt lgkmcnt(0)
  s_sub_u32 s64, s66, s64
  s_min_u32 s46, s46, s64
  s_getreg_b32 s55, hwreg(HW_REG_XCC_ID)
  s_and_b32 s55, s55, 15
  s_lshl_b32 s46, s46, 8
  s_or_b32 s46, s46, s55
  s_add_u32 s40, s21, 0
  s_lshl_b32 s40, s40, 7
  s_add_u32 s40, s40, 1424384
  s_mov_b32 s63, s46
  s_atomic_smax s63, s[4:5], s40 glc
Lnosig_61:
Lchore_60:
  s_waitcnt vmcnt(16) lgkmcnt(0)
  s_barrier
  s_add_u32 m0, s41, 16384
  s_add_u32 s42, s53, 4194304
  buffer_load_dwordx4 v12, s[8:11], s42 offen lds
  s_add_u32 m0, s41, 17408
  s_add_u32 s42, s53, 4259840
  buffer_load_dwordx4 v12, s[8:11], s42 offen lds
  s_add_u32 m0, s41, 18432
  s_add_u32 s42, s53, 4202496
  buffer_load_dwordx4 v12, s[8:11], s42 offen lds
  s_add_u32 m0, s41, 19456
  s_add_u32 s42, s53, 4268032
  buffer_load_dwordx4 v12, s[8:11], s42 offen lds
  s_add_u32 m0, s41, 20480
  s_add_u32 s42, s53, 4456448
  buffer_load_dwordx4 v12, s[8:11], s42 offen lds
  s_add_u32 m0, s41, 21504
  s_add_u32 s42, s53, 4521984
  buffer_load_dwordx4 v12, s[8:11], s42 offen lds
  s_add_u32 m0, s41, 22528
  s_add_u32 s42, s53, 4464640
  buffer_load_dwordx4 v12, s[8:11], s42 offen lds
  s_add_u32 m0, s41, 23552
  s_add_u32 s42, s53, 4530176
  buffer_load_dwordx4 v12, s[8:11], s42 offen lds
  ds_read_b64_tr_b16 v[200:201], v4 offset:24576
  ds_read_b64_tr_b16 v[202:203], v4 offset:26624
  ds_read_b64_tr_b16 v[204:205], v4 offset:28672
  ds_read_b64_tr_b16 v[206:207], v4 offset:30720
  ds_read_b64_tr_b16 v[216:217], v5 offset:24576
  ds_read_b64_tr_b16 v[218:219], v5 offset:26624
  ds_read_b64_tr_b16 v[220:221], v5 offset:28672
  ds_read_b64_tr_b16 v[222:223], v5 offset:30720
  ds_read_b64_tr_b16 v[232:233], v6 offset:24576
  ds_read_b64_tr_b16 v[234:235], v6 offset:26624
  ds_read_b64_tr_b16 v[236:237], v6 offset:28672
  ds_read_b64_tr_b16 v[238:239], v6 offset:30720
  ds_read_b64_tr_b16 v[248:249], v7 offset:24576
  ds_read_b64_tr_b16 v[250:251], v7 offset:26624
  ds_read_b64_tr_b16 v[252:253], v7 offset:28672
  ds_read_b64_tr_b16 v[254:255], v7 offset:30720
  s_waitcnt vmcnt(16) lgkmcnt(0)
  s_barrier
  s_add_u32 m0, s41, 24576
  s_add_u32 s42, s53, 6291456
  buffer_load_dwordx4 v12, s[8:11], s42 offen lds
  s_add_u32 m0, s41, 25600
  s_add_u32 s42, s53, 6356992
  buffer_load_dwordx4 v12, s[8:11], s42 offen lds
  s_add_u32 m0, s41, 26624
  s_add_u32 s42, s53, 6299648
  buffer_load_dwordx4 v12, s[8:11], s42 offen lds
  s_add_u32 m0, s41, 27648
  s_add_u32 s42, s53, 6365184
  buffer_load_dwordx4 v12, s[8:11], s42 offen lds
  s_add_u32 m0, s41, 28672
  s_add_u32 s42, s53, 6553600
  buffer_load_dwordx4 v12, s[8:11], s42 offen lds
  s_add_u32 m0, s41, 29696
  s_add_u32 s42, s53, 6619136
  buffer_load_dwordx4 v12, s[8:11], s42 offen lds
  s_add_u32 m0, s41, 30720
  s_add_u32 s42, s53, 6561792
  buffer_load_dwordx4 v12, s[8:11], s42 offen lds
  s_add_u32 m0, s41, 31744
  s_add_u32 s42, s53, 6627328
  buffer_load_dwordx4 v12, s[8:11], s42 offen lds
  ds_read_b64_tr_b16 v[20:21], v4 offset:0
  ds_read_b64_tr_b16 v[22:23], v4 offset:2048
  ds_read_b64_tr_b16 v[24:25], v4 offset:4096
  ds_read_b64_tr_b16 v[26:27], v4 offset:6144
  ds_read_b64_tr_b16 v[28:29], v5 offset:0
  ds_read_b64_tr_b16 v[30:31], v5 offset:2048
  ds_read_b64_tr_b16 v[32:33], v5 offset:4096
  ds_read_b64_tr_b16 v[34:35], v5 offset:6144
  ds_read_b64_tr_b16 v[36:37], v6 offset:0
  ds_read_b64_tr_b16 v[38:39], v6 offset:2048
  ds_read_b64_tr_b16 v[40:41], v6 offset:4096
  ds_read_b64_tr_b16 v[42:43], v6 offset:6144
  ds_read_b64_tr_b16 v[44:45], v7 offset:0
  ds_read_b64_tr_b16 v[46:47], v7 offset:2048
  ds_read_b64_tr_b16 v[48:49], v7 offset:4096
  ds_read_b64_tr_b16 v[50:51], v7 offset:6144
  s_waitcnt lgkmcnt(0)
  s_barrier
  ds_write_b128 v85, v[20:23] offset:0
  ds_write_b128 v85, v[24:27] offset:1024
  ds_write_b128 v85, v[28:31] offset:2048
  ds_write_b128 v85, v[32:35] offset:3072
  ds_write_b128 v85, v[36:39] offset:4096
  ds_write_b128 v85, v[40:43] offset:5120
  ds_write_b128 v85, v[44:47] offset:6144
  ds_write_b128 v85, v[48:51] offset:7168
  s_waitcnt vmcnt(16) lgkmcnt(0)
  s_barrier
  ds_read_b64_tr_b16 v[20:21], v4 offset:8192
  ds_read_b64_tr_b16 v[22:23], v4 offset:10240
  ds_read_b64_tr_b16 v[24:25], v4 offset:12288
  ds_read_b64_tr_b16 v[26:27], v4 offset:14336
  ds_read_b64_tr_b16 v[28:29], v5 offset:8192
  ds_read_b64_tr_b16 v[30:31], v5 offset:10240
  ds_read_b64_tr_b16 v[32:33], v5 offset:12288
  ds_read_b64_tr_b16 v[34:35], v5 offset:14336
  ds_read_b64_tr_b16 v[36:37], v6 offset:8192
  ds_read_b64_tr_b16 v[38:39], v6 offset:10240
  ds_read_b64_tr_b16 v[40:41], v6 offset:12288
  ds_read_b64_tr_b16 v[42:43], v6 offset:14336
  ds_read_b64_tr_b16 v[44:45], v7 offset:8192
  ds_read_b64_tr_b16 v[46:47], v7 offset:10240
  ds_read_b64_tr_b16 v[48:49], v7 offset:12288
  ds_read_b64_tr_b16 v[50:51], v7 offset:14336
  s_waitcnt lgkmcnt(0)
  s_barrier
  ds_write_b128 v85, v[20:23] offset:8192
  ds_write_b128 v85, v[24:27] offset:9216
  ds_write_b128 v85, v[28:31] offset:10240
  ds_write_b128 v85, v[32:35] offset:11264
  ds_write_b128 v85, v[36:39] offset:12288
  ds_write_b128 v85, v[40:43] offset:13312
  ds_write_b128 v85, v[44:47] offset:14336
  ds_write_b128 v85, v[48:51] offset:15360
  s_waitcnt vmcnt(8) lgkmcnt(0)
  s_barrier
  ds_read_b64_tr_b16 v[20:21], v4 offset:16384
  ds_read_b64_tr_b16 v[22:23], v4 offset:18432
  ds_read_b64_tr_b16 v[24:25], v4 offset:20480
  ds_read_b64_tr_b16 v[26:27], v4 offset:22528
  ds_read_b64_tr_b16 v[28:29], v5 offset:16384
  ds_read_b64_tr_b16 v[30:31], v5 offset:18432
  ds_read_b64_tr_b16 v[32:33], v5 offset:20480
  ds_read_b64_tr_b16 v[34:35], v5 offset:22528
  ds_read_b64_tr_b16 v[36:37], v6 offset:16384
  ds_read_b64_tr_b16 v[38:39], v6 offset:18432
  ds_read_b64_tr_b16 v[40:41], v6 offset:20480
  ds_read_b64_tr_b16 v[42:43], v6 offset:22528
  ds_read_b64_tr_b16 v[44:45], v7 offset:16384
  ds_read_b64_tr_b16 v[46:47], v7 offset:18432
  ds_read_b64_tr_b16 v[48:49], v7 offset:20480
  ds_read_b64_tr_b16 v[50:51], v7 offset:22528
  s_waitcnt lgkmcnt(0)
  s_barrier
  ds_write_b128 v85, v[20:23] offset:16384
  ds_write_b128 v85, v[24:27] offset:17408
  ds_write_b128 v85, v[28:31] offset:18432
  ds_write_b128 v85, v[32:35] offset:19456
  ds_write_b128 v85, v[36:39] offset:20480
  ds_write_b128 v85, v[40:43] offset:21504
  ds_write_b128 v85, v[44:47] offset:22528
  ds_write_b128 v85, v[48:51] offset:23552
  s_waitcnt vmcnt(0) lgkmcnt(0)
  s_barrier
  ds_read_b64_tr_b16 v[20:21], v4 offset:24576
  ds_read_b64_tr_b16 v[22:23], v4 offset:26624
  ds_read_b64_tr_b16 v[24:25], v4 offset:28672
  ds_read_b64_tr_b16 v[26:27], v4 offset:30720
  ds_read_b64_tr_b16 v[28:29], v5 offset:24576
  ds_read_b64_tr_b16 v[30:31], v5 offset:26624
  ds_read_b64_tr_b16 v[32:33], v5 offset:28672
  ds_read_b64_tr_b16 v[34:35], v5 offset:30720
  ds_read_b64_tr_b16 v[36:37], v6 offset:24576
  ds_read_b64_tr_b16 v[38:39], v6 offset:26624
  ds_read_b64_tr_b16 v[40:41], v6 offset:28672
  ds_read_b64_tr_b16 v[42:43], v6 offset:30720
  ds_read_b64_tr_b16 v[44:45], v7 offset:24576
  ds_read_b64_tr_b16 v[46:47], v7 offset:26624
  ds_read_b64_tr_b16 v[48:49], v7 offset:28672
  ds_read_b64_tr_b16 v[50:51], v7 offset:30720
  s_waitcnt lgkmcnt(0)
  s_barrier
  ds_write_b128 v85, v[20:23] offset:24576
  ds_write_b128 v85, v[24:27] offset:25600
  ds_write_b128 v85, v[28:31] offset:26624
  ds_write_b128 v85, v[32:35] offset:27648
  ds_write_b128 v85, v[36:39] offset:28672
  ds_write_b128 v85, v[40:43] offset:29696
  ds_write_b128 v85, v[44:47] offset:30720
  ds_write_b128 v85, v[48:51] offset:31744
  s_waitcnt lgkmcnt(0)
  s_getreg_b32 s55, hwreg(HW_REG_XCC_ID)
  s_and_b32 s55, s55, 15
  v_min_u32 v76, 63, v0
  v_lshlrev_b32 v76, 7, v76
  v_add_u32 v76, 1424384, v76
  s_nop 1
Lpoll_62:
  buffer_load_dword v77, v76, s[4:7], 0 offen sc1
  s_sub_u32 s24, s24, 1
  s_cbranch_scc1 L_FAIL
  s_waitcnt vmcnt(0)
  v_cmp_gt_i32 vcc, 0, v77
  s_cbranch_vccz Lpolld_63
  s_sleep 1
  s_branch Lpoll_62
Lpolld_63:
  v_and_b32 v78, 15, v77
  v_cmp_ne_u32 vcc, s55, v78
  s_lshl_b32 s40, s54, 4
  s_lshl_b32 s40, 0xffff, s40
  s_or_b32 s41, vcc_lo, vcc_hi
  s_and_b32 s40, s40, s41
  s_cselect_b32 s36, 0, 8192
  v_lshrrev_b32 v77, 8, v77
  v_and_b32 v78, 3, v0
  v_lshl_or_b32 v77, v77, 2, v78
  s_nop 1
  v_min_u32_dpp v77, v77, v77 row_ror:8 row_mask:0xf bank_mask:0xf
  s_nop 1
  v_min_u32_dpp v77, v77, v77 row_ror:4 row_mask:0xf bank_mask:0xf
  v_mov_b32 v78, v77
  s_nop 1
  v_permlane16_swap_b32 v78, v77
  v_min_u32 v77, v77, v78
  v_mov_b32 v78, v77
  s_nop 1
  v_permlane32_swap_b32 v78, v77
  v_min_u32 v77, v77, v78
  s_nop 1
  v_min_u32_dpp v77, v77, v77 row_ror:2 row_mask:0xf bank_mask:0xf
  s_nop 1
  v_min_u32_dpp v77, v77, v77 row_ror:1 row_mask:0xf bank_mask:0xf
  s_nop 0
  v_readfirstlane_b32 s26, v77
  s_and_b32 s26, s26, 3
  s_lshl_b32 s26, s26, 13
  s_lshr_b32 s40, s20, 1
  s_mul_i32 s40, s40, 32768
  s_and_b32 s41, s20, 1
  s_lshl_b32 s41, s41, 10
  s_add_u32 s40, s40, s41
  s_lshl_b32 s41, s54, 12
  s_add_u32 s40, s40, s41
  v_lshl_add_u32 v86, v0, 4, s40
  v_xor_b32 v87, 0x1000, v86
  v_and_b32 v76, 2, v0
  v_cmp_eq_u32 vcc, 0, v76
  v_mov_b32 v76, 0xeeee
  v_mov_b32 v77, 0x4444
  v_cndmask_b32 v88, v76, v77, vcc
  s_lshr_b32 s40, s21, 2
  s_mul_i32 s40, s40, 32768
  s_and_b32 s41, s21, 3
  s_lshl_b32 s41, s41, 11
  s_add_u32 s47, s40, s41
  s_lshl_b32 s41, s20, 9
  s_add_u32 s47, s47, s41
  v_lshl_add_u32 v92, v0, 3, s47
  s_lshl_b32 s41, s54, 12
  s_add_u32 s40, s41, 1310720
  s_add_u32 s40, s40, s26
  v_lshrrev_b32 v76, 2, v0
  v_lshl_add_u32 v76, v76, 7, s40
  v_and_b32 v77, 3, v0
  v_lshl_add_u32 v90, v77, 2, v76
  s_mov_b32 s57, s40
  s_cmp_eq_u32 s36, 0
  s_cselect_b32 s56, 1, s20
  s_and_b32 s41, s21, 15
  s_lshl_b32 s41, s41, 7
  s_lshl_b32 s40, s20, 2
  s_add_u32 s40, s40, s41
  s_add_u32 s40, s40, 2048
  s_mov_b32 s25, 0
  s_mov_b32 s60, 0
  s_mov_b32 s61, 0
  s_mov_b32 s51, -1
  v_mov_b32 v91, 2147483392
  s_mov_b64 exec, 1
  v_mov_b32 v91, s40
  s_mov_b64 exec, -1
  v_mov_b32 v80, -1
  v_mov_b32 v81, -1
  v_mov_b32 v82, -1
  v_mov_b32 v83, -1
  v_mov_b32 v112, 0
  v_mov_b32 v113, 0
  v_mov_b32 v114, 0
  v_mov_b32 v115, 0
  v_mov_b32 v116, 0
  v_mov_b32 v117, 0
  v_mov_b32 v118, 0
  v_mov_b32 v119, 0
  v_mov_b32 v120, 0
  v_mov_b32 v121, 0
  v_mov_b32 v108, 0x3f803f80
  v_mov_b32 v109, 0x3f803f80
  v_mov_b32 v110, 0x3f803f80
  v_mov_b32 v111, 0x3f803f80
  v_lshlrev_b32 v95, 4, v0
  s_lshl_b32 s58, s20, 12
  s_add_u32 s40, s58, 149504
  s_add_u32 s58, s58, 131072
  v_lshrrev_b32 v76, 4, v0
  v_bfe_u32 v77, v0, 1, 2
  v_xor_b32 v76, v76, v77
  v_lshl_add_u32 v76, v76, 4, s40
  v_and_b32 v77, 15, v0
  v_lshl_add_u32 v123, v77, 6, v76
  v_bfe_u32 v76, v0, 3, 2
  v_xor_b32 v76, v76, v0
  v_lshl_add_u32 v124, v76, 4, s40
  v_bfe_u32 v76, v0, 4, 1
  v_lshlrev_b32 v76, 1, v76
  v_and_b32 v77, 13, v0
  v_or_b32 v76, v76, v77
  v_lshl_add_u32 v122, v76, 4, s47
  v_lshrrev_b32 v76, 5, v0
  v_lshl_add_u32 v122, v76, 8, v122
  v_and_b32 v76, 2, v0
  v_cmp_eq_u32 vcc, 0, v76
  v_mov_b32 v77, 2147483392
  s_nop 0
  v_cndmask_b32 v122, v122, v77, vcc
  s_lshl_b32 s43, s21, 2
  s_add_u32 s43, s43, s20
  s_and_b32 s46, s20, 1
  s_lshl_b32 s46, s46, 10
  s_mul_i32 s32, s21, 65536
  s_lshl_b32 s40, s20, 11
  s_add_u32 s32, s32, s40
  s_and_b32 s40, s26, 0x2000
  s_xor_b32 s40, s40, 20971520
  s_add_u32 s32, s32, s40
  s_add_u32 s30, s32, s46
  s_add_u32 s30, s30, 49152
  s_lshl_b32 s59, s21, 7
  s_add_u32 s59, s59, 1396736
  s_lshl_b32 s62, s21, 7
  s_add_u32 s62, s62, 1404928
  s_mov_b32 s38, 0x3e0293ee
  s_mov_b32 s39, s38
  v_xor_b32 v125, 4096, v124
  v_xor_b32 v126, 8192, v124
  v_xor_b32 v127, 12288, v124
  v_readfirstlane_b32 s88, v86
  s_xor_b32 s41, s47, 131072
  v_min_u32 v76, 3, v0
  v_lshl_add_u32 v87, v76, 7, s41
  v_lshrrev_b32 v76, 4, v0
  v_lshlrev_b32 v76, 2, v76
  v_and_b32 v77, 15, v0
  v_sub_u32 v76, v77, v76
  s_lshr_b32 s41, s46, 6
  v_add_u32 v76, s41, v76
  v_and_b32 v92, 0xfffffdff, v92
  v_mov_b32 v86, 0xd028965f
  v_cmp_le_i32 s[8:9], 0, v76
  v_cmp_le_i32 s[10:11], 1, v76
  v_cmp_le_i32 s[16:17], 2, v76
  v_cmp_le_i32 s[18:19], 3, v76
  v_cmp_le_i32 s[42:43], 16, v76
  v_cmp_le_i32 s[44:45], 17, v76
  v_cmp_le_i32 s[52:53], 18, v76
  v_cmp_le_i32 s[54:55], 19, v76
  s_xor_b32 s89, s88, 1024
  s_xor_b32 s90, s88, 32768
  s_xor_b32 s91, s88, 33792
  v_lshrrev_b32 v76, 4, v0
  v_lshl_add_u32 v76, v76, 7, s57
  v_and_b32 v77, 15, v0
  v_lshl_add_u32 v90, v77, 2, v76
  s_mov_b32 s25, 0
  s_add_u32 s27, s25, 32
  s_and_b32 s40, s27, 0x28
  s_mul_i32 s40, s40, 0x900
  s_and_b32 s40, s40, 0x6000
  s_xor_b32 s40, s40, s26
  s_lshl_b32 s27, s27, 16
  s_add_u32 s27, s27, s40
  s_lshl_b32 s37, s36, 1
  s_xor_b32 s37, s27, s37
  s_and_b32 s40, s25, 3
  s_lshl_b32 s40, s40, 18
  s_add_u32 s28, s40, s26
  s_lshr_b32 s40, s40, 5
  s_and_b32 s40, s40, 0x4000
  s_xor_b32 s28, s28, s40
  s_xor_b32 s29, s28, 0x4000
  s_xor_b32 s40, s28, 8192
  buffer_load_dword v89, v122, s[4:7], s40 offen sc1
  s_mov_b32 s25, 1
  s_add_u32 s27, s25, 32
  s_and_b32 s40, s27, 0x28
  s_mul_i32 s40, s40, 0x900
  s_and_b32 s40, s40, 0x6000
  s_xor_b32 s40, s40, s26
  s_lshl_b32 s27, s27, 16
  s_add_u32 s27, s27, s40
  s_lshl_b32 s37, s36, 1
  s_xor_b32 s37, s27, s37
  s_and_b32 s40, s25, 3
  s_lshl_b32 s40, s40, 18
  s_add_u32 s28, s40, s26
  s_lshr_b32 s40, s40, 5
  s_and_b32 s40, s40, 0x4000
  s_xor_b32 s28, s28, s40
  s_xor_b32 s29, s28, 0x4000
  s_xor_b32 s40, s28, 8192
  buffer_load_dword v89, v122, s[4:7], s40 offen sc1
  s_mov_b32 s25, 2
  s_add_u32 s27, s25, 32
  s_and_b32 s40, s27, 0x28
  s_mul_i32 s40, s40, 0x900
  s_and_b32 s40, s40, 0x6000
  s_xor_b32 s40, s40, s26
  s_lshl_b32 s27, s27, 16
  s_add_u32 s27, s27, s40
  s_lshl_b32 s37, s36, 1
  s_xor_b32 s37, s27, s37
  s_and_b32 s40, s25, 3
  s_lshl_b32 s40, s40, 18
  s_add_u32 s28, s40, s26
  s_lshr_b32 s40, s40, 5
  s_and_b32 s40, s40, 0x4000
  s_xor_b32 s28, s28, s40
  s_xor_b32 s29, s28, 0x4000
  s_xor_b32 s40, s28, 8192
  buffer_load_dword v89, v122, s[4:7], s40 offen sc1
  s_mov_b32 s25, 3
  s_add_u32 s27, s25, 32
  s_and_b32 s40, s27, 0x28
  s_mul_i32 s40, s40, 0x900
  s_and_b32 s40, s40, 0x6000
  s_xor_b32 s40, s40, s26
  s_lshl_b32 s27, s27, 16
  s_add_u32 s27, s27, s40
  s_lshl_b32 s37, s36, 1
  s_xor_b32 s37, s27, s37
  s_and_b32 s40, s25, 3
  s_lshl_b32 s40, s40, 18
  s_add_u32 s28, s40, s26
  s_lshr_b32 s40, s40, 5
  s_and_b32 s40, s40, 0x4000
  s_xor_b32 s28, s28, s40
  s_xor_b32 s29, s28, 0x4000
  s_xor_b32 s40, s28, 8192
  buffer_load_dword v89, v122, s[4:7], s40 offen sc1
  buffer_load_dword v89, v90, s[4:7], 0 offen offset:0 sc1
  s_mov_b32 s25, 0
  s_mov_b32 s33, 1
  s_mov_b64 s[100:101], 0
  s_cmp_lg_u32 s20, 1
  s_cbranch_scc1 Lskip_66
Lask_64:
  s_min_i32 s47, s100, s101
  s_cmp_ge_i32 s47, s33
  s_cbranch_scc1 Lhave_65
  s_load_dwordx2 s[100:101], s[4:5], s59 glc
  s_sub_u32 s24, s24, 1
  s_cbranch_scc1 L_FAIL
  s_waitcnt lgkmcnt(0)
  s_branch Lask_64
Lhave_65:
  s_add_u32 s33, s33, 2
  s_min_u32 s33, s33, 64
  s_cmp_ge_i32 s47, s33
  s_cbranch_scc1 Lskip_66
  s_load_dwordx2 s[100:101], s[4:5], s59 glc
Lskip_66:
  s_barrier
  s_add_u32 m0, s58, 16384
  s_add_u32 s31, s32, 16384
  buffer_load_dwordx4 v95, s[4:7], s31 offen offset:0 sc1 lds
  buffer_load_dwordx4 v95, s[4:7], s31 offen offset:1024 sc1 lds
  s_add_u32 m0, s58, 2048
  s_add_u32 s31, s32, 32768
  buffer_load_dwordx4 v95, s[4:7], s31 offen offset:0 sc1 lds
  buffer_load_dwordx4 v95, s[4:7], s31 offen offset:1024 sc1 lds
  s_mov_b32 m0, s58
  s_add_u32 s31, s32, s46
  buffer_load_dwordx4 v95, s[4:7], s31 offen offset:0 sc1 lds
  s_sub_u32 s31, s32, s46
  buffer_load_dwordx4 v95, s[4:7], s31 offen offset:1024 sc1 lds
  s_add_u32 s27, s25, 32
  s_and_b32 s40, s27, 0x28
  s_mul_i32 s40, s40, 0x900
  s_and_b32 s40, s40, 0x6000
  s_xor_b32 s40, s40, s26
  s_lshl_b32 s27, s27, 16
  s_add_u32 s27, s27, s40
  s_lshl_b32 s37, s36, 1
  s_xor_b32 s37, s27, s37
  s_and_b32 s40, s25, 3
  s_lshl_b32 s40, s40, 18
  s_add_u32 s28, s40, s26
  s_lshr_b32 s40, s40, 5
  s_and_b32 s40, s40, 0x4000
  s_xor_b32 s28, s28, s40
  s_xor_b32 s29, s28, 0x4000
  s_xor_b32 s34, s28, 0x84000
  s_xor_b32 s48, s28, 8192
  s_lshr_b32 s40, s46, 1
  s_add_u32 s29, s29, s40
  s_xor_b32 s35, s29, 512
  s_add_u32 s92, s37, s88
  s_add_u32 s96, s27, s88
  s_xor_b32 s96, s96, 0x1000
  s_add_u32 s93, s37, s89
  s_add_u32 s97, s27, s89
  s_xor_b32 s97, s97, 0x1000
  s_add_u32 s94, s37, s90
  s_add_u32 s98, s27, s90
  s_xor_b32 s98, s98, 0x1000
  s_add_u32 s95, s37, s91
  s_add_u32 s99, s27, s91
  s_xor_b32 s99, s99, 0x1000
L_QK_top:
  v_mov_b32 v94, s25
  v_mov_b64 v[52:53], 0
  v_mov_b64 v[54:55], 0
  v_mov_b64 v[56:57], 0
  v_mov_b64 v[58:59], 0
  v_mov_b64 v[60:61], 0
  v_mov_b64 v[62:63], 0
  v_mov_b64 v[64:65], 0
  v_mov_b64 v[66:67], 0
  ds_read_b128 v[20:23], v85 offset:0
  ds_read_b128 v[24:27], v85 offset:1024
  ds_read_b128 v[28:31], v85 offset:8192
  ds_read_b128 v[32:35], v85 offset:9216
  ds_read_b128 v[36:39], v85 offset:2048
  ds_read_b128 v[40:43], v85 offset:3072
  ds_read_b128 v[44:47], v85 offset:10240
  ds_read_b128 v[48:51], v85 offset:11264
  s_waitcnt lgkmcnt(0)
  s_and_b32 s40, s25, 63
  s_cselect_b32 s40, s56, 1
  s_cmp_lg_u32 s40, 0
  s_cbranch_scc1 L_QK_park
  v_mov_b32 v76, -1
  s_sleep 4
L_QK_spin:
  s_sub_u32 s24, s24, 1
  s_nop 0
  s_nop 0
  s_cbranch_scc1 L_FAIL
  s_nop 0
  s_waitcnt vmcnt(40)
  buffer_load_dword v76, v90, s[4:7], 0 offen sc1
  s_nop 3
  v_cmp_gt_i32_e64 vcc, s25, v76
  s_cbranch_vccz L_QK_rel
  buffer_load_dword v76, v90, s[4:7], 0 offen sc1
  s_nop 3
  v_cmp_gt_i32 vcc, s25, v76
  s_cbranch_vccz L_QK_rel
  buffer_load_dword v76, v90, s[4:7], 0 offen sc1
  s_nop 3
  v_cmp_gt_i32 vcc, s25, v76
  s_cbranch_vccz L_QK_rel
  buffer_load_dword v76, v90, s[4:7], 0 offen sc1
  s_nop 3
  v_cmp_gt_i32_e64 vcc, s25, v76
  s_cbranch_vccnz L_QK_spin
L_QK_rel:
  s_barrier
  s_mov_b64 exec, -1
L_QK_go:
L_QKM_again:
  buffer_load_dwordx4 v[4:7], v95, s[4:7], s92 offen offset:0
  s_nop 0
  buffer_load_dwordx4 v[8:11], v95, s[4:7], s92 offen offset:2048
  s_nop 0
  buffer_load_dwordx4 v[12:15], v95, s[4:7], s93 offen offset:0
  s_nop 0
  buffer_load_dwordx4 v[16:19], v95, s[4:7], s93 offen offset:2048
  s_nop 0
  buffer_load_dwordx4 v[68:71], v95, s[4:7], s94 offen offset:0
  s_nop 0
  ds_read_b128 v[96:99], v1 offset:2048
  ds_read_b128 v[100:103], v1 offset:3072
  s_cmp_lg_u32 s20, 0
  s_nop 0
  s_cbranch_scc1 L_QK_sigd
  s_mov_b32 s63, s25
  s_waitcnt vmcnt(5)
  s_atomic_smax s63, s[4:5], s62 glc
L_QK_sigd:
  s_waitcnt vmcnt(4)
  v_cmp_eq_u32_e64 vcc, -1, v4
  s_cbranch_vccnz L_QKM_g0
L_QKM_ok0:
  v_smfmac_f32_16x16x64_bf16 v[52:55], v[4:7], a[0:7], v88
  buffer_load_dwordx4 v[72:75], v95, s[4:7], s94 offen offset:2048
  v_smfmac_f32_16x16x64_bf16 v[60:63], v[4:7], v[128:135], v88
  s_waitcnt vmcnt(4)
  v_cmp_eq_u32 vcc, -1, v8
  v_smfmac_f32_16x16x64_bf16 v[56:59], v[4:7], a[128:135], v88
  v_smfmac_f32_16x16x64_bf16 v[64:67], v[4:7], v[20:27], v88
  s_cbranch_vccnz L_QKM_g1
L_QKM_ok1:
  v_smfmac_f32_16x16x64_bf16 v[52:55], v[8:11], a[8:15], v88
  buffer_load_dwordx4 v[4:7], v95, s[4:7], s95 offen offset:0
  ds_read_b128 v[20:23], v85 offset:4096
  v_smfmac_f32_16x16x64_bf16 v[60:63], v[8:11], v[136:143], v88
  s_nop 0
  s_waitcnt vmcnt(4)
  v_cmp_eq_u32_e64 vcc, -1, v12
  v_smfmac_f32_16x16x64_bf16 v[56:59], v[8:11], a[136:143], v88
  ds_read_b128 v[24:27], v85 offset:5120
  v_smfmac_f32_16x16x64_bf16 v[64:67], v[8:11], v[28:35], v88
  s_cbranch_vccnz L_QKM_g2
L_QKM_ok2:
  v_smfmac_f32_16x16x64_bf16 v[52:55], v[12:15], a[16:23], v88
  buffer_load_dwordx4 v[8:11], v95, s[4:7], s95 offen offset:2048
  ds_read_b128 v[28:31], v85 offset:12288
  v_smfmac_f32_16x16x64_bf16 v[60:63], v[12:15], v[144:151], v88
  s_waitcnt vmcnt(4)
  v_cmp_eq_u32 vcc, -1, v16
  v_smfmac_f32_16x16x64_bf16 v[56:59], v[12:15], a[144:151], v88
  ds_read_b128 v[32:35], v85 offset:13312
  v_smfmac_f32_16x16x64_bf16 v[64:67], v[12:15], v[36:43], v88
  s_cbranch_vccnz L_QKM_g3
L_QKM_ok3:
  v_smfmac_f32_16x16x64_bf16 v[52:55], v[16:19], a[24:31], v88
  buffer_load_dwordx4 v[12:15], v95, s[4:7], s96 offen offset:0
  ds_read_b128 v[36:39], v85 offset:6144
  v_smfmac_f32_16x16x64_bf16 v[60:63], v[16:19], v[152:159], v88
  s_waitcnt vmcnt(4)
  v_cmp_eq_u32 vcc, -1, v68
  v_smfmac_f32_16x16x64_bf16 v[56:59], v[16:19], a[152:159], v88
  ds_read_b128 v[40:43], v85 offset:7168
  v_smfmac_f32_16x16x64_bf16 v[64:67], v[16:19], v[44:51], v88
  s_cbranch_vccnz L_QKM_g4
L_QKM_ok4:
  v_smfmac_f32_16x16x64_bf16 v[52:55], v[68:71], a[32:39], v88
  buffer_load_dwordx4 v[16:19], v95, s[4:7], s96 offen offset:2048
  ds_read_b128 v[44:47], v85 offset:14336
  v_smfmac_f32_16x16x64_bf16 v[60:63], v[68:71], v[160:167], v88
  s_waitcnt vmcnt(4)
  v_cmp_eq_u32 vcc, -1, v72
  v_smfmac_f32_16x16x64_bf16 v[56:59], v[68:71], a[160:167], v88
  ds_read_b128 v[48:51], v85 offset:15360
  s_waitcnt lgkmcnt(6)
  v_smfmac_f32_16x16x64_bf16 v[64:67], v[68:71], v[20:27], v88
  s_cbranch_vccnz L_QKM_g5
L_QKM_ok5:
  v_smfmac_f32_16x16x64_bf16 v[52:55], v[72:75], a[40:47], v88
  buffer_load_dwordx4 v[68:71], v95, s[4:7], s97 offen offset:0
  ds_read_b128 v[20:23], v85 offset:16384
  v_smfmac_f32_16x16x64_bf16 v[60:63], v[72:75], v[168:175], v88
  s_waitcnt vmcnt(4)
  v_cmp_eq_u32_e64 vcc, -1, v4
  v_smfmac_f32_16x16x64_bf16 v[56:59], v[72:75], a[168:175], v88
  ds_read_b128 v[24:27], v85 offset:17408
  s_nop 0
  s_waitcnt lgkmcnt(6)
  v_smfmac_f32_16x16x64_bf16 v[64:67], v[72:75], v[28:35], v88
  s_cbranch_vccnz L_QKM_g6
L_QKM_ok6:
  v_smfmac_f32_16x16x64_bf16 v[52:55], v[4:7], a[48:55], v88
  buffer_load_dwordx4 v[72:75], v95, s[4:7], s97 offen offset:2048
  ds_read_b128 v[28:31], v85 offset:24576
  v_smfmac_f32_16x16x64_bf16 v[60:63], v[4:7], v[176:183], v88
  s_waitcnt vmcnt(4)
  v_cmp_eq_u32 vcc, -1, v8
  v_smfmac_f32_16x16x64_bf16 v[56:59], v[4:7], a[176:183], v88
  ds_read_b128 v[32:35], v85 offset:25600
  s_waitcnt lgkmcnt(6)
  v_smfmac_f32_16x16x64_bf16 v[64:67], v[4:7], v[36:43], v88
  s_cbranch_vccnz L_QKM_g7
L_QKM_ok7:
  v_smfmac_f32_16x16x64_bf16 v[52:55], v[8:11], a[56:63], v88
  buffer_load_dwordx4 v[4:7], v95, s[4:7], s98 offen offset:0
  ds_read_b128 v[36:39], v85 offset:18432
  v_smfmac_f32_16x16x64_bf16 v[60:63], v[8:11], v[184:191], v88
  s_waitcnt vmcnt(4)
  v_cmp_eq_u32 vcc, -1, v12
  v_smfmac_f32_16x16x64_bf16 v[56:59], v[8:11], a[184:191], v88
  ds_read_b128 v[40:43], v85 offset:19456
  s_waitcnt lgkmcnt(6)
  v_smfmac_f32_16x16x64_bf16 v[64:67], v[8:11], v[44:51], v88
  s_cbranch_vccnz L_QKM_g8
L_QKM_ok8:
  v_smfmac_f32_16x16x64_bf16 v[52:55], v[12:15], a[64:71], v88
  buffer_load_dwordx4 v[8:11], v95, s[4:7], s98 offen offset:2048
  ds_read_b128 v[44:47], v85 offset:26624
  v_smfmac_f32_16x16x64_bf16 v[60:63], v[12:15], v[192:199], v88
  s_waitcnt vmcnt(4)
  v_cmp_eq_u32_e64 vcc, -1, v16
  v_smfmac_f32_16x16x64_bf16 v[56:59], v[12:15], a[192:199], v88
  ds_read_b128 v[48:51], v85 offset:27648
  s_nop 0
  s_waitcnt lgkmcnt(6)
  v_smfmac_f32_16x16x64_bf16 v[64:67], v[12:15], v[20:27], v88
  s_cbranch_vccnz L_QKM_g9
L_QKM_ok9:
  v_smfmac_f32_16x16x64_bf16 v[52:55], v[16:19], a[72:79], v88
  buffer_load_dwordx4 v[12:15], v95, s[4:7], s99 offen offset:0
  ds_read_b128 v[20:23], v85 offset:20480
  v_smfmac_f32_16x16x64_bf16 v[60:63], v[16:19], v[200:207], v88
  s_waitcnt vmcnt(4)
  v_cmp_eq_u32 vcc, -1, v68
  v_smfmac_f32_16x16x64_bf16 v[56:59], v[16:19], a[200:207], v88
  ds_read_b128 v[24:27], v85 offset:21504
  s_waitcnt lgkmcnt(6)
  v_smfmac_f32_16x16x64_bf16 v[64:67], v[16:19], v[28:35], v88
  s_cbranch_vccnz L_QKM_g10
L_QKM_ok10:
  v_smfmac_f32_16x16x64_bf16 v[52:55], v[68:71], a[80:87], v88
  buffer_load_dwordx4 v[16:19], v95, s[4:7], s99 offen offset:2048
  ds_read_b128 v[28:31], v85 offset:28672
  v_smfmac_f32_16x16x64_bf16 v[60:63], v[68:71], v[208:215], v88
  s_waitcnt vmcnt(4)
  v_cmp_eq_u32 vcc, -1, v72
  v_smfmac_f32_16x16x64_bf16 v[56:59], v[68:71], a[208:215], v88
  ds_read_b128 v[32:35], v85 offset:29696
  s_waitcnt lgkmcnt(6)
  v_smfmac_f32_16x16x64_bf16 v[64:67], v[68:71], v[36:43], v88
  s_cbranch_vccnz L_QKM_g11
L_QKM_ok11:
  v_smfmac_f32_16x16x64_bf16 v[52:55], v[72:75], a[88:95], v88
  ds_read_b128 v[36:39], v85 offset:22528
  v_smfmac_f32_16x16x64_bf16 v[60:63], v[72:75], v[216:223], v88
  s_waitcnt vmcnt(3)
  v_cmp_eq_u32 vcc, -1, v4
  v_smfmac_f32_16x16x64_bf16 v[56:59], v[72:75], a[216:223], v88
  ds_read_b128 v[40:43], v85 offset:23552
  s_waitcnt lgkmcnt(6)
  v_smfmac_f32_16x16x64_bf16 v[64:67], v[72:75], v[44:51], v88
  s_cbranch_vccnz L_QKM_g12
L_QKM_ok12:
  v_smfmac_f32_16x16x64_bf16 v[52:55], v[4:7], a[96:103], v88
  ds_read_b128 v[44:47], v85 offset:30720
  v_smfmac_f32_16x16x64_bf16 v[60:63], v[4:7], v[224:231], v88
  s_waitcnt vmcnt(2)
  v_cmp_eq_u32 vcc, -1, v8
  v_smfmac_f32_16x16x64_bf16 v[56:59], v[4:7], a[224:231], v88
  ds_read_b128 v[48:51], v85 offset:31744
  s_waitcnt lgkmcnt(6)
  v_smfmac_f32_16x16x64_bf16 v[64:67], v[4:7], v[20:27], v88
  s_cbranch_vccnz L_QKM_g13
L_QKM_ok13:
  v_smfmac_f32_16x16x64_bf16 v[52:55], v[8:11], a[104:111], v88
  ds_read_b128 v[20:23], v1 offset:16384
  ds_read_b128 v[24:27], v1 offset:17408
  v_smfmac_f32_16x16x64_bf16 v[60:63], v[8:11], v[232:239], v88
  s_waitcnt vmcnt(1)
  v_cmp_eq_u32_e64 vcc, -1, v12
  v_smfmac_f32_16x16x64_bf16 v[56:59], v[8:11], a[232:239], v88
  ds_read_b128 v[68:71], v84 offset:16384
  s_nop 0
  s_waitcnt lgkmcnt(7)
  v_smfmac_f32_16x16x64_bf16 v[64:67], v[8:11], v[28:35], v88
  s_cbranch_vccnz L_QKM_g14
L_QKM_ok14:
  v_smfmac_f32_16x16x64_bf16 v[52:55], v[12:15], a[112:119], v88
  ds_read_b128 v[28:31], v2 offset:16384
  ds_read_b128 v[32:35], v2 offset:17408
  v_smfmac_f32_16x16x64_bf16 v[60:63], v[12:15], v[240:247], v88
  s_waitcnt vmcnt(0)
  v_cmp_eq_u32 vcc, -1, v16
  v_smfmac_f32_16x16x64_bf16 v[56:59], v[12:15], a[240:247], v88
  ds_read_b128 v[72:75], v84 offset:17408
  s_waitcnt lgkmcnt(8)
  v_smfmac_f32_16x16x64_bf16 v[64:67], v[12:15], v[36:43], v88
  s_cbranch_vccnz L_QKM_g15
L_QKM_ok15:
  v_smfmac_f32_16x16x64_bf16 v[52:55], v[16:19], a[120:127], v88
  ds_read_b128 v[36:39], v3 offset:16384
  v_smfmac_f32_16x16x64_bf16 v[60:63], v[16:19], v[248:255], v88
  ds_read_b128 v[40:43], v3 offset:17408
  v_smfmac_f32_16x16x64_bf16 v[56:59], v[16:19], a[248:255], v88
  s_waitcnt lgkmcnt(8)
  v_smfmac_f32_16x16x64_bf16 v[64:67], v[16:19], v[44:51], v88
L_QKM_join:
  s_nop 1
  v_pk_add_f32 v[52:53], v[52:53], v[54:55]
  s_nop 0
  v_pk_add_f32 v[60:61], v[60:61], v[62:63]
  v_cmp_u_f32 vcc, v52, v53
  v_cvt_pk_bf16_f32 v77, v52, v53
  v_cvt_pk_bf16_f32 v76, v60, v61
  v_pk_add_f32 v[56:57], v[56:57], v[58:59]
  v_pk_add_f32 v[64:65], v[64:65], v[66:67]
  v_cvt_pk_bf16_f32 v79, v56, v57
  v_cvt_pk_bf16_f32 v78, v64, v65
  ds_write_b128 v123, v[76:79]
  ds_read_b64_tr_b16 v[4:5], v124 offset:0
  ds_read_b64_tr_b16 v[6:7], v124 offset:8
  s_cbranch_vccnz L_QKM_nan
L_QKM_done:
  s_waitcnt lgkmcnt(2)
  s_barrier
  ds_read_b64_tr_b16 v[8:9], v125 offset:0
  ds_read_b64_tr_b16 v[10:11], v125 offset:8
  ds_read_b64_tr_b16 v[12:13], v126 offset:0
  ds_read_b64_tr_b16 v[14:15], v126 offset:8
  ds_read_b64_tr_b16 v[16:17], v127 offset:0
  ds_read_b64_tr_b16 v[18:19], v127 offset:8
  s_waitcnt lgkmcnt(6)
  v_mfma_f32_16x16x32_bf16 v[52:55], v[20:23], v[4:7], 0
  v_mfma_f32_16x16x32_bf16 v[56:59], v[24:27], v[4:7], 0
  v_mfma_f32_16x16x32_bf16 v[60:63], v[4:7], v[4:7], 0
  s_waitcnt lgkmcnt(4)
  v_mfma_f32_16x16x32_bf16 v[52:55], v[28:31], v[8:11], v[52:55]
  v_mfma_f32_16x16x32_bf16 v[56:59], v[32:35], v[8:11], v[56:59]
  v_mfma_f32_16x16x32_bf16 v[60:63], v[8:11], v[8:11], v[60:63]
  buffer_load_dwordx2 v[104:105], v92, s[4:7], s29 offen sc1
  buffer_load_dwordx2 v[106:107], v92, s[4:7], s35 offen sc1
  s_waitcnt lgkmcnt(2)
  v_mfma_f32_16x16x32_bf16 v[52:55], v[36:39], v[12:15], v[52:55]
  v_mfma_f32_16x16x32_bf16 v[56:59], v[40:43], v[12:15], v[56:59]
  v_mfma_f32_16x16x32_bf16 v[60:63], v[12:15], v[12:15], v[60:63]
  s_waitcnt lgkmcnt(0)
  v_mfma_f32_16x16x32_bf16 v[52:55], v[68:71], v[16:19], v[52:55]
  v_mfma_f32_16x16x32_bf16 v[56:59], v[72:75], v[16:19], v[56:59]
  v_mfma_f32_16x16x32_bf16 v[60:63], v[16:19], v[16:19], v[60:63]
  s_mov_b32 vcc_lo, 0xcccccccc
  s_mov_b32 vcc_hi, 0xcccccccc
  v_mov_b32 v79, s38
  s_nop 2
  v_max3_f32 v64, v52, v53, v54
  v_max3_f32 v65, v55, v56, v57
  v_max3_f32 v64, v64, v58, v59
  v_max3_f32 v65, v65, v60, v61
  v_max_f32 v66, v64, v65
  v_max_f32 v67, v64, v65
  v_cndmask_b32_dpp v60, v61, v60, vcc quad_perm:[2,3,2,3] row_mask:0xf bank_mask:0xf
  v_cndmask_b32_dpp v52, v56, v52, vcc quad_perm:[2,3,2,3] row_mask:0xf bank_mask:0xf
  v_permlane16_swap_b32 v66, v67
  v_max_f32 v64, v66, v67
  v_max_f32 v65, v66, v67
  v_cndmask_b32_dpp v53, v57, v53, vcc quad_perm:[2,3,2,3] row_mask:0xf bank_mask:0xf
  v_cndmask_b32_dpp v54, v58, v54, vcc quad_perm:[2,3,2,3] row_mask:0xf bank_mask:0xf
  v_permlane32_swap_b32 v64, v65
  v_max_f32 v64, v64, v65
  v_cndmask_b32_dpp v55, v59, v55, vcc quad_perm:[2,3,2,3] row_mask:0xf bank_mask:0xf
  s_nop 0
  v_mul_f32_dpp v64, v64, v79 quad_perm:[2,3,2,3] row_mask:0xf bank_mask:0xf
  v_pk_fma_f32 v[52:53], v[52:53], s[38:39], v[64:65] op_sel_hi:[1,1,0] neg_lo:[0,0,1] neg_hi:[0,0,1]
  v_pk_fma_f32 v[54:55], v[54:55], s[38:39], v[64:65] op_sel_hi:[1,1,0] neg_lo:[0,0,1] neg_hi:[0,0,1]
  v_exp_f32 v52, v52
  v_exp_f32 v53, v53
  v_exp_f32 v54, v54
  v_cvt_pk_bf16_f32 v76, v52, v53
  v_exp_f32 v55, v55
  v_fma_f32 v60, v60, s38, -v64
  v_cvt_pk_bf16_f32 v77, v54, v55
  v_mov_b32_dpp v78, v76 quad_perm:[0,1,0,1] row_mask:0xf bank_mask:0xf
  v_exp_f32 v60, v60
  v_mov_b32_dpp v79, v77 quad_perm:[0,1,0,1] row_mask:0xf bank_mask:0xf
  s_nop 0
  v_mov_b32_dpp v61, v60 quad_perm:[0,1,0,1] row_mask:0xf bank_mask:0xf
  v_mfma_f32_16x16x32_bf16 v[64:67], v[108:111], v[76:79], 0
  v_cvt_pk_bf16_f32 v114, v60, v61
  v_cvt_pk_bf16_f32 v119, v60, v61
  s_waitcnt vmcnt(0)
  v_mfma_f32_16x16x32_bf16 v[44:47], v[96:99], v[76:79], 0
  v_max3_u32 v89, v104, v105, v106
  v_max_u32 v89, v89, v107
  v_mfma_f32_16x16x32_bf16 v[64:67], v[108:111], v[114:117], v[64:67]
  v_cmp_eq_u32 vcc, -1, v89
  v_mfma_f32_16x16x32_bf16 v[48:51], v[100:103], v[76:79], 0
  s_cbranch_vccnz L_QK_vbad
L_QK_vok:
  buffer_store_dword v94, v91, s[4:7], s57 offen
  v_mfma_f32_16x16x32_bf16 v[44:47], v[104:107], v[114:117], v[44:47]
  v_mfma_f32_16x16x32_bf16 v[48:51], v[104:107], v[118:121], v[48:51]
  s_nop 1
  v_rcp_f32 v64, v64
  s_nop 3
  v_pk_mul_f32 v[44:45], v[44:45], v[64:65] op_sel_hi:[1,0]
  v_pk_mul_f32 v[46:47], v[46:47], v[64:65] op_sel_hi:[1,0]
  v_pk_mul_f32 v[48:49], v[48:49], v[64:65] op_sel_hi:[1,0]
  v_pk_mul_f32 v[50:51], v[50:51], v[64:65] op_sel_hi:[1,0]
  v_cvt_pk_bf16_f32 v52, v44, v45
  v_cvt_pk_bf16_f32 v53, v46, v47
  v_cvt_pk_bf16_f32 v54, v48, v49
  v_cvt_pk_bf16_f32 v55, v50, v51
  buffer_store_dwordx4 v[52:55], v122, s[4:7], s48 offen
  ds_read_b128 v[44:47], v1 offset:0
  ds_read_b128 v[48:51], v2 offset:1024
  s_add_u32 s32, s32, 2097152
  s_xor_b32 s32, s32, 0x2000
  s_add_u32 s33, s25, 2
  s_min_u32 s33, s33, 64
  s_waitcnt lgkmcnt(0)
  buffer_store_dwordx4 v[52:55], v122, s[4:7], s28 offen sc1
  v_mfma_f32_16x16x32_bf16 v[56:59], v[20:23], v[44:47], 0
  v_mfma_f32_16x16x32_bf16 v[60:63], v[24:27], v[44:47], 0
  v_mfma_f32_16x16x32_bf16 v[64:67], v[4:7], v[44:47], 0
  ds_read_b128 v[20:23], v3 offset:0
  ds_read_b128 v[24:27], v2 offset:2048
  v_mfma_f32_16x16x32_bf16 v[56:59], v[28:31], v[48:51], v[56:59]
  v_mfma_f32_16x16x32_bf16 v[60:63], v[32:35], v[48:51], v[60:63]
  v_mfma_f32_16x16x32_bf16 v[64:67], v[8:11], v[48:51], v[64:67]
  ds_read_b128 v[28:31], v84 offset:1024
  ds_read_b128 v[32:35], v2 offset:3072
  s_waitcnt lgkmcnt(3)
  v_mfma_f32_16x16x32_bf16 v[56:59], v[36:39], v[20:23], v[56:59]
  v_mfma_f32_16x16x32_bf16 v[60:63], v[40:43], v[20:23], v[60:63]
  v_mfma_f32_16x16x32_bf16 v[64:67], v[12:15], v[20:23], v[64:67]
  s_waitcnt lgkmcnt(0)
  v_mfma_f32_16x16x32_bf16 v[56:59], v[68:71], v[28:31], v[56:59]
  v_mfma_f32_16x16x32_bf16 v[60:63], v[72:75], v[28:31], v[60:63]
  v_mfma_f32_16x16x32_bf16 v[64:67], v[16:19], v[28:31], v[64:67]
  s_cmp_lg_u32 s20, 1
  s_cbranch_scc1 Lskip_69
Lask_67:
  s_min_i32 s47, s100, s101
  s_cmp_ge_i32 s47, s33
  s_cbranch_scc1 Lhave_68
  s_load_dwordx2 s[100:101], s[4:5], s59 glc
  s_sub_u32 s24, s24, 1
  s_cbranch_scc1 L_FAIL
  s_waitcnt lgkmcnt(0)
  s_branch Lask_67
Lhave_68:
  s_add_u32 s33, s33, 2
  s_min_u32 s33, s33, 64
  s_cmp_ge_i32 s47, s33
  s_cbranch_scc1 Lskip_69
  s_load_dwordx2 s[100:101], s[4:5], s59 glc
Lskip_69:
  s_barrier
  v_cndmask_b32 v56, v86, v56, s[8:9]
  v_cndmask_b32 v57, v86, v57, s[10:11]
  v_cndmask_b32 v58, v86, v58, s[16:17]
  v_cndmask_b32 v59, v86, v59, s[18:19]
  v_cndmask_b32 v60, v86, v60, s[42:43]
  v_cndmask_b32 v61, v86, v61, s[44:45]
  v_cndmask_b32 v62, v86, v62, s[52:53]
  v_cndmask_b32 v63, v86, v63, s[54:55]
  v_max3_f32 v72, v56, v57, v58
  v_max3_f32 v73, v59, v60, v61
  buffer_load_dword v89, v87, s[4:7], s28 offen sc1
  v_max3_f32 v72, v72, v62, v63
  v_max3_f32 v73, v73, v64, v65
  s_add_u32 m0, s58, 16384
  s_add_u32 s31, s32, 16384
  buffer_load_dwordx4 v95, s[4:7], s31 offen offset:0 sc1 lds
  v_max_f32 v74, v72, v73
  v_max_f32 v75, v72, v73
  buffer_load_dwordx4 v95, s[4:7], s31 offen offset:1024 sc1 lds
  s_nop 0
  v_permlane16_swap_b32 v74, v75
  v_max_f32 v72, v74, v75
  s_add_u32 m0, s58, 2048
  s_add_u32 s31, s32, 32768
  buffer_load_dwordx4 v95, s[4:7], s31 offen offset:0 sc1 lds
  v_max_f32 v73, v74, v75
  s_nop 1
  v_permlane32_swap_b32 v72, v73
  buffer_load_dwordx4 v95, s[4:7], s31 offen offset:1024 sc1 lds
  v_max_f32 v72, v72, v73
  v_mul_f32 v72, s38, v72
  s_mov_b32 m0, s58
  s_add_u32 s31, s32, s46
  buffer_load_dwordx4 v95, s[4:7], s31 offen offset:0 sc1 lds
  v_pk_fma_f32 v[56:57], v[56:57], s[38:39], v[72:73] op_sel_hi:[1,1,0] neg_lo:[0,0,1] neg_hi:[0,0,1]
  v_pk_fma_f32 v[58:59], v[58:59], s[38:39], v[72:73] op_sel_hi:[1,1,0] neg_lo:[0,0,1] neg_hi:[0,0,1]
  s_sub_u32 s31, s32, s46
  buffer_load_dwordx4 v95, s[4:7], s31 offen offset:1024 sc1 lds
  v_pk_fma_f32 v[60:61], v[60:61], s[38:39], v[72:73] op_sel_hi:[1,1,0] neg_lo:[0,0,1] neg_hi:[0,0,1]
  v_pk_fma_f32 v[62:63], v[62:63], s[38:39], v[72:73] op_sel_hi:[1,1,0] neg_lo:[0,0,1] neg_hi:[0,0,1]
  buffer_store_dwordx4 v[80:83], v122, s[4:7], s34 offen sc1
  v_pk_fma_f32 v[64:65], v[64:65], s[38:39], v[72:73] op_sel_hi:[1,1,0] neg_lo:[0,0,1] neg_hi:[0,0,1]
  v_exp_f32 v56, v56
  s_xor_b32 s40, s34, 8192
  buffer_store_dwordx4 v[80:83], v122, s[4:7], s40 offen
  v_exp_f32 v57, v57
  v_exp_f32 v58, v58
  v_exp_f32 v59, v59
  v_exp_f32 v60, v60
  v_exp_f32 v61, v61
  v_exp_f32 v62, v62
  v_exp_f32 v63, v63
  v_exp_f32 v64, v64
  v_exp_f32 v65, v65
  v_cvt_pk_bf16_f32 v36, v56, v57
  v_cvt_pk_bf16_f32 v37, v58, v59
  v_cvt_pk_bf16_f32 v38, v60, v61
  v_cvt_pk_bf16_f32 v39, v62, v63
  v_cvt_pk_bf16_f32 v114, v64, v65
  v_cvt_pk_bf16_f32 v119, v64, v65
  s_add_u32 s25, s25, 1
  s_xor_b32 s41, s30, 2048
  v_mfma_f32_16x16x32_bf16 v[40:43], v[108:111], v[36:39], 0
  s_add_u32 s27, s25, 32
  s_and_b32 s40, s27, 0x28
  s_mul_i32 s40, s40, 0x900
  v_mfma_f32_16x16x32_bf16 v[52:55], v[96:99], v[36:39], 0
  s_and_b32 s40, s40, 0x6000
  s_xor_b32 s40, s40, s26
  s_lshl_b32 s27, s27, 16
  v_mfma_f32_16x16x32_bf16 v[56:59], v[100:103], v[36:39], 0
  s_add_u32 s27, s27, s40
  s_lshl_b32 s37, s36, 1
  s_xor_b32 s37, s27, s37
  v_mfma_f32_16x16x32_bf16 v[60:63], v[24:27], v[36:39], 0
  s_and_b32 s40, s25, 3
  s_lshl_b32 s40, s40, 18
  s_add_u32 s28, s40, s26
  v_mfma_f32_16x16x32_bf16 v[64:67], v[32:35], v[36:39], 0
  s_lshr_b32 s40, s40, 5
  s_and_b32 s40, s40, 0x4000
  s_xor_b32 s28, s28, s40
  v_mfma_f32_16x16x32_bf16 v[40:43], v[108:111], v[114:117], v[40:43]
  s_xor_b32 s29, s28, 0x4000
  s_xor_b32 s34, s28, 0x84000
  s_xor_b32 s48, s28, 8192
  v_mfma_f32_16x16x32_bf16 v[52:55], v[104:107], v[114:117], v[52:55]
  s_lshr_b32 s40, s46, 1
  s_add_u32 s29, s29, s40
  s_xor_b32 s35, s29, 512
  v_mfma_f32_16x16x32_bf16 v[56:59], v[104:107], v[118:121], v[56:59]
  s_add_u32 s92, s37, s88
  s_add_u32 s96, s27, s88
  s_xor_b32 s96, s96, 0x1000
  v_mfma_f32_16x16x32_bf16 v[60:63], v[104:107], v[112:115], v[60:63]
  s_add_u32 s93, s37, s89
  s_add_u32 s97, s27, s89
  s_xor_b32 s97, s97, 0x1000
  v_mfma_f32_16x16x32_bf16 v[64:67], v[104:107], v[116:119], v[64:67]
  s_add_u32 s94, s37, s90
  s_add_u32 s98, s27, s90
  s_xor_b32 s98, s98, 0x1000
  s_add_u32 s95, s37, s91
  s_add_u32 s99, s27, s91
  s_xor_b32 s99, s99, 0x1000
  v_rcp_f32 v40, v40
  s_nop 0
  v_pk_mul_f32 v[52:53], v[52:53], v[40:41] op_sel_hi:[1,0]
  v_pk_mul_f32 v[54:55], v[54:55], v[40:41] op_sel_hi:[1,0]
  v_pk_mul_f32 v[56:57], v[56:57], v[40:41] op_sel_hi:[1,0]
  v_pk_mul_f32 v[58:59], v[58:59], v[40:41] op_sel_hi:[1,0]
  v_cvt_pk_bf16_f32 v4, v52, v53
  v_cvt_pk_bf16_f32 v5, v54, v55
  v_cvt_pk_bf16_f32 v6, v56, v57
  v_cvt_pk_bf16_f32 v7, v58, v59
  buffer_store_dwordx4 v[4:7], v95, s[4:7], s30 offen sc1
  v_pk_mul_f32 v[60:61], v[60:61], v[40:41] op_sel_hi:[1,0]
  v_pk_mul_f32 v[62:63], v[62:63], v[40:41] op_sel_hi:[1,0]
  v_pk_mul_f32 v[64:65], v[64:65], v[40:41] op_sel_hi:[1,0]
  v_pk_mul_f32 v[66:67], v[66:67], v[40:41] op_sel_hi:[1,0]
  v_cvt_pk_bf16_f32 v8, v60, v61
  v_cvt_pk_bf16_f32 v9, v62, v63
  v_cvt_pk_bf16_f32 v10, v64, v65
  v_cvt_pk_bf16_f32 v11, v66, v67
  buffer_store_dwordx4 v[8:11], v95, s[4:7], s41 offen sc1
  s_add_u32 s30, s30, 2097152
  s_xor_b32 s30, s30, 0x2000
  s_branch L_QK_top
L_QK_park:
  s_waitcnt vmcnt(0)
  s_cmp_lt_u32 s25, 64
  s_cbranch_scc1 L_QK_rel
  s_barrier
  s_cmp_lg_u32 s20, 0
  s_cbranch_scc1 Lnosig_70
  s_mov_b32 s63, s25
  s_atomic_smax s63, s[4:5], s62 glc
Lnosig_70:
  s_branch L_END
L_QKM_nan:
  s_cmp_eq_u32 s51, s25
  s_cbranch_scc1 L_QKM_done
  s_mov_b32 s51, s25
  s_add_u32 s60, s60, 0x10000
  s_waitcnt vmcnt(0) lgkmcnt(0)
L_QKM_v0:
  s_sub_u32 s24, s24, 1
  s_cbranch_scc1 L_FAIL
  buffer_load_dwordx4 v[4:7], v95, s[4:7], s92 offen offset:0 sc1
  buffer_load_dwordx4 v[8:11], v95, s[4:7], s92 offen offset:2048 sc1
  buffer_load_dwordx4 v[12:15], v95, s[4:7], s93 offen offset:0 sc1
  buffer_load_dwordx4 v[16:19], v95, s[4:7], s93 offen offset:2048 sc1
  v_mov_b32 v89, 0
  s_waitcnt vmcnt(0)
  v_max3_u32 v89, v4, v5, v89
  v_max3_u32 v89, v6, v7, v89
  v_max3_u32 v89, v8, v9, v89
  v_max3_u32 v89, v10, v11, v89
  v_max3_u32 v89, v12, v13, v89
  v_max3_u32 v89, v14, v15, v89
  v_max3_u32 v89, v16, v17, v89
  v_max3_u32 v89, v18, v19, v89
  v_cmp_eq_u32 vcc, -1, v89
  s_cbranch_vccnz L_QKM_v0
L_QKM_v4:
  s_sub_u32 s24, s24, 1
  s_cbranch_scc1 L_FAIL
  buffer_load_dwordx4 v[68:71], v95, s[4:7], s94 offen offset:0 sc1
  buffer_load_dwordx4 v[72:75], v95, s[4:7], s94 offen offset:2048 sc1
  buffer_load_dwordx4 v[4:7], v95, s[4:7], s95 offen offset:0 sc1
  buffer_load_dwordx4 v[8:11], v95, s[4:7], s95 offen offset:2048 sc1
  v_mov_b32 v89, 0
  s_waitcnt vmcnt(0)
  v_max3_u32 v89, v68, v69, v89
  v_max3_u32 v89, v70, v71, v89
  v_max3_u32 v89, v72, v73, v89
  v_max3_u32 v89, v74, v75, v89
  v_max3_u32 v89, v4, v5, v89
  v_max3_u32 v89, v6, v7, v89
  v_max3_u32 v89, v8, v9, v89
  v_max3_u32 v89, v10, v11, v89
  v_cmp_eq_u32 vcc, -1, v89
  s_cbranch_vccnz L_QKM_v4
L_QKM_v8:
  s_sub_u32 s24, s24, 1
  s_cbranch_scc1 L_FAIL
  buffer_load_dwordx4 v[12:15], v95, s[4:7], s96 offen offset:0 sc1
  buffer_load_dwordx4 v[16:19], v95, s[4:7], s96 offen offset:2048 sc1
  buffer_load_dwordx4 v[68:71], v95, s[4:7], s97 offen offset:0 sc1
  buffer_load_dwordx4 v[72:75], v95, s[4:7], s97 offen offset:2048 sc1
  v_mov_b32 v89, 0
  s_waitcnt vmcnt(0)
  v_max3_u32 v89, v12, v13, v89
  v_max3_u32 v89, v14, v15, v89
  v_max3_u32 v89, v16, v17, v89
  v_max3_u32 v89, v18, v19, v89
  v_max3_u32 v89, v68, v69, v89
  v_max3_u32 v89, v70, v71, v89
  v_max3_u32 v89, v72, v73, v89
  v_max3_u32 v89, v74, v75, v89
  v_cmp_eq_u32 vcc, -1, v89
  s_cbranch_vccnz L_QKM_v8
L_QKM_v12:
  s_sub_u32 s24, s24, 1
  s_cbranch_scc1 L_FAIL
  buffer_load_dwordx4 v[4:7], v95, s[4:7], s98 offen offset:0 sc1
  buffer_load_dwordx4 v[8:11], v95, s[4:7], s98 offen offset:2048 sc1
  buffer_load_dwordx4 v[12:15], v95, s[4:7], s99 offen offset:0 sc1
  buffer_load_dwordx4 v[16:19], v95, s[4:7], s99 offen offset:2048 sc1
  v_mov_b32 v89, 0
  s_waitcnt vmcnt(0)
  v_max3_u32 v89, v4, v5, v89
  v_max3_u32 v89, v6, v7, v89
  v_max3_u32 v89, v8, v9, v89
  v_max3_u32 v89, v10, v11, v89
  v_max3_u32 v89, v12, v13, v89
  v_max3_u32 v89, v14, v15, v89
  v_max3_u32 v89, v16, v17, v89
  v_max3_u32 v89, v18, v19, v89
  v_cmp_eq_u32 vcc, -1, v89
  s_cbranch_vccnz L_QKM_v12
  v_mov_b64 v[52:53], 0
  v_mov_b64 v[54:55], 0
  v_mov_b64 v[56:57], 0
  v_mov_b64 v[58:59], 0
  v_mov_b64 v[60:61], 0
  v_mov_b64 v[62:63], 0
  v_mov_b64 v[64:65], 0
  v_mov_b64 v[66:67], 0
  ds_read_b128 v[20:23], v85 offset:0
  ds_read_b128 v[24:27], v85 offset:1024
  ds_read_b128 v[28:31], v85 offset:8192
  ds_read_b128 v[32:35], v85 offset:9216
  ds_read_b128 v[36:39], v85 offset:2048
  ds_read_b128 v[40:43], v85 offset:3072
  ds_read_b128 v[44:47], v85 offset:10240
  ds_read_b128 v[48:51], v85 offset:11264
  s_waitcnt lgkmcnt(0)
L_QKMS_again:
  buffer_load_dwordx4 v[4:7], v95, s[4:7], s92 offen offset:0 sc1
  s_nop 0
  buffer_load_dwordx4 v[8:11], v95, s[4:7], s92 offen offset:2048 sc1
  s_nop 0
  buffer_load_dwordx4 v[12:15], v95, s[4:7], s93 offen offset:0 sc1
  s_nop 0
  buffer_load_dwordx4 v[16:19], v95, s[4:7], s93 offen offset:2048 sc1
  s_nop 0
  buffer_load_dwordx4 v[68:71], v95, s[4:7], s94 offen offset:0 sc1
  s_nop 0
  s_waitcnt vmcnt(4)
  buffer_load_dwordx4 v[72:75], v95, s[4:7], s94 offen offset:2048 sc1
  v_smfmac_f32_16x16x64_bf16 v[52:55], v[4:7], a[0:7], v88
  v_smfmac_f32_16x16x64_bf16 v[60:63], v[4:7], v[128:135], v88
  s_waitcnt vmcnt(4)
  v_smfmac_f32_16x16x64_bf16 v[56:59], v[4:7], a[128:135], v88
  v_smfmac_f32_16x16x64_bf16 v[64:67], v[4:7], v[20:27], v88
  buffer_load_dwordx4 v[4:7], v95, s[4:7], s95 offen offset:0 sc1
  v_smfmac_f32_16x16x64_bf16 v[52:55], v[8:11], a[8:15], v88
  ds_read_b128 v[20:23], v85 offset:4096
  v_smfmac_f32_16x16x64_bf16 v[60:63], v[8:11], v[136:143], v88
  ds_read_b128 v[24:27], v85 offset:5120
  s_waitcnt vmcnt(4)
  v_smfmac_f32_16x16x64_bf16 v[56:59], v[8:11], a[136:143], v88
  v_smfmac_f32_16x16x64_bf16 v[64:67], v[8:11], v[28:35], v88
  buffer_load_dwordx4 v[8:11], v95, s[4:7], s95 offen offset:2048 sc1
  v_smfmac_f32_16x16x64_bf16 v[52:55], v[12:15], a[16:23], v88
  ds_read_b128 v[28:31], v85 offset:12288
  v_smfmac_f32_16x16x64_bf16 v[60:63], v[12:15], v[144:151], v88
  ds_read_b128 v[32:35], v85 offset:13312
  s_waitcnt vmcnt(4)
  v_smfmac_f32_16x16x64_bf16 v[56:59], v[12:15], a[144:151], v88
  v_smfmac_f32_16x16x64_bf16 v[64:67], v[12:15], v[36:43], v88
  buffer_load_dwordx4 v[12:15], v95, s[4:7], s96 offen offset:0 sc1
  v_smfmac_f32_16x16x64_bf16 v[52:55], v[16:19], a[24:31], v88
  ds_read_b128 v[36:39], v85 offset:6144
  v_smfmac_f32_16x16x64_bf16 v[60:63], v[16:19], v[152:159], v88
  ds_read_b128 v[40:43], v85 offset:7168
  s_waitcnt vmcnt(4)
  v_smfmac_f32_16x16x64_bf16 v[56:59], v[16:19], a[152:159], v88
  v_smfmac_f32_16x16x64_bf16 v[64:67], v[16:19], v[44:51], v88
  buffer_load_dwordx4 v[16:19], v95, s[4:7], s96 offen offset:2048 sc1
  v_smfmac_f32_16x16x64_bf16 v[52:55], v[68:71], a[32:39], v88
  ds_read_b128 v[44:47], v85 offset:14336
  v_smfmac_f32_16x16x64_bf16 v[60:63], v[68:71], v[160:167], v88
  ds_read_b128 v[48:51], v85 offset:15360
  s_waitcnt vmcnt(4)
  v_smfmac_f32_16x16x64_bf16 v[56:59], v[68:71], a[160:167], v88
  s_waitcnt lgkmcnt(6)
  v_smfmac_f32_16x16x64_bf16 v[64:67], v[68:71], v[20:27], v88
  buffer_load_dwordx4 v[68:71], v95, s[4:7], s97 offen offset:0 sc1
  v_smfmac_f32_16x16x64_bf16 v[52:55], v[72:75], a[40:47], v88
  ds_read_b128 v[20:23], v85 offset:16384
  v_smfmac_f32_16x16x64_bf16 v[60:63], v[72:75], v[168:175], v88
  ds_read_b128 v[24:27], v85 offset:17408
  s_waitcnt vmcnt(4)
  v_smfmac_f32_16x16x64_bf16 v[56:59], v[72:75], a[168:175], v88
  s_waitcnt lgkmcnt(6)
  v_smfmac_f32_16x16x64_bf16 v[64:67], v[72:75], v[28:35], v88
  buffer_load_dwordx4 v[72:75], v95, s[4:7], s97 offen offset:2048 sc1
  v_smfmac_f32_16x16x64_bf16 v[52:55], v[4:7], a[48:55], v88
  ds_read_b128 v[28:31], v85 offset:24576
  v_smfmac_f32_16x16x64_bf16 v[60:63], v[4:7], v[176:183], v88
  ds_read_b128 v[32:35], v85 offset:25600
  s_waitcnt vmcnt(4)
  v_smfmac_f32_16x16x64_bf16 v[56:59], v[4:7], a[176:183], v88
  s_waitcnt lgkmcnt(6)
  v_smfmac_f32_16x16x64_bf16 v[64:67], v[4:7], v[36:43], v88
  buffer_load_dwordx4 v[4:7], v95, s[4:7], s98 offen offset:0 sc1
  v_smfmac_f32_16x16x64_bf16 v[52:55], v[8:11], a[56:63], v88
  ds_read_b128 v[36:39], v85 offset:18432
  v_smfmac_f32_16x16x64_bf16 v[60:63], v[8:11], v[184:191], v88
  ds_read_b128 v[40:43], v85 offset:19456
  s_waitcnt vmcnt(4)
  v_smfmac_f32_16x16x64_bf16 v[56:59], v[8:11], a[184:191], v88
  s_waitcnt lgkmcnt(6)
  v_smfmac_f32_16x16x64_bf16 v[64:67], v[8:11], v[44:51], v88
  buffer_load_dwordx4 v[8:11], v95, s[4:7], s98 offen offset:2048 sc1
  v_smfmac_f32_16x16x64_bf16 v[52:55], v[12:15], a[64:71], v88
  ds_read_b128 v[44:47], v85 offset:26624
  v_smfmac_f32_16x16x64_bf16 v[60:63], v[12:15], v[192:199], v88
  ds_read_b128 v[48:51], v85 offset:27648
  s_waitcnt vmcnt(4)
  v_smfmac_f32_16x16x64_bf16 v[56:59], v[12:15], a[192:199], v88
  s_waitcnt lgkmcnt(6)
  v_smfmac_f32_16x16x64_bf16 v[64:67], v[12:15], v[20:27], v88
  buffer_load_dwordx4 v[12:15], v95, s[4:7], s99 offen offset:0 sc1
  v_smfmac_f32_16x16x64_bf16 v[52:55], v[16:19], a[72:79], v88
  ds_read_b128 v[20:23], v85 offset:20480
  v_smfmac_f32_16x16x64_bf16 v[60:63], v[16:19], v[200:207], v88
  ds_read_b128 v[24:27], v85 offset:21504
  s_waitcnt vmcnt(4)
  v_smfmac_f32_16x16x64_bf16 v[56:59], v[16:19], a[200:207], v88
  s_waitcnt lgkmcnt(6)
  v_smfmac_f32_16x16x64_bf16 v[64:67], v[16:19], v[28:35], v88
  buffer_load_dwordx4 v[16:19], v95, s[4:7], s99 offen offset:2048 sc1
  v_smfmac_f32_16x16x64_bf16 v[52:55], v[68:71], a[80:87], v88
  ds_read_b128 v[28:31], v85 offset:28672
  v_smfmac_f32_16x16x64_bf16 v[60:63], v[68:71], v[208:215], v88
  ds_read_b128 v[32:35], v85 offset:29696
  s_waitcnt vmcnt(4)
  v_smfmac_f32_16x16x64_bf16 v[56:59], v[68:71], a[208:215], v88
  s_waitcnt lgkmcnt(6)
  v_smfmac_f32_16x16x64_bf16 v[64:67], v[68:71], v[36:43], v88
  ds_read_b128 v[36:39], v85 offset:22528
  v_smfmac_f32_16x16x64_bf16 v[52:55], v[72:75], a[88:95], v88
  ds_read_b128 v[40:43], v85 offset:23552
  v_smfmac_f32_16x16x64_bf16 v[60:63], v[72:75], v[216:223], v88
  s_waitcnt vmcnt(3)
  v_smfmac_f32_16x16x64_bf16 v[56:59], v[72:75], a[216:223], v88
  s_waitcnt lgkmcnt(6)
  v_smfmac_f32_16x16x64_bf16 v[64:67], v[72:75], v[44:51], v88
  ds_read_b128 v[44:47], v85 offset:30720
  v_smfmac_f32_16x16x64_bf16 v[52:55], v[4:7], a[96:103], v88
  ds_read_b128 v[48:51], v85 offset:31744
  v_smfmac_f32_16x16x64_bf16 v[60:63], v[4:7], v[224:231], v88
  s_waitcnt vmcnt(2)
  v_smfmac_f32_16x16x64_bf16 v[56:59], v[4:7], a[224:231], v88
  s_waitcnt lgkmcnt(6)
  v_smfmac_f32_16x16x64_bf16 v[64:67], v[4:7], v[20:27], v88
  ds_read_b128 v[20:23], v1 offset:16384
  v_smfmac_f32_16x16x64_bf16 v[52:55], v[8:11], a[104:111], v88
  ds_read_b128 v[24:27], v1 offset:17408
  v_smfmac_f32_16x16x64_bf16 v[60:63], v[8:11], v[232:239], v88
  ds_read_b128 v[68:71], v84 offset:16384
  s_waitcnt vmcnt(1)
  v_smfmac_f32_16x16x64_bf16 v[56:59], v[8:11], a[232:239], v88
  s_waitcnt lgkmcnt(7)
  v_smfmac_f32_16x16x64_bf16 v[64:67], v[8:11], v[28:35], v88
  ds_read_b128 v[28:31], v2 offset:16384
  v_smfmac_f32_16x16x64_bf16 v[52:55], v[12:15], a[112:119], v88
  ds_read_b128 v[32:35], v2 offset:17408
  v_smfmac_f32_16x16x64_bf16 v[60:63], v[12:15], v[240:247], v88
  ds_read_b128 v[72:75], v84 offset:17408
  s_waitcnt vmcnt(0)
  v_smfmac_f32_16x16x64_bf16 v[56:59], v[12:15], a[240:247], v88
  s_waitcnt lgkmcnt(8)
  v_smfmac_f32_16x16x64_bf16 v[64:67], v[12:15], v[36:43], v88
  ds_read_b128 v[36:39], v3 offset:16384
  v_smfmac_f32_16x16x64_bf16 v[52:55], v[16:19], a[120:127], v88
  ds_read_b128 v[40:43], v3 offset:17408
  v_smfmac_f32_16x16x64_bf16 v[60:63], v[16:19], v[248:255], v88
  v_smfmac_f32_16x16x64_bf16 v[56:59], v[16:19], a[248:255], v88
  s_waitcnt lgkmcnt(8)
  v_smfmac_f32_16x16x64_bf16 v[64:67], v[16:19], v[44:51], v88
  s_nop 7
  s_branch L_QKM_join
L_QKM_g0:
  s_sub_u32 s24, s24, 1
  s_cbranch_scc1 L_FAIL
  s_add_u32 s60, s60, 1
  buffer_load_dwordx4 v[4:7], v95, s[4:7], s92 offen offset:0 sc1
  s_waitcnt vmcnt(0)
  v_cmp_eq_u32 vcc, -1, v4
  s_cbranch_vccnz L_QKM_g0
  v_mov_b32 v89, 0
  v_max3_u32 v89, v8, v12, v89
  v_max3_u32 v89, v16, v68, v89
  v_cmp_eq_u32 vcc, -1, v89
  s_cbranch_vccz L_QKM_ok0
  buffer_load_dwordx4 v[8:11], v95, s[4:7], s92 offen offset:2048 sc1
  s_nop 0
  buffer_load_dwordx4 v[12:15], v95, s[4:7], s93 offen offset:0 sc1
  s_nop 0
  buffer_load_dwordx4 v[16:19], v95, s[4:7], s93 offen offset:2048 sc1
  s_nop 0
  buffer_load_dwordx4 v[68:71], v95, s[4:7], s94 offen offset:0 sc1
  s_nop 0
  s_branch L_QKM_ok0
L_QKM_g1:
  s_sub_u32 s24, s24, 1
  s_cbranch_scc1 L_FAIL
  s_add_u32 s60, s60, 1
  buffer_load_dwordx4 v[8:11], v95, s[4:7], s92 offen offset:2048 sc1
  s_waitcnt vmcnt(0)
  v_cmp_eq_u32 vcc, -1, v8
  s_cbranch_vccnz L_QKM_g1
  v_mov_b32 v89, 0
  v_max3_u32 v89, v12, v16, v89
  v_max3_u32 v89, v68, v72, v89
  v_cmp_eq_u32 vcc, -1, v89
  s_cbranch_vccz L_QKM_ok1
  buffer_load_dwordx4 v[12:15], v95, s[4:7], s93 offen offset:0 sc1
  s_nop 0
  buffer_load_dwordx4 v[16:19], v95, s[4:7], s93 offen offset:2048 sc1
  s_nop 0
  buffer_load_dwordx4 v[68:71], v95, s[4:7], s94 offen offset:0 sc1
  s_nop 0
  buffer_load_dwordx4 v[72:75], v95, s[4:7], s94 offen offset:2048 sc1
  s_nop 0
  s_branch L_QKM_ok1
L_QKM_g2:
  s_sub_u32 s24, s24, 1
  s_cbranch_scc1 L_FAIL
  s_add_u32 s60, s60, 1
  buffer_load_dwordx4 v[12:15], v95, s[4:7], s93 offen offset:0 sc1
  s_waitcnt vmcnt(0)
  v_cmp_eq_u32 vcc, -1, v12
  s_cbranch_vccnz L_QKM_g2
  v_mov_b32 v89, 0
  v_max3_u32 v89, v16, v68, v89
  v_max3_u32 v89, v72, v4, v89
  v_cmp_eq_u32 vcc, -1, v89
  s_cbranch_vccz L_QKM_ok2
  buffer_load_dwordx4 v[16:19], v95, s[4:7], s93 offen offset:2048 sc1
  s_nop 0
  buffer_load_dwordx4 v[68:71], v95, s[4:7], s94 offen offset:0 sc1
  s_nop 0
  buffer_load_dwordx4 v[72:75], v95, s[4:7], s94 offen offset:2048 sc1
  s_nop 0
  buffer_load_dwordx4 v[4:7], v95, s[4:7], s95 offen offset:0 sc1
  s_nop 0
  s_branch L_QKM_ok2
L_QKM_g3:
  s_sub_u32 s24, s24, 1
  s_cbranch_scc1 L_FAIL
  s_add_u32 s60, s60, 1
  buffer_load_dwordx4 v[16:19], v95, s[4:7], s93 offen offset:2048 sc1
  s_waitcnt vmcnt(0)
  v_cmp_eq_u32 vcc, -1, v16
  s_cbranch_vccnz L_QKM_g3
  v_mov_b32 v89, 0
  v_max3_u32 v89, v68, v72, v89
  v_max3_u32 v89, v4, v8, v89
  v_cmp_eq_u32 vcc, -1, v89
  s_cbranch_vccz L_QKM_ok3
  buffer_load_dwordx4 v[68:71], v95, s[4:7], s94 offen offset:0 sc1
  s_nop 0
  buffer_load_dwordx4 v[72:75], v95, s[4:7], s94 offen offset:2048 sc1
  s_nop 0
  buffer_load_dwordx4 v[4:7], v95, s[4:7], s95 offen offset:0 sc1
  s_nop 0
  buffer_load_dwordx4 v[8:11], v95, s[4:7], s95 offen offset:2048 sc1
  s_nop 0
  s_branch L_QKM_ok3
L_QKM_g4:
  s_sub_u32 s24, s24, 1
  s_cbranch_scc1 L_FAIL
  s_add_u32 s60, s60, 1
  buffer_load_dwordx4 v[68:71], v95, s[4:7], s94 offen offset:0 sc1
  s_waitcnt vmcnt(0)
  v_cmp_eq_u32 vcc, -1, v68
  s_cbranch_vccnz L_QKM_g4
  v_mov_b32 v89, 0
  v_max3_u32 v89, v72, v4, v89
  v_max3_u32 v89, v8, v12, v89
  v_cmp_eq_u32 vcc, -1, v89
  s_cbranch_vccz L_QKM_ok4
  buffer_load_dwordx4 v[72:75], v95, s[4:7], s94 offen offset:2048 sc1
  s_nop 0
  buffer_load_dwordx4 v[4:7], v95, s[4:7], s95 offen offset:0 sc1
  s_nop 0
  buffer_load_dwordx4 v[8:11], v95, s[4:7], s95 offen offset:2048 sc1
  s_nop 0
  buffer_load_dwordx4 v[12:15], v95, s[4:7], s96 offen offset:0 sc1
  s_nop 0
  s_branch L_QKM_ok4
L_QKM_g5:
  s_sub_u32 s24, s24, 1
  s_cbranch_scc1 L_FAIL
  s_add_u32 s60, s60, 1
  buffer_load_dwordx4 v[72:75], v95, s[4:7], s94 offen offset:2048 sc1
  s_waitcnt vmcnt(0)
  v_cmp_eq_u32 vcc, -1, v72
  s_cbranch_vccnz L_QKM_g5
  v_mov_b32 v89, 0
  v_max3_u32 v89, v4, v8, v89
  v_max3_u32 v89, v12, v16, v89
  v_cmp_eq_u32 vcc, -1, v89
  s_cbranch_vccz L_QKM_ok5
  buffer_load_dwordx4 v[4:7], v95, s[4:7], s95 offen offset:0 sc1
  s_nop 0
  buffer_load_dwordx4 v[8:11], v95, s[4:7], s95 offen offset:2048 sc1
  s_nop 0
  buffer_load_dwordx4 v[12:15], v95, s[4:7], s96 offen offset:0 sc1
  s_nop 0
  buffer_load_dwordx4 v[16:19], v95, s[4:7], s96 offen offset:2048 sc1
  s_nop 0
  s_branch L_QKM_ok5
L_QKM_g6:
  s_sub_u32 s24, s24, 1
  s_cbranch_scc1 L_FAIL
  s_add_u32 s60, s60, 1
  buffer_load_dwordx4 v[4:7], v95, s[4:7], s95 offen offset:0 sc1
  s_waitcnt vmcnt(0)
  v_cmp_eq_u32 vcc, -1, v4
  s_cbranch_vccnz L_QKM_g6
  v_mov_b32 v89, 0
  v_max3_u32 v89, v8, v12, v89
  v_max3_u32 v89, v16, v68, v89
  v_cmp_eq_u32 vcc, -1, v89
  s_cbranch_vccz L_QKM_ok6
  buffer_load_dwordx4 v[8:11], v95, s[4:7], s95 offen offset:2048 sc1
  s_nop 0
  buffer_load_dwordx4 v[12:15], v95, s[4:7], s96 offen offset:0 sc1
  s_nop 0
  buffer_load_dwordx4 v[16:19], v95, s[4:7], s96 offen offset:2048 sc1
  s_nop 0
  buffer_load_dwordx4 v[68:71], v95, s[4:7], s97 offen offset:0 sc1
  s_nop 0
  s_branch L_QKM_ok6
L_QKM_g7:
  s_sub_u32 s24, s24, 1
  s_cbranch_scc1 L_FAIL
  s_add_u32 s60, s60, 1
  buffer_load_dwordx4 v[8:11], v95, s[4:7], s95 offen offset:2048 sc1
  s_waitcnt vmcnt(0)
  v_cmp_eq_u32 vcc, -1, v8
  s_cbranch_vccnz L_QKM_g7
  v_mov_b32 v89, 0
  v_max3_u32 v89, v12, v16, v89
  v_max3_u32 v89, v68, v72, v89
  v_cmp_eq_u32 vcc, -1, v89
  s_cbranch_vccz L_QKM_ok7
  buffer_load_dwordx4 v[12:15], v95, s[4:7], s96 offen offset:0 sc1
  s_nop 0
  buffer_load_dwordx4 v[16:19], v95, s[4:7], s96 offen offset:2048 sc1
  s_nop 0
  buffer_load_dwordx4 v[68:71], v95, s[4:7], s97 offen offset:0 sc1
  s_nop 0
  buffer_load_dwordx4 v[72:75], v95, s[4:7], s97 offen offset:2048 sc1
  s_nop 0
  s_branch L_QKM_ok7
L_QKM_g8:
  s_sub_u32 s24, s24, 1
  s_cbranch_scc1 L_FAIL
  s_add_u32 s60, s60, 256
  buffer_load_dwordx4 v[12:15], v95, s[4:7], s96 offen offset:0 sc1
  s_waitcnt vmcnt(0)
  v_cmp_eq_u32 vcc, -1, v12
  s_cbranch_vccnz L_QKM_g8
  v_mov_b32 v89, 0
  v_max3_u32 v89, v16, v68, v89
  v_max3_u32 v89, v72, v4, v89
  v_cmp_eq_u32 vcc, -1, v89
  s_cbranch_vccz L_QKM_ok8
  buffer_load_dwordx4 v[16:19], v95, s[4:7], s96 offen offset:2048 sc1
  s_nop 0
  buffer_load_dwordx4 v[68:71], v95, s[4:7], s97 offen offset:0 sc1
  s_nop 0
  buffer_load_dwordx4 v[72:75], v95, s[4:7], s97 offen offset:2048 sc1
  s_nop 0
  buffer_load_dwordx4 v[4:7], v95, s[4:7], s98 offen offset:0 sc1
  s_nop 0
  s_branch L_QKM_ok8
L_QKM_g9:
  s_sub_u32 s24, s24, 1
  s_cbranch_scc1 L_FAIL
  s_add_u32 s60, s60, 256
  buffer_load_dwordx4 v[16:19], v95, s[4:7], s96 offen offset:2048 sc1
  s_waitcnt vmcnt(0)
  v_cmp_eq_u32 vcc, -1, v16
  s_cbranch_vccnz L_QKM_g9
  v_mov_b32 v89, 0
  v_max3_u32 v89, v68, v72, v89
  v_max3_u32 v89, v4, v8, v89
  v_cmp_eq_u32 vcc, -1, v89
  s_cbranch_vccz L_QKM_ok9
  buffer_load_dwordx4 v[68:71], v95, s[4:7], s97 offen offset:0 sc1
  s_nop 0
  buffer_load_dwordx4 v[72:75], v95, s[4:7], s97 offen offset:2048 sc1
  s_nop 0
  buffer_load_dwordx4 v[4:7], v95, s[4:7], s98 offen offset:0 sc1
  s_nop 0
  buffer_load_dwordx4 v[8:11], v95, s[4:7], s98 offen offset:2048 sc1
  s_nop 0
  s_branch L_QKM_ok9
L_QKM_g10:
  s_sub_u32 s24, s24, 1
  s_cbranch_scc1 L_FAIL
  s_add_u32 s60, s60, 256
  buffer_load_dwordx4 v[68:71], v95, s[4:7], s97 offen offset:0 sc1
  s_waitcnt vmcnt(0)
  v_cmp_eq_u32 vcc, -1, v68
  s_cbranch_vccnz L_QKM_g10
  v_mov_b32 v89, 0
  v_max3_u32 v89, v72, v4, v89
  v_max3_u32 v89, v8, v12, v89
  v_cmp_eq_u32 vcc, -1, v89
  s_cbranch_vccz L_QKM_ok10
  buffer_load_dwordx4 v[72:75], v95, s[4:7], s97 offen offset:2048 sc1
  s_nop 0
  buffer_load_dwordx4 v[4:7], v95, s[4:7], s98 offen offset:0 sc1
  s_nop 0
  buffer_load_dwordx4 v[8:11], v95, s[4:7], s98 offen offset:2048 sc1
  s_nop 0
  buffer_load_dwordx4 v[12:15], v95, s[4:7], s99 offen offset:0 sc1
  s_nop 0
  s_branch L_QKM_ok10
L_QKM_g11:
  s_sub_u32 s24, s24, 1
  s_cbranch_scc1 L_FAIL
  s_add_u32 s60, s60, 256
  buffer_load_dwordx4 v[72:75], v95, s[4:7], s97 offen offset:2048 sc1
  s_waitcnt vmcnt(0)
  v_cmp_eq_u32 vcc, -1, v72
  s_cbranch_vccnz L_QKM_g11
  v_mov_b32 v89, 0
  v_max3_u32 v89, v4, v8, v89
  v_max3_u32 v89, v12, v16, v89
  v_cmp_eq_u32 vcc, -1, v89
  s_cbranch_vccz L_QKM_ok11
  buffer_load_dwordx4 v[4:7], v95, s[4:7], s98 offen offset:0 sc1
  s_nop 0
  buffer_load_dwordx4 v[8:11], v95, s[4:7], s98 offen offset:2048 sc1
  s_nop 0
  buffer_load_dwordx4 v[12:15], v95, s[4:7], s99 offen offset:0 sc1
  s_nop 0
  buffer_load_dwordx4 v[16:19], v95, s[4:7], s99 offen offset:2048 sc1
  s_nop 0
  s_branch L_QKM_ok11
L_QKM_g12:
  s_sub_u32 s24, s24, 1
  s_cbranch_scc1 L_FAIL
  s_add_u32 s60, s60, 256
  buffer_load_dwordx4 v[4:7], v95, s[4:7], s98 offen offset:0 sc1
  s_waitcnt vmcnt(0)
  v_cmp_eq_u32 vcc, -1, v4
  s_cbranch_vccnz L_QKM_g12
  v_mov_b32 v89, 0
  v_max3_u32 v89, v8, v12, v89
  v_max3_u32 v89, v16, v16, v89
  v_cmp_eq_u32 vcc, -1, v89
  s_cbranch_vccz L_QKM_ok12
  buffer_load_dwordx4 v[8:11], v95, s[4:7], s98 offen offset:2048 sc1
  s_nop 0
  buffer_load_dwordx4 v[12:15], v95, s[4:7], s99 offen offset:0 sc1
  s_nop 0
  buffer_load_dwordx4 v[16:19], v95, s[4:7], s99 offen offset:2048 sc1
  s_nop 0
  s_branch L_QKM_ok12
L_QKM_g13:
  s_sub_u32 s24, s24, 1
  s_cbranch_scc1 L_FAIL
  s_add_u32 s60, s60, 256
  buffer_load_dwordx4 v[8:11], v95, s[4:7], s98 offen offset:2048 sc1
  s_waitcnt vmcnt(0)
  v_cmp_eq_u32 vcc, -1, v8
  s_cbranch_vccnz L_QKM_g13
  v_mov_b32 v89, 0
  v_max3_u32 v89, v12, v16, v89
  v_cmp_eq_u32 vcc, -1, v89
  s_cbranch_vccz L_QKM_ok13
  buffer_load_dwordx4 v[12:15], v95, s[4:7], s99 offen offset:0 sc1
  s_nop 0
  buffer_load_dwordx4 v[16:19], v95, s[4:7], s99 offen offset:2048 sc1
  s_nop 0
  s_branch L_QKM_ok13
L_QKM_g14:
  s_sub_u32 s24, s24, 1
  s_cbranch_scc1 L_FAIL
  s_add_u32 s60, s60, 256
  buffer_load_dwordx4 v[12:15], v95, s[4:7], s99 offen offset:0 sc1
  s_waitcnt vmcnt(0)
  v_cmp_eq_u32 vcc, -1, v12
  s_cbranch_vccnz L_QKM_g14
  v_mov_b32 v89, 0
  v_max3_u32 v89, v16, v16, v89
  v_cmp_eq_u32 vcc, -1, v89
  s_cbranch_vccz L_QKM_ok14
  buffer_load_dwordx4 v[16:19], v95, s[4:7], s99 offen offset:2048 sc1
  s_nop 0
  s_branch L_QKM_ok14
L_QKM_g15:
  s_sub_u32 s24, s24, 1
  s_cbranch_scc1 L_FAIL
  s_add_u32 s60, s60, 256
  buffer_load_dwordx4 v[16:19], v95, s[4:7], s99 offen offset:2048 sc1
  s_waitcnt vmcnt(0)
  v_cmp_eq_u32 vcc, -1, v16
  s_cbranch_vccnz L_QKM_g15
  s_branch L_QKM_ok15
L_QK_vbad:
  s_sub_u32 s24, s24, 1
  s_cbranch_scc1 L_FAIL
  s_add_u32 s61, s61, 1
  buffer_load_dwordx2 v[104:105], v92, s[4:7], s29 offen sc1
  buffer_load_dwordx2 v[106:107], v92, s[4:7], s35 offen sc1
  s_waitcnt vmcnt(0)
  v_max3_u32 v89, v104, v105, v106
  v_max_u32 v89, v89, v107
  v_cmp_eq_u32 vcc, -1, v89
  s_cbranch_vccnz L_QK_vbad
  s_branch L_QK_vok
L_VO:
  v_bfe_u32 v76, v0, 3, 2
  v_xor_b32 v76, s20, v76
  v_lshlrev_b32 v76, 5, v76
  v_lshrrev_b32 v4, 2, v0
  v_lshl_add_u32 v4, v4, 7, v76
  v_and_b32 v76, 3, v0
  v_lshl_add_u32 v4, v76, 3, v4
  s_lshl_b32 s40, s20, 15
  v_add_u32 v4, s40, v4
  v_lshl_add_u32 v85, v0, 4, s40
  s_lshl_b32 s40, s20, 12
  s_add_u32 s40, s40, 131072
  v_lshl_add_u32 v1, v0, 4, s40
  s_lshr_b32 s54, s21, 4
  s_lshl_b32 s52, s54, 22
  s_sub_u32 s53, 0, s52
  v_xor_b32 v5, 32768, v4
  v_xor_b32 v2, 4096, v1
  v_xor_b32 v6, 65536, v4
  v_xor_b32 v3, 8192, v1
  v_xor_b32 v7, 98304, v4
  v_xor_b32 v84, 12288, v1
  v_bfe_u32 v8, v0, 5, 1
  v_mul_u32_u24 v8, 16384, v8
  v_bfe_u32 v76, v0, 4, 1
  v_mul_u32_u24 v76, 32768, v76
  v_add_u32 v8, v8, v76
  v_bfe_u32 v76, v0, 3, 1
  v_mul_u32_u24 v76, 131072, v76
  v_add_u32 v8, v8, v76
  v_lshrrev_b32 v76, 3, v0
  v_and_b32 v76, 6, v76
  v_xor_b32 v76, v76, v0
  v_and_b32 v76, 7, v76
  v_lshl_add_u32 v8, v76, 4, v8
  s_lshl_b32 s40, s20, 19
  v_add_u32 v8, s40, v8
  s_lshl_b32 s44, s21, 8
  s_add_u32 s45, s44, 128
  s_load_dwordx2 s[8:9], s[0:1], 32
  s_mov_b32 s10, 8388608
  s_mov_b32 s11, 0x20000
  s_waitcnt lgkmcnt(0)
  v_add_u32 v9, s44, v8
  v_add_u32 v10, s45, v8
  s_lshl_b32 s41, s20, 15
  s_add_u32 m0, s41, 0
  s_add_u32 s42, s52, 0
  buffer_load_dwordx4 v9, s[8:11], s42 offen lds
  s_add_u32 m0, s41, 1024
  s_add_u32 s42, s52, 65536
  buffer_load_dwordx4 v9, s[8:11], s42 offen lds
  s_add_u32 m0, s41, 2048
  s_add_u32 s42, s52, 8192
  buffer_load_dwordx4 v9, s[8:11], s42 offen lds
  s_add_u32 m0, s41, 3072
  s_add_u32 s42, s52, 73728
  buffer_load_dwordx4 v9, s[8:11], s42 offen lds
  s_add_u32 m0, s41, 4096
  s_add_u32 s42, s52, 262144
  buffer_load_dwordx4 v9, s[8:11], s42 offen lds
  s_add_u32 m0, s41, 5120
  s_add_u32 s42, s52, 327680
  buffer_load_dwordx4 v9, s[8:11], s42 offen lds
  s_add_u32 m0, s41, 6144
  s_add_u32 s42, s52, 270336
  buffer_load_dwordx4 v9, s[8:11], s42 offen lds
  s_add_u32 m0, s41, 7168
  s_add_u32 s42, s52, 335872
  buffer_load_dwordx4 v9, s[8:11], s42 offen lds
  s_add_u32 m0, s41, 8192
  s_add_u32 s42, s52, 2097152
  buffer_load_dwordx4 v9, s[8:11], s42 offen lds
  s_add_u32 m0, s41, 9216
  s_add_u32 s42, s52, 2162688
  buffer_load_dwordx4 v9, s[8:11], s42 offen lds
  s_add_u32 m0, s41, 10240
  s_add_u32 s42, s52, 2105344
  buffer_load_dwordx4 v9, s[8:11], s42 offen lds
  s_add_u32 m0, s41, 11264
  s_add_u32 s42, s52, 2170880
  buffer_load_dwordx4 v9, s[8:11], s42 offen lds
  s_add_u32 m0, s41, 12288
  s_add_u32 s42, s52, 2359296
  buffer_load_dwordx4 v9, s[8:11], s42 offen lds
  s_add_u32 m0, s41, 13312
  s_add_u32 s42, s52, 2424832
  buffer_load_dwordx4 v9, s[8:11], s42 offen lds
  s_add_u32 m0, s41, 14336
  s_add_u32 s42, s52, 2367488
  buffer_load_dwordx4 v9, s[8:11], s42 offen lds
  s_add_u32 m0, s41, 15360
  s_add_u32 s42, s52, 2433024
  buffer_load_dwordx4 v9, s[8:11], s42 offen lds
  s_add_u32 m0, s41, 16384
  s_add_u32 s42, s53, 4194304
  buffer_load_dwordx4 v9, s[8:11], s42 offen lds
  s_add_u32 m0, s41, 17408
  s_add_u32 s42, s53, 4259840
  buffer_load_dwordx4 v9, s[8:11], s42 offen lds
  s_add_u32 m0, s41, 18432
  s_add_u32 s42, s53, 4202496
  buffer_load_dwordx4 v9, s[8:11], s42 offen lds
  s_add_u32 m0, s41, 19456
  s_add_u32 s42, s53, 4268032
  buffer_load_dwordx4 v9, s[8:11], s42 offen lds
  s_add_u32 m0, s41, 20480
  s_add_u32 s42, s53, 4456448
  buffer_load_dwordx4 v9, s[8:11], s42 offen lds
  s_add_u32 m0, s41, 21504
  s_add_u32 s42, s53, 4521984
  buffer_load_dwordx4 v9, s[8:11], s42 offen lds
  s_add_u32 m0, s41, 22528
  s_add_u32 s42, s53, 4464640
  buffer_load_dwordx4 v9, s[8:11], s42 offen lds
  s_add_u32 m0, s41, 23552
  s_add_u32 s42, s53, 4530176
  buffer_load_dwordx4 v9, s[8:11], s42 offen lds
  s_waitcnt vmcnt(16) lgkmcnt(0)
  s_barrier
  s_add_u32 m0, s41, 24576
  s_add_u32 s42, s53, 6291456
  buffer_load_dwordx4 v9, s[8:11], s42 offen lds
  s_add_u32 m0, s41, 25600
  s_add_u32 s42, s53, 6356992
  buffer_load_dwordx4 v9, s[8:11], s42 offen lds
  s_add_u32 m0, s41, 26624
  s_add_u32 s42, s53, 6299648
  buffer_load_dwordx4 v9, s[8:11], s42 offen lds
  s_add_u32 m0, s41, 27648
  s_add_u32 s42, s53, 6365184
  buffer_load_dwordx4 v9, s[8:11], s42 offen lds
  s_add_u32 m0, s41, 28672
  s_add_u32 s42, s53, 6553600
  buffer_load_dwordx4 v9, s[8:11], s42 offen lds
  s_add_u32 m0, s41, 29696
  s_add_u32 s42, s53, 6619136
  buffer_load_dwordx4 v9, s[8:11], s42 offen lds
  s_add_u32 m0, s41, 30720
  s_add_u32 s42, s53, 6561792
  buffer_load_dwordx4 v9, s[8:11], s42 offen lds
  s_add_u32 m0, s41, 31744
  s_add_u32 s42, s53, 6627328
  buffer_load_dwordx4 v9, s[8:11], s42 offen lds
  ds_read_b64_tr_b16 v[128:129], v4 offset:0
  ds_read_b64_tr_b16 v[130:131], v4 offset:2048
  ds_read_b64_tr_b16 v[132:133], v4 offset:4096
  ds_read_b64_tr_b16 v[134:135], v4 offset:6144
  ds_read_b64_tr_b16 v[144:145], v5 offset:0
  ds_read_b64_tr_b16 v[146:147], v5 offset:2048
  ds_read_b64_tr_b16 v[148:149], v5 offset:4096
  ds_read_b64_tr_b16 v[150:151], v5 offset:6144
  ds_read_b64_tr_b16 v[160:161], v6 offset:0
  ds_read_b64_tr_b16 v[162:163], v6 offset:2048
  ds_read_b64_tr_b16 v[164:165], v6 offset:4096
  ds_read_b64_tr_b16 v[166:167], v6 offset:6144
  ds_read_b64_tr_b16 v[176:177], v7 offset:0
  ds_read_b64_tr_b16 v[178:179], v7 offset:2048
  ds_read_b64_tr_b16 v[180:181], v7 offset:4096
  ds_read_b64_tr_b16 v[182:183], v7 offset:6144
  s_waitcnt vmcnt(16) lgkmcnt(0)
  s_barrier
  s_add_u32 m0, s41, 0
  s_add_u32 s42, s52, 0
  buffer_load_dwordx4 v10, s[8:11], s42 offen lds
  s_add_u32 m0, s41, 1024
  s_add_u32 s42, s52, 65536
  buffer_load_dwordx4 v10, s[8:11], s42 offen lds
  s_add_u32 m0, s41, 2048
  s_add_u32 s42, s52, 8192
  buffer_load_dwordx4 v10, s[8:11], s42 offen lds
  s_add_u32 m0, s41, 3072
  s_add_u32 s42, s52, 73728
  buffer_load_dwordx4 v10, s[8:11], s42 offen lds
  s_add_u32 m0, s41, 4096
  s_add_u32 s42, s52, 262144
  buffer_load_dwordx4 v10, s[8:11], s42 offen lds
  s_add_u32 m0, s41, 5120
  s_add_u32 s42, s52, 327680
  buffer_load_dwordx4 v10, s[8:11], s42 offen lds
  s_add_u32 m0, s41, 6144
  s_add_u32 s42, s52, 270336
  buffer_load_dwordx4 v10, s[8:11], s42 offen lds
  s_add_u32 m0, s41, 7168
  s_add_u32 s42, s52, 335872
  buffer_load_dwordx4 v10, s[8:11], s42 offen lds
  ds_read_b64_tr_b16 v[136:137], v4 offset:8192
  ds_read_b64_tr_b16 v[138:139], v4 offset:10240
  ds_read_b64_tr_b16 v[140:141], v4 offset:12288
  ds_read_b64_tr_b16 v[142:143], v4 offset:14336
  ds_read_b64_tr_b16 v[152:153], v5 offset:8192
  ds_read_b64_tr_b16 v[154:155], v5 offset:10240
  ds_read_b64_tr_b16 v[156:157], v5 offset:12288
  ds_read_b64_tr_b16 v[158:159], v5 offset:14336
  ds_read_b64_tr_b16 v[168:169], v6 offset:8192
  ds_read_b64_tr_b16 v[170:171], v6 offset:10240
  ds_read_b64_tr_b16 v[172:173], v6 offset:12288
  ds_read_b64_tr_b16 v[174:175], v6 offset:14336
  ds_read_b64_tr_b16 v[184:185], v7 offset:8192
  ds_read_b64_tr_b16 v[186:187], v7 offset:10240
  ds_read_b64_tr_b16 v[188:189], v7 offset:12288
  ds_read_b64_tr_b16 v[190:191], v7 offset:14336
  s_waitcnt vmcnt(16) lgkmcnt(0)
  s_barrier
  s_add_u32 m0, s41, 8192
  s_add_u32 s42, s52, 2097152
  buffer_load_dwordx4 v10, s[8:11], s42 offen lds
  s_add_u32 m0, s41, 9216
  s_add_u32 s42, s52, 2162688
  buffer_load_dwordx4 v10, s[8:11], s42 offen lds
  s_add_u32 m0, s41, 10240
  s_add_u32 s42, s52, 2105344
  buffer_load_dwordx4 v10, s[8:11], s42 offen lds
  s_add_u32 m0, s41, 11264
  s_add_u32 s42, s52, 2170880
  buffer_load_dwordx4 v10, s[8:11], s42 offen lds
  s_add_u32 m0, s41, 12288
  s_add_u32 s42, s52, 2359296
  buffer_load_dwordx4 v10, s[8:11], s42 offen lds
  s_add_u32 m0, s41, 13312
  s_add_u32 s42, s52, 2424832
  buffer_load_dwordx4 v10, s[8:11], s42 offen lds
  s_add_u32 m0, s41, 14336
  s_add_u32 s42, s52, 2367488
  buffer_load_dwordx4 v10, s[8:11], s42 offen lds
  s_add_u32 m0, s41, 15360
  s_add_u32 s42, s52, 2433024
  buffer_load_dwordx4 v10, s[8:11], s42 offen lds
  ds_read_b64_tr_b16 v[192:193], v4 offset:16384
  ds_read_b64_tr_b16 v[194:195], v4 offset:18432
  ds_read_b64_tr_b16 v[196:197], v4 offset:20480
  ds_read_b64_tr_b16 v[198:199], v4 offset:22528
  ds_read_b64_tr_b16 v[208:209], v5 offset:16384
  ds_read_b64_tr_b16 v[210:211], v5 offset:18432
  ds_read_b64_tr_b16 v[212:213], v5 offset:20480
  ds_read_b64_tr_b16 v[214:215], v5 offset:22528
  ds_read_b64_tr_b16 v[224:225], v6 offset:16384
  ds_read_b64_tr_b16 v[226:227], v6 offset:18432
  ds_read_b64_tr_b16 v[228:229], v6 offset:20480
  ds_read_b64_tr_b16 v[230:231], v6 offset:22528
  ds_read_b64_tr_b16 v[240:241], v7 offset:16384
  ds_read_b64_tr_b16 v[242:243], v7 offset:18432
  ds_read_b64_tr_b16 v[244:245], v7 offset:20480
  ds_read_b64_tr_b16 v[246:247], v7 offset:22528
  s_waitcnt vmcnt(16) lgkmcnt(0)
  s_barrier
  s_add_u32 m0, s41, 16384
  s_add_u32 s42, s53, 4194304
  buffer_load_dwordx4 v10, s[8:11], s42 offen lds
  s_add_u32 m0, s41, 17408
  s_add_u32 s42, s53, 4259840
  buffer_load_dwordx4 v10, s[8:11], s42 offen lds
  s_add_u32 m0, s41, 18432
  s_add_u32 s42, s53, 4202496
  buffer_load_dwordx4 v10, s[8:11], s42 offen lds
  s_add_u32 m0, s41, 19456
  s_add_u32 s42, s53, 4268032
  buffer_load_dwordx4 v10, s[8:11], s42 offen lds
  s_add_u32 m0, s41, 20480
  s_add_u32 s42, s53, 4456448
  buffer_load_dwordx4 v10, s[8:11], s42 offen lds
  s_add_u32 m0, s41, 21504
  s_add_u32 s42, s53, 4521984
  buffer_load_dwordx4 v10, s[8:11], s42 offen lds
  s_add_u32 m0, s41, 22528
  s_add_u32 s42, s53, 4464640
  buffer_load_dwordx4 v10, s[8:11], s42 offen lds
  s_add_u32 m0, s41, 23552
  s_add_u32 s42, s53, 4530176
  buffer_load_dwordx4 v10, s[8:11], s42 offen lds
  ds_read_b64_tr_b16 v[200:201], v4 offset:24576
  ds_read_b64_tr_b16 v[202:203], v4 offset:26624
  ds_read_b64_tr_b16 v[204:205], v4 offset:28672
  ds_read_b64_tr_b16 v[206:207], v4 offset:30720
  ds_read_b64_tr_b16 v[216:217], v5 offset:24576
  ds_read_b64_tr_b16 v[218:219], v5 offset:26624
  ds_read_b64_tr_b16 v[220:221], v5 offset:28672
  ds_read_b64_tr_b16 v[222:223], v5 offset:30720
  ds_read_b64_tr_b16 v[232:233], v6 offset:24576
  ds_read_b64_tr_b16 v[234:235], v6 offset:26624
  ds_read_b64_tr_b16 v[236:237], v6 offset:28672
  ds_read_b64_tr_b16 v[238:239], v6 offset:30720
  ds_read_b64_tr_b16 v[248:249], v7 offset:24576
  ds_read_b64_tr_b16 v[250:251], v7 offset:26624
  ds_read_b64_tr_b16 v[252:253], v7 offset:28672
  ds_read_b64_tr_b16 v[254:255], v7 offset:30720
  s_cmp_lg_u32 s20, 0
  s_cbranch_scc1 Lchore_71
Lini_72:
  s_load_dwordx16 s[64:79], s[12:13], 128 glc
  s_load_dwordx16 s[80:95], s[12:13], 192 glc
  s_sub_u32 s24, s24, 1
  s_cbranch_scc1 L_FAIL
  s_waitcnt lgkmcnt(0)
  s_and_b64 s[64:65], s[64:65], s[66:67]
  s_and_b64 s[64:65], s[64:65], s[68:69]
  s_and_b64 s[64:65], s[64:65], s[70:71]
  s_and_b64 s[64:65], s[64:65], s[72:73]
  s_and_b64 s[64:65], s[64:65], s[74:75]
  s_and_b64 s[64:65], s[64:65], s[76:77]
  s_and_b64 s[64:65], s[64:65], s[78:79]
  s_and_b64 s[64:65], s[64:65], s[80:81]
  s_and_b64 s[64:65], s[64:65], s[82:83]
  s_and_b64 s[64:65], s[64:65], s[84:85]
  s_and_b64 s[64:65], s[64:65], s[86:87]
  s_and_b64 s[64:65], s[64:65], s[88:89]
  s_and_b64 s[64:65], s[64:65], s[90:91]
  s_and_b64 s[64:65], s[64:65], s[92:93]
  s_and_b64 s[64:65], s[64:65], s[94:95]
  s_and_b32 s64, s64, s65
  s_cbranch_scc0 Lini_72
  s_mov_b32 s46, 0xffff
  s_and_b32 s40, s21, 3
  s_lshl_b32 s40, s40, 13
  s_lshr_b32 s43, s21, 2
  s_lshl_b32 s43, s43, 10
  s_add_u32 s43, s43, s40
  s_add_u32 s43, s43, 1344000
  s_waitcnt lgkmcnt(0)
  s_memtime s[64:65]
  s_waitcnt lgkmcnt(0)
  s_load_dword s68, s[4:5], s43 glc
  s_waitcnt lgkmcnt(0)
  s_memtime s[66:67]
  s_waitcnt lgkmcnt(0)
  s_sub_u32 s64, s66, s64
  s_min_u32 s46, s46, s64
  s_getreg_b32 s55, hwreg(HW_REG_XCC_ID)
  s_and_b32 s55, s55, 15
  s_lshl_b32 s46, s46, 8
  s_or_b32 s46, s46, s55
  s_add_u32 s40, s21, 32
  s_lshl_b32 s40, s40, 7
  s_add_u32 s40, s40, 1424384
  s_mov_b32 s63, s46
  s_atomic_smax s63, s[4:5], s40 glc
Lnosig_73:
Lchore_71:
  s_waitcnt vmcnt(16) lgkmcnt(0)
  s_barrier
  s_add_u32 m0, s41, 24576
  s_add_u32 s42, s53, 6291456
  buffer_load_dwordx4 v10, s[8:11], s42 offen lds
  s_add_u32 m0, s41, 25600
  s_add_u32 s42, s53, 6356992
  buffer_load_dwordx4 v10, s[8:11], s42 offen lds
  s_add_u32 m0, s41, 26624
  s_add_u32 s42, s53, 6299648
  buffer_load_dwordx4 v10, s[8:11], s42 offen lds
  s_add_u32 m0, s41, 27648
  s_add_u32 s42, s53, 6365184
  buffer_load_dwordx4 v10, s[8:11], s42 offen lds
  s_add_u32 m0, s41, 28672
  s_add_u32 s42, s53, 6553600
  buffer_load_dwordx4 v10, s[8:11], s42 offen lds
  s_add_u32 m0, s41, 29696
  s_add_u32 s42, s53, 6619136
  buffer_load_dwordx4 v10, s[8:11], s42 offen lds
  s_add_u32 m0, s41, 30720
  s_add_u32 s42, s53, 6561792
  buffer_load_dwordx4 v10, s[8:11], s42 offen lds
  s_add_u32 m0, s41, 31744
  s_add_u32 s42, s53, 6627328
  buffer_load_dwordx4 v10, s[8:11], s42 offen lds
  ds_read_b64_tr_b16 v[20:21], v4 offset:0
  ds_read_b64_tr_b16 v[22:23], v4 offset:2048
  ds_read_b64_tr_b16 v[24:25], v4 offset:4096
  ds_read_b64_tr_b16 v[26:27], v4 offset:6144
  ds_read_b64_tr_b16 v[28:29], v5 offset:0
  ds_read_b64_tr_b16 v[30:31], v5 offset:2048
  ds_read_b64_tr_b16 v[32:33], v5 offset:4096
  ds_read_b64_tr_b16 v[34:35], v5 offset:6144
  ds_read_b64_tr_b16 v[36:37], v6 offset:0
  ds_read_b64_tr_b16 v[38:39], v6 offset:2048
  ds_read_b64_tr_b16 v[40:41], v6 offset:4096
  ds_read_b64_tr_b16 v[42:43], v6 offset:6144
  ds_read_b64_tr_b16 v[44:45], v7 offset:0
  ds_read_b64_tr_b16 v[46:47], v7 offset:2048
  ds_read_b64_tr_b16 v[48:49], v7 offset:4096
  ds_read_b64_tr_b16 v[50:51], v7 offset:6144
  s_waitcnt lgkmcnt(0)
  s_barrier
  ds_write_b128 v85, v[20:23] offset:0
  ds_write_b128 v85, v[24:27] offset:1024
  ds_write_b128 v85, v[28:31] offset:2048
  ds_write_b128 v85, v[32:35] offset:3072
  ds_write_b128 v85, v[36:39] offset:4096
  ds_write_b128 v85, v[40:43] offset:5120
  ds_write_b128 v85, v[44:47] offset:6144
  ds_write_b128 v85, v[48:51] offset:7168
  s_waitcnt vmcnt(16) lgkmcnt(0)
  s_barrier
  ds_read_b64_tr_b16 v[20:21], v4 offset:8192
  ds_read_b64_tr_b16 v[22:23], v4 offset:10240
  ds_read_b64_tr_b16 v[24:25], v4 offset:12288
  ds_read_b64_tr_b16 v[26:27], v4 offset:14336
  ds_read_b64_tr_b16 v[28:29], v5 offset:8192
  ds_read_b64_tr_b16 v[30:31], v5 offset:10240
  ds_read_b64_tr_b16 v[32:33], v5 offset:12288
  ds_read_b64_tr_b16 v[34:35], v5 offset:14336
  ds_read_b64_tr_b16 v[36:37], v6 offset:8192
  ds_read_b64_tr_b16 v[38:39], v6 offset:10240
  ds_read_b64_tr_b16 v[40:41], v6 offset:12288
  ds_read_b64_tr_b16 v[42:43], v6 offset:14336
  ds_read_b64_tr_b16 v[44:45], v7 offset:8192
  ds_read_b64_tr_b16 v[46:47], v7 offset:10240
  ds_read_b64_tr_b16 v[48:49], v7 offset:12288
  ds_read_b64_tr_b16 v[50:51], v7 offset:14336
  s_waitcnt lgkmcnt(0)
  s_barrier
  ds_write_b128 v85, v[20:23] offset:8192
  ds_write_b128 v85, v[24:27] offset:9216
  ds_write_b128 v85, v[28:31] offset:10240
  ds_write_b128 v85, v[32:35] offset:11264
  ds_write_b128 v85, v[36:39] offset:12288
  ds_write_b128 v85, v[40:43] offset:13312
  ds_write_b128 v85, v[44:47] offset:14336
  ds_write_b128 v85, v[48:51] offset:15360
  s_waitcnt vmcnt(8) lgkmcnt(0)
  s_barrier
  ds_read_b64_tr_b16 v[20:21], v4 offset:16384
  ds_read_b64_tr_b16 v[22:23], v4 offset:18432
  ds_read_b64_tr_b16 v[24:25], v4 offset:20480
  ds_read_b64_tr_b16 v[26:27], v4 offset:22528
  ds_read_b64_tr_b16 v[28:29], v5 offset:16384
  ds_read_b64_tr_b16 v[30:31], v5 offset:18432
  ds_read_b64_tr_b16 v[32:33], v5 offset:20480
  ds_read_b64_tr_b16 v[34:35], v5 offset:22528
  ds_read_b64_tr_b16 v[36:37], v6 offset:16384
  ds_read_b64_tr_b16 v[38:39], v6 offset:18432
  ds_read_b64_tr_b16 v[40:41], v6 offset:20480
  ds_read_b64_tr_b16 v[42:43], v6 offset:22528
  ds_read_b64_tr_b16 v[44:45], v7 offset:16384
  ds_read_b64_tr_b16 v[46:47], v7 offset:18432
  ds_read_b64_tr_b16 v[48:49], v7 offset:20480
  ds_read_b64_tr_b16 v[50:51], v7 offset:22528
  s_waitcnt lgkmcnt(0)
  s_barrier
  ds_write_b128 v85, v[20:23] offset:16384
  ds_write_b128 v85, v[24:27] offset:17408
  ds_write_b128 v85, v[28:31] offset:18432
  ds_write_b128 v85, v[32:35] offset:19456
  ds_write_b128 v85, v[36:39] offset:20480
  ds_write_b128 v85, v[40:43] offset:21504
  ds_write_b128 v85, v[44:47] offset:22528
  ds_write_b128 v85, v[48:51] offset:23552
  s_waitcnt vmcnt(0) lgkmcnt(0)
  s_barrier
  ds_read_b64_tr_b16 v[20:21], v4 offset:24576
  ds_read_b64_tr_b16 v[22:23], v4 offset:26624
  ds_read_b64_tr_b16 v[24:25], v4 offset:28672
  ds_read_b64_tr_b16 v[26:27], v4 offset:30720
  ds_read_b64_tr_b16 v[28:29], v5 offset:24576
  ds_read_b64_tr_b16 v[30:31], v5 offset:26624
  ds_read_b64_tr_b16 v[32:33], v5 offset:28672
  ds_read_b64_tr_b16 v[34:35], v5 offset:30720
  ds_read_b64_tr_b16 v[36:37], v6 offset:24576
  ds_read_b64_tr_b16 v[38:39], v6 offset:26624
  ds_read_b64_tr_b16 v[40:41], v6 offset:28672
  ds_read_b64_tr_b16 v[42:43], v6 offset:30720
  ds_read_b64_tr_b16 v[44:45], v7 offset:24576
  ds_read_b64_tr_b16 v[46:47], v7 offset:26624
  ds_read_b64_tr_b16 v[48:49], v7 offset:28672
  ds_read_b64_tr_b16 v[50:51], v7 offset:30720
  s_waitcnt lgkmcnt(0)
  s_barrier
  ds_write_b128 v85, v[20:23] offset:24576
  ds_write_b128 v85, v[24:27] offset:25600
  ds_write_b128 v85, v[28:31] offset:26624
  ds_write_b128 v85, v[32:35] offset:27648
  ds_write_b128 v85, v[36:39] offset:28672
  ds_write_b128 v85, v[40:43] offset:29696
  ds_write_b128 v85, v[44:47] offset:30720
  ds_write_b128 v85, v[48:51] offset:31744
  s_waitcnt lgkmcnt(0)
  s_lshr_b32 s40, s21, 1
  s_lshl_b32 s40, s40, 2
  v_min_u32 v76, 3, v0
  v_add_u32 v76, s40, v76
  v_lshlrev_b32 v76, 7, v76
  v_add_u32 v76, 1432576, v76
  s_nop 1
Lpoll_74:
  buffer_load_dword v77, v76, s[4:7], 0 offen sc1
  s_sub_u32 s24, s24, 1
  s_cbranch_scc1 L_FAIL
  s_waitcnt vmcnt(0)
  v_cmp_gt_i32 vcc, 1, v77
  s_cbranch_vccz Lpolld_75
  s_sleep 1
  s_branch Lpoll_74
Lpolld_75:
  s_lshl_b32 s40, s21, 18
  s_lshl_b32 s41, s20, 15
  s_add_u32 s40, s40, s41
  v_lshl_add_u32 v76, v0, 4, s40
  s_add_u32 s50, s21, s20
  s_and_b32 s50, s50, 3
  s_lshl_b32 s41, s54, 5
  s_add_u32 s41, s41, s50
  s_lshl_b32 s41, s41, 12
  s_xor_b32 s40, s41, 0
  s_add_u32 s40, s40, 10485760
  buffer_load_dwordx4 a[0:3], v76, s[4:7], s40 offen offset:0 sc1
  buffer_load_dwordx4 a[4:7], v76, s[4:7], s40 offen offset:1024 sc1
  buffer_load_dwordx4 a[8:11], v76, s[4:7], s40 offen offset:2048 sc1
  buffer_load_dwordx4 a[12:15], v76, s[4:7], s40 offen offset:3072 sc1
  s_xor_b32 s40, s41, 4096
  s_add_u32 s40, s40, 10485760
  buffer_load_dwordx4 a[16:19], v76, s[4:7], s40 offen offset:0 sc1
  buffer_load_dwordx4 a[20:23], v76, s[4:7], s40 offen offset:1024 sc1
  buffer_load_dwordx4 a[24:27], v76, s[4:7], s40 offen offset:2048 sc1
  buffer_load_dwordx4 a[28:31], v76, s[4:7], s40 offen offset:3072 sc1
  s_xor_b32 s40, s41, 8192
  s_add_u32 s40, s40, 10485760
  buffer_load_dwordx4 a[32:35], v76, s[4:7], s40 offen offset:0 sc1
  buffer_load_dwordx4 a[36:39], v76, s[4:7], s40 offen offset:1024 sc1
  buffer_load_dwordx4 a[40:43], v76, s[4:7], s40 offen offset:2048 sc1
  buffer_load_dwordx4 a[44:47], v76, s[4:7], s40 offen offset:3072 sc1
  s_xor_b32 s40, s41, 12288
  s_add_u32 s40, s40, 10485760
  buffer_load_dwordx4 a[48:51], v76, s[4:7], s40 offen offset:0 sc1
  buffer_load_dwordx4 a[52:55], v76, s[4:7], s40 offen offset:1024 sc1
  buffer_load_dwordx4 a[56:59], v76, s[4:7], s40 offen offset:2048 sc1
  buffer_load_dwordx4 a[60:63], v76, s[4:7], s40 offen offset:3072 sc1
  s_xor_b32 s40, s41, 16384
  s_add_u32 s40, s40, 10485760
  buffer_load_dwordx4 a[64:67], v76, s[4:7], s40 offen offset:0 sc1
  buffer_load_dwordx4 a[68:71], v76, s[4:7], s40 offen offset:1024 sc1
  buffer_load_dwordx4 a[72:75], v76, s[4:7], s40 offen offset:2048 sc1
  buffer_load_dwordx4 a[76:79], v76, s[4:7], s40 offen offset:3072 sc1
  s_xor_b32 s40, s41, 20480
  s_add_u32 s40, s40, 10485760
  buffer_load_dwordx4 a[80:83], v76, s[4:7], s40 offen offset:0 sc1
  buffer_load_dwordx4 a[84:87], v76, s[4:7], s40 offen offset:1024 sc1
  buffer_load_dwordx4 a[88:91], v76, s[4:7], s40 offen offset:2048 sc1
  buffer_load_dwordx4 a[92:95], v76, s[4:7], s40 offen offset:3072 sc1
  s_xor_b32 s40, s41, 24576
  s_add_u32 s40, s40, 10485760
  buffer_load_dwordx4 a[96:99], v76, s[4:7], s40 offen offset:0 sc1
  buffer_load_dwordx4 a[100:103], v76, s[4:7], s40 offen offset:1024 sc1
  buffer_load_dwordx4 a[104:107], v76, s[4:7], s40 offen offset:2048 sc1
  buffer_load_dwordx4 a[108:111], v76, s[4:7], s40 offen offset:3072 sc1
  s_xor_b32 s40, s41, 28672
  s_add_u32 s40, s40, 10485760
  buffer_load_dwordx4 a[112:115], v76, s[4:7], s40 offen offset:0 sc1
  buffer_load_dwordx4 a[116:119], v76, s[4:7], s40 offen offset:1024 sc1
  buffer_load_dwordx4 a[120:123], v76, s[4:7], s40 offen offset:2048 sc1
  buffer_load_dwordx4 a[124:127], v76, s[4:7], s40 offen offset:3072 sc1
  s_xor_b32 s40, s41, 131072
  s_add_u32 s40, s40, 10485760
  buffer_load_dwordx4 a[128:131], v76, s[4:7], s40 offen offset:0 sc1
  buffer_load_dwordx4 a[132:135], v76, s[4:7], s40 offen offset:1024 sc1
  buffer_load_dwordx4 a[136:139], v76, s[4:7], s40 offen offset:2048 sc1
  buffer_load_dwordx4 a[140:143], v76, s[4:7], s40 offen offset:3072 sc1
  s_waitcnt vmcnt(32)
  s_xor_b32 s40, s41, 135168
  s_add_u32 s40, s40, 10485760
  buffer_load_dwordx4 a[144:147], v76, s[4:7], s40 offen offset:0 sc1
  buffer_load_dwordx4 a[148:151], v76, s[4:7], s40 offen offset:1024 sc1
  buffer_load_dwordx4 a[152:155], v76, s[4:7], s40 offen offset:2048 sc1
  buffer_load_dwordx4 a[156:159], v76, s[4:7], s40 offen offset:3072 sc1
  s_waitcnt vmcnt(32)
  s_xor_b32 s40, s41, 139264
  s_add_u32 s40, s40, 10485760
  buffer_load_dwordx4 a[160:163], v76, s[4:7], s40 offen offset:0 sc1
  buffer_load_dwordx4 a[164:167], v76, s[4:7], s40 offen offset:1024 sc1
  buffer_load_dwordx4 a[168:171], v76, s[4:7], s40 offen offset:2048 sc1
  buffer_load_dwordx4 a[172:175], v76, s[4:7], s40 offen offset:3072 sc1
  s_waitcnt vmcnt(32)
  s_xor_b32 s40, s41, 143360
  s_add_u32 s40, s40, 10485760
  buffer_load_dwordx4 a[176:179], v76, s[4:7], s40 offen offset:0 sc1
  buffer_load_dwordx4 a[180:183], v76, s[4:7], s40 offen offset:1024 sc1
  buffer_load_dwordx4 a[184:187], v76, s[4:7], s40 offen offset:2048 sc1
  buffer_load_dwordx4 a[188:191], v76, s[4:7], s40 offen offset:3072 sc1
  s_waitcnt vmcnt(32)
  s_xor_b32 s40, s41, 147456
  s_add_u32 s40, s40, 10485760
  buffer_load_dwordx4 a[192:195], v76, s[4:7], s40 offen offset:0 sc1
  buffer_load_dwordx4 a[196:199], v76, s[4:7], s40 offen offset:1024 sc1
  buffer_load_dwordx4 a[200:203], v76, s[4:7], s40 offen offset:2048 sc1
  buffer_load_dwordx4 a[204:207], v76, s[4:7], s40 offen offset:3072 sc1
  s_waitcnt vmcnt(32)
  s_xor_b32 s40, s41, 151552
  s_add_u32 s40, s40, 10485760
  buffer_load_dwordx4 a[208:211], v76, s[4:7], s40 offen offset:0 sc1
  buffer_load_dwordx4 a[212:215], v76, s[4:7], s40 offen offset:1024 sc1
  buffer_load_dwordx4 a[216:219], v76, s[4:7], s40 offen offset:2048 sc1
  buffer_load_dwordx4 a[220:223], v76, s[4:7], s40 offen offset:3072 sc1
  s_waitcnt vmcnt(32)
  s_xor_b32 s40, s41, 155648
  s_add_u32 s40, s40, 10485760
  buffer_load_dwordx4 a[224:227], v76, s[4:7], s40 offen offset:0 sc1
  buffer_load_dwordx4 a[228:231], v76, s[4:7], s40 offen offset:1024 sc1
  buffer_load_dwordx4 a[232:235], v76, s[4:7], s40 offen offset:2048 sc1
  buffer_load_dwordx4 a[236:239], v76, s[4:7], s40 offen offset:3072 sc1
  s_waitcnt vmcnt(32)
  s_xor_b32 s40, s41, 159744
  s_add_u32 s40, s40, 10485760
  buffer_load_dwordx4 a[240:243], v76, s[4:7], s40 offen offset:0 sc1
  buffer_load_dwordx4 a[244:247], v76, s[4:7], s40 offen offset:1024 sc1
  buffer_load_dwordx4 a[248:251], v76, s[4:7], s40 offen offset:2048 sc1
  buffer_load_dwordx4 a[252:255], v76, s[4:7], s40 offen offset:3072 sc1
  s_waitcnt vmcnt(32)
  s_cmp_lg_u32 s20, 2
  s_cbranch_scc1 Lnotlb_76
  v_lshlrev_b32 v77, 21, v0
  s_mov_b32 s40, 0x1fff80
  buffer_load_dword v78, v77, s[4:7], s40 offen sc1
  s_add_u32 s40, s40, 134217728
  buffer_load_dword v78, v77, s[4:7], s40 offen sc1
  s_waitcnt vmcnt(0)
Lnotlb_76:
  s_getreg_b32 s55, hwreg(HW_REG_XCC_ID)
  s_and_b32 s55, s55, 15
  v_min_u32 v76, 63, v0
  v_lshlrev_b32 v76, 7, v76
  v_add_u32 v76, 1424384, v76
  s_nop 1
Lpoll_77:
  buffer_load_dword v77, v76, s[4:7], 0 offen sc1
  s_sub_u32 s24, s24, 1
  s_cbranch_scc1 L_FAIL
  s_waitcnt vmcnt(0)
  v_cmp_gt_i32 vcc, 0, v77
  s_cbranch_vccz Lpolld_78
  s_sleep 1
  s_branch Lpoll_77
Lpolld_78:
  v_and_b32 v78, 15, v77
  v_cmp_ne_u32 vcc, s55, v78
  s_lshl_b32 s40, s54, 4
  s_lshl_b32 s40, 0xffff, s40
  s_or_b32 s41, vcc_lo, vcc_hi
  s_and_b32 s40, s40, s41
  s_cselect_b32 s36, 0, 8192
  v_lshrrev_b32 v77, 8, v77
  v_and_b32 v78, 3, v0
  v_lshl_or_b32 v77, v77, 2, v78
  s_nop 1
  v_min_u32_dpp v77, v77, v77 row_ror:8 row_mask:0xf bank_mask:0xf
  s_nop 1
  v_min_u32_dpp v77, v77, v77 row_ror:4 row_mask:0xf bank_mask:0xf
  v_mov_b32 v78, v77
  s_nop 1
  v_permlane16_swap_b32 v78, v77
  v_min_u32 v77, v77, v78
  v_mov_b32 v78, v77
  s_nop 1
  v_permlane32_swap_b32 v78, v77
  v_min_u32 v77, v77, v78
  s_nop 1
  v_min_u32_dpp v77, v77, v77 row_ror:2 row_mask:0xf bank_mask:0xf
  s_nop 1
  v_min_u32_dpp v77, v77, v77 row_ror:1 row_mask:0xf bank_mask:0xf
  s_nop 0
  v_readfirstlane_b32 s26, v77
  s_and_b32 s26, s26, 3
  s_lshl_b32 s26, s26, 13
  s_lshr_b32 s40, s20, 1
  s_mul_i32 s40, s40, 32768
  s_and_b32 s41, s20, 1
  s_lshl_b32 s41, s41, 10
  s_add_u32 s40, s40, s41
  s_lshl_b32 s41, s54, 12
  s_add_u32 s40, s40, s41
  v_lshl_add_u32 v86, v0, 4, s40
  v_xor_b32 v87, 0x1000, v86
  v_and_b32 v76, 2, v0
  v_cmp_eq_u32 vcc, 0, v76
  v_mov_b32 v76, 0xeeee
  v_mov_b32 v77, 0x4444
  v_cndmask_b32 v88, v76, v77, vcc
  s_lshr_b32 s40, s21, 2
  s_mul_i32 s40, s40, 32768
  s_and_b32 s41, s21, 3
  s_lshl_b32 s41, s41, 11
  s_add_u32 s47, s40, s41
  s_lshl_b32 s41, s20, 9
  s_add_u32 s47, s47, s41
  v_lshl_add_u32 v92, v0, 3, s47
  s_lshl_b32 s41, s54, 12
  s_add_u32 s40, s41, 1310720
  s_add_u32 s40, s40, s26
  v_lshrrev_b32 v76, 2, v0
  v_lshl_add_u32 v76, v76, 7, s40
  v_and_b32 v77, 3, v0
  v_lshl_add_u32 v90, v77, 2, v76
  s_mov_b32 s57, s40
  s_cmp_eq_u32 s36, 0
  s_cselect_b32 s56, 1, s20
  s_and_b32 s41, s21, 15
  s_lshl_b32 s41, s41, 7
  s_lshl_b32 s40, s20, 2
  s_add_u32 s40, s40, s41
  s_add_u32 s40, s40, 0
  s_mov_b32 s25, 0
  s_mov_b32 s60, 0
  s_mov_b32 s61, 0
  s_mov_b32 s51, -1
  v_mov_b32 v91, 2147483392
  s_mov_b64 exec, 1
  v_mov_b32 v91, s40
  s_mov_b64 exec, -1
  v_mov_b32 v80, -1
  v_mov_b32 v81, -1
  v_mov_b32 v82, -1
  v_mov_b32 v83, -1
  s_mul_i32 s40, s20, 32768
  s_and_b32 s41, s50, 3
  s_lshl_b32 s41, s41, 10
  s_add_u32 s40, s40, s41
  v_lshl_add_u32 v110, v0, 4, s40
  v_xor_b32 v111, 0x400, v110
  v_xor_b32 v112, 0x800, v110
  v_xor_b32 v113, 0xc00, v110
  s_mul_i32 s58, s54, 131072
  s_and_b32 s41, s50, 4
  s_lshl_b32 s41, s41, 10
  s_add_u32 s58, s58, s41
  s_bfe_u32 s40, s21, 0x20002
  s_lshl_b32 s40, s40, 7
  s_and_b32 s41, s21, 3
  s_lshl_b32 s41, s41, 4
  s_add_u32 s40, s40, s41
  s_lshl_b32 s41, s20, 2
  s_add_u32 s41, s41, s40
  s_cmp_eq_u32 s20, 0
  s_cselect_b32 s40, s40, s41
  s_mov_b64 exec, 1
  v_mov_b32 v91, s40
  s_mov_b64 exec, -1
  s_mul_i32 s40, s20, 512
  v_add_u32 v90, s40, v90
  s_lshl_b32 s40, s20, 10
  s_add_u32 s40, s40, 147456
  v_lshl_add_u32 v95, v0, 4, s40
  s_and_b32 s40, s20, 1
  s_lshl_b32 s40, s40, 3
  v_bfe_u32 v4, v0, 2, 3
  v_add_u32 v4, s40, v4
  s_lshr_b32 s40, s20, 1
  s_lshl_b32 s40, s40, 3
  v_and_b32 v5, 3, v0
  v_add_u32 v5, s40, v5
  v_bfe_u32 v76, v4, 1, 1
  v_lshl_add_u32 v5, v76, 2, v5
  v_lshrrev_b32 v76, 2, v4
  v_and_b32 v77, 1, v4
  v_lshl_add_u32 v78, v76, 4, v5
  v_lshlrev_b32 v78, 4, v78
  v_lshl_add_u32 v78, v77, 3, v78
  v_add_u32 v108, 147456, v78
  s_bfe_u32 s41, s21, 0x10002
  s_mul_i32 s41, s41, 32768
  s_lshr_b32 s40, s21, 3
  s_lshl_b32 s40, s40, 11
  s_add_u32 s40, s40, s41
  s_and_b32 s41, s21, 3
  s_lshl_b32 s41, s41, 9
  s_add_u32 s40, s40, s41
  s_lshl_b32 s41, s20, 7
  s_add_u32 s40, s40, s41
  v_lshl_add_u32 v109, v0, 2, s40
  s_mov_b32 exec_lo, 0
  v_mov_b32 v109, 2147483392
  s_mov_b64 exec, -1
  ds_read_b128 v[116:119], v85 offset:20480
  ds_read_b128 v[120:123], v85 offset:21504
  s_mov_b32 s59, 2147483392
  s_mov_b32 s25, 0
  s_add_u32 s27, s25, 32
  s_and_b32 s40, s27, 0x28
  s_mul_i32 s40, s40, 0x900
  s_and_b32 s40, s40, 0x6000
  s_xor_b32 s40, s40, s26
  s_lshl_b32 s27, s27, 16
  s_add_u32 s27, s27, s40
  s_lshl_b32 s37, s36, 1
  s_xor_b32 s37, s27, s37
  s_and_b32 s40, s25, 3
  s_lshl_b32 s40, s40, 18
  s_add_u32 s28, s40, s26
  s_lshr_b32 s40, s40, 5
  s_and_b32 s40, s40, 0x4000
  s_xor_b32 s28, s28, s40
  s_xor_b32 s29, s28, 0x4000
  s_xor_b32 s40, s29, 0
  buffer_load_dword v89, v92, s[4:7], s40 offen sc1
  s_xor_b32 s40, s27, 16384
  buffer_load_dword v89, v109, s[4:7], s40 offen sc1
  s_mov_b32 s25, 1
  s_add_u32 s27, s25, 32
  s_and_b32 s40, s27, 0x28
  s_mul_i32 s40, s40, 0x900
  s_and_b32 s40, s40, 0x6000
  s_xor_b32 s40, s40, s26
  s_lshl_b32 s27, s27, 16
  s_add_u32 s27, s27, s40
  s_lshl_b32 s37, s36, 1
  s_xor_b32 s37, s27, s37
  s_and_b32 s40, s25, 3
  s_lshl_b32 s40, s40, 18
  s_add_u32 s28, s40, s26
  s_lshr_b32 s40, s40, 5
  s_and_b32 s40, s40, 0x4000
  s_xor_b32 s28, s28, s40
  s_xor_b32 s29, s28, 0x4000
  s_xor_b32 s40, s29, 0
  buffer_load_dword v89, v92, s[4:7], s40 offen sc1
  s_xor_b32 s40, s27, 16384
  buffer_load_dword v89, v109, s[4:7], s40 offen sc1
  s_mov_b32 s25, 2
  s_add_u32 s27, s25, 32
  s_and_b32 s40, s27, 0x28
  s_mul_i32 s40, s40, 0x900
  s_and_b32 s40, s40, 0x6000
  s_xor_b32 s40, s40, s26
  s_lshl_b32 s27, s27, 16
  s_add_u32 s27, s27, s40
  s_lshl_b32 s37, s36, 1
  s_xor_b32 s37, s27, s37
  s_and_b32 s40, s25, 3
  s_lshl_b32 s40, s40, 18
  s_add_u32 s28, s40, s26
  s_lshr_b32 s40, s40, 5
  s_and_b32 s40, s40, 0x4000
  s_xor_b32 s28, s28, s40
  s_xor_b32 s29, s28, 0x4000
  s_xor_b32 s40, s29, 0
  buffer_load_dword v89, v92, s[4:7], s40 offen sc1
  s_xor_b32 s40, s27, 16384
  buffer_load_dword v89, v109, s[4:7], s40 offen sc1
  s_mov_b32 s25, 3
  s_add_u32 s27, s25, 32
  s_and_b32 s40, s27, 0x28
  s_mul_i32 s40, s40, 0x900
  s_and_b32 s40, s40, 0x6000
  s_xor_b32 s40, s40, s26
  s_lshl_b32 s27, s27, 16
  s_add_u32 s27, s27, s40
  s_lshl_b32 s37, s36, 1
  s_xor_b32 s37, s27, s37
  s_and_b32 s40, s25, 3
  s_lshl_b32 s40, s40, 18
  s_add_u32 s28, s40, s26
  s_lshr_b32 s40, s40, 5
  s_and_b32 s40, s40, 0x4000
  s_xor_b32 s28, s28, s40
  s_xor_b32 s29, s28, 0x4000
  s_xor_b32 s40, s29, 0
  buffer_load_dword v89, v92, s[4:7], s40 offen sc1
  s_xor_b32 s40, s27, 16384
  buffer_load_dword v89, v109, s[4:7], s40 offen sc1
  buffer_load_dword v89, v90, s[4:7], 0 offen offset:2048 sc1
  s_mov_b32 s25, 0
  v_mov_b64 v[52:53], 0
  v_mov_b64 v[54:55], 0
  v_mov_b64 v[56:57], 0
  v_mov_b64 v[58:59], 0
  ds_read_b128 v[20:23], v85 offset:0
  ds_read_b128 v[24:27], v85 offset:1024
  ds_read_b128 v[28:31], v85 offset:8192
  ds_read_b128 v[32:35], v85 offset:9216
  ds_read_b128 v[36:39], v85 offset:2048
  ds_read_b128 v[40:43], v85 offset:3072
  ds_read_b128 v[44:47], v85 offset:10240
  ds_read_b128 v[48:51], v85 offset:11264
L_VO_top:
  s_add_u32 s27, s25, 32
  s_and_b32 s40, s27, 0x28
  s_mul_i32 s40, s40, 0x900
  s_and_b32 s40, s40, 0x6000
  s_xor_b32 s40, s40, s26
  s_lshl_b32 s27, s27, 16
  s_add_u32 s27, s27, s40
  s_lshl_b32 s37, s36, 1
  s_xor_b32 s37, s27, s37
  s_and_b32 s40, s25, 3
  s_lshl_b32 s40, s40, 18
  s_add_u32 s28, s40, s26
  s_lshr_b32 s40, s40, 5
  s_and_b32 s40, s40, 0x4000
  s_xor_b32 s28, s28, s40
  s_xor_b32 s29, s28, 0x4000
  s_sleep 5
L_VO_retry:
  buffer_load_dwordx4 v[4:7], v86, s[4:7], s37 offen offset:0 sc1
  s_nop 0
  buffer_load_dwordx4 v[8:11], v86, s[4:7], s37 offen offset:2048 sc1
  s_nop 0
  s_waitcnt vmcnt(1) lgkmcnt(0)
  buffer_load_dwordx4 v[68:71], v87, s[4:7], s27 offen offset:0 sc1
  buffer_load_dwordx4 v[72:75], v87, s[4:7], s27 offen offset:2048 sc1
  v_smfmac_f32_16x16x64_bf16 v[52:55], v[4:7], v[128:135], v88
  ds_write_b128 v1, v[4:7] offset:0
  v_max3_u32 v89, v4, v5, v6
  v_smfmac_f32_16x16x64_bf16 v[56:59], v[4:7], v[20:27], v88
  v_max3_u32 v89, v6, v7, v89
  s_waitcnt vmcnt(2)
  ds_write_b128 v1, v[8:11] offset:1024
  v_max3_u32 v89, v8, v9, v89
  v_max3_u32 v89, v10, v11, v89
  v_cmp_eq_u32_e64 vcc, -1, v89
  s_cbranch_vccnz L_VO_bad
  s_waitcnt lgkmcnt(0)
  s_barrier
  ds_read_b128 v[12:15], v2 offset:0
  ds_read_b128 v[16:19], v2 offset:1024
  v_smfmac_f32_16x16x64_bf16 v[52:55], v[8:11], v[136:143], v88
  ds_read_b128 v[4:7], v3 offset:0
  ds_read_b128 v[20:23], v85 offset:4096
  v_smfmac_f32_16x16x64_bf16 v[56:59], v[8:11], v[28:35], v88
  ds_read_b128 v[24:27], v85 offset:5120
  s_waitcnt lgkmcnt(4)
  v_smfmac_f32_16x16x64_bf16 v[52:55], v[12:15], v[144:151], v88
  ds_read_b128 v[8:11], v3 offset:1024
  ds_read_b128 v[28:31], v85 offset:12288
  v_smfmac_f32_16x16x64_bf16 v[56:59], v[12:15], v[36:43], v88
  ds_read_b128 v[32:35], v85 offset:13312
  s_waitcnt lgkmcnt(6)
  v_smfmac_f32_16x16x64_bf16 v[52:55], v[16:19], v[152:159], v88
  ds_read_b128 v[12:15], v84 offset:0
  ds_read_b128 v[36:39], v85 offset:6144
  v_smfmac_f32_16x16x64_bf16 v[56:59], v[16:19], v[44:51], v88
  ds_read_b128 v[40:43], v85 offset:7168
  s_waitcnt lgkmcnt(6)
  v_smfmac_f32_16x16x64_bf16 v[52:55], v[4:7], v[160:167], v88
  ds_read_b128 v[16:19], v84 offset:1024
  ds_read_b128 v[44:47], v85 offset:14336
  v_smfmac_f32_16x16x64_bf16 v[56:59], v[4:7], v[20:27], v88
  ds_read_b128 v[48:51], v85 offset:15360
  s_waitcnt lgkmcnt(6)
  v_smfmac_f32_16x16x64_bf16 v[52:55], v[8:11], v[168:175], v88
  ds_read_b128 v[20:23], v85 offset:16384
  v_smfmac_f32_16x16x64_bf16 v[56:59], v[8:11], v[28:35], v88
  ds_read_b128 v[24:27], v85 offset:17408
  s_waitcnt lgkmcnt(5)
  v_smfmac_f32_16x16x64_bf16 v[52:55], v[12:15], v[176:183], v88
  ds_read_b128 v[28:31], v85 offset:24576
  v_smfmac_f32_16x16x64_bf16 v[56:59], v[12:15], v[36:43], v88
  ds_read_b128 v[32:35], v85 offset:25600
  s_waitcnt lgkmcnt(4)
  s_waitcnt vmcnt(0)
  ds_write_b128 v1, v[68:71] offset:2048
  v_smfmac_f32_16x16x64_bf16 v[52:55], v[16:19], v[184:191], v88
  ds_write_b128 v1, v[72:75] offset:3072
  v_max3_u32 v89, v68, v69, v70
  v_max3_u32 v89, v70, v71, v89
  v_max3_u32 v89, v72, v73, v89
  v_smfmac_f32_16x16x64_bf16 v[56:59], v[16:19], v[44:51], v88
  v_max3_u32 v89, v74, v75, v89
  v_cmp_eq_u32 vcc, -1, v89
  ds_read_b128 v[36:39], v85 offset:18432
  ds_read_b128 v[40:43], v85 offset:19456
  s_cbranch_vccnz L_VO_rbad
L_VO_rok:
  s_waitcnt lgkmcnt(6)
  s_waitcnt lgkmcnt(2)
  s_barrier
  v_smfmac_f32_16x16x64_bf16 v[52:55], v[68:71], v[192:199], v88
  ds_read_b128 v[12:15], v2 offset:2048
  ds_read_b128 v[16:19], v2 offset:3072
  v_smfmac_f32_16x16x64_bf16 v[56:59], v[68:71], v[20:27], v88
  ds_read_b128 v[44:47], v85 offset:26624
  ds_read_b128 v[48:51], v85 offset:27648
  v_smfmac_f32_16x16x64_bf16 v[52:55], v[72:75], v[200:207], v88
  ds_read_b128 v[4:7], v3 offset:2048
  v_smfmac_f32_16x16x64_bf16 v[56:59], v[72:75], v[28:35], v88
  s_waitcnt lgkmcnt(4)
  v_smfmac_f32_16x16x64_bf16 v[52:55], v[12:15], v[208:215], v88
  ds_read_b128 v[8:11], v3 offset:3072
  ds_read_b128 v[28:31], v85 offset:28672
  v_smfmac_f32_16x16x64_bf16 v[56:59], v[12:15], v[36:43], v88
  ds_read_b128 v[32:35], v85 offset:29696
  s_waitcnt lgkmcnt(4)
  v_smfmac_f32_16x16x64_bf16 v[52:55], v[16:19], v[216:223], v88
  ds_read_b128 v[12:15], v84 offset:2048
  ds_read_b128 v[36:39], v85 offset:22528
  v_smfmac_f32_16x16x64_bf16 v[56:59], v[16:19], v[44:51], v88
  ds_read_b128 v[40:43], v85 offset:23552
  s_waitcnt lgkmcnt(6)
  v_smfmac_f32_16x16x64_bf16 v[52:55], v[4:7], v[224:231], v88
  ds_read_b128 v[16:19], v84 offset:3072
  ds_read_b128 v[44:47], v85 offset:30720
  v_smfmac_f32_16x16x64_bf16 v[56:59], v[4:7], v[116:123], v88
  ds_read_b128 v[48:51], v85 offset:31744
  s_waitcnt lgkmcnt(6)
  v_smfmac_f32_16x16x64_bf16 v[52:55], v[8:11], v[232:239], v88
  v_smfmac_f32_16x16x64_bf16 v[56:59], v[8:11], v[28:35], v88
  s_waitcnt lgkmcnt(3)
  v_smfmac_f32_16x16x64_bf16 v[52:55], v[12:15], v[240:247], v88
  v_smfmac_f32_16x16x64_bf16 v[56:59], v[12:15], v[36:43], v88
  s_waitcnt lgkmcnt(0)
  v_smfmac_f32_16x16x64_bf16 v[52:55], v[16:19], v[248:255], v88
  v_smfmac_f32_16x16x64_bf16 v[56:59], v[16:19], v[44:51], v88
  s_nop 6
  v_pk_add_f32 v[52:53], v[52:53], v[54:55]
  v_pk_add_f32 v[56:57], v[56:57], v[58:59]
  v_cvt_pk_bf16_f32 v100, v52, v53
  v_cvt_pk_bf16_f32 v101, v56, v57
  s_cmp_eq_u32 s36, 0
  s_cbranch_scc1 Lwt_79
  buffer_store_dwordx2 v[100:101], v92, s[4:7], s29 offen
  s_branch Lwtd_80
Lwt_79:
  buffer_store_dwordx2 v[100:101], v92, s[4:7], s29 offen sc1
Lwtd_80:
  s_cmp_ge_u32 s25, 63
  s_cbranch_scc1 L_VO_end
  s_add_u32 s42, s28, s58
  s_xor_b32 s30, s42, s36
  s_xor_b32 s31, s30, 4096
  s_xor_b32 s32, s42, 131072
  s_xor_b32 s48, s32, 4096
  s_add_u32 s41, s25, 1
  v_mov_b32 v94, s41
  s_add_u32 s33, s25, 33
  s_and_b32 s40, s33, 0x28
  s_mul_i32 s40, s40, 0x900
  s_and_b32 s40, s40, 0x6000
  s_xor_b32 s40, s40, s26
  s_lshl_b32 s33, s33, 16
  s_add_u32 s33, s33, s40
  s_xor_b32 s49, s33, 16384
  s_add_u32 s34, s25, 35
  s_and_b32 s40, s34, 0x28
  s_mul_i32 s40, s40, 0x900
  s_and_b32 s40, s40, 0x6000
  s_xor_b32 s40, s40, s26
  s_lshl_b32 s34, s34, 16
  s_add_u32 s34, s34, s40
  s_cmp_lt_u32 s25, 61
  s_cselect_b32 s34, s34, 2147483392
  s_xor_b32 s41, s34, 16384
  buffer_load_dword v68, v109, s[4:7], s59 offen sc1
  buffer_store_dword v80, v109, s[4:7], s34 offen sc1
  buffer_store_dword v80, v109, s[4:7], s41 offen sc1
  s_mov_b32 s59, s41
  s_xor_b32 s35, s29, 0x84000
  s_cmp_eq_u32 s36, 0
  s_cbranch_scc1 Lwt_81
  buffer_store_dwordx2 v[80:81], v92, s[4:7], s35 offen
  s_branch Lwtd_82
Lwt_81:
  buffer_store_dwordx2 v[80:81], v92, s[4:7], s35 offen sc1
Lwtd_82:
  v_mov_b64 v[60:61], 0
  v_mov_b64 v[62:63], 0
  v_mov_b64 v[64:65], 0
  v_mov_b64 v[66:67], 0
  v_mov_b64 v[52:53], 0
  v_mov_b64 v[54:55], 0
  v_mov_b64 v[56:57], 0
  v_mov_b64 v[58:59], 0
  ds_read_b128 v[20:23], v85 offset:0
  ds_read_b128 v[24:27], v85 offset:1024
  ds_read_b128 v[28:31], v85 offset:8192
  ds_read_b128 v[32:35], v85 offset:9216
  ds_read_b128 v[36:39], v85 offset:2048
  ds_read_b128 v[40:43], v85 offset:3072
  ds_read_b128 v[44:47], v85 offset:10240
  ds_read_b128 v[48:51], v85 offset:11264
  s_cmp_eq_u32 s36, 0
  s_nop 0
  s_cbranch_scc1 Ltrigd_84
  s_mov_b64 exec, 0xffff
  s_sleep 4
  s_nop 0
  s_nop 0
  s_nop 0
  buffer_load_dword v76, v90, s[4:7], 0 offen offset:2048 sc1
  s_sleep 1
  buffer_load_dword v77, v90, s[4:7], 0 offen offset:2048 sc1
  s_sleep 1
  buffer_load_dword v78, v90, s[4:7], 0 offen offset:2048 sc1
  s_sleep 1
Ltrig_83:
  s_sub_u32 s24, s24, 1
  s_cbranch_scc1 L_FAIL
  buffer_load_dword v79, v90, s[4:7], 0 offen offset:2048 sc1
  s_nop 0
  s_waitcnt vmcnt(3)
  v_cmp_gt_i32_e64 vcc, s25, v76
  s_cbranch_vccz Ltrigd_84
  buffer_load_dword v76, v90, s[4:7], 0 offen offset:2048 sc1
  s_waitcnt vmcnt(3)
  v_cmp_gt_i32 vcc, s25, v77
  s_cbranch_vccz Ltrigd_84
  buffer_load_dword v77, v90, s[4:7], 0 offen offset:2048 sc1
  s_waitcnt vmcnt(3)
  v_cmp_gt_i32 vcc, s25, v78
  s_cbranch_vccz Ltrigd_84
  buffer_load_dword v78, v90, s[4:7], 0 offen offset:2048 sc1
  s_waitcnt vmcnt(3)
  v_cmp_gt_i32_e64 vcc, s25, v79
  s_cbranch_vccnz Ltrig_83
Ltrigd_84:
  s_mov_b64 exec, -1
L_VOO_again:
  buffer_load_dwordx4 v[4:7], v110, s[4:7], s30 offen sc1
  s_nop 0
  buffer_load_dwordx4 v[8:11], v111, s[4:7], s30 offen sc1
  s_nop 0
  buffer_load_dwordx4 v[12:15], v112, s[4:7], s30 offen sc1
  s_nop 0
  buffer_load_dwordx4 v[16:19], v113, s[4:7], s30 offen sc1
  s_nop 0
  buffer_load_dwordx4 v[68:71], v110, s[4:7], s31 offen sc1
  s_nop 0
  buffer_load_dwordx4 v[72:75], v111, s[4:7], s31 offen sc1
  s_nop 0
  s_nop 0
  s_waitcnt vmcnt(5)
  v_cmp_eq_u32_e64 vcc, -1, v4
  s_cbranch_vccnz L_VOO_g0
L_VOO_ok0:
  buffer_load_dwordx4 v[96:99], v112, s[4:7], s31 offen sc1
  v_smfmac_f32_16x16x64_bf16 v[60:63], v[4:7], a[0:7], v88
  s_waitcnt vmcnt(5)
  v_cmp_eq_u32 vcc, -1, v8
  v_smfmac_f32_16x16x64_bf16 v[64:67], v[4:7], a[8:15], v88
  s_cbranch_vccnz L_VOO_g1
L_VOO_ok1:
  buffer_load_dwordx4 v[4:7], v113, s[4:7], s31 offen sc1
  v_smfmac_f32_16x16x64_bf16 v[60:63], v[8:11], a[16:23], v88
  s_waitcnt vmcnt(5)
  v_cmp_eq_u32 vcc, -1, v12
  v_smfmac_f32_16x16x64_bf16 v[64:67], v[8:11], a[24:31], v88
  s_cbranch_vccnz L_VOO_g2
L_VOO_ok2:
  buffer_load_dwordx4 v[8:11], v110, s[4:7], s32 offen sc1
  v_smfmac_f32_16x16x64_bf16 v[60:63], v[12:15], a[32:39], v88
  s_waitcnt vmcnt(5)
  v_cmp_eq_u32 vcc, -1, v16
  v_smfmac_f32_16x16x64_bf16 v[64:67], v[12:15], a[40:47], v88
  s_cbranch_vccnz L_VOO_g3
L_VOO_ok3:
  buffer_load_dwordx4 v[12:15], v111, s[4:7], s32 offen sc1
  v_smfmac_f32_16x16x64_bf16 v[60:63], v[16:19], a[48:55], v88
  s_waitcnt vmcnt(5)
  v_cmp_eq_u32 vcc, -1, v68
  v_smfmac_f32_16x16x64_bf16 v[64:67], v[16:19], a[56:63], v88
  s_cbranch_vccnz L_VOO_g4
L_VOO_ok4:
  buffer_load_dwordx4 v[16:19], v112, s[4:7], s32 offen sc1
  v_smfmac_f32_16x16x64_bf16 v[60:63], v[68:71], a[64:71], v88
  s_waitcnt vmcnt(5)
  v_cmp_eq_u32 vcc, -1, v72
  v_smfmac_f32_16x16x64_bf16 v[64:67], v[68:71], a[72:79], v88
  s_cbranch_vccnz L_VOO_g5
L_VOO_ok5:
  buffer_load_dwordx4 v[68:71], v113, s[4:7], s32 offen sc1
  v_smfmac_f32_16x16x64_bf16 v[60:63], v[72:75], a[80:87], v88
  s_nop 0
  s_waitcnt vmcnt(5)
  v_cmp_eq_u32_e64 vcc, -1, v96
  v_smfmac_f32_16x16x64_bf16 v[64:67], v[72:75], a[88:95], v88
  s_cbranch_vccnz L_VOO_g6
L_VOO_ok6:
  buffer_load_dwordx4 v[72:75], v110, s[4:7], s48 offen sc1
  v_smfmac_f32_16x16x64_bf16 v[60:63], v[96:99], a[96:103], v88
  s_waitcnt vmcnt(5)
  v_cmp_eq_u32 vcc, -1, v4
  v_smfmac_f32_16x16x64_bf16 v[64:67], v[96:99], a[104:111], v88
  s_cbranch_vccnz L_VOO_g7
L_VOO_ok7:
  buffer_load_dwordx4 v[96:99], v111, s[4:7], s48 offen sc1
  v_smfmac_f32_16x16x64_bf16 v[60:63], v[4:7], a[112:119], v88
  s_waitcnt vmcnt(5)
  v_cmp_eq_u32 vcc, -1, v8
  v_smfmac_f32_16x16x64_bf16 v[64:67], v[4:7], a[120:127], v88
  s_cbranch_vccnz L_VOO_g8
L_VOO_ok8:
  buffer_load_dwordx4 v[4:7], v112, s[4:7], s48 offen sc1
  v_smfmac_f32_16x16x64_bf16 v[60:63], v[8:11], a[128:135], v88
  s_waitcnt vmcnt(5)
  v_cmp_eq_u32 vcc, -1, v12
  v_smfmac_f32_16x16x64_bf16 v[64:67], v[8:11], a[136:143], v88
  s_cbranch_vccnz L_VOO_g9
L_VOO_ok9:
  buffer_load_dwordx4 v[8:11], v113, s[4:7], s48 offen sc1
  v_smfmac_f32_16x16x64_bf16 v[60:63], v[12:15], a[144:151], v88
  s_waitcnt vmcnt(5)
  v_cmp_eq_u32 vcc, -1, v16
  v_smfmac_f32_16x16x64_bf16 v[64:67], v[12:15], a[152:159], v88
  s_cbranch_vccnz L_VOO_g10
L_VOO_ok10:
  v_smfmac_f32_16x16x64_bf16 v[60:63], v[16:19], a[160:167], v88
  s_waitcnt vmcnt(4)
  v_cmp_eq_u32 vcc, -1, v68
  v_smfmac_f32_16x16x64_bf16 v[64:67], v[16:19], a[168:175], v88
  s_cbranch_vccnz L_VOO_g11
L_VOO_ok11:
  v_smfmac_f32_16x16x64_bf16 v[60:63], v[68:71], a[176:183], v88
  s_waitcnt vmcnt(3)
  v_cmp_eq_u32 vcc, -1, v72
  v_smfmac_f32_16x16x64_bf16 v[64:67], v[68:71], a[184:191], v88
  s_cbranch_vccnz L_VOO_g12
L_VOO_ok12:
  v_smfmac_f32_16x16x64_bf16 v[60:63], v[72:75], a[192:199], v88
  s_waitcnt vmcnt(2)
  v_cmp_eq_u32 vcc, -1, v96
  v_smfmac_f32_16x16x64_bf16 v[64:67], v[72:75], a[200:207], v88
  s_cbranch_vccnz L_VOO_g13
L_VOO_ok13:
  v_smfmac_f32_16x16x64_bf16 v[60:63], v[96:99], a[208:215], v88
  s_waitcnt vmcnt(1)
  v_cmp_eq_u32 vcc, -1, v4
  v_smfmac_f32_16x16x64_bf16 v[64:67], v[96:99], a[216:223], v88
  s_cbranch_vccnz L_VOO_g14
L_VOO_ok14:
  v_smfmac_f32_16x16x64_bf16 v[60:63], v[4:7], a[224:231], v88
  s_waitcnt vmcnt(0)
  v_cmp_eq_u32_e64 vcc, -1, v8
  v_smfmac_f32_16x16x64_bf16 v[64:67], v[4:7], a[232:239], v88
  s_cbranch_vccnz L_VOO_g15
L_VOO_ok15:
  v_smfmac_f32_16x16x64_bf16 v[60:63], v[8:11], a[240:247], v88
  v_smfmac_f32_16x16x64_bf16 v[64:67], v[8:11], a[248:255], v88
L_VOO_join:
  s_nop 6
  v_add_f32 v100, v60, v62
  v_add_f32 v102, v61, v63
  v_add_f32 v101, v64, v66
  v_add_f32 v103, v65, v67
  ds_write_b128 v95, v[100:103]
  v_cmp_u_f32 vcc, v100, v102
  s_cbranch_vccnz L_VOO_nan
L_VOO_done:
  buffer_store_dword v94, v91, s[4:7], s57 offen
  s_waitcnt lgkmcnt(0)
  s_barrier
  ds_read2st64_b64 v[100:103], v108 offset0:0 offset1:2
  ds_read2st64_b64 v[104:107], v108 offset0:4 offset1:6
  s_waitcnt lgkmcnt(1)
  v_pk_add_f32 v[100:101], v[100:101], v[102:103]
  s_waitcnt lgkmcnt(0)
  v_pk_add_f32 v[104:105], v[104:105], v[106:107]
  v_pk_add_f32 v[100:101], v[100:101], v[104:105]
  v_cvt_pk_bf16_f32 v100, v100, v101
  buffer_store_dword v100, v109, s[4:7], s49 offen
  buffer_store_dword v100, v109, s[4:7], s33 offen sc1
  s_add_u32 s25, s25, 1
  s_branch L_VO_top
L_VO_end:
  s_branch L_END
L_VO_bad:
  s_nop 7
  s_sub_u32 s24, s24, 1
  s_cbranch_scc1 L_FAIL
  s_add_u32 s60, s60, 1
  v_mov_b64 v[52:53], 0
  v_mov_b64 v[54:55], 0
  v_mov_b64 v[56:57], 0
  v_mov_b64 v[58:59], 0
  s_nop 1
  s_branch L_VO_retry
L_VO_rbad:
  s_sub_u32 s24, s24, 1
  s_cbranch_scc1 L_FAIL
  s_add_u32 s60, s60, 0x10000
  s_waitcnt lgkmcnt(0)
  buffer_load_dwordx4 v[68:71], v87, s[4:7], s27 offen offset:0 sc1
  buffer_load_dwordx4 v[72:75], v87, s[4:7], s27 offen offset:2048 sc1
  s_waitcnt vmcnt(0)
  ds_write_b128 v1, v[68:71] offset:2048
  ds_write_b128 v1, v[72:75] offset:3072
  v_max3_u32 v89, v68, v69, v70
  v_max3_u32 v89, v70, v71, v89
  v_max3_u32 v89, v72, v73, v89
  v_max3_u32 v89, v74, v75, v89
  v_cmp_eq_u32 vcc, -1, v89
  s_waitcnt lgkmcnt(0)
  s_cbranch_vccnz L_VO_rbad
  s_branch L_VO_rok
L_VOO_nan:
  s_cmp_eq_u32 s51, s25
  s_cbranch_scc1 L_VOO_done
  s_mov_b32 s51, s25
  s_add_u32 s61, s61, 0x10000
  s_waitcnt vmcnt(0) lgkmcnt(0)
L_VOO_v0:
  s_sub_u32 s24, s24, 1
  s_cbranch_scc1 L_FAIL
  buffer_load_dwordx4 v[4:7], v110, s[4:7], s30 offen sc1
  buffer_load_dwordx4 v[8:11], v111, s[4:7], s30 offen sc1
  buffer_load_dwordx4 v[12:15], v112, s[4:7], s30 offen sc1
  buffer_load_dwordx4 v[16:19], v113, s[4:7], s30 offen sc1
  v_mov_b32 v89, 0
  s_waitcnt vmcnt(0)
  v_max3_u32 v89, v4, v5, v89
  v_max3_u32 v89, v6, v7, v89
  v_max3_u32 v89, v8, v9, v89
  v_max3_u32 v89, v10, v11, v89
  v_max3_u32 v89, v12, v13, v89
  v_max3_u32 v89, v14, v15, v89
  v_max3_u32 v89, v16, v17, v89
  v_max3_u32 v89, v18, v19, v89
  v_cmp_eq_u32 vcc, -1, v89
  s_cbranch_vccnz L_VOO_v0
L_VOO_v4:
  s_sub_u32 s24, s24, 1
  s_cbranch_scc1 L_FAIL
  buffer_load_dwordx4 v[68:71], v110, s[4:7], s31 offen sc1
  buffer_load_dwordx4 v[72:75], v111, s[4:7], s31 offen sc1
  buffer_load_dwordx4 v[96:99], v112, s[4:7], s31 offen sc1
  buffer_load_dwordx4 v[4:7], v113, s[4:7], s31 offen sc1
  v_mov_b32 v89, 0
  s_waitcnt vmcnt(0)
  v_max3_u32 v89, v68, v69, v89
  v_max3_u32 v89, v70, v71, v89
  v_max3_u32 v89, v72, v73, v89
  v_max3_u32 v89, v74, v75, v89
  v_max3_u32 v89, v96, v97, v89
  v_max3_u32 v89, v98, v99, v89
  v_max3_u32 v89, v4, v5, v89
  v_max3_u32 v89, v6, v7, v89
  v_cmp_eq_u32 vcc, -1, v89
  s_cbranch_vccnz L_VOO_v4
L_VOO_v8:
  s_sub_u32 s24, s24, 1
  s_cbranch_scc1 L_FAIL
  buffer_load_dwordx4 v[8:11], v110, s[4:7], s32 offen sc1
  buffer_load_dwordx4 v[12:15], v111, s[4:7], s32 offen sc1
  buffer_load_dwordx4 v[16:19], v112, s[4:7], s32 offen sc1
  buffer_load_dwordx4 v[68:71], v113, s[4:7], s32 offen sc1
  v_mov_b32 v89, 0
  s_waitcnt vmcnt(0)
  v_max3_u32 v89, v8, v9, v89
  v_max3_u32 v89, v10, v11, v89
  v_max3_u32 v89, v12, v13, v89
  v_max3_u32 v89, v14, v15, v89
  v_max3_u32 v89, v16, v17, v89
  v_max3_u32 v89, v18, v19, v89
  v_max3_u32 v89, v68, v69, v89
  v_max3_u32 v89, v70, v71, v89
  v_cmp_eq_u32 vcc, -1, v89
  s_cbranch_vccnz L_VOO_v8
L_VOO_v12:
  s_sub_u32 s24, s24, 1
  s_cbranch_scc1 L_FAIL
  buffer_load_dwordx4 v[72:75], v110, s[4:7], s48 offen sc1
  buffer_load_dwordx4 v[96:99], v111, s[4:7], s48 offen sc1
  buffer_load_dwordx4 v[4:7], v112, s[4:7], s48 offen sc1
  buffer_load_dwordx4 v[8:11], v113, s[4:7], s48 offen sc1
  v_mov_b32 v89, 0
  s_waitcnt vmcnt(0)
  v_max3_u32 v89, v72, v73, v89
  v_max3_u32 v89, v74, v75, v89
  v_max3_u32 v89, v96, v97, v89
  v_max3_u32 v89, v98, v99, v89
  v_max3_u32 v89, v4, v5, v89
  v_max3_u32 v89, v6, v7, v89
  v_max3_u32 v89, v8, v9, v89
  v_max3_u32 v89, v10, v11, v89
  v_cmp_eq_u32 vcc, -1, v89
  s_cbranch_vccnz L_VOO_v12
  v_mov_b64 v[60:61], 0
  v_mov_b64 v[62:63], 0
  v_mov_b64 v[64:65], 0
  v_mov_b64 v[66:67], 0
L_VOOS_again:
  buffer_load_dwordx4 v[4:7], v110, s[4:7], s30 offen sc1
  s_nop 0
  buffer_load_dwordx4 v[8:11], v111, s[4:7], s30 offen sc1
  s_nop 0
  buffer_load_dwordx4 v[12:15], v112, s[4:7], s30 offen sc1
  s_nop 0
  buffer_load_dwordx4 v[16:19], v113, s[4:7], s30 offen sc1
  s_nop 0
  buffer_load_dwordx4 v[68:71], v110, s[4:7], s31 offen sc1
  s_nop 0
  buffer_load_dwordx4 v[72:75], v111, s[4:7], s31 offen sc1
  s_nop 0
  s_waitcnt vmcnt(5)
  buffer_load_dwordx4 v[96:99], v112, s[4:7], s31 offen sc1
  v_smfmac_f32_16x16x64_bf16 v[60:63], v[4:7], a[0:7], v88
  s_waitcnt vmcnt(5)
  v_smfmac_f32_16x16x64_bf16 v[64:67], v[4:7], a[8:15], v88
  buffer_load_dwordx4 v[4:7], v113, s[4:7], s31 offen sc1
  v_smfmac_f32_16x16x64_bf16 v[60:63], v[8:11], a[16:23], v88
  s_waitcnt vmcnt(5)
  v_smfmac_f32_16x16x64_bf16 v[64:67], v[8:11], a[24:31], v88
  buffer_load_dwordx4 v[8:11], v110, s[4:7], s32 offen sc1
  v_smfmac_f32_16x16x64_bf16 v[60:63], v[12:15], a[32:39], v88
  s_waitcnt vmcnt(5)
  v_smfmac_f32_16x16x64_bf16 v[64:67], v[12:15], a[40:47], v88
  buffer_load_dwordx4 v[12:15], v111, s[4:7], s32 offen sc1
  v_smfmac_f32_16x16x64_bf16 v[60:63], v[16:19], a[48:55], v88
  s_waitcnt vmcnt(5)
  v_smfmac_f32_16x16x64_bf16 v[64:67], v[16:19], a[56:63], v88
  buffer_load_dwordx4 v[16:19], v112, s[4:7], s32 offen sc1
  v_smfmac_f32_16x16x64_bf16 v[60:63], v[68:71], a[64:71], v88
  s_waitcnt vmcnt(5)
  v_smfmac_f32_16x16x64_bf16 v[64:67], v[68:71], a[72:79], v88
  buffer_load_dwordx4 v[68:71], v113, s[4:7], s32 offen sc1
  v_smfmac_f32_16x16x64_bf16 v[60:63], v[72:75], a[80:87], v88
  s_waitcnt vmcnt(5)
  v_smfmac_f32_16x16x64_bf16 v[64:67], v[72:75], a[88:95], v88
  buffer_load_dwordx4 v[72:75], v110, s[4:7], s48 offen sc1
  v_smfmac_f32_16x16x64_bf16 v[60:63], v[96:99], a[96:103], v88
  s_waitcnt vmcnt(5)
  v_smfmac_f32_16x16x64_bf16 v[64:67], v[96:99], a[104:111], v88
  buffer_load_dwordx4 v[96:99], v111, s[4:7], s48 offen sc1
  v_smfmac_f32_16x16x64_bf16 v[60:63], v[4:7], a[112:119], v88
  s_waitcnt vmcnt(5)
  v_smfmac_f32_16x16x64_bf16 v[64:67], v[4:7], a[120:127], v88
  buffer_load_dwordx4 v[4:7], v112, s[4:7], s48 offen sc1
  v_smfmac_f32_16x16x64_bf16 v[60:63], v[8:11], a[128:135], v88
  s_waitcnt vmcnt(5)
  v_smfmac_f32_16x16x64_bf16 v[64:67], v[8:11], a[136:143], v88
  buffer_load_dwordx4 v[8:11], v113, s[4:7], s48 offen sc1
  v_smfmac_f32_16x16x64_bf16 v[60:63], v[12:15], a[144:151], v88
  s_waitcnt vmcnt(5)
  v_smfmac_f32_16x16x64_bf16 v[64:67], v[12:15], a[152:159], v88
  v_smfmac_f32_16x16x64_bf16 v[60:63], v[16:19], a[160:167], v88
  s_waitcnt vmcnt(4)
  v_smfmac_f32_16x16x64_bf16 v[64:67], v[16:19], a[168:175], v88
  v_smfmac_f32_16x16x64_bf16 v[60:63], v[68:71], a[176:183], v88
  s_waitcnt vmcnt(3)
  v_smfmac_f32_16x16x64_bf16 v[64:67], v[68:71], a[184:191], v88
  v_smfmac_f32_16x16x64_bf16 v[60:63], v[72:75], a[192:199], v88
  s_waitcnt vmcnt(2)
  v_smfmac_f32_16x16x64_bf16 v[64:67], v[72:75], a[200:207], v88
  v_smfmac_f32_16x16x64_bf16 v[60:63], v[96:99], a[208:215], v88
  s_waitcnt vmcnt(1)
  v_smfmac_f32_16x16x64_bf16 v[64:67], v[96:99], a[216:223], v88
  v_smfmac_f32_16x16x64_bf16 v[60:63], v[4:7], a[224:231], v88
  s_waitcnt vmcnt(0)
  v_smfmac_f32_16x16x64_bf16 v[64:67], v[4:7], a[232:239], v88
  v_smfmac_f32_16x16x64_bf16 v[60:63], v[8:11], a[240:247], v88
  v_smfmac_f32_16x16x64_bf16 v[64:67], v[8:11], a[248:255], v88
  s_nop 7
  s_branch L_VOO_join
L_VOO_g0:
  s_sub_u32 s24, s24, 1
  s_cbranch_scc1 L_FAIL
  s_add_u32 s61, s61, 1
  buffer_load_dwordx4 v[4:7], v110, s[4:7], s30 offen sc1
  s_waitcnt vmcnt(0)
  v_cmp_eq_u32 vcc, -1, v4
  s_cbranch_vccnz L_VOO_g0
  v_mov_b32 v89, 0
  v_max3_u32 v89, v8, v12, v89
  v_max3_u32 v89, v16, v68, v89
  v_max3_u32 v89, v72, v72, v89
  v_cmp_eq_u32 vcc, -1, v89
  s_cbranch_vccz L_VOO_ok0
  buffer_load_dwordx4 v[8:11], v111, s[4:7], s30 offen sc1
  s_nop 0
  buffer_load_dwordx4 v[12:15], v112, s[4:7], s30 offen sc1
  s_nop 0
  buffer_load_dwordx4 v[16:19], v113, s[4:7], s30 offen sc1
  s_nop 0
  buffer_load_dwordx4 v[68:71], v110, s[4:7], s31 offen sc1
  s_nop 0
  buffer_load_dwordx4 v[72:75], v111, s[4:7], s31 offen sc1
  s_nop 0
  s_branch L_VOO_ok0
L_VOO_g1:
  s_sub_u32 s24, s24, 1
  s_cbranch_scc1 L_FAIL
  s_add_u32 s61, s61, 1
  buffer_load_dwordx4 v[8:11], v111, s[4:7], s30 offen sc1
  s_waitcnt vmcnt(0)
  v_cmp_eq_u32 vcc, -1, v8
  s_cbranch_vccnz L_VOO_g1
  v_mov_b32 v89, 0
  v_max3_u32 v89, v12, v16, v89
  v_max3_u32 v89, v68, v72, v89
  v_max3_u32 v89, v96, v96, v89
  v_cmp_eq_u32 vcc, -1, v89
  s_cbranch_vccz L_VOO_ok1
  buffer_load_dwordx4 v[12:15], v112, s[4:7], s30 offen sc1
  s_nop 0
  buffer_load_dwordx4 v[16:19], v113, s[4:7], s30 offen sc1
  s_nop 0
  buffer_load_dwordx4 v[68:71], v110, s[4:7], s31 offen sc1
  s_nop 0
  buffer_load_dwordx4 v[72:75], v111, s[4:7], s31 offen sc1
  s_nop 0
  buffer_load_dwordx4 v[96:99], v112, s[4:7], s31 offen sc1
  s_nop 0
  s_branch L_VOO_ok1
L_VOO_g2:
  s_sub_u32 s24, s24, 1
  s_cbranch_scc1 L_FAIL
  s_add_u32 s61, s61, 1
  buffer_load_dwordx4 v[12:15], v112, s[4:7], s30 offen sc1
  s_waitcnt vmcnt(0)
  v_cmp_eq_u32 vcc, -1, v12
  s_cbranch_vccnz L_VOO_g2
  v_mov_b32 v89, 0
  v_max3_u32 v89, v16, v68, v89
  v_max3_u32 v89, v72, v96, v89
  v_max3_u32 v89, v4, v4, v89
  v_cmp_eq_u32 vcc, -1, v89
  s_cbranch_vccz L_VOO_ok2
  buffer_load_dwordx4 v[16:19], v113, s[4:7], s30 offen sc1
  s_nop 0
  buffer_load_dwordx4 v[68:71], v110, s[4:7], s31 offen sc1
  s_nop 0
  buffer_load_dwordx4 v[72:75], v111, s[4:7], s31 offen sc1
  s_nop 0
  buffer_load_dwordx4 v[96:99], v112, s[4:7], s31 offen sc1
  s_nop 0
  buffer_load_dwordx4 v[4:7], v113, s[4:7], s31 offen sc1
  s_nop 0
  s_branch L_VOO_ok2
L_VOO_g3:
  s_sub_u32 s24, s24, 1
  s_cbranch_scc1 L_FAIL
  s_add_u32 s61, s61, 1
  buffer_load_dwordx4 v[16:19], v113, s[4:7], s30 offen sc1
  s_waitcnt vmcnt(0)
  v_cmp_eq_u32 vcc, -1, v16
  s_cbranch_vccnz L_VOO_g3
  v_mov_b32 v89, 0
  v_max3_u32 v89, v68, v72, v89
  v_max3_u32 v89, v96, v4, v89
  v_max3_u32 v89, v8, v8, v89
  v_cmp_eq_u32 vcc, -1, v89
  s_cbranch_vccz L_VOO_ok3
  buffer_load_dwordx4 v[68:71], v110, s[4:7], s31 offen sc1
  s_nop 0
  buffer_load_dwordx4 v[72:75], v111, s[4:7], s31 offen sc1
  s_nop 0
  buffer_load_dwordx4 v[96:99], v112, s[4:7], s31 offen sc1
  s_nop 0
  buffer_load_dwordx4 v[4:7], v113, s[4:7], s31 offen sc1
  s_nop 0
  buffer_load_dwordx4 v[8:11], v110, s[4:7], s32 offen sc1
  s_nop 0
  s_branch L_VOO_ok3
L_VOO_g4:
  s_sub_u32 s24, s24, 1
  s_cbranch_scc1 L_FAIL
  s_add_u32 s61, s61, 1
  buffer_load_dwordx4 v[68:71], v110, s[4:7], s31 offen sc1
  s_waitcnt vmcnt(0)
  v_cmp_eq_u32 vcc, -1, v68
  s_cbranch_vccnz L_VOO_g4
  v_mov_b32 v89, 0
  v_max3_u32 v89, v72, v96, v89
  v_max3_u32 v89, v4, v8, v89
  v_max3_u32 v89, v12, v12, v89
  v_cmp_eq_u32 vcc, -1, v89
  s_cbranch_vccz L_VOO_ok4
  buffer_load_dwordx4 v[72:75], v111, s[4:7], s31 offen sc1
  s_nop 0
  buffer_load_dwordx4 v[96:99], v112, s[4:7], s31 offen sc1
  s_nop 0
  buffer_load_dwordx4 v[4:7], v113, s[4:7], s31 offen sc1
  s_nop 0
  buffer_load_dwordx4 v[8:11], v110, s[4:7], s32 offen sc1
  s_nop 0
  buffer_load_dwordx4 v[12:15], v111, s[4:7], s32 offen sc1
  s_nop 0
  s_branch L_VOO_ok4
L_VOO_g5:
  s_sub_u32 s24, s24, 1
  s_cbranch_scc1 L_FAIL
  s_add_u32 s61, s61, 1
  buffer_load_dwordx4 v[72:75], v111, s[4:7], s31 offen sc1
  s_waitcnt vmcnt(0)
  v_cmp_eq_u32 vcc, -1, v72
  s_cbranch_vccnz L_VOO_g5
  v_mov_b32 v89, 0
  v_max3_u32 v89, v96, v4, v89
  v_max3_u32 v89, v8, v12, v89
  v_max3_u32 v89, v16, v16, v89
  v_cmp_eq_u32 vcc, -1, v89
  s_cbranch_vccz L_VOO_ok5
  buffer_load_dwordx4 v[96:99], v112, s[4:7], s31 offen sc1
  s_nop 0
  buffer_load_dwordx4 v[4:7], v113, s[4:7], s31 offen sc1
  s_nop 0
  buffer_load_dwordx4 v[8:11], v110, s[4:7], s32 offen sc1
  s_nop 0
  buffer_load_dwordx4 v[12:15], v111, s[4:7], s32 offen sc1
  s_nop 0
  buffer_load_dwordx4 v[16:19], v112, s[4:7], s32 offen sc1
  s_nop 0
  s_branch L_VOO_ok5
L_VOO_g6:
  s_sub_u32 s24, s24, 1
  s_cbranch_scc1 L_FAIL
  s_add_u32 s61, s61, 1
  buffer_load_dwordx4 v[96:99], v112, s[4:7], s31 offen sc1
  s_waitcnt vmcnt(0)
  v_cmp_eq_u32 vcc, -1, v96
  s_cbranch_vccnz L_VOO_g6
  v_mov_b32 v89, 0
  v_max3_u32 v89, v4, v8, v89
  v_max3_u32 v89, v12, v16, v89
  v_max3_u32 v89, v68, v68, v89
  v_cmp_eq_u32 vcc, -1, v89
  s_cbranch_vccz L_VOO_ok6
  buffer_load_dwordx4 v[4:7], v113, s[4:7], s31 offen sc1
  s_nop 0
  buffer_load_dwordx4 v[8:11], v110, s[4:7], s32 offen sc1
  s_nop 0
  buffer_load_dwordx4 v[12:15], v111, s[4:7], s32 offen sc1
  s_nop 0
  buffer_load_dwordx4 v[16:19], v112, s[4:7], s32 offen sc1
  s_nop 0
  buffer_load_dwordx4 v[68:71], v113, s[4:7], s32 offen sc1
  s_nop 0
  s_branch L_VOO_ok6
L_VOO_g7:
  s_sub_u32 s24, s24, 1
  s_cbranch_scc1 L_FAIL
  s_add_u32 s61, s61, 1
  buffer_load_dwordx4 v[4:7], v113, s[4:7], s31 offen sc1
  s_waitcnt vmcnt(0)
  v_cmp_eq_u32 vcc, -1, v4
  s_cbranch_vccnz L_VOO_g7
  v_mov_b32 v89, 0
  v_max3_u32 v89, v8, v12, v89
  v_max3_u32 v89, v16, v68, v89
  v_max3_u32 v89, v72, v72, v89
  v_cmp_eq_u32 vcc, -1, v89
  s_cbranch_vccz L_VOO_ok7
  buffer_load_dwordx4 v[8:11], v110, s[4:7], s32 offen sc1
  s_nop 0
  buffer_load_dwordx4 v[12:15], v111, s[4:7], s32 offen sc1
  s_nop 0
  buffer_load_dwordx4 v[16:19], v112, s[4:7], s32 offen sc1
  s_nop 0
  buffer_load_dwordx4 v[68:71], v113, s[4:7], s32 offen sc1
  s_nop 0
  buffer_load_dwordx4 v[72:75], v110, s[4:7], s48 offen sc1
  s_nop 0
  s_branch L_VOO_ok7
L_VOO_g8:
  s_sub_u32 s24, s24, 1
  s_cbranch_scc1 L_FAIL
  s_add_u32 s61, s61, 256
  buffer_load_dwordx4 v[8:11], v110, s[4:7], s32 offen sc1
  s_waitcnt vmcnt(0)
  v_cmp_eq_u32 vcc, -1, v8
  s_cbranch_vccnz L_VOO_g8
  v_mov_b32 v89, 0
  v_max3_u32 v89, v12, v16, v89
  v_max3_u32 v89, v68, v72, v89
  v_max3_u32 v89, v96, v96, v89
  v_cmp_eq_u32 vcc, -1, v89
  s_cbranch_vccz L_VOO_ok8
  buffer_load_dwordx4 v[12:15], v111, s[4:7], s32 offen sc1
  s_nop 0
  buffer_load_dwordx4 v[16:19], v112, s[4:7], s32 offen sc1
  s_nop 0
  buffer_load_dwordx4 v[68:71], v113, s[4:7], s32 offen sc1
  s_nop 0
  buffer_load_dwordx4 v[72:75], v110, s[4:7], s48 offen sc1
  s_nop 0
  buffer_load_dwordx4 v[96:99], v111, s[4:7], s48 offen sc1
  s_nop 0
  s_branch L_VOO_ok8
L_VOO_g9:
  s_sub_u32 s24, s24, 1
  s_cbranch_scc1 L_FAIL
  s_add_u32 s61, s61, 256
  buffer_load_dwordx4 v[12:15], v111, s[4:7], s32 offen sc1
  s_waitcnt vmcnt(0)
  v_cmp_eq_u32 vcc, -1, v12
  s_cbranch_vccnz L_VOO_g9
  v_mov_b32 v89, 0
  v_max3_u32 v89, v16, v68, v89
  v_max3_u32 v89, v72, v96, v89
  v_max3_u32 v89, v4, v4, v89
  v_cmp_eq_u32 vcc, -1, v89
  s_cbranch_vccz L_VOO_ok9
  buffer_load_dwordx4 v[16:19], v112, s[4:7], s32 offen sc1
  s_nop 0
  buffer_load_dwordx4 v[68:71], v113, s[4:7], s32 offen sc1
  s_nop 0
  buffer_load_dwordx4 v[72:75], v110, s[4:7], s48 offen sc1
  s_nop 0
  buffer_load_dwordx4 v[96:99], v111, s[4:7], s48 offen sc1
  s_nop 0
  buffer_load_dwordx4 v[4:7], v112, s[4:7], s48 offen sc1
  s_nop 0
  s_branch L_VOO_ok9
L_VOO_g10:
  s_sub_u32 s24, s24, 1
  s_cbranch_scc1 L_FAIL
  s_add_u32 s61, s61, 256
  buffer_load_dwordx4 v[16:19], v112, s[4:7], s32 offen sc1
  s_waitcnt vmcnt(0)
  v_cmp_eq_u32 vcc, -1, v16
  s_cbranch_vccnz L_VOO_g10
  v_mov_b32 v89, 0
  v_max3_u32 v89, v68, v72, v89
  v_max3_u32 v89, v96, v4, v89
  v_max3_u32 v89, v8, v8, v89
  v_cmp_eq_u32 vcc, -1, v89
  s_cbranch_vccz L_VOO_ok10
  buffer_load_dwordx4 v[68:71], v113, s[4:7], s32 offen sc1
  s_nop 0
  buffer_load_dwordx4 v[72:75], v110, s[4:7], s48 offen sc1
  s_nop 0
  buffer_load_dwordx4 v[96:99], v111, s[4:7], s48 offen sc1
  s_nop 0
  buffer_load_dwordx4 v[4:7], v112, s[4:7], s48 offen sc1
  s_nop 0
  buffer_load_dwordx4 v[8:11], v113, s[4:7], s48 offen sc1
  s_nop 0
  s_branch L_VOO_ok10
L_VOO_g11:
  s_sub_u32 s24, s24, 1
  s_cbranch_scc1 L_FAIL
  s_add_u32 s61, s61, 256
  buffer_load_dwordx4 v[68:71], v113, s[4:7], s32 offen sc1
  s_waitcnt vmcnt(0)
  v_cmp_eq_u32 vcc, -1, v68
  s_cbranch_vccnz L_VOO_g11
  v_mov_b32 v89, 0
  v_max3_u32 v89, v72, v96, v89
  v_max3_u32 v89, v4, v8, v89
  v_cmp_eq_u32 vcc, -1, v89
  s_cbranch_vccz L_VOO_ok11
  buffer_load_dwordx4 v[72:75], v110, s[4:7], s48 offen sc1
  s_nop 0
  buffer_load_dwordx4 v[96:99], v111, s[4:7], s48 offen sc1
  s_nop 0
  buffer_load_dwordx4 v[4:7], v112, s[4:7], s48 offen sc1
  s_nop 0
  buffer_load_dwordx4 v[8:11], v113, s[4:7], s48 offen sc1
  s_nop 0
  s_branch L_VOO_ok11
L_VOO_g12:
  s_sub_u32 s24, s24, 1
  s_cbranch_scc1 L_FAIL
  s_add_u32 s61, s61, 256
  buffer_load_dwordx4 v[72:75], v110, s[4:7], s48 offen sc1
  s_waitcnt vmcnt(0)
  v_cmp_eq_u32 vcc, -1, v72
  s_cbranch_vccnz L_VOO_g12
  v_mov_b32 v89, 0
  v_max3_u32 v89, v96, v4, v89
  v_max3_u32 v89, v8, v8, v89
  v_cmp_eq_u32 vcc, -1, v89
  s_cbranch_vccz L_VOO_ok12
  buffer_load_dwordx4 v[96:99], v111, s[4:7], s48 offen sc1
  s_nop 0
  buffer_load_dwordx4 v[4:7], v112, s[4:7], s48 offen sc1
  s_nop 0
  buffer_load_dwordx4 v[8:11], v113, s[4:7], s48 offen sc1
  s_nop 0
  s_branch L_VOO_ok12
L_VOO_g13:
  s_sub_u32 s24, s24, 1
  s_cbranch_scc1 L_FAIL
  s_add_u32 s61, s61, 256
  buffer_load_dwordx4 v[96:99], v111, s[4:7], s48 offen sc1
  s_waitcnt vmcnt(0)
  v_cmp_eq_u32 vcc, -1, v96
  s_cbranch_vccnz L_VOO_g13
  v_mov_b32 v89, 0
  v_max3_u32 v89, v4, v8, v89
  v_cmp_eq_u32 vcc, -1, v89
  s_cbranch_vccz L_VOO_ok13
  buffer_load_dwordx4 v[4:7], v112, s[4:7], s48 offen sc1
  s_nop 0
  buffer_load_dwordx4 v[8:11], v113, s[4:7], s48 offen sc1
  s_nop 0
  s_branch L_VOO_ok13
L_VOO_g14:
  s_sub_u32 s24, s24, 1
  s_cbranch_scc1 L_FAIL
  s_add_u32 s61, s61, 256
  buffer_load_dwordx4 v[4:7], v112, s[4:7], s48 offen sc1
  s_waitcnt vmcnt(0)
  v_cmp_eq_u32 vcc, -1, v4
  s_cbranch_vccnz L_VOO_g14
  v_mov_b32 v89, 0
  v_max3_u32 v89, v8, v8, v89
  v_cmp_eq_u32 vcc, -1, v89
  s_cbranch_vccz L_VOO_ok14
  buffer_load_dwordx4 v[8:11], v113, s[4:7], s48 offen sc1
  s_nop 0
  s_branch L_VOO_ok14
L_VOO_g15:
  s_sub_u32 s24, s24, 1
  s_cbranch_scc1 L_FAIL
  s_add_u32 s61, s61, 256
  buffer_load_dwordx4 v[8:11], v113, s[4:7], s48 offen sc1
  s_waitcnt vmcnt(0)
  v_cmp_eq_u32 vcc, -1, v8
  s_cbranch_vccnz L_VOO_g15
  s_branch L_VOO_ok15
L_LAST:
  s_endpgm
.section .rodata,"a"
.p2align 6
.amdhsa_kernel adaLN_cond__memory_aug_recurrent_mem_tr__glu_gated_swiglu__prompt_kernel
  .amdhsa_next_free_vgpr 512
  .amdhsa_next_free_sgpr 102
  .amdhsa_accum_offset 256
  .amdhsa_group_segment_fixed_size 0
  .amdhsa_kernarg_size 128
  .amdhsa_user_sgpr_count 2
  .amdhsa_user_sgpr_kernarg_segment_ptr 1
  .amdhsa_system_sgpr_workgroup_id_x 1
  .amdhsa_float_denorm_mode_32 3
.end_amdhsa_kernel
```

```asm
; @launch grid=(256,1,1) block=(256,1,1) lds=163840
.amdgcn_target "amdgcn-amd-amdhsa--gfx950"
.text
.globl adaLN_cond__memory_aug_recurrent_mem_tr__glu_gated_swiglu__prompt_kernel
.p2align 8
.type adaLN_cond__memory_aug_recurrent_mem_tr__glu_gated_swiglu__prompt_kernel,@function
adaLN_cond__memory_aug_recurrent_mem_tr__glu_gated_swiglu__prompt_kernel:
  s_cmp_ge_u32 s2, 256
  s_cbranch_scc1 L_END
  s_load_dwordx2 s[4:5], s[0:1], 120
  s_load_dwordx2 s[12:13], s[0:1], 112
  v_lshrrev_b32 v1, 6, v0
  v_and_b32 v0, 63, v0
  v_readfirstlane_b32 s20, v1
  s_mov_b32 s6, 163610624
  s_mov_b32 s7, 0x20000
  s_mov_b32 s14, 256
  s_mov_b32 s15, 0x20000
  s_mov_b32 s24, 300000
  s_and_b32 s40, s2, 7
  s_mov_b32 s42, 0x3020100
  s_mov_b32 s43, 0x3020100
  s_cmp_eq_u32 s40, 1
  s_cselect_b32 s42, 0x1b161514, s42
  s_cselect_b32 s43, 0x1b1a1918, s43
  s_cmp_eq_u32 s40, 2
  s_cselect_b32 s42, 0xb0a0908, s42
  s_cselect_b32 s43, 0xb0a0908, s43
  s_cmp_eq_u32 s40, 3
  s_cselect_b32 s42, 0x1f1e1d1c, s42
  s_cselect_b32 s43, 0x1f1e1d1c, s43
  s_cmp_eq_u32 s40, 4
  s_cselect_b32 s42, 0x7060504, s42
  s_cselect_b32 s43, 0x7060504, s43
  s_cmp_eq_u32 s40, 5
  s_cselect_b32 s42, 0x13121110, s42
  s_cselect_b32 s43, 0x13121110, s43
  s_cmp_eq_u32 s40, 6
  s_cselect_b32 s42, 0xf0e0d0c, s42
  s_cselect_b32 s43, 0xf0e0d0c, s43
  s_cmp_eq_u32 s40, 7
  s_cselect_b32 s42, 0x1a191817, s42
  s_cselect_b32 s43, 0x17161514, s43
  s_lshr_b32 s40, s2, 6
  s_lshl_b32 s40, s40, 3
  s_lshr_b32 s42, s42, s40
  s_lshr_b32 s43, s43, s40
  s_bfe_u32 s41, s2, 0x30003
  s_and_b32 s42, s42, 31
  s_lshl_b32 s42, s42, 3
  s_add_u32 s3, s42, s41
  s_bfe_u32 s22, s43, 0x30002
  s_and_b32 s43, s43, 3
  s_lshl_b32 s43, s43, 3
  s_add_u32 s23, s43, s41
  s_waitcnt lgkmcnt(0)
  s_add_u32 s4, s4, 6291455
  s_addc_u32 s5, s5, 0
  s_and_b32 s4, s4, 0xffe00000
  s_cmp_lg_u32 s20, 3
  s_cbranch_scc1 L_NOPRE
  s_getpc_b64 s[40:41]
L_PC:
  s_lshr_b32 s42, s2, 3
  v_lshlrev_b32 v1, 12, v0
  s_lshl_b32 s42, s42, 7
  v_add_u32 v1, s42, v1
  v_min_u32 v1, L_LAST-L_PC, v1
  global_load_dword v255, v1, s[40:41]
L_NOPRE:
  s_cmp_ge_u32 s22, 4
  s_cbranch_scc1 L_TRAIL
  s_lshr_b32 s40, s22, 1
  s_bitcmp1_b32 s22, 0
  s_cbranch_scc0 L_REC
  s_lshl_b32 s40, s40, 5
  s_add_u32 s21, s40, s23
  s_branch L_QKV
L_REC:
  s_lshl_b32 s40, s40, 4
  s_lshr_b32 s41, s23, 1
  s_add_u32 s21, s40, s41
  s_bitcmp1_b32 s23, 0
  s_cbranch_scc1 L_VO
  s_branch L_QK
L_TRAIL:
  s_mov_b32 s21, s23
  s_cmp_eq_u32 s22, 6
  s_cbranch_scc1 L_MOD
  s_sub_u32 s40, s22, 4
  s_lshl_b32 s40, s40, 5
  s_add_u32 s21, s40, s23
  s_cmp_lg_u32 s22, 7
  s_cbranch_scc1 L_WOF
L_INIT:
  s_lshl_b32 s40, s23, 2
  s_add_u32 s40, s40, s20
  s_lshl_b32 s40, s40, 12
  s_add_u32 s41, s40, 1310720
  s_add_u32 s43, s40, 1900544
  s_add_u32 s42, s40, 0x80000
  v_lshlrev_b32 v1, 4, v0
  v_mov_b32 v4, -1
  v_mov_b32 v5, -1
  v_mov_b32 v6, -1
  v_mov_b32 v7, -1
  s_cmp_lt_u32 s23, 16
  s_cselect_b32 s41, s41, s43
  s_cmp_lt_u32 s23, 24
  s_cselect_b32 s41, s41, 2147483392
  buffer_store_dwordx4 v[4:7], v1, s[4:7], s41 offen offset:0 sc1
  buffer_store_dwordx4 v[4:7], v1, s[4:7], s41 offen offset:1024 sc1
  buffer_store_dwordx4 v[4:7], v1, s[4:7], s41 offen offset:2048 sc1
  buffer_store_dwordx4 v[4:7], v1, s[4:7], s41 offen offset:3072 sc1
  buffer_store_dwordx4 v[4:7], v1, s[4:7], s40 offen offset:0 sc1
  buffer_store_dwordx4 v[4:7], v1, s[4:7], s40 offen offset:1024 sc1
  buffer_store_dwordx4 v[4:7], v1, s[4:7], s40 offen offset:2048 sc1
  buffer_store_dwordx4 v[4:7], v1, s[4:7], s40 offen offset:3072 sc1
  buffer_store_dwordx4 v[4:7], v1, s[4:7], s42 offen offset:0 sc1
  buffer_store_dwordx4 v[4:7], v1, s[4:7], s42 offen offset:1024 sc1
  buffer_store_dwordx4 v[4:7], v1, s[4:7], s42 offen offset:2048 sc1
  buffer_store_dwordx4 v[4:7], v1, s[4:7], s42 offen offset:3072 sc1
  s_load_dwordx2 s[16:17], s[0:1], 8
  s_mov_b32 s18, 16384
  s_mov_b32 s19, 0x20000
  s_waitcnt lgkmcnt(0)
  s_and_b32 s40, s20, 1
  s_lshl_b32 s40, s40, 3
  v_bfe_u32 v8, v0, 2, 3
  v_add_u32 v8, s40, v8
  s_lshr_b32 s40, s20, 1
  s_lshl_b32 s40, s40, 3
  v_and_b32 v9, 3, v0
  v_add_u32 v9, s40, v9
  v_bfe_u32 v10, v8, 1, 1
  v_lshl_add_u32 v9, v10, 2, v9
  v_lshrrev_b32 v10, 2, v8
  v_and_b32 v11, 1, v8
  v_lshl_add_u32 v10, v10, 1, v11
  s_lshl_b32 s40, s23, 6
  v_lshl_add_u32 v10, v10, 11, s40
  v_lshl_add_u32 v10, v9, 1, v10
  buffer_load_ushort v11, v10, s[16:19], 0 offen
  buffer_load_ushort v12, v10, s[16:19], 0 offen offset:32
  s_bfe_u32 s41, s23, 0x10002
  s_mul_i32 s41, s41, 32768
  s_lshr_b32 s40, s23, 3
  s_lshl_b32 s40, s40, 11
  s_add_u32 s40, s40, s41
  s_and_b32 s41, s23, 3
  s_lshl_b32 s41, s41, 9
  s_add_u32 s40, s40, s41
  s_lshl_b32 s41, s20, 7
  s_add_u32 s40, s40, s41
  s_add_u32 s40, s40, 2097152
  s_add_u32 s41, s40, 0x4000
  v_and_b32 v8, 31, v0
  v_lshlrev_b32 v8, 2, v8
  v_lshrrev_b32 v9, 5, v0
  v_lshl_add_u32 v8, v9, 13, v8
  s_waitcnt vmcnt(0)
  v_lshl_or_b32 v11, v12, 16, v11
  v_min_u32 v11, -2, v11
  buffer_store_dword v11, v8, s[4:7], s40 offen sc1
  buffer_store_dword v11, v8, s[4:7], s41 offen sc1
  s_lshl_b32 s40, s23, 2
  s_add_u32 s40, s40, 128
  s_cmp_eq_u32 s20, 0
  s_cselect_b32 s40, s40, 2147483392
  v_mov_b32 v2, 2147483392
  s_mov_b64 exec, 1
  v_mov_b32 v2, s40
  s_mov_b64 exec, -1
  v_mov_b32 v3, 1
  s_waitcnt vmcnt(0)
  s_barrier
  buffer_store_dword v3, v2, s[12:15], 0 offen sc1
  s_branch L_LN1
L_MOD:
  s_load_dwordx2 s[16:17], s[0:1], 88
  s_mov_b32 s18, 2048
  s_mov_b32 s19, 0x20000
  s_waitcnt lgkmcnt(0)
  s_load_dwordx2 s[8:9], s[0:1], 96
  s_mov_b32 s10, 12582912
  s_mov_b32 s11, 0x20000
  s_waitcnt lgkmcnt(0)
  s_lshl_b32 s40, s20, 9
  v_lshl_add_u32 v1, v0, 3, s40
  buffer_load_dwordx2 v[8:9], v1, s[16:19], 0 offen
  v_bfe_u32 v2, v0, 5, 1
  v_mul_u32_u24 v2, 98304, v2
  v_bfe_u32 v3, v0, 4, 1
  v_mul_u32_u24 v3, 24576, v3
  v_add_u32 v2, v2, v3
  v_bfe_u32 v3, v0, 3, 1
  v_mul_u32_u24 v3, 12288, v3
  v_add_u32 v2, v2, v3
  v_lshrrev_b32 v3, 3, v0
  v_and_b32 v3, 6, v3
  v_xor_b32 v3, v3, v0
  v_and_b32 v3, 7, v3
  v_lshl_add_u32 v2, v3, 4, v2
  s_lshr_b32 s40, s20, 1
  s_mul_i32 s40, s40, 49152
  s_and_b32 s41, s20, 1
  s_mul_i32 s41, s41, 196608
  s_add_u32 s40, s40, s41
  s_lshl_b32 s41, s21, 7
  s_add_u32 s40, s40, s41
  v_add_u32 v2, s40, v2
  s_lshl_b32 s41, s20, 10
  s_add_u32 m0, s41, 0
  s_mov_b32 s42, 0
  buffer_load_dwordx4 v2, s[8:11], s42 offen nt lds
  s_add_u32 m0, s41, 4096
  s_mov_b32 s42, 393216
  buffer_load_dwordx4 v2, s[8:11], s42 offen nt lds
  s_add_u32 m0, s41, 8192
  s_mov_b32 s42, 786432
  buffer_load_dwordx4 v2, s[8:11], s42 offen nt lds
  s_add_u32 m0, s41, 12288
  s_mov_b32 s42, 1179648
  buffer_load_dwordx4 v2, s[8:11], s42 offen nt lds
  s_add_u32 m0, s41, 16384
  s_mov_b32 s42, 1572864
  buffer_load_dwordx4 v2, s[8:11], s42 offen nt lds
  s_add_u32 m0, s41, 20480
  s_mov_b32 s42, 1966080
  buffer_load_dwordx4 v2, s[8:11], s42 offen nt lds
  s_add_u32 m0, s41, 24576
  s_mov_b32 s42, 2359296
  buffer_load_dwordx4 v2, s[8:11], s42 offen nt lds
  s_add_u32 m0, s41, 28672
  s_mov_b32 s42, 2752512
  buffer_load_dwordx4 v2, s[8:11], s42 offen nt lds
  s_add_u32 m0, s41, 32768
  s_mov_b32 s42, 3145728
  buffer_load_dwordx4 v2, s[8:11], s42 offen nt lds
  s_add_u32 m0, s41, 36864
  s_mov_b32 s42, 3538944
  buffer_load_dwordx4 v2, s[8:11], s42 offen nt lds
  s_add_u32 m0, s41, 40960
  s_mov_b32 s42, 3932160
  buffer_load_dwordx4 v2, s[8:11], s42 offen nt lds
  s_add_u32 m0, s41, 45056
  s_mov_b32 s42, 4325376
  buffer_load_dwordx4 v2, s[8:11], s42 offen nt lds
  s_add_u32 m0, s41, 49152
  s_mov_b32 s42, 4718592
  buffer_load_dwordx4 v2, s[8:11], s42 offen nt lds
  s_add_u32 m0, s41, 53248
  s_mov_b32 s42, 5111808
  buffer_load_dwordx4 v2, s[8:11], s42 offen nt lds
  s_add_u32 m0, s41, 57344
  s_mov_b32 s42, 5505024
  buffer_load_dwordx4 v2, s[8:11], s42 offen nt lds
  s_add_u32 m0, s41, 61440
  s_mov_b32 s42, 5898240
  buffer_load_dwordx4 v2, s[8:11], s42 offen nt lds
  s_add_u32 m0, s41, 65536
  s_mov_b32 s42, 6291456
  buffer_load_dwordx4 v2, s[8:11], s42 offen nt lds
  s_add_u32 m0, s41, 69632
  s_mov_b32 s42, 6684672
  buffer_load_dwordx4 v2, s[8:11], s42 offen nt lds
  s_add_u32 m0, s41, 73728
  s_mov_b32 s42, 7077888
  buffer_load_dwordx4 v2, s[8:11], s42 offen nt lds
  s_add_u32 m0, s41, 77824
  s_mov_b32 s42, 7471104
  buffer_load_dwordx4 v2, s[8:11], s42 offen nt lds
  s_add_u32 m0, s41, 81920
  s_mov_b32 s42, 7864320
  buffer_load_dwordx4 v2, s[8:11], s42 offen nt lds
  s_add_u32 m0, s41, 86016
  s_mov_b32 s42, 8257536
  buffer_load_dwordx4 v2, s[8:11], s42 offen nt lds
  s_add_u32 m0, s41, 90112
  s_mov_b32 s42, 8650752
  buffer_load_dwordx4 v2, s[8:11], s42 offen nt lds
  s_add_u32 m0, s41, 94208
  s_mov_b32 s42, 9043968
  buffer_load_dwordx4 v2, s[8:11], s42 offen nt lds
  s_add_u32 m0, s41, 98304
  s_mov_b32 s42, 9437184
  buffer_load_dwordx4 v2, s[8:11], s42 offen nt lds
  s_add_u32 m0, s41, 102400
  s_mov_b32 s42, 9830400
  buffer_load_dwordx4 v2, s[8:11], s42 offen nt lds
  s_add_u32 m0, s41, 106496
  s_mov_b32 s42, 10223616
  buffer_load_dwordx4 v2, s[8:11], s42 offen nt lds
  s_add_u32 m0, s41, 110592
  s_mov_b32 s42, 10616832
  buffer_load_dwordx4 v2, s[8:11], s42 offen nt lds
  s_add_u32 m0, s41, 114688
  s_mov_b32 s42, 11010048
  buffer_load_dwordx4 v2, s[8:11], s42 offen nt lds
  s_add_u32 m0, s41, 118784
  s_mov_b32 s42, 11403264
  buffer_load_dwordx4 v2, s[8:11], s42 offen nt lds
  s_add_u32 m0, s41, 122880
  s_mov_b32 s42, 11796480
  buffer_load_dwordx4 v2, s[8:11], s42 offen nt lds
  s_add_u32 m0, s41, 126976
  s_mov_b32 s42, 12189696
  buffer_load_dwordx4 v2, s[8:11], s42 offen nt lds
  v_bfe_u32 v3, v0, 3, 2
  v_xor_b32 v3, s20, v3
  v_lshlrev_b32 v3, 5, v3
  v_lshrrev_b32 v4, 2, v0
  v_lshl_add_u32 v4, v4, 7, v3
  v_and_b32 v3, 3, v0
  v_lshl_add_u32 v4, v3, 3, v4
  v_add_u32 v5, 0x10000, v4
  v_lshrrev_b32 v6, 4, v0
  v_lshlrev_b32 v6, 4, v6
  v_add_u32 v6, 0x20000, v6
  v_add_u32 v1, 0x20000, v1
  s_mov_b32 s37, 0xbfb8aa3b
  s_waitcnt vmcnt(32)
  v_lshlrev_b32 v10, 16, v8
  v_and_b32 v11, 0xffff0000, v8
  v_lshlrev_b32 v12, 16, v9
  v_and_b32 v13, 0xffff0000, v9
  v_mul_f32 v14, s37, v10
  v_mul_f32 v15, s37, v11
  v_mul_f32 v16, s37, v12
  v_mul_f32 v17, s37, v13
  v_exp_f32 v14, v14
  v_exp_f32 v15, v15
  v_exp_f32 v16, v16
  v_exp_f32 v17, v17
  v_add_f32 v14, 1.0, v14
  v_add_f32 v15, 1.0, v15
  v_add_f32 v16, 1.0, v16
  v_add_f32 v17, 1.0, v17
  v_rcp_f32 v14, v14
  v_rcp_f32 v15, v15
  v_rcp_f32 v16, v16
  v_rcp_f32 v17, v17
  v_mul_f32 v10, v10, v14
  v_mul_f32 v11, v11, v15
  v_mul_f32 v12, v12, v16
  v_mul_f32 v13, v13, v17
  v_cvt_pk_bf16_f32 v8, v10, v11
  v_cvt_pk_bf16_f32 v9, v12, v13
  ds_write_b64 v1, v[8:9]
  s_waitcnt vmcnt(28) lgkmcnt(0)
  s_barrier
  ds_read_b64_tr_b16 v[24:25], v4 offset:0
  ds_read_b64_tr_b16 v[26:27], v4 offset:2048
  ds_read_b128 v[28:31], v6 offset:0
  ds_read_b64_tr_b16 v[32:33], v4 offset:4096
  ds_read_b64_tr_b16 v[34:35], v4 offset:6144
  ds_read_b128 v[36:39], v6 offset:64
  ds_read_b64_tr_b16 v[40:41], v4 offset:8192
  ds_read_b64_tr_b16 v[42:43], v4 offset:10240
  ds_read_b128 v[44:47], v6 offset:128
  ds_read_b64_tr_b16 v[48:49], v4 offset:12288
  ds_read_b64_tr_b16 v[50:51], v4 offset:14336
  ds_read_b128 v[52:55], v6 offset:192
  s_waitcnt lgkmcnt(9)
  v_mfma_f32_16x16x32_bf16 v[20:23], v[24:27], v[28:31], 0
  s_waitcnt lgkmcnt(6)
  v_mfma_f32_16x16x32_bf16 v[20:23], v[32:35], v[36:39], v[20:23]
  s_waitcnt lgkmcnt(3)
  v_mfma_f32_16x16x32_bf16 v[20:23], v[40:43], v[44:47], v[20:23]
  s_waitcnt lgkmcnt(0)
  v_mfma_f32_16x16x32_bf16 v[20:23], v[48:51], v[52:55], v[20:23]
  s_waitcnt vmcnt(24) lgkmcnt(0)
  s_barrier
  ds_read_b64_tr_b16 v[24:25], v4 offset:16384
  ds_read_b64_tr_b16 v[26:27], v4 offset:18432
  ds_read_b128 v[28:31], v6 offset:256
  ds_read_b64_tr_b16 v[32:33], v4 offset:20480
  ds_read_b64_tr_b16 v[34:35], v4 offset:22528
  ds_read_b128 v[36:39], v6 offset:320
  ds_read_b64_tr_b16 v[40:41], v4 offset:24576
  ds_read_b64_tr_b16 v[42:43], v4 offset:26624
  ds_read_b128 v[44:47], v6 offset:384
  ds_read_b64_tr_b16 v[48:49], v4 offset:28672
  ds_read_b64_tr_b16 v[50:51], v4 offset:30720
  ds_read_b128 v[52:55], v6 offset:448
  s_waitcnt lgkmcnt(9)
  v_mfma_f32_16x16x32_bf16 v[20:23], v[24:27], v[28:31], v[20:23]
  s_waitcnt lgkmcnt(6)
  v_mfma_f32_16x16x32_bf16 v[20:23], v[32:35], v[36:39], v[20:23]
  s_waitcnt lgkmcnt(3)
  v_mfma_f32_16x16x32_bf16 v[20:23], v[40:43], v[44:47], v[20:23]
  s_waitcnt lgkmcnt(0)
  v_mfma_f32_16x16x32_bf16 v[20:23], v[48:51], v[52:55], v[20:23]
  s_waitcnt vmcnt(20) lgkmcnt(0)
  s_barrier
  ds_read_b64_tr_b16 v[24:25], v4 offset:32768
  ds_read_b64_tr_b16 v[26:27], v4 offset:34816
  ds_read_b128 v[28:31], v6 offset:512
  ds_read_b64_tr_b16 v[32:33], v4 offset:36864
  ds_read_b64_tr_b16 v[34:35], v4 offset:38912
  ds_read_b128 v[36:39], v6 offset:576
  ds_read_b64_tr_b16 v[40:41], v4 offset:40960
  ds_read_b64_tr_b16 v[42:43], v4 offset:43008
  ds_read_b128 v[44:47], v6 offset:640
  ds_read_b64_tr_b16 v[48:49], v4 offset:45056
  ds_read_b64_tr_b16 v[50:51], v4 offset:47104
  ds_read_b128 v[52:55], v6 offset:704
  s_waitcnt lgkmcnt(9)
  v_mfma_f32_16x16x32_bf16 v[20:23], v[24:27], v[28:31], v[20:23]
  s_waitcnt lgkmcnt(6)
  v_mfma_f32_16x16x32_bf16 v[20:23], v[32:35], v[36:39], v[20:23]
  s_waitcnt lgkmcnt(3)
  v_mfma_f32_16x16x32_bf16 v[20:23], v[40:43], v[44:47], v[20:23]
  s_waitcnt lgkmcnt(0)
  v_mfma_f32_16x16x32_bf16 v[20:23], v[48:51], v[52:55], v[20:23]
  s_waitcnt vmcnt(16) lgkmcnt(0)
  s_barrier
  ds_read_b64_tr_b16 v[24:25], v4 offset:49152
  ds_read_b64_tr_b16 v[26:27], v4 offset:51200
  ds_read_b128 v[28:31], v6 offset:768
  ds_read_b64_tr_b16 v[32:33], v4 offset:53248
  ds_read_b64_tr_b16 v[34:35], v4 offset:55296
  ds_read_b128 v[36:39], v6 offset:832
  ds_read_b64_tr_b16 v[40:41], v4 offset:57344
  ds_read_b64_tr_b16 v[42:43], v4 offset:59392
  ds_read_b128 v[44:47], v6 offset:896
  ds_read_b64_tr_b16 v[48:49], v4 offset:61440
  ds_read_b64_tr_b16 v[50:51], v4 offset:63488
  ds_read_b128 v[52:55], v6 offset:960
  s_waitcnt lgkmcnt(9)
  v_mfma_f32_16x16x32_bf16 v[20:23], v[24:27], v[28:31], v[20:23]
  s_waitcnt lgkmcnt(6)
  v_mfma_f32_16x16x32_bf16 v[20:23], v[32:35], v[36:39], v[20:23]
  s_waitcnt lgkmcnt(3)
  v_mfma_f32_16x16x32_bf16 v[20:23], v[40:43], v[44:47], v[20:23]
  s_waitcnt lgkmcnt(0)
  v_mfma_f32_16x16x32_bf16 v[20:23], v[48:51], v[52:55], v[20:23]
  s_waitcnt vmcnt(12) lgkmcnt(0)
  s_barrier
  ds_read_b64_tr_b16 v[24:25], v5 offset:0
  ds_read_b64_tr_b16 v[26:27], v5 offset:2048
  ds_read_b128 v[28:31], v6 offset:1024
  ds_read_b64_tr_b16 v[32:33], v5 offset:4096
  ds_read_b64_tr_b16 v[34:35], v5 offset:6144
  ds_read_b128 v[36:39], v6 offset:1088
  ds_read_b64_tr_b16 v[40:41], v5 offset:8192
  ds_read_b64_tr_b16 v[42:43], v5 offset:10240
  ds_read_b128 v[44:47], v6 offset:1152
  ds_read_b64_tr_b16 v[48:49], v5 offset:12288
  ds_read_b64_tr_b16 v[50:51], v5 offset:14336
  ds_read_b128 v[52:55], v6 offset:1216
  s_waitcnt lgkmcnt(9)
  v_mfma_f32_16x16x32_bf16 v[20:23], v[24:27], v[28:31], v[20:23]
  s_waitcnt lgkmcnt(6)
  v_mfma_f32_16x16x32_bf16 v[20:23], v[32:35], v[36:39], v[20:23]
  s_waitcnt lgkmcnt(3)
  v_mfma_f32_16x16x32_bf16 v[20:23], v[40:43], v[44:47], v[20:23]
  s_waitcnt lgkmcnt(0)
  v_mfma_f32_16x16x32_bf16 v[20:23], v[48:51], v[52:55], v[20:23]
  s_waitcnt vmcnt(8) lgkmcnt(0)
  s_barrier
  ds_read_b64_tr_b16 v[24:25], v5 offset:16384
  ds_read_b64_tr_b16 v[26:27], v5 offset:18432
  ds_read_b128 v[28:31], v6 offset:1280
  ds_read_b64_tr_b16 v[32:33], v5 offset:20480
  ds_read_b64_tr_b16 v[34:35], v5 offset:22528
  ds_read_b128 v[36:39], v6 offset:1344
  ds_read_b64_tr_b16 v[40:41], v5 offset:24576
  ds_read_b64_tr_b16 v[42:43], v5 offset:26624
  ds_read_b128 v[44:47], v6 offset:1408
  ds_read_b64_tr_b16 v[48:49], v5 offset:28672
  ds_read_b64_tr_b16 v[50:51], v5 offset:30720
  ds_read_b128 v[52:55], v6 offset:1472
  s_waitcnt lgkmcnt(9)
  v_mfma_f32_16x16x32_bf16 v[20:23], v[24:27], v[28:31], v[20:23]
  s_waitcnt lgkmcnt(6)
  v_mfma_f32_16x16x32_bf16 v[20:23], v[32:35], v[36:39], v[20:23]
  s_waitcnt lgkmcnt(3)
  v_mfma_f32_16x16x32_bf16 v[20:23], v[40:43], v[44:47], v[20:23]
  s_waitcnt lgkmcnt(0)
  v_mfma_f32_16x16x32_bf16 v[20:23], v[48:51], v[52:55], v[20:23]
  s_waitcnt vmcnt(4) lgkmcnt(0)
  s_barrier
  ds_read_b64_tr_b16 v[24:25], v5 offset:32768
  ds_read_b64_tr_b16 v[26:27], v5 offset:34816
  ds_read_b128 v[28:31], v6 offset:1536
  ds_read_b64_tr_b16 v[32:33], v5 offset:36864
  ds_read_b64_tr_b16 v[34:35], v5 offset:38912
  ds_read_b128 v[36:39], v6 offset:1600
  ds_read_b64_tr_b16 v[40:41], v5 offset:40960
  ds_read_b64_tr_b16 v[42:43], v5 offset:43008
  ds_read_b128 v[44:47], v6 offset:1664
  ds_read_b64_tr_b16 v[48:49], v5 offset:45056
  ds_read_b64_tr_b16 v[50:51], v5 offset:47104
  ds_read_b128 v[52:55], v6 offset:1728
  s_waitcnt lgkmcnt(9)
  v_mfma_f32_16x16x32_bf16 v[20:23], v[24:27], v[28:31], v[20:23]
  s_waitcnt lgkmcnt(6)
  v_mfma_f32_16x16x32_bf16 v[20:23], v[32:35], v[36:39], v[20:23]
  s_waitcnt lgkmcnt(3)
  v_mfma_f32_16x16x32_bf16 v[20:23], v[40:43], v[44:47], v[20:23]
  s_waitcnt lgkmcnt(0)
  v_mfma_f32_16x16x32_bf16 v[20:23], v[48:51], v[52:55], v[20:23]
  s_waitcnt vmcnt(0) lgkmcnt(0)
  s_barrier
  ds_read_b64_tr_b16 v[24:25], v5 offset:49152
  ds_read_b64_tr_b16 v[26:27], v5 offset:51200
  ds_read_b128 v[28:31], v6 offset:1792
  ds_read_b64_tr_b16 v[32:33], v5 offset:53248
  ds_read_b64_tr_b16 v[34:35], v5 offset:55296
  ds_read_b128 v[36:39], v6 offset:1856
  ds_read_b64_tr_b16 v[40:41], v5 offset:57344
  ds_read_b64_tr_b16 v[42:43], v5 offset:59392
  ds_read_b128 v[44:47], v6 offset:1920
  ds_read_b64_tr_b16 v[48:49], v5 offset:61440
  ds_read_b64_tr_b16 v[50:51], v5 offset:63488
  ds_read_b128 v[52:55], v6 offset:1984
  s_waitcnt lgkmcnt(9)
  v_mfma_f32_16x16x32_bf16 v[20:23], v[24:27], v[28:31], v[20:23]
  s_waitcnt lgkmcnt(6)
  v_mfma_f32_16x16x32_bf16 v[20:23], v[32:35], v[36:39], v[20:23]
  s_waitcnt lgkmcnt(3)
  v_mfma_f32_16x16x32_bf16 v[20:23], v[40:43], v[44:47], v[20:23]
  s_waitcnt lgkmcnt(0)
  v_mfma_f32_16x16x32_bf16 v[20:23], v[48:51], v[52:55], v[20:23]
  s_lshl_b32 s40, s21, 8
  s_lshl_b32 s41, s20, 6
  s_add_u32 s40, s40, s41
  s_add_u32 s40, s40, 1572864
  v_and_b32 v2, 15, v0
  v_cmp_eq_u32 vcc, 0, v2
  v_mov_b32 v3, 2147483392
  s_nop 0
  v_cndmask_b32 v1, v3, v0, vcc
  v_cvt_pk_bf16_f32 v8, v20, v21
  v_cvt_pk_bf16_f32 v9, v22, v23
  v_lshlrev_b32 v20, 16, v8
  v_and_b32 v21, 0xffff0000, v8
  v_lshlrev_b32 v22, 16, v9
  v_and_b32 v23, 0xffff0000, v9
  buffer_store_dwordx4 v[20:23], v1, s[4:7], s40 offen sc1
  v_min_u32 v2, 31, v0
  v_lshlrev_b32 v2, 2, v2
  v_add_u32 v2, 128, v2
  s_nop 1
Lpoll_1:
  buffer_load_dword v3, v2, s[12:15], 0 offen sc1
  s_sub_u32 s24, s24, 1
  s_cbranch_scc1 L_FAIL
  s_waitcnt vmcnt(0)
  v_cmp_gt_i32 vcc, 1, v3
  s_cbranch_vccz Lpolld_2
  s_sleep 2
  s_branch Lpoll_1
Lpolld_2:
  s_lshl_b32 s40, s21, 7
  s_add_u32 s40, s40, 1376256
  v_mov_b32 v2, 2147483392
  s_mov_b64 exec, 1
  v_mov_b32 v2, s40
  s_mov_b64 exec, -1
  v_mov_b32 v3, 1
  s_barrier
  s_cmp_lg_u32 s20, 0
  s_cbranch_scc1 L_MOD_done
  buffer_store_dword v3, v2, s[4:7], 0 offen sc1
L_MOD_done:
  s_cmp_ge_u32 s21, 32
  s_cbranch_scc1 L_MOD_back
L_LN1:
  s_load_dwordx2 s[16:17], s[0:1], 0
  s_mov_b32 s18, 4194304
  s_mov_b32 s19, 0x20000
  s_waitcnt lgkmcnt(0)
  s_sub_u32 s43, 7, s22
  s_lshl_b32 s43, s43, 5
  s_add_u32 s43, s43, s23
  s_lshl_b32 s43, s43, 2
  s_add_u32 s43, s43, s20
  s_lshl_b32 s44, s43, 13
  s_add_u32 s45, s44, 4096
  v_lshlrev_b32 v1, 3, v0
  v_lshlrev_b32 v2, 4, v0
  buffer_load_dwordx2 v[8:9], v1, s[16:19], s44 offen offset:0 nt
  buffer_load_dwordx2 v[10:11], v1, s[16:19], s44 offen offset:512 nt
  buffer_load_dwordx2 v[12:13], v1, s[16:19], s44 offen offset:1024 nt
  buffer_load_dwordx2 v[14:15], v1, s[16:19], s44 offen offset:1536 nt
  buffer_load_dwordx2 v[16:17], v1, s[16:19], s44 offen offset:2048 nt
  buffer_load_dwordx2 v[18:19], v1, s[16:19], s44 offen offset:2560 nt
  buffer_load_dwordx2 v[20:21], v1, s[16:19], s44 offen offset:3072 nt
  buffer_load_dwordx2 v[22:23], v1, s[16:19], s44 offen offset:3584 nt
  buffer_load_dwordx2 v[24:25], v1, s[16:19], s45 offen offset:0 nt
  buffer_load_dwordx2 v[26:27], v1, s[16:19], s45 offen offset:512 nt
  buffer_load_dwordx2 v[28:29], v1, s[16:19], s45 offen offset:1024 nt
  buffer_load_dwordx2 v[30:31], v1, s[16:19], s45 offen offset:1536 nt
  buffer_load_dwordx2 v[32:33], v1, s[16:19], s45 offen offset:2048 nt
  buffer_load_dwordx2 v[34:35], v1, s[16:19], s45 offen offset:2560 nt
  buffer_load_dwordx2 v[36:37], v1, s[16:19], s45 offen offset:3072 nt
  buffer_load_dwordx2 v[38:39], v1, s[16:19], s45 offen offset:3584 nt
  s_waitcnt vmcnt(0)
  v_lshlrev_b32 v40, 16, v8
  v_and_b32 v41, 0xffff0000, v8
  v_lshlrev_b32 v42, 16, v9
  v_and_b32 v43, 0xffff0000, v9
  v_lshlrev_b32 v44, 16, v10
  v_and_b32 v45, 0xffff0000, v10
  v_lshlrev_b32 v46, 16, v11
  v_and_b32 v47, 0xffff0000, v11
  v_lshlrev_b32 v48, 16, v12
  v_and_b32 v49, 0xffff0000, v12
  v_lshlrev_b32 v50, 16, v13
  v_and_b32 v51, 0xffff0000, v13
  v_lshlrev_b32 v52, 16, v14
  v_and_b32 v53, 0xffff0000, v14
  v_lshlrev_b32 v54, 16, v15
  v_and_b32 v55, 0xffff0000, v15
  v_lshlrev_b32 v56, 16, v16
  v_and_b32 v57, 0xffff0000, v16
  v_lshlrev_b32 v58, 16, v17
  v_and_b32 v59, 0xffff0000, v17
  v_lshlrev_b32 v60, 16, v18
  v_and_b32 v61, 0xffff0000, v18
  v_lshlrev_b32 v62, 16, v19
  v_and_b32 v63, 0xffff0000, v19
  v_lshlrev_b32 v64, 16, v20
  v_and_b32 v65, 0xffff0000, v20
  v_lshlrev_b32 v66, 16, v21
  v_and_b32 v67, 0xffff0000, v21
  v_lshlrev_b32 v68, 16, v22
  v_and_b32 v69, 0xffff0000, v22
  v_lshlrev_b32 v70, 16, v23
  v_and_b32 v71, 0xffff0000, v23
  v_lshlrev_b32 v72, 16, v24
  v_and_b32 v73, 0xffff0000, v24
  v_lshlrev_b32 v74, 16, v25
  v_and_b32 v75, 0xffff0000, v25
  v_lshlrev_b32 v76, 16, v26
  v_and_b32 v77, 0xffff0000, v26
  v_lshlrev_b32 v78, 16, v27
  v_and_b32 v79, 0xffff0000, v27
  v_lshlrev_b32 v80, 16, v28
  v_and_b32 v81, 0xffff0000, v28
  v_lshlrev_b32 v82, 16, v29
  v_and_b32 v83, 0xffff0000, v29
  v_lshlrev_b32 v84, 16, v30
  v_and_b32 v85, 0xffff0000, v30
  v_lshlrev_b32 v86, 16, v31
  v_and_b32 v87, 0xffff0000, v31
  v_lshlrev_b32 v88, 16, v32
  v_and_b32 v89, 0xffff0000, v32
  v_lshlrev_b32 v90, 16, v33
  v_and_b32 v91, 0xffff0000, v33
  v_lshlrev_b32 v92, 16, v34
  v_and_b32 v93, 0xffff0000, v34
  v_lshlrev_b32 v94, 16, v35
  v_and_b32 v95, 0xffff0000, v35
  v_lshlrev_b32 v96, 16, v36
  v_and_b32 v97, 0xffff0000, v36
  v_lshlrev_b32 v98, 16, v37
  v_and_b32 v99, 0xffff0000, v37
  v_lshlrev_b32 v100, 16, v38
  v_and_b32 v101, 0xffff0000, v38
  v_lshlrev_b32 v102, 16, v39
  v_and_b32 v103, 0xffff0000, v39
  v_pk_add_f32 v[104:105], v[40:41], v[42:43]
  v_pk_add_f32 v[108:109], v[56:57], v[58:59]
  v_pk_add_f32 v[112:113], v[72:73], v[74:75]
  v_pk_add_f32 v[116:117], v[88:89], v[90:91]
  v_pk_add_f32 v[104:105], v[104:105], v[44:45]
  v_pk_add_f32 v[108:109], v[108:109], v[60:61]
  v_pk_add_f32 v[112:113], v[112:113], v[76:77]
  v_pk_add_f32 v[116:117], v[116:117], v[92:93]
  v_pk_add_f32 v[104:105], v[104:105], v[46:47]
  v_pk_add_f32 v[108:109], v[108:109], v[62:63]
  v_pk_add_f32 v[112:113], v[112:113], v[78:79]
  v_pk_add_f32 v[116:117], v[116:117], v[94:95]
  v_pk_add_f32 v[104:105], v[104:105], v[48:49]
  v_pk_add_f32 v[108:109], v[108:109], v[64:65]
  v_pk_add_f32 v[112:113], v[112:113], v[80:81]
  v_pk_add_f32 v[116:117], v[116:117], v[96:97]
  v_pk_add_f32 v[104:105], v[104:105], v[50:51]
  v_pk_add_f32 v[108:109], v[108:109], v[66:67]
  v_pk_add_f32 v[112:113], v[112:113], v[82:83]
  v_pk_add_f32 v[116:117], v[116:117], v[98:99]
  v_pk_add_f32 v[104:105], v[104:105], v[52:53]
  v_pk_add_f32 v[108:109], v[108:109], v[68:69]
  v_pk_add_f32 v[112:113], v[112:113], v[84:85]
  v_pk_add_f32 v[116:117], v[116:117], v[100:101]
  v_pk_add_f32 v[104:105], v[104:105], v[54:55]
  v_pk_add_f32 v[108:109], v[108:109], v[70:71]
  v_pk_add_f32 v[112:113], v[112:113], v[86:87]
  v_pk_add_f32 v[116:117], v[116:117], v[102:103]
  v_add_f32 v104, v104, v105
  v_add_f32 v108, v108, v109
  v_add_f32 v112, v112, v113
  v_add_f32 v116, v116, v117
  v_add_f32_dpp v104, v104, v104 row_ror:8 row_mask:0xf bank_mask:0xf
  v_add_f32_dpp v108, v108, v108 row_ror:8 row_mask:0xf bank_mask:0xf
  v_add_f32_dpp v112, v112, v112 row_ror:8 row_mask:0xf bank_mask:0xf
  v_add_f32_dpp v116, v116, v116 row_ror:8 row_mask:0xf bank_mask:0xf
  v_add_f32_dpp v104, v104, v104 row_ror:4 row_mask:0xf bank_mask:0xf
  v_add_f32_dpp v108, v108, v108 row_ror:4 row_mask:0xf bank_mask:0xf
  v_add_f32_dpp v112, v112, v112 row_ror:4 row_mask:0xf bank_mask:0xf
  v_add_f32_dpp v116, v116, v116 row_ror:4 row_mask:0xf bank_mask:0xf
  v_add_f32_dpp v104, v104, v104 row_ror:2 row_mask:0xf bank_mask:0xf
  v_add_f32_dpp v108, v108, v108 row_ror:2 row_mask:0xf bank_mask:0xf
  v_add_f32_dpp v112, v112, v112 row_ror:2 row_mask:0xf bank_mask:0xf
  v_add_f32_dpp v116, v116, v116 row_ror:2 row_mask:0xf bank_mask:0xf
  v_add_f32_dpp v104, v104, v104 row_ror:1 row_mask:0xf bank_mask:0xf
  v_add_f32_dpp v108, v108, v108 row_ror:1 row_mask:0xf bank_mask:0xf
  v_add_f32_dpp v112, v112, v112 row_ror:1 row_mask:0xf bank_mask:0xf
  v_add_f32_dpp v116, v116, v116 row_ror:1 row_mask:0xf bank_mask:0xf
  v_mov_b32 v105, v104
  v_mov_b32 v109, v108
  v_mov_b32 v113, v112
  v_mov_b32 v117, v116
  v_permlane16_swap_b32 v105, v104
  v_permlane16_swap_b32 v109, v108
  v_permlane16_swap_b32 v113, v112
  v_permlane16_swap_b32 v117, v116
  v_add_f32 v104, v104, v105
  v_add_f32 v108, v108, v109
  v_add_f32 v112, v112, v113
  v_add_f32 v116, v116, v117
  v_mov_b32 v105, v104
  v_mov_b32 v109, v108
  v_mov_b32 v113, v112
  v_mov_b32 v117, v116
  v_permlane32_swap_b32 v105, v104
  v_permlane32_swap_b32 v109, v108
  v_permlane32_swap_b32 v113, v112
  v_permlane32_swap_b32 v117, v116
  v_add_f32 v104, v104, v105
  v_add_f32 v108, v108, v109
  v_add_f32 v112, v112, v113
  v_add_f32 v116, v116, v117
  v_mul_f32 v104, 0xba800000, v104
  v_mul_f32 v108, 0xba800000, v108
  v_mul_f32 v112, 0xba800000, v112
  v_mul_f32 v116, 0xba800000, v116
  v_pk_add_f32 v[40:41], v[40:41], v[104:105] op_sel_hi:[1,0]
  v_pk_add_f32 v[56:57], v[56:57], v[108:109] op_sel_hi:[1,0]
  v_pk_add_f32 v[72:73], v[72:73], v[112:113] op_sel_hi:[1,0]
  v_pk_add_f32 v[88:89], v[88:89], v[116:117] op_sel_hi:[1,0]
  v_pk_add_f32 v[42:43], v[42:43], v[104:105] op_sel_hi:[1,0]
  v_pk_add_f32 v[58:59], v[58:59], v[108:109] op_sel_hi:[1,0]
  v_pk_add_f32 v[74:75], v[74:75], v[112:113] op_sel_hi:[1,0]
  v_pk_add_f32 v[90:91], v[90:91], v[116:117] op_sel_hi:[1,0]
  v_pk_add_f32 v[44:45], v[44:45], v[104:105] op_sel_hi:[1,0]
  v_pk_add_f32 v[60:61], v[60:61], v[108:109] op_sel_hi:[1,0]
  v_pk_add_f32 v[76:77], v[76:77], v[112:113] op_sel_hi:[1,0]
  v_pk_add_f32 v[92:93], v[92:93], v[116:117] op_sel_hi:[1,0]
  v_pk_add_f32 v[46:47], v[46:47], v[104:105] op_sel_hi:[1,0]
  v_pk_add_f32 v[62:63], v[62:63], v[108:109] op_sel_hi:[1,0]
  v_pk_add_f32 v[78:79], v[78:79], v[112:113] op_sel_hi:[1,0]
  v_pk_add_f32 v[94:95], v[94:95], v[116:117] op_sel_hi:[1,0]
  v_pk_add_f32 v[48:49], v[48:49], v[104:105] op_sel_hi:[1,0]
  v_pk_add_f32 v[64:65], v[64:65], v[108:109] op_sel_hi:[1,0]
  v_pk_add_f32 v[80:81], v[80:81], v[112:113] op_sel_hi:[1,0]
  v_pk_add_f32 v[96:97], v[96:97], v[116:117] op_sel_hi:[1,0]
  v_pk_add_f32 v[50:51], v[50:51], v[104:105] op_sel_hi:[1,0]
  v_pk_add_f32 v[66:67], v[66:67], v[108:109] op_sel_hi:[1,0]
  v_pk_add_f32 v[82:83], v[82:83], v[112:113] op_sel_hi:[1,0]
  v_pk_add_f32 v[98:99], v[98:99], v[116:117] op_sel_hi:[1,0]
  v_pk_add_f32 v[52:53], v[52:53], v[104:105] op_sel_hi:[1,0]
  v_pk_add_f32 v[68:69], v[68:69], v[108:109] op_sel_hi:[1,0]
  v_pk_add_f32 v[84:85], v[84:85], v[112:113] op_sel_hi:[1,0]
  v_pk_add_f32 v[100:101], v[100:101], v[116:117] op_sel_hi:[1,0]
  v_pk_add_f32 v[54:55], v[54:55], v[104:105] op_sel_hi:[1,0]
  v_pk_add_f32 v[70:71], v[70:71], v[108:109] op_sel_hi:[1,0]
  v_pk_add_f32 v[86:87], v[86:87], v[112:113] op_sel_hi:[1,0]
  v_pk_add_f32 v[102:103], v[102:103], v[116:117] op_sel_hi:[1,0]
  v_pk_mul_f32 v[104:105], v[40:41], v[40:41]
  v_pk_mul_f32 v[108:109], v[56:57], v[56:57]
  v_pk_mul_f32 v[112:113], v[72:73], v[72:73]
  v_pk_mul_f32 v[116:117], v[88:89], v[88:89]
  v_pk_fma_f32 v[104:105], v[42:43], v[42:43], v[104:105]
  v_pk_fma_f32 v[108:109], v[58:59], v[58:59], v[108:109]
  v_pk_fma_f32 v[112:113], v[74:75], v[74:75], v[112:113]
  v_pk_fma_f32 v[116:117], v[90:91], v[90:91], v[116:117]
  v_pk_fma_f32 v[104:105], v[44:45], v[44:45], v[104:105]
  v_pk_fma_f32 v[108:109], v[60:61], v[60:61], v[108:109]
  v_pk_fma_f32 v[112:113], v[76:77], v[76:77], v[112:113]
  v_pk_fma_f32 v[116:117], v[92:93], v[92:93], v[116:117]
  v_pk_fma_f32 v[104:105], v[46:47], v[46:47], v[104:105]
  v_pk_fma_f32 v[108:109], v[62:63], v[62:63], v[108:109]
  v_pk_fma_f32 v[112:113], v[78:79], v[78:79], v[112:113]
  v_pk_fma_f32 v[116:117], v[94:95], v[94:95], v[116:117]
  v_pk_fma_f32 v[104:105], v[48:49], v[48:49], v[104:105]
  v_pk_fma_f32 v[108:109], v[64:65], v[64:65], v[108:109]
  v_pk_fma_f32 v[112:113], v[80:81], v[80:81], v[112:113]
  v_pk_fma_f32 v[116:117], v[96:97], v[96:97], v[116:117]
  v_pk_fma_f32 v[104:105], v[50:51], v[50:51], v[104:105]
  v_pk_fma_f32 v[108:109], v[66:67], v[66:67], v[108:109]
  v_pk_fma_f32 v[112:113], v[82:83], v[82:83], v[112:113]
  v_pk_fma_f32 v[116:117], v[98:99], v[98:99], v[116:117]
  v_pk_fma_f32 v[104:105], v[52:53], v[52:53], v[104:105]
  v_pk_fma_f32 v[108:109], v[68:69], v[68:69], v[108:109]
  v_pk_fma_f32 v[112:113], v[84:85], v[84:85], v[112:113]
  v_pk_fma_f32 v[116:117], v[100:101], v[100:101], v[116:117]
  v_pk_fma_f32 v[104:105], v[54:55], v[54:55], v[104:105]
  v_pk_fma_f32 v[108:109], v[70:71], v[70:71], v[108:109]
  v_pk_fma_f32 v[112:113], v[86:87], v[86:87], v[112:113]
  v_pk_fma_f32 v[116:117], v[102:103], v[102:103], v[116:117]
  v_add_f32 v104, v104, v105
  v_add_f32 v108, v108, v109
  v_add_f32 v112, v112, v113
  v_add_f32 v116, v116, v117
  v_add_f32_dpp v104, v104, v104 row_ror:8 row_mask:0xf bank_mask:0xf
  v_add_f32_dpp v108, v108, v108 row_ror:8 row_mask:0xf bank_mask:0xf
  v_add_f32_dpp v112, v112, v112 row_ror:8 row_mask:0xf bank_mask:0xf
  v_add_f32_dpp v116, v116, v116 row_ror:8 row_mask:0xf bank_mask:0xf
  v_add_f32_dpp v104, v104, v104 row_ror:4 row_mask:0xf bank_mask:0xf
  v_add_f32_dpp v108, v108, v108 row_ror:4 row_mask:0xf bank_mask:0xf
  v_add_f32_dpp v112, v112, v112 row_ror:4 row_mask:0xf bank_mask:0xf
  v_add_f32_dpp v116, v116, v116 row_ror:4 row_mask:0xf bank_mask:0xf
  v_add_f32_dpp v104, v104, v104 row_ror:2 row_mask:0xf bank_mask:0xf
  v_add_f32_dpp v108, v108, v108 row_ror:2 row_mask:0xf bank_mask:0xf
  v_add_f32_dpp v112, v112, v112 row_ror:2 row_mask:0xf bank_mask:0xf
  v_add_f32_dpp v116, v116, v116 row_ror:2 row_mask:0xf bank_mask:0xf
  v_add_f32_dpp v104, v104, v104 row_ror:1 row_mask:0xf bank_mask:0xf
  v_add_f32_dpp v108, v108, v108 row_ror:1 row_mask:0xf bank_mask:0xf
  v_add_f32_dpp v112, v112, v112 row_ror:1 row_mask:0xf bank_mask:0xf
  v_add_f32_dpp v116, v116, v116 row_ror:1 row_mask:0xf bank_mask:0xf
  v_mov_b32 v105, v104
  v_mov_b32 v109, v108
  v_mov_b32 v113, v112
  v_mov_b32 v117, v116
  v_permlane16_swap_b32 v105, v104
  v_permlane16_swap_b32 v109, v108
  v_permlane16_swap_b32 v113, v112
  v_permlane16_swap_b32 v117, v116
  v_add_f32 v104, v104, v105
  v_add_f32 v108, v108, v109
  v_add_f32 v112, v112, v113
  v_add_f32 v116, v116, v117
  v_mov_b32 v105, v104
  v_mov_b32 v109, v108
  v_mov_b32 v113, v112
  v_mov_b32 v117, v116
  v_permlane32_swap_b32 v105, v104
  v_permlane32_swap_b32 v109, v108
  v_permlane32_swap_b32 v113, v112
  v_permlane32_swap_b32 v117, v116
  v_add_f32 v104, v104, v105
  v_add_f32 v108, v108, v109
  v_add_f32 v112, v112, v113
  v_add_f32 v116, v116, v117
  v_mul_f32 v104, 0x3a800000, v104
  v_mul_f32 v108, 0x3a800000, v108
  v_mul_f32 v112, 0x3a800000, v112
  v_mul_f32 v116, 0x3a800000, v116
  v_add_f32 v104, 0x3727c5ac, v104
  v_add_f32 v108, 0x3727c5ac, v108
  v_add_f32 v112, 0x3727c5ac, v112
  v_add_f32 v116, 0x3727c5ac, v116
  v_rsq_f32 v104, v104
  v_rsq_f32 v108, v108
  v_rsq_f32 v112, v112
  v_rsq_f32 v116, v116
  v_pk_mul_f32 v[40:41], v[40:41], v[104:105] op_sel_hi:[1,0]
  v_pk_mul_f32 v[56:57], v[56:57], v[108:109] op_sel_hi:[1,0]
  v_pk_mul_f32 v[72:73], v[72:73], v[112:113] op_sel_hi:[1,0]
  v_pk_mul_f32 v[88:89], v[88:89], v[116:117] op_sel_hi:[1,0]
  v_pk_mul_f32 v[42:43], v[42:43], v[104:105] op_sel_hi:[1,0]
  v_pk_mul_f32 v[58:59], v[58:59], v[108:109] op_sel_hi:[1,0]
  v_pk_mul_f32 v[74:75], v[74:75], v[112:113] op_sel_hi:[1,0]
  v_pk_mul_f32 v[90:91], v[90:91], v[116:117] op_sel_hi:[1,0]
  v_pk_mul_f32 v[44:45], v[44:45], v[104:105] op_sel_hi:[1,0]
  v_pk_mul_f32 v[60:61], v[60:61], v[108:109] op_sel_hi:[1,0]
  v_pk_mul_f32 v[76:77], v[76:77], v[112:113] op_sel_hi:[1,0]
  v_pk_mul_f32 v[92:93], v[92:93], v[116:117] op_sel_hi:[1,0]
  v_pk_mul_f32 v[46:47], v[46:47], v[104:105] op_sel_hi:[1,0]
  v_pk_mul_f32 v[62:63], v[62:63], v[108:109] op_sel_hi:[1,0]
  v_pk_mul_f32 v[78:79], v[78:79], v[112:113] op_sel_hi:[1,0]
  v_pk_mul_f32 v[94:95], v[94:95], v[116:117] op_sel_hi:[1,0]
  v_pk_mul_f32 v[48:49], v[48:49], v[104:105] op_sel_hi:[1,0]
  v_pk_mul_f32 v[64:65], v[64:65], v[108:109] op_sel_hi:[1,0]
  v_pk_mul_f32 v[80:81], v[80:81], v[112:113] op_sel_hi:[1,0]
  v_pk_mul_f32 v[96:97], v[96:97], v[116:117] op_sel_hi:[1,0]
  v_pk_mul_f32 v[50:51], v[50:51], v[104:105] op_sel_hi:[1,0]
  v_pk_mul_f32 v[66:67], v[66:67], v[108:109] op_sel_hi:[1,0]
  v_pk_mul_f32 v[82:83], v[82:83], v[112:113] op_sel_hi:[1,0]
  v_pk_mul_f32 v[98:99], v[98:99], v[116:117] op_sel_hi:[1,0]
  v_pk_mul_f32 v[52:53], v[52:53], v[104:105] op_sel_hi:[1,0]
  v_pk_mul_f32 v[68:69], v[68:69], v[108:109] op_sel_hi:[1,0]
  v_pk_mul_f32 v[84:85], v[84:85], v[112:113] op_sel_hi:[1,0]
  v_pk_mul_f32 v[100:101], v[100:101], v[116:117] op_sel_hi:[1,0]
  v_pk_mul_f32 v[54:55], v[54:55], v[104:105] op_sel_hi:[1,0]
  v_pk_mul_f32 v[70:71], v[70:71], v[108:109] op_sel_hi:[1,0]
  v_pk_mul_f32 v[86:87], v[86:87], v[112:113] op_sel_hi:[1,0]
  v_pk_mul_f32 v[102:103], v[102:103], v[116:117] op_sel_hi:[1,0]
  v_min_u32 v3, 31, v0
  v_lshlrev_b32 v3, 2, v3
  v_add_u32 v3, 128, v3
  s_nop 1
Lpoll_3:
  buffer_load_dword v4, v3, s[12:15], 0 offen sc1
  s_sub_u32 s24, s24, 1
  s_cbranch_scc1 L_FAIL
  s_waitcnt vmcnt(0)
  v_cmp_gt_i32 vcc, 1, v4
  s_cbranch_vccz Lpolld_4
  s_sleep 2
  s_branch Lpoll_3
Lpolld_4:
  v_min_u32 v3, 31, v0
  v_lshlrev_b32 v3, 7, v3
  v_add_u32 v3, 1376256, v3
  s_nop 1
Lpoll_5:
  buffer_load_dword v4, v3, s[4:7], 0 offen sc1
  s_sub_u32 s24, s24, 1
  s_cbranch_scc1 L_FAIL
  s_waitcnt vmcnt(0)
  v_cmp_gt_i32 vcc, 1, v4
  s_cbranch_vccz Lpolld_6
  s_sleep 2
  s_branch Lpoll_5
Lpolld_6:
  s_mov_b32 s40, 1572864
  buffer_load_dwordx4 v[136:139], v2, s[4:7], s40 offen offset:0 sc1
  buffer_load_dwordx4 v[140:143], v2, s[4:7], s40 offen offset:1024 sc1
  buffer_load_dwordx4 v[144:147], v2, s[4:7], s40 offen offset:2048 sc1
  buffer_load_dwordx4 v[148:151], v2, s[4:7], s40 offen offset:3072 sc1
  s_mov_b32 s40, 1576960
  buffer_load_dwordx4 v[120:123], v2, s[4:7], s40 offen offset:0 sc1
  buffer_load_dwordx4 v[124:127], v2, s[4:7], s40 offen offset:1024 sc1
  buffer_load_dwordx4 v[128:131], v2, s[4:7], s40 offen offset:2048 sc1
  buffer_load_dwordx4 v[132:135], v2, s[4:7], s40 offen offset:3072 sc1
  s_waitcnt vmcnt(0)
  v_add_f32 v120, 1.0, v120
  v_add_f32 v121, 1.0, v121
  v_add_f32 v122, 1.0, v122
  v_add_f32 v123, 1.0, v123
  v_add_f32 v124, 1.0, v124
  v_add_f32 v125, 1.0, v125
  v_add_f32 v126, 1.0, v126
  v_add_f32 v127, 1.0, v127
  v_add_f32 v128, 1.0, v128
  v_add_f32 v129, 1.0, v129
  v_add_f32 v130, 1.0, v130
  v_add_f32 v131, 1.0, v131
  v_add_f32 v132, 1.0, v132
  v_add_f32 v133, 1.0, v133
  v_add_f32 v134, 1.0, v134
  v_add_f32 v135, 1.0, v135
  s_add_u32 s44, s44, 6291456
  s_add_u32 s45, s45, 6291456
  v_pk_fma_f32 v[40:41], v[40:41], v[120:121], v[136:137]
  v_pk_fma_f32 v[42:43], v[42:43], v[122:123], v[138:139]
  v_pk_fma_f32 v[44:45], v[44:45], v[124:125], v[140:141]
  v_pk_fma_f32 v[46:47], v[46:47], v[126:127], v[142:143]
  v_pk_fma_f32 v[48:49], v[48:49], v[128:129], v[144:145]
  v_pk_fma_f32 v[50:51], v[50:51], v[130:131], v[146:147]
  v_pk_fma_f32 v[52:53], v[52:53], v[132:133], v[148:149]
  v_pk_fma_f32 v[54:55], v[54:55], v[134:135], v[150:151]
  v_cvt_pk_bf16_f32 v8, v40, v41
  v_cvt_pk_bf16_f32 v9, v42, v43
  v_cvt_pk_bf16_f32 v10, v44, v45
  v_cvt_pk_bf16_f32 v11, v46, v47
  v_cvt_pk_bf16_f32 v12, v48, v49
  v_cvt_pk_bf16_f32 v13, v50, v51
  v_cvt_pk_bf16_f32 v14, v52, v53
  v_cvt_pk_bf16_f32 v15, v54, v55
  buffer_store_dwordx4 v[8:11], v2, s[4:7], s44 offen offset:0 sc1
  buffer_store_dwordx4 v[12:15], v2, s[4:7], s44 offen offset:1024 sc1
  v_pk_fma_f32 v[56:57], v[56:57], v[120:121], v[136:137]
  v_pk_fma_f32 v[58:59], v[58:59], v[122:123], v[138:139]
  v_pk_fma_f32 v[60:61], v[60:61], v[124:125], v[140:141]
  v_pk_fma_f32 v[62:63], v[62:63], v[126:127], v[142:143]
  v_pk_fma_f32 v[64:65], v[64:65], v[128:129], v[144:145]
  v_pk_fma_f32 v[66:67], v[66:67], v[130:131], v[146:147]
  v_pk_fma_f32 v[68:69], v[68:69], v[132:133], v[148:149]
  v_pk_fma_f32 v[70:71], v[70:71], v[134:135], v[150:151]
  v_cvt_pk_bf16_f32 v16, v56, v57
  v_cvt_pk_bf16_f32 v17, v58, v59
  v_cvt_pk_bf16_f32 v18, v60, v61
  v_cvt_pk_bf16_f32 v19, v62, v63
  v_cvt_pk_bf16_f32 v20, v64, v65
  v_cvt_pk_bf16_f32 v21, v66, v67
  v_cvt_pk_bf16_f32 v22, v68, v69
  v_cvt_pk_bf16_f32 v23, v70, v71
  buffer_store_dwordx4 v[16:19], v2, s[4:7], s44 offen offset:2048 sc1
  buffer_store_dwordx4 v[20:23], v2, s[4:7], s44 offen offset:3072 sc1
  v_pk_fma_f32 v[72:73], v[72:73], v[120:121], v[136:137]
  v_pk_fma_f32 v[74:75], v[74:75], v[122:123], v[138:139]
  v_pk_fma_f32 v[76:77], v[76:77], v[124:125], v[140:141]
  v_pk_fma_f32 v[78:79], v[78:79], v[126:127], v[142:143]
  v_pk_fma_f32 v[80:81], v[80:81], v[128:129], v[144:145]
  v_pk_fma_f32 v[82:83], v[82:83], v[130:131], v[146:147]
  v_pk_fma_f32 v[84:85], v[84:85], v[132:133], v[148:149]
  v_pk_fma_f32 v[86:87], v[86:87], v[134:135], v[150:151]
  v_cvt_pk_bf16_f32 v24, v72, v73
  v_cvt_pk_bf16_f32 v25, v74, v75
  v_cvt_pk_bf16_f32 v26, v76, v77
  v_cvt_pk_bf16_f32 v27, v78, v79
  v_cvt_pk_bf16_f32 v28, v80, v81
  v_cvt_pk_bf16_f32 v29, v82, v83
  v_cvt_pk_bf16_f32 v30, v84, v85
  v_cvt_pk_bf16_f32 v31, v86, v87
  buffer_store_dwordx4 v[24:27], v2, s[4:7], s45 offen offset:0 sc1
  buffer_store_dwordx4 v[28:31], v2, s[4:7], s45 offen offset:1024 sc1
  v_pk_fma_f32 v[88:89], v[88:89], v[120:121], v[136:137]
  v_pk_fma_f32 v[90:91], v[90:91], v[122:123], v[138:139]
  v_pk_fma_f32 v[92:93], v[92:93], v[124:125], v[140:141]
  v_pk_fma_f32 v[94:95], v[94:95], v[126:127], v[142:143]
  v_pk_fma_f32 v[96:97], v[96:97], v[128:129], v[144:145]
  v_pk_fma_f32 v[98:99], v[98:99], v[130:131], v[146:147]
  v_pk_fma_f32 v[100:101], v[100:101], v[132:133], v[148:149]
  v_pk_fma_f32 v[102:103], v[102:103], v[134:135], v[150:151]
  v_cvt_pk_bf16_f32 v32, v88, v89
  v_cvt_pk_bf16_f32 v33, v90, v91
  v_cvt_pk_bf16_f32 v34, v92, v93
  v_cvt_pk_bf16_f32 v35, v94, v95
  v_cvt_pk_bf16_f32 v36, v96, v97
  v_cvt_pk_bf16_f32 v37, v98, v99
  v_cvt_pk_bf16_f32 v38, v100, v101
  v_cvt_pk_bf16_f32 v39, v102, v103
  buffer_store_dwordx4 v[32:35], v2, s[4:7], s45 offen offset:2048 sc1
  buffer_store_dwordx4 v[36:39], v2, s[4:7], s45 offen offset:3072 sc1
  s_lshr_b32 s40, s43, 3
  s_lshl_b32 s40, s40, 7
  s_and_b32 s41, s43, 7
  s_lshl_b32 s41, s41, 2
  s_add_u32 s40, s40, s41
  s_add_u32 s40, s40, 1388544
  v_mov_b32 v3, 2147483392
  s_mov_b64 exec, 1
  v_mov_b32 v3, s40
  s_mov_b64 exec, -1
  v_mov_b32 v4, 1
  s_waitcnt vmcnt(0)
  buffer_store_dword v4, v3, s[4:7], 0 offen sc1
  s_cmp_lg_u32 s20, 2
  s_cbranch_scc1 Lnotlb_7
  v_lshlrev_b32 v1, 21, v0
  s_mov_b32 s40, 0x1fff80
  buffer_load_dword v2, v1, s[4:7], s40 offen sc1
  s_add_u32 s40, s40, 134217728
  buffer_load_dword v2, v1, s[4:7], s40 offen sc1
  s_waitcnt vmcnt(0)
Lnotlb_7:
  s_mov_b32 s40, 1404928
  s_cmp_lt_u32 s22, 6
  s_cselect_b32 s40, 1404928, s40
  v_mov_b32 v1, s40
  s_nop 1
Lpoll_8:
  buffer_load_dword v2, v1, s[4:7], 0 offen sc1
  s_sub_u32 s24, s24, 1
  s_cbranch_scc1 L_FAIL
  s_waitcnt vmcnt(0)
  v_cmp_gt_i32 vcc, 0, v2
  s_cbranch_vccz Lpolld_9
  s_sleep 8
  s_branch Lpoll_8
Lpolld_9:
  s_and_b32 s40, s22, 1
  s_add_u32 s40, s40, 1
  s_lshl_b32 s40, s40, 5
  s_add_u32 s21, s40, s23
  s_cmp_lt_u32 s22, 6
  s_cbranch_scc0 L_MOD
L_MOD_back:
L_ROLE:
  s_sub_u32 s21, s3, 128
  s_cmp_lt_u32 s3, 160
  s_cbranch_scc1 L_WO
  s_sub_u32 s21, s3, 160
  s_cmp_lt_u32 s3, 216
  s_cbranch_scc1 L_F1
  s_sub_u32 s21, s3, 216
  s_cmp_lt_u32 s3, 224
  s_cbranch_scc1 L_LN2
  s_sub_u32 s21, s3, 224
  s_cmp_lt_u32 s3, 248
  s_cbranch_scc1 L_F2
  s_sub_u32 s21, s3, 248
  s_branch L_FIN
L_FAIL:
  s_mov_b64 exec, -1
  s_lshl_b32 s40, s2, 8
  s_add_u32 s40, s40, s25
  s_add_u32 s40, s40, 0x70000000
  v_mov_b32 v1, 60
  v_mov_b32 v2, s40
  buffer_store_dword v2, v1, s[12:15], 0 offen
L_END:
  s_endpgm
L_LN2:
  s_load_dwordx2 s[16:17], s[0:1], 0
  s_mov_b32 s18, 4194304
  s_mov_b32 s19, 0x20000
  s_waitcnt lgkmcnt(0)
  s_mov_b32 s25, 0
  s_mov_b32 s29, 1
  s_mov_b32 s26, 0
  s_cmp_eq_u32 s20, 0
  s_cselect_b32 s31, 0, 2147483392
  s_lshl_b32 s40, s21, 8
  s_lshl_b32 s41, s20, 15
  s_add_u32 s40, s40, s41
  v_and_b32 v6, 15, v0
  v_lshl_add_u32 v1, v6, 4, s40
  v_lshrrev_b32 v6, 4, v0
  v_lshl_add_u32 v1, v6, 11, v1
  v_and_b32 v6, 3, v0
  v_lshrrev_b32 v7, 5, v0
  v_lshrrev_b32 v8, 2, v0
  s_lshl_b32 s40, s20, 10
  v_lshl_add_u32 v5, v8, 4, s40
  s_lshl_b32 s40, s21, 13
  s_lshl_b32 s41, s20, 9
  s_add_u32 s40, s40, s41
  v_and_b32 v9, 31, v0
  v_lshl_add_u32 v10, v9, 4, s40
  v_lshl_add_u32 v10, v7, 11, v10
  v_min_u32 v16, 63, v0
  v_lshlrev_b32 v16, 7, v16
  v_add_u32 v16, 1424384, v16
  s_nop 1
Lpoll_10:
  buffer_load_dword v17, v16, s[4:7], 0 offen sc1
  s_sub_u32 s24, s24, 1
  s_cbranch_scc1 L_FAIL
  s_waitcnt vmcnt(0)
  v_cmp_gt_i32 vcc, 0, v17
  s_cbranch_vccz Lpolld_11
  s_sleep 1
  s_branch Lpoll_10
Lpolld_11:
  v_lshrrev_b32 v17, 8, v17
  v_and_b32 v18, 3, v0
  v_lshl_or_b32 v17, v17, 2, v18
  s_nop 1
  v_min_u32_dpp v17, v17, v17 row_ror:8 row_mask:0xf bank_mask:0xf
  s_nop 1
  v_min_u32_dpp v17, v17, v17 row_ror:4 row_mask:0xf bank_mask:0xf
  v_mov_b32 v18, v17
  s_nop 1
  v_permlane16_swap_b32 v18, v17
  v_min_u32 v17, v17, v18
  v_mov_b32 v18, v17
  s_nop 1
  v_permlane32_swap_b32 v18, v17
  v_min_u32 v17, v17, v18
  s_nop 1
  v_min_u32_dpp v17, v17, v17 row_ror:2 row_mask:0xf bank_mask:0xf
  s_nop 1
  v_min_u32_dpp v17, v17, v17 row_ror:1 row_mask:0xf bank_mask:0xf
  s_nop 0
  v_readfirstlane_b32 s27, v17
  s_and_b32 s27, s27, 3
  s_lshl_b32 s27, s27, 13
  s_and_b32 s27, s27, 0x2000
  s_xor_b32 s27, s27, 20979712
  v_min_u32 v2, 63, v0
  v_lshlrev_b32 v2, 7, v2
  v_add_u32 v2, 1380352, v2
  s_nop 1
Lpoll_12:
  buffer_load_dword v3, v2, s[4:7], 0 offen sc1
  s_sub_u32 s24, s24, 1
  s_cbranch_scc1 L_FAIL
  s_waitcnt vmcnt(0)
  v_cmp_gt_i32 vcc, 1, v3
  s_cbranch_vccz Lpolld_13
  s_sleep 2
  s_branch Lpoll_12
Lpolld_13:
  s_mov_b32 s40, 1585152
  buffer_load_dwordx4 v[64:67], v5, s[4:7], s40 offen offset:0 sc1
  buffer_load_dwordx4 v[68:71], v5, s[4:7], s40 offen offset:256 sc1
  buffer_load_dwordx4 v[72:75], v5, s[4:7], s40 offen offset:512 sc1
  buffer_load_dwordx4 v[76:79], v5, s[4:7], s40 offen offset:768 sc1
  s_mov_b32 s40, 1589248
  buffer_load_dwordx4 v[80:83], v5, s[4:7], s40 offen offset:0 sc1
  buffer_load_dwordx4 v[84:87], v5, s[4:7], s40 offen offset:256 sc1
  buffer_load_dwordx4 v[88:91], v5, s[4:7], s40 offen offset:512 sc1
  buffer_load_dwordx4 v[92:95], v5, s[4:7], s40 offen offset:768 sc1
  s_mov_b32 s40, 1581056
  buffer_load_dwordx4 v[48:51], v5, s[4:7], s40 offen offset:0 sc1
  buffer_load_dwordx4 v[52:55], v5, s[4:7], s40 offen offset:256 sc1
  buffer_load_dwordx4 v[56:59], v5, s[4:7], s40 offen offset:512 sc1
  buffer_load_dwordx4 v[60:63], v5, s[4:7], s40 offen offset:768 sc1
  s_waitcnt vmcnt(0)
  v_lshrrev_b32 v48, 16, v48
  v_lshrrev_b32 v50, 16, v50
  v_lshrrev_b32 v52, 16, v52
  v_lshrrev_b32 v54, 16, v54
  v_lshrrev_b32 v56, 16, v56
  v_lshrrev_b32 v58, 16, v58
  v_lshrrev_b32 v60, 16, v60
  v_lshrrev_b32 v62, 16, v62
  v_add_f32 v80, 1.0, v80
  v_add_f32 v81, 1.0, v81
  v_add_f32 v82, 1.0, v82
  v_add_f32 v83, 1.0, v83
  v_add_f32 v84, 1.0, v84
  v_add_f32 v85, 1.0, v85
  v_add_f32 v86, 1.0, v86
  v_add_f32 v87, 1.0, v87
  v_add_f32 v88, 1.0, v88
  v_add_f32 v89, 1.0, v89
  v_add_f32 v90, 1.0, v90
  v_add_f32 v91, 1.0, v91
  v_add_f32 v92, 1.0, v92
  v_add_f32 v93, 1.0, v93
  v_add_f32 v94, 1.0, v94
  v_add_f32 v95, 1.0, v95
  v_min_u32 v2, 31, v0
  v_lshlrev_b32 v2, 7, v2
  v_add_u32 v2, 1409024, v2
  s_lshl_b32 s62, s21, 7
  s_add_u32 s62, s62, 1413120
  s_lshl_b32 s30, s20, 11
  v_lshl_add_u32 v11, v6, 9, s30
  v_lshl_add_u32 v11, v8, 3, v11
  s_lshl_b32 s40, s20, 5
  s_add_u32 s40, s40, 8192
  v_lshl_add_u32 v12, v6, 3, s40
  v_lshlrev_b32 v13, 3, v6
  v_add_u32 v13, 8192, v13
  s_add_u32 m0, s30, 0
  s_add_u32 s40, s26, 0
  buffer_load_dwordx4 v10, s[16:19], s40 offen nt lds
  s_add_u32 m0, s30, 1024
  s_add_u32 s40, s26, 4096
  buffer_load_dwordx4 v10, s[16:19], s40 offen nt lds
  buffer_load_dword v3, v2, s[4:7], s31 offen sc1
  s_waitcnt vmcnt(1)
  ds_read_b64 v[24:25], v11 offset:0
  ds_read_b64 v[26:27], v11 offset:128
  ds_read_b64 v[28:29], v11 offset:256
  ds_read_b64 v[30:31], v11 offset:384
  s_waitcnt lgkmcnt(0)
L_LN2_top:
  v_lshlrev_b32 v96, 16, v24
  v_and_b32 v97, 0xffff0000, v24
  v_lshlrev_b32 v98, 16, v25
  v_and_b32 v99, 0xffff0000, v25
  v_lshlrev_b32 v100, 16, v26
  v_and_b32 v101, 0xffff0000, v26
  v_lshlrev_b32 v102, 16, v27
  v_and_b32 v103, 0xffff0000, v27
  v_lshlrev_b32 v104, 16, v28
  v_and_b32 v105, 0xffff0000, v28
  v_lshlrev_b32 v106, 16, v29
  v_and_b32 v107, 0xffff0000, v29
  v_lshlrev_b32 v108, 16, v30
  v_and_b32 v109, 0xffff0000, v30
  v_lshlrev_b32 v110, 16, v31
  v_and_b32 v111, 0xffff0000, v31
  s_cmp_lg_u32 s20, 0
  s_cbranch_scc1 Lgo_14
  s_waitcnt vmcnt(0)
  v_cmp_gt_i32 vcc, s29, v3
  s_cbranch_vccz Lgo_14
  s_nop 3
Lpoll_15:
  buffer_load_dword v3, v2, s[4:7], 0 offen sc1
  s_sub_u32 s24, s24, 1
  s_cbranch_scc1 L_FAIL
  s_waitcnt vmcnt(0)
  v_cmp_gt_i32 vcc, s29, v3
  s_cbranch_vccz Lpolld_16
  s_sleep 1
  s_branch Lpoll_15
Lpolld_16:
Lgo_14:
  s_barrier
  s_add_u32 s40, s27, 0
  buffer_load_dwordx4 v[112:115], v1, s[4:7], s40 offen sc1
  s_add_u32 s40, s27, 16384
  buffer_load_dwordx4 v[116:119], v1, s[4:7], s40 offen sc1
  s_add_u32 s40, s27, 131072
  buffer_load_dwordx4 v[120:123], v1, s[4:7], s40 offen sc1
  s_add_u32 s40, s27, 147456
  buffer_load_dwordx4 v[124:127], v1, s[4:7], s40 offen sc1
  s_add_u32 s40, s27, 262144
  buffer_load_dwordx4 v[128:131], v1, s[4:7], s40 offen sc1
  s_add_u32 s40, s27, 278528
  buffer_load_dwordx4 v[132:135], v1, s[4:7], s40 offen sc1
  s_add_u32 s40, s27, 393216
  buffer_load_dwordx4 v[136:139], v1, s[4:7], s40 offen sc1
  s_add_u32 s40, s27, 409600
  buffer_load_dwordx4 v[140:143], v1, s[4:7], s40 offen sc1
  s_add_u32 m0, s30, 0
  s_add_u32 s40, s26, 65536
  buffer_load_dwordx4 v10, s[16:19], s40 offen nt lds
  s_add_u32 m0, s30, 1024
  s_add_u32 s40, s26, 69632
  buffer_load_dwordx4 v10, s[16:19], s40 offen nt lds
  s_waitcnt vmcnt(9)
  v_dot2c_f32_bf16 v96, v112, v48
  v_dot2c_f32_bf16 v97, v112, v49
  v_dot2c_f32_bf16 v98, v113, v50
  v_dot2c_f32_bf16 v99, v113, v51
  v_dot2c_f32_bf16 v100, v114, v52
  v_dot2c_f32_bf16 v101, v114, v53
  v_dot2c_f32_bf16 v102, v115, v54
  v_dot2c_f32_bf16 v103, v115, v55
  s_waitcnt vmcnt(8)
  v_dot2c_f32_bf16 v104, v116, v56
  v_dot2c_f32_bf16 v105, v116, v57
  v_dot2c_f32_bf16 v106, v117, v58
  v_dot2c_f32_bf16 v107, v117, v59
  v_dot2c_f32_bf16 v108, v118, v60
  v_dot2c_f32_bf16 v109, v118, v61
  v_dot2c_f32_bf16 v110, v119, v62
  v_dot2c_f32_bf16 v111, v119, v63
  s_waitcnt vmcnt(7)
  v_dot2c_f32_bf16 v96, v120, v48
  v_dot2c_f32_bf16 v97, v120, v49
  v_dot2c_f32_bf16 v98, v121, v50
  v_dot2c_f32_bf16 v99, v121, v51
  v_dot2c_f32_bf16 v100, v122, v52
  v_dot2c_f32_bf16 v101, v122, v53
  v_dot2c_f32_bf16 v102, v123, v54
  v_dot2c_f32_bf16 v103, v123, v55
  s_waitcnt vmcnt(6)
  v_dot2c_f32_bf16 v104, v124, v56
  v_dot2c_f32_bf16 v105, v124, v57
  v_dot2c_f32_bf16 v106, v125, v58
  v_dot2c_f32_bf16 v107, v125, v59
  v_dot2c_f32_bf16 v108, v126, v60
  v_dot2c_f32_bf16 v109, v126, v61
  v_dot2c_f32_bf16 v110, v127, v62
  v_dot2c_f32_bf16 v111, v127, v63
  s_waitcnt vmcnt(5)
  v_dot2c_f32_bf16 v96, v128, v48
  v_dot2c_f32_bf16 v97, v128, v49
  v_dot2c_f32_bf16 v98, v129, v50
  v_dot2c_f32_bf16 v99, v129, v51
  v_dot2c_f32_bf16 v100, v130, v52
  v_dot2c_f32_bf16 v101, v130, v53
  v_dot2c_f32_bf16 v102, v131, v54
  v_dot2c_f32_bf16 v103, v131, v55
  s_waitcnt vmcnt(4)
  v_dot2c_f32_bf16 v104, v132, v56
  v_dot2c_f32_bf16 v105, v132, v57
  v_dot2c_f32_bf16 v106, v133, v58
  v_dot2c_f32_bf16 v107, v133, v59
  v_dot2c_f32_bf16 v108, v134, v60
  v_dot2c_f32_bf16 v109, v134, v61
  v_dot2c_f32_bf16 v110, v135, v62
  v_dot2c_f32_bf16 v111, v135, v63
  s_waitcnt vmcnt(3)
  v_dot2c_f32_bf16 v96, v136, v48
  v_dot2c_f32_bf16 v97, v136, v49
  v_dot2c_f32_bf16 v98, v137, v50
  v_dot2c_f32_bf16 v99, v137, v51
  v_dot2c_f32_bf16 v100, v138, v52
  v_dot2c_f32_bf16 v101, v138, v53
  v_dot2c_f32_bf16 v102, v139, v54
  v_dot2c_f32_bf16 v103, v139, v55
  s_waitcnt vmcnt(2)
  v_dot2c_f32_bf16 v104, v140, v56
  v_dot2c_f32_bf16 v105, v140, v57
  v_dot2c_f32_bf16 v106, v141, v58
  v_dot2c_f32_bf16 v107, v141, v59
  v_dot2c_f32_bf16 v108, v142, v60
  v_dot2c_f32_bf16 v109, v142, v61
  v_dot2c_f32_bf16 v110, v143, v62
  v_dot2c_f32_bf16 v111, v143, v63
  s_nop 2
  v_pk_add_f32 v[32:33], v[96:97], v[98:99]
  v_pk_add_f32 v[32:33], v[32:33], v[100:101]
  v_pk_add_f32 v[32:33], v[32:33], v[102:103]
  v_pk_add_f32 v[32:33], v[32:33], v[104:105]
  v_pk_add_f32 v[32:33], v[32:33], v[106:107]
  v_pk_add_f32 v[32:33], v[32:33], v[108:109]
  v_pk_add_f32 v[32:33], v[32:33], v[110:111]
  v_add_f32 v32, v32, v33
  s_nop 1
  v_add_f32_dpp v32, v32, v32 row_ror:4 row_mask:0xf bank_mask:0xf
  s_nop 1
  v_add_f32_dpp v32, v32, v32 row_ror:8 row_mask:0xf bank_mask:0xf
  v_mov_b32 v33, v32
  s_nop 1
  v_permlane16_swap_b32 v33, v32
  v_add_f32 v32, v32, v33
  v_mov_b32 v33, v32
  s_nop 1
  v_permlane32_swap_b32 v33, v32
  v_add_f32 v32, v32, v33
  v_mul_f32 v32, 0x3b800000, v32
  v_pk_add_f32 v[112:113], v[96:97], v[32:33] op_sel_hi:[1,0] neg_lo:[0,1] neg_hi:[0,1]
  v_pk_add_f32 v[114:115], v[98:99], v[32:33] op_sel_hi:[1,0] neg_lo:[0,1] neg_hi:[0,1]
  v_pk_add_f32 v[116:117], v[100:101], v[32:33] op_sel_hi:[1,0] neg_lo:[0,1] neg_hi:[0,1]
  v_pk_add_f32 v[118:119], v[102:103], v[32:33] op_sel_hi:[1,0] neg_lo:[0,1] neg_hi:[0,1]
  v_pk_add_f32 v[120:121], v[104:105], v[32:33] op_sel_hi:[1,0] neg_lo:[0,1] neg_hi:[0,1]
  v_pk_add_f32 v[122:123], v[106:107], v[32:33] op_sel_hi:[1,0] neg_lo:[0,1] neg_hi:[0,1]
  v_pk_add_f32 v[124:125], v[108:109], v[32:33] op_sel_hi:[1,0] neg_lo:[0,1] neg_hi:[0,1]
  v_pk_add_f32 v[126:127], v[110:111], v[32:33] op_sel_hi:[1,0] neg_lo:[0,1] neg_hi:[0,1]
  v_pk_mul_f32 v[34:35], v[112:113], v[112:113]
  v_pk_fma_f32 v[34:35], v[114:115], v[114:115], v[34:35]
  v_pk_fma_f32 v[34:35], v[116:117], v[116:117], v[34:35]
  v_pk_fma_f32 v[34:35], v[118:119], v[118:119], v[34:35]
  v_pk_fma_f32 v[34:35], v[120:121], v[120:121], v[34:35]
  v_pk_fma_f32 v[34:35], v[122:123], v[122:123], v[34:35]
  v_pk_fma_f32 v[34:35], v[124:125], v[124:125], v[34:35]
  v_pk_fma_f32 v[34:35], v[126:127], v[126:127], v[34:35]
  v_add_f32 v34, v34, v35
  s_nop 1
  v_add_f32_dpp v34, v34, v34 row_ror:4 row_mask:0xf bank_mask:0xf
  s_nop 1
  v_add_f32_dpp v34, v34, v34 row_ror:8 row_mask:0xf bank_mask:0xf
  v_mov_b32 v35, v34
  s_nop 1
  v_permlane16_swap_b32 v35, v34
  v_add_f32 v34, v34, v35
  v_mov_b32 v35, v34
  s_nop 1
  v_permlane32_swap_b32 v35, v34
  v_add_f32 v34, v34, v35
  v_mov_b32 v33, v34
  ds_write_b64 v12, v[32:33]
  v_cvt_pk_bf16_f32 v16, v96, v97
  v_cvt_pk_bf16_f32 v17, v98, v99
  v_cvt_pk_bf16_f32 v18, v100, v101
  v_cvt_pk_bf16_f32 v19, v102, v103
  v_cvt_pk_bf16_f32 v20, v104, v105
  v_cvt_pk_bf16_f32 v21, v106, v107
  v_cvt_pk_bf16_f32 v22, v108, v109
  v_cvt_pk_bf16_f32 v23, v110, v111
  s_waitcnt lgkmcnt(0)
  s_barrier
  ds_read2_b64 v[36:39], v13 offset0:0 offset1:4
  ds_read2_b64 v[40:43], v13 offset0:8 offset1:12
  s_add_u32 s40, s27, 1048576
  buffer_store_dwordx4 v[16:19], v1, s[4:7], s40 offen sc1
  s_add_u32 s40, s27, 1064960
  buffer_store_dwordx4 v[20:23], v1, s[4:7], s40 offen sc1
  s_waitcnt lgkmcnt(0)
  v_pk_add_f32 v[34:35], v[36:37], v[38:39]
  v_pk_add_f32 v[44:45], v[40:41], v[42:43]
  v_pk_add_f32 v[34:35], v[34:35], v[44:45]
  v_mul_f32 v34, 0x3e800000, v34
  v_mul_f32 v35, 0x3b800000, v35
  v_sub_f32 v36, v36, v34
  v_sub_f32 v38, v38, v34
  v_sub_f32 v40, v40, v34
  v_sub_f32 v42, v42, v34
  v_fmac_f32 v35, v36, v36
  v_fmac_f32 v35, v38, v38
  v_fmac_f32 v35, v40, v40
  v_fmac_f32 v35, v42, v42
  v_mul_f32 v35, 0x3e800000, v35
  v_add_f32 v35, 0x3727c5ac, v35
  v_rsq_f32 v44, v35
  v_sub_f32 v32, v32, v34
  v_mul_f32 v32, v32, v44
  v_pk_fma_f32 v[112:113], v[112:113], v[44:45], v[32:33] op_sel_hi:[1,0,0]
  v_pk_fma_f32 v[114:115], v[114:115], v[44:45], v[32:33] op_sel_hi:[1,0,0]
  v_pk_fma_f32 v[116:117], v[116:117], v[44:45], v[32:33] op_sel_hi:[1,0,0]
  v_pk_fma_f32 v[118:119], v[118:119], v[44:45], v[32:33] op_sel_hi:[1,0,0]
  v_pk_fma_f32 v[112:113], v[112:113], v[80:81], v[64:65]
  v_pk_fma_f32 v[114:115], v[114:115], v[82:83], v[66:67]
  v_pk_fma_f32 v[116:117], v[116:117], v[84:85], v[68:69]
  v_pk_fma_f32 v[118:119], v[118:119], v[86:87], v[70:71]
  v_cvt_pk_bf16_f32 v128, v112, v113
  v_cvt_pk_bf16_f32 v129, v114, v115
  v_cvt_pk_bf16_f32 v130, v116, v117
  v_cvt_pk_bf16_f32 v131, v118, v119
  s_add_u32 s40, s27, 917504
  buffer_store_dwordx4 v[128:131], v1, s[4:7], s40 offen sc1
  v_pk_fma_f32 v[120:121], v[120:121], v[44:45], v[32:33] op_sel_hi:[1,0,0]
  v_pk_fma_f32 v[122:123], v[122:123], v[44:45], v[32:33] op_sel_hi:[1,0,0]
  v_pk_fma_f32 v[124:125], v[124:125], v[44:45], v[32:33] op_sel_hi:[1,0,0]
  v_pk_fma_f32 v[126:127], v[126:127], v[44:45], v[32:33] op_sel_hi:[1,0,0]
  v_pk_fma_f32 v[120:121], v[120:121], v[88:89], v[72:73]
  v_pk_fma_f32 v[122:123], v[122:123], v[90:91], v[74:75]
  v_pk_fma_f32 v[124:125], v[124:125], v[92:93], v[76:77]
  v_pk_fma_f32 v[126:127], v[126:127], v[94:95], v[78:79]
  v_cvt_pk_bf16_f32 v132, v120, v121
  v_cvt_pk_bf16_f32 v133, v122, v123
  v_cvt_pk_bf16_f32 v134, v124, v125
  v_cvt_pk_bf16_f32 v135, v126, v127
  s_add_u32 s40, s27, 933888
  buffer_store_dwordx4 v[132:135], v1, s[4:7], s40 offen sc1
  buffer_load_dword v3, v2, s[4:7], s31 offen sc1
  s_waitcnt vmcnt(5)
  ds_read_b64 v[24:25], v11 offset:0
  ds_read_b64 v[26:27], v11 offset:128
  ds_read_b64 v[28:29], v11 offset:256
  ds_read_b64 v[30:31], v11 offset:384
  s_waitcnt vmcnt(1) lgkmcnt(0)
  s_barrier
  s_cmp_lg_u32 s20, 0
  s_cbranch_scc1 Lnosig_17
  s_mov_b32 s63, s29
  s_atomic_smax s63, s[4:5], s62 glc
Lnosig_17:
  s_add_u32 s25, s25, 1
  s_add_u32 s29, s29, 1
  s_add_u32 s26, s26, 65536
  s_add_u32 s27, s27, 2097152
  s_xor_b32 s27, s27, 0x2000
  s_cmp_lt_u32 s25, 64
  s_cbranch_scc1 L_LN2_top
  s_branch L_END
L_FIN:
  s_load_dwordx2 s[16:17], s[0:1], 104
  s_mov_b32 s18, 4194304
  s_mov_b32 s19, 0x20000
  s_waitcnt lgkmcnt(0)
  s_mov_b32 s25, 0
  s_mov_b32 s29, 1
  s_mov_b32 s26, 0
  s_cmp_eq_u32 s20, 0
  s_cselect_b32 s31, 0, 2147483392
  s_lshl_b32 s40, s21, 8
  s_lshl_b32 s41, s20, 15
  s_add_u32 s40, s40, s41
  v_and_b32 v6, 15, v0
  v_lshl_add_u32 v1, v6, 4, s40
  v_lshrrev_b32 v6, 4, v0
  v_lshl_add_u32 v1, v6, 11, v1
  v_and_b32 v6, 3, v0
  v_lshrrev_b32 v7, 5, v0
  v_lshrrev_b32 v8, 2, v0
  s_lshl_b32 s40, s20, 10
  v_lshl_add_u32 v5, v8, 4, s40
  s_lshl_b32 s40, s21, 13
  s_lshl_b32 s41, s20, 9
  s_add_u32 s40, s40, s41
  v_and_b32 v9, 31, v0
  v_lshl_add_u32 v10, v9, 4, s40
  v_lshl_add_u32 v10, v7, 11, v10
  v_min_u32 v16, 63, v0
  v_lshlrev_b32 v16, 7, v16
  v_add_u32 v16, 1424384, v16
  s_nop 1
Lpoll_18:
  buffer_load_dword v17, v16, s[4:7], 0 offen sc1
  s_sub_u32 s24, s24, 1
  s_cbranch_scc1 L_FAIL
  s_waitcnt vmcnt(0)
  v_cmp_gt_i32 vcc, 0, v17
  s_cbranch_vccz Lpolld_19
  s_sleep 1
  s_branch Lpoll_18
Lpolld_19:
  v_lshrrev_b32 v17, 8, v17
  v_and_b32 v18, 3, v0
  v_lshl_or_b32 v17, v17, 2, v18
  s_nop 1
  v_min_u32_dpp v17, v17, v17 row_ror:8 row_mask:0xf bank_mask:0xf
  s_nop 1
  v_min_u32_dpp v17, v17, v17 row_ror:4 row_mask:0xf bank_mask:0xf
  v_mov_b32 v18, v17
  s_nop 1
  v_permlane16_swap_b32 v18, v17
  v_min_u32 v17, v17, v18
  v_mov_b32 v18, v17
  s_nop 1
  v_permlane32_swap_b32 v18, v17
  v_min_u32 v17, v17, v18
  s_nop 1
  v_min_u32_dpp v17, v17, v17 row_ror:2 row_mask:0xf bank_mask:0xf
  s_nop 1
  v_min_u32_dpp v17, v17, v17 row_ror:1 row_mask:0xf bank_mask:0xf
  s_nop 0
  v_readfirstlane_b32 s27, v17
  s_and_b32 s27, s27, 3
  s_lshl_b32 s27, s27, 13
  s_and_b32 s27, s27, 0x2000
  s_xor_b32 s27, s27, 20979712
  v_min_u32 v2, 63, v0
  v_lshlrev_b32 v2, 7, v2
  v_add_u32 v2, 1380352, v2
  s_nop 1
Lpoll_20:
  buffer_load_dword v3, v2, s[4:7], 0 offen sc1
  s_sub_u32 s24, s24, 1
  s_cbranch_scc1 L_FAIL
  s_waitcnt vmcnt(0)
  v_cmp_gt_i32 vcc, 1, v3
  s_cbranch_vccz Lpolld_21
  s_sleep 2
  s_branch Lpoll_20
Lpolld_21:
  s_mov_b32 s40, 1593344
  buffer_load_dwordx4 v[48:51], v5, s[4:7], s40 offen offset:0 sc1
  buffer_load_dwordx4 v[52:55], v5, s[4:7], s40 offen offset:256 sc1
  buffer_load_dwordx4 v[56:59], v5, s[4:7], s40 offen offset:512 sc1
  buffer_load_dwordx4 v[60:63], v5, s[4:7], s40 offen offset:768 sc1
  s_waitcnt vmcnt(0)
  v_lshrrev_b32 v48, 16, v48
  v_lshrrev_b32 v50, 16, v50
  v_lshrrev_b32 v52, 16, v52
  v_lshrrev_b32 v54, 16, v54
  v_lshrrev_b32 v56, 16, v56
  v_lshrrev_b32 v58, 16, v58
  v_lshrrev_b32 v60, 16, v60
  v_lshrrev_b32 v62, 16, v62
  v_min_u32 v2, 23, v0
  v_lshlrev_b32 v2, 7, v2
  v_add_u32 v2, 1421312, v2
  s_mul_i32 s30, s20, 2176
  v_mul_u32_u24 v11, 544, v6
  v_lshl_add_u32 v11, v8, 3, v11
  v_add_u32 v11, s30, v11
  v_mul_u32_u24 v12, 544, v7
  v_lshl_add_u32 v12, v9, 4, v12
  v_add_u32 v12, s30, v12
  buffer_load_dword v3, v2, s[4:7], s31 offen sc1
  s_nop 0
L_FIN_top:
  s_cmp_lg_u32 s20, 0
  s_cbranch_scc1 Lgo_22
  s_waitcnt vmcnt(0)
  v_cmp_gt_i32 vcc, s29, v3
  s_cbranch_vccz Lgo_22
  s_nop 3
Lpoll_23:
  buffer_load_dword v3, v2, s[4:7], 0 offen sc1
  s_sub_u32 s24, s24, 1
  s_cbranch_scc1 L_FAIL
  s_waitcnt vmcnt(0)
  v_cmp_gt_i32 vcc, s29, v3
  s_cbranch_vccz Lpolld_24
  s_sleep 1
  s_branch Lpoll_23
Lpolld_24:
Lgo_22:
  s_barrier
  s_add_u32 s40, s27, 1048576
  buffer_load_dwordx4 v[16:19], v1, s[4:7], s40 offen sc1
  s_add_u32 s40, s27, 1064960
  buffer_load_dwordx4 v[20:23], v1, s[4:7], s40 offen sc1
  s_add_u32 s40, s27, 524288
  buffer_load_dwordx4 v[112:115], v1, s[4:7], s40 offen sc1
  s_add_u32 s40, s27, 540672
  buffer_load_dwordx4 v[116:119], v1, s[4:7], s40 offen sc1
  s_add_u32 s40, s27, 655360
  buffer_load_dwordx4 v[120:123], v1, s[4:7], s40 offen sc1
  s_add_u32 s40, s27, 671744
  buffer_load_dwordx4 v[124:127], v1, s[4:7], s40 offen sc1
  s_add_u32 s40, s27, 786432
  buffer_load_dwordx4 v[128:131], v1, s[4:7], s40 offen sc1
  s_add_u32 s40, s27, 802816
  buffer_load_dwordx4 v[132:135], v1, s[4:7], s40 offen sc1
  s_waitcnt vmcnt(6)
  v_lshlrev_b32 v96, 16, v16
  v_and_b32 v97, 0xffff0000, v16
  v_lshlrev_b32 v98, 16, v17
  v_and_b32 v99, 0xffff0000, v17
  v_lshlrev_b32 v100, 16, v18
  v_and_b32 v101, 0xffff0000, v18
  v_lshlrev_b32 v102, 16, v19
  v_and_b32 v103, 0xffff0000, v19
  v_lshlrev_b32 v104, 16, v20
  v_and_b32 v105, 0xffff0000, v20
  v_lshlrev_b32 v106, 16, v21
  v_and_b32 v107, 0xffff0000, v21
  v_lshlrev_b32 v108, 16, v22
  v_and_b32 v109, 0xffff0000, v22
  v_lshlrev_b32 v110, 16, v23
  v_and_b32 v111, 0xffff0000, v23
  s_waitcnt vmcnt(5)
  v_dot2c_f32_bf16 v96, v112, v48
  v_dot2c_f32_bf16 v97, v112, v49
  v_dot2c_f32_bf16 v98, v113, v50
  v_dot2c_f32_bf16 v99, v113, v51
  v_dot2c_f32_bf16 v100, v114, v52
  v_dot2c_f32_bf16 v101, v114, v53
  v_dot2c_f32_bf16 v102, v115, v54
  v_dot2c_f32_bf16 v103, v115, v55
  s_waitcnt vmcnt(4)
  v_dot2c_f32_bf16 v104, v116, v56
  v_dot2c_f32_bf16 v105, v116, v57
  v_dot2c_f32_bf16 v106, v117, v58
  v_dot2c_f32_bf16 v107, v117, v59
  v_dot2c_f32_bf16 v108, v118, v60
  v_dot2c_f32_bf16 v109, v118, v61
  v_dot2c_f32_bf16 v110, v119, v62
  v_dot2c_f32_bf16 v111, v119, v63
  s_waitcnt vmcnt(3)
  v_dot2c_f32_bf16 v96, v120, v48
  v_dot2c_f32_bf16 v97, v120, v49
  v_dot2c_f32_bf16 v98, v121, v50
  v_dot2c_f32_bf16 v99, v121, v51
  v_dot2c_f32_bf16 v100, v122, v52
  v_dot2c_f32_bf16 v101, v122, v53
  v_dot2c_f32_bf16 v102, v123, v54
  v_dot2c_f32_bf16 v103, v123, v55
  s_waitcnt vmcnt(2)
  v_dot2c_f32_bf16 v104, v124, v56
  v_dot2c_f32_bf16 v105, v124, v57
  v_dot2c_f32_bf16 v106, v125, v58
  v_dot2c_f32_bf16 v107, v125, v59
  v_dot2c_f32_bf16 v108, v126, v60
  v_dot2c_f32_bf16 v109, v126, v61
  v_dot2c_f32_bf16 v110, v127, v62
  v_dot2c_f32_bf16 v111, v127, v63
  s_waitcnt vmcnt(1)
  v_dot2c_f32_bf16 v96, v128, v48
  v_dot2c_f32_bf16 v97, v128, v49
  v_dot2c_f32_bf16 v98, v129, v50
  v_dot2c_f32_bf16 v99, v129, v51
  v_dot2c_f32_bf16 v100, v130, v52
  v_dot2c_f32_bf16 v101, v130, v53
  v_dot2c_f32_bf16 v102, v131, v54
  v_dot2c_f32_bf16 v103, v131, v55
  s_waitcnt vmcnt(0)
  v_dot2c_f32_bf16 v104, v132, v56
  v_dot2c_f32_bf16 v105, v132, v57
  v_dot2c_f32_bf16 v106, v133, v58
  v_dot2c_f32_bf16 v107, v133, v59
  v_dot2c_f32_bf16 v108, v134, v60
  v_dot2c_f32_bf16 v109, v134, v61
  v_dot2c_f32_bf16 v110, v135, v62
  v_dot2c_f32_bf16 v111, v135, v63
  s_nop 2
  buffer_load_dword v3, v2, s[4:7], s31 offen sc1
  v_cvt_pk_bf16_f32 v16, v96, v97
  v_cvt_pk_bf16_f32 v17, v98, v99
  v_cvt_pk_bf16_f32 v18, v100, v101
  v_cvt_pk_bf16_f32 v19, v102, v103
  v_cvt_pk_bf16_f32 v20, v104, v105
  v_cvt_pk_bf16_f32 v21, v106, v107
  v_cvt_pk_bf16_f32 v22, v108, v109
  v_cvt_pk_bf16_f32 v23, v110, v111
  ds_write_b64 v11, v[16:17] offset:0
  ds_write_b64 v11, v[18:19] offset:128
  ds_write_b64 v11, v[20:21] offset:256
  ds_write_b64 v11, v[22:23] offset:384
  ds_read_b128 v[112:115], v12 offset:0
  ds_read_b128 v[116:119], v12 offset:1088
  s_add_u32 s40, s26, 0
  s_waitcnt lgkmcnt(1)
  buffer_store_dwordx4 v[112:115], v10, s[16:19], s40 offen
  s_add_u32 s40, s26, 4096
  s_waitcnt lgkmcnt(0)
  buffer_store_dwordx4 v[116:119], v10, s[16:19], s40 offen
  s_add_u32 s25, s25, 1
  s_add_u32 s29, s29, 1
  s_add_u32 s26, s26, 65536
  s_add_u32 s27, s27, 2097152
  s_xor_b32 s27, s27, 0x2000
  s_cmp_lt_u32 s25, 64
  s_cbranch_scc1 L_FIN_top
  s_branch L_END
L_QKV:
  v_lshrrev_b32 v60, 3, v0
  v_and_b32 v61, 6, v60
  v_xor_b32 v61, v61, v0
  v_and_b32 v61, 7, v61
  v_lshlrev_b32 v61, 4, v61
  v_lshl_add_u32 v1, v60, 11, v61
  s_lshl_b32 s40, s20, 14
  v_add_u32 v1, s40, v1
  s_lshl_b32 s32, s20, 10
  v_and_b32 v60, 6, v0
  v_lshrrev_b32 v61, 4, v0
  v_xor_b32 v60, v60, v61
  v_lshlrev_b32 v60, 4, v60
  v_and_b32 v61, 15, v0
  v_lshl_add_u32 v77, v61, 7, v60
  v_xor_b32 v78, 64, v77
  s_and_b32 s43, s21, 1
  s_lshr_b32 s44, s21, 1
  s_lshl_b32 s44, s44, 8
  s_add_u32 s45, s44, 128
  s_lshl_b32 s46, s43, 7
  s_add_u32 s46, s46, s44
  s_xor_b32 s46, s46, 256
  s_load_dwordx4 s[48:51], s[0:1], 16
  s_waitcnt lgkmcnt(0)
  s_cmp_eq_u32 s43, 0
  s_cselect_b32 s8, s48, s50
  s_cselect_b32 s9, s49, s51
  s_mov_b32 s10, 8388608
  s_mov_b32 s11, 0x20000
  s_lshr_b32 s40, s44, 8
  s_and_b32 s40, s40, 3
  s_cmp_eq_u32 s40, 1
  s_cselect_b64 vcc, -1, 0
  v_bfe_u32 v4, v0, 5, 1
  v_mul_u32_u24 v4, 32768, v4
  v_bfe_u32 v5, v0, 4, 1
  v_mul_u32_u24 v5, 16384, v5
  v_add_u32 v4, v4, v5
  v_bfe_u32 v5, v0, 3, 1
  v_mul_u32_u24 v5, 8192, v5
  v_add_u32 v4, v4, v5
  v_lshrrev_b32 v5, 3, v0
  v_and_b32 v5, 6, v5
  v_xor_b32 v5, v5, v0
  v_and_b32 v5, 7, v5
  v_lshl_add_u32 v4, v5, 4, v4
  s_lshr_b32 s40, s20, 1
  s_mul_i32 s40, s40, 2097152
  s_and_b32 s41, s20, 1
  s_mul_i32 s41, s41, 65536
  s_add_u32 s40, s40, s41
  v_add_u32 v4, s40, v4
  v_bfe_u32 v5, v0, 3, 2
  v_xor_b32 v5, s20, v5
  v_lshlrev_b32 v5, 5, v5
  v_lshrrev_b32 v6, 2, v0
  v_lshl_add_u32 v6, v6, 7, v5
  v_and_b32 v5, 3, v0
  v_lshl_add_u32 v6, v5, 3, v6
  v_add_u32 v7, 0x10000, v6
  v_add_u32 v8, s44, v4
  v_add_u32 v9, s45, v4
  v_add_u32 v10, s46, v4
  s_lshl_b32 s41, s20, 10
  s_add_u32 m0, s41, 0
  s_mov_b32 s42, 0
  s_cbranch_vccnz Lpace_25
  s_waitcnt vmcnt(6)
Lpace_25:
  buffer_load_dwordx4 v8, s[8:11], s42 offen lds
  s_add_u32 m0, s41, 4096
  s_mov_b32 s42, 0
  s_cbranch_vccnz Lpace_26
  s_waitcnt vmcnt(6)
Lpace_26:
  buffer_load_dwordx4 v9, s[8:11], s42 offen lds
  s_add_u32 m0, s41, 8192
  s_mov_b32 s42, 131072
  s_cbranch_vccnz Lpace_27
  s_waitcnt vmcnt(6)
Lpace_27:
  buffer_load_dwordx4 v8, s[8:11], s42 offen lds
  s_add_u32 m0, s41, 12288
  s_mov_b32 s42, 131072
  s_cbranch_vccnz Lpace_28
  s_waitcnt vmcnt(6)
Lpace_28:
  buffer_load_dwordx4 v9, s[8:11], s42 offen lds
  s_add_u32 m0, s41, 16384
  s_mov_b32 s42, 262144
  s_cbranch_vccnz Lpace_29
  s_waitcnt vmcnt(6)
Lpace_29:
  buffer_load_dwordx4 v8, s[8:11], s42 offen lds
  s_add_u32 m0, s41, 20480
  s_mov_b32 s42, 262144
  s_cbranch_vccnz Lpace_30
  s_waitcnt vmcnt(6)
Lpace_30:
  buffer_load_dwordx4 v9, s[8:11], s42 offen lds
  s_add_u32 m0, s41, 24576
  s_mov_b32 s42, 393216
  s_cbranch_vccnz Lpace_31
  s_waitcnt vmcnt(6)
Lpace_31:
  buffer_load_dwordx4 v8, s[8:11], s42 offen lds
  s_add_u32 m0, s41, 28672
  s_mov_b32 s42, 393216
  s_cbranch_vccnz Lpace_32
  s_waitcnt vmcnt(6)
Lpace_32:
  buffer_load_dwordx4 v9, s[8:11], s42 offen lds
  s_add_u32 m0, s41, 32768
  s_mov_b32 s42, 524288
  s_cbranch_vccnz Lpace_33
  s_waitcnt vmcnt(6)
Lpace_33:
  buffer_load_dwordx4 v8, s[8:11], s42 offen lds
  s_add_u32 m0, s41, 36864
  s_mov_b32 s42, 524288
  s_cbranch_vccnz Lpace_34
  s_waitcnt vmcnt(6)
Lpace_34:
  buffer_load_dwordx4 v9, s[8:11], s42 offen lds
  s_add_u32 m0, s41, 40960
  s_mov_b32 s42, 655360
  s_cbranch_vccnz Lpace_35
  s_waitcnt vmcnt(6)
Lpace_35:
  buffer_load_dwordx4 v8, s[8:11], s42 offen lds
  s_add_u32 m0, s41, 45056
  s_mov_b32 s42, 655360
  s_cbranch_vccnz Lpace_36
  s_waitcnt vmcnt(6)
Lpace_36:
  buffer_load_dwordx4 v9, s[8:11], s42 offen lds
  s_add_u32 m0, s41, 49152
  s_mov_b32 s42, 786432
  s_cbranch_vccnz Lpace_37
  s_waitcnt vmcnt(6)
Lpace_37:
  buffer_load_dwordx4 v8, s[8:11], s42 offen lds
  s_add_u32 m0, s41, 53248
  s_mov_b32 s42, 786432
  s_cbranch_vccnz Lpace_38
  s_waitcnt vmcnt(6)
Lpace_38:
  buffer_load_dwordx4 v9, s[8:11], s42 offen lds
  s_add_u32 m0, s41, 57344
  s_mov_b32 s42, 917504
  s_cbranch_vccnz Lpace_39
  s_waitcnt vmcnt(6)
Lpace_39:
  buffer_load_dwordx4 v8, s[8:11], s42 offen lds
  s_add_u32 m0, s41, 61440
  s_mov_b32 s42, 917504
  s_cbranch_vccnz Lpace_40
  s_waitcnt vmcnt(6)
Lpace_40:
  buffer_load_dwordx4 v9, s[8:11], s42 offen lds
  s_add_u32 m0, s41, 65536
  s_mov_b32 s42, 1048576
  s_cbranch_vccnz Lpace_41
  s_waitcnt vmcnt(6)
Lpace_41:
  buffer_load_dwordx4 v8, s[8:11], s42 offen lds
  s_add_u32 m0, s41, 69632
  s_mov_b32 s42, 1048576
  s_cbranch_vccnz Lpace_42
  s_waitcnt vmcnt(6)
Lpace_42:
  buffer_load_dwordx4 v9, s[8:11], s42 offen lds
  s_add_u32 m0, s41, 73728
  s_mov_b32 s42, 1179648
  s_cbranch_vccnz Lpace_43
  s_waitcnt vmcnt(6)
Lpace_43:
  buffer_load_dwordx4 v8, s[8:11], s42 offen lds
  s_add_u32 m0, s41, 77824
  s_mov_b32 s42, 1179648
  s_cbranch_vccnz Lpace_44
  s_waitcnt vmcnt(6)
Lpace_44:
  buffer_load_dwordx4 v9, s[8:11], s42 offen lds
  s_add_u32 m0, s41, 81920
  s_mov_b32 s42, 1310720
  s_cbranch_vccnz Lpace_45
  s_waitcnt vmcnt(6)
Lpace_45:
  buffer_load_dwordx4 v8, s[8:11], s42 offen lds
  s_add_u32 m0, s41, 86016
  s_mov_b32 s42, 1310720
  s_cbranch_vccnz Lpace_46
  s_waitcnt vmcnt(6)
Lpace_46:
  buffer_load_dwordx4 v9, s[8:11], s42 offen lds
  s_add_u32 m0, s41, 90112
  s_mov_b32 s42, 1441792
  s_cbranch_vccnz Lpace_47
  s_waitcnt vmcnt(6)
Lpace_47:
  buffer_load_dwordx4 v8, s[8:11], s42 offen lds
  s_add_u32 m0, s41, 94208
  s_mov_b32 s42, 1441792
  s_cbranch_vccnz Lpace_48
  s_waitcnt vmcnt(6)
Lpace_48:
  buffer_load_dwordx4 v9, s[8:11], s42 offen lds
  s_add_u32 m0, s41, 98304
  s_mov_b32 s42, 1572864
  s_cbranch_vccnz Lpace_49
  s_waitcnt vmcnt(6)
Lpace_49:
  buffer_load_dwordx4 v8, s[8:11], s42 offen lds
  s_add_u32 m0, s41, 102400
  s_mov_b32 s42, 1572864
  s_cbranch_vccnz Lpace_50
  s_waitcnt vmcnt(6)
Lpace_50:
  buffer_load_dwordx4 v9, s[8:11], s42 offen lds
  s_add_u32 m0, s41, 106496
  s_mov_b32 s42, 1703936
  s_cbranch_vccnz Lpace_51
  s_waitcnt vmcnt(6)
Lpace_51:
  buffer_load_dwordx4 v8, s[8:11], s42 offen lds
  s_add_u32 m0, s41, 110592
  s_mov_b32 s42, 1703936
  s_cbranch_vccnz Lpace_52
  s_waitcnt vmcnt(6)
Lpace_52:
  buffer_load_dwordx4 v9, s[8:11], s42 offen lds
  s_waitcnt vmcnt(24) lgkmcnt(0)
  s_barrier
  s_add_u32 m0, s41, 114688
  s_mov_b32 s42, 1835008
  s_cbranch_vccnz Lpace_53
  s_waitcnt vmcnt(6)
Lpace_53:
  buffer_load_dwordx4 v8, s[8:11], s42 offen lds
  s_add_u32 m0, s41, 118784
  s_mov_b32 s42, 1835008
  s_cbranch_vccnz Lpace_54
  s_waitcnt vmcnt(6)
Lpace_54:
  buffer_load_dwordx4 v9, s[8:11], s42 offen lds
  s_add_u32 m0, s41, 122880
  s_mov_b32 s42, 1966080
  s_cbranch_vccnz Lpace_55
  s_waitcnt vmcnt(6)
Lpace_55:
  buffer_load_dwordx4 v8, s[8:11], s42 offen lds
  s_add_u32 m0, s41, 126976
  s_mov_b32 s42, 1966080
  s_cbranch_vccnz Lpace_56
  s_waitcnt vmcnt(6)
Lpace_56:
  buffer_load_dwordx4 v9, s[8:11], s42 offen lds
  ds_read_b64_tr_b16 a[0:1], v6 offset:0
  ds_read_b64_tr_b16 a[2:3], v6 offset:2048
  ds_read_b64_tr_b16 a[128:129], v6 offset:4096
  ds_read_b64_tr_b16 a[130:131], v6 offset:6144
  ds_read_b64_tr_b16 a[4:5], v6 offset:8192
  ds_read_b64_tr_b16 a[6:7], v6 offset:10240
  ds_read_b64_tr_b16 a[132:133], v6 offset:12288
  ds_read_b64_tr_b16 a[134:135], v6 offset:14336
  s_waitcnt vmcnt(24) lgkmcnt(0)
  s_barrier
  s_add_u32 m0, s41, 0
  s_mov_b32 s42, 4194304
  s_cbranch_vccnz Lpace_57
  s_waitcnt vmcnt(6)
Lpace_57:
  buffer_load_dwordx4 v8, s[8:11], s42 offen lds
  s_add_u32 m0, s41, 4096
  s_mov_b32 s42, 4194304
  s_cbranch_vccnz Lpace_58
  s_waitcnt vmcnt(6)
Lpace_58:
  buffer_load_dwordx4 v9, s[8:11], s42 offen lds
  s_add_u32 m0, s41, 8192
  s_mov_b32 s42, 4325376
  s_cbranch_vccnz Lpace_59
  s_waitcnt vmcnt(6)
Lpace_59:
  buffer_load_dwordx4 v8, s[8:11], s42 offen lds
  s_add_u32 m0, s41, 12288
  s_mov_b32 s42, 4325376
  s_cbranch_vccnz Lpace_60
  s_waitcnt vmcnt(6)
Lpace_60:
  buffer_load_dwordx4 v9, s[8:11], s42 offen lds
  ds_read_b64_tr_b16 a[8:9], v6 offset:16384
  ds_read_b64_tr_b16 a[10:11], v6 offset:18432
  ds_read_b64_tr_b16 a[136:137], v6 offset:20480
  ds_read_b64_tr_b16 a[138:139], v6 offset:22528
  ds_read_b64_tr_b16 a[12:13], v6 offset:24576
  ds_read_b64_tr_b16 a[14:15], v6 offset:26624
  ds_read_b64_tr_b16 a[140:141], v6 offset:28672
  ds_read_b64_tr_b16 a[142:143], v6 offset:30720
  s_waitcnt vmcnt(24) lgkmcnt(0)
  s_barrier
  s_add_u32 m0, s41, 16384
  s_mov_b32 s42, 4456448
  s_cbranch_vccnz Lpace_61
  s_waitcnt vmcnt(6)
Lpace_61:
  buffer_load_dwordx4 v8, s[8:11], s42 offen lds
  s_add_u32 m0, s41, 20480
  s_mov_b32 s42, 4456448
  s_cbranch_vccnz Lpace_62
  s_waitcnt vmcnt(6)
Lpace_62:
  buffer_load_dwordx4 v9, s[8:11], s42 offen lds
  s_add_u32 m0, s41, 24576
  s_mov_b32 s42, 4587520
  s_cbranch_vccnz Lpace_63
  s_waitcnt vmcnt(6)
Lpace_63:
  buffer_load_dwordx4 v8, s[8:11], s42 offen lds
  s_add_u32 m0, s41, 28672
  s_mov_b32 s42, 4587520
  s_cbranch_vccnz Lpace_64
  s_waitcnt vmcnt(6)
Lpace_64:
  buffer_load_dwordx4 v9, s[8:11], s42 offen lds
  ds_read_b64_tr_b16 a[16:17], v6 offset:32768
  ds_read_b64_tr_b16 a[18:19], v6 offset:34816
  ds_read_b64_tr_b16 a[144:145], v6 offset:36864
  ds_read_b64_tr_b16 a[146:147], v6 offset:38912
  ds_read_b64_tr_b16 a[20:21], v6 offset:40960
  ds_read_b64_tr_b16 a[22:23], v6 offset:43008
  ds_read_b64_tr_b16 a[148:149], v6 offset:45056
  ds_read_b64_tr_b16 a[150:151], v6 offset:47104
  s_waitcnt vmcnt(24) lgkmcnt(0)
  s_barrier
  s_add_u32 m0, s41, 32768
  s_mov_b32 s42, 4718592
  s_cbranch_vccnz Lpace_65
  s_waitcnt vmcnt(6)
Lpace_65:
  buffer_load_dwordx4 v8, s[8:11], s42 offen lds
  s_add_u32 m0, s41, 36864
  s_mov_b32 s42, 4718592
  s_cbranch_vccnz Lpace_66
  s_waitcnt vmcnt(6)
Lpace_66:
  buffer_load_dwordx4 v9, s[8:11], s42 offen lds
  s_add_u32 m0, s41, 40960
  s_mov_b32 s42, 4849664
  s_cbranch_vccnz Lpace_67
  s_waitcnt vmcnt(6)
Lpace_67:
  buffer_load_dwordx4 v8, s[8:11], s42 offen lds
  s_add_u32 m0, s41, 45056
  s_mov_b32 s42, 4849664
  s_cbranch_vccnz Lpace_68
  s_waitcnt vmcnt(6)
Lpace_68:
  buffer_load_dwordx4 v9, s[8:11], s42 offen lds
  ds_read_b64_tr_b16 a[24:25], v6 offset:49152
  ds_read_b64_tr_b16 a[26:27], v6 offset:51200
  ds_read_b64_tr_b16 a[152:153], v6 offset:53248
  ds_read_b64_tr_b16 a[154:155], v6 offset:55296
  ds_read_b64_tr_b16 a[28:29], v6 offset:57344
  ds_read_b64_tr_b16 a[30:31], v6 offset:59392
  ds_read_b64_tr_b16 a[156:157], v6 offset:61440
  ds_read_b64_tr_b16 a[158:159], v6 offset:63488
  s_waitcnt vmcnt(24) lgkmcnt(0)
  s_barrier
  s_add_u32 m0, s41, 49152
  s_mov_b32 s42, 4980736
  s_cbranch_vccnz Lpace_69
  s_waitcnt vmcnt(6)
Lpace_69:
  buffer_load_dwordx4 v8, s[8:11], s42 offen lds
  s_add_u32 m0, s41, 53248
  s_mov_b32 s42, 4980736
  s_cbranch_vccnz Lpace_70
  s_waitcnt vmcnt(6)
Lpace_70:
  buffer_load_dwordx4 v9, s[8:11], s42 offen lds
  s_add_u32 m0, s41, 57344
  s_mov_b32 s42, 5111808
  s_cbranch_vccnz Lpace_71
  s_waitcnt vmcnt(6)
Lpace_71:
  buffer_load_dwordx4 v8, s[8:11], s42 offen lds
  s_add_u32 m0, s41, 61440
  s_mov_b32 s42, 5111808
  s_cbranch_vccnz Lpace_72
  s_waitcnt vmcnt(6)
Lpace_72:
  buffer_load_dwordx4 v9, s[8:11], s42 offen lds
  ds_read_b64_tr_b16 a[32:33], v7 offset:0
  ds_read_b64_tr_b16 a[34:35], v7 offset:2048
  ds_read_b64_tr_b16 a[160:161], v7 offset:4096
  ds_read_b64_tr_b16 a[162:163], v7 offset:6144
  ds_read_b64_tr_b16 a[36:37], v7 offset:8192
  ds_read_b64_tr_b16 a[38:39], v7 offset:10240
  ds_read_b64_tr_b16 a[164:165], v7 offset:12288
  ds_read_b64_tr_b16 a[166:167], v7 offset:14336
  s_waitcnt vmcnt(24) lgkmcnt(0)
  s_barrier
  s_add_u32 m0, s41, 65536
  s_mov_b32 s42, 5242880
  s_cbranch_vccnz Lpace_73
  s_waitcnt vmcnt(6)
Lpace_73:
  buffer_load_dwordx4 v8, s[8:11], s42 offen lds
  s_add_u32 m0, s41, 69632
  s_mov_b32 s42, 5242880
  s_cbranch_vccnz Lpace_74
  s_waitcnt vmcnt(6)
Lpace_74:
  buffer_load_dwordx4 v9, s[8:11], s42 offen lds
  s_add_u32 m0, s41, 73728
  s_mov_b32 s42, 5373952
  s_cbranch_vccnz Lpace_75
  s_waitcnt vmcnt(6)
Lpace_75:
  buffer_load_dwordx4 v8, s[8:11], s42 offen lds
  s_add_u32 m0, s41, 77824
  s_mov_b32 s42, 5373952
  s_cbranch_vccnz Lpace_76
  s_waitcnt vmcnt(6)
Lpace_76:
  buffer_load_dwordx4 v9, s[8:11], s42 offen lds
  ds_read_b64_tr_b16 a[40:41], v7 offset:16384
  ds_read_b64_tr_b16 a[42:43], v7 offset:18432
  ds_read_b64_tr_b16 a[168:169], v7 offset:20480
  ds_read_b64_tr_b16 a[170:171], v7 offset:22528
  ds_read_b64_tr_b16 a[44:45], v7 offset:24576
  ds_read_b64_tr_b16 a[46:47], v7 offset:26624
  ds_read_b64_tr_b16 a[172:173], v7 offset:28672
  ds_read_b64_tr_b16 a[174:175], v7 offset:30720
  s_waitcnt vmcnt(24) lgkmcnt(0)
  s_barrier
  s_add_u32 m0, s41, 81920
  s_mov_b32 s42, 5505024
  s_cbranch_vccnz Lpace_77
  s_waitcnt vmcnt(6)
Lpace_77:
  buffer_load_dwordx4 v8, s[8:11], s42 offen lds
  s_add_u32 m0, s41, 86016
  s_mov_b32 s42, 5505024
  s_cbranch_vccnz Lpace_78
  s_waitcnt vmcnt(6)
Lpace_78:
  buffer_load_dwordx4 v9, s[8:11], s42 offen lds
  s_add_u32 m0, s41, 90112
  s_mov_b32 s42, 5636096
  s_cbranch_vccnz Lpace_79
  s_waitcnt vmcnt(6)
Lpace_79:
  buffer_load_dwordx4 v8, s[8:11], s42 offen lds
  s_add_u32 m0, s41, 94208
  s_mov_b32 s42, 5636096
  s_cbranch_vccnz Lpace_80
  s_waitcnt vmcnt(6)
Lpace_80:
  buffer_load_dwordx4 v9, s[8:11], s42 offen lds
  ds_read_b64_tr_b16 a[48:49], v7 offset:32768
  ds_read_b64_tr_b16 a[50:51], v7 offset:34816
  ds_read_b64_tr_b16 a[176:177], v7 offset:36864
  ds_read_b64_tr_b16 a[178:179], v7 offset:38912
  ds_read_b64_tr_b16 a[52:53], v7 offset:40960
  ds_read_b64_tr_b16 a[54:55], v7 offset:43008
  ds_read_b64_tr_b16 a[180:181], v7 offset:45056
  ds_read_b64_tr_b16 a[182:183], v7 offset:47104
  s_waitcnt vmcnt(24) lgkmcnt(0)
  s_barrier
  s_add_u32 m0, s41, 98304
  s_mov_b32 s42, 5767168
  s_cbranch_vccnz Lpace_81
  s_waitcnt vmcnt(6)
Lpace_81:
  buffer_load_dwordx4 v8, s[8:11], s42 offen lds
  s_add_u32 m0, s41, 102400
  s_mov_b32 s42, 5767168
  s_cbranch_vccnz Lpace_82
  s_waitcnt vmcnt(6)
Lpace_82:
  buffer_load_dwordx4 v9, s[8:11], s42 offen lds
  s_add_u32 m0, s41, 106496
  s_mov_b32 s42, 5898240
  s_cbranch_vccnz Lpace_83
  s_waitcnt vmcnt(6)
Lpace_83:
  buffer_load_dwordx4 v8, s[8:11], s42 offen lds
  s_add_u32 m0, s41, 110592
  s_mov_b32 s42, 5898240
  s_cbranch_vccnz Lpace_84
  s_waitcnt vmcnt(6)
Lpace_84:
  buffer_load_dwordx4 v9, s[8:11], s42 offen lds
  ds_read_b64_tr_b16 a[56:57], v7 offset:49152
  ds_read_b64_tr_b16 a[58:59], v7 offset:51200
  ds_read_b64_tr_b16 a[184:185], v7 offset:53248
  ds_read_b64_tr_b16 a[186:187], v7 offset:55296
  ds_read_b64_tr_b16 a[60:61], v7 offset:57344
  ds_read_b64_tr_b16 a[62:63], v7 offset:59392
  ds_read_b64_tr_b16 a[188:189], v7 offset:61440
  ds_read_b64_tr_b16 a[190:191], v7 offset:63488
  s_waitcnt vmcnt(24) lgkmcnt(0)
  s_barrier
  s_add_u32 m0, s41, 114688
  s_mov_b32 s42, 6029312
  s_cbranch_vccnz Lpace_85
  s_waitcnt vmcnt(6)
Lpace_85:
  buffer_load_dwordx4 v8, s[8:11], s42 offen lds
  s_add_u32 m0, s41, 118784
  s_mov_b32 s42, 6029312
  s_cbranch_vccnz Lpace_86
  s_waitcnt vmcnt(6)
Lpace_86:
  buffer_load_dwordx4 v9, s[8:11], s42 offen lds
  s_add_u32 m0, s41, 122880
  s_mov_b32 s42, 6160384
  s_cbranch_vccnz Lpace_87
  s_waitcnt vmcnt(6)
Lpace_87:
  buffer_load_dwordx4 v8, s[8:11], s42 offen lds
  s_add_u32 m0, s41, 126976
  s_mov_b32 s42, 6160384
  s_cbranch_vccnz Lpace_88
  s_waitcnt vmcnt(6)
Lpace_88:
  buffer_load_dwordx4 v9, s[8:11], s42 offen lds
  ds_read_b64_tr_b16 a[64:65], v6 offset:0
  ds_read_b64_tr_b16 a[66:67], v6 offset:2048
  ds_read_b64_tr_b16 a[192:193], v6 offset:4096
  ds_read_b64_tr_b16 a[194:195], v6 offset:6144
  ds_read_b64_tr_b16 a[68:69], v6 offset:8192
  ds_read_b64_tr_b16 a[70:71], v6 offset:10240
  ds_read_b64_tr_b16 a[196:197], v6 offset:12288
  ds_read_b64_tr_b16 a[198:199], v6 offset:14336
  s_waitcnt vmcnt(24) lgkmcnt(0)
  s_barrier
  s_load_dwordx2 s[8:9], s[0:1], 32
  s_mov_b32 s10, 8388608
  s_mov_b32 s11, 0x20000
  s_waitcnt lgkmcnt(0)
  s_add_u32 m0, s41, 0
  s_mov_b32 s42, 0
  s_cbranch_vccnz Lpace_89
  s_waitcnt vmcnt(6)
Lpace_89:
  buffer_load_dwordx4 v10, s[8:11], s42 offen lds
  s_add_u32 m0, s41, 4096
  s_mov_b32 s42, 131072
  s_cbranch_vccnz Lpace_90
  s_waitcnt vmcnt(6)
Lpace_90:
  buffer_load_dwordx4 v10, s[8:11], s42 offen lds
  s_add_u32 m0, s41, 8192
  s_mov_b32 s42, 262144
  s_cbranch_vccnz Lpace_91
  s_waitcnt vmcnt(6)
Lpace_91:
  buffer_load_dwordx4 v10, s[8:11], s42 offen lds
  s_add_u32 m0, s41, 12288
  s_mov_b32 s42, 393216
  s_cbranch_vccnz Lpace_92
  s_waitcnt vmcnt(6)
Lpace_92:
  buffer_load_dwordx4 v10, s[8:11], s42 offen lds
  ds_read_b64_tr_b16 a[72:73], v6 offset:16384
  ds_read_b64_tr_b16 a[74:75], v6 offset:18432
  ds_read_b64_tr_b16 a[200:201], v6 offset:20480
  ds_read_b64_tr_b16 a[202:203], v6 offset:22528
  ds_read_b64_tr_b16 a[76:77], v6 offset:24576
  ds_read_b64_tr_b16 a[78:79], v6 offset:26624
  ds_read_b64_tr_b16 a[204:205], v6 offset:28672
  ds_read_b64_tr_b16 a[206:207], v6 offset:30720
  s_waitcnt vmcnt(24) lgkmcnt(0)
  s_barrier
  s_add_u32 m0, s41, 16384
  s_mov_b32 s42, 524288
  s_cbranch_vccnz Lpace_93
  s_waitcnt vmcnt(6)
Lpace_93:
  buffer_load_dwordx4 v10, s[8:11], s42 offen lds
  s_add_u32 m0, s41, 20480
  s_mov_b32 s42, 655360
  s_cbranch_vccnz Lpace_94
  s_waitcnt vmcnt(6)
Lpace_94:
  buffer_load_dwordx4 v10, s[8:11], s42 offen lds
  s_add_u32 m0, s41, 24576
  s_mov_b32 s42, 786432
  s_cbranch_vccnz Lpace_95
  s_waitcnt vmcnt(6)
Lpace_95:
  buffer_load_dwordx4 v10, s[8:11], s42 offen lds
  s_add_u32 m0, s41, 28672
  s_mov_b32 s42, 917504
  s_cbranch_vccnz Lpace_96
  s_waitcnt vmcnt(6)
Lpace_96:
  buffer_load_dwordx4 v10, s[8:11], s42 offen lds
  ds_read_b64_tr_b16 a[80:81], v6 offset:32768
  ds_read_b64_tr_b16 a[82:83], v6 offset:34816
  ds_read_b64_tr_b16 a[208:209], v6 offset:36864
  ds_read_b64_tr_b16 a[210:211], v6 offset:38912
  ds_read_b64_tr_b16 a[84:85], v6 offset:40960
  ds_read_b64_tr_b16 a[86:87], v6 offset:43008
  ds_read_b64_tr_b16 a[212:213], v6 offset:45056
  ds_read_b64_tr_b16 a[214:215], v6 offset:47104
  s_cmp_lg_u32 s20, 0
  s_cbranch_scc1 L_QKV_noinit
Lini_97:
  s_load_dwordx16 s[64:79], s[12:13], 128 glc
  s_load_dwordx16 s[80:95], s[12:13], 192 glc
  s_sub_u32 s24, s24, 1
  s_cbranch_scc1 L_FAIL
  s_waitcnt lgkmcnt(0)
  s_and_b64 s[64:65], s[64:65], s[66:67]
  s_and_b64 s[64:65], s[64:65], s[68:69]
  s_and_b64 s[64:65], s[64:65], s[70:71]
  s_and_b64 s[64:65], s[64:65], s[72:73]
  s_and_b64 s[64:65], s[64:65], s[74:75]
  s_and_b64 s[64:65], s[64:65], s[76:77]
  s_and_b64 s[64:65], s[64:65], s[78:79]
  s_and_b64 s[64:65], s[64:65], s[80:81]
  s_and_b64 s[64:65], s[64:65], s[82:83]
  s_and_b64 s[64:65], s[64:65], s[84:85]
  s_and_b64 s[64:65], s[64:65], s[86:87]
  s_and_b64 s[64:65], s[64:65], s[88:89]
  s_and_b64 s[64:65], s[64:65], s[90:91]
  s_and_b64 s[64:65], s[64:65], s[92:93]
  s_and_b64 s[64:65], s[64:65], s[94:95]
  s_and_b32 s64, s64, s65
  s_cbranch_scc0 Lini_97
L_QKV_noinit:
  s_waitcnt vmcnt(24) lgkmcnt(0)
  s_barrier
  s_add_u32 m0, s41, 32768
  s_mov_b32 s42, 1048576
  s_cbranch_vccnz Lpace_98
  s_waitcnt vmcnt(6)
Lpace_98:
  buffer_load_dwordx4 v10, s[8:11], s42 offen lds
  s_add_u32 m0, s41, 36864
  s_mov_b32 s42, 1179648
  s_cbranch_vccnz Lpace_99
  s_waitcnt vmcnt(6)
Lpace_99:
  buffer_load_dwordx4 v10, s[8:11], s42 offen lds
  s_add_u32 m0, s41, 40960
  s_mov_b32 s42, 1310720
  s_cbranch_vccnz Lpace_100
  s_waitcnt vmcnt(6)
Lpace_100:
  buffer_load_dwordx4 v10, s[8:11], s42 offen lds
  s_add_u32 m0, s41, 45056
  s_mov_b32 s42, 1441792
  s_cbranch_vccnz Lpace_101
  s_waitcnt vmcnt(6)
Lpace_101:
  buffer_load_dwordx4 v10, s[8:11], s42 offen lds
  ds_read_b64_tr_b16 a[88:89], v6 offset:49152
  ds_read_b64_tr_b16 a[90:91], v6 offset:51200
  ds_read_b64_tr_b16 a[216:217], v6 offset:53248
  ds_read_b64_tr_b16 a[218:219], v6 offset:55296
  ds_read_b64_tr_b16 a[92:93], v6 offset:57344
  ds_read_b64_tr_b16 a[94:95], v6 offset:59392
  ds_read_b64_tr_b16 a[220:221], v6 offset:61440
  ds_read_b64_tr_b16 a[222:223], v6 offset:63488
  s_waitcnt vmcnt(24) lgkmcnt(0)
  s_barrier
  s_add_u32 m0, s41, 49152
  s_mov_b32 s42, 1572864
  s_cbranch_vccnz Lpace_102
  s_waitcnt vmcnt(6)
Lpace_102:
  buffer_load_dwordx4 v10, s[8:11], s42 offen lds
  s_add_u32 m0, s41, 53248
  s_mov_b32 s42, 1703936
  s_cbranch_vccnz Lpace_103
  s_waitcnt vmcnt(6)
Lpace_103:
  buffer_load_dwordx4 v10, s[8:11], s42 offen lds
  s_add_u32 m0, s41, 57344
  s_mov_b32 s42, 1835008
  s_cbranch_vccnz Lpace_104
  s_waitcnt vmcnt(6)
Lpace_104:
  buffer_load_dwordx4 v10, s[8:11], s42 offen lds
  s_add_u32 m0, s41, 61440
  s_mov_b32 s42, 1966080
  s_cbranch_vccnz Lpace_105
  s_waitcnt vmcnt(6)
Lpace_105:
  buffer_load_dwordx4 v10, s[8:11], s42 offen lds
  ds_read_b64_tr_b16 a[96:97], v7 offset:0
  ds_read_b64_tr_b16 a[98:99], v7 offset:2048
  ds_read_b64_tr_b16 a[224:225], v7 offset:4096
  ds_read_b64_tr_b16 a[226:227], v7 offset:6144
  ds_read_b64_tr_b16 a[100:101], v7 offset:8192
  ds_read_b64_tr_b16 a[102:103], v7 offset:10240
  ds_read_b64_tr_b16 a[228:229], v7 offset:12288
  ds_read_b64_tr_b16 a[230:231], v7 offset:14336
  s_waitcnt vmcnt(24) lgkmcnt(0)
  s_barrier
  s_add_u32 m0, s41, 65536
  s_mov_b32 s42, 4194304
  s_cbranch_vccnz Lpace_106
  s_waitcnt vmcnt(6)
Lpace_106:
  buffer_load_dwordx4 v10, s[8:11], s42 offen lds
  s_add_u32 m0, s41, 69632
  s_mov_b32 s42, 4325376
  s_cbranch_vccnz Lpace_107
  s_waitcnt vmcnt(6)
Lpace_107:
  buffer_load_dwordx4 v10, s[8:11], s42 offen lds
  s_add_u32 m0, s41, 73728
  s_mov_b32 s42, 4456448
  s_cbranch_vccnz Lpace_108
  s_waitcnt vmcnt(6)
Lpace_108:
  buffer_load_dwordx4 v10, s[8:11], s42 offen lds
  s_add_u32 m0, s41, 77824
  s_mov_b32 s42, 4587520
  s_cbranch_vccnz Lpace_109
  s_waitcnt vmcnt(6)
Lpace_109:
  buffer_load_dwordx4 v10, s[8:11], s42 offen lds
  ds_read_b64_tr_b16 a[104:105], v7 offset:16384
  ds_read_b64_tr_b16 a[106:107], v7 offset:18432
  ds_read_b64_tr_b16 a[232:233], v7 offset:20480
  ds_read_b64_tr_b16 a[234:235], v7 offset:22528
  ds_read_b64_tr_b16 a[108:109], v7 offset:24576
  ds_read_b64_tr_b16 a[110:111], v7 offset:26624
  ds_read_b64_tr_b16 a[236:237], v7 offset:28672
  ds_read_b64_tr_b16 a[238:239], v7 offset:30720
  s_waitcnt vmcnt(24) lgkmcnt(0)
  s_barrier
  s_add_u32 m0, s41, 81920
  s_mov_b32 s42, 4718592
  s_cbranch_vccnz Lpace_110
  s_waitcnt vmcnt(6)
Lpace_110:
  buffer_load_dwordx4 v10, s[8:11], s42 offen lds
  s_add_u32 m0, s41, 86016
  s_mov_b32 s42, 4849664
  s_cbranch_vccnz Lpace_111
  s_waitcnt vmcnt(6)
Lpace_111:
  buffer_load_dwordx4 v10, s[8:11], s42 offen lds
  s_add_u32 m0, s41, 90112
  s_mov_b32 s42, 4980736
  s_cbranch_vccnz Lpace_112
  s_waitcnt vmcnt(6)
Lpace_112:
  buffer_load_dwordx4 v10, s[8:11], s42 offen lds
  s_add_u32 m0, s41, 94208
  s_mov_b32 s42, 5111808
  s_cbranch_vccnz Lpace_113
  s_waitcnt vmcnt(6)
Lpace_113:
  buffer_load_dwordx4 v10, s[8:11], s42 offen lds
  ds_read_b64_tr_b16 a[112:113], v7 offset:32768
  ds_read_b64_tr_b16 a[114:115], v7 offset:34816
  ds_read_b64_tr_b16 a[240:241], v7 offset:36864
  ds_read_b64_tr_b16 a[242:243], v7 offset:38912
  ds_read_b64_tr_b16 a[116:117], v7 offset:40960
  ds_read_b64_tr_b16 a[118:119], v7 offset:43008
  ds_read_b64_tr_b16 a[244:245], v7 offset:45056
  ds_read_b64_tr_b16 a[246:247], v7 offset:47104
  s_waitcnt vmcnt(24) lgkmcnt(0)
  s_barrier
  s_add_u32 m0, s41, 98304
  s_mov_b32 s42, 5242880
  s_cbranch_vccnz Lpace_114
  s_waitcnt vmcnt(6)
Lpace_114:
  buffer_load_dwordx4 v10, s[8:11], s42 offen lds
  s_add_u32 m0, s41, 102400
  s_mov_b32 s42, 5373952
  s_cbranch_vccnz Lpace_115
  s_waitcnt vmcnt(6)
Lpace_115:
  buffer_load_dwordx4 v10, s[8:11], s42 offen lds
  s_add_u32 m0, s41, 106496
  s_mov_b32 s42, 5505024
  s_cbranch_vccnz Lpace_116
  s_waitcnt vmcnt(6)
Lpace_116:
  buffer_load_dwordx4 v10, s[8:11], s42 offen lds
  s_add_u32 m0, s41, 110592
  s_mov_b32 s42, 5636096
  s_cbranch_vccnz Lpace_117
  s_waitcnt vmcnt(6)
Lpace_117:
  buffer_load_dwordx4 v10, s[8:11], s42 offen lds
  ds_read_b64_tr_b16 a[120:121], v7 offset:49152
  ds_read_b64_tr_b16 a[122:123], v7 offset:51200
  ds_read_b64_tr_b16 a[248:249], v7 offset:53248
  ds_read_b64_tr_b16 a[250:251], v7 offset:55296
  ds_read_b64_tr_b16 a[124:125], v7 offset:57344
  ds_read_b64_tr_b16 a[126:127], v7 offset:59392
  ds_read_b64_tr_b16 a[252:253], v7 offset:61440
  ds_read_b64_tr_b16 a[254:255], v7 offset:63488
  s_waitcnt vmcnt(24) lgkmcnt(0)
  s_barrier
  s_add_u32 m0, s41, 114688
  s_mov_b32 s42, 5767168
  s_cbranch_vccnz Lpace_118
  s_waitcnt vmcnt(6)
Lpace_118:
  buffer_load_dwordx4 v10, s[8:11], s42 offen lds
  s_add_u32 m0, s41, 118784
  s_mov_b32 s42, 5898240
  s_cbranch_vccnz Lpace_119
  s_waitcnt vmcnt(6)
Lpace_119:
  buffer_load_dwordx4 v10, s[8:11], s42 offen lds
  s_add_u32 m0, s41, 122880
  s_mov_b32 s42, 6029312
  s_cbranch_vccnz Lpace_120
  s_waitcnt vmcnt(6)
Lpace_120:
  buffer_load_dwordx4 v10, s[8:11], s42 offen lds
  s_add_u32 m0, s41, 126976
  s_mov_b32 s42, 6160384
  s_cbranch_vccnz Lpace_121
  s_waitcnt vmcnt(6)
Lpace_121:
  buffer_load_dwordx4 v10, s[8:11], s42 offen lds
  ds_read_b64_tr_b16 v[128:129], v6 offset:0
  ds_read_b64_tr_b16 v[130:131], v6 offset:2048
  ds_read_b64_tr_b16 v[132:133], v6 offset:4096
  ds_read_b64_tr_b16 v[134:135], v6 offset:6144
  ds_read_b64_tr_b16 v[136:137], v6 offset:8192
  ds_read_b64_tr_b16 v[138:139], v6 offset:10240
  ds_read_b64_tr_b16 v[140:141], v6 offset:12288
  ds_read_b64_tr_b16 v[142:143], v6 offset:14336
  s_waitcnt vmcnt(24) lgkmcnt(0)
  s_barrier
  ds_read_b64_tr_b16 v[144:145], v6 offset:16384
  ds_read_b64_tr_b16 v[146:147], v6 offset:18432
  ds_read_b64_tr_b16 v[148:149], v6 offset:20480
  ds_read_b64_tr_b16 v[150:151], v6 offset:22528
  ds_read_b64_tr_b16 v[152:153], v6 offset:24576
  ds_read_b64_tr_b16 v[154:155], v6 offset:26624
  ds_read_b64_tr_b16 v[156:157], v6 offset:28672
  ds_read_b64_tr_b16 v[158:159], v6 offset:30720
  s_waitcnt vmcnt(20) lgkmcnt(0)
  s_barrier
  ds_read_b64_tr_b16 v[160:161], v6 offset:32768
  ds_read_b64_tr_b16 v[162:163], v6 offset:34816
  ds_read_b64_tr_b16 v[164:165], v6 offset:36864
  ds_read_b64_tr_b16 v[166:167], v6 offset:38912
  ds_read_b64_tr_b16 v[168:169], v6 offset:40960
  ds_read_b64_tr_b16 v[170:171], v6 offset:43008
  ds_read_b64_tr_b16 v[172:173], v6 offset:45056
  ds_read_b64_tr_b16 v[174:175], v6 offset:47104
  s_waitcnt vmcnt(16) lgkmcnt(0)
  s_barrier
  ds_read_b64_tr_b16 v[176:177], v6 offset:49152
  ds_read_b64_tr_b16 v[178:179], v6 offset:51200
  ds_read_b64_tr_b16 v[180:181], v6 offset:53248
  ds_read_b64_tr_b16 v[182:183], v6 offset:55296
  ds_read_b64_tr_b16 v[184:185], v6 offset:57344
  ds_read_b64_tr_b16 v[186:187], v6 offset:59392
  ds_read_b64_tr_b16 v[188:189], v6 offset:61440
  ds_read_b64_tr_b16 v[190:191], v6 offset:63488
  s_waitcnt vmcnt(12) lgkmcnt(0)
  s_barrier
  ds_read_b64_tr_b16 v[192:193], v7 offset:0
  ds_read_b64_tr_b16 v[194:195], v7 offset:2048
  ds_read_b64_tr_b16 v[196:197], v7 offset:4096
  ds_read_b64_tr_b16 v[198:199], v7 offset:6144
  ds_read_b64_tr_b16 v[200:201], v7 offset:8192
  ds_read_b64_tr_b16 v[202:203], v7 offset:10240
  ds_read_b64_tr_b16 v[204:205], v7 offset:12288
  ds_read_b64_tr_b16 v[206:207], v7 offset:14336
  s_waitcnt vmcnt(8) lgkmcnt(0)
  s_barrier
  ds_read_b64_tr_b16 v[208:209], v7 offset:16384
  ds_read_b64_tr_b16 v[210:211], v7 offset:18432
  ds_read_b64_tr_b16 v[212:213], v7 offset:20480
  ds_read_b64_tr_b16 v[214:215], v7 offset:22528
  ds_read_b64_tr_b16 v[216:217], v7 offset:24576
  ds_read_b64_tr_b16 v[218:219], v7 offset:26624
  ds_read_b64_tr_b16 v[220:221], v7 offset:28672
  ds_read_b64_tr_b16 v[222:223], v7 offset:30720
  s_waitcnt vmcnt(4) lgkmcnt(0)
  s_barrier
  ds_read_b64_tr_b16 v[224:225], v7 offset:32768
  ds_read_b64_tr_b16 v[226:227], v7 offset:34816
  ds_read_b64_tr_b16 v[228:229], v7 offset:36864
  ds_read_b64_tr_b16 v[230:231], v7 offset:38912
  ds_read_b64_tr_b16 v[232:233], v7 offset:40960
  ds_read_b64_tr_b16 v[234:235], v7 offset:43008
  ds_read_b64_tr_b16 v[236:237], v7 offset:45056
  ds_read_b64_tr_b16 v[238:239], v7 offset:47104
  s_waitcnt vmcnt(0) lgkmcnt(0)
  s_barrier
  ds_read_b64_tr_b16 v[240:241], v7 offset:49152
  ds_read_b64_tr_b16 v[242:243], v7 offset:51200
  ds_read_b64_tr_b16 v[244:245], v7 offset:53248
  ds_read_b64_tr_b16 v[246:247], v7 offset:55296
  ds_read_b64_tr_b16 v[248:249], v7 offset:57344
  ds_read_b64_tr_b16 v[250:251], v7 offset:59392
  ds_read_b64_tr_b16 v[252:253], v7 offset:61440
  ds_read_b64_tr_b16 v[254:255], v7 offset:63488
  s_waitcnt lgkmcnt(0)
  s_barrier
  s_lshr_b32 s62, s21, 2
  s_lshl_b32 s62, s62, 7
  s_and_b32 s40, s21, 3
  s_lshl_b32 s40, s40, 2
  s_add_u32 s62, s62, s40
  s_add_u32 s62, s62, 1396736
  s_mov_b32 s27, 6291456
  s_lshr_b32 s40, s21, 1
  s_mul_i32 s40, s40, 65536
  s_mov_b32 s31, 0
  s_and_b32 s41, s21, 1
  s_lshl_b32 s42, s20, 11
  s_add_u32 s42, s42, s40
  s_lshl_b32 s40, s41, 14
  s_add_u32 s40, s40, s42
  v_lshl_add_u32 v76, v0, 4, s40
  s_lshl_b32 s40, s41, 10
  s_add_u32 s40, s40, s42
  s_add_u32 s40, s40, 32768
  s_xor_b32 s40, s40, 65536
  v_lshl_add_u32 v83, v0, 4, s40
  v_lshrrev_b32 v2, 3, v0
  v_lshlrev_b32 v2, 7, v2
  v_and_b32 v3, 7, v0
  v_lshl_add_u32 v2, v3, 2, v2
  v_add_u32 v2, 1388544, v2
  s_mov_b32 s25, 0
  s_mov_b32 s37, 2147483392
  s_mov_b32 s30, 0
  s_mov_b32 s34, s32
  s_mov_b32 s35, s27
  v_mov_b32 v81, v77
  v_mov_b32 v82, v78
  s_nop 1
Lpoll_122:
  buffer_load_dword v3, v2, s[4:7], 0 offen sc1
  s_sub_u32 s24, s24, 1
  s_cbranch_scc1 L_FAIL
  s_waitcnt vmcnt(0)
  v_cmp_gt_i32 vcc, 1, v3
  s_cbranch_vccz Lpolld_123
  s_sleep 1
  s_branch Lpoll_122
Lpolld_123:
  s_add_u32 m0, s34, 0
  s_nop 0
  buffer_load_dwordx4 v1, s[4:7], s35 offen offset:0 sc1 lds
  s_add_u32 m0, s34, 3968
  s_nop 0
  buffer_load_dwordx4 v1, s[4:7], s35 offen offset:128 sc1 lds
  s_add_u32 m0, s34, 7936
  s_nop 0
  buffer_load_dwordx4 v1, s[4:7], s35 offen offset:256 sc1 lds
  s_add_u32 m0, s34, 11904
  s_nop 0
  buffer_load_dwordx4 v1, s[4:7], s35 offen offset:384 sc1 lds
  s_add_u32 m0, s34, 15872
  s_nop 0
  buffer_load_dwordx4 v1, s[4:7], s35 offen offset:512 sc1 lds
  s_add_u32 m0, s34, 19840
  s_nop 0
  buffer_load_dwordx4 v1, s[4:7], s35 offen offset:640 sc1 lds
  s_add_u32 m0, s34, 23808
  s_nop 0
  buffer_load_dwordx4 v1, s[4:7], s35 offen offset:768 sc1 lds
  s_add_u32 m0, s34, 27776
  s_nop 0
  buffer_load_dwordx4 v1, s[4:7], s35 offen offset:896 sc1 lds
  s_add_u32 m0, s34, 31744
  s_nop 0
  buffer_load_dwordx4 v1, s[4:7], s35 offen offset:1024 sc1 lds
  s_add_u32 m0, s34, 35712
  s_nop 0
  buffer_load_dwordx4 v1, s[4:7], s35 offen offset:1152 sc1 lds
  s_add_u32 m0, s34, 39680
  s_nop 0
  buffer_load_dwordx4 v1, s[4:7], s35 offen offset:1280 sc1 lds
  s_add_u32 m0, s34, 43648
  s_nop 0
  buffer_load_dwordx4 v1, s[4:7], s35 offen offset:1408 sc1 lds
  s_add_u32 m0, s34, 47616
  s_nop 0
  buffer_load_dwordx4 v1, s[4:7], s35 offen offset:1536 sc1 lds
  s_add_u32 m0, s34, 51584
  s_nop 0
  buffer_load_dwordx4 v1, s[4:7], s35 offen offset:1664 sc1 lds
  s_add_u32 m0, s34, 55552
  s_nop 0
  buffer_load_dwordx4 v1, s[4:7], s35 offen offset:1792 sc1 lds
  s_add_u32 m0, s34, 59520
  s_nop 0
  buffer_load_dwordx4 v1, s[4:7], s35 offen offset:1920 sc1 lds
  v_min_u32 v60, 63, v0
  v_lshlrev_b32 v60, 7, v60
  v_add_u32 v60, 1424384, v60
  s_nop 1
Lpoll_124:
  buffer_load_dword v61, v60, s[4:7], 0 offen sc1
  s_sub_u32 s24, s24, 1
  s_cbranch_scc1 L_FAIL
  s_waitcnt vmcnt(0)
  v_cmp_gt_i32 vcc, 0, v61
  s_cbranch_vccz Lpolld_125
  s_sleep 1
  s_branch Lpoll_124
Lpolld_125:
  v_lshrrev_b32 v61, 8, v61
  v_and_b32 v62, 3, v0
  v_lshl_or_b32 v61, v61, 2, v62
  s_nop 1
  v_min_u32_dpp v61, v61, v61 row_ror:8 row_mask:0xf bank_mask:0xf
  s_nop 1
  v_min_u32_dpp v61, v61, v61 row_ror:4 row_mask:0xf bank_mask:0xf
  v_mov_b32 v62, v61
  s_nop 1
  v_permlane16_swap_b32 v62, v61
  v_min_u32 v61, v61, v62
  v_mov_b32 v62, v61
  s_nop 1
  v_permlane32_swap_b32 v62, v61
  v_min_u32 v61, v61, v62
  s_nop 1
  v_min_u32_dpp v61, v61, v61 row_ror:2 row_mask:0xf bank_mask:0xf
  s_nop 1
  v_min_u32_dpp v61, v61, v61 row_ror:1 row_mask:0xf bank_mask:0xf
  s_nop 0
  v_readfirstlane_b32 s40, v61
  s_and_b32 s40, s40, 3
  s_lshl_b32 s40, s40, 13
  s_and_b32 s40, s40, 0x2000
  s_xor_b32 s40, s40, 20971520
  s_add_u32 s31, s31, s40
  s_barrier
  ds_read_b128 v[4:7], v81 offset:0
  ds_read_b128 v[8:11], v81 offset:2048
  ds_read_b128 v[12:15], v82 offset:0
  ds_read_b128 v[16:19], v82 offset:2048
  ds_read_b128 v[20:23], v81 offset:4096
  ds_read_b128 v[24:27], v81 offset:6144
L_QKV_top:
  s_waitcnt lgkmcnt(4)
  v_cvt_pk_bf16_f32 v60, v36, v37
  v_cvt_pk_bf16_f32 v61, v38, v39
  v_mfma_f32_16x16x32_bf16 v[36:39], a[0:3], v[4:7], 0
  v_cvt_pk_bf16_f32 v62, v44, v45
  v_cvt_pk_bf16_f32 v63, v46, v47
  v_mfma_f32_16x16x32_bf16 v[44:47], a[128:131], v[4:7], 0
  v_cvt_pk_bf16_f32 v64, v40, v41
  v_cvt_pk_bf16_f32 v65, v42, v43
  v_mfma_f32_16x16x32_bf16 v[40:43], a[0:3], v[8:11], 0
  v_cvt_pk_bf16_f32 v66, v48, v49
  v_cvt_pk_bf16_f32 v67, v50, v51
  v_mfma_f32_16x16x32_bf16 v[48:51], a[128:131], v[8:11], 0
  v_cvt_pk_bf16_f32 v68, v52, v53
  v_cvt_pk_bf16_f32 v69, v54, v55
  v_mfma_f32_16x16x32_bf16 v[52:55], v[4:7], v[128:131], 0
  ds_read_b128 v[28:31], v82 offset:4096
  v_cvt_pk_bf16_f32 v70, v56, v57
  v_cvt_pk_bf16_f32 v71, v58, v59
  v_mfma_f32_16x16x32_bf16 v[56:59], v[8:11], v[128:131], 0
  ds_read_b128 v[32:35], v82 offset:6144
  s_waitcnt lgkmcnt(4)
  v_mfma_f32_16x16x32_bf16 v[36:39], a[4:7], v[12:15], v[36:39]
  ds_read_b128 v[4:7], v81 offset:8192
  v_mfma_f32_16x16x32_bf16 v[44:47], a[132:135], v[12:15], v[44:47]
  ds_read_b128 v[8:11], v81 offset:10240
  v_mfma_f32_16x16x32_bf16 v[40:43], a[4:7], v[16:19], v[40:43]
  buffer_store_dwordx4 v[60:63], v76, s[4:7], s37 offen offset:0 sc1
  v_mfma_f32_16x16x32_bf16 v[48:51], a[132:135], v[16:19], v[48:51]
  buffer_store_dwordx4 v[64:67], v76, s[4:7], s37 offen offset:1024 sc1
  v_mfma_f32_16x16x32_bf16 v[52:55], v[12:15], v[132:135], v[52:55]
  v_mfma_f32_16x16x32_bf16 v[56:59], v[16:19], v[132:135], v[56:59]
  s_waitcnt lgkmcnt(4)
  v_mfma_f32_16x16x32_bf16 v[36:39], a[8:11], v[20:23], v[36:39]
  ds_read_b128 v[12:15], v82 offset:8192
  v_mfma_f32_16x16x32_bf16 v[44:47], a[136:139], v[20:23], v[44:47]
  ds_read_b128 v[16:19], v82 offset:10240
  v_mfma_f32_16x16x32_bf16 v[40:43], a[8:11], v[24:27], v[40:43]
  buffer_store_dwordx4 v[68:71], v83, s[4:7], s37 offen sc1
  v_mfma_f32_16x16x32_bf16 v[48:51], a[136:139], v[24:27], v[48:51]
  v_cmp_gt_i32 vcc, 1, v3
  v_mfma_f32_16x16x32_bf16 v[52:55], v[20:23], v[136:139], v[52:55]
  v_mfma_f32_16x16x32_bf16 v[56:59], v[24:27], v[136:139], v[56:59]
  s_xor_b32 s34, s34, 0x10000
  s_add_u32 s35, s35, 65536
  s_cbranch_vccz L_QKV_have
  s_nop 4
Lpoll_126:
  buffer_load_dword v3, v2, s[4:7], s30 offen sc1
  s_sub_u32 s24, s24, 1
  s_cbranch_scc1 L_FAIL
  s_waitcnt vmcnt(0)
  v_cmp_gt_i32 vcc, 1, v3
  s_cbranch_vccz Lpolld_127
  s_sleep 1
  s_branch Lpoll_126
Lpolld_127:
L_QKV_have:
  s_barrier
  s_waitcnt lgkmcnt(4)
  v_mfma_f32_16x16x32_bf16 v[36:39], a[12:15], v[28:31], v[36:39]
  ds_read_b128 v[20:23], v81 offset:12288
  v_mfma_f32_16x16x32_bf16 v[44:47], a[140:143], v[28:31], v[44:47]
  ds_read_b128 v[24:27], v81 offset:14336
  v_mfma_f32_16x16x32_bf16 v[40:43], a[12:15], v[32:35], v[40:43]
  s_add_u32 m0, s34, 0
  s_nop 0
  buffer_load_dwordx4 v1, s[4:7], s35 offen offset:0 sc1 lds
  v_mfma_f32_16x16x32_bf16 v[48:51], a[140:143], v[32:35], v[48:51]
  v_mfma_f32_16x16x32_bf16 v[52:55], v[28:31], v[140:143], v[52:55]
  v_mfma_f32_16x16x32_bf16 v[56:59], v[32:35], v[140:143], v[56:59]
  s_waitcnt lgkmcnt(4)
  v_mfma_f32_16x16x32_bf16 v[36:39], a[16:19], v[4:7], v[36:39]
  ds_read_b128 v[28:31], v82 offset:12288
  v_mfma_f32_16x16x32_bf16 v[44:47], a[144:147], v[4:7], v[44:47]
  ds_read_b128 v[32:35], v82 offset:14336
  v_mfma_f32_16x16x32_bf16 v[40:43], a[16:19], v[8:11], v[40:43]
  s_add_u32 m0, s34, 3968
  s_nop 0
  buffer_load_dwordx4 v1, s[4:7], s35 offen offset:128 sc1 lds
  v_mfma_f32_16x16x32_bf16 v[48:51], a[144:147], v[8:11], v[48:51]
  v_mfma_f32_16x16x32_bf16 v[52:55], v[4:7], v[144:147], v[52:55]
  v_mfma_f32_16x16x32_bf16 v[56:59], v[8:11], v[144:147], v[56:59]
  s_waitcnt lgkmcnt(4)
  v_mfma_f32_16x16x32_bf16 v[36:39], a[20:23], v[12:15], v[36:39]
  ds_read_b128 v[4:7], v81 offset:16384
  v_mfma_f32_16x16x32_bf16 v[44:47], a[148:151], v[12:15], v[44:47]
  ds_read_b128 v[8:11], v81 offset:18432
  v_mfma_f32_16x16x32_bf16 v[40:43], a[20:23], v[16:19], v[40:43]
  s_add_u32 m0, s34, 7936
  s_nop 0
  buffer_load_dwordx4 v1, s[4:7], s35 offen offset:256 sc1 lds
  v_mfma_f32_16x16x32_bf16 v[48:51], a[148:151], v[16:19], v[48:51]
  v_mfma_f32_16x16x32_bf16 v[52:55], v[12:15], v[148:151], v[52:55]
  v_mfma_f32_16x16x32_bf16 v[56:59], v[16:19], v[148:151], v[56:59]
  s_waitcnt lgkmcnt(4)
  v_mfma_f32_16x16x32_bf16 v[36:39], a[24:27], v[20:23], v[36:39]
  ds_read_b128 v[12:15], v82 offset:16384
  v_mfma_f32_16x16x32_bf16 v[44:47], a[152:155], v[20:23], v[44:47]
  ds_read_b128 v[16:19], v82 offset:18432
  v_mfma_f32_16x16x32_bf16 v[40:43], a[24:27], v[24:27], v[40:43]
  s_add_u32 m0, s34, 11904
  s_nop 0
  buffer_load_dwordx4 v1, s[4:7], s35 offen offset:384 sc1 lds
  v_mfma_f32_16x16x32_bf16 v[48:51], a[152:155], v[24:27], v[48:51]
  v_mfma_f32_16x16x32_bf16 v[52:55], v[20:23], v[152:155], v[52:55]
  v_mfma_f32_16x16x32_bf16 v[56:59], v[24:27], v[152:155], v[56:59]
  s_waitcnt lgkmcnt(4)
  v_mfma_f32_16x16x32_bf16 v[36:39], a[28:31], v[28:31], v[36:39]
  ds_read_b128 v[20:23], v81 offset:20480
  v_mfma_f32_16x16x32_bf16 v[44:47], a[156:159], v[28:31], v[44:47]
  ds_read_b128 v[24:27], v81 offset:22528
  v_mfma_f32_16x16x32_bf16 v[40:43], a[28:31], v[32:35], v[40:43]
  s_add_u32 m0, s34, 15872
  s_nop 0
  buffer_load_dwordx4 v1, s[4:7], s35 offen offset:512 sc1 lds
  v_mfma_f32_16x16x32_bf16 v[48:51], a[156:159], v[32:35], v[48:51]
  v_mfma_f32_16x16x32_bf16 v[52:55], v[28:31], v[156:159], v[52:55]
  v_mfma_f32_16x16x32_bf16 v[56:59], v[32:35], v[156:159], v[56:59]
  s_waitcnt lgkmcnt(4)
  v_mfma_f32_16x16x32_bf16 v[36:39], a[32:35], v[4:7], v[36:39]
  ds_read_b128 v[28:31], v82 offset:20480
  v_mfma_f32_16x16x32_bf16 v[44:47], a[160:163], v[4:7], v[44:47]
  ds_read_b128 v[32:35], v82 offset:22528
  v_mfma_f32_16x16x32_bf16 v[40:43], a[32:35], v[8:11], v[40:43]
  s_add_u32 m0, s34, 19840
  s_nop 0
  buffer_load_dwordx4 v1, s[4:7], s35 offen offset:640 sc1 lds
  v_mfma_f32_16x16x32_bf16 v[48:51], a[160:163], v[8:11], v[48:51]
  v_mfma_f32_16x16x32_bf16 v[52:55], v[4:7], v[160:163], v[52:55]
  v_mfma_f32_16x16x32_bf16 v[56:59], v[8:11], v[160:163], v[56:59]
  s_waitcnt lgkmcnt(4)
  v_mfma_f32_16x16x32_bf16 v[36:39], a[36:39], v[12:15], v[36:39]
  ds_read_b128 v[4:7], v81 offset:24576
  v_mfma_f32_16x16x32_bf16 v[44:47], a[164:167], v[12:15], v[44:47]
  ds_read_b128 v[8:11], v81 offset:26624
  v_mfma_f32_16x16x32_bf16 v[40:43], a[36:39], v[16:19], v[40:43]
  s_add_u32 m0, s34, 23808
  s_nop 0
  buffer_load_dwordx4 v1, s[4:7], s35 offen offset:768 sc1 lds
  v_mfma_f32_16x16x32_bf16 v[48:51], a[164:167], v[16:19], v[48:51]
  v_mfma_f32_16x16x32_bf16 v[52:55], v[12:15], v[164:167], v[52:55]
  v_mfma_f32_16x16x32_bf16 v[56:59], v[16:19], v[164:167], v[56:59]
  s_waitcnt lgkmcnt(4)
  v_mfma_f32_16x16x32_bf16 v[36:39], a[40:43], v[20:23], v[36:39]
  ds_read_b128 v[12:15], v82 offset:24576
  v_mfma_f32_16x16x32_bf16 v[44:47], a[168:171], v[20:23], v[44:47]
  ds_read_b128 v[16:19], v82 offset:26624
  v_mfma_f32_16x16x32_bf16 v[40:43], a[40:43], v[24:27], v[40:43]
  s_add_u32 m0, s34, 27776
  s_nop 0
  buffer_load_dwordx4 v1, s[4:7], s35 offen offset:896 sc1 lds
  v_mfma_f32_16x16x32_bf16 v[48:51], a[168:171], v[24:27], v[48:51]
  v_mfma_f32_16x16x32_bf16 v[52:55], v[20:23], v[168:171], v[52:55]
  v_mfma_f32_16x16x32_bf16 v[56:59], v[24:27], v[168:171], v[56:59]
  s_waitcnt lgkmcnt(4)
  v_mfma_f32_16x16x32_bf16 v[36:39], a[44:47], v[28:31], v[36:39]
  ds_read_b128 v[20:23], v81 offset:28672
  v_mfma_f32_16x16x32_bf16 v[44:47], a[172:175], v[28:31], v[44:47]
  ds_read_b128 v[24:27], v81 offset:30720
  v_mfma_f32_16x16x32_bf16 v[40:43], a[44:47], v[32:35], v[40:43]
  s_add_u32 m0, s34, 31744
  s_nop 0
  buffer_load_dwordx4 v1, s[4:7], s35 offen offset:1024 sc1 lds
  v_mfma_f32_16x16x32_bf16 v[48:51], a[172:175], v[32:35], v[48:51]
  v_mfma_f32_16x16x32_bf16 v[52:55], v[28:31], v[172:175], v[52:55]
  v_mfma_f32_16x16x32_bf16 v[56:59], v[32:35], v[172:175], v[56:59]
  s_waitcnt vmcnt(9)
  s_barrier
  s_cmp_lg_u32 s20, 0
  s_cbranch_scc1 Lnosig_128
  s_mov_b32 s63, s25
  s_atomic_smax s63, s[4:5], s62 glc
Lnosig_128:
  s_waitcnt lgkmcnt(4)
  v_mfma_f32_16x16x32_bf16 v[36:39], a[48:51], v[4:7], v[36:39]
  ds_read_b128 v[28:31], v82 offset:28672
  v_mfma_f32_16x16x32_bf16 v[44:47], a[176:179], v[4:7], v[44:47]
  ds_read_b128 v[32:35], v82 offset:30720
  v_mfma_f32_16x16x32_bf16 v[40:43], a[48:51], v[8:11], v[40:43]
  s_add_u32 m0, s34, 35712
  s_nop 0
  buffer_load_dwordx4 v1, s[4:7], s35 offen offset:1152 sc1 lds
  v_mfma_f32_16x16x32_bf16 v[48:51], a[176:179], v[8:11], v[48:51]
  v_mfma_f32_16x16x32_bf16 v[52:55], v[4:7], v[176:179], v[52:55]
  v_mfma_f32_16x16x32_bf16 v[56:59], v[8:11], v[176:179], v[56:59]
  s_waitcnt lgkmcnt(4)
  v_mfma_f32_16x16x32_bf16 v[36:39], a[52:55], v[12:15], v[36:39]
  ds_read_b128 v[4:7], v81 offset:32768
  v_mfma_f32_16x16x32_bf16 v[44:47], a[180:183], v[12:15], v[44:47]
  ds_read_b128 v[8:11], v81 offset:34816
  v_mfma_f32_16x16x32_bf16 v[40:43], a[52:55], v[16:19], v[40:43]
  s_add_u32 m0, s34, 39680
  s_nop 0
  buffer_load_dwordx4 v1, s[4:7], s35 offen offset:1280 sc1 lds
  v_mfma_f32_16x16x32_bf16 v[48:51], a[180:183], v[16:19], v[48:51]
  v_mfma_f32_16x16x32_bf16 v[52:55], v[12:15], v[180:183], v[52:55]
  v_mfma_f32_16x16x32_bf16 v[56:59], v[16:19], v[180:183], v[56:59]
  s_waitcnt lgkmcnt(4)
  v_mfma_f32_16x16x32_bf16 v[36:39], a[56:59], v[20:23], v[36:39]
  ds_read_b128 v[12:15], v82 offset:32768
  v_mfma_f32_16x16x32_bf16 v[44:47], a[184:187], v[20:23], v[44:47]
  ds_read_b128 v[16:19], v82 offset:34816
  v_mfma_f32_16x16x32_bf16 v[40:43], a[56:59], v[24:27], v[40:43]
  s_add_u32 m0, s34, 43648
  s_nop 0
  buffer_load_dwordx4 v1, s[4:7], s35 offen offset:1408 sc1 lds
  v_mfma_f32_16x16x32_bf16 v[48:51], a[184:187], v[24:27], v[48:51]
  v_mfma_f32_16x16x32_bf16 v[52:55], v[20:23], v[184:187], v[52:55]
  v_mfma_f32_16x16x32_bf16 v[56:59], v[24:27], v[184:187], v[56:59]
  s_waitcnt lgkmcnt(4)
  v_mfma_f32_16x16x32_bf16 v[36:39], a[60:63], v[28:31], v[36:39]
  ds_read_b128 v[20:23], v81 offset:36864
  v_mfma_f32_16x16x32_bf16 v[44:47], a[188:191], v[28:31], v[44:47]
  ds_read_b128 v[24:27], v81 offset:38912
  v_mfma_f32_16x16x32_bf16 v[40:43], a[60:63], v[32:35], v[40:43]
  s_add_u32 m0, s34, 47616
  s_nop 0
  buffer_load_dwordx4 v1, s[4:7], s35 offen offset:1536 sc1 lds
  v_mfma_f32_16x16x32_bf16 v[48:51], a[188:191], v[32:35], v[48:51]
  v_mfma_f32_16x16x32_bf16 v[52:55], v[28:31], v[188:191], v[52:55]
  v_mfma_f32_16x16x32_bf16 v[56:59], v[32:35], v[188:191], v[56:59]
  s_waitcnt lgkmcnt(4)
  v_mfma_f32_16x16x32_bf16 v[36:39], a[64:67], v[4:7], v[36:39]
  ds_read_b128 v[28:31], v82 offset:36864
  v_mfma_f32_16x16x32_bf16 v[44:47], a[192:195], v[4:7], v[44:47]
  ds_read_b128 v[32:35], v82 offset:38912
  v_mfma_f32_16x16x32_bf16 v[40:43], a[64:67], v[8:11], v[40:43]
  s_add_u32 m0, s34, 51584
  s_nop 0
  buffer_load_dwordx4 v1, s[4:7], s35 offen offset:1664 sc1 lds
  v_mfma_f32_16x16x32_bf16 v[48:51], a[192:195], v[8:11], v[48:51]
  v_mfma_f32_16x16x32_bf16 v[52:55], v[4:7], v[192:195], v[52:55]
  v_mfma_f32_16x16x32_bf16 v[56:59], v[8:11], v[192:195], v[56:59]
  s_waitcnt lgkmcnt(4)
  v_mfma_f32_16x16x32_bf16 v[36:39], a[68:71], v[12:15], v[36:39]
  ds_read_b128 v[4:7], v81 offset:40960
  v_mfma_f32_16x16x32_bf16 v[44:47], a[196:199], v[12:15], v[44:47]
  ds_read_b128 v[8:11], v81 offset:43008
  v_mfma_f32_16x16x32_bf16 v[40:43], a[68:71], v[16:19], v[40:43]
  s_add_u32 m0, s34, 55552
  s_nop 0
  buffer_load_dwordx4 v1, s[4:7], s35 offen offset:1792 sc1 lds
  v_mfma_f32_16x16x32_bf16 v[48:51], a[196:199], v[16:19], v[48:51]
  v_mfma_f32_16x16x32_bf16 v[52:55], v[12:15], v[196:199], v[52:55]
  v_mfma_f32_16x16x32_bf16 v[56:59], v[16:19], v[196:199], v[56:59]
  s_waitcnt lgkmcnt(4)
  v_mfma_f32_16x16x32_bf16 v[36:39], a[72:75], v[20:23], v[36:39]
  ds_read_b128 v[12:15], v82 offset:40960
  v_mfma_f32_16x16x32_bf16 v[44:47], a[200:203], v[20:23], v[44:47]
  ds_read_b128 v[16:19], v82 offset:43008
  v_mfma_f32_16x16x32_bf16 v[40:43], a[72:75], v[24:27], v[40:43]
  s_add_u32 m0, s34, 59520
  s_nop 0
  buffer_load_dwordx4 v1, s[4:7], s35 offen offset:1920 sc1 lds
  v_mfma_f32_16x16x32_bf16 v[48:51], a[200:203], v[24:27], v[48:51]
  v_mfma_f32_16x16x32_bf16 v[52:55], v[20:23], v[200:203], v[52:55]
  v_mfma_f32_16x16x32_bf16 v[56:59], v[24:27], v[200:203], v[56:59]
  s_waitcnt lgkmcnt(4)
  v_mfma_f32_16x16x32_bf16 v[36:39], a[76:79], v[28:31], v[36:39]
  ds_read_b128 v[20:23], v81 offset:45056
  v_mfma_f32_16x16x32_bf16 v[44:47], a[204:207], v[28:31], v[44:47]
  ds_read_b128 v[24:27], v81 offset:47104
  v_mfma_f32_16x16x32_bf16 v[40:43], a[76:79], v[32:35], v[40:43]
  v_mfma_f32_16x16x32_bf16 v[48:51], a[204:207], v[32:35], v[48:51]
  v_mfma_f32_16x16x32_bf16 v[52:55], v[28:31], v[204:207], v[52:55]
  v_mfma_f32_16x16x32_bf16 v[56:59], v[32:35], v[204:207], v[56:59]
  s_waitcnt lgkmcnt(4)
  v_mfma_f32_16x16x32_bf16 v[36:39], a[80:83], v[4:7], v[36:39]
  ds_read_b128 v[28:31], v82 offset:45056
  v_mfma_f32_16x16x32_bf16 v[44:47], a[208:211], v[4:7], v[44:47]
  ds_read_b128 v[32:35], v82 offset:47104
  v_mfma_f32_16x16x32_bf16 v[40:43], a[80:83], v[8:11], v[40:43]
  s_add_u32 s30, s25, 2
  s_and_b32 s30, s30, 56
  s_lshl_b32 s30, s30, 7
  buffer_load_dword v3, v2, s[4:7], s30 offen sc1
  v_mfma_f32_16x16x32_bf16 v[48:51], a[208:211], v[8:11], v[48:51]
  v_mfma_f32_16x16x32_bf16 v[52:55], v[4:7], v[208:211], v[52:55]
  v_mfma_f32_16x16x32_bf16 v[56:59], v[8:11], v[208:211], v[56:59]
  s_waitcnt lgkmcnt(4)
  v_mfma_f32_16x16x32_bf16 v[36:39], a[84:87], v[12:15], v[36:39]
  ds_read_b128 v[4:7], v81 offset:49152
  v_mfma_f32_16x16x32_bf16 v[44:47], a[212:215], v[12:15], v[44:47]
  ds_read_b128 v[8:11], v81 offset:51200
  v_mfma_f32_16x16x32_bf16 v[40:43], a[84:87], v[16:19], v[40:43]
  v_mfma_f32_16x16x32_bf16 v[48:51], a[212:215], v[16:19], v[48:51]
  v_mfma_f32_16x16x32_bf16 v[52:55], v[12:15], v[212:215], v[52:55]
  v_mfma_f32_16x16x32_bf16 v[56:59], v[16:19], v[212:215], v[56:59]
  s_waitcnt lgkmcnt(4)
  v_mfma_f32_16x16x32_bf16 v[36:39], a[88:91], v[20:23], v[36:39]
  ds_read_b128 v[12:15], v82 offset:49152
  v_mfma_f32_16x16x32_bf16 v[44:47], a[216:219], v[20:23], v[44:47]
  ds_read_b128 v[16:19], v82 offset:51200
  v_mfma_f32_16x16x32_bf16 v[40:43], a[88:91], v[24:27], v[40:43]
  v_mfma_f32_16x16x32_bf16 v[48:51], a[216:219], v[24:27], v[48:51]
  v_mfma_f32_16x16x32_bf16 v[52:55], v[20:23], v[216:219], v[52:55]
  v_mfma_f32_16x16x32_bf16 v[56:59], v[24:27], v[216:219], v[56:59]
  s_waitcnt lgkmcnt(4)
  v_mfma_f32_16x16x32_bf16 v[36:39], a[92:95], v[28:31], v[36:39]
  ds_read_b128 v[20:23], v81 offset:53248
  v_mfma_f32_16x16x32_bf16 v[44:47], a[220:223], v[28:31], v[44:47]
  ds_read_b128 v[24:27], v81 offset:55296
  v_mfma_f32_16x16x32_bf16 v[40:43], a[92:95], v[32:35], v[40:43]
  v_mfma_f32_16x16x32_bf16 v[48:51], a[220:223], v[32:35], v[48:51]
  v_mfma_f32_16x16x32_bf16 v[52:55], v[28:31], v[220:223], v[52:55]
  v_mfma_f32_16x16x32_bf16 v[56:59], v[32:35], v[220:223], v[56:59]
  s_waitcnt lgkmcnt(4)
  v_mfma_f32_16x16x32_bf16 v[36:39], a[96:99], v[4:7], v[36:39]
  ds_read_b128 v[28:31], v82 offset:53248
  v_mfma_f32_16x16x32_bf16 v[44:47], a[224:227], v[4:7], v[44:47]
  ds_read_b128 v[32:35], v82 offset:55296
  v_mfma_f32_16x16x32_bf16 v[40:43], a[96:99], v[8:11], v[40:43]
  v_mfma_f32_16x16x32_bf16 v[48:51], a[224:227], v[8:11], v[48:51]
  v_mfma_f32_16x16x32_bf16 v[52:55], v[4:7], v[224:227], v[52:55]
  v_mfma_f32_16x16x32_bf16 v[56:59], v[8:11], v[224:227], v[56:59]
  s_waitcnt lgkmcnt(4)
  v_mfma_f32_16x16x32_bf16 v[36:39], a[100:103], v[12:15], v[36:39]
  ds_read_b128 v[4:7], v81 offset:57344
  v_mfma_f32_16x16x32_bf16 v[44:47], a[228:231], v[12:15], v[44:47]
  ds_read_b128 v[8:11], v81 offset:59392
  v_mfma_f32_16x16x32_bf16 v[40:43], a[100:103], v[16:19], v[40:43]
  v_mfma_f32_16x16x32_bf16 v[48:51], a[228:231], v[16:19], v[48:51]
  v_mfma_f32_16x16x32_bf16 v[52:55], v[12:15], v[228:231], v[52:55]
  v_mfma_f32_16x16x32_bf16 v[56:59], v[16:19], v[228:231], v[56:59]
  s_waitcnt lgkmcnt(4)
  v_mfma_f32_16x16x32_bf16 v[36:39], a[104:107], v[20:23], v[36:39]
  ds_read_b128 v[12:15], v82 offset:57344
  v_mfma_f32_16x16x32_bf16 v[44:47], a[232:235], v[20:23], v[44:47]
  ds_read_b128 v[16:19], v82 offset:59392
  v_mfma_f32_16x16x32_bf16 v[40:43], a[104:107], v[24:27], v[40:43]
  v_mfma_f32_16x16x32_bf16 v[48:51], a[232:235], v[24:27], v[48:51]
  v_mfma_f32_16x16x32_bf16 v[52:55], v[20:23], v[232:235], v[52:55]
  v_mfma_f32_16x16x32_bf16 v[56:59], v[24:27], v[232:235], v[56:59]
  s_waitcnt lgkmcnt(4)
  v_mfma_f32_16x16x32_bf16 v[36:39], a[108:111], v[28:31], v[36:39]
  ds_read_b128 v[20:23], v81 offset:61440
  v_mfma_f32_16x16x32_bf16 v[44:47], a[236:239], v[28:31], v[44:47]
  ds_read_b128 v[24:27], v81 offset:63488
  v_mfma_f32_16x16x32_bf16 v[40:43], a[108:111], v[32:35], v[40:43]
  v_mfma_f32_16x16x32_bf16 v[48:51], a[236:239], v[32:35], v[48:51]
  v_mfma_f32_16x16x32_bf16 v[52:55], v[28:31], v[236:239], v[52:55]
  v_mfma_f32_16x16x32_bf16 v[56:59], v[32:35], v[236:239], v[56:59]
  s_waitcnt lgkmcnt(4)
  v_mfma_f32_16x16x32_bf16 v[36:39], a[112:115], v[4:7], v[36:39]
  ds_read_b128 v[28:31], v82 offset:61440
  v_mfma_f32_16x16x32_bf16 v[44:47], a[240:243], v[4:7], v[44:47]
  ds_read_b128 v[32:35], v82 offset:63488
  v_mfma_f32_16x16x32_bf16 v[40:43], a[112:115], v[8:11], v[40:43]
  v_mfma_f32_16x16x32_bf16 v[48:51], a[240:243], v[8:11], v[48:51]
  v_mfma_f32_16x16x32_bf16 v[52:55], v[4:7], v[240:243], v[52:55]
  v_mfma_f32_16x16x32_bf16 v[56:59], v[8:11], v[240:243], v[56:59]
  s_waitcnt vmcnt(0)
  s_barrier
  v_xor_b32 v81, 0x10000, v81
  v_xor_b32 v82, 0x10000, v82
  s_waitcnt lgkmcnt(4)
  v_mfma_f32_16x16x32_bf16 v[36:39], a[116:119], v[12:15], v[36:39]
  ds_read_b128 v[4:7], v81 offset:0
  v_mfma_f32_16x16x32_bf16 v[44:47], a[244:247], v[12:15], v[44:47]
  ds_read_b128 v[8:11], v81 offset:2048
  v_mfma_f32_16x16x32_bf16 v[40:43], a[116:119], v[16:19], v[40:43]
  v_mfma_f32_16x16x32_bf16 v[48:51], a[244:247], v[16:19], v[48:51]
  v_mfma_f32_16x16x32_bf16 v[52:55], v[12:15], v[244:247], v[52:55]
  v_mfma_f32_16x16x32_bf16 v[56:59], v[16:19], v[244:247], v[56:59]
  s_waitcnt lgkmcnt(4)
  v_mfma_f32_16x16x32_bf16 v[36:39], a[120:123], v[20:23], v[36:39]
  ds_read_b128 v[12:15], v82 offset:0
  v_mfma_f32_16x16x32_bf16 v[44:47], a[248:251], v[20:23], v[44:47]
  ds_read_b128 v[16:19], v82 offset:2048
  v_mfma_f32_16x16x32_bf16 v[40:43], a[120:123], v[24:27], v[40:43]
  v_mfma_f32_16x16x32_bf16 v[48:51], a[248:251], v[24:27], v[48:51]
  v_mfma_f32_16x16x32_bf16 v[52:55], v[20:23], v[248:251], v[52:55]
  v_mfma_f32_16x16x32_bf16 v[56:59], v[24:27], v[248:251], v[56:59]
  s_waitcnt lgkmcnt(4)
  v_mfma_f32_16x16x32_bf16 v[36:39], a[124:127], v[28:31], v[36:39]
  ds_read_b128 v[20:23], v81 offset:4096
  v_mfma_f32_16x16x32_bf16 v[44:47], a[252:255], v[28:31], v[44:47]
  ds_read_b128 v[24:27], v81 offset:6144
  v_mfma_f32_16x16x32_bf16 v[40:43], a[124:127], v[32:35], v[40:43]
  v_mfma_f32_16x16x32_bf16 v[48:51], a[252:255], v[32:35], v[48:51]
  v_mfma_f32_16x16x32_bf16 v[52:55], v[28:31], v[252:255], v[52:55]
  v_mfma_f32_16x16x32_bf16 v[56:59], v[32:35], v[252:255], v[56:59]
  s_mov_b32 s37, s31
  s_add_u32 s31, s31, 2097152
  s_xor_b32 s31, s31, 0x2000
  s_add_u32 s25, s25, 1
  s_cmp_lt_u32 s25, 64
  s_cbranch_scc1 L_QKV_top
  v_cvt_pk_bf16_f32 v60, v36, v37
  v_cvt_pk_bf16_f32 v61, v38, v39
  v_cvt_pk_bf16_f32 v62, v44, v45
  v_cvt_pk_bf16_f32 v63, v46, v47
  v_cvt_pk_bf16_f32 v64, v40, v41
  v_cvt_pk_bf16_f32 v65, v42, v43
  v_cvt_pk_bf16_f32 v66, v48, v49
  v_cvt_pk_bf16_f32 v67, v50, v51
  v_cvt_pk_bf16_f32 v68, v52, v53
  v_cvt_pk_bf16_f32 v69, v54, v55
  v_cvt_pk_bf16_f32 v70, v56, v57
  v_cvt_pk_bf16_f32 v71, v58, v59
  buffer_store_dwordx4 v[60:63], v76, s[4:7], s37 offen offset:0 sc1
  buffer_store_dwordx4 v[64:67], v76, s[4:7], s37 offen offset:1024 sc1
  buffer_store_dwordx4 v[68:71], v83, s[4:7], s37 offen sc1
  s_waitcnt vmcnt(0) lgkmcnt(0)
  s_barrier
  s_cmp_lg_u32 s20, 0
  s_cbranch_scc1 Lnosig_129
  s_mov_b32 s63, s25
  s_atomic_smax s63, s[4:5], s62 glc
Lnosig_129:
  s_branch L_END
L_WO:
  v_lshlrev_b32 v1, 4, v0
  s_lshl_b32 s32, s20, 12
  s_min_u32 s33, s32, 0x2000
  v_mov_b32 v69, v1
  v_add_u32 v70, 0x10000, v69
  s_load_dwordx2 s[8:9], s[0:1], 40
  s_mov_b32 s10, 8388608
  s_mov_b32 s11, 0x20000
  s_waitcnt lgkmcnt(0)
  s_lshr_b32 s44, s21, 3
  s_mul_i32 s44, s44, 2097152
  s_and_b32 s45, s21, 7
  s_lshl_b32 s45, s45, 8
  s_add_u32 s44, s44, s45
  s_add_u32 s45, s44, 128
  v_bfe_u32 v4, v0, 5, 1
  v_mul_u32_u24 v4, 8192, v4
  v_bfe_u32 v5, v0, 4, 1
  v_mul_u32_u24 v5, 4096, v5
  v_add_u32 v4, v4, v5
  v_bfe_u32 v5, v0, 3, 1
  v_mul_u32_u24 v5, 2048, v5
  v_add_u32 v4, v4, v5
  v_lshrrev_b32 v5, 3, v0
  v_and_b32 v5, 6, v5
  v_xor_b32 v5, v5, v0
  v_and_b32 v5, 7, v5
  v_lshl_add_u32 v4, v5, 4, v4
  s_lshr_b32 s40, s20, 1
  s_mul_i32 s40, s40, 131072
  s_and_b32 s41, s20, 1
  s_mul_i32 s41, s41, 16384
  s_add_u32 s40, s40, s41
  v_add_u32 v4, s40, v4
  v_bfe_u32 v5, v0, 3, 2
  v_xor_b32 v5, s20, v5
  v_lshlrev_b32 v5, 5, v5
  v_lshrrev_b32 v6, 2, v0
  v_lshl_add_u32 v6, v6, 7, v5
  v_and_b32 v5, 3, v0
  v_lshl_add_u32 v6, v5, 3, v6
  v_add_u32 v7, 0x10000, v6
  v_add_u32 v8, s44, v4
  v_add_u32 v9, s45, v4
  s_lshl_b32 s41, s20, 10
  s_add_u32 m0, s41, 0
  s_mov_b32 s42, 0
  buffer_load_dwordx4 v8, s[8:11], s42 offen nt lds
  s_add_u32 m0, s41, 4096
  s_mov_b32 s42, 0
  buffer_load_dwordx4 v9, s[8:11], s42 offen nt lds
  s_add_u32 m0, s41, 8192
  s_mov_b32 s42, 32768
  buffer_load_dwordx4 v8, s[8:11], s42 offen nt lds
  s_add_u32 m0, s41, 12288
  s_mov_b32 s42, 32768
  buffer_load_dwordx4 v9, s[8:11], s42 offen nt lds
  s_add_u32 m0, s41, 16384
  s_mov_b32 s42, 65536
  buffer_load_dwordx4 v8, s[8:11], s42 offen nt lds
  s_add_u32 m0, s41, 20480
  s_mov_b32 s42, 65536
  buffer_load_dwordx4 v9, s[8:11], s42 offen nt lds
  s_add_u32 m0, s41, 24576
  s_mov_b32 s42, 98304
  buffer_load_dwordx4 v8, s[8:11], s42 offen nt lds
  s_add_u32 m0, s41, 28672
  s_mov_b32 s42, 98304
  buffer_load_dwordx4 v9, s[8:11], s42 offen nt lds
  s_add_u32 m0, s41, 32768
  s_mov_b32 s42, 262144
  buffer_load_dwordx4 v8, s[8:11], s42 offen nt lds
  s_add_u32 m0, s41, 36864
  s_mov_b32 s42, 262144
  buffer_load_dwordx4 v9, s[8:11], s42 offen nt lds
  s_add_u32 m0, s41, 40960
  s_mov_b32 s42, 294912
  buffer_load_dwordx4 v8, s[8:11], s42 offen nt lds
  s_add_u32 m0, s41, 45056
  s_mov_b32 s42, 294912
  buffer_load_dwordx4 v9, s[8:11], s42 offen nt lds
  s_add_u32 m0, s41, 49152
  s_mov_b32 s42, 327680
  buffer_load_dwordx4 v8, s[8:11], s42 offen nt lds
  s_add_u32 m0, s41, 53248
  s_mov_b32 s42, 327680
  buffer_load_dwordx4 v9, s[8:11], s42 offen nt lds
  s_add_u32 m0, s41, 57344
  s_mov_b32 s42, 360448
  buffer_load_dwordx4 v8, s[8:11], s42 offen nt lds
  s_add_u32 m0, s41, 61440
  s_mov_b32 s42, 360448
  buffer_load_dwordx4 v9, s[8:11], s42 offen nt lds
  s_add_u32 m0, s41, 65536
  s_mov_b32 s42, 524288
  buffer_load_dwordx4 v8, s[8:11], s42 offen nt lds
  s_add_u32 m0, s41, 69632
  s_mov_b32 s42, 524288
  buffer_load_dwordx4 v9, s[8:11], s42 offen nt lds
  s_add_u32 m0, s41, 73728
  s_mov_b32 s42, 557056
  buffer_load_dwordx4 v8, s[8:11], s42 offen nt lds
  s_add_u32 m0, s41, 77824
  s_mov_b32 s42, 557056
  buffer_load_dwordx4 v9, s[8:11], s42 offen nt lds
  s_add_u32 m0, s41, 81920
  s_mov_b32 s42, 589824
  buffer_load_dwordx4 v8, s[8:11], s42 offen nt lds
  s_add_u32 m0, s41, 86016
  s_mov_b32 s42, 589824
  buffer_load_dwordx4 v9, s[8:11], s42 offen nt lds
  s_add_u32 m0, s41, 90112
  s_mov_b32 s42, 622592
  buffer_load_dwordx4 v8, s[8:11], s42 offen nt lds
  s_add_u32 m0, s41, 94208
  s_mov_b32 s42, 622592
  buffer_load_dwordx4 v9, s[8:11], s42 offen nt lds
  s_add_u32 m0, s41, 98304
  s_mov_b32 s42, 786432
  buffer_load_dwordx4 v8, s[8:11], s42 offen nt lds
  s_add_u32 m0, s41, 102400
  s_mov_b32 s42, 786432
  buffer_load_dwordx4 v9, s[8:11], s42 offen nt lds
  s_add_u32 m0, s41, 106496
  s_mov_b32 s42, 819200
  buffer_load_dwordx4 v8, s[8:11], s42 offen nt lds
  s_add_u32 m0, s41, 110592
  s_mov_b32 s42, 819200
  buffer_load_dwordx4 v9, s[8:11], s42 offen nt lds
  s_waitcnt vmcnt(24) lgkmcnt(0)
  s_barrier
  s_add_u32 m0, s41, 114688
  s_mov_b32 s42, 851968
  buffer_load_dwordx4 v8, s[8:11], s42 offen nt lds
  s_add_u32 m0, s41, 118784
  s_mov_b32 s42, 851968
  buffer_load_dwordx4 v9, s[8:11], s42 offen nt lds
  s_add_u32 m0, s41, 122880
  s_mov_b32 s42, 884736
  buffer_load_dwordx4 v8, s[8:11], s42 offen nt lds
  s_add_u32 m0, s41, 126976
  s_mov_b32 s42, 884736
  buffer_load_dwordx4 v9, s[8:11], s42 offen nt lds
  ds_read_b64_tr_b16 a[0:1], v6 offset:0
  ds_read_b64_tr_b16 a[2:3], v6 offset:2048
  ds_read_b64_tr_b16 a[128:129], v6 offset:4096
  ds_read_b64_tr_b16 a[130:131], v6 offset:6144
  ds_read_b64_tr_b16 a[4:5], v6 offset:8192
  ds_read_b64_tr_b16 a[6:7], v6 offset:10240
  ds_read_b64_tr_b16 a[132:133], v6 offset:12288
  ds_read_b64_tr_b16 a[134:135], v6 offset:14336
  s_waitcnt vmcnt(24) lgkmcnt(0)
  s_barrier
  s_add_u32 m0, s41, 0
  s_mov_b32 s42, 1048576
  buffer_load_dwordx4 v8, s[8:11], s42 offen nt lds
  s_add_u32 m0, s41, 4096
  s_mov_b32 s42, 1048576
  buffer_load_dwordx4 v9, s[8:11], s42 offen nt lds
  s_add_u32 m0, s41, 8192
  s_mov_b32 s42, 1081344
  buffer_load_dwordx4 v8, s[8:11], s42 offen nt lds
  s_add_u32 m0, s41, 12288
  s_mov_b32 s42, 1081344
  buffer_load_dwordx4 v9, s[8:11], s42 offen nt lds
  ds_read_b64_tr_b16 a[8:9], v6 offset:16384
  ds_read_b64_tr_b16 a[10:11], v6 offset:18432
  ds_read_b64_tr_b16 a[136:137], v6 offset:20480
  ds_read_b64_tr_b16 a[138:139], v6 offset:22528
  ds_read_b64_tr_b16 a[12:13], v6 offset:24576
  ds_read_b64_tr_b16 a[14:15], v6 offset:26624
  ds_read_b64_tr_b16 a[140:141], v6 offset:28672
  ds_read_b64_tr_b16 a[142:143], v6 offset:30720
  s_waitcnt vmcnt(24) lgkmcnt(0)
  s_barrier
  s_add_u32 m0, s41, 16384
  s_mov_b32 s42, 1114112
  buffer_load_dwordx4 v8, s[8:11], s42 offen nt lds
  s_add_u32 m0, s41, 20480
  s_mov_b32 s42, 1114112
  buffer_load_dwordx4 v9, s[8:11], s42 offen nt lds
  s_add_u32 m0, s41, 24576
  s_mov_b32 s42, 1146880
  buffer_load_dwordx4 v8, s[8:11], s42 offen nt lds
  s_add_u32 m0, s41, 28672
  s_mov_b32 s42, 1146880
  buffer_load_dwordx4 v9, s[8:11], s42 offen nt lds
  ds_read_b64_tr_b16 a[16:17], v6 offset:32768
  ds_read_b64_tr_b16 a[18:19], v6 offset:34816
  ds_read_b64_tr_b16 a[144:145], v6 offset:36864
  ds_read_b64_tr_b16 a[146:147], v6 offset:38912
  ds_read_b64_tr_b16 a[20:21], v6 offset:40960
  ds_read_b64_tr_b16 a[22:23], v6 offset:43008
  ds_read_b64_tr_b16 a[148:149], v6 offset:45056
  ds_read_b64_tr_b16 a[150:151], v6 offset:47104
  s_waitcnt vmcnt(24) lgkmcnt(0)
  s_barrier
  s_add_u32 m0, s41, 32768
  s_mov_b32 s42, 1310720
  buffer_load_dwordx4 v8, s[8:11], s42 offen nt lds
  s_add_u32 m0, s41, 36864
  s_mov_b32 s42, 1310720
  buffer_load_dwordx4 v9, s[8:11], s42 offen nt lds
  s_add_u32 m0, s41, 40960
  s_mov_b32 s42, 1343488
  buffer_load_dwordx4 v8, s[8:11], s42 offen nt lds
  s_add_u32 m0, s41, 45056
  s_mov_b32 s42, 1343488
  buffer_load_dwordx4 v9, s[8:11], s42 offen nt lds
  ds_read_b64_tr_b16 a[24:25], v6 offset:49152
  ds_read_b64_tr_b16 a[26:27], v6 offset:51200
  ds_read_b64_tr_b16 a[152:153], v6 offset:53248
  ds_read_b64_tr_b16 a[154:155], v6 offset:55296
  ds_read_b64_tr_b16 a[28:29], v6 offset:57344
  ds_read_b64_tr_b16 a[30:31], v6 offset:59392
  ds_read_b64_tr_b16 a[156:157], v6 offset:61440
  ds_read_b64_tr_b16 a[158:159], v6 offset:63488
  s_waitcnt vmcnt(24) lgkmcnt(0)
  s_barrier
  s_add_u32 m0, s41, 49152
  s_mov_b32 s42, 1376256
  buffer_load_dwordx4 v8, s[8:11], s42 offen nt lds
  s_add_u32 m0, s41, 53248
  s_mov_b32 s42, 1376256
  buffer_load_dwordx4 v9, s[8:11], s42 offen nt lds
  s_add_u32 m0, s41, 57344
  s_mov_b32 s42, 1409024
  buffer_load_dwordx4 v8, s[8:11], s42 offen nt lds
  s_add_u32 m0, s41, 61440
  s_mov_b32 s42, 1409024
  buffer_load_dwordx4 v9, s[8:11], s42 offen nt lds
  ds_read_b64_tr_b16 a[32:33], v7 offset:0
  ds_read_b64_tr_b16 a[34:35], v7 offset:2048
  ds_read_b64_tr_b16 a[160:161], v7 offset:4096
  ds_read_b64_tr_b16 a[162:163], v7 offset:6144
  ds_read_b64_tr_b16 a[36:37], v7 offset:8192
  ds_read_b64_tr_b16 a[38:39], v7 offset:10240
  ds_read_b64_tr_b16 a[164:165], v7 offset:12288
  ds_read_b64_tr_b16 a[166:167], v7 offset:14336
  s_waitcnt vmcnt(24) lgkmcnt(0)
  s_barrier
  s_add_u32 m0, s41, 65536
  s_mov_b32 s42, 1572864
  buffer_load_dwordx4 v8, s[8:11], s42 offen nt lds
  s_add_u32 m0, s41, 69632
  s_mov_b32 s42, 1572864
  buffer_load_dwordx4 v9, s[8:11], s42 offen nt lds
  s_add_u32 m0, s41, 73728
  s_mov_b32 s42, 1605632
  buffer_load_dwordx4 v8, s[8:11], s42 offen nt lds
  s_add_u32 m0, s41, 77824
  s_mov_b32 s42, 1605632
  buffer_load_dwordx4 v9, s[8:11], s42 offen nt lds
  ds_read_b64_tr_b16 a[40:41], v7 offset:16384
  ds_read_b64_tr_b16 a[42:43], v7 offset:18432
  ds_read_b64_tr_b16 a[168:169], v7 offset:20480
  ds_read_b64_tr_b16 a[170:171], v7 offset:22528
  ds_read_b64_tr_b16 a[44:45], v7 offset:24576
  ds_read_b64_tr_b16 a[46:47], v7 offset:26624
  ds_read_b64_tr_b16 a[172:173], v7 offset:28672
  ds_read_b64_tr_b16 a[174:175], v7 offset:30720
  s_waitcnt vmcnt(24) lgkmcnt(0)
  s_barrier
  s_add_u32 m0, s41, 81920
  s_mov_b32 s42, 1638400
  buffer_load_dwordx4 v8, s[8:11], s42 offen nt lds
  s_add_u32 m0, s41, 86016
  s_mov_b32 s42, 1638400
  buffer_load_dwordx4 v9, s[8:11], s42 offen nt lds
  s_add_u32 m0, s41, 90112
  s_mov_b32 s42, 1671168
  buffer_load_dwordx4 v8, s[8:11], s42 offen nt lds
  s_add_u32 m0, s41, 94208
  s_mov_b32 s42, 1671168
  buffer_load_dwordx4 v9, s[8:11], s42 offen nt lds
  ds_read_b64_tr_b16 a[48:49], v7 offset:32768
  ds_read_b64_tr_b16 a[50:51], v7 offset:34816
  ds_read_b64_tr_b16 a[176:177], v7 offset:36864
  ds_read_b64_tr_b16 a[178:179], v7 offset:38912
  ds_read_b64_tr_b16 a[52:53], v7 offset:40960
  ds_read_b64_tr_b16 a[54:55], v7 offset:43008
  ds_read_b64_tr_b16 a[180:181], v7 offset:45056
  ds_read_b64_tr_b16 a[182:183], v7 offset:47104
  s_waitcnt vmcnt(24) lgkmcnt(0)
  s_barrier
  s_add_u32 m0, s41, 98304
  s_mov_b32 s42, 1835008
  buffer_load_dwordx4 v8, s[8:11], s42 offen nt lds
  s_add_u32 m0, s41, 102400
  s_mov_b32 s42, 1835008
  buffer_load_dwordx4 v9, s[8:11], s42 offen nt lds
  s_add_u32 m0, s41, 106496
  s_mov_b32 s42, 1867776
  buffer_load_dwordx4 v8, s[8:11], s42 offen nt lds
  s_add_u32 m0, s41, 110592
  s_mov_b32 s42, 1867776
  buffer_load_dwordx4 v9, s[8:11], s42 offen nt lds
  ds_read_b64_tr_b16 a[56:57], v7 offset:49152
  ds_read_b64_tr_b16 a[58:59], v7 offset:51200
  ds_read_b64_tr_b16 a[184:185], v7 offset:53248
  ds_read_b64_tr_b16 a[186:187], v7 offset:55296
  ds_read_b64_tr_b16 a[60:61], v7 offset:57344
  ds_read_b64_tr_b16 a[62:63], v7 offset:59392
  ds_read_b64_tr_b16 a[188:189], v7 offset:61440
  ds_read_b64_tr_b16 a[190:191], v7 offset:63488
  s_waitcnt vmcnt(24) lgkmcnt(0)
  s_barrier
  s_add_u32 m0, s41, 114688
  s_mov_b32 s42, 1900544
  buffer_load_dwordx4 v8, s[8:11], s42 offen nt lds
  s_add_u32 m0, s41, 118784
  s_mov_b32 s42, 1900544
  buffer_load_dwordx4 v9, s[8:11], s42 offen nt lds
  s_add_u32 m0, s41, 122880
  s_mov_b32 s42, 1933312
  buffer_load_dwordx4 v8, s[8:11], s42 offen nt lds
  s_add_u32 m0, s41, 126976
  s_mov_b32 s42, 1933312
  buffer_load_dwordx4 v9, s[8:11], s42 offen nt lds
  ds_read_b64_tr_b16 a[64:65], v6 offset:0
  ds_read_b64_tr_b16 a[66:67], v6 offset:2048
  ds_read_b64_tr_b16 a[192:193], v6 offset:4096
  ds_read_b64_tr_b16 a[194:195], v6 offset:6144
  ds_read_b64_tr_b16 a[68:69], v6 offset:8192
  ds_read_b64_tr_b16 a[70:71], v6 offset:10240
  ds_read_b64_tr_b16 a[196:197], v6 offset:12288
  ds_read_b64_tr_b16 a[198:199], v6 offset:14336
  s_waitcnt vmcnt(24) lgkmcnt(0)
  s_barrier
  ds_read_b64_tr_b16 a[72:73], v6 offset:16384
  ds_read_b64_tr_b16 a[74:75], v6 offset:18432
  ds_read_b64_tr_b16 a[200:201], v6 offset:20480
  ds_read_b64_tr_b16 a[202:203], v6 offset:22528
  ds_read_b64_tr_b16 a[76:77], v6 offset:24576
  ds_read_b64_tr_b16 a[78:79], v6 offset:26624
  ds_read_b64_tr_b16 a[204:205], v6 offset:28672
  ds_read_b64_tr_b16 a[206:207], v6 offset:30720
  s_waitcnt vmcnt(20) lgkmcnt(0)
  s_barrier
  ds_read_b64_tr_b16 a[80:81], v6 offset:32768
  ds_read_b64_tr_b16 a[82:83], v6 offset:34816
  ds_read_b64_tr_b16 a[208:209], v6 offset:36864
  ds_read_b64_tr_b16 a[210:211], v6 offset:38912
  ds_read_b64_tr_b16 a[84:85], v6 offset:40960
  ds_read_b64_tr_b16 a[86:87], v6 offset:43008
  ds_read_b64_tr_b16 a[212:213], v6 offset:45056
  ds_read_b64_tr_b16 a[214:215], v6 offset:47104
  s_waitcnt vmcnt(16) lgkmcnt(0)
  s_barrier
  ds_read_b64_tr_b16 a[88:89], v6 offset:49152
  ds_read_b64_tr_b16 a[90:91], v6 offset:51200
  ds_read_b64_tr_b16 a[216:217], v6 offset:53248
  ds_read_b64_tr_b16 a[218:219], v6 offset:55296
  ds_read_b64_tr_b16 a[92:93], v6 offset:57344
  ds_read_b64_tr_b16 a[94:95], v6 offset:59392
  ds_read_b64_tr_b16 a[220:221], v6 offset:61440
  ds_read_b64_tr_b16 a[222:223], v6 offset:63488
  s_waitcnt vmcnt(12) lgkmcnt(0)
  s_barrier
  ds_read_b64_tr_b16 a[96:97], v7 offset:0
  ds_read_b64_tr_b16 a[98:99], v7 offset:2048
  ds_read_b64_tr_b16 a[224:225], v7 offset:4096
  ds_read_b64_tr_b16 a[226:227], v7 offset:6144
  ds_read_b64_tr_b16 a[100:101], v7 offset:8192
  ds_read_b64_tr_b16 a[102:103], v7 offset:10240
  ds_read_b64_tr_b16 a[228:229], v7 offset:12288
  ds_read_b64_tr_b16 a[230:231], v7 offset:14336
  s_waitcnt vmcnt(8) lgkmcnt(0)
  s_barrier
  ds_read_b64_tr_b16 a[104:105], v7 offset:16384
  ds_read_b64_tr_b16 a[106:107], v7 offset:18432
  ds_read_b64_tr_b16 a[232:233], v7 offset:20480
  ds_read_b64_tr_b16 a[234:235], v7 offset:22528
  ds_read_b64_tr_b16 a[108:109], v7 offset:24576
  ds_read_b64_tr_b16 a[110:111], v7 offset:26624
  ds_read_b64_tr_b16 a[236:237], v7 offset:28672
  ds_read_b64_tr_b16 a[238:239], v7 offset:30720
  s_waitcnt vmcnt(4) lgkmcnt(0)
  s_barrier
  ds_read_b64_tr_b16 a[112:113], v7 offset:32768
  ds_read_b64_tr_b16 a[114:115], v7 offset:34816
  ds_read_b64_tr_b16 a[240:241], v7 offset:36864
  ds_read_b64_tr_b16 a[242:243], v7 offset:38912
  ds_read_b64_tr_b16 a[116:117], v7 offset:40960
  ds_read_b64_tr_b16 a[118:119], v7 offset:43008
  ds_read_b64_tr_b16 a[244:245], v7 offset:45056
  ds_read_b64_tr_b16 a[246:247], v7 offset:47104
  s_waitcnt vmcnt(0) lgkmcnt(0)
  s_barrier
  ds_read_b64_tr_b16 a[120:121], v7 offset:49152
  ds_read_b64_tr_b16 a[122:123], v7 offset:51200
  ds_read_b64_tr_b16 a[248:249], v7 offset:53248
  ds_read_b64_tr_b16 a[250:251], v7 offset:55296
  ds_read_b64_tr_b16 a[124:125], v7 offset:57344
  ds_read_b64_tr_b16 a[126:127], v7 offset:59392
  ds_read_b64_tr_b16 a[252:253], v7 offset:61440
  ds_read_b64_tr_b16 a[254:255], v7 offset:63488
  s_waitcnt lgkmcnt(0)
  s_barrier
  s_and_b32 s43, s21, 24
  v_min_u32 v2, 7, v0
  v_add_u32 v2, s43, v2
  v_lshlrev_b32 v2, 7, v2
  v_add_u32 v2, 1404928, v2
  s_lshl_b32 s62, s21, 7
  s_add_u32 s62, s62, 1409024
  v_min_u32 v52, 63, v0
  v_lshlrev_b32 v52, 7, v52
  v_add_u32 v52, 1424384, v52
  s_nop 1
Lpoll_130:
  buffer_load_dword v53, v52, s[4:7], 0 offen sc1
  s_sub_u32 s24, s24, 1
  s_cbranch_scc1 L_FAIL
  s_waitcnt vmcnt(0)
  v_cmp_gt_i32 vcc, 0, v53
  s_cbranch_vccz Lpolld_131
  s_sleep 1
  s_branch Lpoll_130
Lpolld_131:
  v_lshrrev_b32 v53, 8, v53
  v_and_b32 v54, 3, v0
  v_lshl_or_b32 v53, v53, 2, v54
  s_nop 1
  v_min_u32_dpp v53, v53, v53 row_ror:8 row_mask:0xf bank_mask:0xf
  s_nop 1
  v_min_u32_dpp v53, v53, v53 row_ror:4 row_mask:0xf bank_mask:0xf
  v_mov_b32 v54, v53
  s_nop 1
  v_permlane16_swap_b32 v54, v53
  v_min_u32 v53, v53, v54
  v_mov_b32 v54, v53
  s_nop 1
  v_permlane32_swap_b32 v54, v53
  v_min_u32 v53, v53, v54
  s_nop 1
  v_min_u32_dpp v53, v53, v53 row_ror:2 row_mask:0xf bank_mask:0xf
  s_nop 1
  v_min_u32_dpp v53, v53, v53 row_ror:1 row_mask:0xf bank_mask:0xf
  s_nop 0
  v_readfirstlane_b32 s38, v53
  s_and_b32 s38, s38, 3
  s_lshl_b32 s38, s38, 13
  s_and_b32 s38, s38, 0x2000
  s_xor_b32 s38, s38, 20979712
  s_xor_b32 s27, s38, 0x2000
  s_lshr_b32 s40, s20, 1
  s_add_u32 s40, s40, s43
  s_mul_i32 s40, s40, 65536
  s_and_b32 s41, s20, 1
  s_lshl_b32 s41, s41, 12
  s_add_u32 s40, s40, s41
  s_add_u32 s40, s40, 49152
  s_add_u32 s27, s27, s40
  s_lshl_b32 s40, s21, 14
  s_add_u32 s40, s40, s38
  s_add_u32 s31, s40, 0
  s_lshl_b32 s40, s20, 11
  v_and_b32 v68, 3, v0
  v_lshlrev_b32 v68, 4, v68
  v_lshrrev_b32 v52, 4, v0
  v_lshl_add_u32 v68, v52, 6, v68
  v_bfe_u32 v52, v0, 2, 2
  v_lshl_add_u32 v68, v52, 8, v68
  v_add_u32 v68, s40, v68
  v_lshlrev_b32 v71, 2, v0
  v_add_u32 v71, 131072, v71
  s_mov_b32 s25, 0
  s_mov_b32 s26, 0
  s_mov_b32 s29, 1
  s_mov_b32 s30, 0
  s_mov_b32 s28, 0
L_WO_top:
  s_cmp_eq_u32 s28, 1
  s_cbranch_scc1 L_WO_go
  s_cmp_eq_u32 s28, 2
  s_cbranch_scc1 L_WO_mid
  s_cmp_lg_u32 s20, 0
  s_cbranch_scc1 L_WO_park
  buffer_load_dword v3, v2, s[4:7], s30 offen sc1
  s_waitcnt vmcnt(1)
  s_barrier
  s_mov_b32 s63, s25
  s_atomic_smax s63, s[4:5], s62 glc
Lnosig_132:
  s_cmp_ge_u32 s25, 64
  s_cbranch_scc1 L_END
  s_waitcnt vmcnt(0)
  v_cmp_gt_i32 vcc, s29, v3
  s_cbranch_vccz L_WO_issue
  s_nop 3
Lpoll_133:
  buffer_load_dword v3, v2, s[4:7], s30 offen sc1
  s_sub_u32 s24, s24, 1
  s_cbranch_scc1 L_FAIL
  s_waitcnt vmcnt(0)
  v_cmp_gt_i32 vcc, s29, v3
  s_cbranch_vccz Lpolld_134
  s_sleep 1
  s_branch Lpoll_133
Lpolld_134:
  s_branch L_WO_issue
L_WO_park:
  s_waitcnt vmcnt(0)
  s_barrier
  s_cmp_ge_u32 s25, 64
  s_cbranch_scc1 L_END
L_WO_issue:
  s_barrier
L_WO_mid:
  s_mov_b32 s34, s26
  s_mov_b32 s35, s27
  s_add_u32 s36, s32, 0
  s_add_u32 m0, s34, s36
  s_add_u32 s36, s35, 0
  buffer_load_dwordx4 v1, s[4:7], s36 offen offset:0 sc1 lds
  s_nop 0
  buffer_load_dwordx4 v1, s[4:7], s36 offen offset:1024 sc1 lds
  s_nop 0
  buffer_load_dwordx4 v1, s[4:7], s36 offen offset:2048 sc1 lds
  s_nop 0
  buffer_load_dwordx4 v1, s[4:7], s36 offen offset:3072 sc1 lds
  s_nop 0
  s_add_u32 s36, s32, 16384
  s_add_u32 m0, s34, s36
  s_add_u32 s36, s35, 131072
  buffer_load_dwordx4 v1, s[4:7], s36 offen offset:0 sc1 lds
  s_nop 0
  buffer_load_dwordx4 v1, s[4:7], s36 offen offset:1024 sc1 lds
  s_nop 0
  buffer_load_dwordx4 v1, s[4:7], s36 offen offset:2048 sc1 lds
  s_nop 0
  buffer_load_dwordx4 v1, s[4:7], s36 offen offset:3072 sc1 lds
  s_nop 0
  s_add_u32 s36, s32, 32768
  s_add_u32 m0, s34, s36
  s_add_u32 s36, s35, 262144
  buffer_load_dwordx4 v1, s[4:7], s36 offen offset:0 sc1 lds
  s_nop 0
  buffer_load_dwordx4 v1, s[4:7], s36 offen offset:1024 sc1 lds
  s_nop 0
  buffer_load_dwordx4 v1, s[4:7], s36 offen offset:2048 sc1 lds
  s_nop 0
  buffer_load_dwordx4 v1, s[4:7], s36 offen offset:3072 sc1 lds
  s_nop 0
  s_cmp_eq_u32 s28, 0
  s_cbranch_scc1 L_WO_go
  s_mov_b32 s28, 0
  s_waitcnt vmcnt(12)
  s_barrier
  s_cmp_lg_u32 s20, 0
  s_cbranch_scc1 Lnosig_135
  s_mov_b32 s63, s25
  s_atomic_smax s63, s[4:5], s62 glc
Lnosig_135:
L_WO_go:
  v_add_u32 v73, s26, v69
  v_add_u32 v74, s26, v70
  s_sub_u32 s26, 65536, s26
  s_add_u32 s27, s27, 2097152
  s_xor_b32 s27, s27, 0x2000
  s_add_u32 s29, s29, 1
  s_waitcnt vmcnt(8)
  s_barrier
  ds_read_b128 v[4:7], v73 offset:0
  ds_read_b128 v[8:11], v73 offset:1024
  ds_read_b128 v[12:15], v73 offset:2048
  ds_read_b128 v[16:19], v73 offset:3072
  ds_read_b128 v[20:23], v73 offset:4096
  ds_read_b128 v[24:27], v73 offset:5120
  s_waitcnt lgkmcnt(4)
  v_mfma_f32_16x16x32_bf16 v[36:39], a[0:3], v[4:7], 0
  ds_read_b128 v[28:31], v73 offset:6144
  v_mfma_f32_16x16x32_bf16 v[40:43], a[0:3], v[8:11], 0
  ds_read_b128 v[32:35], v73 offset:7168
  v_mfma_f32_16x16x32_bf16 v[44:47], a[128:131], v[4:7], 0
  s_add_u32 s36, s32, 49152
  s_add_u32 m0, s34, s36
  s_add_u32 s36, s35, 393216
  buffer_load_dwordx4 v1, s[4:7], s36 offen offset:0 sc1 lds
  v_mfma_f32_16x16x32_bf16 v[48:51], a[128:131], v[8:11], 0
  s_waitcnt lgkmcnt(4)
  v_mfma_f32_16x16x32_bf16 v[36:39], a[4:7], v[12:15], v[36:39]
  ds_read_b128 v[4:7], v73 offset:8192
  v_mfma_f32_16x16x32_bf16 v[40:43], a[4:7], v[16:19], v[40:43]
  ds_read_b128 v[8:11], v73 offset:9216
  v_mfma_f32_16x16x32_bf16 v[44:47], a[132:135], v[12:15], v[44:47]
  buffer_load_dwordx4 v1, s[4:7], s36 offen offset:1024 sc1 lds
  v_mfma_f32_16x16x32_bf16 v[48:51], a[132:135], v[16:19], v[48:51]
  s_waitcnt lgkmcnt(4)
  v_mfma_f32_16x16x32_bf16 v[36:39], a[8:11], v[20:23], v[36:39]
  ds_read_b128 v[12:15], v73 offset:10240
  v_mfma_f32_16x16x32_bf16 v[40:43], a[8:11], v[24:27], v[40:43]
  ds_read_b128 v[16:19], v73 offset:11264
  v_mfma_f32_16x16x32_bf16 v[44:47], a[136:139], v[20:23], v[44:47]
  buffer_load_dwordx4 v1, s[4:7], s36 offen offset:2048 sc1 lds
  v_mfma_f32_16x16x32_bf16 v[48:51], a[136:139], v[24:27], v[48:51]
  s_waitcnt lgkmcnt(4)
  v_mfma_f32_16x16x32_bf16 v[36:39], a[12:15], v[28:31], v[36:39]
  ds_read_b128 v[20:23], v73 offset:12288
  v_mfma_f32_16x16x32_bf16 v[40:43], a[12:15], v[32:35], v[40:43]
  ds_read_b128 v[24:27], v73 offset:13312
  v_mfma_f32_16x16x32_bf16 v[44:47], a[140:143], v[28:31], v[44:47]
  buffer_load_dwordx4 v1, s[4:7], s36 offen offset:3072 sc1 lds
  v_mfma_f32_16x16x32_bf16 v[48:51], a[140:143], v[32:35], v[48:51]
  s_waitcnt lgkmcnt(4)
  v_mfma_f32_16x16x32_bf16 v[36:39], a[16:19], v[4:7], v[36:39]
  ds_read_b128 v[28:31], v73 offset:14336
  v_mfma_f32_16x16x32_bf16 v[40:43], a[16:19], v[8:11], v[40:43]
  ds_read_b128 v[32:35], v73 offset:15360
  v_mfma_f32_16x16x32_bf16 v[44:47], a[144:147], v[4:7], v[44:47]
  v_mfma_f32_16x16x32_bf16 v[48:51], a[144:147], v[8:11], v[48:51]
  s_waitcnt vmcnt(8)
  s_barrier
  s_mov_b32 s34, s26
  s_mov_b32 s35, s27
  s_waitcnt lgkmcnt(4)
  v_mfma_f32_16x16x32_bf16 v[36:39], a[20:23], v[12:15], v[36:39]
  ds_read_b128 v[4:7], v73 offset:16384
  v_mfma_f32_16x16x32_bf16 v[40:43], a[20:23], v[16:19], v[40:43]
  ds_read_b128 v[8:11], v73 offset:17408
  v_mfma_f32_16x16x32_bf16 v[44:47], a[148:151], v[12:15], v[44:47]
  v_mfma_f32_16x16x32_bf16 v[48:51], a[148:151], v[16:19], v[48:51]
  s_waitcnt lgkmcnt(4)
  v_mfma_f32_16x16x32_bf16 v[36:39], a[24:27], v[20:23], v[36:39]
  ds_read_b128 v[12:15], v73 offset:18432
  v_mfma_f32_16x16x32_bf16 v[40:43], a[24:27], v[24:27], v[40:43]
  ds_read_b128 v[16:19], v73 offset:19456
  v_mfma_f32_16x16x32_bf16 v[44:47], a[152:155], v[20:23], v[44:47]
  v_mfma_f32_16x16x32_bf16 v[48:51], a[152:155], v[24:27], v[48:51]
  s_waitcnt lgkmcnt(4)
  v_mfma_f32_16x16x32_bf16 v[36:39], a[28:31], v[28:31], v[36:39]
  ds_read_b128 v[20:23], v73 offset:20480
  v_mfma_f32_16x16x32_bf16 v[40:43], a[28:31], v[32:35], v[40:43]
  ds_read_b128 v[24:27], v73 offset:21504
  v_mfma_f32_16x16x32_bf16 v[44:47], a[156:159], v[28:31], v[44:47]
  v_mfma_f32_16x16x32_bf16 v[48:51], a[156:159], v[32:35], v[48:51]
  s_waitcnt lgkmcnt(4)
  v_mfma_f32_16x16x32_bf16 v[36:39], a[32:35], v[4:7], v[36:39]
  ds_read_b128 v[28:31], v73 offset:22528
  v_mfma_f32_16x16x32_bf16 v[40:43], a[32:35], v[8:11], v[40:43]
  ds_read_b128 v[32:35], v73 offset:23552
  v_mfma_f32_16x16x32_bf16 v[44:47], a[160:163], v[4:7], v[44:47]
  v_mfma_f32_16x16x32_bf16 v[48:51], a[160:163], v[8:11], v[48:51]
  s_waitcnt lgkmcnt(4)
  v_mfma_f32_16x16x32_bf16 v[36:39], a[36:39], v[12:15], v[36:39]
  ds_read_b128 v[4:7], v73 offset:24576
  v_mfma_f32_16x16x32_bf16 v[40:43], a[36:39], v[16:19], v[40:43]
  ds_read_b128 v[8:11], v73 offset:25600
  v_mfma_f32_16x16x32_bf16 v[44:47], a[164:167], v[12:15], v[44:47]
  v_mfma_f32_16x16x32_bf16 v[48:51], a[164:167], v[16:19], v[48:51]
  s_waitcnt lgkmcnt(4)
  v_mfma_f32_16x16x32_bf16 v[36:39], a[40:43], v[20:23], v[36:39]
  ds_read_b128 v[12:15], v73 offset:26624
  v_mfma_f32_16x16x32_bf16 v[40:43], a[40:43], v[24:27], v[40:43]
  ds_read_b128 v[16:19], v73 offset:27648
  v_mfma_f32_16x16x32_bf16 v[44:47], a[168:171], v[20:23], v[44:47]
  v_mfma_f32_16x16x32_bf16 v[48:51], a[168:171], v[24:27], v[48:51]
  s_waitcnt lgkmcnt(4)
  v_mfma_f32_16x16x32_bf16 v[36:39], a[44:47], v[28:31], v[36:39]
  ds_read_b128 v[20:23], v73 offset:28672
  v_mfma_f32_16x16x32_bf16 v[40:43], a[44:47], v[32:35], v[40:43]
  ds_read_b128 v[24:27], v73 offset:29696
  v_mfma_f32_16x16x32_bf16 v[44:47], a[172:175], v[28:31], v[44:47]
  v_mfma_f32_16x16x32_bf16 v[48:51], a[172:175], v[32:35], v[48:51]
  s_lshl_b32 s40, s20, 8
  s_add_u32 m0, s40, 131072
  s_cmp_eq_u32 s20, 0
  s_cselect_b32 s40, s30, 2147483392
  buffer_load_dword v2, s[4:7], s40 offen sc1 lds
  s_waitcnt lgkmcnt(4)
  v_mfma_f32_16x16x32_bf16 v[36:39], a[48:51], v[4:7], v[36:39]
  ds_read_b128 v[28:31], v73 offset:30720
  v_mfma_f32_16x16x32_bf16 v[40:43], a[48:51], v[8:11], v[40:43]
  ds_read_b128 v[32:35], v73 offset:31744
  v_mfma_f32_16x16x32_bf16 v[44:47], a[176:179], v[4:7], v[44:47]
  v_mfma_f32_16x16x32_bf16 v[48:51], a[176:179], v[8:11], v[48:51]
  s_waitcnt vmcnt(5)
  s_barrier
  s_lshl_b32 s40, s20, 1
  s_add_u32 s40, s40, 1
  s_cmp_lg_u32 s40, s28
  s_cbranch_scc1 L_WO_s2
  s_mov_b32 s63, s25
  s_atomic_smax s63, s[4:5], s62 glc
Lnosig_136:
L_WO_s2:
  s_waitcnt lgkmcnt(4)
  v_mfma_f32_16x16x32_bf16 v[36:39], a[52:55], v[12:15], v[36:39]
  ds_read_b128 v[4:7], v73 offset:32768
  v_mfma_f32_16x16x32_bf16 v[40:43], a[52:55], v[16:19], v[40:43]
  ds_read_b128 v[8:11], v73 offset:33792
  v_mfma_f32_16x16x32_bf16 v[44:47], a[180:183], v[12:15], v[44:47]
  v_mfma_f32_16x16x32_bf16 v[48:51], a[180:183], v[16:19], v[48:51]
  s_waitcnt lgkmcnt(4)
  v_mfma_f32_16x16x32_bf16 v[36:39], a[56:59], v[20:23], v[36:39]
  ds_read_b128 v[12:15], v73 offset:34816
  v_mfma_f32_16x16x32_bf16 v[40:43], a[56:59], v[24:27], v[40:43]
  ds_read_b128 v[16:19], v73 offset:35840
  v_mfma_f32_16x16x32_bf16 v[44:47], a[184:187], v[20:23], v[44:47]
  v_mfma_f32_16x16x32_bf16 v[48:51], a[184:187], v[24:27], v[48:51]
  s_waitcnt lgkmcnt(4)
  v_mfma_f32_16x16x32_bf16 v[36:39], a[60:63], v[28:31], v[36:39]
  ds_read_b128 v[20:23], v73 offset:36864
  v_mfma_f32_16x16x32_bf16 v[40:43], a[60:63], v[32:35], v[40:43]
  ds_read_b128 v[24:27], v73 offset:37888
  v_mfma_f32_16x16x32_bf16 v[44:47], a[188:191], v[28:31], v[44:47]
  v_mfma_f32_16x16x32_bf16 v[48:51], a[188:191], v[32:35], v[48:51]
  s_waitcnt lgkmcnt(4)
  v_mfma_f32_16x16x32_bf16 v[36:39], a[64:67], v[4:7], v[36:39]
  ds_read_b128 v[28:31], v73 offset:38912
  v_mfma_f32_16x16x32_bf16 v[40:43], a[64:67], v[8:11], v[40:43]
  ds_read_b128 v[32:35], v73 offset:39936
  v_mfma_f32_16x16x32_bf16 v[44:47], a[192:195], v[4:7], v[44:47]
  v_mfma_f32_16x16x32_bf16 v[48:51], a[192:195], v[8:11], v[48:51]
  s_waitcnt lgkmcnt(4)
  v_mfma_f32_16x16x32_bf16 v[36:39], a[68:71], v[12:15], v[36:39]
  ds_read_b128 v[4:7], v73 offset:40960
  v_mfma_f32_16x16x32_bf16 v[40:43], a[68:71], v[16:19], v[40:43]
  ds_read_b128 v[8:11], v73 offset:41984
  v_mfma_f32_16x16x32_bf16 v[44:47], a[196:199], v[12:15], v[44:47]
  v_mfma_f32_16x16x32_bf16 v[48:51], a[196:199], v[16:19], v[48:51]
  s_waitcnt lgkmcnt(4)
  v_mfma_f32_16x16x32_bf16 v[36:39], a[72:75], v[20:23], v[36:39]
  ds_read_b128 v[12:15], v73 offset:43008
  v_mfma_f32_16x16x32_bf16 v[40:43], a[72:75], v[24:27], v[40:43]
  ds_read_b128 v[16:19], v73 offset:44032
  v_mfma_f32_16x16x32_bf16 v[44:47], a[200:203], v[20:23], v[44:47]
  v_mfma_f32_16x16x32_bf16 v[48:51], a[200:203], v[24:27], v[48:51]
  s_waitcnt vmcnt(0)
  s_barrier
  ds_read_b32 v3, v71
  s_waitcnt lgkmcnt(4)
  v_mfma_f32_16x16x32_bf16 v[36:39], a[76:79], v[28:31], v[36:39]
  ds_read_b128 v[20:23], v73 offset:45056
  v_mfma_f32_16x16x32_bf16 v[40:43], a[76:79], v[32:35], v[40:43]
  ds_read_b128 v[24:27], v73 offset:46080
  v_mfma_f32_16x16x32_bf16 v[44:47], a[204:207], v[28:31], v[44:47]
  v_mfma_f32_16x16x32_bf16 v[48:51], a[204:207], v[32:35], v[48:51]
  s_waitcnt lgkmcnt(4)
  v_mfma_f32_16x16x32_bf16 v[36:39], a[80:83], v[4:7], v[36:39]
  ds_read_b128 v[28:31], v73 offset:47104
  v_mfma_f32_16x16x32_bf16 v[40:43], a[80:83], v[8:11], v[40:43]
  ds_read_b128 v[32:35], v73 offset:48128
  v_mfma_f32_16x16x32_bf16 v[44:47], a[208:211], v[4:7], v[44:47]
  v_mfma_f32_16x16x32_bf16 v[48:51], a[208:211], v[8:11], v[48:51]
  s_waitcnt lgkmcnt(4)
  v_cmp_gt_i32 vcc, s29, v3
  s_mov_b32 s28, 0
  s_cbranch_vccnz L_WO_nopf
  s_cmp_ge_u32 s25, 63
  s_cbranch_scc1 L_WO_nopf
  s_mov_b32 s28, 1
  s_waitcnt lgkmcnt(4)
  v_mfma_f32_16x16x32_bf16 v[36:39], a[84:87], v[12:15], v[36:39]
  ds_read_b128 v[4:7], v73 offset:49152
  v_mfma_f32_16x16x32_bf16 v[40:43], a[84:87], v[16:19], v[40:43]
  ds_read_b128 v[8:11], v73 offset:50176
  v_mfma_f32_16x16x32_bf16 v[44:47], a[212:215], v[12:15], v[44:47]
  s_add_u32 s36, s32, 0
  s_add_u32 m0, s34, s36
  s_add_u32 s36, s35, 0
  buffer_load_dwordx4 v1, s[4:7], s36 offen offset:0 sc1 lds
  v_mfma_f32_16x16x32_bf16 v[48:51], a[212:215], v[16:19], v[48:51]
  buffer_load_dwordx4 v1, s[4:7], s36 offen offset:1024 sc1 lds
  s_waitcnt lgkmcnt(4)
  v_mfma_f32_16x16x32_bf16 v[36:39], a[88:91], v[20:23], v[36:39]
  ds_read_b128 v[12:15], v73 offset:51200
  v_mfma_f32_16x16x32_bf16 v[40:43], a[88:91], v[24:27], v[40:43]
  ds_read_b128 v[16:19], v73 offset:52224
  v_mfma_f32_16x16x32_bf16 v[44:47], a[216:219], v[20:23], v[44:47]
  buffer_load_dwordx4 v1, s[4:7], s36 offen offset:2048 sc1 lds
  v_mfma_f32_16x16x32_bf16 v[48:51], a[216:219], v[24:27], v[48:51]
  buffer_load_dwordx4 v1, s[4:7], s36 offen offset:3072 sc1 lds
  s_waitcnt lgkmcnt(4)
  v_mfma_f32_16x16x32_bf16 v[36:39], a[92:95], v[28:31], v[36:39]
  ds_read_b128 v[20:23], v73 offset:53248
  v_mfma_f32_16x16x32_bf16 v[40:43], a[92:95], v[32:35], v[40:43]
  ds_read_b128 v[24:27], v73 offset:54272
  v_mfma_f32_16x16x32_bf16 v[44:47], a[220:223], v[28:31], v[44:47]
  s_add_u32 s36, s32, 16384
  s_add_u32 m0, s34, s36
  s_add_u32 s36, s35, 131072
  buffer_load_dwordx4 v1, s[4:7], s36 offen offset:0 sc1 lds
  v_mfma_f32_16x16x32_bf16 v[48:51], a[220:223], v[32:35], v[48:51]
  buffer_load_dwordx4 v1, s[4:7], s36 offen offset:1024 sc1 lds
  s_waitcnt lgkmcnt(4)
  v_mfma_f32_16x16x32_bf16 v[36:39], a[96:99], v[4:7], v[36:39]
  ds_read_b128 v[28:31], v73 offset:55296
  v_mfma_f32_16x16x32_bf16 v[40:43], a[96:99], v[8:11], v[40:43]
  ds_read_b128 v[32:35], v73 offset:56320
  v_mfma_f32_16x16x32_bf16 v[44:47], a[224:227], v[4:7], v[44:47]
  buffer_load_dwordx4 v1, s[4:7], s36 offen offset:2048 sc1 lds
  v_mfma_f32_16x16x32_bf16 v[48:51], a[224:227], v[8:11], v[48:51]
  buffer_load_dwordx4 v1, s[4:7], s36 offen offset:3072 sc1 lds
  s_waitcnt lgkmcnt(4)
  v_mfma_f32_16x16x32_bf16 v[36:39], a[100:103], v[12:15], v[36:39]
  ds_read_b128 v[4:7], v73 offset:57344
  v_mfma_f32_16x16x32_bf16 v[40:43], a[100:103], v[16:19], v[40:43]
  ds_read_b128 v[8:11], v73 offset:58368
  v_mfma_f32_16x16x32_bf16 v[44:47], a[228:231], v[12:15], v[44:47]
  s_add_u32 s36, s32, 32768
  s_add_u32 m0, s34, s36
  s_add_u32 s36, s35, 262144
  buffer_load_dwordx4 v1, s[4:7], s36 offen offset:0 sc1 lds
  v_mfma_f32_16x16x32_bf16 v[48:51], a[228:231], v[16:19], v[48:51]
  buffer_load_dwordx4 v1, s[4:7], s36 offen offset:1024 sc1 lds
  s_waitcnt lgkmcnt(4)
  v_mfma_f32_16x16x32_bf16 v[36:39], a[104:107], v[20:23], v[36:39]
  ds_read_b128 v[12:15], v73 offset:59392
  v_mfma_f32_16x16x32_bf16 v[40:43], a[104:107], v[24:27], v[40:43]
  ds_read_b128 v[16:19], v73 offset:60416
  v_mfma_f32_16x16x32_bf16 v[44:47], a[232:235], v[20:23], v[44:47]
  buffer_load_dwordx4 v1, s[4:7], s36 offen offset:2048 sc1 lds
  v_mfma_f32_16x16x32_bf16 v[48:51], a[232:235], v[24:27], v[48:51]
  buffer_load_dwordx4 v1, s[4:7], s36 offen offset:3072 sc1 lds
  s_waitcnt lgkmcnt(4)
  v_mfma_f32_16x16x32_bf16 v[36:39], a[108:111], v[28:31], v[36:39]
  ds_read_b128 v[20:23], v73 offset:61440
  v_mfma_f32_16x16x32_bf16 v[40:43], a[108:111], v[32:35], v[40:43]
  ds_read_b128 v[24:27], v73 offset:62464
  v_mfma_f32_16x16x32_bf16 v[44:47], a[236:239], v[28:31], v[44:47]
  v_mfma_f32_16x16x32_bf16 v[48:51], a[236:239], v[32:35], v[48:51]
  s_waitcnt lgkmcnt(4)
  v_mfma_f32_16x16x32_bf16 v[36:39], a[112:115], v[4:7], v[36:39]
  ds_read_b128 v[28:31], v73 offset:63488
  v_mfma_f32_16x16x32_bf16 v[40:43], a[112:115], v[8:11], v[40:43]
  ds_read_b128 v[32:35], v73 offset:64512
  v_mfma_f32_16x16x32_bf16 v[44:47], a[240:243], v[4:7], v[44:47]
  v_mfma_f32_16x16x32_bf16 v[48:51], a[240:243], v[8:11], v[48:51]
  s_waitcnt lgkmcnt(4)
  v_mfma_f32_16x16x32_bf16 v[36:39], a[116:119], v[12:15], v[36:39]
  v_mfma_f32_16x16x32_bf16 v[40:43], a[116:119], v[16:19], v[40:43]
  v_mfma_f32_16x16x32_bf16 v[44:47], a[244:247], v[12:15], v[44:47]
  v_mfma_f32_16x16x32_bf16 v[48:51], a[244:247], v[16:19], v[48:51]
  s_waitcnt lgkmcnt(2)
  v_mfma_f32_16x16x32_bf16 v[36:39], a[120:123], v[20:23], v[36:39]
  v_mfma_f32_16x16x32_bf16 v[40:43], a[120:123], v[24:27], v[40:43]
  v_mfma_f32_16x16x32_bf16 v[44:47], a[248:251], v[20:23], v[44:47]
  v_mfma_f32_16x16x32_bf16 v[48:51], a[248:251], v[24:27], v[48:51]
  s_waitcnt lgkmcnt(0)
  v_mfma_f32_16x16x32_bf16 v[36:39], a[124:127], v[28:31], v[36:39]
  v_mfma_f32_16x16x32_bf16 v[40:43], a[124:127], v[32:35], v[40:43]
  v_mfma_f32_16x16x32_bf16 v[44:47], a[252:255], v[28:31], v[44:47]
  v_mfma_f32_16x16x32_bf16 v[48:51], a[252:255], v[32:35], v[48:51]
  s_nop 7
  s_branch L_WO_epi
L_WO_nopf:
  s_waitcnt lgkmcnt(4)
  v_mfma_f32_16x16x32_bf16 v[36:39], a[84:87], v[12:15], v[36:39]
  ds_read_b128 v[4:7], v73 offset:49152
  v_mfma_f32_16x16x32_bf16 v[40:43], a[84:87], v[16:19], v[40:43]
  ds_read_b128 v[8:11], v73 offset:50176
  v_mfma_f32_16x16x32_bf16 v[44:47], a[212:215], v[12:15], v[44:47]
  v_mfma_f32_16x16x32_bf16 v[48:51], a[212:215], v[16:19], v[48:51]
  s_waitcnt lgkmcnt(4)
  v_mfma_f32_16x16x32_bf16 v[36:39], a[88:91], v[20:23], v[36:39]
  ds_read_b128 v[12:15], v73 offset:51200
  v_mfma_f32_16x16x32_bf16 v[40:43], a[88:91], v[24:27], v[40:43]
  ds_read_b128 v[16:19], v73 offset:52224
  v_mfma_f32_16x16x32_bf16 v[44:47], a[216:219], v[20:23], v[44:47]
  v_mfma_f32_16x16x32_bf16 v[48:51], a[216:219], v[24:27], v[48:51]
  s_waitcnt lgkmcnt(4)
  v_mfma_f32_16x16x32_bf16 v[36:39], a[92:95], v[28:31], v[36:39]
  ds_read_b128 v[20:23], v73 offset:53248
  v_mfma_f32_16x16x32_bf16 v[40:43], a[92:95], v[32:35], v[40:43]
  ds_read_b128 v[24:27], v73 offset:54272
  v_mfma_f32_16x16x32_bf16 v[44:47], a[220:223], v[28:31], v[44:47]
  v_mfma_f32_16x16x32_bf16 v[48:51], a[220:223], v[32:35], v[48:51]
  s_barrier
  s_lshl_b32 s40, s20, 8
  s_add_u32 m0, s40, 131072
  s_cmp_eq_u32 s20, 0
  s_cselect_b32 s40, s30, 2147483392
  buffer_load_dword v2, s[4:7], s40 offen sc1 lds
  s_waitcnt lgkmcnt(4)
  v_mfma_f32_16x16x32_bf16 v[36:39], a[96:99], v[4:7], v[36:39]
  ds_read_b128 v[28:31], v73 offset:55296
  v_mfma_f32_16x16x32_bf16 v[40:43], a[96:99], v[8:11], v[40:43]
  ds_read_b128 v[32:35], v73 offset:56320
  v_mfma_f32_16x16x32_bf16 v[44:47], a[224:227], v[4:7], v[44:47]
  v_mfma_f32_16x16x32_bf16 v[48:51], a[224:227], v[8:11], v[48:51]
  s_waitcnt lgkmcnt(4)
  v_mfma_f32_16x16x32_bf16 v[36:39], a[100:103], v[12:15], v[36:39]
  ds_read_b128 v[4:7], v73 offset:57344
  v_mfma_f32_16x16x32_bf16 v[40:43], a[100:103], v[16:19], v[40:43]
  ds_read_b128 v[8:11], v73 offset:58368
  v_mfma_f32_16x16x32_bf16 v[44:47], a[228:231], v[12:15], v[44:47]
  v_mfma_f32_16x16x32_bf16 v[48:51], a[228:231], v[16:19], v[48:51]
  s_waitcnt lgkmcnt(4)
  v_mfma_f32_16x16x32_bf16 v[36:39], a[104:107], v[20:23], v[36:39]
  ds_read_b128 v[12:15], v73 offset:59392
  v_mfma_f32_16x16x32_bf16 v[40:43], a[104:107], v[24:27], v[40:43]
  ds_read_b128 v[16:19], v73 offset:60416
  v_mfma_f32_16x16x32_bf16 v[44:47], a[232:235], v[20:23], v[44:47]
  v_mfma_f32_16x16x32_bf16 v[48:51], a[232:235], v[24:27], v[48:51]
  s_waitcnt lgkmcnt(4)
  v_mfma_f32_16x16x32_bf16 v[36:39], a[108:111], v[28:31], v[36:39]
  ds_read_b128 v[20:23], v73 offset:61440
  v_mfma_f32_16x16x32_bf16 v[40:43], a[108:111], v[32:35], v[40:43]
  ds_read_b128 v[24:27], v73 offset:62464
  v_mfma_f32_16x16x32_bf16 v[44:47], a[236:239], v[28:31], v[44:47]
  v_mfma_f32_16x16x32_bf16 v[48:51], a[236:239], v[32:35], v[48:51]
  s_waitcnt lgkmcnt(4)
  v_mfma_f32_16x16x32_bf16 v[36:39], a[112:115], v[4:7], v[36:39]
  ds_read_b128 v[28:31], v73 offset:63488
  v_mfma_f32_16x16x32_bf16 v[40:43], a[112:115], v[8:11], v[40:43]
  ds_read_b128 v[32:35], v73 offset:64512
  v_mfma_f32_16x16x32_bf16 v[44:47], a[240:243], v[4:7], v[44:47]
  v_mfma_f32_16x16x32_bf16 v[48:51], a[240:243], v[8:11], v[48:51]
  s_waitcnt lgkmcnt(4)
  v_mfma_f32_16x16x32_bf16 v[36:39], a[116:119], v[12:15], v[36:39]
  v_mfma_f32_16x16x32_bf16 v[40:43], a[116:119], v[16:19], v[40:43]
  v_mfma_f32_16x16x32_bf16 v[44:47], a[244:247], v[12:15], v[44:47]
  v_mfma_f32_16x16x32_bf16 v[48:51], a[244:247], v[16:19], v[48:51]
  s_waitcnt vmcnt(0)
  s_barrier
  ds_read_b32 v3, v71
  s_waitcnt lgkmcnt(2)
  v_mfma_f32_16x16x32_bf16 v[36:39], a[120:123], v[20:23], v[36:39]
  v_mfma_f32_16x16x32_bf16 v[40:43], a[120:123], v[24:27], v[40:43]
  v_mfma_f32_16x16x32_bf16 v[44:47], a[248:251], v[20:23], v[44:47]
  v_mfma_f32_16x16x32_bf16 v[48:51], a[248:251], v[24:27], v[48:51]
  s_waitcnt lgkmcnt(0)
  v_mfma_f32_16x16x32_bf16 v[36:39], a[124:127], v[28:31], v[36:39]
  v_mfma_f32_16x16x32_bf16 v[40:43], a[124:127], v[32:35], v[40:43]
  v_mfma_f32_16x16x32_bf16 v[44:47], a[252:255], v[28:31], v[44:47]
  v_mfma_f32_16x16x32_bf16 v[48:51], a[252:255], v[32:35], v[48:51]
  v_cmp_gt_i32 vcc, s29, v3
  s_cmp_eq_u64 vcc, 0
  s_cselect_b32 s28, 2, 0
  s_cmp_lt_u32 s25, 63
  s_cselect_b32 s28, s28, 0
L_WO_epi:
  v_cvt_pk_bf16_f32 v52, v36, v37
  v_cvt_pk_bf16_f32 v53, v38, v39
  v_cvt_pk_bf16_f32 v54, v44, v45
  v_cvt_pk_bf16_f32 v55, v46, v47
  buffer_store_dwordx4 v[52:55], v68, s[4:7], s31 offen offset:0 sc1
  v_cvt_pk_bf16_f32 v56, v40, v41
  v_cvt_pk_bf16_f32 v57, v42, v43
  v_cvt_pk_bf16_f32 v58, v48, v49
  v_cvt_pk_bf16_f32 v59, v50, v51
  buffer_store_dwordx4 v[56:59], v68, s[4:7], s31 offen offset:1024 sc1
  s_add_u32 s25, s25, 1
  s_add_u32 s31, s31, 2097152
  s_xor_b32 s31, s31, 0x2000
  s_branch L_WO_top
L_F1:
  v_lshlrev_b32 v1, 4, v0
  s_lshl_b32 s32, s20, 12
  s_min_u32 s33, s32, 0x2000
  v_mov_b32 v69, v1
  v_add_u32 v70, 0x10000, v69
  v_and_b32 v1, 3, v0
  v_lshlrev_b32 v1, 4, v1
  v_lshrrev_b32 v52, 4, v0
  v_lshl_add_u32 v1, v52, 6, v1
  v_bfe_u32 v52, v0, 2, 2
  v_lshl_add_u32 v1, v52, 8, v1
  s_load_dwordx2 s[8:9], s[0:1], 64
  s_mov_b32 s10, 7340032
  s_mov_b32 s11, 0x20000
  s_waitcnt lgkmcnt(0)
  s_lshl_b32 s44, s21, 7
  v_bfe_u32 v4, v0, 5, 1
  v_mul_u32_u24 v4, 28672, v4
  v_bfe_u32 v5, v0, 4, 1
  v_mul_u32_u24 v5, 14336, v5
  v_add_u32 v4, v4, v5
  v_bfe_u32 v5, v0, 3, 1
  v_mul_u32_u24 v5, 7168, v5
  v_add_u32 v4, v4, v5
  v_lshrrev_b32 v5, 3, v0
  v_and_b32 v5, 6, v5
  v_xor_b32 v5, v5, v0
  v_and_b32 v5, 7, v5
  v_lshl_add_u32 v4, v5, 4, v4
  s_lshr_b32 s40, s20, 1
  s_mul_i32 s40, s40, 458752
  s_and_b32 s41, s20, 1
  s_mul_i32 s41, s41, 57344
  s_add_u32 s40, s40, s41
  v_add_u32 v4, s40, v4
  v_bfe_u32 v5, v0, 3, 2
  v_xor_b32 v5, s20, v5
  v_lshlrev_b32 v5, 5, v5
  v_lshrrev_b32 v6, 2, v0
  v_lshl_add_u32 v6, v6, 7, v5
  v_and_b32 v5, 3, v0
  v_lshl_add_u32 v6, v5, 3, v6
  v_add_u32 v7, 0x10000, v6
  v_add_u32 v8, s44, v4
  v_add_u32 v9, s44, v4
  s_lshl_b32 s41, s20, 10
  s_add_u32 m0, s41, 0
  s_mov_b32 s42, 0
  buffer_load_dwordx4 v8, s[8:11], s42 offen nt lds
  s_add_u32 m0, s41, 4096
  s_mov_b32 s42, 114688
  buffer_load_dwordx4 v8, s[8:11], s42 offen nt lds
  s_add_u32 m0, s41, 8192
  s_mov_b32 s42, 229376
  buffer_load_dwordx4 v8, s[8:11], s42 offen nt lds
  s_add_u32 m0, s41, 12288
  s_mov_b32 s42, 344064
  buffer_load_dwordx4 v8, s[8:11], s42 offen nt lds
  s_add_u32 m0, s41, 16384
  s_mov_b32 s42, 917504
  buffer_load_dwordx4 v8, s[8:11], s42 offen nt lds
  s_add_u32 m0, s41, 20480
  s_mov_b32 s42, 1032192
  buffer_load_dwordx4 v8, s[8:11], s42 offen nt lds
  s_add_u32 m0, s41, 24576
  s_mov_b32 s42, 1146880
  buffer_load_dwordx4 v8, s[8:11], s42 offen nt lds
  s_add_u32 m0, s41, 28672
  s_mov_b32 s42, 1261568
  buffer_load_dwordx4 v8, s[8:11], s42 offen nt lds
  s_add_u32 m0, s41, 32768
  s_mov_b32 s42, 1835008
  buffer_load_dwordx4 v8, s[8:11], s42 offen nt lds
  s_add_u32 m0, s41, 36864
  s_mov_b32 s42, 1949696
  buffer_load_dwordx4 v8, s[8:11], s42 offen nt lds
  s_add_u32 m0, s41, 40960
  s_mov_b32 s42, 2064384
  buffer_load_dwordx4 v8, s[8:11], s42 offen nt lds
  s_add_u32 m0, s41, 45056
  s_mov_b32 s42, 2179072
  buffer_load_dwordx4 v8, s[8:11], s42 offen nt lds
  s_add_u32 m0, s41, 49152
  s_mov_b32 s42, 2752512
  buffer_load_dwordx4 v8, s[8:11], s42 offen nt lds
  s_add_u32 m0, s41, 53248
  s_mov_b32 s42, 2867200
  buffer_load_dwordx4 v8, s[8:11], s42 offen nt lds
  s_add_u32 m0, s41, 57344
  s_mov_b32 s42, 2981888
  buffer_load_dwordx4 v8, s[8:11], s42 offen nt lds
  s_add_u32 m0, s41, 61440
  s_mov_b32 s42, 3096576
  buffer_load_dwordx4 v8, s[8:11], s42 offen nt lds
  s_add_u32 m0, s41, 65536
  s_mov_b32 s42, 3670016
  buffer_load_dwordx4 v8, s[8:11], s42 offen nt lds
  s_add_u32 m0, s41, 69632
  s_mov_b32 s42, 3784704
  buffer_load_dwordx4 v8, s[8:11], s42 offen nt lds
  s_add_u32 m0, s41, 73728
  s_mov_b32 s42, 3899392
  buffer_load_dwordx4 v8, s[8:11], s42 offen nt lds
  s_add_u32 m0, s41, 77824
  s_mov_b32 s42, 4014080
  buffer_load_dwordx4 v8, s[8:11], s42 offen nt lds
  s_add_u32 m0, s41, 81920
  s_mov_b32 s42, 4587520
  buffer_load_dwordx4 v8, s[8:11], s42 offen nt lds
  s_add_u32 m0, s41, 86016
  s_mov_b32 s42, 4702208
  buffer_load_dwordx4 v8, s[8:11], s42 offen nt lds
  s_add_u32 m0, s41, 90112
  s_mov_b32 s42, 4816896
  buffer_load_dwordx4 v8, s[8:11], s42 offen nt lds
  s_add_u32 m0, s41, 94208
  s_mov_b32 s42, 4931584
  buffer_load_dwordx4 v8, s[8:11], s42 offen nt lds
  s_add_u32 m0, s41, 98304
  s_mov_b32 s42, 5505024
  buffer_load_dwordx4 v8, s[8:11], s42 offen nt lds
  s_add_u32 m0, s41, 102400
  s_mov_b32 s42, 5619712
  buffer_load_dwordx4 v8, s[8:11], s42 offen nt lds
  s_add_u32 m0, s41, 106496
  s_mov_b32 s42, 5734400
  buffer_load_dwordx4 v8, s[8:11], s42 offen nt lds
  s_add_u32 m0, s41, 110592
  s_mov_b32 s42, 5849088
  buffer_load_dwordx4 v8, s[8:11], s42 offen nt lds
  s_waitcnt vmcnt(24) lgkmcnt(0)
  s_barrier
  s_add_u32 m0, s41, 114688
  s_mov_b32 s42, 6422528
  buffer_load_dwordx4 v8, s[8:11], s42 offen nt lds
  s_add_u32 m0, s41, 118784
  s_mov_b32 s42, 6537216
  buffer_load_dwordx4 v8, s[8:11], s42 offen nt lds
  s_add_u32 m0, s41, 122880
  s_mov_b32 s42, 6651904
  buffer_load_dwordx4 v8, s[8:11], s42 offen nt lds
  s_add_u32 m0, s41, 126976
  s_mov_b32 s42, 6766592
  buffer_load_dwordx4 v8, s[8:11], s42 offen nt lds
  ds_read_b64_tr_b16 a[0:1], v6 offset:0
  ds_read_b64_tr_b16 a[2:3], v6 offset:2048
  ds_read_b64_tr_b16 a[4:5], v6 offset:4096
  ds_read_b64_tr_b16 a[6:7], v6 offset:6144
  ds_read_b64_tr_b16 a[8:9], v6 offset:8192
  ds_read_b64_tr_b16 a[10:11], v6 offset:10240
  ds_read_b64_tr_b16 a[12:13], v6 offset:12288
  ds_read_b64_tr_b16 a[14:15], v6 offset:14336
  s_waitcnt vmcnt(24) lgkmcnt(0)
  s_barrier
  s_load_dwordx2 s[8:9], s[0:1], 72
  s_mov_b32 s10, 7340032
  s_mov_b32 s11, 0x20000
  s_waitcnt lgkmcnt(0)
  s_add_u32 m0, s41, 0
  s_mov_b32 s42, 0
  buffer_load_dwordx4 v9, s[8:11], s42 offen nt lds
  s_add_u32 m0, s41, 4096
  s_mov_b32 s42, 114688
  buffer_load_dwordx4 v9, s[8:11], s42 offen nt lds
  s_add_u32 m0, s41, 8192
  s_mov_b32 s42, 229376
  buffer_load_dwordx4 v9, s[8:11], s42 offen nt lds
  s_add_u32 m0, s41, 12288
  s_mov_b32 s42, 344064
  buffer_load_dwordx4 v9, s[8:11], s42 offen nt lds
  ds_read_b64_tr_b16 a[16:17], v6 offset:16384
  ds_read_b64_tr_b16 a[18:19], v6 offset:18432
  ds_read_b64_tr_b16 a[20:21], v6 offset:20480
  ds_read_b64_tr_b16 a[22:23], v6 offset:22528
  ds_read_b64_tr_b16 a[24:25], v6 offset:24576
  ds_read_b64_tr_b16 a[26:27], v6 offset:26624
  ds_read_b64_tr_b16 a[28:29], v6 offset:28672
  ds_read_b64_tr_b16 a[30:31], v6 offset:30720
  s_waitcnt vmcnt(24) lgkmcnt(0)
  s_barrier
  s_add_u32 m0, s41, 16384
  s_mov_b32 s42, 917504
  buffer_load_dwordx4 v9, s[8:11], s42 offen nt lds
  s_add_u32 m0, s41, 20480
  s_mov_b32 s42, 1032192
  buffer_load_dwordx4 v9, s[8:11], s42 offen nt lds
  s_add_u32 m0, s41, 24576
  s_mov_b32 s42, 1146880
  buffer_load_dwordx4 v9, s[8:11], s42 offen nt lds
  s_add_u32 m0, s41, 28672
  s_mov_b32 s42, 1261568
  buffer_load_dwordx4 v9, s[8:11], s42 offen nt lds
  ds_read_b64_tr_b16 a[32:33], v6 offset:32768
  ds_read_b64_tr_b16 a[34:35], v6 offset:34816
  ds_read_b64_tr_b16 a[36:37], v6 offset:36864
  ds_read_b64_tr_b16 a[38:39], v6 offset:38912
  ds_read_b64_tr_b16 a[40:41], v6 offset:40960
  ds_read_b64_tr_b16 a[42:43], v6 offset:43008
  ds_read_b64_tr_b16 a[44:45], v6 offset:45056
  ds_read_b64_tr_b16 a[46:47], v6 offset:47104
  s_waitcnt vmcnt(24) lgkmcnt(0)
  s_barrier
  s_add_u32 m0, s41, 32768
  s_mov_b32 s42, 1835008
  buffer_load_dwordx4 v9, s[8:11], s42 offen nt lds
  s_add_u32 m0, s41, 36864
  s_mov_b32 s42, 1949696
  buffer_load_dwordx4 v9, s[8:11], s42 offen nt lds
  s_add_u32 m0, s41, 40960
  s_mov_b32 s42, 2064384
  buffer_load_dwordx4 v9, s[8:11], s42 offen nt lds
  s_add_u32 m0, s41, 45056
  s_mov_b32 s42, 2179072
  buffer_load_dwordx4 v9, s[8:11], s42 offen nt lds
  ds_read_b64_tr_b16 a[48:49], v6 offset:49152
  ds_read_b64_tr_b16 a[50:51], v6 offset:51200
  ds_read_b64_tr_b16 a[52:53], v6 offset:53248
  ds_read_b64_tr_b16 a[54:55], v6 offset:55296
  ds_read_b64_tr_b16 a[56:57], v6 offset:57344
  ds_read_b64_tr_b16 a[58:59], v6 offset:59392
  ds_read_b64_tr_b16 a[60:61], v6 offset:61440
  ds_read_b64_tr_b16 a[62:63], v6 offset:63488
  s_waitcnt vmcnt(24) lgkmcnt(0)
  s_barrier
  s_add_u32 m0, s41, 49152
  s_mov_b32 s42, 2752512
  buffer_load_dwordx4 v9, s[8:11], s42 offen nt lds
  s_add_u32 m0, s41, 53248
  s_mov_b32 s42, 2867200
  buffer_load_dwordx4 v9, s[8:11], s42 offen nt lds
  s_add_u32 m0, s41, 57344
  s_mov_b32 s42, 2981888
  buffer_load_dwordx4 v9, s[8:11], s42 offen nt lds
  s_add_u32 m0, s41, 61440
  s_mov_b32 s42, 3096576
  buffer_load_dwordx4 v9, s[8:11], s42 offen nt lds
  ds_read_b64_tr_b16 a[64:65], v7 offset:0
  ds_read_b64_tr_b16 a[66:67], v7 offset:2048
  ds_read_b64_tr_b16 a[68:69], v7 offset:4096
  ds_read_b64_tr_b16 a[70:71], v7 offset:6144
  ds_read_b64_tr_b16 a[72:73], v7 offset:8192
  ds_read_b64_tr_b16 a[74:75], v7 offset:10240
  ds_read_b64_tr_b16 a[76:77], v7 offset:12288
  ds_read_b64_tr_b16 a[78:79], v7 offset:14336
  s_waitcnt vmcnt(24) lgkmcnt(0)
  s_barrier
  s_add_u32 m0, s41, 65536
  s_mov_b32 s42, 3670016
  buffer_load_dwordx4 v9, s[8:11], s42 offen nt lds
  s_add_u32 m0, s41, 69632
  s_mov_b32 s42, 3784704
  buffer_load_dwordx4 v9, s[8:11], s42 offen nt lds
  s_add_u32 m0, s41, 73728
  s_mov_b32 s42, 3899392
  buffer_load_dwordx4 v9, s[8:11], s42 offen nt lds
  s_add_u32 m0, s41, 77824
  s_mov_b32 s42, 4014080
  buffer_load_dwordx4 v9, s[8:11], s42 offen nt lds
  ds_read_b64_tr_b16 a[80:81], v7 offset:16384
  ds_read_b64_tr_b16 a[82:83], v7 offset:18432
  ds_read_b64_tr_b16 a[84:85], v7 offset:20480
  ds_read_b64_tr_b16 a[86:87], v7 offset:22528
  ds_read_b64_tr_b16 a[88:89], v7 offset:24576
  ds_read_b64_tr_b16 a[90:91], v7 offset:26624
  ds_read_b64_tr_b16 a[92:93], v7 offset:28672
  ds_read_b64_tr_b16 a[94:95], v7 offset:30720
  s_waitcnt vmcnt(24) lgkmcnt(0)
  s_barrier
  s_add_u32 m0, s41, 81920
  s_mov_b32 s42, 4587520
  buffer_load_dwordx4 v9, s[8:11], s42 offen nt lds
  s_add_u32 m0, s41, 86016
  s_mov_b32 s42, 4702208
  buffer_load_dwordx4 v9, s[8:11], s42 offen nt lds
  s_add_u32 m0, s41, 90112
  s_mov_b32 s42, 4816896
  buffer_load_dwordx4 v9, s[8:11], s42 offen nt lds
  s_add_u32 m0, s41, 94208
  s_mov_b32 s42, 4931584
  buffer_load_dwordx4 v9, s[8:11], s42 offen nt lds
  ds_read_b64_tr_b16 a[96:97], v7 offset:32768
  ds_read_b64_tr_b16 a[98:99], v7 offset:34816
  ds_read_b64_tr_b16 a[100:101], v7 offset:36864
  ds_read_b64_tr_b16 a[102:103], v7 offset:38912
  ds_read_b64_tr_b16 a[104:105], v7 offset:40960
  ds_read_b64_tr_b16 a[106:107], v7 offset:43008
  ds_read_b64_tr_b16 a[108:109], v7 offset:45056
  ds_read_b64_tr_b16 a[110:111], v7 offset:47104
  s_waitcnt vmcnt(24) lgkmcnt(0)
  s_barrier
  s_add_u32 m0, s41, 98304
  s_mov_b32 s42, 5505024
  buffer_load_dwordx4 v9, s[8:11], s42 offen nt lds
  s_add_u32 m0, s41, 102400
  s_mov_b32 s42, 5619712
  buffer_load_dwordx4 v9, s[8:11], s42 offen nt lds
  s_add_u32 m0, s41, 106496
  s_mov_b32 s42, 5734400
  buffer_load_dwordx4 v9, s[8:11], s42 offen nt lds
  s_add_u32 m0, s41, 110592
  s_mov_b32 s42, 5849088
  buffer_load_dwordx4 v9, s[8:11], s42 offen nt lds
  ds_read_b64_tr_b16 a[112:113], v7 offset:49152
  ds_read_b64_tr_b16 a[114:115], v7 offset:51200
  ds_read_b64_tr_b16 a[116:117], v7 offset:53248
  ds_read_b64_tr_b16 a[118:119], v7 offset:55296
  ds_read_b64_tr_b16 a[120:121], v7 offset:57344
  ds_read_b64_tr_b16 a[122:123], v7 offset:59392
  ds_read_b64_tr_b16 a[124:125], v7 offset:61440
  ds_read_b64_tr_b16 a[126:127], v7 offset:63488
  s_waitcnt vmcnt(24) lgkmcnt(0)
  s_barrier
  s_add_u32 m0, s41, 114688
  s_mov_b32 s42, 6422528
  buffer_load_dwordx4 v9, s[8:11], s42 offen nt lds
  s_add_u32 m0, s41, 118784
  s_mov_b32 s42, 6537216
  buffer_load_dwordx4 v9, s[8:11], s42 offen nt lds
  s_add_u32 m0, s41, 122880
  s_mov_b32 s42, 6651904
  buffer_load_dwordx4 v9, s[8:11], s42 offen nt lds
  s_add_u32 m0, s41, 126976
  s_mov_b32 s42, 6766592
  buffer_load_dwordx4 v9, s[8:11], s42 offen nt lds
  ds_read_b64_tr_b16 a[128:129], v6 offset:0
  ds_read_b64_tr_b16 a[130:131], v6 offset:2048
  ds_read_b64_tr_b16 a[132:133], v6 offset:4096
  ds_read_b64_tr_b16 a[134:135], v6 offset:6144
  ds_read_b64_tr_b16 a[136:137], v6 offset:8192
  ds_read_b64_tr_b16 a[138:139], v6 offset:10240
  ds_read_b64_tr_b16 a[140:141], v6 offset:12288
  ds_read_b64_tr_b16 a[142:143], v6 offset:14336
  s_waitcnt vmcnt(24) lgkmcnt(0)
  s_barrier
  ds_read_b64_tr_b16 a[144:145], v6 offset:16384
  ds_read_b64_tr_b16 a[146:147], v6 offset:18432
  ds_read_b64_tr_b16 a[148:149], v6 offset:20480
  ds_read_b64_tr_b16 a[150:151], v6 offset:22528
  ds_read_b64_tr_b16 a[152:153], v6 offset:24576
  ds_read_b64_tr_b16 a[154:155], v6 offset:26624
  ds_read_b64_tr_b16 a[156:157], v6 offset:28672
  ds_read_b64_tr_b16 a[158:159], v6 offset:30720
  s_waitcnt vmcnt(20) lgkmcnt(0)
  s_barrier
  ds_read_b64_tr_b16 a[160:161], v6 offset:32768
  ds_read_b64_tr_b16 a[162:163], v6 offset:34816
  ds_read_b64_tr_b16 a[164:165], v6 offset:36864
  ds_read_b64_tr_b16 a[166:167], v6 offset:38912
  ds_read_b64_tr_b16 a[168:169], v6 offset:40960
  ds_read_b64_tr_b16 a[170:171], v6 offset:43008
  ds_read_b64_tr_b16 a[172:173], v6 offset:45056
  ds_read_b64_tr_b16 a[174:175], v6 offset:47104
  s_waitcnt vmcnt(16) lgkmcnt(0)
  s_barrier
  ds_read_b64_tr_b16 a[176:177], v6 offset:49152
  ds_read_b64_tr_b16 a[178:179], v6 offset:51200
  ds_read_b64_tr_b16 a[180:181], v6 offset:53248
  ds_read_b64_tr_b16 a[182:183], v6 offset:55296
  ds_read_b64_tr_b16 a[184:185], v6 offset:57344
  ds_read_b64_tr_b16 a[186:187], v6 offset:59392
  ds_read_b64_tr_b16 a[188:189], v6 offset:61440
  ds_read_b64_tr_b16 a[190:191], v6 offset:63488
  s_waitcnt vmcnt(12) lgkmcnt(0)
  s_barrier
  ds_read_b64_tr_b16 a[192:193], v7 offset:0
  ds_read_b64_tr_b16 a[194:195], v7 offset:2048
  ds_read_b64_tr_b16 a[196:197], v7 offset:4096
  ds_read_b64_tr_b16 a[198:199], v7 offset:6144
  ds_read_b64_tr_b16 a[200:201], v7 offset:8192
  ds_read_b64_tr_b16 a[202:203], v7 offset:10240
  ds_read_b64_tr_b16 a[204:205], v7 offset:12288
  ds_read_b64_tr_b16 a[206:207], v7 offset:14336
  s_waitcnt vmcnt(8) lgkmcnt(0)
  s_barrier
  ds_read_b64_tr_b16 a[208:209], v7 offset:16384
  ds_read_b64_tr_b16 a[210:211], v7 offset:18432
  ds_read_b64_tr_b16 a[212:213], v7 offset:20480
  ds_read_b64_tr_b16 a[214:215], v7 offset:22528
  ds_read_b64_tr_b16 a[216:217], v7 offset:24576
  ds_read_b64_tr_b16 a[218:219], v7 offset:26624
  ds_read_b64_tr_b16 a[220:221], v7 offset:28672
  ds_read_b64_tr_b16 a[222:223], v7 offset:30720
  s_waitcnt vmcnt(4) lgkmcnt(0)
  s_barrier
  ds_read_b64_tr_b16 a[224:225], v7 offset:32768
  ds_read_b64_tr_b16 a[226:227], v7 offset:34816
  ds_read_b64_tr_b16 a[228:229], v7 offset:36864
  ds_read_b64_tr_b16 a[230:231], v7 offset:38912
  ds_read_b64_tr_b16 a[232:233], v7 offset:40960
  ds_read_b64_tr_b16 a[234:235], v7 offset:43008
  ds_read_b64_tr_b16 a[236:237], v7 offset:45056
  ds_read_b64_tr_b16 a[238:239], v7 offset:47104
  s_waitcnt vmcnt(0) lgkmcnt(0)
  s_barrier
  ds_read_b64_tr_b16 a[240:241], v7 offset:49152
  ds_read_b64_tr_b16 a[242:243], v7 offset:51200
  ds_read_b64_tr_b16 a[244:245], v7 offset:53248
  ds_read_b64_tr_b16 a[246:247], v7 offset:55296
  ds_read_b64_tr_b16 a[248:249], v7 offset:57344
  ds_read_b64_tr_b16 a[250:251], v7 offset:59392
  ds_read_b64_tr_b16 a[252:253], v7 offset:61440
  ds_read_b64_tr_b16 a[254:255], v7 offset:63488
  s_waitcnt lgkmcnt(0)
  s_barrier
  v_min_u32 v2, 7, v0
  v_lshlrev_b32 v2, 7, v2
  v_add_u32 v2, 1413120, v2
  s_lshl_b32 s62, s21, 7
  s_add_u32 s62, s62, 1414144
  v_min_u32 v52, 63, v0
  v_lshlrev_b32 v52, 7, v52
  v_add_u32 v52, 1424384, v52
  s_nop 1
Lpoll_137:
  buffer_load_dword v53, v52, s[4:7], 0 offen sc1
  s_sub_u32 s24, s24, 1
  s_cbranch_scc1 L_FAIL
  s_waitcnt vmcnt(0)
  v_cmp_gt_i32 vcc, 0, v53
  s_cbranch_vccz Lpolld_138
  s_sleep 1
  s_branch Lpoll_137
Lpolld_138:
  v_lshrrev_b32 v53, 8, v53
  v_and_b32 v54, 3, v0
  v_lshl_or_b32 v53, v53, 2, v54
  s_nop 1
  v_min_u32_dpp v53, v53, v53 row_ror:8 row_mask:0xf bank_mask:0xf
  s_nop 1
  v_min_u32_dpp v53, v53, v53 row_ror:4 row_mask:0xf bank_mask:0xf
  v_mov_b32 v54, v53
  s_nop 1
  v_permlane16_swap_b32 v54, v53
  v_min_u32 v53, v53, v54
  v_mov_b32 v54, v53
  s_nop 1
  v_permlane32_swap_b32 v54, v53
  v_min_u32 v53, v53, v54
  s_nop 1
  v_min_u32_dpp v53, v53, v53 row_ror:2 row_mask:0xf bank_mask:0xf
  s_nop 1
  v_min_u32_dpp v53, v53, v53 row_ror:1 row_mask:0xf bank_mask:0xf
  s_nop 0
  v_readfirstlane_b32 s38, v53
  s_and_b32 s38, s38, 3
  s_lshl_b32 s38, s38, 13
  s_and_b32 s38, s38, 0x2000
  s_xor_b32 s38, s38, 20979712
  s_lshr_b32 s40, s20, 1
  s_lshl_b32 s40, s40, 14
  s_and_b32 s41, s20, 1
  s_lshl_b32 s41, s41, 12
  s_add_u32 s27, s40, s41
  s_lshr_b32 s40, s21, 1
  s_lshl_b32 s40, s40, 14
  s_and_b32 s41, s21, 1
  s_lshl_b32 s41, s41, 12
  s_add_u32 s31, s40, s41
  s_add_u32 s27, s27, s38
  s_add_u32 s27, s27, 917504
  s_add_u32 s31, s31, s38
  s_add_u32 s31, s31, 1179648
  s_lshr_b32 s40, s20, 1
  s_lshl_b32 s40, s40, 11
  s_and_b32 s41, s20, 1
  s_lshl_b32 s41, s41, 9
  s_add_u32 s40, s40, s41
  v_and_b32 v52, 31, v0
  v_lshl_add_u32 v68, v52, 4, s40
  v_lshrrev_b32 v52, 5, v0
  v_lshl_add_u32 v68, v52, 10, v68
  s_mov_b32 s37, 0xbfb8aa3b
  v_lshlrev_b32 v71, 2, v0
  v_add_u32 v71, 131072, v71
  s_mov_b32 s25, 0
  s_mov_b32 s26, 0
  s_mov_b32 s29, 1
  s_mov_b32 s30, 0
  s_mov_b32 s28, 0
L_F1_top:
  s_cmp_eq_u32 s28, 1
  s_cbranch_scc1 L_F1_go
  s_cmp_eq_u32 s28, 2
  s_cbranch_scc1 L_F1_mid
  s_cmp_lg_u32 s20, 0
  s_cbranch_scc1 L_F1_park
  buffer_load_dword v3, v2, s[4:7], s30 offen sc1
  s_waitcnt vmcnt(1)
  s_barrier
  s_mov_b32 s63, s25
  s_atomic_smax s63, s[4:5], s62 glc
Lnosig_139:
  s_cmp_ge_u32 s25, 64
  s_cbranch_scc1 L_END
  s_waitcnt vmcnt(0)
  v_cmp_gt_i32 vcc, s29, v3
  s_cbranch_vccz L_F1_issue
  s_nop 3
Lpoll_140:
  buffer_load_dword v3, v2, s[4:7], s30 offen sc1
  s_sub_u32 s24, s24, 1
  s_cbranch_scc1 L_FAIL
  s_waitcnt vmcnt(0)
  v_cmp_gt_i32 vcc, s29, v3
  s_cbranch_vccz Lpolld_141
  s_sleep 1
  s_branch Lpoll_140
Lpolld_141:
  s_branch L_F1_issue
L_F1_park:
  s_waitcnt vmcnt(0)
  s_barrier
  s_cmp_ge_u32 s25, 64
  s_cbranch_scc1 L_END
L_F1_issue:
  s_barrier
L_F1_mid:
  s_mov_b32 s34, s26
  s_mov_b32 s35, s27
  s_add_u32 s36, s32, 0
  s_add_u32 m0, s34, s36
  s_add_u32 s36, s35, 0
  buffer_load_dwordx4 v1, s[4:7], s36 offen offset:0 sc1 lds
  s_nop 0
  buffer_load_dwordx4 v1, s[4:7], s36 offen offset:1024 sc1 lds
  s_nop 0
  buffer_load_dwordx4 v1, s[4:7], s36 offen offset:2048 sc1 lds
  s_nop 0
  buffer_load_dwordx4 v1, s[4:7], s36 offen offset:3072 sc1 lds
  s_nop 0
  s_add_u32 s36, s32, 16384
  s_add_u32 m0, s34, s36
  s_add_u32 s36, s35, 32768
  buffer_load_dwordx4 v1, s[4:7], s36 offen offset:0 sc1 lds
  s_nop 0
  buffer_load_dwordx4 v1, s[4:7], s36 offen offset:1024 sc1 lds
  s_nop 0
  buffer_load_dwordx4 v1, s[4:7], s36 offen offset:2048 sc1 lds
  s_nop 0
  buffer_load_dwordx4 v1, s[4:7], s36 offen offset:3072 sc1 lds
  s_nop 0
  s_add_u32 s36, s32, 32768
  s_add_u32 m0, s34, s36
  s_add_u32 s36, s35, 65536
  buffer_load_dwordx4 v1, s[4:7], s36 offen offset:0 sc1 lds
  s_nop 0
  buffer_load_dwordx4 v1, s[4:7], s36 offen offset:1024 sc1 lds
  s_nop 0
  buffer_load_dwordx4 v1, s[4:7], s36 offen offset:2048 sc1 lds
  s_nop 0
  buffer_load_dwordx4 v1, s[4:7], s36 offen offset:3072 sc1 lds
  s_nop 0
  s_cmp_eq_u32 s28, 0
  s_cbranch_scc1 L_F1_go
  s_mov_b32 s28, 0
  s_waitcnt vmcnt(12)
  s_barrier
  s_cmp_lg_u32 s20, 0
  s_cbranch_scc1 Lnosig_142
  s_mov_b32 s63, s25
  s_atomic_smax s63, s[4:5], s62 glc
Lnosig_142:
L_F1_go:
  v_add_u32 v73, s26, v69
  v_add_u32 v74, s26, v70
  s_sub_u32 s26, 65536, s26
  s_add_u32 s27, s27, 2097152
  s_xor_b32 s27, s27, 0x2000
  s_add_u32 s29, s29, 1
  s_waitcnt vmcnt(8)
  s_barrier
  ds_read_b128 v[4:7], v73 offset:0
  ds_read_b128 v[8:11], v73 offset:1024
  ds_read_b128 v[12:15], v73 offset:2048
  ds_read_b128 v[16:19], v73 offset:3072
  ds_read_b128 v[20:23], v73 offset:4096
  ds_read_b128 v[24:27], v73 offset:5120
  s_waitcnt lgkmcnt(4)
  v_mfma_f32_16x16x32_bf16 v[36:39], a[0:3], v[4:7], 0
  ds_read_b128 v[28:31], v73 offset:6144
  v_mfma_f32_16x16x32_bf16 v[40:43], a[0:3], v[8:11], 0
  ds_read_b128 v[32:35], v73 offset:7168
  v_mfma_f32_16x16x32_bf16 v[44:47], a[128:131], v[4:7], 0
  s_add_u32 s36, s32, 49152
  s_add_u32 m0, s34, s36
  s_add_u32 s36, s35, 98304
  buffer_load_dwordx4 v1, s[4:7], s36 offen offset:0 sc1 lds
  v_mfma_f32_16x16x32_bf16 v[48:51], a[128:131], v[8:11], 0
  s_waitcnt lgkmcnt(4)
  v_mfma_f32_16x16x32_bf16 v[36:39], a[4:7], v[12:15], v[36:39]
  ds_read_b128 v[4:7], v73 offset:8192
  v_mfma_f32_16x16x32_bf16 v[40:43], a[4:7], v[16:19], v[40:43]
  ds_read_b128 v[8:11], v73 offset:9216
  v_mfma_f32_16x16x32_bf16 v[44:47], a[132:135], v[12:15], v[44:47]
  buffer_load_dwordx4 v1, s[4:7], s36 offen offset:1024 sc1 lds
  v_mfma_f32_16x16x32_bf16 v[48:51], a[132:135], v[16:19], v[48:51]
  s_waitcnt lgkmcnt(4)
  v_mfma_f32_16x16x32_bf16 v[36:39], a[8:11], v[20:23], v[36:39]
  ds_read_b128 v[12:15], v73 offset:10240
  v_mfma_f32_16x16x32_bf16 v[40:43], a[8:11], v[24:27], v[40:43]
  ds_read_b128 v[16:19], v73 offset:11264
  v_mfma_f32_16x16x32_bf16 v[44:47], a[136:139], v[20:23], v[44:47]
  buffer_load_dwordx4 v1, s[4:7], s36 offen offset:2048 sc1 lds
  v_mfma_f32_16x16x32_bf16 v[48:51], a[136:139], v[24:27], v[48:51]
  s_waitcnt lgkmcnt(4)
  v_mfma_f32_16x16x32_bf16 v[36:39], a[12:15], v[28:31], v[36:39]
  ds_read_b128 v[20:23], v73 offset:12288
  v_mfma_f32_16x16x32_bf16 v[40:43], a[12:15], v[32:35], v[40:43]
  ds_read_b128 v[24:27], v73 offset:13312
  v_mfma_f32_16x16x32_bf16 v[44:47], a[140:143], v[28:31], v[44:47]
  buffer_load_dwordx4 v1, s[4:7], s36 offen offset:3072 sc1 lds
  v_mfma_f32_16x16x32_bf16 v[48:51], a[140:143], v[32:35], v[48:51]
  s_waitcnt lgkmcnt(4)
  v_mfma_f32_16x16x32_bf16 v[36:39], a[16:19], v[4:7], v[36:39]
  ds_read_b128 v[28:31], v73 offset:14336
  v_mfma_f32_16x16x32_bf16 v[40:43], a[16:19], v[8:11], v[40:43]
  ds_read_b128 v[32:35], v73 offset:15360
  v_mfma_f32_16x16x32_bf16 v[44:47], a[144:147], v[4:7], v[44:47]
  v_mfma_f32_16x16x32_bf16 v[48:51], a[144:147], v[8:11], v[48:51]
  s_waitcnt vmcnt(8)
  s_barrier
  s_mov_b32 s34, s26
  s_mov_b32 s35, s27
  s_waitcnt lgkmcnt(4)
  v_mfma_f32_16x16x32_bf16 v[36:39], a[20:23], v[12:15], v[36:39]
  ds_read_b128 v[4:7], v73 offset:16384
  v_mfma_f32_16x16x32_bf16 v[40:43], a[20:23], v[16:19], v[40:43]
  ds_read_b128 v[8:11], v73 offset:17408
  v_mfma_f32_16x16x32_bf16 v[44:47], a[148:151], v[12:15], v[44:47]
  v_mfma_f32_16x16x32_bf16 v[48:51], a[148:151], v[16:19], v[48:51]
  s_waitcnt lgkmcnt(4)
  v_mfma_f32_16x16x32_bf16 v[36:39], a[24:27], v[20:23], v[36:39]
  ds_read_b128 v[12:15], v73 offset:18432
  v_mfma_f32_16x16x32_bf16 v[40:43], a[24:27], v[24:27], v[40:43]
  ds_read_b128 v[16:19], v73 offset:19456
  v_mfma_f32_16x16x32_bf16 v[44:47], a[152:155], v[20:23], v[44:47]
  v_mfma_f32_16x16x32_bf16 v[48:51], a[152:155], v[24:27], v[48:51]
  s_waitcnt lgkmcnt(4)
  v_mfma_f32_16x16x32_bf16 v[36:39], a[28:31], v[28:31], v[36:39]
  ds_read_b128 v[20:23], v73 offset:20480
  v_mfma_f32_16x16x32_bf16 v[40:43], a[28:31], v[32:35], v[40:43]
  ds_read_b128 v[24:27], v73 offset:21504
  v_mfma_f32_16x16x32_bf16 v[44:47], a[156:159], v[28:31], v[44:47]
  v_mfma_f32_16x16x32_bf16 v[48:51], a[156:159], v[32:35], v[48:51]
  s_waitcnt lgkmcnt(4)
  v_mfma_f32_16x16x32_bf16 v[36:39], a[32:35], v[4:7], v[36:39]
  ds_read_b128 v[28:31], v73 offset:22528
  v_mfma_f32_16x16x32_bf16 v[40:43], a[32:35], v[8:11], v[40:43]
  ds_read_b128 v[32:35], v73 offset:23552
  v_mfma_f32_16x16x32_bf16 v[44:47], a[160:163], v[4:7], v[44:47]
  v_mfma_f32_16x16x32_bf16 v[48:51], a[160:163], v[8:11], v[48:51]
  s_waitcnt lgkmcnt(4)
  v_mfma_f32_16x16x32_bf16 v[36:39], a[36:39], v[12:15], v[36:39]
  ds_read_b128 v[4:7], v73 offset:24576
  v_mfma_f32_16x16x32_bf16 v[40:43], a[36:39], v[16:19], v[40:43]
  ds_read_b128 v[8:11], v73 offset:25600
  v_mfma_f32_16x16x32_bf16 v[44:47], a[164:167], v[12:15], v[44:47]
  v_mfma_f32_16x16x32_bf16 v[48:51], a[164:167], v[16:19], v[48:51]
  s_waitcnt lgkmcnt(4)
  v_mfma_f32_16x16x32_bf16 v[36:39], a[40:43], v[20:23], v[36:39]
  ds_read_b128 v[12:15], v73 offset:26624
  v_mfma_f32_16x16x32_bf16 v[40:43], a[40:43], v[24:27], v[40:43]
  ds_read_b128 v[16:19], v73 offset:27648
  v_mfma_f32_16x16x32_bf16 v[44:47], a[168:171], v[20:23], v[44:47]
  v_mfma_f32_16x16x32_bf16 v[48:51], a[168:171], v[24:27], v[48:51]
  s_waitcnt lgkmcnt(4)
  v_mfma_f32_16x16x32_bf16 v[36:39], a[44:47], v[28:31], v[36:39]
  ds_read_b128 v[20:23], v73 offset:28672
  v_mfma_f32_16x16x32_bf16 v[40:43], a[44:47], v[32:35], v[40:43]
  ds_read_b128 v[24:27], v73 offset:29696
  v_mfma_f32_16x16x32_bf16 v[44:47], a[172:175], v[28:31], v[44:47]
  v_mfma_f32_16x16x32_bf16 v[48:51], a[172:175], v[32:35], v[48:51]
  s_lshl_b32 s40, s20, 8
  s_add_u32 m0, s40, 131072
  s_cmp_eq_u32 s20, 0
  s_cselect_b32 s40, s30, 2147483392
  buffer_load_dword v2, s[4:7], s40 offen sc1 lds
  s_waitcnt lgkmcnt(4)
  v_mfma_f32_16x16x32_bf16 v[36:39], a[48:51], v[4:7], v[36:39]
  ds_read_b128 v[28:31], v73 offset:30720
  v_mfma_f32_16x16x32_bf16 v[40:43], a[48:51], v[8:11], v[40:43]
  ds_read_b128 v[32:35], v73 offset:31744
  v_mfma_f32_16x16x32_bf16 v[44:47], a[176:179], v[4:7], v[44:47]
  v_mfma_f32_16x16x32_bf16 v[48:51], a[176:179], v[8:11], v[48:51]
  s_waitcnt vmcnt(5)
  s_barrier
  s_lshl_b32 s40, s20, 1
  s_add_u32 s40, s40, 1
  s_cmp_lg_u32 s40, s28
  s_cbranch_scc1 L_F1_s2
  s_mov_b32 s63, s25
  s_atomic_smax s63, s[4:5], s62 glc
Lnosig_143:
L_F1_s2:
  s_waitcnt lgkmcnt(4)
  v_mfma_f32_16x16x32_bf16 v[36:39], a[52:55], v[12:15], v[36:39]
  ds_read_b128 v[4:7], v73 offset:32768
  v_mfma_f32_16x16x32_bf16 v[40:43], a[52:55], v[16:19], v[40:43]
  ds_read_b128 v[8:11], v73 offset:33792
  v_mfma_f32_16x16x32_bf16 v[44:47], a[180:183], v[12:15], v[44:47]
  v_mfma_f32_16x16x32_bf16 v[48:51], a[180:183], v[16:19], v[48:51]
  s_waitcnt lgkmcnt(4)
  v_mfma_f32_16x16x32_bf16 v[36:39], a[56:59], v[20:23], v[36:39]
  ds_read_b128 v[12:15], v73 offset:34816
  v_mfma_f32_16x16x32_bf16 v[40:43], a[56:59], v[24:27], v[40:43]
  ds_read_b128 v[16:19], v73 offset:35840
  v_mfma_f32_16x16x32_bf16 v[44:47], a[184:187], v[20:23], v[44:47]
  v_mfma_f32_16x16x32_bf16 v[48:51], a[184:187], v[24:27], v[48:51]
  s_waitcnt lgkmcnt(4)
  v_mfma_f32_16x16x32_bf16 v[36:39], a[60:63], v[28:31], v[36:39]
  ds_read_b128 v[20:23], v73 offset:36864
  v_mfma_f32_16x16x32_bf16 v[40:43], a[60:63], v[32:35], v[40:43]
  ds_read_b128 v[24:27], v73 offset:37888
  v_mfma_f32_16x16x32_bf16 v[44:47], a[188:191], v[28:31], v[44:47]
  v_mfma_f32_16x16x32_bf16 v[48:51], a[188:191], v[32:35], v[48:51]
  s_waitcnt lgkmcnt(4)
  v_mfma_f32_16x16x32_bf16 v[36:39], a[64:67], v[4:7], v[36:39]
  ds_read_b128 v[28:31], v73 offset:38912
  v_mfma_f32_16x16x32_bf16 v[40:43], a[64:67], v[8:11], v[40:43]
  ds_read_b128 v[32:35], v73 offset:39936
  v_mfma_f32_16x16x32_bf16 v[44:47], a[192:195], v[4:7], v[44:47]
  v_mfma_f32_16x16x32_bf16 v[48:51], a[192:195], v[8:11], v[48:51]
  s_waitcnt lgkmcnt(4)
  v_mfma_f32_16x16x32_bf16 v[36:39], a[68:71], v[12:15], v[36:39]
  ds_read_b128 v[4:7], v73 offset:40960
  v_mfma_f32_16x16x32_bf16 v[40:43], a[68:71], v[16:19], v[40:43]
  ds_read_b128 v[8:11], v73 offset:41984
  v_mfma_f32_16x16x32_bf16 v[44:47], a[196:199], v[12:15], v[44:47]
  v_mfma_f32_16x16x32_bf16 v[48:51], a[196:199], v[16:19], v[48:51]
  s_waitcnt lgkmcnt(4)
  v_mfma_f32_16x16x32_bf16 v[36:39], a[72:75], v[20:23], v[36:39]
  ds_read_b128 v[12:15], v73 offset:43008
  v_mfma_f32_16x16x32_bf16 v[40:43], a[72:75], v[24:27], v[40:43]
  ds_read_b128 v[16:19], v73 offset:44032
  v_mfma_f32_16x16x32_bf16 v[44:47], a[200:203], v[20:23], v[44:47]
  v_mfma_f32_16x16x32_bf16 v[48:51], a[200:203], v[24:27], v[48:51]
  s_waitcnt vmcnt(0)
  s_barrier
  ds_read_b32 v3, v71
  s_waitcnt lgkmcnt(4)
  v_mfma_f32_16x16x32_bf16 v[36:39], a[76:79], v[28:31], v[36:39]
  ds_read_b128 v[20:23], v73 offset:45056
  v_mfma_f32_16x16x32_bf16 v[40:43], a[76:79], v[32:35], v[40:43]
  ds_read_b128 v[24:27], v73 offset:46080
  v_mfma_f32_16x16x32_bf16 v[44:47], a[204:207], v[28:31], v[44:47]
  v_mfma_f32_16x16x32_bf16 v[48:51], a[204:207], v[32:35], v[48:51]
  s_waitcnt lgkmcnt(4)
  v_mfma_f32_16x16x32_bf16 v[36:39], a[80:83], v[4:7], v[36:39]
  ds_read_b128 v[28:31], v73 offset:47104
  v_mfma_f32_16x16x32_bf16 v[40:43], a[80:83], v[8:11], v[40:43]
  ds_read_b128 v[32:35], v73 offset:48128
  v_mfma_f32_16x16x32_bf16 v[44:47], a[208:211], v[4:7], v[44:47]
  v_mfma_f32_16x16x32_bf16 v[48:51], a[208:211], v[8:11], v[48:51]
  s_waitcnt lgkmcnt(4)
  v_cmp_gt_i32 vcc, s29, v3
  s_mov_b32 s28, 0
  s_cbranch_vccnz L_F1_nopf
  s_cmp_ge_u32 s25, 63
  s_cbranch_scc1 L_F1_nopf
  s_mov_b32 s28, 1
  s_waitcnt lgkmcnt(4)
  v_mfma_f32_16x16x32_bf16 v[36:39], a[84:87], v[12:15], v[36:39]
  ds_read_b128 v[4:7], v73 offset:49152
  v_mfma_f32_16x16x32_bf16 v[40:43], a[84:87], v[16:19], v[40:43]
  ds_read_b128 v[8:11], v73 offset:50176
  v_mfma_f32_16x16x32_bf16 v[44:47], a[212:215], v[12:15], v[44:47]
  s_add_u32 s36, s32, 0
  s_add_u32 m0, s34, s36
  s_add_u32 s36, s35, 0
  buffer_load_dwordx4 v1, s[4:7], s36 offen offset:0 sc1 lds
  v_mfma_f32_16x16x32_bf16 v[48:51], a[212:215], v[16:19], v[48:51]
  buffer_load_dwordx4 v1, s[4:7], s36 offen offset:1024 sc1 lds
  s_waitcnt lgkmcnt(4)
  v_mfma_f32_16x16x32_bf16 v[36:39], a[88:91], v[20:23], v[36:39]
  ds_read_b128 v[12:15], v73 offset:51200
  v_mfma_f32_16x16x32_bf16 v[40:43], a[88:91], v[24:27], v[40:43]
  ds_read_b128 v[16:19], v73 offset:52224
  v_mfma_f32_16x16x32_bf16 v[44:47], a[216:219], v[20:23], v[44:47]
  buffer_load_dwordx4 v1, s[4:7], s36 offen offset:2048 sc1 lds
  v_mfma_f32_16x16x32_bf16 v[48:51], a[216:219], v[24:27], v[48:51]
  buffer_load_dwordx4 v1, s[4:7], s36 offen offset:3072 sc1 lds
  s_waitcnt lgkmcnt(4)
  v_mfma_f32_16x16x32_bf16 v[36:39], a[92:95], v[28:31], v[36:39]
  ds_read_b128 v[20:23], v73 offset:53248
  v_mfma_f32_16x16x32_bf16 v[40:43], a[92:95], v[32:35], v[40:43]
  ds_read_b128 v[24:27], v73 offset:54272
  v_mfma_f32_16x16x32_bf16 v[44:47], a[220:223], v[28:31], v[44:47]
  s_add_u32 s36, s32, 16384
  s_add_u32 m0, s34, s36
  s_add_u32 s36, s35, 32768
  buffer_load_dwordx4 v1, s[4:7], s36 offen offset:0 sc1 lds
  v_mfma_f32_16x16x32_bf16 v[48:51], a[220:223], v[32:35], v[48:51]
  buffer_load_dwordx4 v1, s[4:7], s36 offen offset:1024 sc1 lds
  s_waitcnt lgkmcnt(4)
  v_mfma_f32_16x16x32_bf16 v[36:39], a[96:99], v[4:7], v[36:39]
  ds_read_b128 v[28:31], v73 offset:55296
  v_mfma_f32_16x16x32_bf16 v[40:43], a[96:99], v[8:11], v[40:43]
  ds_read_b128 v[32:35], v73 offset:56320
  v_mfma_f32_16x16x32_bf16 v[44:47], a[224:227], v[4:7], v[44:47]
  buffer_load_dwordx4 v1, s[4:7], s36 offen offset:2048 sc1 lds
  v_mfma_f32_16x16x32_bf16 v[48:51], a[224:227], v[8:11], v[48:51]
  buffer_load_dwordx4 v1, s[4:7], s36 offen offset:3072 sc1 lds
  s_waitcnt lgkmcnt(4)
  v_mfma_f32_16x16x32_bf16 v[36:39], a[100:103], v[12:15], v[36:39]
  ds_read_b128 v[4:7], v73 offset:57344
  v_mfma_f32_16x16x32_bf16 v[40:43], a[100:103], v[16:19], v[40:43]
  ds_read_b128 v[8:11], v73 offset:58368
  v_mfma_f32_16x16x32_bf16 v[44:47], a[228:231], v[12:15], v[44:47]
  s_add_u32 s36, s32, 32768
  s_add_u32 m0, s34, s36
  s_add_u32 s36, s35, 65536
  buffer_load_dwordx4 v1, s[4:7], s36 offen offset:0 sc1 lds
  v_mfma_f32_16x16x32_bf16 v[48:51], a[228:231], v[16:19], v[48:51]
  buffer_load_dwordx4 v1, s[4:7], s36 offen offset:1024 sc1 lds
  s_waitcnt lgkmcnt(4)
  v_mfma_f32_16x16x32_bf16 v[36:39], a[104:107], v[20:23], v[36:39]
  ds_read_b128 v[12:15], v73 offset:59392
  v_mfma_f32_16x16x32_bf16 v[40:43], a[104:107], v[24:27], v[40:43]
  ds_read_b128 v[16:19], v73 offset:60416
  v_mfma_f32_16x16x32_bf16 v[44:47], a[232:235], v[20:23], v[44:47]
  buffer_load_dwordx4 v1, s[4:7], s36 offen offset:2048 sc1 lds
  v_mfma_f32_16x16x32_bf16 v[48:51], a[232:235], v[24:27], v[48:51]
  buffer_load_dwordx4 v1, s[4:7], s36 offen offset:3072 sc1 lds
  s_waitcnt lgkmcnt(4)
  v_mfma_f32_16x16x32_bf16 v[36:39], a[108:111], v[28:31], v[36:39]
  ds_read_b128 v[20:23], v73 offset:61440
  v_mfma_f32_16x16x32_bf16 v[40:43], a[108:111], v[32:35], v[40:43]
  ds_read_b128 v[24:27], v73 offset:62464
  v_mfma_f32_16x16x32_bf16 v[44:47], a[236:239], v[28:31], v[44:47]
  v_mfma_f32_16x16x32_bf16 v[48:51], a[236:239], v[32:35], v[48:51]
  s_waitcnt lgkmcnt(4)
  v_mfma_f32_16x16x32_bf16 v[36:39], a[112:115], v[4:7], v[36:39]
  ds_read_b128 v[28:31], v73 offset:63488
  v_mfma_f32_16x16x32_bf16 v[40:43], a[112:115], v[8:11], v[40:43]
  ds_read_b128 v[32:35], v73 offset:64512
  v_mfma_f32_16x16x32_bf16 v[44:47], a[240:243], v[4:7], v[44:47]
  v_mfma_f32_16x16x32_bf16 v[48:51], a[240:243], v[8:11], v[48:51]
  s_waitcnt lgkmcnt(4)
  v_mfma_f32_16x16x32_bf16 v[36:39], a[116:119], v[12:15], v[36:39]
  v_mfma_f32_16x16x32_bf16 v[40:43], a[116:119], v[16:19], v[40:43]
  v_mfma_f32_16x16x32_bf16 v[44:47], a[244:247], v[12:15], v[44:47]
  v_mfma_f32_16x16x32_bf16 v[48:51], a[244:247], v[16:19], v[48:51]
  s_waitcnt lgkmcnt(2)
  v_mfma_f32_16x16x32_bf16 v[36:39], a[120:123], v[20:23], v[36:39]
  v_mfma_f32_16x16x32_bf16 v[40:43], a[120:123], v[24:27], v[40:43]
  v_mfma_f32_16x16x32_bf16 v[44:47], a[248:251], v[20:23], v[44:47]
  v_mfma_f32_16x16x32_bf16 v[48:51], a[248:251], v[24:27], v[48:51]
  s_waitcnt lgkmcnt(0)
  v_mfma_f32_16x16x32_bf16 v[36:39], a[124:127], v[28:31], v[36:39]
  v_mfma_f32_16x16x32_bf16 v[40:43], a[124:127], v[32:35], v[40:43]
  v_mfma_f32_16x16x32_bf16 v[44:47], a[252:255], v[28:31], v[44:47]
  v_mfma_f32_16x16x32_bf16 v[48:51], a[252:255], v[32:35], v[48:51]
  s_nop 7
  s_branch L_F1_epi
L_F1_nopf:
  s_waitcnt lgkmcnt(4)
  v_mfma_f32_16x16x32_bf16 v[36:39], a[84:87], v[12:15], v[36:39]
  ds_read_b128 v[4:7], v73 offset:49152
  v_mfma_f32_16x16x32_bf16 v[40:43], a[84:87], v[16:19], v[40:43]
  ds_read_b128 v[8:11], v73 offset:50176
  v_mfma_f32_16x16x32_bf16 v[44:47], a[212:215], v[12:15], v[44:47]
  v_mfma_f32_16x16x32_bf16 v[48:51], a[212:215], v[16:19], v[48:51]
  s_waitcnt lgkmcnt(4)
  v_mfma_f32_16x16x32_bf16 v[36:39], a[88:91], v[20:23], v[36:39]
  ds_read_b128 v[12:15], v73 offset:51200
  v_mfma_f32_16x16x32_bf16 v[40:43], a[88:91], v[24:27], v[40:43]
  ds_read_b128 v[16:19], v73 offset:52224
  v_mfma_f32_16x16x32_bf16 v[44:47], a[216:219], v[20:23], v[44:47]
  v_mfma_f32_16x16x32_bf16 v[48:51], a[216:219], v[24:27], v[48:51]
  s_waitcnt lgkmcnt(4)
  v_mfma_f32_16x16x32_bf16 v[36:39], a[92:95], v[28:31], v[36:39]
  ds_read_b128 v[20:23], v73 offset:53248
  v_mfma_f32_16x16x32_bf16 v[40:43], a[92:95], v[32:35], v[40:43]
  ds_read_b128 v[24:27], v73 offset:54272
  v_mfma_f32_16x16x32_bf16 v[44:47], a[220:223], v[28:31], v[44:47]
  v_mfma_f32_16x16x32_bf16 v[48:51], a[220:223], v[32:35], v[48:51]
  s_barrier
  s_lshl_b32 s40, s20, 8
  s_add_u32 m0, s40, 131072
  s_cmp_eq_u32 s20, 0
  s_cselect_b32 s40, s30, 2147483392
  buffer_load_dword v2, s[4:7], s40 offen sc1 lds
  s_waitcnt lgkmcnt(4)
  v_mfma_f32_16x16x32_bf16 v[36:39], a[96:99], v[4:7], v[36:39]
  ds_read_b128 v[28:31], v73 offset:55296
  v_mfma_f32_16x16x32_bf16 v[40:43], a[96:99], v[8:11], v[40:43]
  ds_read_b128 v[32:35], v73 offset:56320
  v_mfma_f32_16x16x32_bf16 v[44:47], a[224:227], v[4:7], v[44:47]
  v_mfma_f32_16x16x32_bf16 v[48:51], a[224:227], v[8:11], v[48:51]
  s_waitcnt lgkmcnt(4)
  v_mfma_f32_16x16x32_bf16 v[36:39], a[100:103], v[12:15], v[36:39]
  ds_read_b128 v[4:7], v73 offset:57344
  v_mfma_f32_16x16x32_bf16 v[40:43], a[100:103], v[16:19], v[40:43]
  ds_read_b128 v[8:11], v73 offset:58368
  v_mfma_f32_16x16x32_bf16 v[44:47], a[228:231], v[12:15], v[44:47]
  v_mfma_f32_16x16x32_bf16 v[48:51], a[228:231], v[16:19], v[48:51]
  s_waitcnt lgkmcnt(4)
  v_mfma_f32_16x16x32_bf16 v[36:39], a[104:107], v[20:23], v[36:39]
  ds_read_b128 v[12:15], v73 offset:59392
  v_mfma_f32_16x16x32_bf16 v[40:43], a[104:107], v[24:27], v[40:43]
  ds_read_b128 v[16:19], v73 offset:60416
  v_mfma_f32_16x16x32_bf16 v[44:47], a[232:235], v[20:23], v[44:47]
  v_mfma_f32_16x16x32_bf16 v[48:51], a[232:235], v[24:27], v[48:51]
  s_waitcnt lgkmcnt(4)
  v_mfma_f32_16x16x32_bf16 v[36:39], a[108:111], v[28:31], v[36:39]
  ds_read_b128 v[20:23], v73 offset:61440
  v_mfma_f32_16x16x32_bf16 v[40:43], a[108:111], v[32:35], v[40:43]
  ds_read_b128 v[24:27], v73 offset:62464
  v_mfma_f32_16x16x32_bf16 v[44:47], a[236:239], v[28:31], v[44:47]
  v_mfma_f32_16x16x32_bf16 v[48:51], a[236:239], v[32:35], v[48:51]
  s_waitcnt lgkmcnt(4)
  v_mfma_f32_16x16x32_bf16 v[36:39], a[112:115], v[4:7], v[36:39]
  ds_read_b128 v[28:31], v73 offset:63488
  v_mfma_f32_16x16x32_bf16 v[40:43], a[112:115], v[8:11], v[40:43]
  ds_read_b128 v[32:35], v73 offset:64512
  v_mfma_f32_16x16x32_bf16 v[44:47], a[240:243], v[4:7], v[44:47]
  v_mfma_f32_16x16x32_bf16 v[48:51], a[240:243], v[8:11], v[48:51]
  s_waitcnt lgkmcnt(4)
  v_mfma_f32_16x16x32_bf16 v[36:39], a[116:119], v[12:15], v[36:39]
  v_mfma_f32_16x16x32_bf16 v[40:43], a[116:119], v[16:19], v[40:43]
  v_mfma_f32_16x16x32_bf16 v[44:47], a[244:247], v[12:15], v[44:47]
  v_mfma_f32_16x16x32_bf16 v[48:51], a[244:247], v[16:19], v[48:51]
  s_waitcnt vmcnt(0)
  s_barrier
  ds_read_b32 v3, v71
  s_waitcnt lgkmcnt(2)
  v_mfma_f32_16x16x32_bf16 v[36:39], a[120:123], v[20:23], v[36:39]
  v_mfma_f32_16x16x32_bf16 v[40:43], a[120:123], v[24:27], v[40:43]
  v_mfma_f32_16x16x32_bf16 v[44:47], a[248:251], v[20:23], v[44:47]
  v_mfma_f32_16x16x32_bf16 v[48:51], a[248:251], v[24:27], v[48:51]
  s_waitcnt lgkmcnt(0)
  v_mfma_f32_16x16x32_bf16 v[36:39], a[124:127], v[28:31], v[36:39]
  v_mfma_f32_16x16x32_bf16 v[40:43], a[124:127], v[32:35], v[40:43]
  v_mfma_f32_16x16x32_bf16 v[44:47], a[252:255], v[28:31], v[44:47]
  v_mfma_f32_16x16x32_bf16 v[48:51], a[252:255], v[32:35], v[48:51]
  v_cmp_gt_i32 vcc, s29, v3
  s_cmp_eq_u64 vcc, 0
  s_cselect_b32 s28, 2, 0
  s_cmp_lt_u32 s25, 63
  s_cselect_b32 s28, s28, 0
L_F1_epi:
  v_mul_f32 v52, s37, v36
  v_mul_f32 v53, s37, v37
  v_mul_f32 v54, s37, v38
  v_mul_f32 v55, s37, v39
  v_mul_f32 v56, s37, v40
  v_mul_f32 v57, s37, v41
  v_mul_f32 v58, s37, v42
  v_mul_f32 v59, s37, v43
  v_exp_f32 v52, v52
  v_exp_f32 v53, v53
  v_exp_f32 v54, v54
  v_exp_f32 v55, v55
  v_exp_f32 v56, v56
  v_exp_f32 v57, v57
  v_exp_f32 v58, v58
  v_exp_f32 v59, v59
  v_pk_mul_f32 v[36:37], v[36:37], v[44:45]
  v_pk_mul_f32 v[38:39], v[38:39], v[46:47]
  v_pk_mul_f32 v[40:41], v[40:41], v[48:49]
  v_pk_mul_f32 v[42:43], v[42:43], v[50:51]
  v_add_f32 v52, 1.0, v52
  v_add_f32 v53, 1.0, v53
  v_add_f32 v54, 1.0, v54
  v_add_f32 v55, 1.0, v55
  v_add_f32 v56, 1.0, v56
  v_add_f32 v57, 1.0, v57
  v_add_f32 v58, 1.0, v58
  v_add_f32 v59, 1.0, v59
  v_rcp_f32 v52, v52
  v_rcp_f32 v53, v53
  v_rcp_f32 v54, v54
  v_rcp_f32 v55, v55
  v_rcp_f32 v56, v56
  v_rcp_f32 v57, v57
  v_rcp_f32 v58, v58
  v_rcp_f32 v59, v59
  v_pk_mul_f32 v[36:37], v[36:37], v[52:53]
  v_pk_mul_f32 v[38:39], v[38:39], v[54:55]
  v_pk_mul_f32 v[40:41], v[40:41], v[56:57]
  v_pk_mul_f32 v[42:43], v[42:43], v[58:59]
  v_cvt_pk_bf16_f32 v60, v36, v37
  v_cvt_pk_bf16_f32 v61, v38, v39
  v_cvt_pk_bf16_f32 v62, v40, v41
  v_cvt_pk_bf16_f32 v63, v42, v43
  s_nop 0
  v_permlane32_swap_b32 v60, v62
  v_permlane32_swap_b32 v61, v63
  buffer_store_dwordx4 v[60:63], v68, s[4:7], s31 offen sc1
  s_add_u32 s25, s25, 1
  s_add_u32 s31, s31, 2097152
  s_xor_b32 s31, s31, 0x2000
  s_branch L_F1_top
L_F2:
  v_lshlrev_b32 v1, 4, v0
  s_lshl_b32 s32, s20, 12
  s_min_u32 s33, s32, 0x2000
  v_mov_b32 v69, v1
  v_add_u32 v70, 0x10000, v69
  s_load_dwordx2 s[8:9], s[0:1], 80
  s_mov_b32 s10, 7340032
  s_mov_b32 s11, 0x20000
  s_waitcnt lgkmcnt(0)
  s_lshr_b32 s44, s21, 3
  s_mul_i32 s44, s44, 2490368
  s_and_b32 s45, s21, 7
  s_lshl_b32 s45, s45, 8
  s_add_u32 s44, s44, s45
  s_add_u32 s45, s44, 128
  s_cmp_ge_u32 s21, 16
  s_cselect_b32 s40, 131072, 0
  s_sub_u32 s44, s44, s40
  s_sub_u32 s45, s45, s40
  v_bfe_u32 v4, v0, 5, 1
  v_mul_u32_u24 v4, 8192, v4
  v_bfe_u32 v5, v0, 4, 1
  v_mul_u32_u24 v5, 4096, v5
  v_add_u32 v4, v4, v5
  v_bfe_u32 v5, v0, 3, 1
  v_mul_u32_u24 v5, 2048, v5
  v_add_u32 v4, v4, v5
  v_lshrrev_b32 v5, 3, v0
  v_and_b32 v5, 6, v5
  v_xor_b32 v5, v5, v0
  v_and_b32 v5, 7, v5
  v_lshl_add_u32 v4, v5, 4, v4
  s_lshr_b32 s40, s20, 1
  s_mul_i32 s40, s40, 16384
  s_and_b32 s41, s20, 1
  s_mul_i32 s41, s41, 32768
  s_add_u32 s40, s40, s41
  v_add_u32 v4, s40, v4
  v_bfe_u32 v5, v0, 3, 2
  v_xor_b32 v5, s20, v5
  v_lshlrev_b32 v5, 5, v5
  v_lshrrev_b32 v6, 2, v0
  v_lshl_add_u32 v6, v6, 7, v5
  v_and_b32 v5, 3, v0
  v_lshl_add_u32 v6, v5, 3, v6
  v_add_u32 v7, 0x10000, v6
  v_add_u32 v8, s44, v4
  v_add_u32 v9, s45, v4
  s_lshl_b32 s41, s20, 10
  s_add_u32 m0, s41, 0
  s_mov_b32 s42, 0
  buffer_load_dwordx4 v8, s[8:11], s42 offen nt lds
  s_add_u32 m0, s41, 4096
  s_mov_b32 s42, 0
  buffer_load_dwordx4 v9, s[8:11], s42 offen nt lds
  s_add_u32 m0, s41, 8192
  s_mov_b32 s42, 65536
  buffer_load_dwordx4 v8, s[8:11], s42 offen nt lds
  s_add_u32 m0, s41, 12288
  s_mov_b32 s42, 65536
  buffer_load_dwordx4 v9, s[8:11], s42 offen nt lds
  s_add_u32 m0, s41, 16384
  s_mov_b32 s42, 131072
  buffer_load_dwordx4 v8, s[8:11], s42 offen nt lds
  s_add_u32 m0, s41, 20480
  s_mov_b32 s42, 131072
  buffer_load_dwordx4 v9, s[8:11], s42 offen nt lds
  s_add_u32 m0, s41, 24576
  s_mov_b32 s42, 196608
  buffer_load_dwordx4 v8, s[8:11], s42 offen nt lds
  s_add_u32 m0, s41, 28672
  s_mov_b32 s42, 196608
  buffer_load_dwordx4 v9, s[8:11], s42 offen nt lds
  s_add_u32 m0, s41, 32768
  s_mov_b32 s42, 262144
  buffer_load_dwordx4 v8, s[8:11], s42 offen nt lds
  s_add_u32 m0, s41, 36864
  s_mov_b32 s42, 262144
  buffer_load_dwordx4 v9, s[8:11], s42 offen nt lds
  s_add_u32 m0, s41, 40960
  s_mov_b32 s42, 327680
  buffer_load_dwordx4 v8, s[8:11], s42 offen nt lds
  s_add_u32 m0, s41, 45056
  s_mov_b32 s42, 327680
  buffer_load_dwordx4 v9, s[8:11], s42 offen nt lds
  s_add_u32 m0, s41, 49152
  s_mov_b32 s42, 393216
  buffer_load_dwordx4 v8, s[8:11], s42 offen nt lds
  s_add_u32 m0, s41, 53248
  s_mov_b32 s42, 393216
  buffer_load_dwordx4 v9, s[8:11], s42 offen nt lds
  s_add_u32 m0, s41, 57344
  s_mov_b32 s42, 458752
  buffer_load_dwordx4 v8, s[8:11], s42 offen nt lds
  s_add_u32 m0, s41, 61440
  s_mov_b32 s42, 458752
  buffer_load_dwordx4 v9, s[8:11], s42 offen nt lds
  s_add_u32 m0, s41, 65536
  s_mov_b32 s42, 524288
  buffer_load_dwordx4 v8, s[8:11], s42 offen nt lds
  s_add_u32 m0, s41, 69632
  s_mov_b32 s42, 524288
  buffer_load_dwordx4 v9, s[8:11], s42 offen nt lds
  s_add_u32 m0, s41, 73728
  s_mov_b32 s42, 589824
  buffer_load_dwordx4 v8, s[8:11], s42 offen nt lds
  s_add_u32 m0, s41, 77824
  s_mov_b32 s42, 589824
  buffer_load_dwordx4 v9, s[8:11], s42 offen nt lds
  s_add_u32 m0, s41, 81920
  s_mov_b32 s42, 655360
  buffer_load_dwordx4 v8, s[8:11], s42 offen nt lds
  s_add_u32 m0, s41, 86016
  s_mov_b32 s42, 655360
  buffer_load_dwordx4 v9, s[8:11], s42 offen nt lds
  s_add_u32 m0, s41, 90112
  s_mov_b32 s42, 720896
  buffer_load_dwordx4 v8, s[8:11], s42 offen nt lds
  s_add_u32 m0, s41, 94208
  s_mov_b32 s42, 720896
  buffer_load_dwordx4 v9, s[8:11], s42 offen nt lds
  s_add_u32 m0, s41, 98304
  s_mov_b32 s42, 786432
  buffer_load_dwordx4 v8, s[8:11], s42 offen nt lds
  s_add_u32 m0, s41, 102400
  s_mov_b32 s42, 786432
  buffer_load_dwordx4 v9, s[8:11], s42 offen nt lds
  s_add_u32 m0, s41, 106496
  s_mov_b32 s42, 851968
  buffer_load_dwordx4 v8, s[8:11], s42 offen nt lds
  s_add_u32 m0, s41, 110592
  s_mov_b32 s42, 851968
  buffer_load_dwordx4 v9, s[8:11], s42 offen nt lds
  s_waitcnt vmcnt(24) lgkmcnt(0)
  s_barrier
  s_add_u32 m0, s41, 114688
  s_mov_b32 s42, 917504
  buffer_load_dwordx4 v8, s[8:11], s42 offen nt lds
  s_add_u32 m0, s41, 118784
  s_mov_b32 s42, 917504
  buffer_load_dwordx4 v9, s[8:11], s42 offen nt lds
  s_add_u32 m0, s41, 122880
  s_mov_b32 s42, 983040
  buffer_load_dwordx4 v8, s[8:11], s42 offen nt lds
  s_add_u32 m0, s41, 126976
  s_mov_b32 s42, 983040
  buffer_load_dwordx4 v9, s[8:11], s42 offen nt lds
  ds_read_b64_tr_b16 a[0:1], v6 offset:0
  ds_read_b64_tr_b16 a[2:3], v6 offset:2048
  ds_read_b64_tr_b16 a[152:153], v6 offset:4096
  ds_read_b64_tr_b16 a[154:155], v6 offset:6144
  ds_read_b64_tr_b16 a[4:5], v6 offset:8192
  ds_read_b64_tr_b16 a[6:7], v6 offset:10240
  ds_read_b64_tr_b16 a[156:157], v6 offset:12288
  ds_read_b64_tr_b16 a[158:159], v6 offset:14336
  s_waitcnt vmcnt(24) lgkmcnt(0)
  s_barrier
  s_add_u32 m0, s41, 0
  s_mov_b32 s42, 1048576
  buffer_load_dwordx4 v8, s[8:11], s42 offen nt lds
  s_add_u32 m0, s41, 4096
  s_mov_b32 s42, 1048576
  buffer_load_dwordx4 v9, s[8:11], s42 offen nt lds
  s_add_u32 m0, s41, 8192
  s_mov_b32 s42, 1114112
  buffer_load_dwordx4 v8, s[8:11], s42 offen nt lds
  s_add_u32 m0, s41, 12288
  s_mov_b32 s42, 1114112
  buffer_load_dwordx4 v9, s[8:11], s42 offen nt lds
  ds_read_b64_tr_b16 a[8:9], v6 offset:16384
  ds_read_b64_tr_b16 a[10:11], v6 offset:18432
  ds_read_b64_tr_b16 a[160:161], v6 offset:20480
  ds_read_b64_tr_b16 a[162:163], v6 offset:22528
  ds_read_b64_tr_b16 a[12:13], v6 offset:24576
  ds_read_b64_tr_b16 a[14:15], v6 offset:26624
  ds_read_b64_tr_b16 a[164:165], v6 offset:28672
  ds_read_b64_tr_b16 a[166:167], v6 offset:30720
  s_waitcnt vmcnt(24) lgkmcnt(0)
  s_barrier
  s_add_u32 m0, s41, 16384
  s_mov_b32 s42, 1179648
  buffer_load_dwordx4 v8, s[8:11], s42 offen nt lds
  s_add_u32 m0, s41, 20480
  s_mov_b32 s42, 1179648
  buffer_load_dwordx4 v9, s[8:11], s42 offen nt lds
  s_add_u32 m0, s41, 24576
  s_mov_b32 s42, 1245184
  buffer_load_dwordx4 v8, s[8:11], s42 offen nt lds
  s_add_u32 m0, s41, 28672
  s_mov_b32 s42, 1245184
  buffer_load_dwordx4 v9, s[8:11], s42 offen nt lds
  ds_read_b64_tr_b16 a[16:17], v6 offset:32768
  ds_read_b64_tr_b16 a[18:19], v6 offset:34816
  ds_read_b64_tr_b16 a[168:169], v6 offset:36864
  ds_read_b64_tr_b16 a[170:171], v6 offset:38912
  ds_read_b64_tr_b16 a[20:21], v6 offset:40960
  ds_read_b64_tr_b16 a[22:23], v6 offset:43008
  ds_read_b64_tr_b16 a[172:173], v6 offset:45056
  ds_read_b64_tr_b16 a[174:175], v6 offset:47104
  s_waitcnt vmcnt(24) lgkmcnt(0)
  s_barrier
  s_add_u32 m0, s41, 32768
  s_mov_b32 s42, 1310720
  buffer_load_dwordx4 v8, s[8:11], s42 offen nt lds
  s_add_u32 m0, s41, 36864
  s_mov_b32 s42, 1310720
  buffer_load_dwordx4 v9, s[8:11], s42 offen nt lds
  s_add_u32 m0, s41, 40960
  s_mov_b32 s42, 1376256
  buffer_load_dwordx4 v8, s[8:11], s42 offen nt lds
  s_add_u32 m0, s41, 45056
  s_mov_b32 s42, 1376256
  buffer_load_dwordx4 v9, s[8:11], s42 offen nt lds
  ds_read_b64_tr_b16 a[24:25], v6 offset:49152
  ds_read_b64_tr_b16 a[26:27], v6 offset:51200
  ds_read_b64_tr_b16 a[176:177], v6 offset:53248
  ds_read_b64_tr_b16 a[178:179], v6 offset:55296
  ds_read_b64_tr_b16 a[28:29], v6 offset:57344
  ds_read_b64_tr_b16 a[30:31], v6 offset:59392
  ds_read_b64_tr_b16 a[180:181], v6 offset:61440
  ds_read_b64_tr_b16 a[182:183], v6 offset:63488
  s_waitcnt vmcnt(24) lgkmcnt(0)
  s_barrier
  s_add_u32 m0, s41, 49152
  s_mov_b32 s42, 1441792
  buffer_load_dwordx4 v8, s[8:11], s42 offen nt lds
  s_add_u32 m0, s41, 53248
  s_mov_b32 s42, 1441792
  buffer_load_dwordx4 v9, s[8:11], s42 offen nt lds
  s_add_u32 m0, s41, 57344
  s_mov_b32 s42, 1507328
  buffer_load_dwordx4 v8, s[8:11], s42 offen nt lds
  s_add_u32 m0, s41, 61440
  s_mov_b32 s42, 1507328
  buffer_load_dwordx4 v9, s[8:11], s42 offen nt lds
  ds_read_b64_tr_b16 a[32:33], v7 offset:0
  ds_read_b64_tr_b16 a[34:35], v7 offset:2048
  ds_read_b64_tr_b16 a[184:185], v7 offset:4096
  ds_read_b64_tr_b16 a[186:187], v7 offset:6144
  ds_read_b64_tr_b16 a[36:37], v7 offset:8192
  ds_read_b64_tr_b16 a[38:39], v7 offset:10240
  ds_read_b64_tr_b16 a[188:189], v7 offset:12288
  ds_read_b64_tr_b16 a[190:191], v7 offset:14336
  s_waitcnt vmcnt(24) lgkmcnt(0)
  s_barrier
  s_add_u32 m0, s41, 65536
  s_mov_b32 s42, 1572864
  buffer_load_dwordx4 v8, s[8:11], s42 offen nt lds
  s_add_u32 m0, s41, 69632
  s_mov_b32 s42, 1572864
  buffer_load_dwordx4 v9, s[8:11], s42 offen nt lds
  s_add_u32 m0, s41, 73728
  s_mov_b32 s42, 1638400
  buffer_load_dwordx4 v8, s[8:11], s42 offen nt lds
  s_add_u32 m0, s41, 77824
  s_mov_b32 s42, 1638400
  buffer_load_dwordx4 v9, s[8:11], s42 offen nt lds
  ds_read_b64_tr_b16 a[40:41], v7 offset:16384
  ds_read_b64_tr_b16 a[42:43], v7 offset:18432
  ds_read_b64_tr_b16 a[192:193], v7 offset:20480
  ds_read_b64_tr_b16 a[194:195], v7 offset:22528
  ds_read_b64_tr_b16 a[44:45], v7 offset:24576
  ds_read_b64_tr_b16 a[46:47], v7 offset:26624
  ds_read_b64_tr_b16 a[196:197], v7 offset:28672
  ds_read_b64_tr_b16 a[198:199], v7 offset:30720
  s_waitcnt vmcnt(24) lgkmcnt(0)
  s_barrier
  s_add_u32 m0, s41, 81920
  s_mov_b32 s42, 1703936
  buffer_load_dwordx4 v8, s[8:11], s42 offen nt lds
  s_add_u32 m0, s41, 86016
  s_mov_b32 s42, 1703936
  buffer_load_dwordx4 v9, s[8:11], s42 offen nt lds
  s_add_u32 m0, s41, 90112
  s_mov_b32 s42, 1769472
  buffer_load_dwordx4 v8, s[8:11], s42 offen nt lds
  s_add_u32 m0, s41, 94208
  s_mov_b32 s42, 1769472
  buffer_load_dwordx4 v9, s[8:11], s42 offen nt lds
  ds_read_b64_tr_b16 a[48:49], v7 offset:32768
  ds_read_b64_tr_b16 a[50:51], v7 offset:34816
  ds_read_b64_tr_b16 a[200:201], v7 offset:36864
  ds_read_b64_tr_b16 a[202:203], v7 offset:38912
  ds_read_b64_tr_b16 a[52:53], v7 offset:40960
  ds_read_b64_tr_b16 a[54:55], v7 offset:43008
  ds_read_b64_tr_b16 a[204:205], v7 offset:45056
  ds_read_b64_tr_b16 a[206:207], v7 offset:47104
  s_waitcnt vmcnt(24) lgkmcnt(0)
  s_barrier
  s_add_u32 m0, s41, 98304
  s_mov_b32 s42, 1835008
  buffer_load_dwordx4 v8, s[8:11], s42 offen nt lds
  s_add_u32 m0, s41, 102400
  s_mov_b32 s42, 1835008
  buffer_load_dwordx4 v9, s[8:11], s42 offen nt lds
  s_add_u32 m0, s41, 106496
  s_mov_b32 s42, 1900544
  buffer_load_dwordx4 v8, s[8:11], s42 offen nt lds
  s_add_u32 m0, s41, 110592
  s_mov_b32 s42, 1900544
  buffer_load_dwordx4 v9, s[8:11], s42 offen nt lds
  ds_read_b64_tr_b16 a[56:57], v7 offset:49152
  ds_read_b64_tr_b16 a[58:59], v7 offset:51200
  ds_read_b64_tr_b16 a[208:209], v7 offset:53248
  ds_read_b64_tr_b16 a[210:211], v7 offset:55296
  ds_read_b64_tr_b16 a[60:61], v7 offset:57344
  ds_read_b64_tr_b16 a[62:63], v7 offset:59392
  ds_read_b64_tr_b16 a[212:213], v7 offset:61440
  ds_read_b64_tr_b16 a[214:215], v7 offset:63488
  s_waitcnt vmcnt(24) lgkmcnt(0)
  s_barrier
  s_add_u32 m0, s41, 114688
  s_mov_b32 s42, 1966080
  buffer_load_dwordx4 v8, s[8:11], s42 offen nt lds
  s_add_u32 m0, s41, 118784
  s_mov_b32 s42, 1966080
  buffer_load_dwordx4 v9, s[8:11], s42 offen nt lds
  s_add_u32 m0, s41, 122880
  s_mov_b32 s42, 2031616
  buffer_load_dwordx4 v8, s[8:11], s42 offen nt lds
  s_add_u32 m0, s41, 126976
  s_mov_b32 s42, 2031616
  buffer_load_dwordx4 v9, s[8:11], s42 offen nt lds
  ds_read_b64_tr_b16 a[64:65], v6 offset:0
  ds_read_b64_tr_b16 a[66:67], v6 offset:2048
  ds_read_b64_tr_b16 a[216:217], v6 offset:4096
  ds_read_b64_tr_b16 a[218:219], v6 offset:6144
  ds_read_b64_tr_b16 a[68:69], v6 offset:8192
  ds_read_b64_tr_b16 a[70:71], v6 offset:10240
  ds_read_b64_tr_b16 a[220:221], v6 offset:12288
  ds_read_b64_tr_b16 a[222:223], v6 offset:14336
  s_waitcnt vmcnt(24) lgkmcnt(0)
  s_barrier
  s_add_u32 m0, s41, 0
  s_mov_b32 s42, 2097152
  buffer_load_dwordx4 v8, s[8:11], s42 offen nt lds
  s_add_u32 m0, s41, 4096
  s_mov_b32 s42, 2097152
  buffer_load_dwordx4 v9, s[8:11], s42 offen nt lds
  s_add_u32 m0, s41, 8192
  s_mov_b32 s42, 2162688
  buffer_load_dwordx4 v8, s[8:11], s42 offen nt lds
  s_add_u32 m0, s41, 12288
  s_mov_b32 s42, 2162688
  buffer_load_dwordx4 v9, s[8:11], s42 offen nt lds
  ds_read_b64_tr_b16 a[72:73], v6 offset:16384
  ds_read_b64_tr_b16 a[74:75], v6 offset:18432
  ds_read_b64_tr_b16 a[224:225], v6 offset:20480
  ds_read_b64_tr_b16 a[226:227], v6 offset:22528
  ds_read_b64_tr_b16 a[76:77], v6 offset:24576
  ds_read_b64_tr_b16 a[78:79], v6 offset:26624
  ds_read_b64_tr_b16 a[228:229], v6 offset:28672
  ds_read_b64_tr_b16 a[230:231], v6 offset:30720
  s_waitcnt vmcnt(24) lgkmcnt(0)
  s_barrier
  s_add_u32 m0, s41, 16384
  s_mov_b32 s42, 2228224
  buffer_load_dwordx4 v8, s[8:11], s42 offen nt lds
  s_add_u32 m0, s41, 20480
  s_mov_b32 s42, 2228224
  buffer_load_dwordx4 v9, s[8:11], s42 offen nt lds
  s_add_u32 m0, s41, 24576
  s_mov_b32 s42, 2293760
  buffer_load_dwordx4 v8, s[8:11], s42 offen nt lds
  s_add_u32 m0, s41, 28672
  s_mov_b32 s42, 2293760
  buffer_load_dwordx4 v9, s[8:11], s42 offen nt lds
  ds_read_b64_tr_b16 a[80:81], v6 offset:32768
  ds_read_b64_tr_b16 a[82:83], v6 offset:34816
  ds_read_b64_tr_b16 a[232:233], v6 offset:36864
  ds_read_b64_tr_b16 a[234:235], v6 offset:38912
  ds_read_b64_tr_b16 a[84:85], v6 offset:40960
  ds_read_b64_tr_b16 a[86:87], v6 offset:43008
  ds_read_b64_tr_b16 a[236:237], v6 offset:45056
  ds_read_b64_tr_b16 a[238:239], v6 offset:47104
  s_waitcnt vmcnt(24) lgkmcnt(0)
  s_barrier
  s_add_u32 m0, s41, 32768
  s_mov_b32 s42, 2359296
  buffer_load_dwordx4 v8, s[8:11], s42 offen nt lds
  s_add_u32 m0, s41, 36864
  s_mov_b32 s42, 2359296
  buffer_load_dwordx4 v9, s[8:11], s42 offen nt lds
  s_add_u32 m0, s41, 40960
  s_mov_b32 s42, 2424832
  buffer_load_dwordx4 v8, s[8:11], s42 offen nt lds
  s_add_u32 m0, s41, 45056
  s_mov_b32 s42, 2424832
  buffer_load_dwordx4 v9, s[8:11], s42 offen nt lds
  ds_read_b64_tr_b16 a[88:89], v6 offset:49152
  ds_read_b64_tr_b16 a[90:91], v6 offset:51200
  ds_read_b64_tr_b16 a[240:241], v6 offset:53248
  ds_read_b64_tr_b16 a[242:243], v6 offset:55296
  ds_read_b64_tr_b16 a[92:93], v6 offset:57344
  ds_read_b64_tr_b16 a[94:95], v6 offset:59392
  ds_read_b64_tr_b16 a[244:245], v6 offset:61440
  ds_read_b64_tr_b16 a[246:247], v6 offset:63488
  s_waitcnt vmcnt(24) lgkmcnt(0)
  s_barrier
  ds_read_b64_tr_b16 a[96:97], v7 offset:0
  ds_read_b64_tr_b16 a[98:99], v7 offset:2048
  ds_read_b64_tr_b16 a[248:249], v7 offset:4096
  ds_read_b64_tr_b16 a[250:251], v7 offset:6144
  ds_read_b64_tr_b16 a[100:101], v7 offset:8192
  ds_read_b64_tr_b16 a[102:103], v7 offset:10240
  ds_read_b64_tr_b16 a[252:253], v7 offset:12288
  ds_read_b64_tr_b16 a[254:255], v7 offset:14336
  s_waitcnt vmcnt(20) lgkmcnt(0)
  s_barrier
  ds_read_b64_tr_b16 a[104:105], v7 offset:16384
  ds_read_b64_tr_b16 a[106:107], v7 offset:18432
  ds_read_b64_tr_b16 v[128:129], v7 offset:20480
  ds_read_b64_tr_b16 v[130:131], v7 offset:22528
  ds_read_b64_tr_b16 a[108:109], v7 offset:24576
  ds_read_b64_tr_b16 a[110:111], v7 offset:26624
  ds_read_b64_tr_b16 v[132:133], v7 offset:28672
  ds_read_b64_tr_b16 v[134:135], v7 offset:30720
  s_waitcnt vmcnt(16) lgkmcnt(0)
  s_barrier
  ds_read_b64_tr_b16 a[112:113], v7 offset:32768
  ds_read_b64_tr_b16 a[114:115], v7 offset:34816
  ds_read_b64_tr_b16 v[136:137], v7 offset:36864
  ds_read_b64_tr_b16 v[138:139], v7 offset:38912
  ds_read_b64_tr_b16 a[116:117], v7 offset:40960
  ds_read_b64_tr_b16 a[118:119], v7 offset:43008
  ds_read_b64_tr_b16 v[140:141], v7 offset:45056
  ds_read_b64_tr_b16 v[142:143], v7 offset:47104
  s_waitcnt vmcnt(12) lgkmcnt(0)
  s_barrier
  ds_read_b64_tr_b16 a[120:121], v7 offset:49152
  ds_read_b64_tr_b16 a[122:123], v7 offset:51200
  ds_read_b64_tr_b16 v[144:145], v7 offset:53248
  ds_read_b64_tr_b16 v[146:147], v7 offset:55296
  ds_read_b64_tr_b16 a[124:125], v7 offset:57344
  ds_read_b64_tr_b16 a[126:127], v7 offset:59392
  ds_read_b64_tr_b16 v[148:149], v7 offset:61440
  ds_read_b64_tr_b16 v[150:151], v7 offset:63488
  s_waitcnt vmcnt(8) lgkmcnt(0)
  s_barrier
  ds_read_b64_tr_b16 a[128:129], v6 offset:0
  ds_read_b64_tr_b16 a[130:131], v6 offset:2048
  ds_read_b64_tr_b16 v[152:153], v6 offset:4096
  ds_read_b64_tr_b16 v[154:155], v6 offset:6144
  ds_read_b64_tr_b16 a[132:133], v6 offset:8192
  ds_read_b64_tr_b16 a[134:135], v6 offset:10240
  ds_read_b64_tr_b16 v[156:157], v6 offset:12288
  ds_read_b64_tr_b16 v[158:159], v6 offset:14336
  s_waitcnt vmcnt(4) lgkmcnt(0)
  s_barrier
  ds_read_b64_tr_b16 a[136:137], v6 offset:16384
  ds_read_b64_tr_b16 a[138:139], v6 offset:18432
  ds_read_b64_tr_b16 v[160:161], v6 offset:20480
  ds_read_b64_tr_b16 v[162:163], v6 offset:22528
  ds_read_b64_tr_b16 a[140:141], v6 offset:24576
  ds_read_b64_tr_b16 a[142:143], v6 offset:26624
  ds_read_b64_tr_b16 v[164:165], v6 offset:28672
  ds_read_b64_tr_b16 v[166:167], v6 offset:30720
  s_waitcnt vmcnt(0) lgkmcnt(0)
  s_barrier
  ds_read_b64_tr_b16 a[144:145], v6 offset:32768
  ds_read_b64_tr_b16 a[146:147], v6 offset:34816
  ds_read_b64_tr_b16 v[168:169], v6 offset:36864
  ds_read_b64_tr_b16 v[170:171], v6 offset:38912
  ds_read_b64_tr_b16 a[148:149], v6 offset:40960
  ds_read_b64_tr_b16 a[150:151], v6 offset:43008
  ds_read_b64_tr_b16 v[172:173], v6 offset:45056
  ds_read_b64_tr_b16 v[174:175], v6 offset:47104
  s_waitcnt lgkmcnt(0)
  s_barrier
  s_cmp_lt_u32 s21, 16
  s_cbranch_scc1 L_F2_keep
  v_accvgpr_write_b32 a0, 0
  v_accvgpr_write_b32 a1, 0
  v_accvgpr_write_b32 a2, 0
  v_accvgpr_write_b32 a3, 0
  v_accvgpr_write_b32 a4, 0
  v_accvgpr_write_b32 a5, 0
  v_accvgpr_write_b32 a6, 0
  v_accvgpr_write_b32 a7, 0
  v_accvgpr_write_b32 a152, 0
  v_accvgpr_write_b32 a153, 0
  v_accvgpr_write_b32 a154, 0
  v_accvgpr_write_b32 a155, 0
  v_accvgpr_write_b32 a156, 0
  v_accvgpr_write_b32 a157, 0
  v_accvgpr_write_b32 a158, 0
  v_accvgpr_write_b32 a159, 0
  s_nop 1
L_F2_keep:
  v_min_u32 v52, 63, v0
  v_lshlrev_b32 v52, 7, v52
  v_add_u32 v52, 1424384, v52
  s_nop 1
Lpoll_144:
  buffer_load_dword v53, v52, s[4:7], 0 offen sc1
  s_sub_u32 s24, s24, 1
  s_cbranch_scc1 L_FAIL
  s_waitcnt vmcnt(0)
  v_cmp_gt_i32 vcc, 0, v53
  s_cbranch_vccz Lpolld_145
  s_sleep 1
  s_branch Lpoll_144
Lpolld_145:
  v_lshrrev_b32 v53, 8, v53
  v_and_b32 v54, 3, v0
  v_lshl_or_b32 v53, v53, 2, v54
  s_nop 1
  v_min_u32_dpp v53, v53, v53 row_ror:8 row_mask:0xf bank_mask:0xf
  s_nop 1
  v_min_u32_dpp v53, v53, v53 row_ror:4 row_mask:0xf bank_mask:0xf
  v_mov_b32 v54, v53
  s_nop 1
  v_permlane16_swap_b32 v54, v53
  v_min_u32 v53, v53, v54
  v_mov_b32 v54, v53
  s_nop 1
  v_permlane32_swap_b32 v54, v53
  v_min_u32 v53, v53, v54
  s_nop 1
  v_min_u32_dpp v53, v53, v53 row_ror:2 row_mask:0xf bank_mask:0xf
  s_nop 1
  v_min_u32_dpp v53, v53, v53 row_ror:1 row_mask:0xf bank_mask:0xf
  s_nop 0
  v_readfirstlane_b32 s38, v53
  s_and_b32 s38, s38, 3
  s_lshl_b32 s38, s38, 13
  s_and_b32 s38, s38, 0x2000
  s_xor_b32 s38, s38, 20979712
  s_lshr_b32 s43, s21, 3
  s_mul_i32 s43, s43, 19
  s_min_u32 s43, s43, 37
  v_min_u32 v2, 18, v0
  v_add_u32 v2, s43, v2
  v_lshlrev_b32 v2, 7, v2
  v_add_u32 v2, 1414144, v2
  s_add_u32 s44, s43, s20
  s_min_u32 s45, s20, 2
  s_add_u32 s45, s45, s43
  s_lshr_b32 s40, s44, 1
  s_lshl_b32 s40, s40, 14
  s_and_b32 s41, s44, 1
  s_lshl_b32 s41, s41, 12
  s_add_u32 s27, s40, s41
  s_lshr_b32 s40, s45, 1
  s_lshl_b32 s40, s40, 14
  s_and_b32 s41, s45, 1
  s_lshl_b32 s41, s41, 12
  s_add_u32 s39, s40, s41
  s_sub_u32 s39, s39, s27
  s_add_u32 s27, s27, s38
  s_add_u32 s27, s27, 1179648
  s_lshl_b32 s62, s21, 7
  s_add_u32 s62, s62, 1421312
  s_lshl_b32 s40, s21, 14
  s_add_u32 s40, s40, s38
  s_add_u32 s31, s40, 524288
  s_lshl_b32 s40, s20, 11
  v_and_b32 v68, 3, v0
  v_lshlrev_b32 v68, 4, v68
  v_lshrrev_b32 v52, 4, v0
  v_lshl_add_u32 v68, v52, 6, v68
  v_bfe_u32 v52, v0, 2, 2
  v_lshl_add_u32 v68, v52, 8, v68
  v_add_u32 v68, s40, v68
  v_lshlrev_b32 v71, 2, v0
  v_add_u32 v71, 155648, v71
  s_mov_b32 s25, 0
  s_mov_b32 s26, 0
  s_mov_b32 s29, 1
  s_mov_b32 s30, 0
  s_mov_b32 s28, 0
L_F2_top:
  s_cmp_eq_u32 s28, 1
  s_cbranch_scc1 L_F2_go
  s_cmp_eq_u32 s28, 2
  s_cbranch_scc1 L_F2_mid
  s_cmp_lg_u32 s20, 0
  s_cbranch_scc1 L_F2_park
  buffer_load_dword v3, v2, s[4:7], s30 offen sc1
  s_waitcnt vmcnt(1)
  s_barrier
  s_mov_b32 s63, s25
  s_atomic_smax s63, s[4:5], s62 glc
Lnosig_146:
  s_cmp_ge_u32 s25, 64
  s_cbranch_scc1 L_END
  s_waitcnt vmcnt(0)
  v_cmp_gt_i32 vcc, s29, v3
  s_cbranch_vccz L_F2_issue
  s_nop 3
Lpoll_147:
  buffer_load_dword v3, v2, s[4:7], s30 offen sc1
  s_sub_u32 s24, s24, 1
  s_cbranch_scc1 L_FAIL
  s_waitcnt vmcnt(0)
  v_cmp_gt_i32 vcc, s29, v3
  s_cbranch_vccz Lpolld_148
  s_sleep 1
  s_branch Lpoll_147
Lpolld_148:
  s_branch L_F2_issue
L_F2_park:
  s_waitcnt vmcnt(0)
  s_barrier
  s_cmp_ge_u32 s25, 64
  s_cbranch_scc1 L_END
L_F2_issue:
  s_barrier
L_F2_mid:
  s_mov_b32 s34, s26
  s_mov_b32 s35, s27
  s_add_u32 s36, s32, 0
  s_add_u32 m0, s34, s36
  s_add_u32 s36, s35, 0
  buffer_load_dwordx4 v1, s[4:7], s36 offen offset:0 sc1 lds
  s_nop 0
  buffer_load_dwordx4 v1, s[4:7], s36 offen offset:1024 sc1 lds
  s_nop 0
  buffer_load_dwordx4 v1, s[4:7], s36 offen offset:2048 sc1 lds
  s_nop 0
  buffer_load_dwordx4 v1, s[4:7], s36 offen offset:3072 sc1 lds
  s_nop 0
  s_add_u32 s36, s32, 16384
  s_add_u32 m0, s34, s36
  s_add_u32 s36, s35, 32768
  buffer_load_dwordx4 v1, s[4:7], s36 offen offset:0 sc1 lds
  s_nop 0
  buffer_load_dwordx4 v1, s[4:7], s36 offen offset:1024 sc1 lds
  s_nop 0
  buffer_load_dwordx4 v1, s[4:7], s36 offen offset:2048 sc1 lds
  s_nop 0
  buffer_load_dwordx4 v1, s[4:7], s36 offen offset:3072 sc1 lds
  s_nop 0
  s_add_u32 s36, s32, 32768
  s_add_u32 m0, s34, s36
  s_add_u32 s36, s35, 65536
  buffer_load_dwordx4 v1, s[4:7], s36 offen offset:0 sc1 lds
  s_nop 0
  buffer_load_dwordx4 v1, s[4:7], s36 offen offset:1024 sc1 lds
  s_nop 0
  buffer_load_dwordx4 v1, s[4:7], s36 offen offset:2048 sc1 lds
  s_nop 0
  buffer_load_dwordx4 v1, s[4:7], s36 offen offset:3072 sc1 lds
  s_nop 0
  s_cmp_eq_u32 s28, 0
  s_cbranch_scc1 L_F2_go
  s_mov_b32 s28, 0
  s_waitcnt vmcnt(12)
  s_barrier
  s_cmp_lg_u32 s20, 0
  s_cbranch_scc1 Lnosig_149
  s_mov_b32 s63, s25
  s_atomic_smax s63, s[4:5], s62 glc
Lnosig_149:
L_F2_go:
  v_add_u32 v73, s26, v69
  v_add_u32 v74, s26, v70
  s_sub_u32 s26, 77824, s26
  s_add_u32 s27, s27, 2097152
  s_xor_b32 s27, s27, 0x2000
  s_add_u32 s29, s29, 1
  s_waitcnt vmcnt(8)
  s_barrier
  ds_read_b128 v[4:7], v73 offset:0
  ds_read_b128 v[8:11], v73 offset:1024
  ds_read_b128 v[12:15], v73 offset:2048
  ds_read_b128 v[16:19], v73 offset:3072
  ds_read_b128 v[20:23], v73 offset:4096
  ds_read_b128 v[24:27], v73 offset:5120
  s_waitcnt lgkmcnt(4)
  v_mfma_f32_16x16x32_bf16 v[36:39], a[0:3], v[4:7], 0
  ds_read_b128 v[28:31], v73 offset:6144
  v_mfma_f32_16x16x32_bf16 v[40:43], a[0:3], v[8:11], 0
  ds_read_b128 v[32:35], v73 offset:7168
  v_mfma_f32_16x16x32_bf16 v[44:47], a[152:155], v[4:7], 0
  s_add_u32 s36, s32, 49152
  s_add_u32 m0, s34, s36
  s_add_u32 s36, s35, 98304
  buffer_load_dwordx4 v1, s[4:7], s36 offen offset:0 sc1 lds
  v_mfma_f32_16x16x32_bf16 v[48:51], a[152:155], v[8:11], 0
  buffer_load_dwordx4 v1, s[4:7], s36 offen offset:1024 sc1 lds
  s_waitcnt lgkmcnt(4)
  v_mfma_f32_16x16x32_bf16 v[36:39], a[4:7], v[12:15], v[36:39]
  ds_read_b128 v[4:7], v73 offset:8192
  v_mfma_f32_16x16x32_bf16 v[40:43], a[4:7], v[16:19], v[40:43]
  ds_read_b128 v[8:11], v73 offset:9216
  v_mfma_f32_16x16x32_bf16 v[44:47], a[156:159], v[12:15], v[44:47]
  buffer_load_dwordx4 v1, s[4:7], s36 offen offset:2048 sc1 lds
  v_mfma_f32_16x16x32_bf16 v[48:51], a[156:159], v[16:19], v[48:51]
  buffer_load_dwordx4 v1, s[4:7], s36 offen offset:3072 sc1 lds
  s_waitcnt lgkmcnt(4)
  v_mfma_f32_16x16x32_bf16 v[36:39], a[8:11], v[20:23], v[36:39]
  ds_read_b128 v[12:15], v73 offset:10240
  v_mfma_f32_16x16x32_bf16 v[40:43], a[8:11], v[24:27], v[40:43]
  ds_read_b128 v[16:19], v73 offset:11264
  v_mfma_f32_16x16x32_bf16 v[44:47], a[160:163], v[20:23], v[44:47]
  s_add_u32 s36, s33, 65536
  s_add_u32 m0, s34, s36
  s_add_u32 s36, s35, 131072
  s_add_u32 s36, s36, s39
  buffer_load_dwordx4 v1, s[4:7], s36 offen offset:0 sc1 lds
  v_mfma_f32_16x16x32_bf16 v[48:51], a[160:163], v[24:27], v[48:51]
  buffer_load_dwordx4 v1, s[4:7], s36 offen offset:1024 sc1 lds
  s_waitcnt lgkmcnt(4)
  v_mfma_f32_16x16x32_bf16 v[36:39], a[12:15], v[28:31], v[36:39]
  ds_read_b128 v[20:23], v73 offset:12288
  v_mfma_f32_16x16x32_bf16 v[40:43], a[12:15], v[32:35], v[40:43]
  ds_read_b128 v[24:27], v73 offset:13312
  v_mfma_f32_16x16x32_bf16 v[44:47], a[164:167], v[28:31], v[44:47]
  buffer_load_dwordx4 v1, s[4:7], s36 offen offset:2048 sc1 lds
  v_mfma_f32_16x16x32_bf16 v[48:51], a[164:167], v[32:35], v[48:51]
  buffer_load_dwordx4 v1, s[4:7], s36 offen offset:3072 sc1 lds
  s_waitcnt lgkmcnt(4)
  v_mfma_f32_16x16x32_bf16 v[36:39], a[16:19], v[4:7], v[36:39]
  ds_read_b128 v[28:31], v73 offset:14336
  v_mfma_f32_16x16x32_bf16 v[40:43], a[16:19], v[8:11], v[40:43]
  ds_read_b128 v[32:35], v73 offset:15360
  v_mfma_f32_16x16x32_bf16 v[44:47], a[168:171], v[4:7], v[44:47]
  v_mfma_f32_16x16x32_bf16 v[48:51], a[168:171], v[8:11], v[48:51]
  s_waitcnt vmcnt(12)
  s_barrier
  s_mov_b32 s34, s26
  s_mov_b32 s35, s27
  s_waitcnt lgkmcnt(4)
  v_mfma_f32_16x16x32_bf16 v[36:39], a[20:23], v[12:15], v[36:39]
  ds_read_b128 v[4:7], v73 offset:16384
  v_mfma_f32_16x16x32_bf16 v[40:43], a[20:23], v[16:19], v[40:43]
  ds_read_b128 v[8:11], v73 offset:17408
  v_mfma_f32_16x16x32_bf16 v[44:47], a[172:175], v[12:15], v[44:47]
  v_mfma_f32_16x16x32_bf16 v[48:51], a[172:175], v[16:19], v[48:51]
  s_waitcnt lgkmcnt(4)
  v_mfma_f32_16x16x32_bf16 v[36:39], a[24:27], v[20:23], v[36:39]
  ds_read_b128 v[12:15], v73 offset:18432
  v_mfma_f32_16x16x32_bf16 v[40:43], a[24:27], v[24:27], v[40:43]
  ds_read_b128 v[16:19], v73 offset:19456
  v_mfma_f32_16x16x32_bf16 v[44:47], a[176:179], v[20:23], v[44:47]
  v_mfma_f32_16x16x32_bf16 v[48:51], a[176:179], v[24:27], v[48:51]
  s_waitcnt lgkmcnt(4)
  v_mfma_f32_16x16x32_bf16 v[36:39], a[28:31], v[28:31], v[36:39]
  ds_read_b128 v[20:23], v73 offset:20480
  v_mfma_f32_16x16x32_bf16 v[40:43], a[28:31], v[32:35], v[40:43]
  ds_read_b128 v[24:27], v73 offset:21504
  v_mfma_f32_16x16x32_bf16 v[44:47], a[180:183], v[28:31], v[44:47]
  v_mfma_f32_16x16x32_bf16 v[48:51], a[180:183], v[32:35], v[48:51]
  s_waitcnt lgkmcnt(4)
  v_mfma_f32_16x16x32_bf16 v[36:39], a[32:35], v[4:7], v[36:39]
  ds_read_b128 v[28:31], v73 offset:22528
  v_mfma_f32_16x16x32_bf16 v[40:43], a[32:35], v[8:11], v[40:43]
  ds_read_b128 v[32:35], v73 offset:23552
  v_mfma_f32_16x16x32_bf16 v[44:47], a[184:187], v[4:7], v[44:47]
  v_mfma_f32_16x16x32_bf16 v[48:51], a[184:187], v[8:11], v[48:51]
  s_waitcnt lgkmcnt(4)
  v_mfma_f32_16x16x32_bf16 v[36:39], a[36:39], v[12:15], v[36:39]
  ds_read_b128 v[4:7], v73 offset:24576
  v_mfma_f32_16x16x32_bf16 v[40:43], a[36:39], v[16:19], v[40:43]
  ds_read_b128 v[8:11], v73 offset:25600
  v_mfma_f32_16x16x32_bf16 v[44:47], a[188:191], v[12:15], v[44:47]
  v_mfma_f32_16x16x32_bf16 v[48:51], a[188:191], v[16:19], v[48:51]
  s_waitcnt lgkmcnt(4)
  v_mfma_f32_16x16x32_bf16 v[36:39], a[40:43], v[20:23], v[36:39]
  ds_read_b128 v[12:15], v73 offset:26624
  v_mfma_f32_16x16x32_bf16 v[40:43], a[40:43], v[24:27], v[40:43]
  ds_read_b128 v[16:19], v73 offset:27648
  v_mfma_f32_16x16x32_bf16 v[44:47], a[192:195], v[20:23], v[44:47]
  v_mfma_f32_16x16x32_bf16 v[48:51], a[192:195], v[24:27], v[48:51]
  s_waitcnt lgkmcnt(4)
  v_mfma_f32_16x16x32_bf16 v[36:39], a[44:47], v[28:31], v[36:39]
  ds_read_b128 v[20:23], v73 offset:28672
  v_mfma_f32_16x16x32_bf16 v[40:43], a[44:47], v[32:35], v[40:43]
  ds_read_b128 v[24:27], v73 offset:29696
  v_mfma_f32_16x16x32_bf16 v[44:47], a[196:199], v[28:31], v[44:47]
  v_mfma_f32_16x16x32_bf16 v[48:51], a[196:199], v[32:35], v[48:51]
  s_lshl_b32 s40, s20, 8
  s_add_u32 m0, s40, 155648
  s_cmp_eq_u32 s20, 0
  s_cselect_b32 s40, s30, 2147483392
  buffer_load_dword v2, s[4:7], s40 offen sc1 lds
  s_waitcnt lgkmcnt(4)
  v_mfma_f32_16x16x32_bf16 v[36:39], a[48:51], v[4:7], v[36:39]
  ds_read_b128 v[28:31], v73 offset:30720
  v_mfma_f32_16x16x32_bf16 v[40:43], a[48:51], v[8:11], v[40:43]
  ds_read_b128 v[32:35], v73 offset:31744
  v_mfma_f32_16x16x32_bf16 v[44:47], a[200:203], v[4:7], v[44:47]
  v_mfma_f32_16x16x32_bf16 v[48:51], a[200:203], v[8:11], v[48:51]
  s_waitcnt vmcnt(9)
  s_barrier
  s_lshl_b32 s40, s20, 1
  s_add_u32 s40, s40, 1
  s_cmp_lg_u32 s40, s28
  s_cbranch_scc1 L_F2_s2
  s_mov_b32 s63, s25
  s_atomic_smax s63, s[4:5], s62 glc
Lnosig_150:
L_F2_s2:
  s_waitcnt lgkmcnt(4)
  v_mfma_f32_16x16x32_bf16 v[36:39], a[52:55], v[12:15], v[36:39]
  ds_read_b128 v[4:7], v73 offset:32768
  v_mfma_f32_16x16x32_bf16 v[40:43], a[52:55], v[16:19], v[40:43]
  ds_read_b128 v[8:11], v73 offset:33792
  v_mfma_f32_16x16x32_bf16 v[44:47], a[204:207], v[12:15], v[44:47]
  v_mfma_f32_16x16x32_bf16 v[48:51], a[204:207], v[16:19], v[48:51]
  s_waitcnt lgkmcnt(4)
  v_mfma_f32_16x16x32_bf16 v[36:39], a[56:59], v[20:23], v[36:39]
  ds_read_b128 v[12:15], v73 offset:34816
  v_mfma_f32_16x16x32_bf16 v[40:43], a[56:59], v[24:27], v[40:43]
  ds_read_b128 v[16:19], v73 offset:35840
  v_mfma_f32_16x16x32_bf16 v[44:47], a[208:211], v[20:23], v[44:47]
  v_mfma_f32_16x16x32_bf16 v[48:51], a[208:211], v[24:27], v[48:51]
  s_waitcnt lgkmcnt(4)
  v_mfma_f32_16x16x32_bf16 v[36:39], a[60:63], v[28:31], v[36:39]
  ds_read_b128 v[20:23], v73 offset:36864
  v_mfma_f32_16x16x32_bf16 v[40:43], a[60:63], v[32:35], v[40:43]
  ds_read_b128 v[24:27], v73 offset:37888
  v_mfma_f32_16x16x32_bf16 v[44:47], a[212:215], v[28:31], v[44:47]
  v_mfma_f32_16x16x32_bf16 v[48:51], a[212:215], v[32:35], v[48:51]
  s_waitcnt lgkmcnt(4)
  v_mfma_f32_16x16x32_bf16 v[36:39], a[64:67], v[4:7], v[36:39]
  ds_read_b128 v[28:31], v73 offset:38912
  v_mfma_f32_16x16x32_bf16 v[40:43], a[64:67], v[8:11], v[40:43]
  ds_read_b128 v[32:35], v73 offset:39936
  v_mfma_f32_16x16x32_bf16 v[44:47], a[216:219], v[4:7], v[44:47]
  v_mfma_f32_16x16x32_bf16 v[48:51], a[216:219], v[8:11], v[48:51]
  s_waitcnt lgkmcnt(4)
  v_mfma_f32_16x16x32_bf16 v[36:39], a[68:71], v[12:15], v[36:39]
  ds_read_b128 v[4:7], v73 offset:40960
  v_mfma_f32_16x16x32_bf16 v[40:43], a[68:71], v[16:19], v[40:43]
  ds_read_b128 v[8:11], v73 offset:41984
  v_mfma_f32_16x16x32_bf16 v[44:47], a[220:223], v[12:15], v[44:47]
  v_mfma_f32_16x16x32_bf16 v[48:51], a[220:223], v[16:19], v[48:51]
  s_waitcnt lgkmcnt(4)
  v_mfma_f32_16x16x32_bf16 v[36:39], a[72:75], v[20:23], v[36:39]
  ds_read_b128 v[12:15], v73 offset:43008
  v_mfma_f32_16x16x32_bf16 v[40:43], a[72:75], v[24:27], v[40:43]
  ds_read_b128 v[16:19], v73 offset:44032
  v_mfma_f32_16x16x32_bf16 v[44:47], a[224:227], v[20:23], v[44:47]
  v_mfma_f32_16x16x32_bf16 v[48:51], a[224:227], v[24:27], v[48:51]
  s_waitcnt vmcnt(0)
  s_barrier
  ds_read_b32 v3, v71
  s_waitcnt lgkmcnt(4)
  v_mfma_f32_16x16x32_bf16 v[36:39], a[76:79], v[28:31], v[36:39]
  ds_read_b128 v[20:23], v73 offset:45056
  v_mfma_f32_16x16x32_bf16 v[40:43], a[76:79], v[32:35], v[40:43]
  ds_read_b128 v[24:27], v73 offset:46080
  v_mfma_f32_16x16x32_bf16 v[44:47], a[228:231], v[28:31], v[44:47]
  v_mfma_f32_16x16x32_bf16 v[48:51], a[228:231], v[32:35], v[48:51]
  s_waitcnt lgkmcnt(4)
  v_mfma_f32_16x16x32_bf16 v[36:39], a[80:83], v[4:7], v[36:39]
  ds_read_b128 v[28:31], v73 offset:47104
  v_mfma_f32_16x16x32_bf16 v[40:43], a[80:83], v[8:11], v[40:43]
  ds_read_b128 v[32:35], v73 offset:48128
  v_mfma_f32_16x16x32_bf16 v[44:47], a[232:235], v[4:7], v[44:47]
  v_mfma_f32_16x16x32_bf16 v[48:51], a[232:235], v[8:11], v[48:51]
  s_waitcnt lgkmcnt(4)
  v_cmp_gt_i32 vcc, s29, v3
  s_mov_b32 s28, 0
  s_cbranch_vccnz L_F2_nopf
  s_cmp_ge_u32 s25, 63
  s_cbranch_scc1 L_F2_nopf
  s_mov_b32 s28, 1
  s_waitcnt lgkmcnt(4)
  v_mfma_f32_16x16x32_bf16 v[36:39], a[84:87], v[12:15], v[36:39]
  ds_read_b128 v[4:7], v73 offset:49152
  v_mfma_f32_16x16x32_bf16 v[40:43], a[84:87], v[16:19], v[40:43]
  ds_read_b128 v[8:11], v73 offset:50176
  v_mfma_f32_16x16x32_bf16 v[44:47], a[236:239], v[12:15], v[44:47]
  s_add_u32 s36, s32, 0
  s_add_u32 m0, s34, s36
  s_add_u32 s36, s35, 0
  buffer_load_dwordx4 v1, s[4:7], s36 offen offset:0 sc1 lds
  v_mfma_f32_16x16x32_bf16 v[48:51], a[236:239], v[16:19], v[48:51]
  s_waitcnt lgkmcnt(4)
  v_mfma_f32_16x16x32_bf16 v[36:39], a[88:91], v[20:23], v[36:39]
  ds_read_b128 v[12:15], v73 offset:51200
  v_mfma_f32_16x16x32_bf16 v[40:43], a[88:91], v[24:27], v[40:43]
  ds_read_b128 v[16:19], v73 offset:52224
  v_mfma_f32_16x16x32_bf16 v[44:47], a[240:243], v[20:23], v[44:47]
  buffer_load_dwordx4 v1, s[4:7], s36 offen offset:1024 sc1 lds
  v_mfma_f32_16x16x32_bf16 v[48:51], a[240:243], v[24:27], v[48:51]
  s_waitcnt lgkmcnt(4)
  v_mfma_f32_16x16x32_bf16 v[36:39], a[92:95], v[28:31], v[36:39]
  ds_read_b128 v[20:23], v73 offset:53248
  v_mfma_f32_16x16x32_bf16 v[40:43], a[92:95], v[32:35], v[40:43]
  ds_read_b128 v[24:27], v73 offset:54272
  v_mfma_f32_16x16x32_bf16 v[44:47], a[244:247], v[28:31], v[44:47]
  buffer_load_dwordx4 v1, s[4:7], s36 offen offset:2048 sc1 lds
  v_mfma_f32_16x16x32_bf16 v[48:51], a[244:247], v[32:35], v[48:51]
  s_waitcnt lgkmcnt(4)
  v_mfma_f32_16x16x32_bf16 v[36:39], a[96:99], v[4:7], v[36:39]
  ds_read_b128 v[28:31], v73 offset:55296
  v_mfma_f32_16x16x32_bf16 v[40:43], a[96:99], v[8:11], v[40:43]
  ds_read_b128 v[32:35], v73 offset:56320
  v_mfma_f32_16x16x32_bf16 v[44:47], a[248:251], v[4:7], v[44:47]
  buffer_load_dwordx4 v1, s[4:7], s36 offen offset:3072 sc1 lds
  v_mfma_f32_16x16x32_bf16 v[48:51], a[248:251], v[8:11], v[48:51]
  s_waitcnt lgkmcnt(4)
  v_mfma_f32_16x16x32_bf16 v[36:39], a[100:103], v[12:15], v[36:39]
  ds_read_b128 v[4:7], v73 offset:57344
  v_mfma_f32_16x16x32_bf16 v[40:43], a[100:103], v[16:19], v[40:43]
  ds_read_b128 v[8:11], v73 offset:58368
  v_mfma_f32_16x16x32_bf16 v[44:47], a[252:255], v[12:15], v[44:47]
  s_add_u32 s36, s32, 16384
  s_add_u32 m0, s34, s36
  s_add_u32 s36, s35, 32768
  buffer_load_dwordx4 v1, s[4:7], s36 offen offset:0 sc1 lds
  v_mfma_f32_16x16x32_bf16 v[48:51], a[252:255], v[16:19], v[48:51]
  s_waitcnt lgkmcnt(4)
  v_mfma_f32_16x16x32_bf16 v[36:39], a[104:107], v[20:23], v[36:39]
  ds_read_b128 v[12:15], v73 offset:59392
  v_mfma_f32_16x16x32_bf16 v[40:43], a[104:107], v[24:27], v[40:43]
  ds_read_b128 v[16:19], v73 offset:60416
  v_mfma_f32_16x16x32_bf16 v[44:47], v[128:131], v[20:23], v[44:47]
  buffer_load_dwordx4 v1, s[4:7], s36 offen offset:1024 sc1 lds
  v_mfma_f32_16x16x32_bf16 v[48:51], v[128:131], v[24:27], v[48:51]
  s_waitcnt lgkmcnt(4)
  v_mfma_f32_16x16x32_bf16 v[36:39], a[108:111], v[28:31], v[36:39]
  ds_read_b128 v[20:23], v73 offset:61440
  v_mfma_f32_16x16x32_bf16 v[40:43], a[108:111], v[32:35], v[40:43]
  ds_read_b128 v[24:27], v73 offset:62464
  v_mfma_f32_16x16x32_bf16 v[44:47], v[132:135], v[28:31], v[44:47]
  buffer_load_dwordx4 v1, s[4:7], s36 offen offset:2048 sc1 lds
  v_mfma_f32_16x16x32_bf16 v[48:51], v[132:135], v[32:35], v[48:51]
  s_waitcnt lgkmcnt(4)
  v_mfma_f32_16x16x32_bf16 v[36:39], a[112:115], v[4:7], v[36:39]
  ds_read_b128 v[28:31], v73 offset:63488
  v_mfma_f32_16x16x32_bf16 v[40:43], a[112:115], v[8:11], v[40:43]
  ds_read_b128 v[32:35], v73 offset:64512
  v_mfma_f32_16x16x32_bf16 v[44:47], v[136:139], v[4:7], v[44:47]
  buffer_load_dwordx4 v1, s[4:7], s36 offen offset:3072 sc1 lds
  v_mfma_f32_16x16x32_bf16 v[48:51], v[136:139], v[8:11], v[48:51]
  s_waitcnt lgkmcnt(4)
  v_mfma_f32_16x16x32_bf16 v[36:39], a[116:119], v[12:15], v[36:39]
  ds_read_b128 v[4:7], v74 offset:0
  v_mfma_f32_16x16x32_bf16 v[40:43], a[116:119], v[16:19], v[40:43]
  ds_read_b128 v[8:11], v74 offset:1024
  v_mfma_f32_16x16x32_bf16 v[44:47], v[140:143], v[12:15], v[44:47]
  s_add_u32 s36, s32, 32768
  s_add_u32 m0, s34, s36
  s_add_u32 s36, s35, 65536
  buffer_load_dwordx4 v1, s[4:7], s36 offen offset:0 sc1 lds
  v_mfma_f32_16x16x32_bf16 v[48:51], v[140:143], v[16:19], v[48:51]
  s_waitcnt lgkmcnt(4)
  v_mfma_f32_16x16x32_bf16 v[36:39], a[120:123], v[20:23], v[36:39]
  ds_read_b128 v[12:15], v74 offset:2048
  v_mfma_f32_16x16x32_bf16 v[40:43], a[120:123], v[24:27], v[40:43]
  ds_read_b128 v[16:19], v74 offset:3072
  v_mfma_f32_16x16x32_bf16 v[44:47], v[144:147], v[20:23], v[44:47]
  buffer_load_dwordx4 v1, s[4:7], s36 offen offset:1024 sc1 lds
  v_mfma_f32_16x16x32_bf16 v[48:51], v[144:147], v[24:27], v[48:51]
  s_waitcnt lgkmcnt(4)
  v_mfma_f32_16x16x32_bf16 v[36:39], a[124:127], v[28:31], v[36:39]
  ds_read_b128 v[20:23], v74 offset:4096
  v_mfma_f32_16x16x32_bf16 v[40:43], a[124:127], v[32:35], v[40:43]
  ds_read_b128 v[24:27], v74 offset:5120
  v_mfma_f32_16x16x32_bf16 v[44:47], v[148:151], v[28:31], v[44:47]
  buffer_load_dwordx4 v1, s[4:7], s36 offen offset:2048 sc1 lds
  v_mfma_f32_16x16x32_bf16 v[48:51], v[148:151], v[32:35], v[48:51]
  s_waitcnt lgkmcnt(4)
  v_mfma_f32_16x16x32_bf16 v[36:39], a[128:131], v[4:7], v[36:39]
  ds_read_b128 v[28:31], v74 offset:6144
  v_mfma_f32_16x16x32_bf16 v[40:43], a[128:131], v[8:11], v[40:43]
  ds_read_b128 v[32:35], v74 offset:7168
  v_mfma_f32_16x16x32_bf16 v[44:47], v[152:155], v[4:7], v[44:47]
  buffer_load_dwordx4 v1, s[4:7], s36 offen offset:3072 sc1 lds
  v_mfma_f32_16x16x32_bf16 v[48:51], v[152:155], v[8:11], v[48:51]
  s_waitcnt lgkmcnt(4)
  v_mfma_f32_16x16x32_bf16 v[36:39], a[132:135], v[12:15], v[36:39]
  ds_read_b128 v[4:7], v74 offset:8192
  v_mfma_f32_16x16x32_bf16 v[40:43], a[132:135], v[16:19], v[40:43]
  ds_read_b128 v[8:11], v74 offset:9216
  v_mfma_f32_16x16x32_bf16 v[44:47], v[156:159], v[12:15], v[44:47]
  v_mfma_f32_16x16x32_bf16 v[48:51], v[156:159], v[16:19], v[48:51]
  s_waitcnt lgkmcnt(4)
  v_mfma_f32_16x16x32_bf16 v[36:39], a[136:139], v[20:23], v[36:39]
  ds_read_b128 v[12:15], v74 offset:10240
  v_mfma_f32_16x16x32_bf16 v[40:43], a[136:139], v[24:27], v[40:43]
  ds_read_b128 v[16:19], v74 offset:11264
  v_mfma_f32_16x16x32_bf16 v[44:47], v[160:163], v[20:23], v[44:47]
  v_mfma_f32_16x16x32_bf16 v[48:51], v[160:163], v[24:27], v[48:51]
  s_waitcnt lgkmcnt(4)
  v_mfma_f32_16x16x32_bf16 v[36:39], a[140:143], v[28:31], v[36:39]
  v_mfma_f32_16x16x32_bf16 v[40:43], a[140:143], v[32:35], v[40:43]
  v_mfma_f32_16x16x32_bf16 v[44:47], v[164:167], v[28:31], v[44:47]
  v_mfma_f32_16x16x32_bf16 v[48:51], v[164:167], v[32:35], v[48:51]
  s_waitcnt lgkmcnt(2)
  v_mfma_f32_16x16x32_bf16 v[36:39], a[144:147], v[4:7], v[36:39]
  v_mfma_f32_16x16x32_bf16 v[40:43], a[144:147], v[8:11], v[40:43]
  v_mfma_f32_16x16x32_bf16 v[44:47], v[168:171], v[4:7], v[44:47]
  v_mfma_f32_16x16x32_bf16 v[48:51], v[168:171], v[8:11], v[48:51]
  s_waitcnt lgkmcnt(0)
  v_mfma_f32_16x16x32_bf16 v[36:39], a[148:151], v[12:15], v[36:39]
  v_mfma_f32_16x16x32_bf16 v[40:43], a[148:151], v[16:19], v[40:43]
  v_mfma_f32_16x16x32_bf16 v[44:47], v[172:175], v[12:15], v[44:47]
  v_mfma_f32_16x16x32_bf16 v[48:51], v[172:175], v[16:19], v[48:51]
  s_nop 7
  s_branch L_F2_epi
L_F2_nopf:
  s_waitcnt lgkmcnt(4)
  v_mfma_f32_16x16x32_bf16 v[36:39], a[84:87], v[12:15], v[36:39]
  ds_read_b128 v[4:7], v73 offset:49152
  v_mfma_f32_16x16x32_bf16 v[40:43], a[84:87], v[16:19], v[40:43]
  ds_read_b128 v[8:11], v73 offset:50176
  v_mfma_f32_16x16x32_bf16 v[44:47], a[236:239], v[12:15], v[44:47]
  v_mfma_f32_16x16x32_bf16 v[48:51], a[236:239], v[16:19], v[48:51]
  s_waitcnt lgkmcnt(4)
  v_mfma_f32_16x16x32_bf16 v[36:39], a[88:91], v[20:23], v[36:39]
  ds_read_b128 v[12:15], v73 offset:51200
  v_mfma_f32_16x16x32_bf16 v[40:43], a[88:91], v[24:27], v[40:43]
  ds_read_b128 v[16:19], v73 offset:52224
  v_mfma_f32_16x16x32_bf16 v[44:47], a[240:243], v[20:23], v[44:47]
  v_mfma_f32_16x16x32_bf16 v[48:51], a[240:243], v[24:27], v[48:51]
  s_waitcnt lgkmcnt(4)
  v_mfma_f32_16x16x32_bf16 v[36:39], a[92:95], v[28:31], v[36:39]
  ds_read_b128 v[20:23], v73 offset:53248
  v_mfma_f32_16x16x32_bf16 v[40:43], a[92:95], v[32:35], v[40:43]
  ds_read_b128 v[24:27], v73 offset:54272
  v_mfma_f32_16x16x32_bf16 v[44:47], a[244:247], v[28:31], v[44:47]
  v_mfma_f32_16x16x32_bf16 v[48:51], a[244:247], v[32:35], v[48:51]
  s_waitcnt lgkmcnt(4)
  v_mfma_f32_16x16x32_bf16 v[36:39], a[96:99], v[4:7], v[36:39]
  ds_read_b128 v[28:31], v73 offset:55296
  v_mfma_f32_16x16x32_bf16 v[40:43], a[96:99], v[8:11], v[40:43]
  ds_read_b128 v[32:35], v73 offset:56320
  v_mfma_f32_16x16x32_bf16 v[44:47], a[248:251], v[4:7], v[44:47]
  v_mfma_f32_16x16x32_bf16 v[48:51], a[248:251], v[8:11], v[48:51]
  s_waitcnt lgkmcnt(4)
  v_mfma_f32_16x16x32_bf16 v[36:39], a[100:103], v[12:15], v[36:39]
  ds_read_b128 v[4:7], v73 offset:57344
  v_mfma_f32_16x16x32_bf16 v[40:43], a[100:103], v[16:19], v[40:43]
  ds_read_b128 v[8:11], v73 offset:58368
  v_mfma_f32_16x16x32_bf16 v[44:47], a[252:255], v[12:15], v[44:47]
  v_mfma_f32_16x16x32_bf16 v[48:51], a[252:255], v[16:19], v[48:51]
  s_waitcnt lgkmcnt(4)
  v_mfma_f32_16x16x32_bf16 v[36:39], a[104:107], v[20:23], v[36:39]
  ds_read_b128 v[12:15], v73 offset:59392
  v_mfma_f32_16x16x32_bf16 v[40:43], a[104:107], v[24:27], v[40:43]
  ds_read_b128 v[16:19], v73 offset:60416
  v_mfma_f32_16x16x32_bf16 v[44:47], v[128:131], v[20:23], v[44:47]
  v_mfma_f32_16x16x32_bf16 v[48:51], v[128:131], v[24:27], v[48:51]
  s_waitcnt lgkmcnt(4)
  v_mfma_f32_16x16x32_bf16 v[36:39], a[108:111], v[28:31], v[36:39]
  ds_read_b128 v[20:23], v73 offset:61440
  v_mfma_f32_16x16x32_bf16 v[40:43], a[108:111], v[32:35], v[40:43]
  ds_read_b128 v[24:27], v73 offset:62464
  v_mfma_f32_16x16x32_bf16 v[44:47], v[132:135], v[28:31], v[44:47]
  v_mfma_f32_16x16x32_bf16 v[48:51], v[132:135], v[32:35], v[48:51]
  s_waitcnt lgkmcnt(4)
  v_mfma_f32_16x16x32_bf16 v[36:39], a[112:115], v[4:7], v[36:39]
  ds_read_b128 v[28:31], v73 offset:63488
  v_mfma_f32_16x16x32_bf16 v[40:43], a[112:115], v[8:11], v[40:43]
  ds_read_b128 v[32:35], v73 offset:64512
  v_mfma_f32_16x16x32_bf16 v[44:47], v[136:139], v[4:7], v[44:47]
  v_mfma_f32_16x16x32_bf16 v[48:51], v[136:139], v[8:11], v[48:51]
  s_waitcnt lgkmcnt(4)
  v_mfma_f32_16x16x32_bf16 v[36:39], a[116:119], v[12:15], v[36:39]
  ds_read_b128 v[4:7], v74 offset:0
  v_mfma_f32_16x16x32_bf16 v[40:43], a[116:119], v[16:19], v[40:43]
  ds_read_b128 v[8:11], v74 offset:1024
  v_mfma_f32_16x16x32_bf16 v[44:47], v[140:143], v[12:15], v[44:47]
  v_mfma_f32_16x16x32_bf16 v[48:51], v[140:143], v[16:19], v[48:51]
  s_barrier
  s_lshl_b32 s40, s20, 8
  s_add_u32 m0, s40, 155648
  s_cmp_eq_u32 s20, 0
  s_cselect_b32 s40, s30, 2147483392
  buffer_load_dword v2, s[4:7], s40 offen sc1 lds
  s_waitcnt lgkmcnt(4)
  v_mfma_f32_16x16x32_bf16 v[36:39], a[120:123], v[20:23], v[36:39]
  ds_read_b128 v[12:15], v74 offset:2048
  v_mfma_f32_16x16x32_bf16 v[40:43], a[120:123], v[24:27], v[40:43]
  ds_read_b128 v[16:19], v74 offset:3072
  v_mfma_f32_16x16x32_bf16 v[44:47], v[144:147], v[20:23], v[44:47]
  v_mfma_f32_16x16x32_bf16 v[48:51], v[144:147], v[24:27], v[48:51]
  s_waitcnt lgkmcnt(4)
  v_mfma_f32_16x16x32_bf16 v[36:39], a[124:127], v[28:31], v[36:39]
  ds_read_b128 v[20:23], v74 offset:4096
  v_mfma_f32_16x16x32_bf16 v[40:43], a[124:127], v[32:35], v[40:43]
  ds_read_b128 v[24:27], v74 offset:5120
  v_mfma_f32_16x16x32_bf16 v[44:47], v[148:151], v[28:31], v[44:47]
  v_mfma_f32_16x16x32_bf16 v[48:51], v[148:151], v[32:35], v[48:51]
  s_waitcnt lgkmcnt(4)
  v_mfma_f32_16x16x32_bf16 v[36:39], a[128:131], v[4:7], v[36:39]
  ds_read_b128 v[28:31], v74 offset:6144
  v_mfma_f32_16x16x32_bf16 v[40:43], a[128:131], v[8:11], v[40:43]
  ds_read_b128 v[32:35], v74 offset:7168
  v_mfma_f32_16x16x32_bf16 v[44:47], v[152:155], v[4:7], v[44:47]
  v_mfma_f32_16x16x32_bf16 v[48:51], v[152:155], v[8:11], v[48:51]
  s_waitcnt lgkmcnt(4)
  v_mfma_f32_16x16x32_bf16 v[36:39], a[132:135], v[12:15], v[36:39]
  ds_read_b128 v[4:7], v74 offset:8192
  v_mfma_f32_16x16x32_bf16 v[40:43], a[132:135], v[16:19], v[40:43]
  ds_read_b128 v[8:11], v74 offset:9216
  v_mfma_f32_16x16x32_bf16 v[44:47], v[156:159], v[12:15], v[44:47]
  v_mfma_f32_16x16x32_bf16 v[48:51], v[156:159], v[16:19], v[48:51]
  s_waitcnt lgkmcnt(4)
  v_mfma_f32_16x16x32_bf16 v[36:39], a[136:139], v[20:23], v[36:39]
  ds_read_b128 v[12:15], v74 offset:10240
  v_mfma_f32_16x16x32_bf16 v[40:43], a[136:139], v[24:27], v[40:43]
  ds_read_b128 v[16:19], v74 offset:11264
  v_mfma_f32_16x16x32_bf16 v[44:47], v[160:163], v[20:23], v[44:47]
  v_mfma_f32_16x16x32_bf16 v[48:51], v[160:163], v[24:27], v[48:51]
  s_waitcnt lgkmcnt(4)
  v_mfma_f32_16x16x32_bf16 v[36:39], a[140:143], v[28:31], v[36:39]
  v_mfma_f32_16x16x32_bf16 v[40:43], a[140:143], v[32:35], v[40:43]
  v_mfma_f32_16x16x32_bf16 v[44:47], v[164:167], v[28:31], v[44:47]
  v_mfma_f32_16x16x32_bf16 v[48:51], v[164:167], v[32:35], v[48:51]
  s_waitcnt vmcnt(0)
  s_barrier
  ds_read_b32 v3, v71
  s_waitcnt lgkmcnt(2)
  v_mfma_f32_16x16x32_bf16 v[36:39], a[144:147], v[4:7], v[36:39]
  v_mfma_f32_16x16x32_bf16 v[40:43], a[144:147], v[8:11], v[40:43]
  v_mfma_f32_16x16x32_bf16 v[44:47], v[168:171], v[4:7], v[44:47]
  v_mfma_f32_16x16x32_bf16 v[48:51], v[168:171], v[8:11], v[48:51]
  s_waitcnt lgkmcnt(0)
  v_mfma_f32_16x16x32_bf16 v[36:39], a[148:151], v[12:15], v[36:39]
  v_mfma_f32_16x16x32_bf16 v[40:43], a[148:151], v[16:19], v[40:43]
  v_mfma_f32_16x16x32_bf16 v[44:47], v[172:175], v[12:15], v[44:47]
  v_mfma_f32_16x16x32_bf16 v[48:51], v[172:175], v[16:19], v[48:51]
  v_cmp_gt_i32 vcc, s29, v3
  s_cmp_eq_u64 vcc, 0
  s_cselect_b32 s28, 2, 0
  s_cmp_lt_u32 s25, 63
  s_cselect_b32 s28, s28, 0
L_F2_epi:
  v_cvt_pk_bf16_f32 v52, v36, v37
  v_cvt_pk_bf16_f32 v53, v38, v39
  v_cvt_pk_bf16_f32 v54, v44, v45
  v_cvt_pk_bf16_f32 v55, v46, v47
  buffer_store_dwordx4 v[52:55], v68, s[4:7], s31 offen offset:0 sc1
  v_cvt_pk_bf16_f32 v56, v40, v41
  v_cvt_pk_bf16_f32 v57, v42, v43
  v_cvt_pk_bf16_f32 v58, v48, v49
  v_cvt_pk_bf16_f32 v59, v50, v51
  buffer_store_dwordx4 v[56:59], v68, s[4:7], s31 offen offset:1024 sc1
  s_add_u32 s25, s25, 1
  s_add_u32 s31, s31, 2097152
  s_xor_b32 s31, s31, 0x2000
  s_branch L_F2_top
L_WOF:
  s_load_dwordx2 s[8:9], s[0:1], 40
  s_mov_b32 s10, 8388608
  s_mov_b32 s11, 0x20000
  s_waitcnt lgkmcnt(0)
  v_bfe_u32 v1, v0, 5, 1
  v_mul_u32_u24 v1, 131072, v1
  v_bfe_u32 v2, v0, 4, 1
  v_mul_u32_u24 v2, 8192, v2
  v_add_u32 v1, v1, v2
  v_bfe_u32 v2, v0, 3, 1
  v_mul_u32_u24 v2, 2048, v2
  v_add_u32 v1, v1, v2
  v_lshrrev_b32 v2, 3, v0
  v_and_b32 v2, 6, v2
  v_xor_b32 v2, v2, v0
  v_and_b32 v2, 7, v2
  v_lshl_add_u32 v1, v2, 4, v1
  v_bfe_u32 v2, v0, 3, 2
  v_xor_b32 v2, 0, v2
  v_lshlrev_b32 v2, 5, v2
  v_lshrrev_b32 v4, 2, v0
  v_lshl_add_u32 v4, v4, 7, v2
  v_and_b32 v2, 3, v0
  v_lshl_add_u32 v4, v2, 3, v4
  s_and_b32 s43, s21, 3
  s_lshl_b32 s43, s43, 2
  s_add_u32 s43, s43, s20
  s_lshr_b32 s44, s21, 2
  s_lshl_b32 s40, s43, 19
  s_lshl_b32 s41, s44, 7
  s_add_u32 s40, s40, s41
  v_add_u32 v1, s40, v1
  s_lshl_b32 s41, s20, 15
  v_add_u32 v4, s41, v4
  s_lshl_b32 s40, s44, 19
  s_lshl_b32 s45, s43, 14
  s_add_u32 s40, s40, s45
  v_lshl_add_u32 v3, v0, 4, s40
  v_xor_b32 v5, 32, v4
  v_xor_b32 v6, 64, v4
  v_xor_b32 v7, 96, v4
  s_add_u32 m0, s41, 0
  s_mov_b32 s42, 0
  buffer_load_dwordx4 v1, s[8:11], s42 offen nt lds
  s_add_u32 m0, s41, 1024
  s_mov_b32 s42, 16384
  buffer_load_dwordx4 v1, s[8:11], s42 offen nt lds
  s_add_u32 m0, s41, 2048
  s_mov_b32 s42, 4096
  buffer_load_dwordx4 v1, s[8:11], s42 offen nt lds
  s_add_u32 m0, s41, 3072
  s_mov_b32 s42, 20480
  buffer_load_dwordx4 v1, s[8:11], s42 offen nt lds
  s_add_u32 m0, s41, 4096
  s_mov_b32 s42, 32768
  buffer_load_dwordx4 v1, s[8:11], s42 offen nt lds
  s_add_u32 m0, s41, 5120
  s_mov_b32 s42, 49152
  buffer_load_dwordx4 v1, s[8:11], s42 offen nt lds
  s_add_u32 m0, s41, 6144
  s_mov_b32 s42, 36864
  buffer_load_dwordx4 v1, s[8:11], s42 offen nt lds
  s_add_u32 m0, s41, 7168
  s_mov_b32 s42, 53248
  buffer_load_dwordx4 v1, s[8:11], s42 offen nt lds
  s_add_u32 m0, s41, 8192
  s_mov_b32 s42, 65536
  buffer_load_dwordx4 v1, s[8:11], s42 offen nt lds
  s_add_u32 m0, s41, 9216
  s_mov_b32 s42, 81920
  buffer_load_dwordx4 v1, s[8:11], s42 offen nt lds
  s_add_u32 m0, s41, 10240
  s_mov_b32 s42, 69632
  buffer_load_dwordx4 v1, s[8:11], s42 offen nt lds
  s_add_u32 m0, s41, 11264
  s_mov_b32 s42, 86016
  buffer_load_dwordx4 v1, s[8:11], s42 offen nt lds
  s_add_u32 m0, s41, 12288
  s_mov_b32 s42, 98304
  buffer_load_dwordx4 v1, s[8:11], s42 offen nt lds
  s_add_u32 m0, s41, 13312
  s_mov_b32 s42, 114688
  buffer_load_dwordx4 v1, s[8:11], s42 offen nt lds
  s_add_u32 m0, s41, 14336
  s_mov_b32 s42, 102400
  buffer_load_dwordx4 v1, s[8:11], s42 offen nt lds
  s_add_u32 m0, s41, 15360
  s_mov_b32 s42, 118784
  buffer_load_dwordx4 v1, s[8:11], s42 offen nt lds
  s_add_u32 m0, s41, 16384
  s_mov_b32 s42, 262144
  buffer_load_dwordx4 v1, s[8:11], s42 offen nt lds
  s_add_u32 m0, s41, 17408
  s_mov_b32 s42, 278528
  buffer_load_dwordx4 v1, s[8:11], s42 offen nt lds
  s_add_u32 m0, s41, 18432
  s_mov_b32 s42, 266240
  buffer_load_dwordx4 v1, s[8:11], s42 offen nt lds
  s_add_u32 m0, s41, 19456
  s_mov_b32 s42, 282624
  buffer_load_dwordx4 v1, s[8:11], s42 offen nt lds
  s_add_u32 m0, s41, 20480
  s_mov_b32 s42, 294912
  buffer_load_dwordx4 v1, s[8:11], s42 offen nt lds
  s_add_u32 m0, s41, 21504
  s_mov_b32 s42, 311296
  buffer_load_dwordx4 v1, s[8:11], s42 offen nt lds
  s_add_u32 m0, s41, 22528
  s_mov_b32 s42, 299008
  buffer_load_dwordx4 v1, s[8:11], s42 offen nt lds
  s_add_u32 m0, s41, 23552
  s_mov_b32 s42, 315392
  buffer_load_dwordx4 v1, s[8:11], s42 offen nt lds
  s_add_u32 m0, s41, 24576
  s_mov_b32 s42, 327680
  buffer_load_dwordx4 v1, s[8:11], s42 offen nt lds
  s_add_u32 m0, s41, 25600
  s_mov_b32 s42, 344064
  buffer_load_dwordx4 v1, s[8:11], s42 offen nt lds
  s_add_u32 m0, s41, 26624
  s_mov_b32 s42, 331776
  buffer_load_dwordx4 v1, s[8:11], s42 offen nt lds
  s_add_u32 m0, s41, 27648
  s_mov_b32 s42, 348160
  buffer_load_dwordx4 v1, s[8:11], s42 offen nt lds
  s_add_u32 m0, s41, 28672
  s_mov_b32 s42, 360448
  buffer_load_dwordx4 v1, s[8:11], s42 offen nt lds
  s_add_u32 m0, s41, 29696
  s_mov_b32 s42, 376832
  buffer_load_dwordx4 v1, s[8:11], s42 offen nt lds
  s_add_u32 m0, s41, 30720
  s_mov_b32 s42, 364544
  buffer_load_dwordx4 v1, s[8:11], s42 offen nt lds
  s_add_u32 m0, s41, 31744
  s_mov_b32 s42, 380928
  buffer_load_dwordx4 v1, s[8:11], s42 offen nt lds
  s_waitcnt vmcnt(24)
  ds_read_b64_tr_b16 v[8:9], v4 offset:0
  ds_read_b64_tr_b16 v[10:11], v4 offset:2048
  ds_read_b64_tr_b16 v[12:13], v4 offset:4096
  ds_read_b64_tr_b16 v[14:15], v4 offset:6144
  ds_read_b64_tr_b16 v[16:17], v5 offset:0
  ds_read_b64_tr_b16 v[18:19], v5 offset:2048
  ds_read_b64_tr_b16 v[20:21], v5 offset:4096
  ds_read_b64_tr_b16 v[22:23], v5 offset:6144
  ds_read_b64_tr_b16 v[24:25], v6 offset:0
  ds_read_b64_tr_b16 v[26:27], v6 offset:2048
  ds_read_b64_tr_b16 v[28:29], v6 offset:4096
  ds_read_b64_tr_b16 v[30:31], v6 offset:6144
  ds_read_b64_tr_b16 v[32:33], v7 offset:0
  ds_read_b64_tr_b16 v[34:35], v7 offset:2048
  ds_read_b64_tr_b16 v[36:37], v7 offset:4096
  ds_read_b64_tr_b16 v[38:39], v7 offset:6144
  s_mov_b32 s42, 10485760
  s_waitcnt lgkmcnt(12)
  buffer_store_dwordx4 v[8:11], v3, s[4:7], s42 offen offset:0 sc1
  buffer_store_dwordx4 v[12:15], v3, s[4:7], s42 offen offset:1024 sc1
  s_mov_b32 s42, 10485760
  s_waitcnt lgkmcnt(8)
  buffer_store_dwordx4 v[16:19], v3, s[4:7], s42 offen offset:2048 sc1
  buffer_store_dwordx4 v[20:23], v3, s[4:7], s42 offen offset:3072 sc1
  s_mov_b32 s42, 10747904
  s_waitcnt lgkmcnt(4)
  buffer_store_dwordx4 v[24:27], v3, s[4:7], s42 offen offset:0 sc1
  buffer_store_dwordx4 v[28:31], v3, s[4:7], s42 offen offset:1024 sc1
  s_mov_b32 s42, 10747904
  s_waitcnt lgkmcnt(0)
  buffer_store_dwordx4 v[32:35], v3, s[4:7], s42 offen offset:2048 sc1
  buffer_store_dwordx4 v[36:39], v3, s[4:7], s42 offen offset:3072 sc1
  s_waitcnt vmcnt(24)
  ds_read_b64_tr_b16 v[40:41], v4 offset:8192
  ds_read_b64_tr_b16 v[42:43], v4 offset:10240
  ds_read_b64_tr_b16 v[44:45], v4 offset:12288
  ds_read_b64_tr_b16 v[46:47], v4 offset:14336
  ds_read_b64_tr_b16 v[48:49], v5 offset:8192
  ds_read_b64_tr_b16 v[50:51], v5 offset:10240
  ds_read_b64_tr_b16 v[52:53], v5 offset:12288
  ds_read_b64_tr_b16 v[54:55], v5 offset:14336
  ds_read_b64_tr_b16 v[56:57], v6 offset:8192
  ds_read_b64_tr_b16 v[58:59], v6 offset:10240
  ds_read_b64_tr_b16 v[60:61], v6 offset:12288
  ds_read_b64_tr_b16 v[62:63], v6 offset:14336
  ds_read_b64_tr_b16 v[64:65], v7 offset:8192
  ds_read_b64_tr_b16 v[66:67], v7 offset:10240
  ds_read_b64_tr_b16 v[68:69], v7 offset:12288
  ds_read_b64_tr_b16 v[70:71], v7 offset:14336
  s_mov_b32 s42, 10489856
  s_waitcnt lgkmcnt(12)
  buffer_store_dwordx4 v[40:43], v3, s[4:7], s42 offen offset:0 sc1
  buffer_store_dwordx4 v[44:47], v3, s[4:7], s42 offen offset:1024 sc1
  s_mov_b32 s42, 10489856
  s_waitcnt lgkmcnt(8)
  buffer_store_dwordx4 v[48:51], v3, s[4:7], s42 offen offset:2048 sc1
  buffer_store_dwordx4 v[52:55], v3, s[4:7], s42 offen offset:3072 sc1
  s_mov_b32 s42, 10752000
  s_waitcnt lgkmcnt(4)
  buffer_store_dwordx4 v[56:59], v3, s[4:7], s42 offen offset:0 sc1
  buffer_store_dwordx4 v[60:63], v3, s[4:7], s42 offen offset:1024 sc1
  s_mov_b32 s42, 10752000
  s_waitcnt lgkmcnt(0)
  buffer_store_dwordx4 v[64:67], v3, s[4:7], s42 offen offset:2048 sc1
  buffer_store_dwordx4 v[68:71], v3, s[4:7], s42 offen offset:3072 sc1
  s_waitcnt vmcnt(24)
  ds_read_b64_tr_b16 v[72:73], v4 offset:16384
  ds_read_b64_tr_b16 v[74:75], v4 offset:18432
  ds_read_b64_tr_b16 v[76:77], v4 offset:20480
  ds_read_b64_tr_b16 v[78:79], v4 offset:22528
  ds_read_b64_tr_b16 v[80:81], v5 offset:16384
  ds_read_b64_tr_b16 v[82:83], v5 offset:18432
  ds_read_b64_tr_b16 v[84:85], v5 offset:20480
  ds_read_b64_tr_b16 v[86:87], v5 offset:22528
  ds_read_b64_tr_b16 v[88:89], v6 offset:16384
  ds_read_b64_tr_b16 v[90:91], v6 offset:18432
  ds_read_b64_tr_b16 v[92:93], v6 offset:20480
  ds_read_b64_tr_b16 v[94:95], v6 offset:22528
  ds_read_b64_tr_b16 v[96:97], v7 offset:16384
  ds_read_b64_tr_b16 v[98:99], v7 offset:18432
  ds_read_b64_tr_b16 v[100:101], v7 offset:20480
  ds_read_b64_tr_b16 v[102:103], v7 offset:22528
  s_mov_b32 s42, 10493952
  s_waitcnt lgkmcnt(12)
  buffer_store_dwordx4 v[72:75], v3, s[4:7], s42 offen offset:0 sc1
  buffer_store_dwordx4 v[76:79], v3, s[4:7], s42 offen offset:1024 sc1
  s_mov_b32 s42, 10493952
  s_waitcnt lgkmcnt(8)
  buffer_store_dwordx4 v[80:83], v3, s[4:7], s42 offen offset:2048 sc1
  buffer_store_dwordx4 v[84:87], v3, s[4:7], s42 offen offset:3072 sc1
  s_mov_b32 s42, 10756096
  s_waitcnt lgkmcnt(4)
  buffer_store_dwordx4 v[88:91], v3, s[4:7], s42 offen offset:0 sc1
  buffer_store_dwordx4 v[92:95], v3, s[4:7], s42 offen offset:1024 sc1
  s_mov_b32 s42, 10756096
  s_waitcnt lgkmcnt(0)
  buffer_store_dwordx4 v[96:99], v3, s[4:7], s42 offen offset:2048 sc1
  buffer_store_dwordx4 v[100:103], v3, s[4:7], s42 offen offset:3072 sc1
  s_waitcnt vmcnt(24)
  ds_read_b64_tr_b16 v[104:105], v4 offset:24576
  ds_read_b64_tr_b16 v[106:107], v4 offset:26624
  ds_read_b64_tr_b16 v[108:109], v4 offset:28672
  ds_read_b64_tr_b16 v[110:111], v4 offset:30720
  ds_read_b64_tr_b16 v[112:113], v5 offset:24576
  ds_read_b64_tr_b16 v[114:115], v5 offset:26624
  ds_read_b64_tr_b16 v[116:117], v5 offset:28672
  ds_read_b64_tr_b16 v[118:119], v5 offset:30720
  ds_read_b64_tr_b16 v[120:121], v6 offset:24576
  ds_read_b64_tr_b16 v[122:123], v6 offset:26624
  ds_read_b64_tr_b16 v[124:125], v6 offset:28672
  ds_read_b64_tr_b16 v[126:127], v6 offset:30720
  ds_read_b64_tr_b16 v[128:129], v7 offset:24576
  ds_read_b64_tr_b16 v[130:131], v7 offset:26624
  ds_read_b64_tr_b16 v[132:133], v7 offset:28672
  ds_read_b64_tr_b16 v[134:135], v7 offset:30720
  s_mov_b32 s42, 10498048
  s_waitcnt lgkmcnt(12)
  buffer_store_dwordx4 v[104:107], v3, s[4:7], s42 offen offset:0 sc1
  buffer_store_dwordx4 v[108:111], v3, s[4:7], s42 offen offset:1024 sc1
  s_mov_b32 s42, 10498048
  s_waitcnt lgkmcnt(8)
  buffer_store_dwordx4 v[112:115], v3, s[4:7], s42 offen offset:2048 sc1
  buffer_store_dwordx4 v[116:119], v3, s[4:7], s42 offen offset:3072 sc1
  s_mov_b32 s42, 10760192
  s_waitcnt lgkmcnt(4)
  buffer_store_dwordx4 v[120:123], v3, s[4:7], s42 offen offset:0 sc1
  buffer_store_dwordx4 v[124:127], v3, s[4:7], s42 offen offset:1024 sc1
  s_mov_b32 s42, 10760192
  s_waitcnt lgkmcnt(0)
  buffer_store_dwordx4 v[128:131], v3, s[4:7], s42 offen offset:2048 sc1
  buffer_store_dwordx4 v[132:135], v3, s[4:7], s42 offen offset:3072 sc1
  v_min_u32 v1, 31, v0
  v_lshlrev_b32 v1, 2, v1
  v_add_u32 v1, 128, v1
  s_nop 1
Lpoll_151:
  buffer_load_dword v2, v1, s[12:15], 0 offen sc1
  s_sub_u32 s24, s24, 1
  s_cbranch_scc1 L_FAIL
  s_waitcnt vmcnt(0)
  v_cmp_gt_i32 vcc, 1, v2
  s_cbranch_vccz Lpolld_152
  s_sleep 2
  s_branch Lpoll_151
Lpolld_152:
  s_barrier
  s_lshl_b32 s40, s21, 7
  s_add_u32 s40, s40, 1432576
  s_cmp_lg_u32 s20, 0
  s_cbranch_scc1 Lnosig_153
  s_mov_b32 s63, 1
  s_atomic_smax s63, s[4:5], s40 glc
Lnosig_153:
  s_branch L_LN1
L_QK:
  v_bfe_u32 v76, v0, 3, 2
  v_xor_b32 v76, s20, v76
  v_lshlrev_b32 v76, 5, v76
  v_lshrrev_b32 v4, 2, v0
  v_lshl_add_u32 v4, v4, 7, v76
  v_and_b32 v76, 3, v0
  v_lshl_add_u32 v4, v76, 3, v4
  s_lshl_b32 s40, s20, 15
  v_add_u32 v4, s40, v4
  v_lshl_add_u32 v85, v0, 4, s40
  s_lshl_b32 s40, s20, 12
  s_add_u32 s40, s40, 131072
  v_lshl_add_u32 v1, v0, 4, s40
  s_lshr_b32 s54, s21, 4
  s_lshl_b32 s52, s54, 22
  s_sub_u32 s53, 0, s52
  v_xor_b32 v5, 32768, v4
  v_xor_b32 v2, 4096, v1
  v_xor_b32 v6, 65536, v4
  v_xor_b32 v3, 8192, v1
  v_xor_b32 v7, 98304, v4
  v_xor_b32 v84, 12288, v1
  v_bfe_u32 v8, v0, 5, 1
  v_mul_u32_u24 v8, 16384, v8
  v_bfe_u32 v76, v0, 4, 1
  v_mul_u32_u24 v76, 32768, v76
  v_add_u32 v8, v8, v76
  v_bfe_u32 v76, v0, 3, 1
  v_mul_u32_u24 v76, 131072, v76
  v_add_u32 v8, v8, v76
  v_lshrrev_b32 v76, 3, v0
  v_and_b32 v76, 6, v76
  v_xor_b32 v76, v76, v0
  v_and_b32 v76, 7, v76
  v_lshl_add_u32 v8, v76, 4, v8
  s_lshl_b32 s40, s20, 19
  v_add_u32 v8, s40, v8
  s_lshl_b32 s44, s21, 8
  s_add_u32 s45, s44, 128
  v_add_u32 v9, s44, v8
  v_add_u32 v10, s44, v8
  v_add_u32 v11, s45, v8
  v_add_u32 v12, s45, v8
  s_lshl_b32 s41, s20, 15
  s_and_b32 s40, s21, 3
  s_cmp_eq_u32 s40, 1
  s_cselect_b64 vcc, -1, 0
  s_load_dwordx2 s[8:9], s[0:1], 24
  s_mov_b32 s10, 8388608
  s_mov_b32 s11, 0x20000
  s_waitcnt lgkmcnt(0)
  s_add_u32 m0, s41, 0
  s_add_u32 s42, s52, 0
  buffer_load_dwordx4 v9, s[8:11], s42 offen lds
  s_add_u32 m0, s41, 1024
  s_add_u32 s42, s52, 65536
  buffer_load_dwordx4 v9, s[8:11], s42 offen lds
  s_add_u32 m0, s41, 2048
  s_add_u32 s42, s52, 8192
  buffer_load_dwordx4 v9, s[8:11], s42 offen lds
  s_add_u32 m0, s41, 3072
  s_add_u32 s42, s52, 73728
  buffer_load_dwordx4 v9, s[8:11], s42 offen lds
  s_add_u32 m0, s41, 4096
  s_add_u32 s42, s52, 262144
  buffer_load_dwordx4 v9, s[8:11], s42 offen lds
  s_add_u32 m0, s41, 5120
  s_add_u32 s42, s52, 327680
  buffer_load_dwordx4 v9, s[8:11], s42 offen lds
  s_add_u32 m0, s41, 6144
  s_add_u32 s42, s52, 270336
  buffer_load_dwordx4 v9, s[8:11], s42 offen lds
  s_add_u32 m0, s41, 7168
  s_add_u32 s42, s52, 335872
  buffer_load_dwordx4 v9, s[8:11], s42 offen lds
  s_add_u32 m0, s41, 8192
  s_add_u32 s42, s52, 2097152
  buffer_load_dwordx4 v9, s[8:11], s42 offen lds
  s_add_u32 m0, s41, 9216
  s_add_u32 s42, s52, 2162688
  buffer_load_dwordx4 v9, s[8:11], s42 offen lds
  s_add_u32 m0, s41, 10240
  s_add_u32 s42, s52, 2105344
  buffer_load_dwordx4 v9, s[8:11], s42 offen lds
  s_add_u32 m0, s41, 11264
  s_add_u32 s42, s52, 2170880
  buffer_load_dwordx4 v9, s[8:11], s42 offen lds
  s_add_u32 m0, s41, 12288
  s_add_u32 s42, s52, 2359296
  buffer_load_dwordx4 v9, s[8:11], s42 offen lds
  s_add_u32 m0, s41, 13312
  s_add_u32 s42, s52, 2424832
  buffer_load_dwordx4 v9, s[8:11], s42 offen lds
  s_add_u32 m0, s41, 14336
  s_add_u32 s42, s52, 2367488
  buffer_load_dwordx4 v9, s[8:11], s42 offen lds
  s_add_u32 m0, s41, 15360
  s_add_u32 s42, s52, 2433024
  buffer_load_dwordx4 v9, s[8:11], s42 offen lds
  s_add_u32 m0, s41, 16384
  s_add_u32 s42, s53, 4194304
  buffer_load_dwordx4 v9, s[8:11], s42 offen lds
  s_add_u32 m0, s41, 17408
  s_add_u32 s42, s53, 4259840
  buffer_load_dwordx4 v9, s[8:11], s42 offen lds
  s_add_u32 m0, s41, 18432
  s_add_u32 s42, s53, 4202496
  buffer_load_dwordx4 v9, s[8:11], s42 offen lds
  s_add_u32 m0, s41, 19456
  s_add_u32 s42, s53, 4268032
  buffer_load_dwordx4 v9, s[8:11], s42 offen lds
  s_add_u32 m0, s41, 20480
  s_add_u32 s42, s53, 4456448
  buffer_load_dwordx4 v9, s[8:11], s42 offen lds
  s_add_u32 m0, s41, 21504
  s_add_u32 s42, s53, 4521984
  buffer_load_dwordx4 v9, s[8:11], s42 offen lds
  s_add_u32 m0, s41, 22528
  s_add_u32 s42, s53, 4464640
  buffer_load_dwordx4 v9, s[8:11], s42 offen lds
  s_add_u32 m0, s41, 23552
  s_add_u32 s42, s53, 4530176
  buffer_load_dwordx4 v9, s[8:11], s42 offen lds
  s_waitcnt vmcnt(16) lgkmcnt(0)
  s_barrier
  s_add_u32 m0, s41, 24576
  s_add_u32 s42, s53, 6291456
  buffer_load_dwordx4 v9, s[8:11], s42 offen lds
  s_add_u32 m0, s41, 25600
  s_add_u32 s42, s53, 6356992
  buffer_load_dwordx4 v9, s[8:11], s42 offen lds
  s_add_u32 m0, s41, 26624
  s_add_u32 s42, s53, 6299648
  buffer_load_dwordx4 v9, s[8:11], s42 offen lds
  s_add_u32 m0, s41, 27648
  s_add_u32 s42, s53, 6365184
  buffer_load_dwordx4 v9, s[8:11], s42 offen lds
  s_add_u32 m0, s41, 28672
  s_add_u32 s42, s53, 6553600
  buffer_load_dwordx4 v9, s[8:11], s42 offen lds
  s_add_u32 m0, s41, 29696
  s_add_u32 s42, s53, 6619136
  buffer_load_dwordx4 v9, s[8:11], s42 offen lds
  s_add_u32 m0, s41, 30720
  s_add_u32 s42, s53, 6561792
  buffer_load_dwordx4 v9, s[8:11], s42 offen lds
  s_add_u32 m0, s41, 31744
  s_add_u32 s42, s53, 6627328
  buffer_load_dwordx4 v9, s[8:11], s42 offen lds
  ds_read_b64_tr_b16 v[128:129], v4 offset:0
  ds_read_b64_tr_b16 v[130:131], v4 offset:2048
  ds_read_b64_tr_b16 v[132:133], v4 offset:4096
  ds_read_b64_tr_b16 v[134:135], v4 offset:6144
  ds_read_b64_tr_b16 v[144:145], v5 offset:0
  ds_read_b64_tr_b16 v[146:147], v5 offset:2048
  ds_read_b64_tr_b16 v[148:149], v5 offset:4096
  ds_read_b64_tr_b16 v[150:151], v5 offset:6144
  ds_read_b64_tr_b16 v[160:161], v6 offset:0
  ds_read_b64_tr_b16 v[162:163], v6 offset:2048
  ds_read_b64_tr_b16 v[164:165], v6 offset:4096
  ds_read_b64_tr_b16 v[166:167], v6 offset:6144
  ds_read_b64_tr_b16 v[176:177], v7 offset:0
  ds_read_b64_tr_b16 v[178:179], v7 offset:2048
  ds_read_b64_tr_b16 v[180:181], v7 offset:4096
  ds_read_b64_tr_b16 v[182:183], v7 offset:6144
  s_waitcnt vmcnt(16) lgkmcnt(0)
  s_barrier
  s_load_dwordx2 s[8:9], s[0:1], 16
  s_mov_b32 s10, 8388608
  s_mov_b32 s11, 0x20000
  s_waitcnt lgkmcnt(0)
  s_add_u32 m0, s41, 0
  s_add_u32 s42, s52, 0
  buffer_load_dwordx4 v10, s[8:11], s42 offen lds
  s_add_u32 m0, s41, 1024
  s_add_u32 s42, s52, 65536
  buffer_load_dwordx4 v10, s[8:11], s42 offen lds
  s_add_u32 m0, s41, 2048
  s_add_u32 s42, s52, 8192
  buffer_load_dwordx4 v10, s[8:11], s42 offen lds
  s_add_u32 m0, s41, 3072
  s_add_u32 s42, s52, 73728
  buffer_load_dwordx4 v10, s[8:11], s42 offen lds
  s_add_u32 m0, s41, 4096
  s_add_u32 s42, s52, 262144
  buffer_load_dwordx4 v10, s[8:11], s42 offen lds
  s_add_u32 m0, s41, 5120
  s_add_u32 s42, s52, 327680
  buffer_load_dwordx4 v10, s[8:11], s42 offen lds
  s_add_u32 m0, s41, 6144
  s_add_u32 s42, s52, 270336
  buffer_load_dwordx4 v10, s[8:11], s42 offen lds
  s_add_u32 m0, s41, 7168
  s_add_u32 s42, s52, 335872
  buffer_load_dwordx4 v10, s[8:11], s42 offen lds
  ds_read_b64_tr_b16 v[136:137], v4 offset:8192
  ds_read_b64_tr_b16 v[138:139], v4 offset:10240
  ds_read_b64_tr_b16 v[140:141], v4 offset:12288
  ds_read_b64_tr_b16 v[142:143], v4 offset:14336
  ds_read_b64_tr_b16 v[152:153], v5 offset:8192
  ds_read_b64_tr_b16 v[154:155], v5 offset:10240
  ds_read_b64_tr_b16 v[156:157], v5 offset:12288
  ds_read_b64_tr_b16 v[158:159], v5 offset:14336
  ds_read_b64_tr_b16 v[168:169], v6 offset:8192
  ds_read_b64_tr_b16 v[170:171], v6 offset:10240
  ds_read_b64_tr_b16 v[172:173], v6 offset:12288
  ds_read_b64_tr_b16 v[174:175], v6 offset:14336
  ds_read_b64_tr_b16 v[184:185], v7 offset:8192
  ds_read_b64_tr_b16 v[186:187], v7 offset:10240
  ds_read_b64_tr_b16 v[188:189], v7 offset:12288
  ds_read_b64_tr_b16 v[190:191], v7 offset:14336
  s_waitcnt vmcnt(16) lgkmcnt(0)
  s_barrier
  s_add_u32 m0, s41, 8192
  s_add_u32 s42, s52, 2097152
  buffer_load_dwordx4 v10, s[8:11], s42 offen lds
  s_add_u32 m0, s41, 9216
  s_add_u32 s42, s52, 2162688
  buffer_load_dwordx4 v10, s[8:11], s42 offen lds
  s_add_u32 m0, s41, 10240
  s_add_u32 s42, s52, 2105344
  buffer_load_dwordx4 v10, s[8:11], s42 offen lds
  s_add_u32 m0, s41, 11264
  s_add_u32 s42, s52, 2170880
  buffer_load_dwordx4 v10, s[8:11], s42 offen lds
  s_add_u32 m0, s41, 12288
  s_add_u32 s42, s52, 2359296
  buffer_load_dwordx4 v10, s[8:11], s42 offen lds
  s_add_u32 m0, s41, 13312
  s_add_u32 s42, s52, 2424832
  buffer_load_dwordx4 v10, s[8:11], s42 offen lds
  s_add_u32 m0, s41, 14336
  s_add_u32 s42, s52, 2367488
  buffer_load_dwordx4 v10, s[8:11], s42 offen lds
  s_add_u32 m0, s41, 15360
  s_add_u32 s42, s52, 2433024
  buffer_load_dwordx4 v10, s[8:11], s42 offen lds
  ds_read_b64_tr_b16 v[192:193], v4 offset:16384
  ds_read_b64_tr_b16 v[194:195], v4 offset:18432
  ds_read_b64_tr_b16 v[196:197], v4 offset:20480
  ds_read_b64_tr_b16 v[198:199], v4 offset:22528
  ds_read_b64_tr_b16 v[208:209], v5 offset:16384
  ds_read_b64_tr_b16 v[210:211], v5 offset:18432
  ds_read_b64_tr_b16 v[212:213], v5 offset:20480
  ds_read_b64_tr_b16 v[214:215], v5 offset:22528
  ds_read_b64_tr_b16 v[224:225], v6 offset:16384
  ds_read_b64_tr_b16 v[226:227], v6 offset:18432
  ds_read_b64_tr_b16 v[228:229], v6 offset:20480
  ds_read_b64_tr_b16 v[230:231], v6 offset:22528
  ds_read_b64_tr_b16 v[240:241], v7 offset:16384
  ds_read_b64_tr_b16 v[242:243], v7 offset:18432
  ds_read_b64_tr_b16 v[244:245], v7 offset:20480
  ds_read_b64_tr_b16 v[246:247], v7 offset:22528
  s_waitcnt vmcnt(16) lgkmcnt(0)
  s_barrier
  s_add_u32 m0, s41, 16384
  s_add_u32 s42, s53, 4194304
  buffer_load_dwordx4 v10, s[8:11], s42 offen lds
  s_add_u32 m0, s41, 17408
  s_add_u32 s42, s53, 4259840
  buffer_load_dwordx4 v10, s[8:11], s42 offen lds
  s_add_u32 m0, s41, 18432
  s_add_u32 s42, s53, 4202496
  buffer_load_dwordx4 v10, s[8:11], s42 offen lds
  s_add_u32 m0, s41, 19456
  s_add_u32 s42, s53, 4268032
  buffer_load_dwordx4 v10, s[8:11], s42 offen lds
  s_add_u32 m0, s41, 20480
  s_add_u32 s42, s53, 4456448
  buffer_load_dwordx4 v10, s[8:11], s42 offen lds
  s_add_u32 m0, s41, 21504
  s_add_u32 s42, s53, 4521984
  buffer_load_dwordx4 v10, s[8:11], s42 offen lds
  s_add_u32 m0, s41, 22528
  s_add_u32 s42, s53, 4464640
  buffer_load_dwordx4 v10, s[8:11], s42 offen lds
  s_add_u32 m0, s41, 23552
  s_add_u32 s42, s53, 4530176
  buffer_load_dwordx4 v10, s[8:11], s42 offen lds
  ds_read_b64_tr_b16 v[200:201], v4 offset:24576
  ds_read_b64_tr_b16 v[202:203], v4 offset:26624
  ds_read_b64_tr_b16 v[204:205], v4 offset:28672
  ds_read_b64_tr_b16 v[206:207], v4 offset:30720
  ds_read_b64_tr_b16 v[216:217], v5 offset:24576
  ds_read_b64_tr_b16 v[218:219], v5 offset:26624
  ds_read_b64_tr_b16 v[220:221], v5 offset:28672
  ds_read_b64_tr_b16 v[222:223], v5 offset:30720
  ds_read_b64_tr_b16 v[232:233], v6 offset:24576
  ds_read_b64_tr_b16 v[234:235], v6 offset:26624
  ds_read_b64_tr_b16 v[236:237], v6 offset:28672
  ds_read_b64_tr_b16 v[238:239], v6 offset:30720
  ds_read_b64_tr_b16 v[248:249], v7 offset:24576
  ds_read_b64_tr_b16 v[250:251], v7 offset:26624
  ds_read_b64_tr_b16 v[252:253], v7 offset:28672
  ds_read_b64_tr_b16 v[254:255], v7 offset:30720
  s_waitcnt vmcnt(16) lgkmcnt(0)
  s_barrier
  s_add_u32 m0, s41, 24576
  s_add_u32 s42, s53, 6291456
  buffer_load_dwordx4 v10, s[8:11], s42 offen lds
  s_add_u32 m0, s41, 25600
  s_add_u32 s42, s53, 6356992
  buffer_load_dwordx4 v10, s[8:11], s42 offen lds
  s_add_u32 m0, s41, 26624
  s_add_u32 s42, s53, 6299648
  buffer_load_dwordx4 v10, s[8:11], s42 offen lds
  s_add_u32 m0, s41, 27648
  s_add_u32 s42, s53, 6365184
  buffer_load_dwordx4 v10, s[8:11], s42 offen lds
  s_add_u32 m0, s41, 28672
  s_add_u32 s42, s53, 6553600
  buffer_load_dwordx4 v10, s[8:11], s42 offen lds
  s_add_u32 m0, s41, 29696
  s_add_u32 s42, s53, 6619136
  buffer_load_dwordx4 v10, s[8:11], s42 offen lds
  s_add_u32 m0, s41, 30720
  s_add_u32 s42, s53, 6561792
  buffer_load_dwordx4 v10, s[8:11], s42 offen lds
  s_add_u32 m0, s41, 31744
  s_add_u32 s42, s53, 6627328
  buffer_load_dwordx4 v10, s[8:11], s42 offen lds
  ds_read_b64_tr_b16 a[0:1], v4 offset:0
  ds_read_b64_tr_b16 a[2:3], v4 offset:2048
  ds_read_b64_tr_b16 a[4:5], v4 offset:4096
  ds_read_b64_tr_b16 a[6:7], v4 offset:6144
  ds_read_b64_tr_b16 a[16:17], v5 offset:0
  ds_read_b64_tr_b16 a[18:19], v5 offset:2048
  ds_read_b64_tr_b16 a[20:21], v5 offset:4096
  ds_read_b64_tr_b16 a[22:23], v5 offset:6144
  ds_read_b64_tr_b16 a[32:33], v6 offset:0
  ds_read_b64_tr_b16 a[34:35], v6 offset:2048
  ds_read_b64_tr_b16 a[36:37], v6 offset:4096
  ds_read_b64_tr_b16 a[38:39], v6 offset:6144
  ds_read_b64_tr_b16 a[48:49], v7 offset:0
  ds_read_b64_tr_b16 a[50:51], v7 offset:2048
  ds_read_b64_tr_b16 a[52:53], v7 offset:4096
  ds_read_b64_tr_b16 a[54:55], v7 offset:6144
  s_waitcnt vmcnt(16) lgkmcnt(0)
  s_barrier
  s_load_dwordx2 s[8:9], s[0:1], 16
  s_mov_b32 s10, 8388608
  s_mov_b32 s11, 0x20000
  s_waitcnt lgkmcnt(0)
  s_add_u32 m0, s41, 0
  s_add_u32 s42, s52, 0
  buffer_load_dwordx4 v11, s[8:11], s42 offen lds
  s_add_u32 m0, s41, 1024
  s_add_u32 s42, s52, 65536
  buffer_load_dwordx4 v11, s[8:11], s42 offen lds
  s_add_u32 m0, s41, 2048
  s_add_u32 s42, s52, 8192
  buffer_load_dwordx4 v11, s[8:11], s42 offen lds
  s_add_u32 m0, s41, 3072
  s_add_u32 s42, s52, 73728
  buffer_load_dwordx4 v11, s[8:11], s42 offen lds
  s_add_u32 m0, s41, 4096
  s_add_u32 s42, s52, 262144
  buffer_load_dwordx4 v11, s[8:11], s42 offen lds
  s_add_u32 m0, s41, 5120
  s_add_u32 s42, s52, 327680
  buffer_load_dwordx4 v11, s[8:11], s42 offen lds
  s_add_u32 m0, s41, 6144
  s_add_u32 s42, s52, 270336
  buffer_load_dwordx4 v11, s[8:11], s42 offen lds
  s_add_u32 m0, s41, 7168
  s_add_u32 s42, s52, 335872
  buffer_load_dwordx4 v11, s[8:11], s42 offen lds
  ds_read_b64_tr_b16 a[8:9], v4 offset:8192
  ds_read_b64_tr_b16 a[10:11], v4 offset:10240
  ds_read_b64_tr_b16 a[12:13], v4 offset:12288
  ds_read_b64_tr_b16 a[14:15], v4 offset:14336
  ds_read_b64_tr_b16 a[24:25], v5 offset:8192
  ds_read_b64_tr_b16 a[26:27], v5 offset:10240
  ds_read_b64_tr_b16 a[28:29], v5 offset:12288
  ds_read_b64_tr_b16 a[30:31], v5 offset:14336
  ds_read_b64_tr_b16 a[40:41], v6 offset:8192
  ds_read_b64_tr_b16 a[42:43], v6 offset:10240
  ds_read_b64_tr_b16 a[44:45], v6 offset:12288
  ds_read_b64_tr_b16 a[46:47], v6 offset:14336
  ds_read_b64_tr_b16 a[56:57], v7 offset:8192
  ds_read_b64_tr_b16 a[58:59], v7 offset:10240
  ds_read_b64_tr_b16 a[60:61], v7 offset:12288
  ds_read_b64_tr_b16 a[62:63], v7 offset:14336
  s_waitcnt vmcnt(16) lgkmcnt(0)
  s_barrier
  s_add_u32 m0, s41, 8192
  s_add_u32 s42, s52, 2097152
  buffer_load_dwordx4 v11, s[8:11], s42 offen lds
  s_add_u32 m0, s41, 9216
  s_add_u32 s42, s52, 2162688
  buffer_load_dwordx4 v11, s[8:11], s42 offen lds
  s_add_u32 m0, s41, 10240
  s_add_u32 s42, s52, 2105344
  buffer_load_dwordx4 v11, s[8:11], s42 offen lds
  s_add_u32 m0, s41, 11264
  s_add_u32 s42, s52, 2170880
  buffer_load_dwordx4 v11, s[8:11], s42 offen lds
  s_add_u32 m0, s41, 12288
  s_add_u32 s42, s52, 2359296
  buffer_load_dwordx4 v11, s[8:11], s42 offen lds
  s_add_u32 m0, s41, 13312
  s_add_u32 s42, s52, 2424832
  buffer_load_dwordx4 v11, s[8:11], s42 offen lds
  s_add_u32 m0, s41, 14336
  s_add_u32 s42, s52, 2367488
  buffer_load_dwordx4 v11, s[8:11], s42 offen lds
  s_add_u32 m0, s41, 15360
  s_add_u32 s42, s52, 2433024
  buffer_load_dwordx4 v11, s[8:11], s42 offen lds
  ds_read_b64_tr_b16 a[64:65], v4 offset:16384
  ds_read_b64_tr_b16 a[66:67], v4 offset:18432
  ds_read_b64_tr_b16 a[68:69], v4 offset:20480
  ds_read_b64_tr_b16 a[70:71], v4 offset:22528
  ds_read_b64_tr_b16 a[80:81], v5 offset:16384
  ds_read_b64_tr_b16 a[82:83], v5 offset:18432
  ds_read_b64_tr_b16 a[84:85], v5 offset:20480
  ds_read_b64_tr_b16 a[86:87], v5 offset:22528
  ds_read_b64_tr_b16 a[96:97], v6 offset:16384
  ds_read_b64_tr_b16 a[98:99], v6 offset:18432
  ds_read_b64_tr_b16 a[100:101], v6 offset:20480
  ds_read_b64_tr_b16 a[102:103], v6 offset:22528
  ds_read_b64_tr_b16 a[112:113], v7 offset:16384
  ds_read_b64_tr_b16 a[114:115], v7 offset:18432
  ds_read_b64_tr_b16 a[116:117], v7 offset:20480
  ds_read_b64_tr_b16 a[118:119], v7 offset:22528
  s_cmp_lg_u32 s20, 0
  s_cbranch_scc1 Lchore_154
Lini_155:
  s_load_dwordx16 s[64:79], s[12:13], 128 glc
  s_load_dwordx16 s[80:95], s[12:13], 192 glc
  s_sub_u32 s24, s24, 1
  s_cbranch_scc1 L_FAIL
  s_waitcnt lgkmcnt(0)
  s_and_b64 s[64:65], s[64:65], s[66:67]
  s_and_b64 s[64:65], s[64:65], s[68:69]
  s_and_b64 s[64:65], s[64:65], s[70:71]
  s_and_b64 s[64:65], s[64:65], s[72:73]
  s_and_b64 s[64:65], s[64:65], s[74:75]
  s_and_b64 s[64:65], s[64:65], s[76:77]
  s_and_b64 s[64:65], s[64:65], s[78:79]
  s_and_b64 s[64:65], s[64:65], s[80:81]
  s_and_b64 s[64:65], s[64:65], s[82:83]
  s_and_b64 s[64:65], s[64:65], s[84:85]
  s_and_b64 s[64:65], s[64:65], s[86:87]
  s_and_b64 s[64:65], s[64:65], s[88:89]
  s_and_b64 s[64:65], s[64:65], s[90:91]
  s_and_b64 s[64:65], s[64:65], s[92:93]
  s_and_b64 s[64:65], s[64:65], s[94:95]
  s_and_b32 s64, s64, s65
  s_cbranch_scc0 Lini_155
  s_mov_b32 s46, 0xffff
  s_and_b32 s40, s21, 3
  s_lshl_b32 s40, s40, 13
  s_lshr_b32 s43, s21, 2
  s_lshl_b32 s43, s43, 10
  s_add_u32 s43, s43, s40
  s_add_u32 s43, s43, 1343488
  s_waitcnt lgkmcnt(0)
  s_memtime s[64:65]
  s_waitcnt lgkmcnt(0)
  s_load_dword s68, s[4:5], s43 glc
  s_waitcnt lgkmcnt(0)
  s_memtime s[66:67]
  s_waitcnt lgkmcnt(0)
  s_sub_u32 s64, s66, s64
  s_min_u32 s46, s46, s64
  s_getreg_b32 s55, hwreg(HW_REG_XCC_ID)
  s_and_b32 s55, s55, 15
  s_lshl_b32 s46, s46, 8
  s_or_b32 s46, s46, s55
  s_add_u32 s40, s21, 0
  s_lshl_b32 s40, s40, 7
  s_add_u32 s40, s40, 1424384
  s_mov_b32 s63, s46
  s_atomic_smax s63, s[4:5], s40 glc
Lnosig_156:
Lchore_154:
  s_waitcnt vmcnt(16) lgkmcnt(0)
  s_barrier
  s_add_u32 m0, s41, 16384
  s_add_u32 s42, s53, 4194304
  buffer_load_dwordx4 v11, s[8:11], s42 offen lds
  s_add_u32 m0, s41, 17408
  s_add_u32 s42, s53, 4259840
  buffer_load_dwordx4 v11, s[8:11], s42 offen lds
  s_add_u32 m0, s41, 18432
  s_add_u32 s42, s53, 4202496
  buffer_load_dwordx4 v11, s[8:11], s42 offen lds
  s_add_u32 m0, s41, 19456
  s_add_u32 s42, s53, 4268032
  buffer_load_dwordx4 v11, s[8:11], s42 offen lds
  s_add_u32 m0, s41, 20480
  s_add_u32 s42, s53, 4456448
  buffer_load_dwordx4 v11, s[8:11], s42 offen lds
  s_add_u32 m0, s41, 21504
  s_add_u32 s42, s53, 4521984
  buffer_load_dwordx4 v11, s[8:11], s42 offen lds
  s_add_u32 m0, s41, 22528
  s_add_u32 s42, s53, 4464640
  buffer_load_dwordx4 v11, s[8:11], s42 offen lds
  s_add_u32 m0, s41, 23552
  s_add_u32 s42, s53, 4530176
  buffer_load_dwordx4 v11, s[8:11], s42 offen lds
  ds_read_b64_tr_b16 a[72:73], v4 offset:24576
  ds_read_b64_tr_b16 a[74:75], v4 offset:26624
  ds_read_b64_tr_b16 a[76:77], v4 offset:28672
  ds_read_b64_tr_b16 a[78:79], v4 offset:30720
  ds_read_b64_tr_b16 a[88:89], v5 offset:24576
  ds_read_b64_tr_b16 a[90:91], v5 offset:26624
  ds_read_b64_tr_b16 a[92:93], v5 offset:28672
  ds_read_b64_tr_b16 a[94:95], v5 offset:30720
  ds_read_b64_tr_b16 a[104:105], v6 offset:24576
  ds_read_b64_tr_b16 a[106:107], v6 offset:26624
  ds_read_b64_tr_b16 a[108:109], v6 offset:28672
  ds_read_b64_tr_b16 a[110:111], v6 offset:30720
  ds_read_b64_tr_b16 a[120:121], v7 offset:24576
  ds_read_b64_tr_b16 a[122:123], v7 offset:26624
  ds_read_b64_tr_b16 a[124:125], v7 offset:28672
  ds_read_b64_tr_b16 a[126:127], v7 offset:30720
  s_waitcnt vmcnt(16) lgkmcnt(0)
  s_barrier
  s_add_u32 m0, s41, 24576
  s_add_u32 s42, s53, 6291456
  buffer_load_dwordx4 v11, s[8:11], s42 offen lds
  s_add_u32 m0, s41, 25600
  s_add_u32 s42, s53, 6356992
  buffer_load_dwordx4 v11, s[8:11], s42 offen lds
  s_add_u32 m0, s41, 26624
  s_add_u32 s42, s53, 6299648
  buffer_load_dwordx4 v11, s[8:11], s42 offen lds
  s_add_u32 m0, s41, 27648
  s_add_u32 s42, s53, 6365184
  buffer_load_dwordx4 v11, s[8:11], s42 offen lds
  s_add_u32 m0, s41, 28672
  s_add_u32 s42, s53, 6553600
  buffer_load_dwordx4 v11, s[8:11], s42 offen lds
  s_add_u32 m0, s41, 29696
  s_add_u32 s42, s53, 6619136
  buffer_load_dwordx4 v11, s[8:11], s42 offen lds
  s_add_u32 m0, s41, 30720
  s_add_u32 s42, s53, 6561792
  buffer_load_dwordx4 v11, s[8:11], s42 offen lds
  s_add_u32 m0, s41, 31744
  s_add_u32 s42, s53, 6627328
  buffer_load_dwordx4 v11, s[8:11], s42 offen lds
  ds_read_b64_tr_b16 a[128:129], v4 offset:0
  ds_read_b64_tr_b16 a[130:131], v4 offset:2048
  ds_read_b64_tr_b16 a[132:133], v4 offset:4096
  ds_read_b64_tr_b16 a[134:135], v4 offset:6144
  ds_read_b64_tr_b16 a[144:145], v5 offset:0
  ds_read_b64_tr_b16 a[146:147], v5 offset:2048
  ds_read_b64_tr_b16 a[148:149], v5 offset:4096
  ds_read_b64_tr_b16 a[150:151], v5 offset:6144
  ds_read_b64_tr_b16 a[160:161], v6 offset:0
  ds_read_b64_tr_b16 a[162:163], v6 offset:2048
  ds_read_b64_tr_b16 a[164:165], v6 offset:4096
  ds_read_b64_tr_b16 a[166:167], v6 offset:6144
  ds_read_b64_tr_b16 a[176:177], v7 offset:0
  ds_read_b64_tr_b16 a[178:179], v7 offset:2048
  ds_read_b64_tr_b16 a[180:181], v7 offset:4096
  ds_read_b64_tr_b16 a[182:183], v7 offset:6144
  s_waitcnt vmcnt(16) lgkmcnt(0)
  s_barrier
  s_load_dwordx2 s[8:9], s[0:1], 24
  s_mov_b32 s10, 8388608
  s_mov_b32 s11, 0x20000
  s_waitcnt lgkmcnt(0)
  s_add_u32 m0, s41, 0
  s_add_u32 s42, s52, 0
  buffer_load_dwordx4 v12, s[8:11], s42 offen lds
  s_add_u32 m0, s41, 1024
  s_add_u32 s42, s52, 65536
  buffer_load_dwordx4 v12, s[8:11], s42 offen lds
  s_add_u32 m0, s41, 2048
  s_add_u32 s42, s52, 8192
  buffer_load_dwordx4 v12, s[8:11], s42 offen lds
  s_add_u32 m0, s41, 3072
  s_add_u32 s42, s52, 73728
  buffer_load_dwordx4 v12, s[8:11], s42 offen lds
  s_add_u32 m0, s41, 4096
  s_add_u32 s42, s52, 262144
  buffer_load_dwordx4 v12, s[8:11], s42 offen lds
  s_add_u32 m0, s41, 5120
  s_add_u32 s42, s52, 327680
  buffer_load_dwordx4 v12, s[8:11], s42 offen lds
  s_add_u32 m0, s41, 6144
  s_add_u32 s42, s52, 270336
  buffer_load_dwordx4 v12, s[8:11], s42 offen lds
  s_add_u32 m0, s41, 7168
  s_add_u32 s42, s52, 335872
  buffer_load_dwordx4 v12, s[8:11], s42 offen lds
  ds_read_b64_tr_b16 a[136:137], v4 offset:8192
  ds_read_b64_tr_b16 a[138:139], v4 offset:10240
  ds_read_b64_tr_b16 a[140:141], v4 offset:12288
  ds_read_b64_tr_b16 a[142:143], v4 offset:14336
  ds_read_b64_tr_b16 a[152:153], v5 offset:8192
  ds_read_b64_tr_b16 a[154:155], v5 offset:10240
  ds_read_b64_tr_b16 a[156:157], v5 offset:12288
  ds_read_b64_tr_b16 a[158:159], v5 offset:14336
  ds_read_b64_tr_b16 a[168:169], v6 offset:8192
  ds_read_b64_tr_b16 a[170:171], v6 offset:10240
  ds_read_b64_tr_b16 a[172:173], v6 offset:12288
  ds_read_b64_tr_b16 a[174:175], v6 offset:14336
  ds_read_b64_tr_b16 a[184:185], v7 offset:8192
  ds_read_b64_tr_b16 a[186:187], v7 offset:10240
  ds_read_b64_tr_b16 a[188:189], v7 offset:12288
  ds_read_b64_tr_b16 a[190:191], v7 offset:14336
  s_waitcnt vmcnt(16) lgkmcnt(0)
  s_barrier
  s_add_u32 m0, s41, 8192
  s_add_u32 s42, s52, 2097152
  buffer_load_dwordx4 v12, s[8:11], s42 offen lds
  s_add_u32 m0, s41, 9216
  s_add_u32 s42, s52, 2162688
  buffer_load_dwordx4 v12, s[8:11], s42 offen lds
  s_add_u32 m0, s41, 10240
  s_add_u32 s42, s52, 2105344
  buffer_load_dwordx4 v12, s[8:11], s42 offen lds
  s_add_u32 m0, s41, 11264
  s_add_u32 s42, s52, 2170880
  buffer_load_dwordx4 v12, s[8:11], s42 offen lds
  s_add_u32 m0, s41, 12288
  s_add_u32 s42, s52, 2359296
  buffer_load_dwordx4 v12, s[8:11], s42 offen lds
  s_add_u32 m0, s41, 13312
  s_add_u32 s42, s52, 2424832
  buffer_load_dwordx4 v12, s[8:11], s42 offen lds
  s_add_u32 m0, s41, 14336
  s_add_u32 s42, s52, 2367488
  buffer_load_dwordx4 v12, s[8:11], s42 offen lds
  s_add_u32 m0, s41, 15360
  s_add_u32 s42, s52, 2433024
  buffer_load_dwordx4 v12, s[8:11], s42 offen lds
  ds_read_b64_tr_b16 a[192:193], v4 offset:16384
  ds_read_b64_tr_b16 a[194:195], v4 offset:18432
  ds_read_b64_tr_b16 a[196:197], v4 offset:20480
  ds_read_b64_tr_b16 a[198:199], v4 offset:22528
  ds_read_b64_tr_b16 a[208:209], v5 offset:16384
  ds_read_b64_tr_b16 a[210:211], v5 offset:18432
  ds_read_b64_tr_b16 a[212:213], v5 offset:20480
  ds_read_b64_tr_b16 a[214:215], v5 offset:22528
  ds_read_b64_tr_b16 a[224:225], v6 offset:16384
  ds_read_b64_tr_b16 a[226:227], v6 offset:18432
  ds_read_b64_tr_b16 a[228:229], v6 offset:20480
  ds_read_b64_tr_b16 a[230:231], v6 offset:22528
  ds_read_b64_tr_b16 a[240:241], v7 offset:16384
  ds_read_b64_tr_b16 a[242:243], v7 offset:18432
  ds_read_b64_tr_b16 a[244:245], v7 offset:20480
  ds_read_b64_tr_b16 a[246:247], v7 offset:22528
  s_waitcnt vmcnt(16) lgkmcnt(0)
  s_barrier
  s_add_u32 m0, s41, 16384
  s_add_u32 s42, s53, 4194304
  buffer_load_dwordx4 v12, s[8:11], s42 offen lds
  s_add_u32 m0, s41, 17408
  s_add_u32 s42, s53, 4259840
  buffer_load_dwordx4 v12, s[8:11], s42 offen lds
  s_add_u32 m0, s41, 18432
  s_add_u32 s42, s53, 4202496
  buffer_load_dwordx4 v12, s[8:11], s42 offen lds
  s_add_u32 m0, s41, 19456
  s_add_u32 s42, s53, 4268032
  buffer_load_dwordx4 v12, s[8:11], s42 offen lds
  s_add_u32 m0, s41, 20480
  s_add_u32 s42, s53, 4456448
  buffer_load_dwordx4 v12, s[8:11], s42 offen lds
  s_add_u32 m0, s41, 21504
  s_add_u32 s42, s53, 4521984
  buffer_load_dwordx4 v12, s[8:11], s42 offen lds
  s_add_u32 m0, s41, 22528
  s_add_u32 s42, s53, 4464640
  buffer_load_dwordx4 v12, s[8:11], s42 offen lds
  s_add_u32 m0, s41, 23552
  s_add_u32 s42, s53, 4530176
  buffer_load_dwordx4 v12, s[8:11], s42 offen lds
  ds_read_b64_tr_b16 a[200:201], v4 offset:24576
  ds_read_b64_tr_b16 a[202:203], v4 offset:26624
  ds_read_b64_tr_b16 a[204:205], v4 offset:28672
  ds_read_b64_tr_b16 a[206:207], v4 offset:30720
  ds_read_b64_tr_b16 a[216:217], v5 offset:24576
  ds_read_b64_tr_b16 a[218:219], v5 offset:26624
  ds_read_b64_tr_b16 a[220:221], v5 offset:28672
  ds_read_b64_tr_b16 a[222:223], v5 offset:30720
  ds_read_b64_tr_b16 a[232:233], v6 offset:24576
  ds_read_b64_tr_b16 a[234:235], v6 offset:26624
  ds_read_b64_tr_b16 a[236:237], v6 offset:28672
  ds_read_b64_tr_b16 a[238:239], v6 offset:30720
  ds_read_b64_tr_b16 a[248:249], v7 offset:24576
  ds_read_b64_tr_b16 a[250:251], v7 offset:26624
  ds_read_b64_tr_b16 a[252:253], v7 offset:28672
  ds_read_b64_tr_b16 a[254:255], v7 offset:30720
  s_waitcnt vmcnt(16) lgkmcnt(0)
  s_barrier
  s_add_u32 m0, s41, 24576
  s_add_u32 s42, s53, 6291456
  buffer_load_dwordx4 v12, s[8:11], s42 offen lds
  s_add_u32 m0, s41, 25600
  s_add_u32 s42, s53, 6356992
  buffer_load_dwordx4 v12, s[8:11], s42 offen lds
  s_add_u32 m0, s41, 26624
  s_add_u32 s42, s53, 6299648
  buffer_load_dwordx4 v12, s[8:11], s42 offen lds
  s_add_u32 m0, s41, 27648
  s_add_u32 s42, s53, 6365184
  buffer_load_dwordx4 v12, s[8:11], s42 offen lds
  s_add_u32 m0, s41, 28672
  s_add_u32 s42, s53, 6553600
  buffer_load_dwordx4 v12, s[8:11], s42 offen lds
  s_add_u32 m0, s41, 29696
  s_add_u32 s42, s53, 6619136
  buffer_load_dwordx4 v12, s[8:11], s42 offen lds
  s_add_u32 m0, s41, 30720
  s_add_u32 s42, s53, 6561792
  buffer_load_dwordx4 v12, s[8:11], s42 offen lds
  s_add_u32 m0, s41, 31744
  s_add_u32 s42, s53, 6627328
  buffer_load_dwordx4 v12, s[8:11], s42 offen lds
  ds_read_b64_tr_b16 v[20:21], v4 offset:0
  ds_read_b64_tr_b16 v[22:23], v4 offset:2048
  ds_read_b64_tr_b16 v[24:25], v4 offset:4096
  ds_read_b64_tr_b16 v[26:27], v4 offset:6144
  ds_read_b64_tr_b16 v[28:29], v5 offset:0
  ds_read_b64_tr_b16 v[30:31], v5 offset:2048
  ds_read_b64_tr_b16 v[32:33], v5 offset:4096
  ds_read_b64_tr_b16 v[34:35], v5 offset:6144
  ds_read_b64_tr_b16 v[36:37], v6 offset:0
  ds_read_b64_tr_b16 v[38:39], v6 offset:2048
  ds_read_b64_tr_b16 v[40:41], v6 offset:4096
  ds_read_b64_tr_b16 v[42:43], v6 offset:6144
  ds_read_b64_tr_b16 v[44:45], v7 offset:0
  ds_read_b64_tr_b16 v[46:47], v7 offset:2048
  ds_read_b64_tr_b16 v[48:49], v7 offset:4096
  ds_read_b64_tr_b16 v[50:51], v7 offset:6144
  s_waitcnt lgkmcnt(0)
  s_barrier
  ds_write_b128 v85, v[20:23] offset:0
  ds_write_b128 v85, v[24:27] offset:1024
  ds_write_b128 v85, v[28:31] offset:2048
  ds_write_b128 v85, v[32:35] offset:3072
  ds_write_b128 v85, v[36:39] offset:4096
  ds_write_b128 v85, v[40:43] offset:5120
  ds_write_b128 v85, v[44:47] offset:6144
  ds_write_b128 v85, v[48:51] offset:7168
  s_waitcnt vmcnt(16) lgkmcnt(0)
  s_barrier
  ds_read_b64_tr_b16 v[20:21], v4 offset:8192
  ds_read_b64_tr_b16 v[22:23], v4 offset:10240
  ds_read_b64_tr_b16 v[24:25], v4 offset:12288
  ds_read_b64_tr_b16 v[26:27], v4 offset:14336
  ds_read_b64_tr_b16 v[28:29], v5 offset:8192
  ds_read_b64_tr_b16 v[30:31], v5 offset:10240
  ds_read_b64_tr_b16 v[32:33], v5 offset:12288
  ds_read_b64_tr_b16 v[34:35], v5 offset:14336
  ds_read_b64_tr_b16 v[36:37], v6 offset:8192
  ds_read_b64_tr_b16 v[38:39], v6 offset:10240
  ds_read_b64_tr_b16 v[40:41], v6 offset:12288
  ds_read_b64_tr_b16 v[42:43], v6 offset:14336
  ds_read_b64_tr_b16 v[44:45], v7 offset:8192
  ds_read_b64_tr_b16 v[46:47], v7 offset:10240
  ds_read_b64_tr_b16 v[48:49], v7 offset:12288
  ds_read_b64_tr_b16 v[50:51], v7 offset:14336
  s_waitcnt lgkmcnt(0)
  s_barrier
  ds_write_b128 v85, v[20:23] offset:8192
  ds_write_b128 v85, v[24:27] offset:9216
  ds_write_b128 v85, v[28:31] offset:10240
  ds_write_b128 v85, v[32:35] offset:11264
  ds_write_b128 v85, v[36:39] offset:12288
  ds_write_b128 v85, v[40:43] offset:13312
  ds_write_b128 v85, v[44:47] offset:14336
  ds_write_b128 v85, v[48:51] offset:15360
  s_waitcnt vmcnt(8) lgkmcnt(0)
  s_barrier
  ds_read_b64_tr_b16 v[20:21], v4 offset:16384
  ds_read_b64_tr_b16 v[22:23], v4 offset:18432
  ds_read_b64_tr_b16 v[24:25], v4 offset:20480
  ds_read_b64_tr_b16 v[26:27], v4 offset:22528
  ds_read_b64_tr_b16 v[28:29], v5 offset:16384
  ds_read_b64_tr_b16 v[30:31], v5 offset:18432
  ds_read_b64_tr_b16 v[32:33], v5 offset:20480
  ds_read_b64_tr_b16 v[34:35], v5 offset:22528
  ds_read_b64_tr_b16 v[36:37], v6 offset:16384
  ds_read_b64_tr_b16 v[38:39], v6 offset:18432
  ds_read_b64_tr_b16 v[40:41], v6 offset:20480
  ds_read_b64_tr_b16 v[42:43], v6 offset:22528
  ds_read_b64_tr_b16 v[44:45], v7 offset:16384
  ds_read_b64_tr_b16 v[46:47], v7 offset:18432
  ds_read_b64_tr_b16 v[48:49], v7 offset:20480
  ds_read_b64_tr_b16 v[50:51], v7 offset:22528
  s_waitcnt lgkmcnt(0)
  s_barrier
  ds_write_b128 v85, v[20:23] offset:16384
  ds_write_b128 v85, v[24:27] offset:17408
  ds_write_b128 v85, v[28:31] offset:18432
  ds_write_b128 v85, v[32:35] offset:19456
  ds_write_b128 v85, v[36:39] offset:20480
  ds_write_b128 v85, v[40:43] offset:21504
  ds_write_b128 v85, v[44:47] offset:22528
  ds_write_b128 v85, v[48:51] offset:23552
  s_waitcnt vmcnt(0) lgkmcnt(0)
  s_barrier
  ds_read_b64_tr_b16 v[20:21], v4 offset:24576
  ds_read_b64_tr_b16 v[22:23], v4 offset:26624
  ds_read_b64_tr_b16 v[24:25], v4 offset:28672
  ds_read_b64_tr_b16 v[26:27], v4 offset:30720
  ds_read_b64_tr_b16 v[28:29], v5 offset:24576
  ds_read_b64_tr_b16 v[30:31], v5 offset:26624
  ds_read_b64_tr_b16 v[32:33], v5 offset:28672
  ds_read_b64_tr_b16 v[34:35], v5 offset:30720
  ds_read_b64_tr_b16 v[36:37], v6 offset:24576
  ds_read_b64_tr_b16 v[38:39], v6 offset:26624
  ds_read_b64_tr_b16 v[40:41], v6 offset:28672
  ds_read_b64_tr_b16 v[42:43], v6 offset:30720
  ds_read_b64_tr_b16 v[44:45], v7 offset:24576
  ds_read_b64_tr_b16 v[46:47], v7 offset:26624
  ds_read_b64_tr_b16 v[48:49], v7 offset:28672
  ds_read_b64_tr_b16 v[50:51], v7 offset:30720
  s_waitcnt lgkmcnt(0)
  s_barrier
  ds_write_b128 v85, v[20:23] offset:24576
  ds_write_b128 v85, v[24:27] offset:25600
  ds_write_b128 v85, v[28:31] offset:26624
  ds_write_b128 v85, v[32:35] offset:27648
  ds_write_b128 v85, v[36:39] offset:28672
  ds_write_b128 v85, v[40:43] offset:29696
  ds_write_b128 v85, v[44:47] offset:30720
  ds_write_b128 v85, v[48:51] offset:31744
  s_waitcnt lgkmcnt(0)
  s_getreg_b32 s55, hwreg(HW_REG_XCC_ID)
  s_and_b32 s55, s55, 15
  v_min_u32 v76, 63, v0
  v_lshlrev_b32 v76, 7, v76
  v_add_u32 v76, 1424384, v76
  s_nop 1
Lpoll_157:
  buffer_load_dword v77, v76, s[4:7], 0 offen sc1
  s_sub_u32 s24, s24, 1
  s_cbranch_scc1 L_FAIL
  s_waitcnt vmcnt(0)
  v_cmp_gt_i32 vcc, 0, v77
  s_cbranch_vccz Lpolld_158
  s_sleep 1
  s_branch Lpoll_157
Lpolld_158:
  v_and_b32 v78, 15, v77
  v_cmp_ne_u32 vcc, s55, v78
  s_lshl_b32 s40, s54, 4
  s_lshl_b32 s40, 0xffff, s40
  s_or_b32 s41, vcc_lo, vcc_hi
  s_and_b32 s40, s40, s41
  s_cselect_b32 s36, 0, 8192
  v_lshrrev_b32 v77, 8, v77
  v_and_b32 v78, 3, v0
  v_lshl_or_b32 v77, v77, 2, v78
  s_nop 1
  v_min_u32_dpp v77, v77, v77 row_ror:8 row_mask:0xf bank_mask:0xf
  s_nop 1
  v_min_u32_dpp v77, v77, v77 row_ror:4 row_mask:0xf bank_mask:0xf
  v_mov_b32 v78, v77
  s_nop 1
  v_permlane16_swap_b32 v78, v77
  v_min_u32 v77, v77, v78
  v_mov_b32 v78, v77
  s_nop 1
  v_permlane32_swap_b32 v78, v77
  v_min_u32 v77, v77, v78
  s_nop 1
  v_min_u32_dpp v77, v77, v77 row_ror:2 row_mask:0xf bank_mask:0xf
  s_nop 1
  v_min_u32_dpp v77, v77, v77 row_ror:1 row_mask:0xf bank_mask:0xf
  s_nop 0
  v_readfirstlane_b32 s26, v77
  s_and_b32 s26, s26, 3
  s_lshl_b32 s26, s26, 13
  s_lshr_b32 s40, s20, 1
  s_mul_i32 s40, s40, 32768
  s_and_b32 s41, s20, 1
  s_lshl_b32 s41, s41, 10
  s_add_u32 s40, s40, s41
  s_lshl_b32 s41, s54, 12
  s_add_u32 s40, s40, s41
  v_lshl_add_u32 v86, v0, 4, s40
  v_xor_b32 v87, 0x1000, v86
  v_and_b32 v76, 2, v0
  v_cmp_eq_u32 vcc, 0, v76
  v_mov_b32 v76, 0xeeee
  v_mov_b32 v77, 0x4444
  v_cndmask_b32 v88, v76, v77, vcc
  s_lshr_b32 s40, s21, 2
  s_mul_i32 s40, s40, 32768
  s_and_b32 s41, s21, 3
  s_lshl_b32 s41, s41, 11
  s_add_u32 s47, s40, s41
  s_lshl_b32 s41, s20, 9
  s_add_u32 s47, s47, s41
  v_lshl_add_u32 v92, v0, 3, s47
  s_lshl_b32 s41, s54, 12
  s_add_u32 s40, s41, 1310720
  s_add_u32 s40, s40, s26
  v_lshrrev_b32 v76, 2, v0
  v_lshl_add_u32 v76, v76, 7, s40
  v_and_b32 v77, 3, v0
  v_lshl_add_u32 v90, v77, 2, v76
  s_mov_b32 s57, s40
  s_cmp_eq_u32 s36, 0
  s_cselect_b32 s56, 1, s20
  s_and_b32 s41, s21, 15
  s_lshl_b32 s41, s41, 7
  s_lshl_b32 s40, s20, 2
  s_add_u32 s40, s40, s41
  s_add_u32 s40, s40, 2048
  s_mov_b32 s25, 0
  s_mov_b32 s60, 0
  s_mov_b32 s61, 0
  s_mov_b32 s51, -1
  v_mov_b32 v91, 2147483392
  s_mov_b64 exec, 1
  v_mov_b32 v91, s40
  s_mov_b64 exec, -1
  v_mov_b32 v80, -1
  v_mov_b32 v81, -1
  v_mov_b32 v82, -1
  v_mov_b32 v83, -1
  v_mov_b32 v112, 0
  v_mov_b32 v113, 0
  v_mov_b32 v114, 0
  v_mov_b32 v115, 0
  v_mov_b32 v116, 0
  v_mov_b32 v117, 0
  v_mov_b32 v118, 0
  v_mov_b32 v119, 0
  v_mov_b32 v120, 0
  v_mov_b32 v121, 0
  v_mov_b32 v106, 0
  v_mov_b32 v107, 0
  v_mov_b32 v108, 0x3f803f80
  v_mov_b32 v109, 0x3f803f80
  v_mov_b32 v110, 0x3f803f80
  v_mov_b32 v111, 0x3f803f80
  v_lshlrev_b32 v95, 4, v0
  s_lshl_b32 s58, s20, 12
  s_add_u32 s40, s58, 149504
  s_add_u32 s58, s58, 131072
  v_lshrrev_b32 v76, 4, v0
  v_bfe_u32 v77, v0, 2, 2
  v_xor_b32 v77, v76, v77
  v_lshl_add_u32 v123, v77, 3, s40
  v_and_b32 v77, 15, v0
  v_lshl_add_u32 v123, v77, 5, v123
  v_xor_b32 v76, v76, v0
  v_lshl_add_u32 v124, v76, 3, s40
  v_bfe_u32 v76, v0, 4, 1
  v_lshlrev_b32 v76, 1, v76
  v_and_b32 v77, 13, v0
  v_or_b32 v76, v76, v77
  v_lshl_add_u32 v122, v76, 4, s47
  v_lshrrev_b32 v76, 5, v0
  v_lshl_add_u32 v122, v76, 8, v122
  v_and_b32 v76, 2, v0
  v_cmp_eq_u32 vcc, 0, v76
  v_mov_b32 v77, 2147483392
  s_nop 0
  v_cndmask_b32 v122, v122, v77, vcc
  s_lshl_b32 s43, s21, 2
  s_add_u32 s43, s43, s20
  s_and_b32 s49, s20, 1
  s_lshl_b32 s49, s49, 10
  s_mul_i32 s32, s21, 65536
  s_lshl_b32 s40, s20, 11
  s_add_u32 s32, s32, s40
  s_and_b32 s40, s26, 0x2000
  s_xor_b32 s40, s40, 20971520
  s_add_u32 s32, s32, s40
  s_add_u32 s30, s32, s49
  s_add_u32 s30, s30, 49152
  s_lshr_b32 s59, s21, 1
  s_lshl_b32 s59, s59, 7
  s_add_u32 s59, s59, 1396736
  s_lshl_b32 s62, s21, 7
  s_add_u32 s62, s62, 1404928
  s_mov_b32 s38, 0x3e0293ee
  s_mov_b32 s39, s38
  v_xor_b32 v125, 4096, v124
  v_xor_b32 v126, 8192, v124
  v_xor_b32 v127, 12288, v124
  v_readfirstlane_b32 s88, v86
  s_xor_b32 s41, s47, 131072
  v_min_u32 v76, 3, v0
  v_lshl_add_u32 v87, v76, 7, s41
  v_lshrrev_b32 v76, 4, v0
  v_lshlrev_b32 v76, 2, v76
  v_and_b32 v77, 15, v0
  v_sub_u32 v76, v77, v76
  s_lshr_b32 s41, s49, 6
  v_add_u32 v76, s41, v76
  v_and_b32 v92, 0xfffffdff, v92
  v_mov_b32 v86, 0xd028965f
  v_cmp_le_i32 s[8:9], 0, v76
  v_cmp_le_i32 s[10:11], 1, v76
  v_cmp_le_i32 s[16:17], 2, v76
  v_cmp_le_i32 s[18:19], 3, v76
  v_cmp_le_i32 s[42:43], 16, v76
  v_cmp_le_i32 s[100:101], 17, v76
  v_cmp_le_i32 s[52:53], 18, v76
  v_cmp_le_i32 s[54:55], 19, v76
  s_xor_b32 s89, s88, 1024
  s_xor_b32 s90, s88, 32768
  s_xor_b32 s91, s88, 33792
  v_lshrrev_b32 v76, 4, v0
  v_lshl_add_u32 v76, v76, 7, s57
  v_and_b32 v77, 15, v0
  v_lshl_add_u32 v90, v77, 2, v76
  s_mov_b32 s25, 0
  s_add_u32 s27, s25, 32
  s_and_b32 s40, s27, 0x28
  s_mul_i32 s40, s40, 0x900
  s_and_b32 s40, s40, 0x6000
  s_xor_b32 s40, s40, s26
  s_lshl_b32 s27, s27, 16
  s_add_u32 s27, s27, s40
  s_lshl_b32 s37, s36, 1
  s_xor_b32 s37, s27, s37
  s_and_b32 s40, s25, 3
  s_lshl_b32 s40, s40, 18
  s_add_u32 s28, s40, s26
  s_lshr_b32 s40, s40, 5
  s_and_b32 s40, s40, 0x4000
  s_xor_b32 s28, s28, s40
  s_xor_b32 s29, s28, 0x4000
  s_xor_b32 s40, s28, 8192
  buffer_load_dword v89, v122, s[4:7], s40 offen sc1
  s_mov_b32 s25, 1
  s_add_u32 s27, s25, 32
  s_and_b32 s40, s27, 0x28
  s_mul_i32 s40, s40, 0x900
  s_and_b32 s40, s40, 0x6000
  s_xor_b32 s40, s40, s26
  s_lshl_b32 s27, s27, 16
  s_add_u32 s27, s27, s40
  s_lshl_b32 s37, s36, 1
  s_xor_b32 s37, s27, s37
  s_and_b32 s40, s25, 3
  s_lshl_b32 s40, s40, 18
  s_add_u32 s28, s40, s26
  s_lshr_b32 s40, s40, 5
  s_and_b32 s40, s40, 0x4000
  s_xor_b32 s28, s28, s40
  s_xor_b32 s29, s28, 0x4000
  s_xor_b32 s40, s28, 8192
  buffer_load_dword v89, v122, s[4:7], s40 offen sc1
  s_mov_b32 s25, 2
  s_add_u32 s27, s25, 32
  s_and_b32 s40, s27, 0x28
  s_mul_i32 s40, s40, 0x900
  s_and_b32 s40, s40, 0x6000
  s_xor_b32 s40, s40, s26
  s_lshl_b32 s27, s27, 16
  s_add_u32 s27, s27, s40
  s_lshl_b32 s37, s36, 1
  s_xor_b32 s37, s27, s37
  s_and_b32 s40, s25, 3
  s_lshl_b32 s40, s40, 18
  s_add_u32 s28, s40, s26
  s_lshr_b32 s40, s40, 5
  s_and_b32 s40, s40, 0x4000
  s_xor_b32 s28, s28, s40
  s_xor_b32 s29, s28, 0x4000
  s_xor_b32 s40, s28, 8192
  buffer_load_dword v89, v122, s[4:7], s40 offen sc1
  s_mov_b32 s25, 3
  s_add_u32 s27, s25, 32
  s_and_b32 s40, s27, 0x28
  s_mul_i32 s40, s40, 0x900
  s_and_b32 s40, s40, 0x6000
  s_xor_b32 s40, s40, s26
  s_lshl_b32 s27, s27, 16
  s_add_u32 s27, s27, s40
  s_lshl_b32 s37, s36, 1
  s_xor_b32 s37, s27, s37
  s_and_b32 s40, s25, 3
  s_lshl_b32 s40, s40, 18
  s_add_u32 s28, s40, s26
  s_lshr_b32 s40, s40, 5
  s_and_b32 s40, s40, 0x4000
  s_xor_b32 s28, s28, s40
  s_xor_b32 s29, s28, 0x4000
  s_xor_b32 s40, s28, 8192
  buffer_load_dword v89, v122, s[4:7], s40 offen sc1
  buffer_load_dword v89, v90, s[4:7], 0 offen offset:0 sc1
  s_mov_b32 s25, 0
  s_mov_b32 s33, 1
  s_mov_b64 s[44:45], 0
  s_mov_b64 s[46:47], 0
  s_cmp_lg_u32 s20, 1
  s_cbranch_scc1 Lskip_161
Lask_159:
  s_min_i32 s50, s44, s45
  s_min_i32 s50, s50, s46
  s_min_i32 s50, s50, s47
  s_cmp_ge_i32 s50, s33
  s_cbranch_scc1 Lhave_160
  s_load_dwordx4 s[44:47], s[4:5], s59 glc
  s_sub_u32 s24, s24, 1
  s_cbranch_scc1 L_FAIL
  s_waitcnt lgkmcnt(0)
  s_branch Lask_159
Lhave_160:
  s_add_u32 s33, s33, 2
  s_min_u32 s33, s33, 64
  s_cmp_ge_i32 s50, s33
  s_cbranch_scc1 Lskip_161
  s_load_dwordx4 s[44:47], s[4:5], s59 glc
Lskip_161:
  s_barrier
  s_add_u32 m0, s58, 16384
  s_add_u32 s31, s32, 16384
  buffer_load_dwordx4 v95, s[4:7], s31 offen offset:0 sc1 lds
  buffer_load_dwordx4 v95, s[4:7], s31 offen offset:1024 sc1 lds
  s_add_u32 m0, s58, 2048
  s_add_u32 s31, s32, 32768
  buffer_load_dwordx4 v95, s[4:7], s31 offen offset:0 sc1 lds
  buffer_load_dwordx4 v95, s[4:7], s31 offen offset:1024 sc1 lds
  s_mov_b32 m0, s58
  s_add_u32 s31, s32, s49
  buffer_load_dwordx4 v95, s[4:7], s31 offen offset:0 sc1 lds
  s_sub_u32 s31, s32, s49
  buffer_load_dwordx4 v95, s[4:7], s31 offen offset:1024 sc1 lds
  s_add_u32 s27, s25, 32
  s_and_b32 s40, s27, 0x28
  s_mul_i32 s40, s40, 0x900
  s_and_b32 s40, s40, 0x6000
  s_xor_b32 s40, s40, s26
  s_lshl_b32 s27, s27, 16
  s_add_u32 s27, s27, s40
  s_lshl_b32 s37, s36, 1
  s_xor_b32 s37, s27, s37
  s_and_b32 s40, s25, 3
  s_lshl_b32 s40, s40, 18
  s_add_u32 s28, s40, s26
  s_lshr_b32 s40, s40, 5
  s_and_b32 s40, s40, 0x4000
  s_xor_b32 s28, s28, s40
  s_xor_b32 s29, s28, 0x4000
  s_xor_b32 s34, s28, 0x84000
  s_xor_b32 s48, s28, 8192
  s_lshr_b32 s40, s49, 1
  s_add_u32 s29, s29, s40
  s_xor_b32 s35, s29, 512
  s_add_u32 s92, s37, s88
  s_add_u32 s96, s27, s88
  s_xor_b32 s96, s96, 0x1000
  s_add_u32 s93, s37, s89
  s_add_u32 s97, s27, s89
  s_xor_b32 s97, s97, 0x1000
  s_add_u32 s94, s37, s90
  s_add_u32 s98, s27, s90
  s_xor_b32 s98, s98, 0x1000
  s_add_u32 s95, s37, s91
  s_add_u32 s99, s27, s91
  s_xor_b32 s99, s99, 0x1000
L_QK_top:
  v_mov_b32 v94, s25
  v_mov_b64 v[52:53], 0
  v_mov_b64 v[54:55], 0
  v_mov_b64 v[56:57], 0
  v_mov_b64 v[58:59], 0
  v_mov_b64 v[60:61], 0
  v_mov_b64 v[62:63], 0
  v_mov_b64 v[64:65], 0
  v_mov_b64 v[66:67], 0
  ds_read_b128 v[20:23], v85 offset:0
  ds_read_b128 v[24:27], v85 offset:1024
  ds_read_b128 v[28:31], v85 offset:8192
  ds_read_b128 v[32:35], v85 offset:9216
  ds_read_b128 v[36:39], v85 offset:2048
  ds_read_b128 v[40:43], v85 offset:3072
  ds_read_b128 v[44:47], v85 offset:10240
  ds_read_b128 v[48:51], v85 offset:11264
  s_waitcnt lgkmcnt(0)
  s_and_b32 s40, s25, 63
  s_cselect_b32 s40, s56, 1
  s_cmp_lg_u32 s40, 0
  s_cbranch_scc1 L_QK_park
  v_mov_b32 v76, -1
  s_sleep 4
L_QK_spin:
  s_sub_u32 s24, s24, 1
  s_cbranch_scc1 L_FAIL
  s_nop 0
  s_waitcnt vmcnt(40)
  buffer_load_dword v76, v90, s[4:7], 0 offen sc1
  s_nop 3
  v_cmp_gt_i32_e64 vcc, s25, v76
  s_cbranch_vccz L_QK_rel
  buffer_load_dword v76, v90, s[4:7], 0 offen sc1
  s_nop 3
  v_cmp_gt_i32 vcc, s25, v76
  s_cbranch_vccz L_QK_rel
  buffer_load_dword v76, v90, s[4:7], 0 offen sc1
  s_nop 3
  v_cmp_gt_i32 vcc, s25, v76
  s_cbranch_vccz L_QK_rel
  buffer_load_dword v76, v90, s[4:7], 0 offen sc1
  s_nop 3
  v_cmp_gt_i32_e64 vcc, s25, v76
  s_cbranch_vccnz L_QK_spin
L_QK_rel:
  s_barrier
  s_mov_b64 exec, -1
L_QK_go:
L_QKM_again:
  buffer_load_dwordx4 v[4:7], v95, s[4:7], s92 offen offset:0
  s_nop 0
  buffer_load_dwordx4 v[8:11], v95, s[4:7], s92 offen offset:2048
  s_nop 0
  buffer_load_dwordx4 v[12:15], v95, s[4:7], s93 offen offset:0
  s_nop 0
  buffer_load_dwordx4 v[16:19], v95, s[4:7], s93 offen offset:2048
  s_nop 0
  buffer_load_dwordx4 v[68:71], v95, s[4:7], s94 offen offset:0
  s_nop 0
  ds_read_b128 v[96:99], v1 offset:2048
  ds_read_b128 v[100:103], v1 offset:3072
  s_cmp_lg_u32 s20, 0
  s_nop 0
  s_cbranch_scc1 L_QK_sigd
  s_mov_b32 s63, s25
  s_waitcnt vmcnt(5)
  s_atomic_smax s63, s[4:5], s62 glc
L_QK_sigd:
  s_waitcnt vmcnt(4)
  v_cmp_eq_u32_e64 vcc, -1, v4
  s_cbranch_vccnz L_QKM_g0
L_QKM_ok0:
  v_smfmac_f32_16x16x64_bf16 v[52:55], v[4:7], a[0:7], v88
  buffer_load_dwordx4 v[72:75], v95, s[4:7], s94 offen offset:2048
  v_smfmac_f32_16x16x64_bf16 v[60:63], v[4:7], v[128:135], v88
  s_waitcnt vmcnt(4)
  v_cmp_eq_u32 vcc, -1, v8
  v_smfmac_f32_16x16x64_bf16 v[56:59], v[4:7], a[128:135], v88
  v_smfmac_f32_16x16x64_bf16 v[64:67], v[4:7], v[20:27], v88
  s_cbranch_vccnz L_QKM_g1
L_QKM_ok1:
  v_smfmac_f32_16x16x64_bf16 v[52:55], v[8:11], a[8:15], v88
  buffer_load_dwordx4 v[4:7], v95, s[4:7], s95 offen offset:0
  ds_read_b128 v[20:23], v85 offset:4096
  v_smfmac_f32_16x16x64_bf16 v[60:63], v[8:11], v[136:143], v88
  s_nop 0
  s_waitcnt vmcnt(4)
  v_cmp_eq_u32_e64 vcc, -1, v12
  v_smfmac_f32_16x16x64_bf16 v[56:59], v[8:11], a[136:143], v88
  ds_read_b128 v[24:27], v85 offset:5120
  v_smfmac_f32_16x16x64_bf16 v[64:67], v[8:11], v[28:35], v88
  s_cbranch_vccnz L_QKM_g2
L_QKM_ok2:
  v_smfmac_f32_16x16x64_bf16 v[52:55], v[12:15], a[16:23], v88
  buffer_load_dwordx4 v[8:11], v95, s[4:7], s95 offen offset:2048
  ds_read_b128 v[28:31], v85 offset:12288
  v_smfmac_f32_16x16x64_bf16 v[60:63], v[12:15], v[144:151], v88
  s_waitcnt vmcnt(4)
  v_cmp_eq_u32 vcc, -1, v16
  v_smfmac_f32_16x16x64_bf16 v[56:59], v[12:15], a[144:151], v88
  ds_read_b128 v[32:35], v85 offset:13312
  v_smfmac_f32_16x16x64_bf16 v[64:67], v[12:15], v[36:43], v88
  s_cbranch_vccnz L_QKM_g3
L_QKM_ok3:
  v_smfmac_f32_16x16x64_bf16 v[52:55], v[16:19], a[24:31], v88
  buffer_load_dwordx4 v[12:15], v95, s[4:7], s96 offen offset:0
  ds_read_b128 v[36:39], v85 offset:6144
  v_smfmac_f32_16x16x64_bf16 v[60:63], v[16:19], v[152:159], v88
  s_waitcnt vmcnt(4)
  v_cmp_eq_u32 vcc, -1, v68
  v_smfmac_f32_16x16x64_bf16 v[56:59], v[16:19], a[152:159], v88
  ds_read_b128 v[40:43], v85 offset:7168
  v_smfmac_f32_16x16x64_bf16 v[64:67], v[16:19], v[44:51], v88
  s_cbranch_vccnz L_QKM_g4
L_QKM_ok4:
  v_smfmac_f32_16x16x64_bf16 v[52:55], v[68:71], a[32:39], v88
  buffer_load_dwordx4 v[16:19], v95, s[4:7], s96 offen offset:2048
  ds_read_b128 v[44:47], v85 offset:14336
  v_smfmac_f32_16x16x64_bf16 v[60:63], v[68:71], v[160:167], v88
  s_waitcnt vmcnt(4)
  v_cmp_eq_u32 vcc, -1, v72
  v_smfmac_f32_16x16x64_bf16 v[56:59], v[68:71], a[160:167], v88
  ds_read_b128 v[48:51], v85 offset:15360
  s_waitcnt lgkmcnt(6)
  v_smfmac_f32_16x16x64_bf16 v[64:67], v[68:71], v[20:27], v88
  s_cbranch_vccnz L_QKM_g5
L_QKM_ok5:
  v_smfmac_f32_16x16x64_bf16 v[52:55], v[72:75], a[40:47], v88
  buffer_load_dwordx4 v[68:71], v95, s[4:7], s97 offen offset:0
  ds_read_b128 v[20:23], v85 offset:16384
  v_smfmac_f32_16x16x64_bf16 v[60:63], v[72:75], v[168:175], v88
  s_waitcnt vmcnt(4)
  v_cmp_eq_u32_e64 vcc, -1, v4
  v_smfmac_f32_16x16x64_bf16 v[56:59], v[72:75], a[168:175], v88
  ds_read_b128 v[24:27], v85 offset:17408
  s_nop 0
  s_waitcnt lgkmcnt(6)
  v_smfmac_f32_16x16x64_bf16 v[64:67], v[72:75], v[28:35], v88
  s_cbranch_vccnz L_QKM_g6
L_QKM_ok6:
  v_smfmac_f32_16x16x64_bf16 v[52:55], v[4:7], a[48:55], v88
  buffer_load_dwordx4 v[72:75], v95, s[4:7], s97 offen offset:2048
  ds_read_b128 v[28:31], v85 offset:24576
  v_smfmac_f32_16x16x64_bf16 v[60:63], v[4:7], v[176:183], v88
  s_waitcnt vmcnt(4)
  v_cmp_eq_u32 vcc, -1, v8
  v_smfmac_f32_16x16x64_bf16 v[56:59], v[4:7], a[176:183], v88
  ds_read_b128 v[32:35], v85 offset:25600
  s_waitcnt lgkmcnt(6)
  v_smfmac_f32_16x16x64_bf16 v[64:67], v[4:7], v[36:43], v88
  s_cbranch_vccnz L_QKM_g7
L_QKM_ok7:
  v_smfmac_f32_16x16x64_bf16 v[52:55], v[8:11], a[56:63], v88
  buffer_load_dwordx4 v[4:7], v95, s[4:7], s98 offen offset:0
  ds_read_b128 v[36:39], v85 offset:18432
  v_smfmac_f32_16x16x64_bf16 v[60:63], v[8:11], v[184:191], v88
  s_waitcnt vmcnt(4)
  v_cmp_eq_u32 vcc, -1, v12
  v_smfmac_f32_16x16x64_bf16 v[56:59], v[8:11], a[184:191], v88
  ds_read_b128 v[40:43], v85 offset:19456
  s_waitcnt lgkmcnt(6)
  v_smfmac_f32_16x16x64_bf16 v[64:67], v[8:11], v[44:51], v88
  s_cbranch_vccnz L_QKM_g8
L_QKM_ok8:
  v_smfmac_f32_16x16x64_bf16 v[52:55], v[12:15], a[64:71], v88
  buffer_load_dwordx4 v[8:11], v95, s[4:7], s98 offen offset:2048
  ds_read_b128 v[44:47], v85 offset:26624
  v_smfmac_f32_16x16x64_bf16 v[60:63], v[12:15], v[192:199], v88
  s_waitcnt vmcnt(4)
  v_cmp_eq_u32_e64 vcc, -1, v16
  v_smfmac_f32_16x16x64_bf16 v[56:59], v[12:15], a[192:199], v88
  ds_read_b128 v[48:51], v85 offset:27648
  s_nop 0
  s_waitcnt lgkmcnt(6)
  v_smfmac_f32_16x16x64_bf16 v[64:67], v[12:15], v[20:27], v88
  s_cbranch_vccnz L_QKM_g9
L_QKM_ok9:
  v_smfmac_f32_16x16x64_bf16 v[52:55], v[16:19], a[72:79], v88
  buffer_load_dwordx4 v[12:15], v95, s[4:7], s99 offen offset:0
  ds_read_b128 v[20:23], v85 offset:20480
  v_smfmac_f32_16x16x64_bf16 v[60:63], v[16:19], v[200:207], v88
  s_waitcnt vmcnt(4)
  v_cmp_eq_u32 vcc, -1, v68
  v_smfmac_f32_16x16x64_bf16 v[56:59], v[16:19], a[200:207], v88
  ds_read_b128 v[24:27], v85 offset:21504
  s_waitcnt lgkmcnt(6)
  v_smfmac_f32_16x16x64_bf16 v[64:67], v[16:19], v[28:35], v88
  s_cbranch_vccnz L_QKM_g10
L_QKM_ok10:
  v_smfmac_f32_16x16x64_bf16 v[52:55], v[68:71], a[80:87], v88
  buffer_load_dwordx4 v[16:19], v95, s[4:7], s99 offen offset:2048
  ds_read_b128 v[28:31], v85 offset:28672
  v_smfmac_f32_16x16x64_bf16 v[60:63], v[68:71], v[208:215], v88
  s_waitcnt vmcnt(4)
  v_cmp_eq_u32 vcc, -1, v72
  v_smfmac_f32_16x16x64_bf16 v[56:59], v[68:71], a[208:215], v88
  ds_read_b128 v[32:35], v85 offset:29696
  s_waitcnt lgkmcnt(6)
  v_smfmac_f32_16x16x64_bf16 v[64:67], v[68:71], v[36:43], v88
  s_cbranch_vccnz L_QKM_g11
L_QKM_ok11:
  v_smfmac_f32_16x16x64_bf16 v[52:55], v[72:75], a[88:95], v88
  ds_read_b128 v[36:39], v85 offset:22528
  v_smfmac_f32_16x16x64_bf16 v[60:63], v[72:75], v[216:223], v88
  s_waitcnt vmcnt(3)
  v_cmp_eq_u32 vcc, -1, v4
  v_smfmac_f32_16x16x64_bf16 v[56:59], v[72:75], a[216:223], v88
  ds_read_b128 v[40:43], v85 offset:23552
  s_waitcnt lgkmcnt(6)
  v_smfmac_f32_16x16x64_bf16 v[64:67], v[72:75], v[44:51], v88
  s_cbranch_vccnz L_QKM_g12
L_QKM_ok12:
  v_smfmac_f32_16x16x64_bf16 v[52:55], v[4:7], a[96:103], v88
  ds_read_b128 v[44:47], v85 offset:30720
  v_smfmac_f32_16x16x64_bf16 v[60:63], v[4:7], v[224:231], v88
  s_waitcnt vmcnt(2)
  v_cmp_eq_u32 vcc, -1, v8
  v_smfmac_f32_16x16x64_bf16 v[56:59], v[4:7], a[224:231], v88
  ds_read_b128 v[48:51], v85 offset:31744
  s_waitcnt lgkmcnt(6)
  v_smfmac_f32_16x16x64_bf16 v[64:67], v[4:7], v[20:27], v88
  s_cbranch_vccnz L_QKM_g13
L_QKM_ok13:
  v_smfmac_f32_16x16x64_bf16 v[52:55], v[8:11], a[104:111], v88
  ds_read_b128 v[20:23], v1 offset:16384
  ds_read_b128 v[24:27], v1 offset:17408
  v_smfmac_f32_16x16x64_bf16 v[60:63], v[8:11], v[232:239], v88
  s_waitcnt vmcnt(1)
  v_cmp_eq_u32_e64 vcc, -1, v12
  v_smfmac_f32_16x16x64_bf16 v[56:59], v[8:11], a[232:239], v88
  ds_read_b128 v[68:71], v84 offset:16384
  s_nop 0
  s_waitcnt lgkmcnt(7)
  v_smfmac_f32_16x16x64_bf16 v[64:67], v[8:11], v[28:35], v88
  s_cbranch_vccnz L_QKM_g14
L_QKM_ok14:
  v_smfmac_f32_16x16x64_bf16 v[52:55], v[12:15], a[112:119], v88
  ds_read_b128 v[28:31], v2 offset:16384
  ds_read_b128 v[32:35], v2 offset:17408
  v_smfmac_f32_16x16x64_bf16 v[60:63], v[12:15], v[240:247], v88
  s_waitcnt vmcnt(0)
  v_cmp_eq_u32 vcc, -1, v16
  v_smfmac_f32_16x16x64_bf16 v[56:59], v[12:15], a[240:247], v88
  ds_read_b128 v[72:75], v84 offset:17408
  s_waitcnt lgkmcnt(8)
  v_smfmac_f32_16x16x64_bf16 v[64:67], v[12:15], v[36:43], v88
  s_cbranch_vccnz L_QKM_g15
L_QKM_ok15:
  v_smfmac_f32_16x16x64_bf16 v[52:55], v[16:19], a[120:127], v88
  ds_read_b128 v[36:39], v3 offset:16384
  v_smfmac_f32_16x16x64_bf16 v[60:63], v[16:19], v[248:255], v88
  ds_read_b128 v[40:43], v3 offset:17408
  v_smfmac_f32_16x16x64_bf16 v[56:59], v[16:19], a[248:255], v88
  s_waitcnt lgkmcnt(8)
  v_smfmac_f32_16x16x64_bf16 v[64:67], v[16:19], v[44:51], v88
L_QKM_join:
  s_nop 1
  v_pk_add_f32 v[52:53], v[52:53], v[54:55]
  s_nop 0
  v_pk_add_f32 v[60:61], v[60:61], v[62:63]
  v_cmp_u_f32 vcc, v52, v53
  v_cvt_pk_bf16_f32 v77, v52, v53
  v_cvt_pk_bf16_f32 v76, v60, v61
  ds_write_b64 v123, v[76:77] offset:0
  v_pk_add_f32 v[56:57], v[56:57], v[58:59]
  v_pk_add_f32 v[64:65], v[64:65], v[66:67]
  v_cvt_pk_bf16_f32 v79, v56, v57
  v_cvt_pk_bf16_f32 v78, v64, v65
  ds_write_b64 v123, v[78:79] offset:512
  ds_read_b64_tr_b16 v[4:5], v124 offset:0
  ds_read_b64_tr_b16 v[6:7], v124 offset:512
  s_cbranch_vccnz L_QKM_nan
L_QKM_done:
  s_waitcnt lgkmcnt(2)
  s_barrier
  ds_read_b64_tr_b16 v[8:9], v125 offset:0
  ds_read_b64_tr_b16 v[10:11], v125 offset:512
  s_waitcnt lgkmcnt(2)
  v_mfma_f32_16x16x32_bf16 v[52:55], v[20:23], v[4:7], 0
  ds_read_b64_tr_b16 v[12:13], v126 offset:0
  ds_read_b64_tr_b16 v[14:15], v126 offset:512
  v_mfma_f32_16x16x32_bf16 v[56:59], v[24:27], v[4:7], 0
  ds_read_b64_tr_b16 v[16:17], v127 offset:0
  ds_read_b64_tr_b16 v[18:19], v127 offset:512
  v_mfma_f32_16x16x32_bf16 v[60:63], v[4:7], v[4:7], 0
  s_waitcnt lgkmcnt(4)
  v_mfma_f32_16x16x32_bf16 v[52:55], v[28:31], v[8:11], v[52:55]
  v_mfma_f32_16x16x32_bf16 v[56:59], v[32:35], v[8:11], v[56:59]
  v_mfma_f32_16x16x32_bf16 v[60:63], v[8:11], v[8:11], v[60:63]
  s_waitcnt lgkmcnt(2)
  v_mfma_f32_16x16x32_bf16 v[52:55], v[36:39], v[12:15], v[52:55]
  v_mfma_f32_16x16x32_bf16 v[56:59], v[40:43], v[12:15], v[56:59]
  v_mfma_f32_16x16x32_bf16 v[60:63], v[12:15], v[12:15], v[60:63]
  s_waitcnt lgkmcnt(0)
  v_mfma_f32_16x16x32_bf16 v[52:55], v[68:71], v[16:19], v[52:55]
  buffer_load_dwordx2 v[104:105], v92, s[4:7], s29 offen sc1
  v_mfma_f32_16x16x32_bf16 v[56:59], v[72:75], v[16:19], v[56:59]
  v_mfma_f32_16x16x32_bf16 v[60:63], v[16:19], v[16:19], v[60:63]
  s_mov_b32 vcc_lo, 0xcccccccc
  s_mov_b32 vcc_hi, 0xcccccccc
  v_mov_b32 v79, s38
  s_nop 1
  v_max3_f32 v64, v52, v53, v54
  s_nop 0
  v_max3_f32 v65, v55, v56, v57
  v_max3_f32 v64, v64, v58, v59
  v_max3_f32 v65, v65, v60, v61
  v_max_f32 v66, v64, v65
  v_max_f32 v67, v64, v65
  v_cndmask_b32_dpp v60, v61, v60, vcc quad_perm:[2,3,2,3] row_mask:0xf bank_mask:0xf
  v_cndmask_b32_dpp v52, v56, v52, vcc quad_perm:[2,3,2,3] row_mask:0xf bank_mask:0xf
  v_permlane16_swap_b32 v66, v67
  v_max_f32 v64, v66, v67
  v_max_f32 v65, v66, v67
  v_cndmask_b32_dpp v53, v57, v53, vcc quad_perm:[2,3,2,3] row_mask:0xf bank_mask:0xf
  v_cndmask_b32_dpp v54, v58, v54, vcc quad_perm:[2,3,2,3] row_mask:0xf bank_mask:0xf
  v_permlane32_swap_b32 v64, v65
  v_max_f32 v64, v64, v65
  v_cndmask_b32_dpp v55, v59, v55, vcc quad_perm:[2,3,2,3] row_mask:0xf bank_mask:0xf
  s_nop 0
  v_mul_f32_dpp v64, v64, v79 quad_perm:[2,3,2,3] row_mask:0xf bank_mask:0xf
  v_pk_fma_f32 v[52:53], v[52:53], s[38:39], v[64:65] op_sel_hi:[1,1,0] neg_lo:[0,0,1] neg_hi:[0,0,1]
  v_pk_fma_f32 v[54:55], v[54:55], s[38:39], v[64:65] op_sel_hi:[1,1,0] neg_lo:[0,0,1] neg_hi:[0,0,1]
  v_exp_f32 v52, v52
  v_exp_f32 v53, v53
  v_exp_f32 v54, v54
  v_cvt_pk_bf16_f32 v76, v52, v53
  v_exp_f32 v55, v55
  v_fma_f32 v60, v60, s38, -v64
  v_cvt_pk_bf16_f32 v77, v54, v55
  v_mov_b32_dpp v78, v76 quad_perm:[0,1,0,1] row_mask:0xf bank_mask:0xf
  v_exp_f32 v60, v60
  v_mov_b32_dpp v79, v77 quad_perm:[0,1,0,1] row_mask:0xf bank_mask:0xf
  s_nop 0
  v_mov_b32_dpp v61, v60 quad_perm:[0,1,0,1] row_mask:0xf bank_mask:0xf
  v_mfma_f32_16x16x32_bf16 v[64:67], v[108:111], v[76:79], 0
  v_cvt_pk_bf16_f32 v114, v60, v61
  v_cvt_pk_bf16_f32 v119, v60, v61
  s_waitcnt vmcnt(0)
  v_mfma_f32_16x16x32_bf16 v[44:47], v[96:99], v[76:79], 0
  v_max_u32 v89, v104, v105
  v_cmp_eq_u32 vcc, -1, v89
  v_mfma_f32_16x16x32_bf16 v[64:67], v[108:111], v[114:117], v[64:67]
  v_mfma_f32_16x16x32_bf16 v[48:51], v[100:103], v[76:79], 0
  s_cbranch_vccnz L_QK_vbad0
L_QK_vok0:
  buffer_store_dword v94, v91, s[4:7], s57 offen
  v_mfma_f32_16x16x32_bf16 v[44:47], v[104:107], v[114:117], v[44:47]
  v_mfma_f32_16x16x32_bf16 v[48:51], v[104:107], v[118:121], v[48:51]
  s_nop 2
  v_rcp_f32_e64 v64, v64
  s_nop 2
  v_pk_mul_f32 v[44:45], v[44:45], v[64:65] op_sel_hi:[1,0]
  v_pk_mul_f32 v[46:47], v[46:47], v[64:65] op_sel_hi:[1,0]
  v_pk_mul_f32 v[48:49], v[48:49], v[64:65] op_sel_hi:[1,0]
  v_pk_mul_f32 v[50:51], v[50:51], v[64:65] op_sel_hi:[1,0]
  v_cvt_pk_bf16_f32 v52, v44, v45
  v_cvt_pk_bf16_f32 v53, v46, v47
  v_cvt_pk_bf16_f32 v54, v48, v49
  v_cvt_pk_bf16_f32 v55, v50, v51
  buffer_store_dwordx4 v[52:55], v122, s[4:7], s48 offen
  ds_read_b128 v[44:47], v1 offset:0
  ds_read_b128 v[48:51], v2 offset:1024
  s_add_u32 s32, s32, 2097152
  s_xor_b32 s32, s32, 0x2000
  s_add_u32 s33, s25, 2
  s_min_u32 s33, s33, 64
  s_waitcnt lgkmcnt(0)
  buffer_load_dwordx2 v[106:107], v92, s[4:7], s35 offen sc1
  buffer_store_dwordx4 v[52:55], v122, s[4:7], s28 offen sc1
  v_mfma_f32_16x16x32_bf16 v[56:59], v[20:23], v[44:47], 0
  v_mfma_f32_16x16x32_bf16 v[60:63], v[24:27], v[44:47], 0
  v_mfma_f32_16x16x32_bf16 v[64:67], v[4:7], v[44:47], 0
  ds_read_b128 v[20:23], v3 offset:0
  ds_read_b128 v[24:27], v2 offset:2048
  v_mfma_f32_16x16x32_bf16 v[56:59], v[28:31], v[48:51], v[56:59]
  v_mfma_f32_16x16x32_bf16 v[60:63], v[32:35], v[48:51], v[60:63]
  v_mfma_f32_16x16x32_bf16 v[64:67], v[8:11], v[48:51], v[64:67]
  ds_read_b128 v[28:31], v84 offset:1024
  ds_read_b128 v[32:35], v2 offset:3072
  s_waitcnt lgkmcnt(3)
  v_mfma_f32_16x16x32_bf16 v[56:59], v[36:39], v[20:23], v[56:59]
  v_mfma_f32_16x16x32_bf16 v[60:63], v[40:43], v[20:23], v[60:63]
  v_mfma_f32_16x16x32_bf16 v[64:67], v[12:15], v[20:23], v[64:67]
  s_nop 0
  s_waitcnt lgkmcnt(0)
  v_mfma_f32_16x16x32_bf16 v[56:59], v[68:71], v[28:31], v[56:59]
  v_mfma_f32_16x16x32_bf16 v[60:63], v[72:75], v[28:31], v[60:63]
  v_mfma_f32_16x16x32_bf16 v[64:67], v[16:19], v[28:31], v[64:67]
  s_cmp_lg_u32 s20, 1
  s_cbranch_scc1 Lskip_164
Lask_162:
  s_min_i32 s50, s44, s45
  s_min_i32 s50, s50, s46
  s_min_i32 s50, s50, s47
  s_cmp_ge_i32 s50, s33
  s_cbranch_scc1 Lhave_163
  s_load_dwordx4 s[44:47], s[4:5], s59 glc
  s_sub_u32 s24, s24, 1
  s_cbranch_scc1 L_FAIL
  s_waitcnt lgkmcnt(0)
  s_branch Lask_162
Lhave_163:
  s_add_u32 s33, s33, 2
  s_min_u32 s33, s33, 64
  s_cmp_ge_i32 s50, s33
  s_nop 0
  s_cbranch_scc1 Lskip_164
  s_load_dwordx4 s[44:47], s[4:5], s59 glc
Lskip_164:
  s_barrier
  v_cndmask_b32 v56, v86, v56, s[8:9]
  v_cndmask_b32 v57, v86, v57, s[10:11]
  v_cndmask_b32 v58, v86, v58, s[16:17]
  v_cndmask_b32 v59, v86, v59, s[18:19]
  v_cndmask_b32 v60, v86, v60, s[42:43]
  v_cndmask_b32 v61, v86, v61, s[100:101]
  buffer_load_dword v77, v87, s[4:7], s28 offen sc1
  v_cndmask_b32 v62, v86, v62, s[52:53]
  v_cndmask_b32 v63, v86, v63, s[54:55]
  s_add_u32 m0, s58, 16384
  s_add_u32 s31, s32, 16384
  buffer_load_dwordx4 v95, s[4:7], s31 offen offset:0 sc1 lds
  v_max3_f32 v72, v56, v57, v58
  v_max3_f32 v73, v59, v60, v61
  buffer_load_dwordx4 v95, s[4:7], s31 offen offset:1024 sc1 lds
  v_max3_f32 v72, v72, v62, v63
  v_max3_f32 v73, v73, v64, v65
  s_add_u32 m0, s58, 2048
  s_add_u32 s31, s32, 32768
  buffer_load_dwordx4 v95, s[4:7], s31 offen offset:0 sc1 lds
  v_max_f32 v74, v72, v73
  v_max_f32 v75, v72, v73
  buffer_load_dwordx4 v95, s[4:7], s31 offen offset:1024 sc1 lds
  s_nop 0
  v_permlane16_swap_b32 v74, v75
  v_max_f32 v72, v74, v75
  s_mov_b32 m0, s58
  s_add_u32 s31, s32, s49
  buffer_load_dwordx4 v95, s[4:7], s31 offen offset:0 sc1 lds
  v_max_f32 v73, v74, v75
  s_nop 1
  v_permlane32_swap_b32 v72, v73
  s_sub_u32 s31, s32, s49
  buffer_load_dwordx4 v95, s[4:7], s31 offen offset:1024 sc1 lds
  v_max_f32 v72, v72, v73
  v_mul_f32 v72, s38, v72
  buffer_store_dwordx4 v[80:83], v122, s[4:7], s34 offen sc1
  v_pk_fma_f32 v[56:57], v[56:57], s[38:39], v[72:73] op_sel_hi:[1,1,0] neg_lo:[0,0,1] neg_hi:[0,0,1]
  v_pk_fma_f32 v[58:59], v[58:59], s[38:39], v[72:73] op_sel_hi:[1,1,0] neg_lo:[0,0,1] neg_hi:[0,0,1]
  s_xor_b32 s40, s34, 8192
  buffer_store_dwordx4 v[80:83], v122, s[4:7], s40 offen
  v_pk_fma_f32 v[60:61], v[60:61], s[38:39], v[72:73] op_sel_hi:[1,1,0] neg_lo:[0,0,1] neg_hi:[0,0,1]
  v_pk_fma_f32 v[62:63], v[62:63], s[38:39], v[72:73] op_sel_hi:[1,1,0] neg_lo:[0,0,1] neg_hi:[0,0,1]
  v_pk_fma_f32 v[64:65], v[64:65], s[38:39], v[72:73] op_sel_hi:[1,1,0] neg_lo:[0,0,1] neg_hi:[0,0,1]
  v_exp_f32 v56, v56
  v_exp_f32 v57, v57
  v_exp_f32 v58, v58
  v_exp_f32 v59, v59
  v_exp_f32 v60, v60
  v_exp_f32 v61, v61
  v_exp_f32 v62, v62
  v_exp_f32 v63, v63
  v_exp_f32 v64, v64
  v_exp_f32 v65, v65
  s_waitcnt vmcnt(10)
  v_max_u32 v89, v106, v107
  v_cmp_eq_u32 vcc, -1, v89
  v_cvt_pk_bf16_f32 v36, v56, v57
  v_cvt_pk_bf16_f32 v37, v58, v59
  v_cvt_pk_bf16_f32 v38, v60, v61
  v_cvt_pk_bf16_f32 v39, v62, v63
  v_cvt_pk_bf16_f32 v114, v64, v65
  v_cvt_pk_bf16_f32 v119, v64, v65
  s_cbranch_vccnz L_QK_vbad1
L_QK_vok1:
  s_add_u32 s25, s25, 1
  s_xor_b32 s41, s30, 2048
  v_mfma_f32_16x16x32_bf16 v[40:43], v[108:111], v[36:39], 0
  s_add_u32 s27, s25, 32
  s_and_b32 s40, s27, 0x28
  s_mul_i32 s40, s40, 0x900
  v_mfma_f32_16x16x32_bf16 v[52:55], v[96:99], v[36:39], 0
  s_and_b32 s40, s40, 0x6000
  s_xor_b32 s40, s40, s26
  s_lshl_b32 s27, s27, 16
  v_mfma_f32_16x16x32_bf16 v[56:59], v[100:103], v[36:39], 0
  s_add_u32 s27, s27, s40
  s_lshl_b32 s37, s36, 1
  s_xor_b32 s37, s27, s37
  v_mfma_f32_16x16x32_bf16 v[60:63], v[24:27], v[36:39], 0
  s_and_b32 s40, s25, 3
  s_lshl_b32 s40, s40, 18
  s_add_u32 s28, s40, s26
  v_mfma_f32_16x16x32_bf16 v[64:67], v[32:35], v[36:39], 0
  s_lshr_b32 s40, s40, 5
  s_and_b32 s40, s40, 0x4000
  s_xor_b32 s28, s28, s40
  v_mfma_f32_16x16x32_bf16 v[40:43], v[108:111], v[114:117], v[40:43]
  s_xor_b32 s29, s28, 0x4000
  s_xor_b32 s34, s28, 0x84000
  s_xor_b32 s48, s28, 8192
  v_mfma_f32_16x16x32_bf16 v[52:55], v[104:107], v[114:117], v[52:55]
  s_lshr_b32 s40, s49, 1
  s_add_u32 s29, s29, s40
  s_xor_b32 s35, s29, 512
  v_mfma_f32_16x16x32_bf16 v[56:59], v[104:107], v[118:121], v[56:59]
  s_add_u32 s92, s37, s88
  s_add_u32 s96, s27, s88
  s_xor_b32 s96, s96, 0x1000
  v_mfma_f32_16x16x32_bf16 v[60:63], v[104:107], v[112:115], v[60:63]
  s_add_u32 s93, s37, s89
  s_add_u32 s97, s27, s89
  s_xor_b32 s97, s97, 0x1000
  v_mfma_f32_16x16x32_bf16 v[64:67], v[104:107], v[116:119], v[64:67]
  s_add_u32 s94, s37, s90
  s_add_u32 s98, s27, s90
  s_xor_b32 s98, s98, 0x1000
  s_add_u32 s95, s37, s91
  s_add_u32 s99, s27, s91
  s_xor_b32 s99, s99, 0x1000
  v_rcp_f32 v40, v40
  s_nop 0
  v_pk_mul_f32 v[52:53], v[52:53], v[40:41] op_sel_hi:[1,0]
  v_pk_mul_f32 v[54:55], v[54:55], v[40:41] op_sel_hi:[1,0]
  v_pk_mul_f32 v[56:57], v[56:57], v[40:41] op_sel_hi:[1,0]
  v_pk_mul_f32 v[58:59], v[58:59], v[40:41] op_sel_hi:[1,0]
  v_cvt_pk_bf16_f32 v4, v52, v53
  v_cvt_pk_bf16_f32 v5, v54, v55
  v_cvt_pk_bf16_f32 v6, v56, v57
  v_cvt_pk_bf16_f32 v7, v58, v59
  buffer_store_dwordx4 v[4:7], v95, s[4:7], s30 offen sc1
  v_pk_mul_f32 v[60:61], v[60:61], v[40:41] op_sel_hi:[1,0]
  v_pk_mul_f32 v[62:63], v[62:63], v[40:41] op_sel_hi:[1,0]
  v_pk_mul_f32 v[64:65], v[64:65], v[40:41] op_sel_hi:[1,0]
  v_pk_mul_f32 v[66:67], v[66:67], v[40:41] op_sel_hi:[1,0]
  v_cvt_pk_bf16_f32 v8, v60, v61
  v_cvt_pk_bf16_f32 v9, v62, v63
  v_cvt_pk_bf16_f32 v10, v64, v65
  v_cvt_pk_bf16_f32 v11, v66, v67
  buffer_store_dwordx4 v[8:11], v95, s[4:7], s41 offen sc1
  s_add_u32 s30, s30, 2097152
  s_xor_b32 s30, s30, 0x2000
  s_branch L_QK_top
L_QK_park:
  s_waitcnt vmcnt(0)
  s_cmp_lt_u32 s25, 64
  s_cbranch_scc1 L_QK_rel
  s_barrier
  s_cmp_lg_u32 s20, 0
  s_cbranch_scc1 Lnosig_165
  s_mov_b32 s63, s25
  s_atomic_smax s63, s[4:5], s62 glc
Lnosig_165:
  s_branch L_END
L_QKM_nan:
  s_cmp_eq_u32 s51, s25
  s_cbranch_scc1 L_QKM_done
  s_mov_b32 s51, s25
  s_add_u32 s60, s60, 0x10000
  s_waitcnt vmcnt(0) lgkmcnt(0)
L_QKM_v0:
  s_sub_u32 s24, s24, 1
  s_cbranch_scc1 L_FAIL
  buffer_load_dwordx4 v[4:7], v95, s[4:7], s92 offen offset:0 sc1
  buffer_load_dwordx4 v[8:11], v95, s[4:7], s92 offen offset:2048 sc1
  buffer_load_dwordx4 v[12:15], v95, s[4:7], s93 offen offset:0 sc1
  buffer_load_dwordx4 v[16:19], v95, s[4:7], s93 offen offset:2048 sc1
  v_mov_b32 v89, 0
  s_waitcnt vmcnt(0)
  v_max3_u32 v89, v4, v5, v89
  v_max3_u32 v89, v6, v7, v89
  v_max3_u32 v89, v8, v9, v89
  v_max3_u32 v89, v10, v11, v89
  v_max3_u32 v89, v12, v13, v89
  v_max3_u32 v89, v14, v15, v89
  v_max3_u32 v89, v16, v17, v89
  v_max3_u32 v89, v18, v19, v89
  v_cmp_eq_u32 vcc, -1, v89
  s_cbranch_vccnz L_QKM_v0
L_QKM_v4:
  s_sub_u32 s24, s24, 1
  s_cbranch_scc1 L_FAIL
  buffer_load_dwordx4 v[68:71], v95, s[4:7], s94 offen offset:0 sc1
  buffer_load_dwordx4 v[72:75], v95, s[4:7], s94 offen offset:2048 sc1
  buffer_load_dwordx4 v[4:7], v95, s[4:7], s95 offen offset:0 sc1
  buffer_load_dwordx4 v[8:11], v95, s[4:7], s95 offen offset:2048 sc1
  v_mov_b32 v89, 0
  s_waitcnt vmcnt(0)
  v_max3_u32 v89, v68, v69, v89
  v_max3_u32 v89, v70, v71, v89
  v_max3_u32 v89, v72, v73, v89
  v_max3_u32 v89, v74, v75, v89
  v_max3_u32 v89, v4, v5, v89
  v_max3_u32 v89, v6, v7, v89
  v_max3_u32 v89, v8, v9, v89
  v_max3_u32 v89, v10, v11, v89
  v_cmp_eq_u32 vcc, -1, v89
  s_cbranch_vccnz L_QKM_v4
L_QKM_v8:
  s_sub_u32 s24, s24, 1
  s_cbranch_scc1 L_FAIL
  buffer_load_dwordx4 v[12:15], v95, s[4:7], s96 offen offset:0 sc1
  buffer_load_dwordx4 v[16:19], v95, s[4:7], s96 offen offset:2048 sc1
  buffer_load_dwordx4 v[68:71], v95, s[4:7], s97 offen offset:0 sc1
  buffer_load_dwordx4 v[72:75], v95, s[4:7], s97 offen offset:2048 sc1
  v_mov_b32 v89, 0
  s_waitcnt vmcnt(0)
  v_max3_u32 v89, v12, v13, v89
  v_max3_u32 v89, v14, v15, v89
  v_max3_u32 v89, v16, v17, v89
  v_max3_u32 v89, v18, v19, v89
  v_max3_u32 v89, v68, v69, v89
  v_max3_u32 v89, v70, v71, v89
  v_max3_u32 v89, v72, v73, v89
  v_max3_u32 v89, v74, v75, v89
  v_cmp_eq_u32 vcc, -1, v89
  s_cbranch_vccnz L_QKM_v8
L_QKM_v12:
  s_sub_u32 s24, s24, 1
  s_cbranch_scc1 L_FAIL
  buffer_load_dwordx4 v[4:7], v95, s[4:7], s98 offen offset:0 sc1
  buffer_load_dwordx4 v[8:11], v95, s[4:7], s98 offen offset:2048 sc1
  buffer_load_dwordx4 v[12:15], v95, s[4:7], s99 offen offset:0 sc1
  buffer_load_dwordx4 v[16:19], v95, s[4:7], s99 offen offset:2048 sc1
  v_mov_b32 v89, 0
  s_waitcnt vmcnt(0)
  v_max3_u32 v89, v4, v5, v89
  v_max3_u32 v89, v6, v7, v89
  v_max3_u32 v89, v8, v9, v89
  v_max3_u32 v89, v10, v11, v89
  v_max3_u32 v89, v12, v13, v89
  v_max3_u32 v89, v14, v15, v89
  v_max3_u32 v89, v16, v17, v89
  v_max3_u32 v89, v18, v19, v89
  v_cmp_eq_u32 vcc, -1, v89
  s_cbranch_vccnz L_QKM_v12
  v_mov_b64 v[52:53], 0
  v_mov_b64 v[54:55], 0
  v_mov_b64 v[56:57], 0
  v_mov_b64 v[58:59], 0
  v_mov_b64 v[60:61], 0
  v_mov_b64 v[62:63], 0
  v_mov_b64 v[64:65], 0
  v_mov_b64 v[66:67], 0
  ds_read_b128 v[20:23], v85 offset:0
  ds_read_b128 v[24:27], v85 offset:1024
  ds_read_b128 v[28:31], v85 offset:8192
  ds_read_b128 v[32:35], v85 offset:9216
  ds_read_b128 v[36:39], v85 offset:2048
  ds_read_b128 v[40:43], v85 offset:3072
  ds_read_b128 v[44:47], v85 offset:10240
  ds_read_b128 v[48:51], v85 offset:11264
  s_waitcnt lgkmcnt(0)
L_QKMS_again:
  buffer_load_dwordx4 v[4:7], v95, s[4:7], s92 offen offset:0 sc1
  s_nop 0
  buffer_load_dwordx4 v[8:11], v95, s[4:7], s92 offen offset:2048 sc1
  s_nop 0
  buffer_load_dwordx4 v[12:15], v95, s[4:7], s93 offen offset:0 sc1
  s_nop 0
  buffer_load_dwordx4 v[16:19], v95, s[4:7], s93 offen offset:2048 sc1
  s_nop 0
  buffer_load_dwordx4 v[68:71], v95, s[4:7], s94 offen offset:0 sc1
  s_nop 0
  s_waitcnt vmcnt(4)
  buffer_load_dwordx4 v[72:75], v95, s[4:7], s94 offen offset:2048 sc1
  v_smfmac_f32_16x16x64_bf16 v[52:55], v[4:7], a[0:7], v88
  v_smfmac_f32_16x16x64_bf16 v[60:63], v[4:7], v[128:135], v88
  s_waitcnt vmcnt(4)
  v_smfmac_f32_16x16x64_bf16 v[56:59], v[4:7], a[128:135], v88
  v_smfmac_f32_16x16x64_bf16 v[64:67], v[4:7], v[20:27], v88
  buffer_load_dwordx4 v[4:7], v95, s[4:7], s95 offen offset:0 sc1
  v_smfmac_f32_16x16x64_bf16 v[52:55], v[8:11], a[8:15], v88
  ds_read_b128 v[20:23], v85 offset:4096
  v_smfmac_f32_16x16x64_bf16 v[60:63], v[8:11], v[136:143], v88
  ds_read_b128 v[24:27], v85 offset:5120
  s_waitcnt vmcnt(4)
  v_smfmac_f32_16x16x64_bf16 v[56:59], v[8:11], a[136:143], v88
  v_smfmac_f32_16x16x64_bf16 v[64:67], v[8:11], v[28:35], v88
  buffer_load_dwordx4 v[8:11], v95, s[4:7], s95 offen offset:2048 sc1
  v_smfmac_f32_16x16x64_bf16 v[52:55], v[12:15], a[16:23], v88
  ds_read_b128 v[28:31], v85 offset:12288
  v_smfmac_f32_16x16x64_bf16 v[60:63], v[12:15], v[144:151], v88
  ds_read_b128 v[32:35], v85 offset:13312
  s_waitcnt vmcnt(4)
  v_smfmac_f32_16x16x64_bf16 v[56:59], v[12:15], a[144:151], v88
  v_smfmac_f32_16x16x64_bf16 v[64:67], v[12:15], v[36:43], v88
  buffer_load_dwordx4 v[12:15], v95, s[4:7], s96 offen offset:0 sc1
  v_smfmac_f32_16x16x64_bf16 v[52:55], v[16:19], a[24:31], v88
  ds_read_b128 v[36:39], v85 offset:6144
  v_smfmac_f32_16x16x64_bf16 v[60:63], v[16:19], v[152:159], v88
  ds_read_b128 v[40:43], v85 offset:7168
  s_waitcnt vmcnt(4)
  v_smfmac_f32_16x16x64_bf16 v[56:59], v[16:19], a[152:159], v88
  v_smfmac_f32_16x16x64_bf16 v[64:67], v[16:19], v[44:51], v88
  buffer_load_dwordx4 v[16:19], v95, s[4:7], s96 offen offset:2048 sc1
  v_smfmac_f32_16x16x64_bf16 v[52:55], v[68:71], a[32:39], v88
  ds_read_b128 v[44:47], v85 offset:14336
  v_smfmac_f32_16x16x64_bf16 v[60:63], v[68:71], v[160:167], v88
  ds_read_b128 v[48:51], v85 offset:15360
  s_waitcnt vmcnt(4)
  v_smfmac_f32_16x16x64_bf16 v[56:59], v[68:71], a[160:167], v88
  s_waitcnt lgkmcnt(6)
  v_smfmac_f32_16x16x64_bf16 v[64:67], v[68:71], v[20:27], v88
  buffer_load_dwordx4 v[68:71], v95, s[4:7], s97 offen offset:0 sc1
  v_smfmac_f32_16x16x64_bf16 v[52:55], v[72:75], a[40:47], v88
  ds_read_b128 v[20:23], v85 offset:16384
  v_smfmac_f32_16x16x64_bf16 v[60:63], v[72:75], v[168:175], v88
  ds_read_b128 v[24:27], v85 offset:17408
  s_waitcnt vmcnt(4)
  v_smfmac_f32_16x16x64_bf16 v[56:59], v[72:75], a[168:175], v88
  s_waitcnt lgkmcnt(6)
  v_smfmac_f32_16x16x64_bf16 v[64:67], v[72:75], v[28:35], v88
  buffer_load_dwordx4 v[72:75], v95, s[4:7], s97 offen offset:2048 sc1
  v_smfmac_f32_16x16x64_bf16 v[52:55], v[4:7], a[48:55], v88
  ds_read_b128 v[28:31], v85 offset:24576
  v_smfmac_f32_16x16x64_bf16 v[60:63], v[4:7], v[176:183], v88
  ds_read_b128 v[32:35], v85 offset:25600
  s_waitcnt vmcnt(4)
  v_smfmac_f32_16x16x64_bf16 v[56:59], v[4:7], a[176:183], v88
  s_waitcnt lgkmcnt(6)
  v_smfmac_f32_16x16x64_bf16 v[64:67], v[4:7], v[36:43], v88
  buffer_load_dwordx4 v[4:7], v95, s[4:7], s98 offen offset:0 sc1
  v_smfmac_f32_16x16x64_bf16 v[52:55], v[8:11], a[56:63], v88
  ds_read_b128 v[36:39], v85 offset:18432
  v_smfmac_f32_16x16x64_bf16 v[60:63], v[8:11], v[184:191], v88
  ds_read_b128 v[40:43], v85 offset:19456
  s_waitcnt vmcnt(4)
  v_smfmac_f32_16x16x64_bf16 v[56:59], v[8:11], a[184:191], v88
  s_waitcnt lgkmcnt(6)
  v_smfmac_f32_16x16x64_bf16 v[64:67], v[8:11], v[44:51], v88
  buffer_load_dwordx4 v[8:11], v95, s[4:7], s98 offen offset:2048 sc1
  v_smfmac_f32_16x16x64_bf16 v[52:55], v[12:15], a[64:71], v88
  ds_read_b128 v[44:47], v85 offset:26624
  v_smfmac_f32_16x16x64_bf16 v[60:63], v[12:15], v[192:199], v88
  ds_read_b128 v[48:51], v85 offset:27648
  s_waitcnt vmcnt(4)
  v_smfmac_f32_16x16x64_bf16 v[56:59], v[12:15], a[192:199], v88
  s_waitcnt lgkmcnt(6)
  v_smfmac_f32_16x16x64_bf16 v[64:67], v[12:15], v[20:27], v88
  buffer_load_dwordx4 v[12:15], v95, s[4:7], s99 offen offset:0 sc1
  v_smfmac_f32_16x16x64_bf16 v[52:55], v[16:19], a[72:79], v88
  ds_read_b128 v[20:23], v85 offset:20480
  v_smfmac_f32_16x16x64_bf16 v[60:63], v[16:19], v[200:207], v88
  ds_read_b128 v[24:27], v85 offset:21504
  s_waitcnt vmcnt(4)
  v_smfmac_f32_16x16x64_bf16 v[56:59], v[16:19], a[200:207], v88
  s_waitcnt lgkmcnt(6)
  v_smfmac_f32_16x16x64_bf16 v[64:67], v[16:19], v[28:35], v88
  buffer_load_dwordx4 v[16:19], v95, s[4:7], s99 offen offset:2048 sc1
  v_smfmac_f32_16x16x64_bf16 v[52:55], v[68:71], a[80:87], v88
  ds_read_b128 v[28:31], v85 offset:28672
  v_smfmac_f32_16x16x64_bf16 v[60:63], v[68:71], v[208:215], v88
  ds_read_b128 v[32:35], v85 offset:29696
  s_waitcnt vmcnt(4)
  v_smfmac_f32_16x16x64_bf16 v[56:59], v[68:71], a[208:215], v88
  s_waitcnt lgkmcnt(6)
  v_smfmac_f32_16x16x64_bf16 v[64:67], v[68:71], v[36:43], v88
  ds_read_b128 v[36:39], v85 offset:22528
  v_smfmac_f32_16x16x64_bf16 v[52:55], v[72:75], a[88:95], v88
  ds_read_b128 v[40:43], v85 offset:23552
  v_smfmac_f32_16x16x64_bf16 v[60:63], v[72:75], v[216:223], v88
  s_waitcnt vmcnt(3)
  v_smfmac_f32_16x16x64_bf16 v[56:59], v[72:75], a[216:223], v88
  s_waitcnt lgkmcnt(6)
  v_smfmac_f32_16x16x64_bf16 v[64:67], v[72:75], v[44:51], v88
  ds_read_b128 v[44:47], v85 offset:30720
  v_smfmac_f32_16x16x64_bf16 v[52:55], v[4:7], a[96:103], v88
  ds_read_b128 v[48:51], v85 offset:31744
  v_smfmac_f32_16x16x64_bf16 v[60:63], v[4:7], v[224:231], v88
  s_waitcnt vmcnt(2)
  v_smfmac_f32_16x16x64_bf16 v[56:59], v[4:7], a[224:231], v88
  s_waitcnt lgkmcnt(6)
  v_smfmac_f32_16x16x64_bf16 v[64:67], v[4:7], v[20:27], v88
  ds_read_b128 v[20:23], v1 offset:16384
  v_smfmac_f32_16x16x64_bf16 v[52:55], v[8:11], a[104:111], v88
  ds_read_b128 v[24:27], v1 offset:17408
  v_smfmac_f32_16x16x64_bf16 v[60:63], v[8:11], v[232:239], v88
  ds_read_b128 v[68:71], v84 offset:16384
  s_waitcnt vmcnt(1)
  v_smfmac_f32_16x16x64_bf16 v[56:59], v[8:11], a[232:239], v88
  s_waitcnt lgkmcnt(7)
  v_smfmac_f32_16x16x64_bf16 v[64:67], v[8:11], v[28:35], v88
  ds_read_b128 v[28:31], v2 offset:16384
  v_smfmac_f32_16x16x64_bf16 v[52:55], v[12:15], a[112:119], v88
  ds_read_b128 v[32:35], v2 offset:17408
  v_smfmac_f32_16x16x64_bf16 v[60:63], v[12:15], v[240:247], v88
  ds_read_b128 v[72:75], v84 offset:17408
  s_waitcnt vmcnt(0)
  v_smfmac_f32_16x16x64_bf16 v[56:59], v[12:15], a[240:247], v88
  s_waitcnt lgkmcnt(8)
  v_smfmac_f32_16x16x64_bf16 v[64:67], v[12:15], v[36:43], v88
  ds_read_b128 v[36:39], v3 offset:16384
  v_smfmac_f32_16x16x64_bf16 v[52:55], v[16:19], a[120:127], v88
  ds_read_b128 v[40:43], v3 offset:17408
  v_smfmac_f32_16x16x64_bf16 v[60:63], v[16:19], v[248:255], v88
  v_smfmac_f32_16x16x64_bf16 v[56:59], v[16:19], a[248:255], v88
  s_waitcnt lgkmcnt(8)
  v_smfmac_f32_16x16x64_bf16 v[64:67], v[16:19], v[44:51], v88
  s_nop 7
  s_branch L_QKM_join
L_QKM_g0:
  s_sub_u32 s24, s24, 1
  s_cbranch_scc1 L_FAIL
  s_add_u32 s60, s60, 1
  buffer_load_dwordx4 v[4:7], v95, s[4:7], s92 offen offset:0 sc1
  s_waitcnt vmcnt(0)
  v_cmp_eq_u32 vcc, -1, v4
  s_cbranch_vccnz L_QKM_g0
  v_mov_b32 v89, 0
  v_max3_u32 v89, v8, v12, v89
  v_max3_u32 v89, v16, v68, v89
  v_cmp_eq_u32 vcc, -1, v89
  s_cbranch_vccz L_QKM_ok0
  buffer_load_dwordx4 v[8:11], v95, s[4:7], s92 offen offset:2048 sc1
  s_nop 0
  buffer_load_dwordx4 v[12:15], v95, s[4:7], s93 offen offset:0 sc1
  s_nop 0
  buffer_load_dwordx4 v[16:19], v95, s[4:7], s93 offen offset:2048 sc1
  s_nop 0
  buffer_load_dwordx4 v[68:71], v95, s[4:7], s94 offen offset:0 sc1
  s_nop 0
  s_branch L_QKM_ok0
L_QKM_g1:
  s_sub_u32 s24, s24, 1
  s_cbranch_scc1 L_FAIL
  s_add_u32 s60, s60, 1
  buffer_load_dwordx4 v[8:11], v95, s[4:7], s92 offen offset:2048 sc1
  s_waitcnt vmcnt(0)
  v_cmp_eq_u32 vcc, -1, v8
  s_cbranch_vccnz L_QKM_g1
  v_mov_b32 v89, 0
  v_max3_u32 v89, v12, v16, v89
  v_max3_u32 v89, v68, v72, v89
  v_cmp_eq_u32 vcc, -1, v89
  s_cbranch_vccz L_QKM_ok1
  buffer_load_dwordx4 v[12:15], v95, s[4:7], s93 offen offset:0 sc1
  s_nop 0
  buffer_load_dwordx4 v[16:19], v95, s[4:7], s93 offen offset:2048 sc1
  s_nop 0
  buffer_load_dwordx4 v[68:71], v95, s[4:7], s94 offen offset:0 sc1
  s_nop 0
  buffer_load_dwordx4 v[72:75], v95, s[4:7], s94 offen offset:2048 sc1
  s_nop 0
  s_branch L_QKM_ok1
L_QKM_g2:
  s_sub_u32 s24, s24, 1
  s_cbranch_scc1 L_FAIL
  s_add_u32 s60, s60, 1
  buffer_load_dwordx4 v[12:15], v95, s[4:7], s93 offen offset:0 sc1
  s_waitcnt vmcnt(0)
  v_cmp_eq_u32 vcc, -1, v12
  s_cbranch_vccnz L_QKM_g2
  v_mov_b32 v89, 0
  v_max3_u32 v89, v16, v68, v89
  v_max3_u32 v89, v72, v4, v89
  v_cmp_eq_u32 vcc, -1, v89
  s_cbranch_vccz L_QKM_ok2
  buffer_load_dwordx4 v[16:19], v95, s[4:7], s93 offen offset:2048 sc1
  s_nop 0
  buffer_load_dwordx4 v[68:71], v95, s[4:7], s94 offen offset:0 sc1
  s_nop 0
  buffer_load_dwordx4 v[72:75], v95, s[4:7], s94 offen offset:2048 sc1
  s_nop 0
  buffer_load_dwordx4 v[4:7], v95, s[4:7], s95 offen offset:0 sc1
  s_nop 0
  s_branch L_QKM_ok2
L_QKM_g3:
  s_sub_u32 s24, s24, 1
  s_cbranch_scc1 L_FAIL
  s_add_u32 s60, s60, 1
  buffer_load_dwordx4 v[16:19], v95, s[4:7], s93 offen offset:2048 sc1
  s_waitcnt vmcnt(0)
  v_cmp_eq_u32 vcc, -1, v16
  s_cbranch_vccnz L_QKM_g3
  v_mov_b32 v89, 0
  v_max3_u32 v89, v68, v72, v89
  v_max3_u32 v89, v4, v8, v89
  v_cmp_eq_u32 vcc, -1, v89
  s_cbranch_vccz L_QKM_ok3
  buffer_load_dwordx4 v[68:71], v95, s[4:7], s94 offen offset:0 sc1
  s_nop 0
  buffer_load_dwordx4 v[72:75], v95, s[4:7], s94 offen offset:2048 sc1
  s_nop 0
  buffer_load_dwordx4 v[4:7], v95, s[4:7], s95 offen offset:0 sc1
  s_nop 0
  buffer_load_dwordx4 v[8:11], v95, s[4:7], s95 offen offset:2048 sc1
  s_nop 0
  s_branch L_QKM_ok3
L_QKM_g4:
  s_sub_u32 s24, s24, 1
  s_cbranch_scc1 L_FAIL
  s_add_u32 s60, s60, 1
  buffer_load_dwordx4 v[68:71], v95, s[4:7], s94 offen offset:0 sc1
  s_waitcnt vmcnt(0)
  v_cmp_eq_u32 vcc, -1, v68
  s_cbranch_vccnz L_QKM_g4
  v_mov_b32 v89, 0
  v_max3_u32 v89, v72, v4, v89
  v_max3_u32 v89, v8, v12, v89
  v_cmp_eq_u32 vcc, -1, v89
  s_cbranch_vccz L_QKM_ok4
  buffer_load_dwordx4 v[72:75], v95, s[4:7], s94 offen offset:2048 sc1
  s_nop 0
  buffer_load_dwordx4 v[4:7], v95, s[4:7], s95 offen offset:0 sc1
  s_nop 0
  buffer_load_dwordx4 v[8:11], v95, s[4:7], s95 offen offset:2048 sc1
  s_nop 0
  buffer_load_dwordx4 v[12:15], v95, s[4:7], s96 offen offset:0 sc1
  s_nop 0
  s_branch L_QKM_ok4
L_QKM_g5:
  s_sub_u32 s24, s24, 1
  s_cbranch_scc1 L_FAIL
  s_add_u32 s60, s60, 1
  buffer_load_dwordx4 v[72:75], v95, s[4:7], s94 offen offset:2048 sc1
  s_waitcnt vmcnt(0)
  v_cmp_eq_u32 vcc, -1, v72
  s_cbranch_vccnz L_QKM_g5
  v_mov_b32 v89, 0
  v_max3_u32 v89, v4, v8, v89
  v_max3_u32 v89, v12, v16, v89
  v_cmp_eq_u32 vcc, -1, v89
  s_cbranch_vccz L_QKM_ok5
  buffer_load_dwordx4 v[4:7], v95, s[4:7], s95 offen offset:0 sc1
  s_nop 0
  buffer_load_dwordx4 v[8:11], v95, s[4:7], s95 offen offset:2048 sc1
  s_nop 0
  buffer_load_dwordx4 v[12:15], v95, s[4:7], s96 offen offset:0 sc1
  s_nop 0
  buffer_load_dwordx4 v[16:19], v95, s[4:7], s96 offen offset:2048 sc1
  s_nop 0
  s_branch L_QKM_ok5
L_QKM_g6:
  s_sub_u32 s24, s24, 1
  s_cbranch_scc1 L_FAIL
  s_add_u32 s60, s60, 1
  buffer_load_dwordx4 v[4:7], v95, s[4:7], s95 offen offset:0 sc1
  s_waitcnt vmcnt(0)
  v_cmp_eq_u32 vcc, -1, v4
  s_cbranch_vccnz L_QKM_g6
  v_mov_b32 v89, 0
  v_max3_u32 v89, v8, v12, v89
  v_max3_u32 v89, v16, v68, v89
  v_cmp_eq_u32 vcc, -1, v89
  s_cbranch_vccz L_QKM_ok6
  buffer_load_dwordx4 v[8:11], v95, s[4:7], s95 offen offset:2048 sc1
  s_nop 0
  buffer_load_dwordx4 v[12:15], v95, s[4:7], s96 offen offset:0 sc1
  s_nop 0
  buffer_load_dwordx4 v[16:19], v95, s[4:7], s96 offen offset:2048 sc1
  s_nop 0
  buffer_load_dwordx4 v[68:71], v95, s[4:7], s97 offen offset:0 sc1
  s_nop 0
  s_branch L_QKM_ok6
L_QKM_g7:
  s_sub_u32 s24, s24, 1
  s_cbranch_scc1 L_FAIL
  s_add_u32 s60, s60, 1
  buffer_load_dwordx4 v[8:11], v95, s[4:7], s95 offen offset:2048 sc1
  s_waitcnt vmcnt(0)
  v_cmp_eq_u32 vcc, -1, v8
  s_cbranch_vccnz L_QKM_g7
  v_mov_b32 v89, 0
  v_max3_u32 v89, v12, v16, v89
  v_max3_u32 v89, v68, v72, v89
  v_cmp_eq_u32 vcc, -1, v89
  s_cbranch_vccz L_QKM_ok7
  buffer_load_dwordx4 v[12:15], v95, s[4:7], s96 offen offset:0 sc1
  s_nop 0
  buffer_load_dwordx4 v[16:19], v95, s[4:7], s96 offen offset:2048 sc1
  s_nop 0
  buffer_load_dwordx4 v[68:71], v95, s[4:7], s97 offen offset:0 sc1
  s_nop 0
  buffer_load_dwordx4 v[72:75], v95, s[4:7], s97 offen offset:2048 sc1
  s_nop 0
  s_branch L_QKM_ok7
L_QKM_g8:
  s_sub_u32 s24, s24, 1
  s_cbranch_scc1 L_FAIL
  s_add_u32 s60, s60, 256
  buffer_load_dwordx4 v[12:15], v95, s[4:7], s96 offen offset:0 sc1
  s_waitcnt vmcnt(0)
  v_cmp_eq_u32 vcc, -1, v12
  s_cbranch_vccnz L_QKM_g8
  v_mov_b32 v89, 0
  v_max3_u32 v89, v16, v68, v89
  v_max3_u32 v89, v72, v4, v89
  v_cmp_eq_u32 vcc, -1, v89
  s_cbranch_vccz L_QKM_ok8
  buffer_load_dwordx4 v[16:19], v95, s[4:7], s96 offen offset:2048 sc1
  s_nop 0
  buffer_load_dwordx4 v[68:71], v95, s[4:7], s97 offen offset:0 sc1
  s_nop 0
  buffer_load_dwordx4 v[72:75], v95, s[4:7], s97 offen offset:2048 sc1
  s_nop 0
  buffer_load_dwordx4 v[4:7], v95, s[4:7], s98 offen offset:0 sc1
  s_nop 0
  s_branch L_QKM_ok8
L_QKM_g9:
  s_sub_u32 s24, s24, 1
  s_cbranch_scc1 L_FAIL
  s_add_u32 s60, s60, 256
  buffer_load_dwordx4 v[16:19], v95, s[4:7], s96 offen offset:2048 sc1
  s_waitcnt vmcnt(0)
  v_cmp_eq_u32 vcc, -1, v16
  s_cbranch_vccnz L_QKM_g9
  v_mov_b32 v89, 0
  v_max3_u32 v89, v68, v72, v89
  v_max3_u32 v89, v4, v8, v89
  v_cmp_eq_u32 vcc, -1, v89
  s_cbranch_vccz L_QKM_ok9
  buffer_load_dwordx4 v[68:71], v95, s[4:7], s97 offen offset:0 sc1
  s_nop 0
  buffer_load_dwordx4 v[72:75], v95, s[4:7], s97 offen offset:2048 sc1
  s_nop 0
  buffer_load_dwordx4 v[4:7], v95, s[4:7], s98 offen offset:0 sc1
  s_nop 0
  buffer_load_dwordx4 v[8:11], v95, s[4:7], s98 offen offset:2048 sc1
  s_nop 0
  s_branch L_QKM_ok9
L_QKM_g10:
  s_sub_u32 s24, s24, 1
  s_cbranch_scc1 L_FAIL
  s_add_u32 s60, s60, 256
  buffer_load_dwordx4 v[68:71], v95, s[4:7], s97 offen offset:0 sc1
  s_waitcnt vmcnt(0)
  v_cmp_eq_u32 vcc, -1, v68
  s_cbranch_vccnz L_QKM_g10
  v_mov_b32 v89, 0
  v_max3_u32 v89, v72, v4, v89
  v_max3_u32 v89, v8, v12, v89
  v_cmp_eq_u32 vcc, -1, v89
  s_cbranch_vccz L_QKM_ok10
  buffer_load_dwordx4 v[72:75], v95, s[4:7], s97 offen offset:2048 sc1
  s_nop 0
  buffer_load_dwordx4 v[4:7], v95, s[4:7], s98 offen offset:0 sc1
  s_nop 0
  buffer_load_dwordx4 v[8:11], v95, s[4:7], s98 offen offset:2048 sc1
  s_nop 0
  buffer_load_dwordx4 v[12:15], v95, s[4:7], s99 offen offset:0 sc1
  s_nop 0
  s_branch L_QKM_ok10
L_QKM_g11:
  s_sub_u32 s24, s24, 1
  s_cbranch_scc1 L_FAIL
  s_add_u32 s60, s60, 256
  buffer_load_dwordx4 v[72:75], v95, s[4:7], s97 offen offset:2048 sc1
  s_waitcnt vmcnt(0)
  v_cmp_eq_u32 vcc, -1, v72
  s_cbranch_vccnz L_QKM_g11
  v_mov_b32 v89, 0
  v_max3_u32 v89, v4, v8, v89
  v_max3_u32 v89, v12, v16, v89
  v_cmp_eq_u32 vcc, -1, v89
  s_cbranch_vccz L_QKM_ok11
  buffer_load_dwordx4 v[4:7], v95, s[4:7], s98 offen offset:0 sc1
  s_nop 0
  buffer_load_dwordx4 v[8:11], v95, s[4:7], s98 offen offset:2048 sc1
  s_nop 0
  buffer_load_dwordx4 v[12:15], v95, s[4:7], s99 offen offset:0 sc1
  s_nop 0
  buffer_load_dwordx4 v[16:19], v95, s[4:7], s99 offen offset:2048 sc1
  s_nop 0
  s_branch L_QKM_ok11
L_QKM_g12:
  s_sub_u32 s24, s24, 1
  s_cbranch_scc1 L_FAIL
  s_add_u32 s60, s60, 256
  buffer_load_dwordx4 v[4:7], v95, s[4:7], s98 offen offset:0 sc1
  s_waitcnt vmcnt(0)
  v_cmp_eq_u32 vcc, -1, v4
  s_cbranch_vccnz L_QKM_g12
  v_mov_b32 v89, 0
  v_max3_u32 v89, v8, v12, v89
  v_max3_u32 v89, v16, v16, v89
  v_cmp_eq_u32 vcc, -1, v89
  s_cbranch_vccz L_QKM_ok12
  buffer_load_dwordx4 v[8:11], v95, s[4:7], s98 offen offset:2048 sc1
  s_nop 0
  buffer_load_dwordx4 v[12:15], v95, s[4:7], s99 offen offset:0 sc1
  s_nop 0
  buffer_load_dwordx4 v[16:19], v95, s[4:7], s99 offen offset:2048 sc1
  s_nop 0
  s_branch L_QKM_ok12
L_QKM_g13:
  s_sub_u32 s24, s24, 1
  s_cbranch_scc1 L_FAIL
  s_add_u32 s60, s60, 256
  buffer_load_dwordx4 v[8:11], v95, s[4:7], s98 offen offset:2048 sc1
  s_waitcnt vmcnt(0)
  v_cmp_eq_u32 vcc, -1, v8
  s_cbranch_vccnz L_QKM_g13
  v_mov_b32 v89, 0
  v_max3_u32 v89, v12, v16, v89
  v_cmp_eq_u32 vcc, -1, v89
  s_cbranch_vccz L_QKM_ok13
  buffer_load_dwordx4 v[12:15], v95, s[4:7], s99 offen offset:0 sc1
  s_nop 0
  buffer_load_dwordx4 v[16:19], v95, s[4:7], s99 offen offset:2048 sc1
  s_nop 0
  s_branch L_QKM_ok13
L_QKM_g14:
  s_sub_u32 s24, s24, 1
  s_cbranch_scc1 L_FAIL
  s_add_u32 s60, s60, 256
  buffer_load_dwordx4 v[12:15], v95, s[4:7], s99 offen offset:0 sc1
  s_waitcnt vmcnt(0)
  v_cmp_eq_u32 vcc, -1, v12
  s_cbranch_vccnz L_QKM_g14
  v_mov_b32 v89, 0
  v_max3_u32 v89, v16, v16, v89
  v_cmp_eq_u32 vcc, -1, v89
  s_cbranch_vccz L_QKM_ok14
  buffer_load_dwordx4 v[16:19], v95, s[4:7], s99 offen offset:2048 sc1
  s_nop 0
  s_branch L_QKM_ok14
L_QKM_g15:
  s_sub_u32 s24, s24, 1
  s_cbranch_scc1 L_FAIL
  s_add_u32 s60, s60, 256
  buffer_load_dwordx4 v[16:19], v95, s[4:7], s99 offen offset:2048 sc1
  s_waitcnt vmcnt(0)
  v_cmp_eq_u32 vcc, -1, v16
  s_cbranch_vccnz L_QKM_g15
  s_branch L_QKM_ok15
L_QK_vbad0:
  s_sub_u32 s24, s24, 1
  s_cbranch_scc1 L_FAIL
  s_add_u32 s61, s61, 1
  buffer_load_dwordx2 v[104:105], v92, s[4:7], s29 offen sc1
  s_waitcnt vmcnt(0)
  v_max_u32 v89, v104, v105
  v_cmp_eq_u32 vcc, -1, v89
  s_cbranch_vccnz L_QK_vbad0
  s_branch L_QK_vok0
L_QK_vbad1:
  s_sub_u32 s24, s24, 1
  s_cbranch_scc1 L_FAIL
  s_add_u32 s61, s61, 1
  buffer_load_dwordx2 v[106:107], v92, s[4:7], s35 offen sc1
  s_waitcnt vmcnt(0)
  v_max_u32 v89, v106, v107
  v_cmp_eq_u32 vcc, -1, v89
  s_cbranch_vccnz L_QK_vbad1
  s_branch L_QK_vok1
L_VO:
  v_bfe_u32 v76, v0, 3, 2
  v_xor_b32 v76, s20, v76
  v_lshlrev_b32 v76, 5, v76
  v_lshrrev_b32 v4, 2, v0
  v_lshl_add_u32 v4, v4, 7, v76
  v_and_b32 v76, 3, v0
  v_lshl_add_u32 v4, v76, 3, v4
  s_lshl_b32 s40, s20, 15
  v_add_u32 v4, s40, v4
  v_lshl_add_u32 v85, v0, 4, s40
  s_lshl_b32 s40, s20, 12
  s_add_u32 s40, s40, 131072
  v_lshl_add_u32 v1, v0, 4, s40
  s_lshr_b32 s54, s21, 4
  s_lshl_b32 s52, s54, 22
  s_sub_u32 s53, 0, s52
  v_xor_b32 v5, 32768, v4
  v_xor_b32 v2, 4096, v1
  v_xor_b32 v6, 65536, v4
  v_xor_b32 v3, 8192, v1
  v_xor_b32 v7, 98304, v4
  v_xor_b32 v84, 12288, v1
  v_bfe_u32 v8, v0, 5, 1
  v_mul_u32_u24 v8, 16384, v8
  v_bfe_u32 v76, v0, 4, 1
  v_mul_u32_u24 v76, 32768, v76
  v_add_u32 v8, v8, v76
  v_bfe_u32 v76, v0, 3, 1
  v_mul_u32_u24 v76, 131072, v76
  v_add_u32 v8, v8, v76
  v_lshrrev_b32 v76, 3, v0
  v_and_b32 v76, 6, v76
  v_xor_b32 v76, v76, v0
  v_and_b32 v76, 7, v76
  v_lshl_add_u32 v8, v76, 4, v8
  s_lshl_b32 s40, s20, 19
  v_add_u32 v8, s40, v8
  s_lshl_b32 s44, s21, 8
  s_add_u32 s45, s44, 128
  s_load_dwordx2 s[8:9], s[0:1], 32
  s_mov_b32 s10, 8388608
  s_mov_b32 s11, 0x20000
  s_waitcnt lgkmcnt(0)
  v_add_u32 v9, s44, v8
  v_add_u32 v10, s45, v8
  s_lshl_b32 s41, s20, 15
  s_and_b32 s40, s21, 3
  s_cmp_eq_u32 s40, 1
  s_cselect_b64 vcc, -1, 0
  s_add_u32 m0, s41, 0
  s_add_u32 s42, s52, 0
  buffer_load_dwordx4 v9, s[8:11], s42 offen lds
  s_add_u32 m0, s41, 1024
  s_add_u32 s42, s52, 65536
  buffer_load_dwordx4 v9, s[8:11], s42 offen lds
  s_add_u32 m0, s41, 2048
  s_add_u32 s42, s52, 8192
  buffer_load_dwordx4 v9, s[8:11], s42 offen lds
  s_add_u32 m0, s41, 3072
  s_add_u32 s42, s52, 73728
  buffer_load_dwordx4 v9, s[8:11], s42 offen lds
  s_add_u32 m0, s41, 4096
  s_add_u32 s42, s52, 262144
  buffer_load_dwordx4 v9, s[8:11], s42 offen lds
  s_add_u32 m0, s41, 5120
  s_add_u32 s42, s52, 327680
  buffer_load_dwordx4 v9, s[8:11], s42 offen lds
  s_add_u32 m0, s41, 6144
  s_add_u32 s42, s52, 270336
  buffer_load_dwordx4 v9, s[8:11], s42 offen lds
  s_add_u32 m0, s41, 7168
  s_add_u32 s42, s52, 335872
  buffer_load_dwordx4 v9, s[8:11], s42 offen lds
  s_add_u32 m0, s41, 8192
  s_add_u32 s42, s52, 2097152
  buffer_load_dwordx4 v9, s[8:11], s42 offen lds
  s_add_u32 m0, s41, 9216
  s_add_u32 s42, s52, 2162688
  buffer_load_dwordx4 v9, s[8:11], s42 offen lds
  s_add_u32 m0, s41, 10240
  s_add_u32 s42, s52, 2105344
  buffer_load_dwordx4 v9, s[8:11], s42 offen lds
  s_add_u32 m0, s41, 11264
  s_add_u32 s42, s52, 2170880
  buffer_load_dwordx4 v9, s[8:11], s42 offen lds
  s_add_u32 m0, s41, 12288
  s_add_u32 s42, s52, 2359296
  buffer_load_dwordx4 v9, s[8:11], s42 offen lds
  s_add_u32 m0, s41, 13312
  s_add_u32 s42, s52, 2424832
  buffer_load_dwordx4 v9, s[8:11], s42 offen lds
  s_add_u32 m0, s41, 14336
  s_add_u32 s42, s52, 2367488
  buffer_load_dwordx4 v9, s[8:11], s42 offen lds
  s_add_u32 m0, s41, 15360
  s_add_u32 s42, s52, 2433024
  buffer_load_dwordx4 v9, s[8:11], s42 offen lds
  s_add_u32 m0, s41, 16384
  s_add_u32 s42, s53, 4194304
  buffer_load_dwordx4 v9, s[8:11], s42 offen lds
  s_add_u32 m0, s41, 17408
  s_add_u32 s42, s53, 4259840
  buffer_load_dwordx4 v9, s[8:11], s42 offen lds
  s_add_u32 m0, s41, 18432
  s_add_u32 s42, s53, 4202496
  buffer_load_dwordx4 v9, s[8:11], s42 offen lds
  s_add_u32 m0, s41, 19456
  s_add_u32 s42, s53, 4268032
  buffer_load_dwordx4 v9, s[8:11], s42 offen lds
  s_add_u32 m0, s41, 20480
  s_add_u32 s42, s53, 4456448
  buffer_load_dwordx4 v9, s[8:11], s42 offen lds
  s_add_u32 m0, s41, 21504
  s_add_u32 s42, s53, 4521984
  buffer_load_dwordx4 v9, s[8:11], s42 offen lds
  s_add_u32 m0, s41, 22528
  s_add_u32 s42, s53, 4464640
  buffer_load_dwordx4 v9, s[8:11], s42 offen lds
  s_add_u32 m0, s41, 23552
  s_add_u32 s42, s53, 4530176
  buffer_load_dwordx4 v9, s[8:11], s42 offen lds
  s_waitcnt vmcnt(16) lgkmcnt(0)
  s_barrier
  s_add_u32 m0, s41, 24576
  s_add_u32 s42, s53, 6291456
  buffer_load_dwordx4 v9, s[8:11], s42 offen lds
  s_add_u32 m0, s41, 25600
  s_add_u32 s42, s53, 6356992
  buffer_load_dwordx4 v9, s[8:11], s42 offen lds
  s_add_u32 m0, s41, 26624
  s_add_u32 s42, s53, 6299648
  buffer_load_dwordx4 v9, s[8:11], s42 offen lds
  s_add_u32 m0, s41, 27648
  s_add_u32 s42, s53, 6365184
  buffer_load_dwordx4 v9, s[8:11], s42 offen lds
  s_add_u32 m0, s41, 28672
  s_add_u32 s42, s53, 6553600
  buffer_load_dwordx4 v9, s[8:11], s42 offen lds
  s_add_u32 m0, s41, 29696
  s_add_u32 s42, s53, 6619136
  buffer_load_dwordx4 v9, s[8:11], s42 offen lds
  s_add_u32 m0, s41, 30720
  s_add_u32 s42, s53, 6561792
  buffer_load_dwordx4 v9, s[8:11], s42 offen lds
  s_add_u32 m0, s41, 31744
  s_add_u32 s42, s53, 6627328
  buffer_load_dwordx4 v9, s[8:11], s42 offen lds
  ds_read_b64_tr_b16 v[128:129], v4 offset:0
  ds_read_b64_tr_b16 v[130:131], v4 offset:2048
  ds_read_b64_tr_b16 v[132:133], v4 offset:4096
  ds_read_b64_tr_b16 v[134:135], v4 offset:6144
  ds_read_b64_tr_b16 v[144:145], v5 offset:0
  ds_read_b64_tr_b16 v[146:147], v5 offset:2048
  ds_read_b64_tr_b16 v[148:149], v5 offset:4096
  ds_read_b64_tr_b16 v[150:151], v5 offset:6144
  ds_read_b64_tr_b16 v[160:161], v6 offset:0
  ds_read_b64_tr_b16 v[162:163], v6 offset:2048
  ds_read_b64_tr_b16 v[164:165], v6 offset:4096
  ds_read_b64_tr_b16 v[166:167], v6 offset:6144
  ds_read_b64_tr_b16 v[176:177], v7 offset:0
  ds_read_b64_tr_b16 v[178:179], v7 offset:2048
  ds_read_b64_tr_b16 v[180:181], v7 offset:4096
  ds_read_b64_tr_b16 v[182:183], v7 offset:6144
  s_waitcnt vmcnt(16) lgkmcnt(0)
  s_barrier
  s_add_u32 m0, s41, 0
  s_add_u32 s42, s52, 0
  buffer_load_dwordx4 v10, s[8:11], s42 offen lds
  s_add_u32 m0, s41, 1024
  s_add_u32 s42, s52, 65536
  buffer_load_dwordx4 v10, s[8:11], s42 offen lds
  s_add_u32 m0, s41, 2048
  s_add_u32 s42, s52, 8192
  buffer_load_dwordx4 v10, s[8:11], s42 offen lds
  s_add_u32 m0, s41, 3072
  s_add_u32 s42, s52, 73728
  buffer_load_dwordx4 v10, s[8:11], s42 offen lds
  s_add_u32 m0, s41, 4096
  s_add_u32 s42, s52, 262144
  buffer_load_dwordx4 v10, s[8:11], s42 offen lds
  s_add_u32 m0, s41, 5120
  s_add_u32 s42, s52, 327680
  buffer_load_dwordx4 v10, s[8:11], s42 offen lds
  s_add_u32 m0, s41, 6144
  s_add_u32 s42, s52, 270336
  buffer_load_dwordx4 v10, s[8:11], s42 offen lds
  s_add_u32 m0, s41, 7168
  s_add_u32 s42, s52, 335872
  buffer_load_dwordx4 v10, s[8:11], s42 offen lds
  ds_read_b64_tr_b16 v[136:137], v4 offset:8192
  ds_read_b64_tr_b16 v[138:139], v4 offset:10240
  ds_read_b64_tr_b16 v[140:141], v4 offset:12288
  ds_read_b64_tr_b16 v[142:143], v4 offset:14336
  ds_read_b64_tr_b16 v[152:153], v5 offset:8192
  ds_read_b64_tr_b16 v[154:155], v5 offset:10240
  ds_read_b64_tr_b16 v[156:157], v5 offset:12288
  ds_read_b64_tr_b16 v[158:159], v5 offset:14336
  ds_read_b64_tr_b16 v[168:169], v6 offset:8192
  ds_read_b64_tr_b16 v[170:171], v6 offset:10240
  ds_read_b64_tr_b16 v[172:173], v6 offset:12288
  ds_read_b64_tr_b16 v[174:175], v6 offset:14336
  ds_read_b64_tr_b16 v[184:185], v7 offset:8192
  ds_read_b64_tr_b16 v[186:187], v7 offset:10240
  ds_read_b64_tr_b16 v[188:189], v7 offset:12288
  ds_read_b64_tr_b16 v[190:191], v7 offset:14336
  s_waitcnt vmcnt(16) lgkmcnt(0)
  s_barrier
  s_add_u32 m0, s41, 8192
  s_add_u32 s42, s52, 2097152
  buffer_load_dwordx4 v10, s[8:11], s42 offen lds
  s_add_u32 m0, s41, 9216
  s_add_u32 s42, s52, 2162688
  buffer_load_dwordx4 v10, s[8:11], s42 offen lds
  s_add_u32 m0, s41, 10240
  s_add_u32 s42, s52, 2105344
  buffer_load_dwordx4 v10, s[8:11], s42 offen lds
  s_add_u32 m0, s41, 11264
  s_add_u32 s42, s52, 2170880
  buffer_load_dwordx4 v10, s[8:11], s42 offen lds
  s_add_u32 m0, s41, 12288
  s_add_u32 s42, s52, 2359296
  buffer_load_dwordx4 v10, s[8:11], s42 offen lds
  s_add_u32 m0, s41, 13312
  s_add_u32 s42, s52, 2424832
  buffer_load_dwordx4 v10, s[8:11], s42 offen lds
  s_add_u32 m0, s41, 14336
  s_add_u32 s42, s52, 2367488
  buffer_load_dwordx4 v10, s[8:11], s42 offen lds
  s_add_u32 m0, s41, 15360
  s_add_u32 s42, s52, 2433024
  buffer_load_dwordx4 v10, s[8:11], s42 offen lds
  ds_read_b64_tr_b16 v[192:193], v4 offset:16384
  ds_read_b64_tr_b16 v[194:195], v4 offset:18432
  ds_read_b64_tr_b16 v[196:197], v4 offset:20480
  ds_read_b64_tr_b16 v[198:199], v4 offset:22528
  ds_read_b64_tr_b16 v[208:209], v5 offset:16384
  ds_read_b64_tr_b16 v[210:211], v5 offset:18432
  ds_read_b64_tr_b16 v[212:213], v5 offset:20480
  ds_read_b64_tr_b16 v[214:215], v5 offset:22528
  ds_read_b64_tr_b16 v[224:225], v6 offset:16384
  ds_read_b64_tr_b16 v[226:227], v6 offset:18432
  ds_read_b64_tr_b16 v[228:229], v6 offset:20480
  ds_read_b64_tr_b16 v[230:231], v6 offset:22528
  ds_read_b64_tr_b16 v[240:241], v7 offset:16384
  ds_read_b64_tr_b16 v[242:243], v7 offset:18432
  ds_read_b64_tr_b16 v[244:245], v7 offset:20480
  ds_read_b64_tr_b16 v[246:247], v7 offset:22528
  s_waitcnt vmcnt(16) lgkmcnt(0)
  s_barrier
  s_add_u32 m0, s41, 16384
  s_add_u32 s42, s53, 4194304
  buffer_load_dwordx4 v10, s[8:11], s42 offen lds
  s_add_u32 m0, s41, 17408
  s_add_u32 s42, s53, 4259840
  buffer_load_dwordx4 v10, s[8:11], s42 offen lds
  s_add_u32 m0, s41, 18432
  s_add_u32 s42, s53, 4202496
  buffer_load_dwordx4 v10, s[8:11], s42 offen lds
  s_add_u32 m0, s41, 19456
  s_add_u32 s42, s53, 4268032
  buffer_load_dwordx4 v10, s[8:11], s42 offen lds
  s_add_u32 m0, s41, 20480
  s_add_u32 s42, s53, 4456448
  buffer_load_dwordx4 v10, s[8:11], s42 offen lds
  s_add_u32 m0, s41, 21504
  s_add_u32 s42, s53, 4521984
  buffer_load_dwordx4 v10, s[8:11], s42 offen lds
  s_add_u32 m0, s41, 22528
  s_add_u32 s42, s53, 4464640
  buffer_load_dwordx4 v10, s[8:11], s42 offen lds
  s_add_u32 m0, s41, 23552
  s_add_u32 s42, s53, 4530176
  buffer_load_dwordx4 v10, s[8:11], s42 offen lds
  ds_read_b64_tr_b16 v[200:201], v4 offset:24576
  ds_read_b64_tr_b16 v[202:203], v4 offset:26624
  ds_read_b64_tr_b16 v[204:205], v4 offset:28672
  ds_read_b64_tr_b16 v[206:207], v4 offset:30720
  ds_read_b64_tr_b16 v[216:217], v5 offset:24576
  ds_read_b64_tr_b16 v[218:219], v5 offset:26624
  ds_read_b64_tr_b16 v[220:221], v5 offset:28672
  ds_read_b64_tr_b16 v[222:223], v5 offset:30720
  ds_read_b64_tr_b16 v[232:233], v6 offset:24576
  ds_read_b64_tr_b16 v[234:235], v6 offset:26624
  ds_read_b64_tr_b16 v[236:237], v6 offset:28672
  ds_read_b64_tr_b16 v[238:239], v6 offset:30720
  ds_read_b64_tr_b16 v[248:249], v7 offset:24576
  ds_read_b64_tr_b16 v[250:251], v7 offset:26624
  ds_read_b64_tr_b16 v[252:253], v7 offset:28672
  ds_read_b64_tr_b16 v[254:255], v7 offset:30720
  s_cmp_lg_u32 s20, 0
  s_cbranch_scc1 Lchore_166
Lini_167:
  s_load_dwordx16 s[64:79], s[12:13], 128 glc
  s_load_dwordx16 s[80:95], s[12:13], 192 glc
  s_sub_u32 s24, s24, 1
  s_cbranch_scc1 L_FAIL
  s_waitcnt lgkmcnt(0)
  s_and_b64 s[64:65], s[64:65], s[66:67]
  s_and_b64 s[64:65], s[64:65], s[68:69]
  s_and_b64 s[64:65], s[64:65], s[70:71]
  s_and_b64 s[64:65], s[64:65], s[72:73]
  s_and_b64 s[64:65], s[64:65], s[74:75]
  s_and_b64 s[64:65], s[64:65], s[76:77]
  s_and_b64 s[64:65], s[64:65], s[78:79]
  s_and_b64 s[64:65], s[64:65], s[80:81]
  s_and_b64 s[64:65], s[64:65], s[82:83]
  s_and_b64 s[64:65], s[64:65], s[84:85]
  s_and_b64 s[64:65], s[64:65], s[86:87]
  s_and_b64 s[64:65], s[64:65], s[88:89]
  s_and_b64 s[64:65], s[64:65], s[90:91]
  s_and_b64 s[64:65], s[64:65], s[92:93]
  s_and_b64 s[64:65], s[64:65], s[94:95]
  s_and_b32 s64, s64, s65
  s_cbranch_scc0 Lini_167
  s_mov_b32 s46, 0xffff
  s_and_b32 s40, s21, 3
  s_lshl_b32 s40, s40, 13
  s_lshr_b32 s43, s21, 2
  s_lshl_b32 s43, s43, 10
  s_add_u32 s43, s43, s40
  s_add_u32 s43, s43, 1344000
  s_waitcnt lgkmcnt(0)
  s_memtime s[64:65]
  s_waitcnt lgkmcnt(0)
  s_load_dword s68, s[4:5], s43 glc
  s_waitcnt lgkmcnt(0)
  s_memtime s[66:67]
  s_waitcnt lgkmcnt(0)
  s_sub_u32 s64, s66, s64
  s_min_u32 s46, s46, s64
  s_getreg_b32 s55, hwreg(HW_REG_XCC_ID)
  s_and_b32 s55, s55, 15
  s_lshl_b32 s46, s46, 8
  s_or_b32 s46, s46, s55
  s_add_u32 s40, s21, 32
  s_lshl_b32 s40, s40, 7
  s_add_u32 s40, s40, 1424384
  s_mov_b32 s63, s46
  s_atomic_smax s63, s[4:5], s40 glc
Lnosig_168:
Lchore_166:
  s_waitcnt vmcnt(16) lgkmcnt(0)
  s_barrier
  s_add_u32 m0, s41, 24576
  s_add_u32 s42, s53, 6291456
  buffer_load_dwordx4 v10, s[8:11], s42 offen lds
  s_add_u32 m0, s41, 25600
  s_add_u32 s42, s53, 6356992
  buffer_load_dwordx4 v10, s[8:11], s42 offen lds
  s_add_u32 m0, s41, 26624
  s_add_u32 s42, s53, 6299648
  buffer_load_dwordx4 v10, s[8:11], s42 offen lds
  s_add_u32 m0, s41, 27648
  s_add_u32 s42, s53, 6365184
  buffer_load_dwordx4 v10, s[8:11], s42 offen lds
  s_add_u32 m0, s41, 28672
  s_add_u32 s42, s53, 6553600
  buffer_load_dwordx4 v10, s[8:11], s42 offen lds
  s_add_u32 m0, s41, 29696
  s_add_u32 s42, s53, 6619136
  buffer_load_dwordx4 v10, s[8:11], s42 offen lds
  s_add_u32 m0, s41, 30720
  s_add_u32 s42, s53, 6561792
  buffer_load_dwordx4 v10, s[8:11], s42 offen lds
  s_add_u32 m0, s41, 31744
  s_add_u32 s42, s53, 6627328
  buffer_load_dwordx4 v10, s[8:11], s42 offen lds
  ds_read_b64_tr_b16 v[20:21], v4 offset:0
  ds_read_b64_tr_b16 v[22:23], v4 offset:2048
  ds_read_b64_tr_b16 v[24:25], v4 offset:4096
  ds_read_b64_tr_b16 v[26:27], v4 offset:6144
  ds_read_b64_tr_b16 v[28:29], v5 offset:0
  ds_read_b64_tr_b16 v[30:31], v5 offset:2048
  ds_read_b64_tr_b16 v[32:33], v5 offset:4096
  ds_read_b64_tr_b16 v[34:35], v5 offset:6144
  ds_read_b64_tr_b16 v[36:37], v6 offset:0
  ds_read_b64_tr_b16 v[38:39], v6 offset:2048
  ds_read_b64_tr_b16 v[40:41], v6 offset:4096
  ds_read_b64_tr_b16 v[42:43], v6 offset:6144
  ds_read_b64_tr_b16 v[44:45], v7 offset:0
  ds_read_b64_tr_b16 v[46:47], v7 offset:2048
  ds_read_b64_tr_b16 v[48:49], v7 offset:4096
  ds_read_b64_tr_b16 v[50:51], v7 offset:6144
  s_waitcnt lgkmcnt(0)
  s_barrier
  ds_write_b128 v85, v[20:23] offset:0
  ds_write_b128 v85, v[24:27] offset:1024
  ds_write_b128 v85, v[28:31] offset:2048
  ds_write_b128 v85, v[32:35] offset:3072
  ds_write_b128 v85, v[36:39] offset:4096
  ds_write_b128 v85, v[40:43] offset:5120
  ds_write_b128 v85, v[44:47] offset:6144
  ds_write_b128 v85, v[48:51] offset:7168
  s_waitcnt vmcnt(16) lgkmcnt(0)
  s_barrier
  ds_read_b64_tr_b16 v[20:21], v4 offset:8192
  ds_read_b64_tr_b16 v[22:23], v4 offset:10240
  ds_read_b64_tr_b16 v[24:25], v4 offset:12288
  ds_read_b64_tr_b16 v[26:27], v4 offset:14336
  ds_read_b64_tr_b16 v[28:29], v5 offset:8192
  ds_read_b64_tr_b16 v[30:31], v5 offset:10240
  ds_read_b64_tr_b16 v[32:33], v5 offset:12288
  ds_read_b64_tr_b16 v[34:35], v5 offset:14336
  ds_read_b64_tr_b16 v[36:37], v6 offset:8192
  ds_read_b64_tr_b16 v[38:39], v6 offset:10240
  ds_read_b64_tr_b16 v[40:41], v6 offset:12288
  ds_read_b64_tr_b16 v[42:43], v6 offset:14336
  ds_read_b64_tr_b16 v[44:45], v7 offset:8192
  ds_read_b64_tr_b16 v[46:47], v7 offset:10240
  ds_read_b64_tr_b16 v[48:49], v7 offset:12288
  ds_read_b64_tr_b16 v[50:51], v7 offset:14336
  s_waitcnt lgkmcnt(0)
  s_barrier
  ds_write_b128 v85, v[20:23] offset:8192
  ds_write_b128 v85, v[24:27] offset:9216
  ds_write_b128 v85, v[28:31] offset:10240
  ds_write_b128 v85, v[32:35] offset:11264
  ds_write_b128 v85, v[36:39] offset:12288
  ds_write_b128 v85, v[40:43] offset:13312
  ds_write_b128 v85, v[44:47] offset:14336
  ds_write_b128 v85, v[48:51] offset:15360
  s_waitcnt vmcnt(8) lgkmcnt(0)
  s_barrier
  ds_read_b64_tr_b16 v[20:21], v4 offset:16384
  ds_read_b64_tr_b16 v[22:23], v4 offset:18432
  ds_read_b64_tr_b16 v[24:25], v4 offset:20480
  ds_read_b64_tr_b16 v[26:27], v4 offset:22528
  ds_read_b64_tr_b16 v[28:29], v5 offset:16384
  ds_read_b64_tr_b16 v[30:31], v5 offset:18432
  ds_read_b64_tr_b16 v[32:33], v5 offset:20480
  ds_read_b64_tr_b16 v[34:35], v5 offset:22528
  ds_read_b64_tr_b16 v[36:37], v6 offset:16384
  ds_read_b64_tr_b16 v[38:39], v6 offset:18432
  ds_read_b64_tr_b16 v[40:41], v6 offset:20480
  ds_read_b64_tr_b16 v[42:43], v6 offset:22528
  ds_read_b64_tr_b16 v[44:45], v7 offset:16384
  ds_read_b64_tr_b16 v[46:47], v7 offset:18432
  ds_read_b64_tr_b16 v[48:49], v7 offset:20480
  ds_read_b64_tr_b16 v[50:51], v7 offset:22528
  s_waitcnt lgkmcnt(0)
  s_barrier
  ds_write_b128 v85, v[20:23] offset:16384
  ds_write_b128 v85, v[24:27] offset:17408
  ds_write_b128 v85, v[28:31] offset:18432
  ds_write_b128 v85, v[32:35] offset:19456
  ds_write_b128 v85, v[36:39] offset:20480
  ds_write_b128 v85, v[40:43] offset:21504
  ds_write_b128 v85, v[44:47] offset:22528
  ds_write_b128 v85, v[48:51] offset:23552
  s_waitcnt vmcnt(0) lgkmcnt(0)
  s_barrier
  ds_read_b64_tr_b16 v[20:21], v4 offset:24576
  ds_read_b64_tr_b16 v[22:23], v4 offset:26624
  ds_read_b64_tr_b16 v[24:25], v4 offset:28672
  ds_read_b64_tr_b16 v[26:27], v4 offset:30720
  ds_read_b64_tr_b16 v[28:29], v5 offset:24576
  ds_read_b64_tr_b16 v[30:31], v5 offset:26624
  ds_read_b64_tr_b16 v[32:33], v5 offset:28672
  ds_read_b64_tr_b16 v[34:35], v5 offset:30720
  ds_read_b64_tr_b16 v[36:37], v6 offset:24576
  ds_read_b64_tr_b16 v[38:39], v6 offset:26624
  ds_read_b64_tr_b16 v[40:41], v6 offset:28672
  ds_read_b64_tr_b16 v[42:43], v6 offset:30720
  ds_read_b64_tr_b16 v[44:45], v7 offset:24576
  ds_read_b64_tr_b16 v[46:47], v7 offset:26624
  ds_read_b64_tr_b16 v[48:49], v7 offset:28672
  ds_read_b64_tr_b16 v[50:51], v7 offset:30720
  s_waitcnt lgkmcnt(0)
  s_barrier
  ds_write_b128 v85, v[20:23] offset:24576
  ds_write_b128 v85, v[24:27] offset:25600
  ds_write_b128 v85, v[28:31] offset:26624
  ds_write_b128 v85, v[32:35] offset:27648
  ds_write_b128 v85, v[36:39] offset:28672
  ds_write_b128 v85, v[40:43] offset:29696
  ds_write_b128 v85, v[44:47] offset:30720
  ds_write_b128 v85, v[48:51] offset:31744
  s_waitcnt lgkmcnt(0)
  s_lshr_b32 s40, s21, 1
  s_lshl_b32 s40, s40, 2
  v_min_u32 v76, 3, v0
  v_add_u32 v76, s40, v76
  v_lshlrev_b32 v76, 7, v76
  v_add_u32 v76, 1432576, v76
  s_nop 1
Lpoll_169:
  buffer_load_dword v77, v76, s[4:7], 0 offen sc1
  s_sub_u32 s24, s24, 1
  s_cbranch_scc1 L_FAIL
  s_waitcnt vmcnt(0)
  v_cmp_gt_i32 vcc, 1, v77
  s_cbranch_vccz Lpolld_170
  s_sleep 1
  s_branch Lpoll_169
Lpolld_170:
  s_lshl_b32 s40, s21, 18
  s_lshl_b32 s41, s20, 15
  s_add_u32 s40, s40, s41
  v_lshl_add_u32 v76, v0, 4, s40
  s_add_u32 s50, s21, s20
  s_and_b32 s50, s50, 3
  s_lshl_b32 s41, s54, 5
  s_add_u32 s41, s41, s50
  s_lshl_b32 s41, s41, 12
  s_xor_b32 s40, s41, 0
  s_add_u32 s40, s40, 10485760
  buffer_load_dwordx4 a[0:3], v76, s[4:7], s40 offen offset:0 sc1
  buffer_load_dwordx4 a[4:7], v76, s[4:7], s40 offen offset:1024 sc1
  buffer_load_dwordx4 a[8:11], v76, s[4:7], s40 offen offset:2048 sc1
  buffer_load_dwordx4 a[12:15], v76, s[4:7], s40 offen offset:3072 sc1
  s_waitcnt vmcnt(32)
  s_xor_b32 s40, s41, 4096
  s_add_u32 s40, s40, 10485760
  buffer_load_dwordx4 a[16:19], v76, s[4:7], s40 offen offset:0 sc1
  buffer_load_dwordx4 a[20:23], v76, s[4:7], s40 offen offset:1024 sc1
  buffer_load_dwordx4 a[24:27], v76, s[4:7], s40 offen offset:2048 sc1
  buffer_load_dwordx4 a[28:31], v76, s[4:7], s40 offen offset:3072 sc1
  s_waitcnt vmcnt(32)
  s_xor_b32 s40, s41, 8192
  s_add_u32 s40, s40, 10485760
  buffer_load_dwordx4 a[32:35], v76, s[4:7], s40 offen offset:0 sc1
  buffer_load_dwordx4 a[36:39], v76, s[4:7], s40 offen offset:1024 sc1
  buffer_load_dwordx4 a[40:43], v76, s[4:7], s40 offen offset:2048 sc1
  buffer_load_dwordx4 a[44:47], v76, s[4:7], s40 offen offset:3072 sc1
  s_waitcnt vmcnt(32)
  s_xor_b32 s40, s41, 12288
  s_add_u32 s40, s40, 10485760
  buffer_load_dwordx4 a[48:51], v76, s[4:7], s40 offen offset:0 sc1
  buffer_load_dwordx4 a[52:55], v76, s[4:7], s40 offen offset:1024 sc1
  buffer_load_dwordx4 a[56:59], v76, s[4:7], s40 offen offset:2048 sc1
  buffer_load_dwordx4 a[60:63], v76, s[4:7], s40 offen offset:3072 sc1
  s_waitcnt vmcnt(32)
  s_xor_b32 s40, s41, 16384
  s_add_u32 s40, s40, 10485760
  buffer_load_dwordx4 a[64:67], v76, s[4:7], s40 offen offset:0 sc1
  buffer_load_dwordx4 a[68:71], v76, s[4:7], s40 offen offset:1024 sc1
  buffer_load_dwordx4 a[72:75], v76, s[4:7], s40 offen offset:2048 sc1
  buffer_load_dwordx4 a[76:79], v76, s[4:7], s40 offen offset:3072 sc1
  s_waitcnt vmcnt(32)
  s_xor_b32 s40, s41, 20480
  s_add_u32 s40, s40, 10485760
  buffer_load_dwordx4 a[80:83], v76, s[4:7], s40 offen offset:0 sc1
  buffer_load_dwordx4 a[84:87], v76, s[4:7], s40 offen offset:1024 sc1
  buffer_load_dwordx4 a[88:91], v76, s[4:7], s40 offen offset:2048 sc1
  buffer_load_dwordx4 a[92:95], v76, s[4:7], s40 offen offset:3072 sc1
  s_waitcnt vmcnt(32)
  s_xor_b32 s40, s41, 24576
  s_add_u32 s40, s40, 10485760
  buffer_load_dwordx4 a[96:99], v76, s[4:7], s40 offen offset:0 sc1
  buffer_load_dwordx4 a[100:103], v76, s[4:7], s40 offen offset:1024 sc1
  buffer_load_dwordx4 a[104:107], v76, s[4:7], s40 offen offset:2048 sc1
  buffer_load_dwordx4 a[108:111], v76, s[4:7], s40 offen offset:3072 sc1
  s_waitcnt vmcnt(32)
  s_xor_b32 s40, s41, 28672
  s_add_u32 s40, s40, 10485760
  buffer_load_dwordx4 a[112:115], v76, s[4:7], s40 offen offset:0 sc1
  buffer_load_dwordx4 a[116:119], v76, s[4:7], s40 offen offset:1024 sc1
  buffer_load_dwordx4 a[120:123], v76, s[4:7], s40 offen offset:2048 sc1
  buffer_load_dwordx4 a[124:127], v76, s[4:7], s40 offen offset:3072 sc1
  s_waitcnt vmcnt(32)
  s_xor_b32 s40, s41, 131072
  s_add_u32 s40, s40, 10485760
  buffer_load_dwordx4 a[128:131], v76, s[4:7], s40 offen offset:0 sc1
  buffer_load_dwordx4 a[132:135], v76, s[4:7], s40 offen offset:1024 sc1
  buffer_load_dwordx4 a[136:139], v76, s[4:7], s40 offen offset:2048 sc1
  buffer_load_dwordx4 a[140:143], v76, s[4:7], s40 offen offset:3072 sc1
  s_waitcnt vmcnt(32)
  s_xor_b32 s40, s41, 135168
  s_add_u32 s40, s40, 10485760
  buffer_load_dwordx4 a[144:147], v76, s[4:7], s40 offen offset:0 sc1
  buffer_load_dwordx4 a[148:151], v76, s[4:7], s40 offen offset:1024 sc1
  buffer_load_dwordx4 a[152:155], v76, s[4:7], s40 offen offset:2048 sc1
  buffer_load_dwordx4 a[156:159], v76, s[4:7], s40 offen offset:3072 sc1
  s_waitcnt vmcnt(32)
  s_xor_b32 s40, s41, 139264
  s_add_u32 s40, s40, 10485760
  buffer_load_dwordx4 a[160:163], v76, s[4:7], s40 offen offset:0 sc1
  buffer_load_dwordx4 a[164:167], v76, s[4:7], s40 offen offset:1024 sc1
  buffer_load_dwordx4 a[168:171], v76, s[4:7], s40 offen offset:2048 sc1
  buffer_load_dwordx4 a[172:175], v76, s[4:7], s40 offen offset:3072 sc1
  s_waitcnt vmcnt(32)
  s_xor_b32 s40, s41, 143360
  s_add_u32 s40, s40, 10485760
  buffer_load_dwordx4 a[176:179], v76, s[4:7], s40 offen offset:0 sc1
  buffer_load_dwordx4 a[180:183], v76, s[4:7], s40 offen offset:1024 sc1
  buffer_load_dwordx4 a[184:187], v76, s[4:7], s40 offen offset:2048 sc1
  buffer_load_dwordx4 a[188:191], v76, s[4:7], s40 offen offset:3072 sc1
  s_waitcnt vmcnt(32)
  s_xor_b32 s40, s41, 147456
  s_add_u32 s40, s40, 10485760
  buffer_load_dwordx4 a[192:195], v76, s[4:7], s40 offen offset:0 sc1
  buffer_load_dwordx4 a[196:199], v76, s[4:7], s40 offen offset:1024 sc1
  buffer_load_dwordx4 a[200:203], v76, s[4:7], s40 offen offset:2048 sc1
  buffer_load_dwordx4 a[204:207], v76, s[4:7], s40 offen offset:3072 sc1
  s_waitcnt vmcnt(32)
  s_xor_b32 s40, s41, 151552
  s_add_u32 s40, s40, 10485760
  buffer_load_dwordx4 a[208:211], v76, s[4:7], s40 offen offset:0 sc1
  buffer_load_dwordx4 a[212:215], v76, s[4:7], s40 offen offset:1024 sc1
  buffer_load_dwordx4 a[216:219], v76, s[4:7], s40 offen offset:2048 sc1
  buffer_load_dwordx4 a[220:223], v76, s[4:7], s40 offen offset:3072 sc1
  s_waitcnt vmcnt(32)
  s_xor_b32 s40, s41, 155648
  s_add_u32 s40, s40, 10485760
  buffer_load_dwordx4 a[224:227], v76, s[4:7], s40 offen offset:0 sc1
  buffer_load_dwordx4 a[228:231], v76, s[4:7], s40 offen offset:1024 sc1
  buffer_load_dwordx4 a[232:235], v76, s[4:7], s40 offen offset:2048 sc1
  buffer_load_dwordx4 a[236:239], v76, s[4:7], s40 offen offset:3072 sc1
  s_waitcnt vmcnt(32)
  s_xor_b32 s40, s41, 159744
  s_add_u32 s40, s40, 10485760
  buffer_load_dwordx4 a[240:243], v76, s[4:7], s40 offen offset:0 sc1
  buffer_load_dwordx4 a[244:247], v76, s[4:7], s40 offen offset:1024 sc1
  buffer_load_dwordx4 a[248:251], v76, s[4:7], s40 offen offset:2048 sc1
  buffer_load_dwordx4 a[252:255], v76, s[4:7], s40 offen offset:3072 sc1
  s_waitcnt vmcnt(32)
  s_cmp_lg_u32 s20, 2
  s_cbranch_scc1 Lnotlb_171
  v_lshlrev_b32 v77, 21, v0
  s_mov_b32 s40, 0x1fff80
  buffer_load_dword v78, v77, s[4:7], s40 offen sc1
  s_add_u32 s40, s40, 134217728
  buffer_load_dword v78, v77, s[4:7], s40 offen sc1
  s_waitcnt vmcnt(0)
Lnotlb_171:
  s_getreg_b32 s55, hwreg(HW_REG_XCC_ID)
  s_and_b32 s55, s55, 15
  v_min_u32 v76, 63, v0
  v_lshlrev_b32 v76, 7, v76
  v_add_u32 v76, 1424384, v76
  s_nop 1
Lpoll_172:
  buffer_load_dword v77, v76, s[4:7], 0 offen sc1
  s_sub_u32 s24, s24, 1
  s_cbranch_scc1 L_FAIL
  s_waitcnt vmcnt(0)
  v_cmp_gt_i32 vcc, 0, v77
  s_cbranch_vccz Lpolld_173
  s_sleep 1
  s_branch Lpoll_172
Lpolld_173:
  v_and_b32 v78, 15, v77
  v_cmp_ne_u32 vcc, s55, v78
  s_lshl_b32 s40, s54, 4
  s_lshl_b32 s40, 0xffff, s40
  s_or_b32 s41, vcc_lo, vcc_hi
  s_and_b32 s40, s40, s41
  s_cselect_b32 s36, 0, 8192
  v_lshrrev_b32 v77, 8, v77
  v_and_b32 v78, 3, v0
  v_lshl_or_b32 v77, v77, 2, v78
  s_nop 1
  v_min_u32_dpp v77, v77, v77 row_ror:8 row_mask:0xf bank_mask:0xf
  s_nop 1
  v_min_u32_dpp v77, v77, v77 row_ror:4 row_mask:0xf bank_mask:0xf
  v_mov_b32 v78, v77
  s_nop 1
  v_permlane16_swap_b32 v78, v77
  v_min_u32 v77, v77, v78
  v_mov_b32 v78, v77
  s_nop 1
  v_permlane32_swap_b32 v78, v77
  v_min_u32 v77, v77, v78
  s_nop 1
  v_min_u32_dpp v77, v77, v77 row_ror:2 row_mask:0xf bank_mask:0xf
  s_nop 1
  v_min_u32_dpp v77, v77, v77 row_ror:1 row_mask:0xf bank_mask:0xf
  s_nop 0
  v_readfirstlane_b32 s26, v77
  s_and_b32 s26, s26, 3
  s_lshl_b32 s26, s26, 13
  s_lshr_b32 s40, s20, 1
  s_mul_i32 s40, s40, 32768
  s_and_b32 s41, s20, 1
  s_lshl_b32 s41, s41, 10
  s_add_u32 s40, s40, s41
  s_lshl_b32 s41, s54, 12
  s_add_u32 s40, s40, s41
  v_lshl_add_u32 v86, v0, 4, s40
  v_xor_b32 v87, 0x1000, v86
  v_and_b32 v76, 2, v0
  v_cmp_eq_u32 vcc, 0, v76
  v_mov_b32 v76, 0xeeee
  v_mov_b32 v77, 0x4444
  v_cndmask_b32 v88, v76, v77, vcc
  s_lshr_b32 s40, s21, 2
  s_mul_i32 s40, s40, 32768
  s_and_b32 s41, s21, 3
  s_lshl_b32 s41, s41, 11
  s_add_u32 s47, s40, s41
  s_lshl_b32 s41, s20, 9
  s_add_u32 s47, s47, s41
  v_lshl_add_u32 v92, v0, 3, s47
  s_lshl_b32 s41, s54, 12
  s_add_u32 s40, s41, 1310720
  s_add_u32 s40, s40, s26
  v_lshrrev_b32 v76, 2, v0
  v_lshl_add_u32 v76, v76, 7, s40
  v_and_b32 v77, 3, v0
  v_lshl_add_u32 v90, v77, 2, v76
  s_mov_b32 s57, s40
  s_cmp_eq_u32 s36, 0
  s_cselect_b32 s56, 1, s20
  s_and_b32 s41, s21, 15
  s_lshl_b32 s41, s41, 7
  s_lshl_b32 s40, s20, 2
  s_add_u32 s40, s40, s41
  s_add_u32 s40, s40, 0
  s_mov_b32 s25, 0
  s_mov_b32 s60, 0
  s_mov_b32 s61, 0
  s_mov_b32 s51, -1
  v_mov_b32 v91, 2147483392
  s_mov_b64 exec, 1
  v_mov_b32 v91, s40
  s_mov_b64 exec, -1
  v_mov_b32 v80, -1
  v_mov_b32 v81, -1
  v_mov_b32 v82, -1
  v_mov_b32 v83, -1
  s_mul_i32 s40, s20, 32768
  s_and_b32 s41, s50, 3
  s_lshl_b32 s41, s41, 10
  s_add_u32 s40, s40, s41
  v_lshl_add_u32 v111, v0, 4, s40
  v_xor_b32 v112, 0x400, v111
  v_xor_b32 v113, 0x800, v111
  v_xor_b32 v114, 0xc00, v111
  s_mul_i32 s58, s54, 131072
  s_and_b32 s41, s50, 4
  s_lshl_b32 s41, s41, 10
  s_add_u32 s58, s58, s41
  s_bfe_u32 s40, s21, 0x20002
  s_lshl_b32 s40, s40, 7
  s_and_b32 s41, s21, 3
  s_lshl_b32 s41, s41, 4
  s_add_u32 s40, s40, s41
  s_lshl_b32 s41, s20, 2
  s_add_u32 s41, s41, s40
  s_cmp_eq_u32 s20, 0
  s_cselect_b32 s40, s40, s41
  s_mov_b64 exec, 1
  v_mov_b32 v91, s40
  s_mov_b64 exec, -1
  s_mul_i32 s40, s20, 512
  v_add_u32 v90, s40, v90
  v_bfe_u32 v76, v0, 2, 2
  v_xor_b32 v76, s20, v76
  v_lshlrev_b32 v76, 3, v76
  v_lshl_add_u32 v76, v0, 5, v76
  v_add_u32 v95, 147456, v76
  s_and_b32 s40, s20, 1
  s_lshl_b32 s40, s40, 3
  v_bfe_u32 v4, v0, 2, 3
  v_add_u32 v4, s40, v4
  s_lshr_b32 s40, s20, 1
  s_lshl_b32 s40, s40, 3
  v_and_b32 v5, 3, v0
  v_add_u32 v5, s40, v5
  v_bfe_u32 v76, v4, 1, 1
  v_lshl_add_u32 v5, v76, 2, v5
  v_lshrrev_b32 v76, 2, v4
  v_and_b32 v77, 1, v4
  v_lshl_add_u32 v78, v76, 4, v5
  v_lshlrev_b32 v78, 5, v78
  v_mul_u32_u24 v77, 2064, v77
  v_add_u32 v78, v77, v78
  v_add_u32 v108, 147456, v78
  v_xor_b32 v109, 16, v108
  s_bfe_u32 s41, s21, 0x10002
  s_mul_i32 s41, s41, 32768
  s_lshr_b32 s40, s21, 3
  s_lshl_b32 s40, s40, 11
  s_add_u32 s40, s40, s41
  s_and_b32 s41, s21, 3
  s_lshl_b32 s41, s41, 9
  s_add_u32 s40, s40, s41
  s_lshl_b32 s41, s20, 7
  s_add_u32 s40, s40, s41
  v_lshl_add_u32 v110, v0, 2, s40
  s_mov_b32 exec_lo, 0
  v_mov_b32 v110, 2147483392
  s_mov_b64 exec, -1
  ds_read_b128 v[116:119], v85 offset:20480
  ds_read_b128 v[120:123], v85 offset:21504
  s_mov_b32 s59, 2147483392
  s_mov_b32 s25, 0
  s_add_u32 s27, s25, 32
  s_and_b32 s40, s27, 0x28
  s_mul_i32 s40, s40, 0x900
  s_and_b32 s40, s40, 0x6000
  s_xor_b32 s40, s40, s26
  s_lshl_b32 s27, s27, 16
  s_add_u32 s27, s27, s40
  s_lshl_b32 s37, s36, 1
  s_xor_b32 s37, s27, s37
  s_and_b32 s40, s25, 3
  s_lshl_b32 s40, s40, 18
  s_add_u32 s28, s40, s26
  s_lshr_b32 s40, s40, 5
  s_and_b32 s40, s40, 0x4000
  s_xor_b32 s28, s28, s40
  s_xor_b32 s29, s28, 0x4000
  s_xor_b32 s40, s29, 0
  buffer_load_dword v89, v92, s[4:7], s40 offen sc1
  s_xor_b32 s40, s27, 16384
  buffer_load_dword v89, v110, s[4:7], s40 offen sc1
  s_mov_b32 s25, 1
  s_add_u32 s27, s25, 32
  s_and_b32 s40, s27, 0x28
  s_mul_i32 s40, s40, 0x900
  s_and_b32 s40, s40, 0x6000
  s_xor_b32 s40, s40, s26
  s_lshl_b32 s27, s27, 16
  s_add_u32 s27, s27, s40
  s_lshl_b32 s37, s36, 1
  s_xor_b32 s37, s27, s37
  s_and_b32 s40, s25, 3
  s_lshl_b32 s40, s40, 18
  s_add_u32 s28, s40, s26
  s_lshr_b32 s40, s40, 5
  s_and_b32 s40, s40, 0x4000
  s_xor_b32 s28, s28, s40
  s_xor_b32 s29, s28, 0x4000
  s_xor_b32 s40, s29, 0
  buffer_load_dword v89, v92, s[4:7], s40 offen sc1
  s_xor_b32 s40, s27, 16384
  buffer_load_dword v89, v110, s[4:7], s40 offen sc1
  s_mov_b32 s25, 2
  s_add_u32 s27, s25, 32
  s_and_b32 s40, s27, 0x28
  s_mul_i32 s40, s40, 0x900
  s_and_b32 s40, s40, 0x6000
  s_xor_b32 s40, s40, s26
  s_lshl_b32 s27, s27, 16
  s_add_u32 s27, s27, s40
  s_lshl_b32 s37, s36, 1
  s_xor_b32 s37, s27, s37
  s_and_b32 s40, s25, 3
  s_lshl_b32 s40, s40, 18
  s_add_u32 s28, s40, s26
  s_lshr_b32 s40, s40, 5
  s_and_b32 s40, s40, 0x4000
  s_xor_b32 s28, s28, s40
  s_xor_b32 s29, s28, 0x4000
  s_xor_b32 s40, s29, 0
  buffer_load_dword v89, v92, s[4:7], s40 offen sc1
  s_xor_b32 s40, s27, 16384
  buffer_load_dword v89, v110, s[4:7], s40 offen sc1
  s_mov_b32 s25, 3
  s_add_u32 s27, s25, 32
  s_and_b32 s40, s27, 0x28
  s_mul_i32 s40, s40, 0x900
  s_and_b32 s40, s40, 0x6000
  s_xor_b32 s40, s40, s26
  s_lshl_b32 s27, s27, 16
  s_add_u32 s27, s27, s40
  s_lshl_b32 s37, s36, 1
  s_xor_b32 s37, s27, s37
  s_and_b32 s40, s25, 3
  s_lshl_b32 s40, s40, 18
  s_add_u32 s28, s40, s26
  s_lshr_b32 s40, s40, 5
  s_and_b32 s40, s40, 0x4000
  s_xor_b32 s28, s28, s40
  s_xor_b32 s29, s28, 0x4000
  s_xor_b32 s40, s29, 0
  buffer_load_dword v89, v92, s[4:7], s40 offen sc1
  s_xor_b32 s40, s27, 16384
  buffer_load_dword v89, v110, s[4:7], s40 offen sc1
  buffer_load_dword v89, v90, s[4:7], 0 offen offset:2048 sc1
  s_mov_b32 s25, 0
  v_mov_b64 v[52:53], 0
  v_mov_b64 v[54:55], 0
  v_mov_b64 v[56:57], 0
  v_mov_b64 v[58:59], 0
  ds_read_b128 v[20:23], v85 offset:0
  ds_read_b128 v[24:27], v85 offset:1024
  ds_read_b128 v[28:31], v85 offset:8192
  ds_read_b128 v[32:35], v85 offset:9216
  ds_read_b128 v[36:39], v85 offset:2048
  ds_read_b128 v[40:43], v85 offset:3072
  ds_read_b128 v[44:47], v85 offset:10240
  ds_read_b128 v[48:51], v85 offset:11264
L_VO_top:
  s_add_u32 s27, s25, 32
  s_and_b32 s40, s27, 0x28
  s_mul_i32 s40, s40, 0x900
  s_and_b32 s40, s40, 0x6000
  s_xor_b32 s40, s40, s26
  s_lshl_b32 s27, s27, 16
  s_add_u32 s27, s27, s40
  s_lshl_b32 s37, s36, 1
  s_xor_b32 s37, s27, s37
  s_and_b32 s40, s25, 3
  s_lshl_b32 s40, s40, 18
  s_add_u32 s28, s40, s26
  s_lshr_b32 s40, s40, 5
  s_and_b32 s40, s40, 0x4000
  s_xor_b32 s28, s28, s40
  s_xor_b32 s29, s28, 0x4000
  s_add_u32 s33, s25, 33
  s_and_b32 s40, s33, 0x28
  s_mul_i32 s40, s40, 0x900
  s_and_b32 s40, s40, 0x6000
  s_xor_b32 s40, s40, s26
  s_lshl_b32 s33, s33, 16
  s_add_u32 s33, s33, s40
  s_xor_b32 s49, s33, 16384
  s_add_u32 s34, s25, 35
  s_and_b32 s40, s34, 0x28
  s_mul_i32 s40, s40, 0x900
  s_and_b32 s40, s40, 0x6000
  s_xor_b32 s40, s40, s26
  s_lshl_b32 s34, s34, 16
  s_add_u32 s34, s34, s40
  s_cmp_lt_u32 s25, 61
  s_cselect_b32 s34, s34, 2147483392
  s_sleep 4
L_VO_retry:
  buffer_load_dwordx4 v[4:7], v86, s[4:7], s37 offen offset:0 sc1
  s_nop 0
  buffer_load_dwordx4 v[8:11], v86, s[4:7], s37 offen offset:2048 sc1
  s_nop 0
  s_waitcnt vmcnt(1) lgkmcnt(0)
  buffer_load_dwordx4 v[68:71], v87, s[4:7], s27 offen offset:0 sc1
  buffer_load_dwordx4 v[72:75], v87, s[4:7], s27 offen offset:2048 sc1
  v_smfmac_f32_16x16x64_bf16 v[52:55], v[4:7], v[128:135], v88
  ds_write_b128 v1, v[4:7] offset:0
  v_max3_u32 v89, v4, v5, v6
  v_smfmac_f32_16x16x64_bf16 v[56:59], v[4:7], v[20:27], v88
  v_max3_u32 v89, v6, v7, v89
  s_nop 0
  s_waitcnt vmcnt(2)
  ds_write_b128 v1, v[8:11] offset:1024
  v_max3_u32 v89, v8, v9, v89
  v_max3_u32 v89, v10, v11, v89
  v_cmp_eq_u32_e64 vcc, -1, v89
  s_cbranch_vccnz L_VO_bad
  s_waitcnt lgkmcnt(0)
  s_barrier
  ds_read_b128 v[12:15], v2 offset:0
  ds_read_b128 v[16:19], v2 offset:1024
  v_smfmac_f32_16x16x64_bf16 v[52:55], v[8:11], v[136:143], v88
  ds_read_b128 v[4:7], v3 offset:0
  ds_read_b128 v[20:23], v85 offset:4096
  v_smfmac_f32_16x16x64_bf16 v[56:59], v[8:11], v[28:35], v88
  ds_read_b128 v[24:27], v85 offset:5120
  s_waitcnt lgkmcnt(4)
  v_smfmac_f32_16x16x64_bf16 v[52:55], v[12:15], v[144:151], v88
  ds_read_b128 v[8:11], v3 offset:1024
  ds_read_b128 v[28:31], v85 offset:12288
  v_smfmac_f32_16x16x64_bf16 v[56:59], v[12:15], v[36:43], v88
  ds_read_b128 v[32:35], v85 offset:13312
  s_waitcnt lgkmcnt(6)
  v_smfmac_f32_16x16x64_bf16 v[52:55], v[16:19], v[152:159], v88
  ds_read_b128 v[12:15], v84 offset:0
  ds_read_b128 v[36:39], v85 offset:6144
  v_smfmac_f32_16x16x64_bf16 v[56:59], v[16:19], v[44:51], v88
  ds_read_b128 v[40:43], v85 offset:7168
  s_waitcnt lgkmcnt(6)
  v_smfmac_f32_16x16x64_bf16 v[52:55], v[4:7], v[160:167], v88
  ds_read_b128 v[16:19], v84 offset:1024
  ds_read_b128 v[44:47], v85 offset:14336
  v_smfmac_f32_16x16x64_bf16 v[56:59], v[4:7], v[20:27], v88
  ds_read_b128 v[48:51], v85 offset:15360
  s_waitcnt lgkmcnt(6)
  v_smfmac_f32_16x16x64_bf16 v[52:55], v[8:11], v[168:175], v88
  ds_read_b128 v[20:23], v85 offset:16384
  v_smfmac_f32_16x16x64_bf16 v[56:59], v[8:11], v[28:35], v88
  ds_read_b128 v[24:27], v85 offset:17408
  s_waitcnt lgkmcnt(5)
  v_smfmac_f32_16x16x64_bf16 v[52:55], v[12:15], v[176:183], v88
  ds_read_b128 v[28:31], v85 offset:24576
  v_smfmac_f32_16x16x64_bf16 v[56:59], v[12:15], v[36:43], v88
  ds_read_b128 v[32:35], v85 offset:25600
  s_waitcnt lgkmcnt(4)
  s_waitcnt vmcnt(0)
  ds_write_b128 v1, v[68:71] offset:2048
  v_smfmac_f32_16x16x64_bf16 v[52:55], v[16:19], v[184:191], v88
  ds_write_b128 v1, v[72:75] offset:3072
  v_max3_u32 v89, v68, v69, v70
  v_max3_u32 v89, v70, v71, v89
  v_max3_u32 v89, v72, v73, v89
  v_smfmac_f32_16x16x64_bf16 v[56:59], v[16:19], v[44:51], v88
  v_max3_u32 v89, v74, v75, v89
  v_cmp_eq_u32 vcc, -1, v89
  ds_read_b128 v[36:39], v85 offset:18432
  ds_read_b128 v[40:43], v85 offset:19456
  s_cbranch_vccnz L_VO_rbad
L_VO_rok:
  s_waitcnt lgkmcnt(6)
  s_waitcnt lgkmcnt(2)
  s_barrier
  v_smfmac_f32_16x16x64_bf16 v[52:55], v[68:71], v[192:199], v88
  ds_read_b128 v[12:15], v2 offset:2048
  ds_read_b128 v[16:19], v2 offset:3072
  v_smfmac_f32_16x16x64_bf16 v[56:59], v[68:71], v[20:27], v88
  ds_read_b128 v[44:47], v85 offset:26624
  ds_read_b128 v[48:51], v85 offset:27648
  v_smfmac_f32_16x16x64_bf16 v[52:55], v[72:75], v[200:207], v88
  ds_read_b128 v[4:7], v3 offset:2048
  v_smfmac_f32_16x16x64_bf16 v[56:59], v[72:75], v[28:35], v88
  s_waitcnt lgkmcnt(4)
  v_smfmac_f32_16x16x64_bf16 v[52:55], v[12:15], v[208:215], v88
  ds_read_b128 v[8:11], v3 offset:3072
  ds_read_b128 v[28:31], v85 offset:28672
  v_smfmac_f32_16x16x64_bf16 v[56:59], v[12:15], v[36:43], v88
  ds_read_b128 v[32:35], v85 offset:29696
  s_waitcnt lgkmcnt(4)
  v_smfmac_f32_16x16x64_bf16 v[52:55], v[16:19], v[216:223], v88
  ds_read_b128 v[12:15], v84 offset:2048
  ds_read_b128 v[36:39], v85 offset:22528
  v_smfmac_f32_16x16x64_bf16 v[56:59], v[16:19], v[44:51], v88
  ds_read_b128 v[40:43], v85 offset:23552
  s_waitcnt lgkmcnt(6)
  v_smfmac_f32_16x16x64_bf16 v[52:55], v[4:7], v[224:231], v88
  ds_read_b128 v[16:19], v84 offset:3072
  ds_read_b128 v[44:47], v85 offset:30720
  v_smfmac_f32_16x16x64_bf16 v[56:59], v[4:7], v[116:123], v88
  ds_read_b128 v[48:51], v85 offset:31744
  s_waitcnt lgkmcnt(6)
  v_smfmac_f32_16x16x64_bf16 v[52:55], v[8:11], v[232:239], v88
  v_smfmac_f32_16x16x64_bf16 v[56:59], v[8:11], v[28:35], v88
  s_waitcnt lgkmcnt(3)
  v_smfmac_f32_16x16x64_bf16 v[52:55], v[12:15], v[240:247], v88
  v_smfmac_f32_16x16x64_bf16 v[56:59], v[12:15], v[36:43], v88
  s_waitcnt lgkmcnt(0)
  v_smfmac_f32_16x16x64_bf16 v[52:55], v[16:19], v[248:255], v88
  v_smfmac_f32_16x16x64_bf16 v[56:59], v[16:19], v[44:51], v88
  s_nop 6
  v_pk_add_f32 v[52:53], v[52:53], v[54:55]
  v_pk_add_f32 v[56:57], v[56:57], v[58:59]
  v_cvt_pk_bf16_f32 v100, v52, v53
  v_cvt_pk_bf16_f32 v101, v56, v57
  s_cmp_eq_u32 s36, 0
  s_cbranch_scc1 Lwt_174
  buffer_store_dwordx2 v[100:101], v92, s[4:7], s29 offen
  s_branch Lwtd_175
Lwt_174:
  buffer_store_dwordx2 v[100:101], v92, s[4:7], s29 offen sc1
Lwtd_175:
  s_cmp_ge_u32 s25, 63
  s_cbranch_scc1 L_VO_end
  s_add_u32 s42, s28, s58
  s_xor_b32 s30, s42, s36
  s_xor_b32 s31, s30, 4096
  s_xor_b32 s32, s42, 131072
  s_xor_b32 s48, s32, 4096
  s_add_u32 s41, s25, 1
  v_mov_b32 v94, s41
  s_xor_b32 s35, s29, 0x84000
  buffer_load_dword v76, v110, s[4:7], s59 offen sc1
  buffer_store_dword v80, v110, s[4:7], s34 offen sc1
  s_xor_b32 s59, s34, 16384
  buffer_store_dword v80, v110, s[4:7], s59 offen sc1
  s_cmp_eq_u32 s36, 0
  s_cbranch_scc1 Lwt_176
  buffer_store_dwordx2 v[80:81], v92, s[4:7], s35 offen
  s_branch Lwtd_177
Lwt_176:
  buffer_store_dwordx2 v[80:81], v92, s[4:7], s35 offen sc1
Lwtd_177:
  v_mov_b64 v[60:61], 0
  v_mov_b64 v[62:63], 0
  v_mov_b64 v[64:65], 0
  v_mov_b64 v[66:67], 0
  v_mov_b64 v[52:53], 0
  v_mov_b64 v[54:55], 0
  v_mov_b64 v[56:57], 0
  v_mov_b64 v[58:59], 0
  ds_read_b128 v[20:23], v85 offset:0
  ds_read_b128 v[24:27], v85 offset:1024
  ds_read_b128 v[28:31], v85 offset:8192
  ds_read_b128 v[32:35], v85 offset:9216
  ds_read_b128 v[36:39], v85 offset:2048
  ds_read_b128 v[40:43], v85 offset:3072
  ds_read_b128 v[44:47], v85 offset:10240
  ds_read_b128 v[48:51], v85 offset:11264
  s_cmp_eq_u32 s36, 0
  s_nop 0
  s_cbranch_scc1 Ltrigd_179
  s_mov_b64 exec, 0xffff
  s_sleep 4
  s_nop 0
  s_nop 0
  s_nop 0
  buffer_load_dword v76, v90, s[4:7], 0 offen offset:2048 sc1
  s_sleep 1
  buffer_load_dword v77, v90, s[4:7], 0 offen offset:2048 sc1
  s_sleep 1
  buffer_load_dword v78, v90, s[4:7], 0 offen offset:2048 sc1
  s_sleep 1
Ltrig_178:
  s_sub_u32 s24, s24, 1
  s_cbranch_scc1 L_FAIL
  buffer_load_dword v79, v90, s[4:7], 0 offen offset:2048 sc1
  s_nop 0
  s_waitcnt vmcnt(3)
  v_cmp_gt_i32_e64 vcc, s25, v76
  s_cbranch_vccz Ltrigd_179
  buffer_load_dword v76, v90, s[4:7], 0 offen offset:2048 sc1
  s_waitcnt vmcnt(3)
  v_cmp_gt_i32 vcc, s25, v77
  s_cbranch_vccz Ltrigd_179
  buffer_load_dword v77, v90, s[4:7], 0 offen offset:2048 sc1
  s_waitcnt vmcnt(3)
  v_cmp_gt_i32 vcc, s25, v78
  s_cbranch_vccz Ltrigd_179
  buffer_load_dword v78, v90, s[4:7], 0 offen offset:2048 sc1
  s_waitcnt vmcnt(3)
  v_cmp_gt_i32_e64 vcc, s25, v79
  s_cbranch_vccnz Ltrig_178
Ltrigd_179:
  s_mov_b64 exec, -1
L_VOO_again:
  buffer_load_dwordx4 v[4:7], v111, s[4:7], s30 offen sc1
  s_nop 0
  buffer_load_dwordx4 v[8:11], v112, s[4:7], s30 offen sc1
  s_nop 0
  buffer_load_dwordx4 v[12:15], v113, s[4:7], s30 offen sc1
  s_nop 0
  buffer_load_dwordx4 v[16:19], v114, s[4:7], s30 offen sc1
  s_nop 0
  buffer_load_dwordx4 v[68:71], v111, s[4:7], s31 offen sc1
  s_nop 0
  buffer_load_dwordx4 v[72:75], v112, s[4:7], s31 offen sc1
  s_nop 0
  s_nop 0
  s_waitcnt vmcnt(5)
  v_cmp_eq_u32_e64 vcc, -1, v4
  s_cbranch_vccnz L_VOO_g0
L_VOO_ok0:
  buffer_load_dwordx4 v[96:99], v113, s[4:7], s31 offen sc1
  v_smfmac_f32_16x16x64_bf16 v[60:63], v[4:7], a[0:7], v88
  s_waitcnt vmcnt(5)
  v_cmp_eq_u32 vcc, -1, v8
  v_smfmac_f32_16x16x64_bf16 v[64:67], v[4:7], a[8:15], v88
  s_cbranch_vccnz L_VOO_g1
L_VOO_ok1:
  buffer_load_dwordx4 v[4:7], v114, s[4:7], s31 offen sc1
  v_smfmac_f32_16x16x64_bf16 v[60:63], v[8:11], a[16:23], v88
  s_waitcnt vmcnt(5)
  v_cmp_eq_u32 vcc, -1, v12
  v_smfmac_f32_16x16x64_bf16 v[64:67], v[8:11], a[24:31], v88
  s_cbranch_vccnz L_VOO_g2
L_VOO_ok2:
  buffer_load_dwordx4 v[8:11], v111, s[4:7], s32 offen sc1
  v_smfmac_f32_16x16x64_bf16 v[60:63], v[12:15], a[32:39], v88
  s_waitcnt vmcnt(5)
  v_cmp_eq_u32 vcc, -1, v16
  v_smfmac_f32_16x16x64_bf16 v[64:67], v[12:15], a[40:47], v88
  s_cbranch_vccnz L_VOO_g3
L_VOO_ok3:
  buffer_load_dwordx4 v[12:15], v112, s[4:7], s32 offen sc1
  v_smfmac_f32_16x16x64_bf16 v[60:63], v[16:19], a[48:55], v88
  s_waitcnt vmcnt(5)
  v_cmp_eq_u32 vcc, -1, v68
  v_smfmac_f32_16x16x64_bf16 v[64:67], v[16:19], a[56:63], v88
  s_cbranch_vccnz L_VOO_g4
L_VOO_ok4:
  buffer_load_dwordx4 v[16:19], v113, s[4:7], s32 offen sc1
  v_smfmac_f32_16x16x64_bf16 v[60:63], v[68:71], a[64:71], v88
  s_waitcnt vmcnt(5)
  v_cmp_eq_u32 vcc, -1, v72
  v_smfmac_f32_16x16x64_bf16 v[64:67], v[68:71], a[72:79], v88
  s_cbranch_vccnz L_VOO_g5
L_VOO_ok5:
  buffer_load_dwordx4 v[68:71], v114, s[4:7], s32 offen sc1
  v_smfmac_f32_16x16x64_bf16 v[60:63], v[72:75], a[80:87], v88
  s_nop 0
  s_waitcnt vmcnt(5)
  v_cmp_eq_u32_e64 vcc, -1, v96
  v_smfmac_f32_16x16x64_bf16 v[64:67], v[72:75], a[88:95], v88
  s_cbranch_vccnz L_VOO_g6
L_VOO_ok6:
  buffer_load_dwordx4 v[72:75], v111, s[4:7], s48 offen sc1
  v_smfmac_f32_16x16x64_bf16 v[60:63], v[96:99], a[96:103], v88
  s_waitcnt vmcnt(5)
  v_cmp_eq_u32 vcc, -1, v4
  v_smfmac_f32_16x16x64_bf16 v[64:67], v[96:99], a[104:111], v88
  s_cbranch_vccnz L_VOO_g7
L_VOO_ok7:
  buffer_load_dwordx4 v[96:99], v112, s[4:7], s48 offen sc1
  v_smfmac_f32_16x16x64_bf16 v[60:63], v[4:7], a[112:119], v88
  s_waitcnt vmcnt(5)
  v_cmp_eq_u32 vcc, -1, v8
  v_smfmac_f32_16x16x64_bf16 v[64:67], v[4:7], a[120:127], v88
  s_cbranch_vccnz L_VOO_g8
L_VOO_ok8:
  buffer_load_dwordx4 v[4:7], v113, s[4:7], s48 offen sc1
  v_smfmac_f32_16x16x64_bf16 v[60:63], v[8:11], a[128:135], v88
  s_waitcnt vmcnt(5)
  v_cmp_eq_u32 vcc, -1, v12
  v_smfmac_f32_16x16x64_bf16 v[64:67], v[8:11], a[136:143], v88
  s_cbranch_vccnz L_VOO_g9
L_VOO_ok9:
  buffer_load_dwordx4 v[8:11], v114, s[4:7], s48 offen sc1
  v_smfmac_f32_16x16x64_bf16 v[60:63], v[12:15], a[144:151], v88
  s_waitcnt vmcnt(5)
  v_cmp_eq_u32 vcc, -1, v16
  v_smfmac_f32_16x16x64_bf16 v[64:67], v[12:15], a[152:159], v88
  s_cbranch_vccnz L_VOO_g10
L_VOO_ok10:
  v_smfmac_f32_16x16x64_bf16 v[60:63], v[16:19], a[160:167], v88
  s_waitcnt vmcnt(4)
  v_cmp_eq_u32 vcc, -1, v68
  v_smfmac_f32_16x16x64_bf16 v[64:67], v[16:19], a[168:175], v88
  s_cbranch_vccnz L_VOO_g11
L_VOO_ok11:
  v_smfmac_f32_16x16x64_bf16 v[60:63], v[68:71], a[176:183], v88
  s_waitcnt vmcnt(3)
  v_cmp_eq_u32 vcc, -1, v72
  v_smfmac_f32_16x16x64_bf16 v[64:67], v[68:71], a[184:191], v88
  s_cbranch_vccnz L_VOO_g12
L_VOO_ok12:
  v_smfmac_f32_16x16x64_bf16 v[60:63], v[72:75], a[192:199], v88
  s_waitcnt vmcnt(2)
  v_cmp_eq_u32 vcc, -1, v96
  v_smfmac_f32_16x16x64_bf16 v[64:67], v[72:75], a[200:207], v88
  s_cbranch_vccnz L_VOO_g13
L_VOO_ok13:
  v_smfmac_f32_16x16x64_bf16 v[60:63], v[96:99], a[208:215], v88
  s_waitcnt vmcnt(1)
  v_cmp_eq_u32 vcc, -1, v4
  v_smfmac_f32_16x16x64_bf16 v[64:67], v[96:99], a[216:223], v88
  s_cbranch_vccnz L_VOO_g14
L_VOO_ok14:
  v_smfmac_f32_16x16x64_bf16 v[60:63], v[4:7], a[224:231], v88
  s_waitcnt vmcnt(0)
  v_cmp_eq_u32_e64 vcc, -1, v8
  v_smfmac_f32_16x16x64_bf16 v[64:67], v[4:7], a[232:239], v88
  s_cbranch_vccnz L_VOO_g15
L_VOO_ok15:
  v_smfmac_f32_16x16x64_bf16 v[60:63], v[8:11], a[240:247], v88
  v_smfmac_f32_16x16x64_bf16 v[64:67], v[8:11], a[248:255], v88
L_VOO_join:
  s_nop 6
  v_add_f32 v100, v60, v62
  v_add_f32 v101, v64, v66
  v_add_f32 v102, v61, v63
  v_add_f32 v103, v65, v67
  ds_write_b64 v95, v[100:101]
  ds_write_b64 v95, v[102:103] offset:2048
  buffer_store_dword v94, v91, s[4:7], s57 offen
  v_cmp_u_f32 vcc, v100, v102
  s_cbranch_vccnz L_VOO_nan
L_VOO_done:
  s_waitcnt lgkmcnt(0)
  s_barrier
  ds_read_b128 v[100:103], v108
  ds_read_b128 v[104:107], v109
  s_waitcnt lgkmcnt(1)
  v_pk_add_f32 v[100:101], v[100:101], v[102:103]
  s_waitcnt lgkmcnt(0)
  v_pk_add_f32 v[104:105], v[104:105], v[106:107]
  v_pk_add_f32 v[100:101], v[100:101], v[104:105]
  v_cvt_pk_bf16_f32 v100, v100, v101
  buffer_store_dword v100, v110, s[4:7], s49 offen
  buffer_store_dword v100, v110, s[4:7], s33 offen sc1
  s_add_u32 s25, s25, 1
  s_branch L_VO_top
L_VO_end:
  s_branch L_END
L_VO_bad:
  s_nop 7
  s_sub_u32 s24, s24, 1
  s_cbranch_scc1 L_FAIL
  s_add_u32 s60, s60, 1
  v_mov_b64 v[52:53], 0
  v_mov_b64 v[54:55], 0
  v_mov_b64 v[56:57], 0
  v_mov_b64 v[58:59], 0
  s_nop 1
  s_branch L_VO_retry
L_VO_rbad:
  s_sub_u32 s24, s24, 1
  s_cbranch_scc1 L_FAIL
  s_add_u32 s60, s60, 0x10000
  s_waitcnt lgkmcnt(0)
  buffer_load_dwordx4 v[68:71], v87, s[4:7], s27 offen offset:0 sc1
  buffer_load_dwordx4 v[72:75], v87, s[4:7], s27 offen offset:2048 sc1
  s_waitcnt vmcnt(0)
  ds_write_b128 v1, v[68:71] offset:2048
  ds_write_b128 v1, v[72:75] offset:3072
  v_max3_u32 v89, v68, v69, v70
  v_max3_u32 v89, v70, v71, v89
  v_max3_u32 v89, v72, v73, v89
  v_max3_u32 v89, v74, v75, v89
  v_cmp_eq_u32 vcc, -1, v89
  s_waitcnt lgkmcnt(0)
  s_cbranch_vccnz L_VO_rbad
  s_branch L_VO_rok
L_VOO_nan:
  s_cmp_eq_u32 s51, s25
  s_cbranch_scc1 L_VOO_done
  s_mov_b32 s51, s25
  s_add_u32 s61, s61, 0x10000
  s_waitcnt vmcnt(0) lgkmcnt(0)
L_VOO_v0:
  s_sub_u32 s24, s24, 1
  s_cbranch_scc1 L_FAIL
  buffer_load_dwordx4 v[4:7], v111, s[4:7], s30 offen sc1
  buffer_load_dwordx4 v[8:11], v112, s[4:7], s30 offen sc1
  buffer_load_dwordx4 v[12:15], v113, s[4:7], s30 offen sc1
  buffer_load_dwordx4 v[16:19], v114, s[4:7], s30 offen sc1
  v_mov_b32 v89, 0
  s_waitcnt vmcnt(0)
  v_max3_u32 v89, v4, v5, v89
  v_max3_u32 v89, v6, v7, v89
  v_max3_u32 v89, v8, v9, v89
  v_max3_u32 v89, v10, v11, v89
  v_max3_u32 v89, v12, v13, v89
  v_max3_u32 v89, v14, v15, v89
  v_max3_u32 v89, v16, v17, v89
  v_max3_u32 v89, v18, v19, v89
  v_cmp_eq_u32 vcc, -1, v89
  s_cbranch_vccnz L_VOO_v0
L_VOO_v4:
  s_sub_u32 s24, s24, 1
  s_cbranch_scc1 L_FAIL
  buffer_load_dwordx4 v[68:71], v111, s[4:7], s31 offen sc1
  buffer_load_dwordx4 v[72:75], v112, s[4:7], s31 offen sc1
  buffer_load_dwordx4 v[96:99], v113, s[4:7], s31 offen sc1
  buffer_load_dwordx4 v[4:7], v114, s[4:7], s31 offen sc1
  v_mov_b32 v89, 0
  s_waitcnt vmcnt(0)
  v_max3_u32 v89, v68, v69, v89
  v_max3_u32 v89, v70, v71, v89
  v_max3_u32 v89, v72, v73, v89
  v_max3_u32 v89, v74, v75, v89
  v_max3_u32 v89, v96, v97, v89
  v_max3_u32 v89, v98, v99, v89
  v_max3_u32 v89, v4, v5, v89
  v_max3_u32 v89, v6, v7, v89
  v_cmp_eq_u32 vcc, -1, v89
  s_cbranch_vccnz L_VOO_v4
L_VOO_v8:
  s_sub_u32 s24, s24, 1
  s_cbranch_scc1 L_FAIL
  buffer_load_dwordx4 v[8:11], v111, s[4:7], s32 offen sc1
  buffer_load_dwordx4 v[12:15], v112, s[4:7], s32 offen sc1
  buffer_load_dwordx4 v[16:19], v113, s[4:7], s32 offen sc1
  buffer_load_dwordx4 v[68:71], v114, s[4:7], s32 offen sc1
  v_mov_b32 v89, 0
  s_waitcnt vmcnt(0)
  v_max3_u32 v89, v8, v9, v89
  v_max3_u32 v89, v10, v11, v89
  v_max3_u32 v89, v12, v13, v89
  v_max3_u32 v89, v14, v15, v89
  v_max3_u32 v89, v16, v17, v89
  v_max3_u32 v89, v18, v19, v89
  v_max3_u32 v89, v68, v69, v89
  v_max3_u32 v89, v70, v71, v89
  v_cmp_eq_u32 vcc, -1, v89
  s_cbranch_vccnz L_VOO_v8
L_VOO_v12:
  s_sub_u32 s24, s24, 1
  s_cbranch_scc1 L_FAIL
  buffer_load_dwordx4 v[72:75], v111, s[4:7], s48 offen sc1
  buffer_load_dwordx4 v[96:99], v112, s[4:7], s48 offen sc1
  buffer_load_dwordx4 v[4:7], v113, s[4:7], s48 offen sc1
  buffer_load_dwordx4 v[8:11], v114, s[4:7], s48 offen sc1
  v_mov_b32 v89, 0
  s_waitcnt vmcnt(0)
  v_max3_u32 v89, v72, v73, v89
  v_max3_u32 v89, v74, v75, v89
  v_max3_u32 v89, v96, v97, v89
  v_max3_u32 v89, v98, v99, v89
  v_max3_u32 v89, v4, v5, v89
  v_max3_u32 v89, v6, v7, v89
  v_max3_u32 v89, v8, v9, v89
  v_max3_u32 v89, v10, v11, v89
  v_cmp_eq_u32 vcc, -1, v89
  s_cbranch_vccnz L_VOO_v12
  v_mov_b64 v[60:61], 0
  v_mov_b64 v[62:63], 0
  v_mov_b64 v[64:65], 0
  v_mov_b64 v[66:67], 0
L_VOOS_again:
  buffer_load_dwordx4 v[4:7], v111, s[4:7], s30 offen sc1
  s_nop 0
  buffer_load_dwordx4 v[8:11], v112, s[4:7], s30 offen sc1
  s_nop 0
  buffer_load_dwordx4 v[12:15], v113, s[4:7], s30 offen sc1
  s_nop 0
  buffer_load_dwordx4 v[16:19], v114, s[4:7], s30 offen sc1
  s_nop 0
  buffer_load_dwordx4 v[68:71], v111, s[4:7], s31 offen sc1
  s_nop 0
  buffer_load_dwordx4 v[72:75], v112, s[4:7], s31 offen sc1
  s_nop 0
  s_waitcnt vmcnt(5)
  buffer_load_dwordx4 v[96:99], v113, s[4:7], s31 offen sc1
  v_smfmac_f32_16x16x64_bf16 v[60:63], v[4:7], a[0:7], v88
  s_waitcnt vmcnt(5)
  v_smfmac_f32_16x16x64_bf16 v[64:67], v[4:7], a[8:15], v88
  buffer_load_dwordx4 v[4:7], v114, s[4:7], s31 offen sc1
  v_smfmac_f32_16x16x64_bf16 v[60:63], v[8:11], a[16:23], v88
  s_waitcnt vmcnt(5)
  v_smfmac_f32_16x16x64_bf16 v[64:67], v[8:11], a[24:31], v88
  buffer_load_dwordx4 v[8:11], v111, s[4:7], s32 offen sc1
  v_smfmac_f32_16x16x64_bf16 v[60:63], v[12:15], a[32:39], v88
  s_waitcnt vmcnt(5)
  v_smfmac_f32_16x16x64_bf16 v[64:67], v[12:15], a[40:47], v88
  buffer_load_dwordx4 v[12:15], v112, s[4:7], s32 offen sc1
  v_smfmac_f32_16x16x64_bf16 v[60:63], v[16:19], a[48:55], v88
  s_waitcnt vmcnt(5)
  v_smfmac_f32_16x16x64_bf16 v[64:67], v[16:19], a[56:63], v88
  buffer_load_dwordx4 v[16:19], v113, s[4:7], s32 offen sc1
  v_smfmac_f32_16x16x64_bf16 v[60:63], v[68:71], a[64:71], v88
  s_waitcnt vmcnt(5)
  v_smfmac_f32_16x16x64_bf16 v[64:67], v[68:71], a[72:79], v88
  buffer_load_dwordx4 v[68:71], v114, s[4:7], s32 offen sc1
  v_smfmac_f32_16x16x64_bf16 v[60:63], v[72:75], a[80:87], v88
  s_waitcnt vmcnt(5)
  v_smfmac_f32_16x16x64_bf16 v[64:67], v[72:75], a[88:95], v88
  buffer_load_dwordx4 v[72:75], v111, s[4:7], s48 offen sc1
  v_smfmac_f32_16x16x64_bf16 v[60:63], v[96:99], a[96:103], v88
  s_waitcnt vmcnt(5)
  v_smfmac_f32_16x16x64_bf16 v[64:67], v[96:99], a[104:111], v88
  buffer_load_dwordx4 v[96:99], v112, s[4:7], s48 offen sc1
  v_smfmac_f32_16x16x64_bf16 v[60:63], v[4:7], a[112:119], v88
  s_waitcnt vmcnt(5)
  v_smfmac_f32_16x16x64_bf16 v[64:67], v[4:7], a[120:127], v88
  buffer_load_dwordx4 v[4:7], v113, s[4:7], s48 offen sc1
  v_smfmac_f32_16x16x64_bf16 v[60:63], v[8:11], a[128:135], v88
  s_waitcnt vmcnt(5)
  v_smfmac_f32_16x16x64_bf16 v[64:67], v[8:11], a[136:143], v88
  buffer_load_dwordx4 v[8:11], v114, s[4:7], s48 offen sc1
  v_smfmac_f32_16x16x64_bf16 v[60:63], v[12:15], a[144:151], v88
  s_waitcnt vmcnt(5)
  v_smfmac_f32_16x16x64_bf16 v[64:67], v[12:15], a[152:159], v88
  v_smfmac_f32_16x16x64_bf16 v[60:63], v[16:19], a[160:167], v88
  s_waitcnt vmcnt(4)
  v_smfmac_f32_16x16x64_bf16 v[64:67], v[16:19], a[168:175], v88
  v_smfmac_f32_16x16x64_bf16 v[60:63], v[68:71], a[176:183], v88
  s_waitcnt vmcnt(3)
  v_smfmac_f32_16x16x64_bf16 v[64:67], v[68:71], a[184:191], v88
  v_smfmac_f32_16x16x64_bf16 v[60:63], v[72:75], a[192:199], v88
  s_waitcnt vmcnt(2)
  v_smfmac_f32_16x16x64_bf16 v[64:67], v[72:75], a[200:207], v88
  v_smfmac_f32_16x16x64_bf16 v[60:63], v[96:99], a[208:215], v88
  s_waitcnt vmcnt(1)
  v_smfmac_f32_16x16x64_bf16 v[64:67], v[96:99], a[216:223], v88
  v_smfmac_f32_16x16x64_bf16 v[60:63], v[4:7], a[224:231], v88
  s_waitcnt vmcnt(0)
  v_smfmac_f32_16x16x64_bf16 v[64:67], v[4:7], a[232:239], v88
  v_smfmac_f32_16x16x64_bf16 v[60:63], v[8:11], a[240:247], v88
  v_smfmac_f32_16x16x64_bf16 v[64:67], v[8:11], a[248:255], v88
  s_nop 7
  s_branch L_VOO_join
L_VOO_g0:
  s_sub_u32 s24, s24, 1
  s_cbranch_scc1 L_FAIL
  s_add_u32 s61, s61, 1
  buffer_load_dwordx4 v[4:7], v111, s[4:7], s30 offen sc1
  s_waitcnt vmcnt(0)
  v_cmp_eq_u32 vcc, -1, v4
  s_cbranch_vccnz L_VOO_g0
  v_mov_b32 v89, 0
  v_max3_u32 v89, v8, v12, v89
  v_max3_u32 v89, v16, v68, v89
  v_max3_u32 v89, v72, v72, v89
  v_cmp_eq_u32 vcc, -1, v89
  s_cbranch_vccz L_VOO_ok0
  buffer_load_dwordx4 v[8:11], v112, s[4:7], s30 offen sc1
  s_nop 0
  buffer_load_dwordx4 v[12:15], v113, s[4:7], s30 offen sc1
  s_nop 0
  buffer_load_dwordx4 v[16:19], v114, s[4:7], s30 offen sc1
  s_nop 0
  buffer_load_dwordx4 v[68:71], v111, s[4:7], s31 offen sc1
  s_nop 0
  buffer_load_dwordx4 v[72:75], v112, s[4:7], s31 offen sc1
  s_nop 0
  s_branch L_VOO_ok0
L_VOO_g1:
  s_sub_u32 s24, s24, 1
  s_cbranch_scc1 L_FAIL
  s_add_u32 s61, s61, 1
  buffer_load_dwordx4 v[8:11], v112, s[4:7], s30 offen sc1
  s_waitcnt vmcnt(0)
  v_cmp_eq_u32 vcc, -1, v8
  s_cbranch_vccnz L_VOO_g1
  v_mov_b32 v89, 0
  v_max3_u32 v89, v12, v16, v89
  v_max3_u32 v89, v68, v72, v89
  v_max3_u32 v89, v96, v96, v89
  v_cmp_eq_u32 vcc, -1, v89
  s_cbranch_vccz L_VOO_ok1
  buffer_load_dwordx4 v[12:15], v113, s[4:7], s30 offen sc1
  s_nop 0
  buffer_load_dwordx4 v[16:19], v114, s[4:7], s30 offen sc1
  s_nop 0
  buffer_load_dwordx4 v[68:71], v111, s[4:7], s31 offen sc1
  s_nop 0
  buffer_load_dwordx4 v[72:75], v112, s[4:7], s31 offen sc1
  s_nop 0
  buffer_load_dwordx4 v[96:99], v113, s[4:7], s31 offen sc1
  s_nop 0
  s_branch L_VOO_ok1
L_VOO_g2:
  s_sub_u32 s24, s24, 1
  s_cbranch_scc1 L_FAIL
  s_add_u32 s61, s61, 1
  buffer_load_dwordx4 v[12:15], v113, s[4:7], s30 offen sc1
  s_waitcnt vmcnt(0)
  v_cmp_eq_u32 vcc, -1, v12
  s_cbranch_vccnz L_VOO_g2
  v_mov_b32 v89, 0
  v_max3_u32 v89, v16, v68, v89
  v_max3_u32 v89, v72, v96, v89
  v_max3_u32 v89, v4, v4, v89
  v_cmp_eq_u32 vcc, -1, v89
  s_cbranch_vccz L_VOO_ok2
  buffer_load_dwordx4 v[16:19], v114, s[4:7], s30 offen sc1
  s_nop 0
  buffer_load_dwordx4 v[68:71], v111, s[4:7], s31 offen sc1
  s_nop 0
  buffer_load_dwordx4 v[72:75], v112, s[4:7], s31 offen sc1
  s_nop 0
  buffer_load_dwordx4 v[96:99], v113, s[4:7], s31 offen sc1
  s_nop 0
  buffer_load_dwordx4 v[4:7], v114, s[4:7], s31 offen sc1
  s_nop 0
  s_branch L_VOO_ok2
L_VOO_g3:
  s_sub_u32 s24, s24, 1
  s_cbranch_scc1 L_FAIL
  s_add_u32 s61, s61, 1
  buffer_load_dwordx4 v[16:19], v114, s[4:7], s30 offen sc1
  s_waitcnt vmcnt(0)
  v_cmp_eq_u32 vcc, -1, v16
  s_cbranch_vccnz L_VOO_g3
  v_mov_b32 v89, 0
  v_max3_u32 v89, v68, v72, v89
  v_max3_u32 v89, v96, v4, v89
  v_max3_u32 v89, v8, v8, v89
  v_cmp_eq_u32 vcc, -1, v89
  s_cbranch_vccz L_VOO_ok3
  buffer_load_dwordx4 v[68:71], v111, s[4:7], s31 offen sc1
  s_nop 0
  buffer_load_dwordx4 v[72:75], v112, s[4:7], s31 offen sc1
  s_nop 0
  buffer_load_dwordx4 v[96:99], v113, s[4:7], s31 offen sc1
  s_nop 0
  buffer_load_dwordx4 v[4:7], v114, s[4:7], s31 offen sc1
  s_nop 0
  buffer_load_dwordx4 v[8:11], v111, s[4:7], s32 offen sc1
  s_nop 0
  s_branch L_VOO_ok3
L_VOO_g4:
  s_sub_u32 s24, s24, 1
  s_cbranch_scc1 L_FAIL
  s_add_u32 s61, s61, 1
  buffer_load_dwordx4 v[68:71], v111, s[4:7], s31 offen sc1
  s_waitcnt vmcnt(0)
  v_cmp_eq_u32 vcc, -1, v68
  s_cbranch_vccnz L_VOO_g4
  v_mov_b32 v89, 0
  v_max3_u32 v89, v72, v96, v89
  v_max3_u32 v89, v4, v8, v89
  v_max3_u32 v89, v12, v12, v89
  v_cmp_eq_u32 vcc, -1, v89
  s_cbranch_vccz L_VOO_ok4
  buffer_load_dwordx4 v[72:75], v112, s[4:7], s31 offen sc1
  s_nop 0
  buffer_load_dwordx4 v[96:99], v113, s[4:7], s31 offen sc1
  s_nop 0
  buffer_load_dwordx4 v[4:7], v114, s[4:7], s31 offen sc1
  s_nop 0
  buffer_load_dwordx4 v[8:11], v111, s[4:7], s32 offen sc1
  s_nop 0
  buffer_load_dwordx4 v[12:15], v112, s[4:7], s32 offen sc1
  s_nop 0
  s_branch L_VOO_ok4
L_VOO_g5:
  s_sub_u32 s24, s24, 1
  s_cbranch_scc1 L_FAIL
  s_add_u32 s61, s61, 1
  buffer_load_dwordx4 v[72:75], v112, s[4:7], s31 offen sc1
  s_waitcnt vmcnt(0)
  v_cmp_eq_u32 vcc, -1, v72
  s_cbranch_vccnz L_VOO_g5
  v_mov_b32 v89, 0
  v_max3_u32 v89, v96, v4, v89
  v_max3_u32 v89, v8, v12, v89
  v_max3_u32 v89, v16, v16, v89
  v_cmp_eq_u32 vcc, -1, v89
  s_cbranch_vccz L_VOO_ok5
  buffer_load_dwordx4 v[96:99], v113, s[4:7], s31 offen sc1
  s_nop 0
  buffer_load_dwordx4 v[4:7], v114, s[4:7], s31 offen sc1
  s_nop 0
  buffer_load_dwordx4 v[8:11], v111, s[4:7], s32 offen sc1
  s_nop 0
  buffer_load_dwordx4 v[12:15], v112, s[4:7], s32 offen sc1
  s_nop 0
  buffer_load_dwordx4 v[16:19], v113, s[4:7], s32 offen sc1
  s_nop 0
  s_branch L_VOO_ok5
L_VOO_g6:
  s_sub_u32 s24, s24, 1
  s_cbranch_scc1 L_FAIL
  s_add_u32 s61, s61, 1
  buffer_load_dwordx4 v[96:99], v113, s[4:7], s31 offen sc1
  s_waitcnt vmcnt(0)
  v_cmp_eq_u32 vcc, -1, v96
  s_cbranch_vccnz L_VOO_g6
  v_mov_b32 v89, 0
  v_max3_u32 v89, v4, v8, v89
  v_max3_u32 v89, v12, v16, v89
  v_max3_u32 v89, v68, v68, v89
  v_cmp_eq_u32 vcc, -1, v89
  s_cbranch_vccz L_VOO_ok6
  buffer_load_dwordx4 v[4:7], v114, s[4:7], s31 offen sc1
  s_nop 0
  buffer_load_dwordx4 v[8:11], v111, s[4:7], s32 offen sc1
  s_nop 0
  buffer_load_dwordx4 v[12:15], v112, s[4:7], s32 offen sc1
  s_nop 0
  buffer_load_dwordx4 v[16:19], v113, s[4:7], s32 offen sc1
  s_nop 0
  buffer_load_dwordx4 v[68:71], v114, s[4:7], s32 offen sc1
  s_nop 0
  s_branch L_VOO_ok6
L_VOO_g7:
  s_sub_u32 s24, s24, 1
  s_cbranch_scc1 L_FAIL
  s_add_u32 s61, s61, 1
  buffer_load_dwordx4 v[4:7], v114, s[4:7], s31 offen sc1
  s_waitcnt vmcnt(0)
  v_cmp_eq_u32 vcc, -1, v4
  s_cbranch_vccnz L_VOO_g7
  v_mov_b32 v89, 0
  v_max3_u32 v89, v8, v12, v89
  v_max3_u32 v89, v16, v68, v89
  v_max3_u32 v89, v72, v72, v89
  v_cmp_eq_u32 vcc, -1, v89
  s_cbranch_vccz L_VOO_ok7
  buffer_load_dwordx4 v[8:11], v111, s[4:7], s32 offen sc1
  s_nop 0
  buffer_load_dwordx4 v[12:15], v112, s[4:7], s32 offen sc1
  s_nop 0
  buffer_load_dwordx4 v[16:19], v113, s[4:7], s32 offen sc1
  s_nop 0
  buffer_load_dwordx4 v[68:71], v114, s[4:7], s32 offen sc1
  s_nop 0
  buffer_load_dwordx4 v[72:75], v111, s[4:7], s48 offen sc1
  s_nop 0
  s_branch L_VOO_ok7
L_VOO_g8:
  s_sub_u32 s24, s24, 1
  s_cbranch_scc1 L_FAIL
  s_add_u32 s61, s61, 256
  buffer_load_dwordx4 v[8:11], v111, s[4:7], s32 offen sc1
  s_waitcnt vmcnt(0)
  v_cmp_eq_u32 vcc, -1, v8
  s_cbranch_vccnz L_VOO_g8
  v_mov_b32 v89, 0
  v_max3_u32 v89, v12, v16, v89
  v_max3_u32 v89, v68, v72, v89
  v_max3_u32 v89, v96, v96, v89
  v_cmp_eq_u32 vcc, -1, v89
  s_cbranch_vccz L_VOO_ok8
  buffer_load_dwordx4 v[12:15], v112, s[4:7], s32 offen sc1
  s_nop 0
  buffer_load_dwordx4 v[16:19], v113, s[4:7], s32 offen sc1
  s_nop 0
  buffer_load_dwordx4 v[68:71], v114, s[4:7], s32 offen sc1
  s_nop 0
  buffer_load_dwordx4 v[72:75], v111, s[4:7], s48 offen sc1
  s_nop 0
  buffer_load_dwordx4 v[96:99], v112, s[4:7], s48 offen sc1
  s_nop 0
  s_branch L_VOO_ok8
L_VOO_g9:
  s_sub_u32 s24, s24, 1
  s_cbranch_scc1 L_FAIL
  s_add_u32 s61, s61, 256
  buffer_load_dwordx4 v[12:15], v112, s[4:7], s32 offen sc1
  s_waitcnt vmcnt(0)
  v_cmp_eq_u32 vcc, -1, v12
  s_cbranch_vccnz L_VOO_g9
  v_mov_b32 v89, 0
  v_max3_u32 v89, v16, v68, v89
  v_max3_u32 v89, v72, v96, v89
  v_max3_u32 v89, v4, v4, v89
  v_cmp_eq_u32 vcc, -1, v89
  s_cbranch_vccz L_VOO_ok9
  buffer_load_dwordx4 v[16:19], v113, s[4:7], s32 offen sc1
  s_nop 0
  buffer_load_dwordx4 v[68:71], v114, s[4:7], s32 offen sc1
  s_nop 0
  buffer_load_dwordx4 v[72:75], v111, s[4:7], s48 offen sc1
  s_nop 0
  buffer_load_dwordx4 v[96:99], v112, s[4:7], s48 offen sc1
  s_nop 0
  buffer_load_dwordx4 v[4:7], v113, s[4:7], s48 offen sc1
  s_nop 0
  s_branch L_VOO_ok9
L_VOO_g10:
  s_sub_u32 s24, s24, 1
  s_cbranch_scc1 L_FAIL
  s_add_u32 s61, s61, 256
  buffer_load_dwordx4 v[16:19], v113, s[4:7], s32 offen sc1
  s_waitcnt vmcnt(0)
  v_cmp_eq_u32 vcc, -1, v16
  s_cbranch_vccnz L_VOO_g10
  v_mov_b32 v89, 0
  v_max3_u32 v89, v68, v72, v89
  v_max3_u32 v89, v96, v4, v89
  v_max3_u32 v89, v8, v8, v89
  v_cmp_eq_u32 vcc, -1, v89
  s_cbranch_vccz L_VOO_ok10
  buffer_load_dwordx4 v[68:71], v114, s[4:7], s32 offen sc1
  s_nop 0
  buffer_load_dwordx4 v[72:75], v111, s[4:7], s48 offen sc1
  s_nop 0
  buffer_load_dwordx4 v[96:99], v112, s[4:7], s48 offen sc1
  s_nop 0
  buffer_load_dwordx4 v[4:7], v113, s[4:7], s48 offen sc1
  s_nop 0
  buffer_load_dwordx4 v[8:11], v114, s[4:7], s48 offen sc1
  s_nop 0
  s_branch L_VOO_ok10
L_VOO_g11:
  s_sub_u32 s24, s24, 1
  s_cbranch_scc1 L_FAIL
  s_add_u32 s61, s61, 256
  buffer_load_dwordx4 v[68:71], v114, s[4:7], s32 offen sc1
  s_waitcnt vmcnt(0)
  v_cmp_eq_u32 vcc, -1, v68
  s_cbranch_vccnz L_VOO_g11
  v_mov_b32 v89, 0
  v_max3_u32 v89, v72, v96, v89
  v_max3_u32 v89, v4, v8, v89
  v_cmp_eq_u32 vcc, -1, v89
  s_cbranch_vccz L_VOO_ok11
  buffer_load_dwordx4 v[72:75], v111, s[4:7], s48 offen sc1
  s_nop 0
  buffer_load_dwordx4 v[96:99], v112, s[4:7], s48 offen sc1
  s_nop 0
  buffer_load_dwordx4 v[4:7], v113, s[4:7], s48 offen sc1
  s_nop 0
  buffer_load_dwordx4 v[8:11], v114, s[4:7], s48 offen sc1
  s_nop 0
  s_branch L_VOO_ok11
L_VOO_g12:
  s_sub_u32 s24, s24, 1
  s_cbranch_scc1 L_FAIL
  s_add_u32 s61, s61, 256
  buffer_load_dwordx4 v[72:75], v111, s[4:7], s48 offen sc1
  s_waitcnt vmcnt(0)
  v_cmp_eq_u32 vcc, -1, v72
  s_cbranch_vccnz L_VOO_g12
  v_mov_b32 v89, 0
  v_max3_u32 v89, v96, v4, v89
  v_max3_u32 v89, v8, v8, v89
  v_cmp_eq_u32 vcc, -1, v89
  s_cbranch_vccz L_VOO_ok12
  buffer_load_dwordx4 v[96:99], v112, s[4:7], s48 offen sc1
  s_nop 0
  buffer_load_dwordx4 v[4:7], v113, s[4:7], s48 offen sc1
  s_nop 0
  buffer_load_dwordx4 v[8:11], v114, s[4:7], s48 offen sc1
  s_nop 0
  s_branch L_VOO_ok12
L_VOO_g13:
  s_sub_u32 s24, s24, 1
  s_cbranch_scc1 L_FAIL
  s_add_u32 s61, s61, 256
  buffer_load_dwordx4 v[96:99], v112, s[4:7], s48 offen sc1
  s_waitcnt vmcnt(0)
  v_cmp_eq_u32 vcc, -1, v96
  s_cbranch_vccnz L_VOO_g13
  v_mov_b32 v89, 0
  v_max3_u32 v89, v4, v8, v89
  v_cmp_eq_u32 vcc, -1, v89
  s_cbranch_vccz L_VOO_ok13
  buffer_load_dwordx4 v[4:7], v113, s[4:7], s48 offen sc1
  s_nop 0
  buffer_load_dwordx4 v[8:11], v114, s[4:7], s48 offen sc1
  s_nop 0
  s_branch L_VOO_ok13
L_VOO_g14:
  s_sub_u32 s24, s24, 1
  s_cbranch_scc1 L_FAIL
  s_add_u32 s61, s61, 256
  buffer_load_dwordx4 v[4:7], v113, s[4:7], s48 offen sc1
  s_waitcnt vmcnt(0)
  v_cmp_eq_u32 vcc, -1, v4
  s_cbranch_vccnz L_VOO_g14
  v_mov_b32 v89, 0
  v_max3_u32 v89, v8, v8, v89
  v_cmp_eq_u32 vcc, -1, v89
  s_cbranch_vccz L_VOO_ok14
  buffer_load_dwordx4 v[8:11], v114, s[4:7], s48 offen sc1
  s_nop 0
  s_branch L_VOO_ok14
L_VOO_g15:
  s_sub_u32 s24, s24, 1
  s_cbranch_scc1 L_FAIL
  s_add_u32 s61, s61, 256
  buffer_load_dwordx4 v[8:11], v114, s[4:7], s48 offen sc1
  s_waitcnt vmcnt(0)
  v_cmp_eq_u32 vcc, -1, v8
  s_cbranch_vccnz L_VOO_g15
  s_branch L_VOO_ok15
L_LAST:
  s_endpgm
.section .rodata,"a"
.p2align 6
.amdhsa_kernel adaLN_cond__memory_aug_recurrent_mem_tr__glu_gated_swiglu__prompt_kernel
  .amdhsa_next_free_vgpr 512
  .amdhsa_next_free_sgpr 102
  .amdhsa_accum_offset 256
  .amdhsa_group_segment_fixed_size 0
  .amdhsa_kernarg_size 128
  .amdhsa_user_sgpr_count 2
  .amdhsa_user_sgpr_kernarg_segment_ptr 1
  .amdhsa_system_sgpr_workgroup_id_x 1
  .amdhsa_float_denorm_mode_32 3
.end_amdhsa_kernel
```

```asm
; @launch grid=(256,1,1) block=(256,1,1) lds=163840
.amdgcn_target "amdgcn-amd-amdhsa--gfx950"
.text
.globl adaLN_cond__memory_aug_recurrent_mem_tr__glu_gated_swiglu__prompt_kernel
.p2align 8
.type adaLN_cond__memory_aug_recurrent_mem_tr__glu_gated_swiglu__prompt_kernel,@function
adaLN_cond__memory_aug_recurrent_mem_tr__glu_gated_swiglu__prompt_kernel:
  s_cmp_ge_u32 s2, 256
  s_cbranch_scc1 L_END
  s_load_dwordx2 s[4:5], s[0:1], 120
  s_load_dwordx2 s[12:13], s[0:1], 112
  v_lshrrev_b32 v1, 6, v0
  v_and_b32 v0, 63, v0
  v_readfirstlane_b32 s20, v1
  s_mov_b32 s6, 163610624
  s_mov_b32 s7, 0x20000
  s_mov_b32 s14, 256
  s_mov_b32 s15, 0x20000
  s_mov_b32 s24, 300000
  s_and_b32 s40, s2, 7
  s_mov_b32 s42, 0x3020100
  s_mov_b32 s43, 0x3020100
  s_cmp_eq_u32 s40, 1
  s_cselect_b32 s42, 0x1b161514, s42
  s_cselect_b32 s43, 0x1b1a1918, s43
  s_cmp_eq_u32 s40, 2
  s_cselect_b32 s42, 0xb0a0908, s42
  s_cselect_b32 s43, 0xb0a0908, s43
  s_cmp_eq_u32 s40, 3
  s_cselect_b32 s42, 0x1f1e1d1c, s42
  s_cselect_b32 s43, 0x1f1e1d1c, s43
  s_cmp_eq_u32 s40, 4
  s_cselect_b32 s42, 0x7060504, s42
  s_cselect_b32 s43, 0x7060504, s43
  s_cmp_eq_u32 s40, 5
  s_cselect_b32 s42, 0x13121110, s42
  s_cselect_b32 s43, 0x13121110, s43
  s_cmp_eq_u32 s40, 6
  s_cselect_b32 s42, 0xf0e0d0c, s42
  s_cselect_b32 s43, 0xf0e0d0c, s43
  s_cmp_eq_u32 s40, 7
  s_cselect_b32 s42, 0x1a191817, s42
  s_cselect_b32 s43, 0x17161514, s43
  s_lshr_b32 s40, s2, 6
  s_lshl_b32 s40, s40, 3
  s_lshr_b32 s42, s42, s40
  s_lshr_b32 s43, s43, s40
  s_bfe_u32 s41, s2, 0x30003
  s_and_b32 s42, s42, 31
  s_lshl_b32 s42, s42, 3
  s_add_u32 s3, s42, s41
  s_bfe_u32 s22, s43, 0x30002
  s_and_b32 s43, s43, 3
  s_lshl_b32 s43, s43, 3
  s_add_u32 s23, s43, s41
  s_waitcnt lgkmcnt(0)
  s_add_u32 s4, s4, 6291455
  s_addc_u32 s5, s5, 0
  s_and_b32 s4, s4, 0xffe00000
  s_cmp_lg_u32 s20, 3
  s_cbranch_scc1 L_NOPRE
  s_getpc_b64 s[40:41]
L_PC:
  s_lshr_b32 s42, s2, 3
  v_lshlrev_b32 v1, 12, v0
  s_lshl_b32 s42, s42, 7
  v_add_u32 v1, s42, v1
  v_min_u32 v1, L_LAST-L_PC, v1
  global_load_dword v255, v1, s[40:41]
L_NOPRE:
  s_cmp_ge_u32 s22, 4
  s_cbranch_scc1 L_TRAIL
  s_lshr_b32 s40, s22, 1
  s_bitcmp1_b32 s22, 0
  s_cbranch_scc0 L_REC
  s_lshl_b32 s40, s40, 5
  s_add_u32 s21, s40, s23
  s_branch L_QKV
L_REC:
  s_lshl_b32 s40, s40, 4
  s_lshr_b32 s41, s23, 1
  s_add_u32 s21, s40, s41
  s_bitcmp1_b32 s23, 0
  s_cbranch_scc1 L_VO
  s_branch L_QK
L_TRAIL:
  s_mov_b32 s21, s23
  s_cmp_eq_u32 s22, 6
  s_cbranch_scc1 L_MOD
  s_sub_u32 s40, s22, 4
  s_lshl_b32 s40, s40, 5
  s_add_u32 s21, s40, s23
  s_cmp_lg_u32 s22, 7
  s_cbranch_scc1 L_WOF
L_INIT:
  s_lshl_b32 s40, s23, 2
  s_add_u32 s40, s40, s20
  s_lshl_b32 s40, s40, 12
  s_add_u32 s41, s40, 1310720
  s_add_u32 s43, s40, 1900544
  s_add_u32 s42, s40, 0x80000
  v_lshlrev_b32 v1, 4, v0
  v_mov_b32 v4, -1
  v_mov_b32 v5, -1
  v_mov_b32 v6, -1
  v_mov_b32 v7, -1
  s_cmp_lt_u32 s23, 16
  s_cselect_b32 s41, s41, s43
  s_cmp_lt_u32 s23, 24
  s_cselect_b32 s41, s41, 2147483392
  buffer_store_dwordx4 v[4:7], v1, s[4:7], s41 offen offset:0 sc1
  buffer_store_dwordx4 v[4:7], v1, s[4:7], s41 offen offset:1024 sc1
  buffer_store_dwordx4 v[4:7], v1, s[4:7], s41 offen offset:2048 sc1
  buffer_store_dwordx4 v[4:7], v1, s[4:7], s41 offen offset:3072 sc1
  buffer_store_dwordx4 v[4:7], v1, s[4:7], s40 offen offset:0 sc1
  buffer_store_dwordx4 v[4:7], v1, s[4:7], s40 offen offset:1024 sc1
  buffer_store_dwordx4 v[4:7], v1, s[4:7], s40 offen offset:2048 sc1
  buffer_store_dwordx4 v[4:7], v1, s[4:7], s40 offen offset:3072 sc1
  buffer_store_dwordx4 v[4:7], v1, s[4:7], s42 offen offset:0 sc1
  buffer_store_dwordx4 v[4:7], v1, s[4:7], s42 offen offset:1024 sc1
  buffer_store_dwordx4 v[4:7], v1, s[4:7], s42 offen offset:2048 sc1
  buffer_store_dwordx4 v[4:7], v1, s[4:7], s42 offen offset:3072 sc1
  s_load_dwordx2 s[16:17], s[0:1], 8
  s_mov_b32 s18, 16384
  s_mov_b32 s19, 0x20000
  s_waitcnt lgkmcnt(0)
  s_and_b32 s40, s20, 1
  s_lshl_b32 s40, s40, 3
  v_bfe_u32 v8, v0, 2, 3
  v_add_u32 v8, s40, v8
  s_lshr_b32 s40, s20, 1
  s_lshl_b32 s40, s40, 3
  v_and_b32 v9, 3, v0
  v_add_u32 v9, s40, v9
  v_bfe_u32 v10, v8, 1, 1
  v_lshl_add_u32 v9, v10, 2, v9
  v_lshrrev_b32 v10, 2, v8
  v_and_b32 v11, 1, v8
  v_lshl_add_u32 v10, v10, 1, v11
  s_lshl_b32 s40, s23, 6
  v_lshl_add_u32 v10, v10, 11, s40
  v_lshl_add_u32 v10, v9, 1, v10
  buffer_load_ushort v11, v10, s[16:19], 0 offen
  buffer_load_ushort v12, v10, s[16:19], 0 offen offset:32
  s_bfe_u32 s41, s23, 0x10002
  s_mul_i32 s41, s41, 32768
  s_lshr_b32 s40, s23, 3
  s_lshl_b32 s40, s40, 11
  s_add_u32 s40, s40, s41
  s_and_b32 s41, s23, 3
  s_lshl_b32 s41, s41, 9
  s_add_u32 s40, s40, s41
  s_lshl_b32 s41, s20, 7
  s_add_u32 s40, s40, s41
  s_add_u32 s40, s40, 2097152
  s_add_u32 s41, s40, 0x4000
  v_and_b32 v8, 31, v0
  v_lshlrev_b32 v8, 2, v8
  v_lshrrev_b32 v9, 5, v0
  v_lshl_add_u32 v8, v9, 13, v8
  s_waitcnt vmcnt(0)
  v_lshl_or_b32 v11, v12, 16, v11
  v_min_u32 v11, -2, v11
  buffer_store_dword v11, v8, s[4:7], s40 offen sc1
  buffer_store_dword v11, v8, s[4:7], s41 offen sc1
  s_lshl_b32 s40, s23, 2
  s_add_u32 s40, s40, 128
  s_cmp_eq_u32 s20, 0
  s_cselect_b32 s40, s40, 2147483392
  v_mov_b32 v2, 2147483392
  s_mov_b64 exec, 1
  v_mov_b32 v2, s40
  s_mov_b64 exec, -1
  v_mov_b32 v3, 1
  s_waitcnt vmcnt(0)
  s_barrier
  buffer_store_dword v3, v2, s[12:15], 0 offen sc1
  s_branch L_LN1
L_MOD:
  s_load_dwordx2 s[16:17], s[0:1], 88
  s_mov_b32 s18, 2048
  s_mov_b32 s19, 0x20000
  s_waitcnt lgkmcnt(0)
  s_load_dwordx2 s[8:9], s[0:1], 96
  s_mov_b32 s10, 12582912
  s_mov_b32 s11, 0x20000
  s_waitcnt lgkmcnt(0)
  s_lshl_b32 s40, s20, 9
  v_lshl_add_u32 v1, v0, 3, s40
  buffer_load_dwordx2 v[8:9], v1, s[16:19], 0 offen
  v_bfe_u32 v2, v0, 5, 1
  v_mul_u32_u24 v2, 98304, v2
  v_bfe_u32 v3, v0, 4, 1
  v_mul_u32_u24 v3, 24576, v3
  v_add_u32 v2, v2, v3
  v_bfe_u32 v3, v0, 3, 1
  v_mul_u32_u24 v3, 12288, v3
  v_add_u32 v2, v2, v3
  v_lshrrev_b32 v3, 3, v0
  v_and_b32 v3, 6, v3
  v_xor_b32 v3, v3, v0
  v_and_b32 v3, 7, v3
  v_lshl_add_u32 v2, v3, 4, v2
  s_lshr_b32 s40, s20, 1
  s_mul_i32 s40, s40, 49152
  s_and_b32 s41, s20, 1
  s_mul_i32 s41, s41, 196608
  s_add_u32 s40, s40, s41
  s_lshl_b32 s41, s21, 7
  s_add_u32 s40, s40, s41
  v_add_u32 v2, s40, v2
  s_lshl_b32 s41, s20, 10
  s_add_u32 m0, s41, 0
  s_mov_b32 s42, 0
  buffer_load_dwordx4 v2, s[8:11], s42 offen nt lds
  s_add_u32 m0, s41, 4096
  s_mov_b32 s42, 393216
  buffer_load_dwordx4 v2, s[8:11], s42 offen nt lds
  s_add_u32 m0, s41, 8192
  s_mov_b32 s42, 786432
  buffer_load_dwordx4 v2, s[8:11], s42 offen nt lds
  s_add_u32 m0, s41, 12288
  s_mov_b32 s42, 1179648
  buffer_load_dwordx4 v2, s[8:11], s42 offen nt lds
  s_add_u32 m0, s41, 16384
  s_mov_b32 s42, 1572864
  buffer_load_dwordx4 v2, s[8:11], s42 offen nt lds
  s_add_u32 m0, s41, 20480
  s_mov_b32 s42, 1966080
  buffer_load_dwordx4 v2, s[8:11], s42 offen nt lds
  s_add_u32 m0, s41, 24576
  s_mov_b32 s42, 2359296
  buffer_load_dwordx4 v2, s[8:11], s42 offen nt lds
  s_add_u32 m0, s41, 28672
  s_mov_b32 s42, 2752512
  buffer_load_dwordx4 v2, s[8:11], s42 offen nt lds
  s_add_u32 m0, s41, 32768
  s_mov_b32 s42, 3145728
  buffer_load_dwordx4 v2, s[8:11], s42 offen nt lds
  s_add_u32 m0, s41, 36864
  s_mov_b32 s42, 3538944
  buffer_load_dwordx4 v2, s[8:11], s42 offen nt lds
  s_add_u32 m0, s41, 40960
  s_mov_b32 s42, 3932160
  buffer_load_dwordx4 v2, s[8:11], s42 offen nt lds
  s_add_u32 m0, s41, 45056
  s_mov_b32 s42, 4325376
  buffer_load_dwordx4 v2, s[8:11], s42 offen nt lds
  s_add_u32 m0, s41, 49152
  s_mov_b32 s42, 4718592
  buffer_load_dwordx4 v2, s[8:11], s42 offen nt lds
  s_add_u32 m0, s41, 53248
  s_mov_b32 s42, 5111808
  buffer_load_dwordx4 v2, s[8:11], s42 offen nt lds
  s_add_u32 m0, s41, 57344
  s_mov_b32 s42, 5505024
  buffer_load_dwordx4 v2, s[8:11], s42 offen nt lds
  s_add_u32 m0, s41, 61440
  s_mov_b32 s42, 5898240
  buffer_load_dwordx4 v2, s[8:11], s42 offen nt lds
  s_add_u32 m0, s41, 65536
  s_mov_b32 s42, 6291456
  buffer_load_dwordx4 v2, s[8:11], s42 offen nt lds
  s_add_u32 m0, s41, 69632
  s_mov_b32 s42, 6684672
  buffer_load_dwordx4 v2, s[8:11], s42 offen nt lds
  s_add_u32 m0, s41, 73728
  s_mov_b32 s42, 7077888
  buffer_load_dwordx4 v2, s[8:11], s42 offen nt lds
  s_add_u32 m0, s41, 77824
  s_mov_b32 s42, 7471104
  buffer_load_dwordx4 v2, s[8:11], s42 offen nt lds
  s_add_u32 m0, s41, 81920
  s_mov_b32 s42, 7864320
  buffer_load_dwordx4 v2, s[8:11], s42 offen nt lds
  s_add_u32 m0, s41, 86016
  s_mov_b32 s42, 8257536
  buffer_load_dwordx4 v2, s[8:11], s42 offen nt lds
  s_add_u32 m0, s41, 90112
  s_mov_b32 s42, 8650752
  buffer_load_dwordx4 v2, s[8:11], s42 offen nt lds
  s_add_u32 m0, s41, 94208
  s_mov_b32 s42, 9043968
  buffer_load_dwordx4 v2, s[8:11], s42 offen nt lds
  s_add_u32 m0, s41, 98304
  s_mov_b32 s42, 9437184
  buffer_load_dwordx4 v2, s[8:11], s42 offen nt lds
  s_add_u32 m0, s41, 102400
  s_mov_b32 s42, 9830400
  buffer_load_dwordx4 v2, s[8:11], s42 offen nt lds
  s_add_u32 m0, s41, 106496
  s_mov_b32 s42, 10223616
  buffer_load_dwordx4 v2, s[8:11], s42 offen nt lds
  s_add_u32 m0, s41, 110592
  s_mov_b32 s42, 10616832
  buffer_load_dwordx4 v2, s[8:11], s42 offen nt lds
  s_add_u32 m0, s41, 114688
  s_mov_b32 s42, 11010048
  buffer_load_dwordx4 v2, s[8:11], s42 offen nt lds
  s_add_u32 m0, s41, 118784
  s_mov_b32 s42, 11403264
  buffer_load_dwordx4 v2, s[8:11], s42 offen nt lds
  s_add_u32 m0, s41, 122880
  s_mov_b32 s42, 11796480
  buffer_load_dwordx4 v2, s[8:11], s42 offen nt lds
  s_add_u32 m0, s41, 126976
  s_mov_b32 s42, 12189696
  buffer_load_dwordx4 v2, s[8:11], s42 offen nt lds
  v_bfe_u32 v3, v0, 3, 2
  v_xor_b32 v3, s20, v3
  v_lshlrev_b32 v3, 5, v3
  v_lshrrev_b32 v4, 2, v0
  v_lshl_add_u32 v4, v4, 7, v3
  v_and_b32 v3, 3, v0
  v_lshl_add_u32 v4, v3, 3, v4
  v_add_u32 v5, 0x10000, v4
  v_lshrrev_b32 v6, 4, v0
  v_lshlrev_b32 v6, 4, v6
  v_add_u32 v6, 0x20000, v6
  v_add_u32 v1, 0x20000, v1
  s_mov_b32 s37, 0xbfb8aa3b
  s_waitcnt vmcnt(32)
  v_lshlrev_b32 v10, 16, v8
  v_and_b32 v11, 0xffff0000, v8
  v_lshlrev_b32 v12, 16, v9
  v_and_b32 v13, 0xffff0000, v9
  v_mul_f32 v14, s37, v10
  v_mul_f32 v15, s37, v11
  v_mul_f32 v16, s37, v12
  v_mul_f32 v17, s37, v13
  v_exp_f32 v14, v14
  v_exp_f32 v15, v15
  v_exp_f32 v16, v16
  v_exp_f32 v17, v17
  v_add_f32 v14, 1.0, v14
  v_add_f32 v15, 1.0, v15
  v_add_f32 v16, 1.0, v16
  v_add_f32 v17, 1.0, v17
  v_rcp_f32 v14, v14
  v_rcp_f32 v15, v15
  v_rcp_f32 v16, v16
  v_rcp_f32 v17, v17
  v_mul_f32 v10, v10, v14
  v_mul_f32 v11, v11, v15
  v_mul_f32 v12, v12, v16
  v_mul_f32 v13, v13, v17
  v_cvt_pk_bf16_f32 v8, v10, v11
  v_cvt_pk_bf16_f32 v9, v12, v13
  ds_write_b64 v1, v[8:9]
  s_waitcnt vmcnt(28) lgkmcnt(0)
  s_barrier
  ds_read_b64_tr_b16 v[24:25], v4 offset:0
  ds_read_b64_tr_b16 v[26:27], v4 offset:2048
  ds_read_b128 v[28:31], v6 offset:0
  ds_read_b64_tr_b16 v[32:33], v4 offset:4096
  ds_read_b64_tr_b16 v[34:35], v4 offset:6144
  ds_read_b128 v[36:39], v6 offset:64
  ds_read_b64_tr_b16 v[40:41], v4 offset:8192
  ds_read_b64_tr_b16 v[42:43], v4 offset:10240
  ds_read_b128 v[44:47], v6 offset:128
  ds_read_b64_tr_b16 v[48:49], v4 offset:12288
  ds_read_b64_tr_b16 v[50:51], v4 offset:14336
  ds_read_b128 v[52:55], v6 offset:192
  s_waitcnt lgkmcnt(9)
  v_mfma_f32_16x16x32_bf16 v[20:23], v[24:27], v[28:31], 0
  s_waitcnt lgkmcnt(6)
  v_mfma_f32_16x16x32_bf16 v[20:23], v[32:35], v[36:39], v[20:23]
  s_waitcnt lgkmcnt(3)
  v_mfma_f32_16x16x32_bf16 v[20:23], v[40:43], v[44:47], v[20:23]
  s_waitcnt lgkmcnt(0)
  v_mfma_f32_16x16x32_bf16 v[20:23], v[48:51], v[52:55], v[20:23]
  s_waitcnt vmcnt(24) lgkmcnt(0)
  s_barrier
  ds_read_b64_tr_b16 v[24:25], v4 offset:16384
  ds_read_b64_tr_b16 v[26:27], v4 offset:18432
  ds_read_b128 v[28:31], v6 offset:256
  ds_read_b64_tr_b16 v[32:33], v4 offset:20480
  ds_read_b64_tr_b16 v[34:35], v4 offset:22528
  ds_read_b128 v[36:39], v6 offset:320
  ds_read_b64_tr_b16 v[40:41], v4 offset:24576
  ds_read_b64_tr_b16 v[42:43], v4 offset:26624
  ds_read_b128 v[44:47], v6 offset:384
  ds_read_b64_tr_b16 v[48:49], v4 offset:28672
  ds_read_b64_tr_b16 v[50:51], v4 offset:30720
  ds_read_b128 v[52:55], v6 offset:448
  s_waitcnt lgkmcnt(9)
  v_mfma_f32_16x16x32_bf16 v[20:23], v[24:27], v[28:31], v[20:23]
  s_waitcnt lgkmcnt(6)
  v_mfma_f32_16x16x32_bf16 v[20:23], v[32:35], v[36:39], v[20:23]
  s_waitcnt lgkmcnt(3)
  v_mfma_f32_16x16x32_bf16 v[20:23], v[40:43], v[44:47], v[20:23]
  s_waitcnt lgkmcnt(0)
  v_mfma_f32_16x16x32_bf16 v[20:23], v[48:51], v[52:55], v[20:23]
  s_waitcnt vmcnt(20) lgkmcnt(0)
  s_barrier
  ds_read_b64_tr_b16 v[24:25], v4 offset:32768
  ds_read_b64_tr_b16 v[26:27], v4 offset:34816
  ds_read_b128 v[28:31], v6 offset:512
  ds_read_b64_tr_b16 v[32:33], v4 offset:36864
  ds_read_b64_tr_b16 v[34:35], v4 offset:38912
  ds_read_b128 v[36:39], v6 offset:576
  ds_read_b64_tr_b16 v[40:41], v4 offset:40960
  ds_read_b64_tr_b16 v[42:43], v4 offset:43008
  ds_read_b128 v[44:47], v6 offset:640
  ds_read_b64_tr_b16 v[48:49], v4 offset:45056
  ds_read_b64_tr_b16 v[50:51], v4 offset:47104
  ds_read_b128 v[52:55], v6 offset:704
  s_waitcnt lgkmcnt(9)
  v_mfma_f32_16x16x32_bf16 v[20:23], v[24:27], v[28:31], v[20:23]
  s_waitcnt lgkmcnt(6)
  v_mfma_f32_16x16x32_bf16 v[20:23], v[32:35], v[36:39], v[20:23]
  s_waitcnt lgkmcnt(3)
  v_mfma_f32_16x16x32_bf16 v[20:23], v[40:43], v[44:47], v[20:23]
  s_waitcnt lgkmcnt(0)
  v_mfma_f32_16x16x32_bf16 v[20:23], v[48:51], v[52:55], v[20:23]
  s_waitcnt vmcnt(16) lgkmcnt(0)
  s_barrier
  ds_read_b64_tr_b16 v[24:25], v4 offset:49152
  ds_read_b64_tr_b16 v[26:27], v4 offset:51200
  ds_read_b128 v[28:31], v6 offset:768
  ds_read_b64_tr_b16 v[32:33], v4 offset:53248
  ds_read_b64_tr_b16 v[34:35], v4 offset:55296
  ds_read_b128 v[36:39], v6 offset:832
  ds_read_b64_tr_b16 v[40:41], v4 offset:57344
  ds_read_b64_tr_b16 v[42:43], v4 offset:59392
  ds_read_b128 v[44:47], v6 offset:896
  ds_read_b64_tr_b16 v[48:49], v4 offset:61440
  ds_read_b64_tr_b16 v[50:51], v4 offset:63488
  ds_read_b128 v[52:55], v6 offset:960
  s_waitcnt lgkmcnt(9)
  v_mfma_f32_16x16x32_bf16 v[20:23], v[24:27], v[28:31], v[20:23]
  s_waitcnt lgkmcnt(6)
  v_mfma_f32_16x16x32_bf16 v[20:23], v[32:35], v[36:39], v[20:23]
  s_waitcnt lgkmcnt(3)
  v_mfma_f32_16x16x32_bf16 v[20:23], v[40:43], v[44:47], v[20:23]
  s_waitcnt lgkmcnt(0)
  v_mfma_f32_16x16x32_bf16 v[20:23], v[48:51], v[52:55], v[20:23]
  s_waitcnt vmcnt(12) lgkmcnt(0)
  s_barrier
  ds_read_b64_tr_b16 v[24:25], v5 offset:0
  ds_read_b64_tr_b16 v[26:27], v5 offset:2048
  ds_read_b128 v[28:31], v6 offset:1024
  ds_read_b64_tr_b16 v[32:33], v5 offset:4096
  ds_read_b64_tr_b16 v[34:35], v5 offset:6144
  ds_read_b128 v[36:39], v6 offset:1088
  ds_read_b64_tr_b16 v[40:41], v5 offset:8192
  ds_read_b64_tr_b16 v[42:43], v5 offset:10240
  ds_read_b128 v[44:47], v6 offset:1152
  ds_read_b64_tr_b16 v[48:49], v5 offset:12288
  ds_read_b64_tr_b16 v[50:51], v5 offset:14336
  ds_read_b128 v[52:55], v6 offset:1216
  s_waitcnt lgkmcnt(9)
  v_mfma_f32_16x16x32_bf16 v[20:23], v[24:27], v[28:31], v[20:23]
  s_waitcnt lgkmcnt(6)
  v_mfma_f32_16x16x32_bf16 v[20:23], v[32:35], v[36:39], v[20:23]
  s_waitcnt lgkmcnt(3)
  v_mfma_f32_16x16x32_bf16 v[20:23], v[40:43], v[44:47], v[20:23]
  s_waitcnt lgkmcnt(0)
  v_mfma_f32_16x16x32_bf16 v[20:23], v[48:51], v[52:55], v[20:23]
  s_waitcnt vmcnt(8) lgkmcnt(0)
  s_barrier
  ds_read_b64_tr_b16 v[24:25], v5 offset:16384
  ds_read_b64_tr_b16 v[26:27], v5 offset:18432
  ds_read_b128 v[28:31], v6 offset:1280
  ds_read_b64_tr_b16 v[32:33], v5 offset:20480
  ds_read_b64_tr_b16 v[34:35], v5 offset:22528
  ds_read_b128 v[36:39], v6 offset:1344
  ds_read_b64_tr_b16 v[40:41], v5 offset:24576
  ds_read_b64_tr_b16 v[42:43], v5 offset:26624
  ds_read_b128 v[44:47], v6 offset:1408
  ds_read_b64_tr_b16 v[48:49], v5 offset:28672
  ds_read_b64_tr_b16 v[50:51], v5 offset:30720
  ds_read_b128 v[52:55], v6 offset:1472
  s_waitcnt lgkmcnt(9)
  v_mfma_f32_16x16x32_bf16 v[20:23], v[24:27], v[28:31], v[20:23]
  s_waitcnt lgkmcnt(6)
  v_mfma_f32_16x16x32_bf16 v[20:23], v[32:35], v[36:39], v[20:23]
  s_waitcnt lgkmcnt(3)
  v_mfma_f32_16x16x32_bf16 v[20:23], v[40:43], v[44:47], v[20:23]
  s_waitcnt lgkmcnt(0)
  v_mfma_f32_16x16x32_bf16 v[20:23], v[48:51], v[52:55], v[20:23]
  s_waitcnt vmcnt(4) lgkmcnt(0)
  s_barrier
  ds_read_b64_tr_b16 v[24:25], v5 offset:32768
  ds_read_b64_tr_b16 v[26:27], v5 offset:34816
  ds_read_b128 v[28:31], v6 offset:1536
  ds_read_b64_tr_b16 v[32:33], v5 offset:36864
  ds_read_b64_tr_b16 v[34:35], v5 offset:38912
  ds_read_b128 v[36:39], v6 offset:1600
  ds_read_b64_tr_b16 v[40:41], v5 offset:40960
  ds_read_b64_tr_b16 v[42:43], v5 offset:43008
  ds_read_b128 v[44:47], v6 offset:1664
  ds_read_b64_tr_b16 v[48:49], v5 offset:45056
  ds_read_b64_tr_b16 v[50:51], v5 offset:47104
  ds_read_b128 v[52:55], v6 offset:1728
  s_waitcnt lgkmcnt(9)
  v_mfma_f32_16x16x32_bf16 v[20:23], v[24:27], v[28:31], v[20:23]
  s_waitcnt lgkmcnt(6)
  v_mfma_f32_16x16x32_bf16 v[20:23], v[32:35], v[36:39], v[20:23]
  s_waitcnt lgkmcnt(3)
  v_mfma_f32_16x16x32_bf16 v[20:23], v[40:43], v[44:47], v[20:23]
  s_waitcnt lgkmcnt(0)
  v_mfma_f32_16x16x32_bf16 v[20:23], v[48:51], v[52:55], v[20:23]
  s_waitcnt vmcnt(0) lgkmcnt(0)
  s_barrier
  ds_read_b64_tr_b16 v[24:25], v5 offset:49152
  ds_read_b64_tr_b16 v[26:27], v5 offset:51200
  ds_read_b128 v[28:31], v6 offset:1792
  ds_read_b64_tr_b16 v[32:33], v5 offset:53248
  ds_read_b64_tr_b16 v[34:35], v5 offset:55296
  ds_read_b128 v[36:39], v6 offset:1856
  ds_read_b64_tr_b16 v[40:41], v5 offset:57344
  ds_read_b64_tr_b16 v[42:43], v5 offset:59392
  ds_read_b128 v[44:47], v6 offset:1920
  ds_read_b64_tr_b16 v[48:49], v5 offset:61440
  ds_read_b64_tr_b16 v[50:51], v5 offset:63488
  ds_read_b128 v[52:55], v6 offset:1984
  s_waitcnt lgkmcnt(9)
  v_mfma_f32_16x16x32_bf16 v[20:23], v[24:27], v[28:31], v[20:23]
  s_waitcnt lgkmcnt(6)
  v_mfma_f32_16x16x32_bf16 v[20:23], v[32:35], v[36:39], v[20:23]
  s_waitcnt lgkmcnt(3)
  v_mfma_f32_16x16x32_bf16 v[20:23], v[40:43], v[44:47], v[20:23]
  s_waitcnt lgkmcnt(0)
  v_mfma_f32_16x16x32_bf16 v[20:23], v[48:51], v[52:55], v[20:23]
  s_lshl_b32 s40, s21, 8
  s_lshl_b32 s41, s20, 6
  s_add_u32 s40, s40, s41
  s_add_u32 s40, s40, 1572864
  v_and_b32 v2, 15, v0
  v_cmp_eq_u32 vcc, 0, v2
  v_mov_b32 v3, 2147483392
  s_nop 0
  v_cndmask_b32 v1, v3, v0, vcc
  v_cvt_pk_bf16_f32 v8, v20, v21
  v_cvt_pk_bf16_f32 v9, v22, v23
  v_lshlrev_b32 v20, 16, v8
  v_and_b32 v21, 0xffff0000, v8
  v_lshlrev_b32 v22, 16, v9
  v_and_b32 v23, 0xffff0000, v9
  buffer_store_dwordx4 v[20:23], v1, s[4:7], s40 offen sc1
  v_min_u32 v2, 31, v0
  v_lshlrev_b32 v2, 2, v2
  v_add_u32 v2, 128, v2
  s_nop 1
Lpoll_1:
  buffer_load_dword v3, v2, s[12:15], 0 offen sc1
  s_sub_u32 s24, s24, 1
  s_cbranch_scc1 L_FAIL
  s_waitcnt vmcnt(0)
  v_cmp_gt_i32 vcc, 1, v3
  s_cbranch_vccz Lpolld_2
  s_sleep 2
  s_branch Lpoll_1
Lpolld_2:
  s_lshl_b32 s40, s21, 7
  s_add_u32 s40, s40, 1376256
  v_mov_b32 v2, 2147483392
  s_mov_b64 exec, 1
  v_mov_b32 v2, s40
  s_mov_b64 exec, -1
  v_mov_b32 v3, 1
  s_barrier
  s_cmp_lg_u32 s20, 0
  s_cbranch_scc1 L_MOD_done
  buffer_store_dword v3, v2, s[4:7], 0 offen sc1
L_MOD_done:
  s_cmp_ge_u32 s21, 32
  s_cbranch_scc1 L_MOD_back
L_LN1:
  s_load_dwordx2 s[16:17], s[0:1], 0
  s_mov_b32 s18, 4194304
  s_mov_b32 s19, 0x20000
  s_waitcnt lgkmcnt(0)
  s_sub_u32 s43, 7, s22
  s_lshl_b32 s43, s43, 5
  s_add_u32 s43, s43, s23
  s_lshl_b32 s43, s43, 2
  s_add_u32 s43, s43, s20
  s_lshl_b32 s44, s43, 13
  s_add_u32 s45, s44, 4096
  v_lshlrev_b32 v1, 3, v0
  v_lshlrev_b32 v2, 4, v0
  buffer_load_dwordx2 v[8:9], v1, s[16:19], s44 offen offset:0 nt
  buffer_load_dwordx2 v[10:11], v1, s[16:19], s44 offen offset:512 nt
  buffer_load_dwordx2 v[12:13], v1, s[16:19], s44 offen offset:1024 nt
  buffer_load_dwordx2 v[14:15], v1, s[16:19], s44 offen offset:1536 nt
  buffer_load_dwordx2 v[16:17], v1, s[16:19], s44 offen offset:2048 nt
  buffer_load_dwordx2 v[18:19], v1, s[16:19], s44 offen offset:2560 nt
  buffer_load_dwordx2 v[20:21], v1, s[16:19], s44 offen offset:3072 nt
  buffer_load_dwordx2 v[22:23], v1, s[16:19], s44 offen offset:3584 nt
  buffer_load_dwordx2 v[24:25], v1, s[16:19], s45 offen offset:0 nt
  buffer_load_dwordx2 v[26:27], v1, s[16:19], s45 offen offset:512 nt
  buffer_load_dwordx2 v[28:29], v1, s[16:19], s45 offen offset:1024 nt
  buffer_load_dwordx2 v[30:31], v1, s[16:19], s45 offen offset:1536 nt
  buffer_load_dwordx2 v[32:33], v1, s[16:19], s45 offen offset:2048 nt
  buffer_load_dwordx2 v[34:35], v1, s[16:19], s45 offen offset:2560 nt
  buffer_load_dwordx2 v[36:37], v1, s[16:19], s45 offen offset:3072 nt
  buffer_load_dwordx2 v[38:39], v1, s[16:19], s45 offen offset:3584 nt
  s_waitcnt vmcnt(0)
  v_lshlrev_b32 v40, 16, v8
  v_and_b32 v41, 0xffff0000, v8
  v_lshlrev_b32 v42, 16, v9
  v_and_b32 v43, 0xffff0000, v9
  v_lshlrev_b32 v44, 16, v10
  v_and_b32 v45, 0xffff0000, v10
  v_lshlrev_b32 v46, 16, v11
  v_and_b32 v47, 0xffff0000, v11
  v_lshlrev_b32 v48, 16, v12
  v_and_b32 v49, 0xffff0000, v12
  v_lshlrev_b32 v50, 16, v13
  v_and_b32 v51, 0xffff0000, v13
  v_lshlrev_b32 v52, 16, v14
  v_and_b32 v53, 0xffff0000, v14
  v_lshlrev_b32 v54, 16, v15
  v_and_b32 v55, 0xffff0000, v15
  v_lshlrev_b32 v56, 16, v16
  v_and_b32 v57, 0xffff0000, v16
  v_lshlrev_b32 v58, 16, v17
  v_and_b32 v59, 0xffff0000, v17
  v_lshlrev_b32 v60, 16, v18
  v_and_b32 v61, 0xffff0000, v18
  v_lshlrev_b32 v62, 16, v19
  v_and_b32 v63, 0xffff0000, v19
  v_lshlrev_b32 v64, 16, v20
  v_and_b32 v65, 0xffff0000, v20
  v_lshlrev_b32 v66, 16, v21
  v_and_b32 v67, 0xffff0000, v21
  v_lshlrev_b32 v68, 16, v22
  v_and_b32 v69, 0xffff0000, v22
  v_lshlrev_b32 v70, 16, v23
  v_and_b32 v71, 0xffff0000, v23
  v_lshlrev_b32 v72, 16, v24
  v_and_b32 v73, 0xffff0000, v24
  v_lshlrev_b32 v74, 16, v25
  v_and_b32 v75, 0xffff0000, v25
  v_lshlrev_b32 v76, 16, v26
  v_and_b32 v77, 0xffff0000, v26
  v_lshlrev_b32 v78, 16, v27
  v_and_b32 v79, 0xffff0000, v27
  v_lshlrev_b32 v80, 16, v28
  v_and_b32 v81, 0xffff0000, v28
  v_lshlrev_b32 v82, 16, v29
  v_and_b32 v83, 0xffff0000, v29
  v_lshlrev_b32 v84, 16, v30
  v_and_b32 v85, 0xffff0000, v30
  v_lshlrev_b32 v86, 16, v31
  v_and_b32 v87, 0xffff0000, v31
  v_lshlrev_b32 v88, 16, v32
  v_and_b32 v89, 0xffff0000, v32
  v_lshlrev_b32 v90, 16, v33
  v_and_b32 v91, 0xffff0000, v33
  v_lshlrev_b32 v92, 16, v34
  v_and_b32 v93, 0xffff0000, v34
  v_lshlrev_b32 v94, 16, v35
  v_and_b32 v95, 0xffff0000, v35
  v_lshlrev_b32 v96, 16, v36
  v_and_b32 v97, 0xffff0000, v36
  v_lshlrev_b32 v98, 16, v37
  v_and_b32 v99, 0xffff0000, v37
  v_lshlrev_b32 v100, 16, v38
  v_and_b32 v101, 0xffff0000, v38
  v_lshlrev_b32 v102, 16, v39
  v_and_b32 v103, 0xffff0000, v39
  v_pk_add_f32 v[104:105], v[40:41], v[42:43]
  v_pk_add_f32 v[108:109], v[56:57], v[58:59]
  v_pk_add_f32 v[112:113], v[72:73], v[74:75]
  v_pk_add_f32 v[116:117], v[88:89], v[90:91]
  v_pk_add_f32 v[104:105], v[104:105], v[44:45]
  v_pk_add_f32 v[108:109], v[108:109], v[60:61]
  v_pk_add_f32 v[112:113], v[112:113], v[76:77]
  v_pk_add_f32 v[116:117], v[116:117], v[92:93]
  v_pk_add_f32 v[104:105], v[104:105], v[46:47]
  v_pk_add_f32 v[108:109], v[108:109], v[62:63]
  v_pk_add_f32 v[112:113], v[112:113], v[78:79]
  v_pk_add_f32 v[116:117], v[116:117], v[94:95]
  v_pk_add_f32 v[104:105], v[104:105], v[48:49]
  v_pk_add_f32 v[108:109], v[108:109], v[64:65]
  v_pk_add_f32 v[112:113], v[112:113], v[80:81]
  v_pk_add_f32 v[116:117], v[116:117], v[96:97]
  v_pk_add_f32 v[104:105], v[104:105], v[50:51]
  v_pk_add_f32 v[108:109], v[108:109], v[66:67]
  v_pk_add_f32 v[112:113], v[112:113], v[82:83]
  v_pk_add_f32 v[116:117], v[116:117], v[98:99]
  v_pk_add_f32 v[104:105], v[104:105], v[52:53]
  v_pk_add_f32 v[108:109], v[108:109], v[68:69]
  v_pk_add_f32 v[112:113], v[112:113], v[84:85]
  v_pk_add_f32 v[116:117], v[116:117], v[100:101]
  v_pk_add_f32 v[104:105], v[104:105], v[54:55]
  v_pk_add_f32 v[108:109], v[108:109], v[70:71]
  v_pk_add_f32 v[112:113], v[112:113], v[86:87]
  v_pk_add_f32 v[116:117], v[116:117], v[102:103]
  v_add_f32 v104, v104, v105
  v_add_f32 v108, v108, v109
  v_add_f32 v112, v112, v113
  v_add_f32 v116, v116, v117
  v_add_f32_dpp v104, v104, v104 row_ror:8 row_mask:0xf bank_mask:0xf
  v_add_f32_dpp v108, v108, v108 row_ror:8 row_mask:0xf bank_mask:0xf
  v_add_f32_dpp v112, v112, v112 row_ror:8 row_mask:0xf bank_mask:0xf
  v_add_f32_dpp v116, v116, v116 row_ror:8 row_mask:0xf bank_mask:0xf
  v_add_f32_dpp v104, v104, v104 row_ror:4 row_mask:0xf bank_mask:0xf
  v_add_f32_dpp v108, v108, v108 row_ror:4 row_mask:0xf bank_mask:0xf
  v_add_f32_dpp v112, v112, v112 row_ror:4 row_mask:0xf bank_mask:0xf
  v_add_f32_dpp v116, v116, v116 row_ror:4 row_mask:0xf bank_mask:0xf
  v_add_f32_dpp v104, v104, v104 row_ror:2 row_mask:0xf bank_mask:0xf
  v_add_f32_dpp v108, v108, v108 row_ror:2 row_mask:0xf bank_mask:0xf
  v_add_f32_dpp v112, v112, v112 row_ror:2 row_mask:0xf bank_mask:0xf
  v_add_f32_dpp v116, v116, v116 row_ror:2 row_mask:0xf bank_mask:0xf
  v_add_f32_dpp v104, v104, v104 row_ror:1 row_mask:0xf bank_mask:0xf
  v_add_f32_dpp v108, v108, v108 row_ror:1 row_mask:0xf bank_mask:0xf
  v_add_f32_dpp v112, v112, v112 row_ror:1 row_mask:0xf bank_mask:0xf
  v_add_f32_dpp v116, v116, v116 row_ror:1 row_mask:0xf bank_mask:0xf
  v_mov_b32 v105, v104
  v_mov_b32 v109, v108
  v_mov_b32 v113, v112
  v_mov_b32 v117, v116
  v_permlane16_swap_b32 v105, v104
  v_permlane16_swap_b32 v109, v108
  v_permlane16_swap_b32 v113, v112
  v_permlane16_swap_b32 v117, v116
  v_add_f32 v104, v104, v105
  v_add_f32 v108, v108, v109
  v_add_f32 v112, v112, v113
  v_add_f32 v116, v116, v117
  v_mov_b32 v105, v104
  v_mov_b32 v109, v108
  v_mov_b32 v113, v112
  v_mov_b32 v117, v116
  v_permlane32_swap_b32 v105, v104
  v_permlane32_swap_b32 v109, v108
  v_permlane32_swap_b32 v113, v112
  v_permlane32_swap_b32 v117, v116
  v_add_f32 v104, v104, v105
  v_add_f32 v108, v108, v109
  v_add_f32 v112, v112, v113
  v_add_f32 v116, v116, v117
  v_mul_f32 v104, 0xba800000, v104
  v_mul_f32 v108, 0xba800000, v108
  v_mul_f32 v112, 0xba800000, v112
  v_mul_f32 v116, 0xba800000, v116
  v_pk_add_f32 v[40:41], v[40:41], v[104:105] op_sel_hi:[1,0]
  v_pk_add_f32 v[56:57], v[56:57], v[108:109] op_sel_hi:[1,0]
  v_pk_add_f32 v[72:73], v[72:73], v[112:113] op_sel_hi:[1,0]
  v_pk_add_f32 v[88:89], v[88:89], v[116:117] op_sel_hi:[1,0]
  v_pk_add_f32 v[42:43], v[42:43], v[104:105] op_sel_hi:[1,0]
  v_pk_add_f32 v[58:59], v[58:59], v[108:109] op_sel_hi:[1,0]
  v_pk_add_f32 v[74:75], v[74:75], v[112:113] op_sel_hi:[1,0]
  v_pk_add_f32 v[90:91], v[90:91], v[116:117] op_sel_hi:[1,0]
  v_pk_add_f32 v[44:45], v[44:45], v[104:105] op_sel_hi:[1,0]
  v_pk_add_f32 v[60:61], v[60:61], v[108:109] op_sel_hi:[1,0]
  v_pk_add_f32 v[76:77], v[76:77], v[112:113] op_sel_hi:[1,0]
  v_pk_add_f32 v[92:93], v[92:93], v[116:117] op_sel_hi:[1,0]
  v_pk_add_f32 v[46:47], v[46:47], v[104:105] op_sel_hi:[1,0]
  v_pk_add_f32 v[62:63], v[62:63], v[108:109] op_sel_hi:[1,0]
  v_pk_add_f32 v[78:79], v[78:79], v[112:113] op_sel_hi:[1,0]
  v_pk_add_f32 v[94:95], v[94:95], v[116:117] op_sel_hi:[1,0]
  v_pk_add_f32 v[48:49], v[48:49], v[104:105] op_sel_hi:[1,0]
  v_pk_add_f32 v[64:65], v[64:65], v[108:109] op_sel_hi:[1,0]
  v_pk_add_f32 v[80:81], v[80:81], v[112:113] op_sel_hi:[1,0]
  v_pk_add_f32 v[96:97], v[96:97], v[116:117] op_sel_hi:[1,0]
  v_pk_add_f32 v[50:51], v[50:51], v[104:105] op_sel_hi:[1,0]
  v_pk_add_f32 v[66:67], v[66:67], v[108:109] op_sel_hi:[1,0]
  v_pk_add_f32 v[82:83], v[82:83], v[112:113] op_sel_hi:[1,0]
  v_pk_add_f32 v[98:99], v[98:99], v[116:117] op_sel_hi:[1,0]
  v_pk_add_f32 v[52:53], v[52:53], v[104:105] op_sel_hi:[1,0]
  v_pk_add_f32 v[68:69], v[68:69], v[108:109] op_sel_hi:[1,0]
  v_pk_add_f32 v[84:85], v[84:85], v[112:113] op_sel_hi:[1,0]
  v_pk_add_f32 v[100:101], v[100:101], v[116:117] op_sel_hi:[1,0]
  v_pk_add_f32 v[54:55], v[54:55], v[104:105] op_sel_hi:[1,0]
  v_pk_add_f32 v[70:71], v[70:71], v[108:109] op_sel_hi:[1,0]
  v_pk_add_f32 v[86:87], v[86:87], v[112:113] op_sel_hi:[1,0]
  v_pk_add_f32 v[102:103], v[102:103], v[116:117] op_sel_hi:[1,0]
  v_pk_mul_f32 v[104:105], v[40:41], v[40:41]
  v_pk_mul_f32 v[108:109], v[56:57], v[56:57]
  v_pk_mul_f32 v[112:113], v[72:73], v[72:73]
  v_pk_mul_f32 v[116:117], v[88:89], v[88:89]
  v_pk_fma_f32 v[104:105], v[42:43], v[42:43], v[104:105]
  v_pk_fma_f32 v[108:109], v[58:59], v[58:59], v[108:109]
  v_pk_fma_f32 v[112:113], v[74:75], v[74:75], v[112:113]
  v_pk_fma_f32 v[116:117], v[90:91], v[90:91], v[116:117]
  v_pk_fma_f32 v[104:105], v[44:45], v[44:45], v[104:105]
  v_pk_fma_f32 v[108:109], v[60:61], v[60:61], v[108:109]
  v_pk_fma_f32 v[112:113], v[76:77], v[76:77], v[112:113]
  v_pk_fma_f32 v[116:117], v[92:93], v[92:93], v[116:117]
  v_pk_fma_f32 v[104:105], v[46:47], v[46:47], v[104:105]
  v_pk_fma_f32 v[108:109], v[62:63], v[62:63], v[108:109]
  v_pk_fma_f32 v[112:113], v[78:79], v[78:79], v[112:113]
  v_pk_fma_f32 v[116:117], v[94:95], v[94:95], v[116:117]
  v_pk_fma_f32 v[104:105], v[48:49], v[48:49], v[104:105]
  v_pk_fma_f32 v[108:109], v[64:65], v[64:65], v[108:109]
  v_pk_fma_f32 v[112:113], v[80:81], v[80:81], v[112:113]
  v_pk_fma_f32 v[116:117], v[96:97], v[96:97], v[116:117]
  v_pk_fma_f32 v[104:105], v[50:51], v[50:51], v[104:105]
  v_pk_fma_f32 v[108:109], v[66:67], v[66:67], v[108:109]
  v_pk_fma_f32 v[112:113], v[82:83], v[82:83], v[112:113]
  v_pk_fma_f32 v[116:117], v[98:99], v[98:99], v[116:117]
  v_pk_fma_f32 v[104:105], v[52:53], v[52:53], v[104:105]
  v_pk_fma_f32 v[108:109], v[68:69], v[68:69], v[108:109]
  v_pk_fma_f32 v[112:113], v[84:85], v[84:85], v[112:113]
  v_pk_fma_f32 v[116:117], v[100:101], v[100:101], v[116:117]
  v_pk_fma_f32 v[104:105], v[54:55], v[54:55], v[104:105]
  v_pk_fma_f32 v[108:109], v[70:71], v[70:71], v[108:109]
  v_pk_fma_f32 v[112:113], v[86:87], v[86:87], v[112:113]
  v_pk_fma_f32 v[116:117], v[102:103], v[102:103], v[116:117]
  v_add_f32 v104, v104, v105
  v_add_f32 v108, v108, v109
  v_add_f32 v112, v112, v113
  v_add_f32 v116, v116, v117
  v_add_f32_dpp v104, v104, v104 row_ror:8 row_mask:0xf bank_mask:0xf
  v_add_f32_dpp v108, v108, v108 row_ror:8 row_mask:0xf bank_mask:0xf
  v_add_f32_dpp v112, v112, v112 row_ror:8 row_mask:0xf bank_mask:0xf
  v_add_f32_dpp v116, v116, v116 row_ror:8 row_mask:0xf bank_mask:0xf
  v_add_f32_dpp v104, v104, v104 row_ror:4 row_mask:0xf bank_mask:0xf
  v_add_f32_dpp v108, v108, v108 row_ror:4 row_mask:0xf bank_mask:0xf
  v_add_f32_dpp v112, v112, v112 row_ror:4 row_mask:0xf bank_mask:0xf
  v_add_f32_dpp v116, v116, v116 row_ror:4 row_mask:0xf bank_mask:0xf
  v_add_f32_dpp v104, v104, v104 row_ror:2 row_mask:0xf bank_mask:0xf
  v_add_f32_dpp v108, v108, v108 row_ror:2 row_mask:0xf bank_mask:0xf
  v_add_f32_dpp v112, v112, v112 row_ror:2 row_mask:0xf bank_mask:0xf
  v_add_f32_dpp v116, v116, v116 row_ror:2 row_mask:0xf bank_mask:0xf
  v_add_f32_dpp v104, v104, v104 row_ror:1 row_mask:0xf bank_mask:0xf
  v_add_f32_dpp v108, v108, v108 row_ror:1 row_mask:0xf bank_mask:0xf
  v_add_f32_dpp v112, v112, v112 row_ror:1 row_mask:0xf bank_mask:0xf
  v_add_f32_dpp v116, v116, v116 row_ror:1 row_mask:0xf bank_mask:0xf
  v_mov_b32 v105, v104
  v_mov_b32 v109, v108
  v_mov_b32 v113, v112
  v_mov_b32 v117, v116
  v_permlane16_swap_b32 v105, v104
  v_permlane16_swap_b32 v109, v108
  v_permlane16_swap_b32 v113, v112
  v_permlane16_swap_b32 v117, v116
  v_add_f32 v104, v104, v105
  v_add_f32 v108, v108, v109
  v_add_f32 v112, v112, v113
  v_add_f32 v116, v116, v117
  v_mov_b32 v105, v104
  v_mov_b32 v109, v108
  v_mov_b32 v113, v112
  v_mov_b32 v117, v116
  v_permlane32_swap_b32 v105, v104
  v_permlane32_swap_b32 v109, v108
  v_permlane32_swap_b32 v113, v112
  v_permlane32_swap_b32 v117, v116
  v_add_f32 v104, v104, v105
  v_add_f32 v108, v108, v109
  v_add_f32 v112, v112, v113
  v_add_f32 v116, v116, v117
  v_mul_f32 v104, 0x3a800000, v104
  v_mul_f32 v108, 0x3a800000, v108
  v_mul_f32 v112, 0x3a800000, v112
  v_mul_f32 v116, 0x3a800000, v116
  v_add_f32 v104, 0x3727c5ac, v104
  v_add_f32 v108, 0x3727c5ac, v108
  v_add_f32 v112, 0x3727c5ac, v112
  v_add_f32 v116, 0x3727c5ac, v116
  v_rsq_f32 v104, v104
  v_rsq_f32 v108, v108
  v_rsq_f32 v112, v112
  v_rsq_f32 v116, v116
  v_pk_mul_f32 v[40:41], v[40:41], v[104:105] op_sel_hi:[1,0]
  v_pk_mul_f32 v[56:57], v[56:57], v[108:109] op_sel_hi:[1,0]
  v_pk_mul_f32 v[72:73], v[72:73], v[112:113] op_sel_hi:[1,0]
  v_pk_mul_f32 v[88:89], v[88:89], v[116:117] op_sel_hi:[1,0]
  v_pk_mul_f32 v[42:43], v[42:43], v[104:105] op_sel_hi:[1,0]
  v_pk_mul_f32 v[58:59], v[58:59], v[108:109] op_sel_hi:[1,0]
  v_pk_mul_f32 v[74:75], v[74:75], v[112:113] op_sel_hi:[1,0]
  v_pk_mul_f32 v[90:91], v[90:91], v[116:117] op_sel_hi:[1,0]
  v_pk_mul_f32 v[44:45], v[44:45], v[104:105] op_sel_hi:[1,0]
  v_pk_mul_f32 v[60:61], v[60:61], v[108:109] op_sel_hi:[1,0]
  v_pk_mul_f32 v[76:77], v[76:77], v[112:113] op_sel_hi:[1,0]
  v_pk_mul_f32 v[92:93], v[92:93], v[116:117] op_sel_hi:[1,0]
  v_pk_mul_f32 v[46:47], v[46:47], v[104:105] op_sel_hi:[1,0]
  v_pk_mul_f32 v[62:63], v[62:63], v[108:109] op_sel_hi:[1,0]
  v_pk_mul_f32 v[78:79], v[78:79], v[112:113] op_sel_hi:[1,0]
  v_pk_mul_f32 v[94:95], v[94:95], v[116:117] op_sel_hi:[1,0]
  v_pk_mul_f32 v[48:49], v[48:49], v[104:105] op_sel_hi:[1,0]
  v_pk_mul_f32 v[64:65], v[64:65], v[108:109] op_sel_hi:[1,0]
  v_pk_mul_f32 v[80:81], v[80:81], v[112:113] op_sel_hi:[1,0]
  v_pk_mul_f32 v[96:97], v[96:97], v[116:117] op_sel_hi:[1,0]
  v_pk_mul_f32 v[50:51], v[50:51], v[104:105] op_sel_hi:[1,0]
  v_pk_mul_f32 v[66:67], v[66:67], v[108:109] op_sel_hi:[1,0]
  v_pk_mul_f32 v[82:83], v[82:83], v[112:113] op_sel_hi:[1,0]
  v_pk_mul_f32 v[98:99], v[98:99], v[116:117] op_sel_hi:[1,0]
  v_pk_mul_f32 v[52:53], v[52:53], v[104:105] op_sel_hi:[1,0]
  v_pk_mul_f32 v[68:69], v[68:69], v[108:109] op_sel_hi:[1,0]
  v_pk_mul_f32 v[84:85], v[84:85], v[112:113] op_sel_hi:[1,0]
  v_pk_mul_f32 v[100:101], v[100:101], v[116:117] op_sel_hi:[1,0]
  v_pk_mul_f32 v[54:55], v[54:55], v[104:105] op_sel_hi:[1,0]
  v_pk_mul_f32 v[70:71], v[70:71], v[108:109] op_sel_hi:[1,0]
  v_pk_mul_f32 v[86:87], v[86:87], v[112:113] op_sel_hi:[1,0]
  v_pk_mul_f32 v[102:103], v[102:103], v[116:117] op_sel_hi:[1,0]
  v_min_u32 v3, 31, v0
  v_lshlrev_b32 v3, 2, v3
  v_add_u32 v3, 128, v3
  s_nop 1
Lpoll_3:
  buffer_load_dword v4, v3, s[12:15], 0 offen sc1
  s_sub_u32 s24, s24, 1
  s_cbranch_scc1 L_FAIL
  s_waitcnt vmcnt(0)
  v_cmp_gt_i32 vcc, 1, v4
  s_cbranch_vccz Lpolld_4
  s_sleep 2
  s_branch Lpoll_3
Lpolld_4:
  v_min_u32 v3, 31, v0
  v_lshlrev_b32 v3, 7, v3
  v_add_u32 v3, 1376256, v3
  s_nop 1
Lpoll_5:
  buffer_load_dword v4, v3, s[4:7], 0 offen sc1
  s_sub_u32 s24, s24, 1
  s_cbranch_scc1 L_FAIL
  s_waitcnt vmcnt(0)
  v_cmp_gt_i32 vcc, 1, v4
  s_cbranch_vccz Lpolld_6
  s_sleep 2
  s_branch Lpoll_5
Lpolld_6:
  s_mov_b32 s40, 1572864
  buffer_load_dwordx4 v[136:139], v2, s[4:7], s40 offen offset:0 sc1
  buffer_load_dwordx4 v[140:143], v2, s[4:7], s40 offen offset:1024 sc1
  buffer_load_dwordx4 v[144:147], v2, s[4:7], s40 offen offset:2048 sc1
  buffer_load_dwordx4 v[148:151], v2, s[4:7], s40 offen offset:3072 sc1
  s_mov_b32 s40, 1576960
  buffer_load_dwordx4 v[120:123], v2, s[4:7], s40 offen offset:0 sc1
  buffer_load_dwordx4 v[124:127], v2, s[4:7], s40 offen offset:1024 sc1
  buffer_load_dwordx4 v[128:131], v2, s[4:7], s40 offen offset:2048 sc1
  buffer_load_dwordx4 v[132:135], v2, s[4:7], s40 offen offset:3072 sc1
  s_waitcnt vmcnt(0)
  v_add_f32 v120, 1.0, v120
  v_add_f32 v121, 1.0, v121
  v_add_f32 v122, 1.0, v122
  v_add_f32 v123, 1.0, v123
  v_add_f32 v124, 1.0, v124
  v_add_f32 v125, 1.0, v125
  v_add_f32 v126, 1.0, v126
  v_add_f32 v127, 1.0, v127
  v_add_f32 v128, 1.0, v128
  v_add_f32 v129, 1.0, v129
  v_add_f32 v130, 1.0, v130
  v_add_f32 v131, 1.0, v131
  v_add_f32 v132, 1.0, v132
  v_add_f32 v133, 1.0, v133
  v_add_f32 v134, 1.0, v134
  v_add_f32 v135, 1.0, v135
  s_add_u32 s44, s44, 6291456
  s_add_u32 s45, s45, 6291456
  v_pk_fma_f32 v[40:41], v[40:41], v[120:121], v[136:137]
  v_pk_fma_f32 v[42:43], v[42:43], v[122:123], v[138:139]
  v_pk_fma_f32 v[44:45], v[44:45], v[124:125], v[140:141]
  v_pk_fma_f32 v[46:47], v[46:47], v[126:127], v[142:143]
  v_pk_fma_f32 v[48:49], v[48:49], v[128:129], v[144:145]
  v_pk_fma_f32 v[50:51], v[50:51], v[130:131], v[146:147]
  v_pk_fma_f32 v[52:53], v[52:53], v[132:133], v[148:149]
  v_pk_fma_f32 v[54:55], v[54:55], v[134:135], v[150:151]
  v_cvt_pk_bf16_f32 v8, v40, v41
  v_cvt_pk_bf16_f32 v9, v42, v43
  v_cvt_pk_bf16_f32 v10, v44, v45
  v_cvt_pk_bf16_f32 v11, v46, v47
  v_cvt_pk_bf16_f32 v12, v48, v49
  v_cvt_pk_bf16_f32 v13, v50, v51
  v_cvt_pk_bf16_f32 v14, v52, v53
  v_cvt_pk_bf16_f32 v15, v54, v55
  buffer_store_dwordx4 v[8:11], v2, s[4:7], s44 offen offset:0 sc1
  buffer_store_dwordx4 v[12:15], v2, s[4:7], s44 offen offset:1024 sc1
  v_pk_fma_f32 v[56:57], v[56:57], v[120:121], v[136:137]
  v_pk_fma_f32 v[58:59], v[58:59], v[122:123], v[138:139]
  v_pk_fma_f32 v[60:61], v[60:61], v[124:125], v[140:141]
  v_pk_fma_f32 v[62:63], v[62:63], v[126:127], v[142:143]
  v_pk_fma_f32 v[64:65], v[64:65], v[128:129], v[144:145]
  v_pk_fma_f32 v[66:67], v[66:67], v[130:131], v[146:147]
  v_pk_fma_f32 v[68:69], v[68:69], v[132:133], v[148:149]
  v_pk_fma_f32 v[70:71], v[70:71], v[134:135], v[150:151]
  v_cvt_pk_bf16_f32 v16, v56, v57
  v_cvt_pk_bf16_f32 v17, v58, v59
  v_cvt_pk_bf16_f32 v18, v60, v61
  v_cvt_pk_bf16_f32 v19, v62, v63
  v_cvt_pk_bf16_f32 v20, v64, v65
  v_cvt_pk_bf16_f32 v21, v66, v67
  v_cvt_pk_bf16_f32 v22, v68, v69
  v_cvt_pk_bf16_f32 v23, v70, v71
  buffer_store_dwordx4 v[16:19], v2, s[4:7], s44 offen offset:2048 sc1
  buffer_store_dwordx4 v[20:23], v2, s[4:7], s44 offen offset:3072 sc1
  v_pk_fma_f32 v[72:73], v[72:73], v[120:121], v[136:137]
  v_pk_fma_f32 v[74:75], v[74:75], v[122:123], v[138:139]
  v_pk_fma_f32 v[76:77], v[76:77], v[124:125], v[140:141]
  v_pk_fma_f32 v[78:79], v[78:79], v[126:127], v[142:143]
  v_pk_fma_f32 v[80:81], v[80:81], v[128:129], v[144:145]
  v_pk_fma_f32 v[82:83], v[82:83], v[130:131], v[146:147]
  v_pk_fma_f32 v[84:85], v[84:85], v[132:133], v[148:149]
  v_pk_fma_f32 v[86:87], v[86:87], v[134:135], v[150:151]
  v_cvt_pk_bf16_f32 v24, v72, v73
  v_cvt_pk_bf16_f32 v25, v74, v75
  v_cvt_pk_bf16_f32 v26, v76, v77
  v_cvt_pk_bf16_f32 v27, v78, v79
  v_cvt_pk_bf16_f32 v28, v80, v81
  v_cvt_pk_bf16_f32 v29, v82, v83
  v_cvt_pk_bf16_f32 v30, v84, v85
  v_cvt_pk_bf16_f32 v31, v86, v87
  buffer_store_dwordx4 v[24:27], v2, s[4:7], s45 offen offset:0 sc1
  buffer_store_dwordx4 v[28:31], v2, s[4:7], s45 offen offset:1024 sc1
  v_pk_fma_f32 v[88:89], v[88:89], v[120:121], v[136:137]
  v_pk_fma_f32 v[90:91], v[90:91], v[122:123], v[138:139]
  v_pk_fma_f32 v[92:93], v[92:93], v[124:125], v[140:141]
  v_pk_fma_f32 v[94:95], v[94:95], v[126:127], v[142:143]
  v_pk_fma_f32 v[96:97], v[96:97], v[128:129], v[144:145]
  v_pk_fma_f32 v[98:99], v[98:99], v[130:131], v[146:147]
  v_pk_fma_f32 v[100:101], v[100:101], v[132:133], v[148:149]
  v_pk_fma_f32 v[102:103], v[102:103], v[134:135], v[150:151]
  v_cvt_pk_bf16_f32 v32, v88, v89
  v_cvt_pk_bf16_f32 v33, v90, v91
  v_cvt_pk_bf16_f32 v34, v92, v93
  v_cvt_pk_bf16_f32 v35, v94, v95
  v_cvt_pk_bf16_f32 v36, v96, v97
  v_cvt_pk_bf16_f32 v37, v98, v99
  v_cvt_pk_bf16_f32 v38, v100, v101
  v_cvt_pk_bf16_f32 v39, v102, v103
  buffer_store_dwordx4 v[32:35], v2, s[4:7], s45 offen offset:2048 sc1
  buffer_store_dwordx4 v[36:39], v2, s[4:7], s45 offen offset:3072 sc1
  s_lshr_b32 s40, s43, 3
  s_lshl_b32 s40, s40, 7
  s_and_b32 s41, s43, 7
  s_lshl_b32 s41, s41, 2
  s_add_u32 s40, s40, s41
  s_add_u32 s40, s40, 1388544
  v_mov_b32 v3, 2147483392
  s_mov_b64 exec, 1
  v_mov_b32 v3, s40
  s_mov_b64 exec, -1
  v_mov_b32 v4, 1
  s_waitcnt vmcnt(0)
  buffer_store_dword v4, v3, s[4:7], 0 offen sc1
  s_cmp_lg_u32 s20, 2
  s_cbranch_scc1 Lnotlb_7
  v_lshlrev_b32 v1, 21, v0
  s_mov_b32 s40, 0x1fff80
  buffer_load_dword v2, v1, s[4:7], s40 offen sc1
  s_add_u32 s40, s40, 134217728
  buffer_load_dword v2, v1, s[4:7], s40 offen sc1
  s_waitcnt vmcnt(0)
Lnotlb_7:
  s_mov_b32 s40, 1404928
  s_cmp_lt_u32 s22, 6
  s_cselect_b32 s40, 1404928, s40
  v_mov_b32 v1, s40
  s_nop 1
Lpoll_8:
  buffer_load_dword v2, v1, s[4:7], 0 offen sc1
  s_sub_u32 s24, s24, 1
  s_cbranch_scc1 L_FAIL
  s_waitcnt vmcnt(0)
  v_cmp_gt_i32 vcc, 0, v2
  s_cbranch_vccz Lpolld_9
  s_sleep 8
  s_branch Lpoll_8
Lpolld_9:
  s_and_b32 s40, s22, 1
  s_add_u32 s40, s40, 1
  s_lshl_b32 s40, s40, 5
  s_add_u32 s21, s40, s23
  s_cmp_lt_u32 s22, 6
  s_cbranch_scc0 L_MOD
L_MOD_back:
L_ROLE:
  s_sub_u32 s21, s3, 128
  s_cmp_lt_u32 s3, 160
  s_cbranch_scc1 L_WO
  s_sub_u32 s21, s3, 160
  s_cmp_lt_u32 s3, 216
  s_cbranch_scc1 L_F1
  s_sub_u32 s21, s3, 216
  s_cmp_lt_u32 s3, 224
  s_cbranch_scc1 L_LN2
  s_sub_u32 s21, s3, 224
  s_cmp_lt_u32 s3, 248
  s_cbranch_scc1 L_F2
  s_sub_u32 s21, s3, 248
  s_branch L_FIN
L_FAIL:
  s_mov_b64 exec, -1
  s_lshl_b32 s40, s2, 8
  s_add_u32 s40, s40, s25
  s_add_u32 s40, s40, 0x70000000
  v_mov_b32 v1, 60
  v_mov_b32 v2, s40
  buffer_store_dword v2, v1, s[12:15], 0 offen
L_END:
  s_endpgm
L_LN2:
  s_load_dwordx2 s[16:17], s[0:1], 0
  s_mov_b32 s18, 4194304
  s_mov_b32 s19, 0x20000
  s_waitcnt lgkmcnt(0)
  s_mov_b32 s25, 0
  s_mov_b32 s29, 1
  s_mov_b32 s26, 0
  s_cmp_eq_u32 s20, 0
  s_cselect_b32 s31, 0, 2147483392
  s_lshl_b32 s40, s21, 8
  s_lshl_b32 s41, s20, 15
  s_add_u32 s40, s40, s41
  v_and_b32 v6, 15, v0
  v_lshl_add_u32 v1, v6, 4, s40
  v_lshrrev_b32 v6, 4, v0
  v_lshl_add_u32 v1, v6, 11, v1
  v_and_b32 v6, 3, v0
  v_lshrrev_b32 v7, 5, v0
  v_lshrrev_b32 v8, 2, v0
  s_lshl_b32 s40, s20, 10
  v_lshl_add_u32 v5, v8, 4, s40
  s_lshl_b32 s40, s21, 13
  s_lshl_b32 s41, s20, 9
  s_add_u32 s40, s40, s41
  v_and_b32 v9, 31, v0
  v_lshl_add_u32 v10, v9, 4, s40
  v_lshl_add_u32 v10, v7, 11, v10
  v_min_u32 v16, 63, v0
  v_lshlrev_b32 v16, 7, v16
  v_add_u32 v16, 1424384, v16
  s_nop 1
Lpoll_11:
  buffer_load_dword v17, v16, s[4:7], 0 offen sc1
  s_sub_u32 s24, s24, 1
  s_cbranch_scc1 L_FAIL
  s_waitcnt vmcnt(0)
  v_cmp_gt_i32 vcc, 0, v17
  s_cbranch_vccz Lpolld_12
  s_sleep 1
  s_branch Lpoll_11
Lpolld_12:
Ltab_10:
  v_lshrrev_b32 v17, 8, v17
  v_and_b32 v18, 3, v0
  v_lshl_or_b32 v17, v17, 2, v18
  s_nop 1
  v_min_u32_dpp v17, v17, v17 row_ror:8 row_mask:0xf bank_mask:0xf
  s_nop 1
  v_min_u32_dpp v17, v17, v17 row_ror:4 row_mask:0xf bank_mask:0xf
  v_mov_b32 v18, v17
  s_nop 1
  v_permlane16_swap_b32 v18, v17
  v_min_u32 v17, v17, v18
  v_mov_b32 v18, v17
  s_nop 1
  v_permlane32_swap_b32 v18, v17
  v_min_u32 v17, v17, v18
  s_nop 1
  v_min_u32_dpp v17, v17, v17 row_ror:2 row_mask:0xf bank_mask:0xf
  s_nop 1
  v_min_u32_dpp v17, v17, v17 row_ror:1 row_mask:0xf bank_mask:0xf
  s_nop 0
  v_readfirstlane_b32 s27, v17
  s_and_b32 s27, s27, 3
  s_lshl_b32 s27, s27, 13
  s_and_b32 s27, s27, 0x2000
  s_xor_b32 s27, s27, 20979712
  v_min_u32 v2, 63, v0
  v_lshlrev_b32 v2, 7, v2
  v_add_u32 v2, 1380352, v2
  s_nop 1
Lpoll_13:
  buffer_load_dword v3, v2, s[4:7], 0 offen sc1
  s_sub_u32 s24, s24, 1
  s_cbranch_scc1 L_FAIL
  s_waitcnt vmcnt(0)
  v_cmp_gt_i32 vcc, 1, v3
  s_cbranch_vccz Lpolld_14
  s_sleep 2
  s_branch Lpoll_13
Lpolld_14:
  s_mov_b32 s40, 1585152
  buffer_load_dwordx4 v[64:67], v5, s[4:7], s40 offen offset:0 sc1
  buffer_load_dwordx4 v[68:71], v5, s[4:7], s40 offen offset:256 sc1
  buffer_load_dwordx4 v[72:75], v5, s[4:7], s40 offen offset:512 sc1
  buffer_load_dwordx4 v[76:79], v5, s[4:7], s40 offen offset:768 sc1
  s_mov_b32 s40, 1589248
  buffer_load_dwordx4 v[80:83], v5, s[4:7], s40 offen offset:0 sc1
  buffer_load_dwordx4 v[84:87], v5, s[4:7], s40 offen offset:256 sc1
  buffer_load_dwordx4 v[88:91], v5, s[4:7], s40 offen offset:512 sc1
  buffer_load_dwordx4 v[92:95], v5, s[4:7], s40 offen offset:768 sc1
  s_mov_b32 s40, 1581056
  buffer_load_dwordx4 v[48:51], v5, s[4:7], s40 offen offset:0 sc1
  buffer_load_dwordx4 v[52:55], v5, s[4:7], s40 offen offset:256 sc1
  buffer_load_dwordx4 v[56:59], v5, s[4:7], s40 offen offset:512 sc1
  buffer_load_dwordx4 v[60:63], v5, s[4:7], s40 offen offset:768 sc1
  s_waitcnt vmcnt(0)
  v_lshrrev_b32 v48, 16, v48
  v_lshrrev_b32 v50, 16, v50
  v_lshrrev_b32 v52, 16, v52
  v_lshrrev_b32 v54, 16, v54
  v_lshrrev_b32 v56, 16, v56
  v_lshrrev_b32 v58, 16, v58
  v_lshrrev_b32 v60, 16, v60
  v_lshrrev_b32 v62, 16, v62
  v_add_f32 v80, 1.0, v80
  v_add_f32 v81, 1.0, v81
  v_add_f32 v82, 1.0, v82
  v_add_f32 v83, 1.0, v83
  v_add_f32 v84, 1.0, v84
  v_add_f32 v85, 1.0, v85
  v_add_f32 v86, 1.0, v86
  v_add_f32 v87, 1.0, v87
  v_add_f32 v88, 1.0, v88
  v_add_f32 v89, 1.0, v89
  v_add_f32 v90, 1.0, v90
  v_add_f32 v91, 1.0, v91
  v_add_f32 v92, 1.0, v92
  v_add_f32 v93, 1.0, v93
  v_add_f32 v94, 1.0, v94
  v_add_f32 v95, 1.0, v95
  v_min_u32 v2, 31, v0
  v_lshlrev_b32 v2, 7, v2
  v_add_u32 v2, 1409024, v2
  s_lshl_b32 s62, s21, 7
  s_add_u32 s62, s62, 1413120
  s_lshl_b32 s30, s20, 11
  v_lshl_add_u32 v11, v6, 9, s30
  v_lshl_add_u32 v11, v8, 3, v11
  s_lshl_b32 s40, s20, 5
  s_add_u32 s40, s40, 8192
  v_lshl_add_u32 v12, v6, 3, s40
  v_lshlrev_b32 v13, 3, v6
  v_add_u32 v13, 8192, v13
  s_add_u32 m0, s30, 0
  s_add_u32 s40, s26, 0
  buffer_load_dwordx4 v10, s[16:19], s40 offen nt lds
  s_add_u32 m0, s30, 1024
  s_add_u32 s40, s26, 4096
  buffer_load_dwordx4 v10, s[16:19], s40 offen nt lds
  buffer_load_dword v3, v2, s[4:7], s31 offen sc1
  s_waitcnt vmcnt(1)
  ds_read_b64 v[24:25], v11 offset:0
  ds_read_b64 v[26:27], v11 offset:128
  ds_read_b64 v[28:29], v11 offset:256
  ds_read_b64 v[30:31], v11 offset:384
  s_waitcnt lgkmcnt(0)
L_LN2_top:
  v_lshlrev_b32 v96, 16, v24
  v_and_b32 v97, 0xffff0000, v24
  v_lshlrev_b32 v98, 16, v25
  v_and_b32 v99, 0xffff0000, v25
  v_lshlrev_b32 v100, 16, v26
  v_and_b32 v101, 0xffff0000, v26
  v_lshlrev_b32 v102, 16, v27
  v_and_b32 v103, 0xffff0000, v27
  v_lshlrev_b32 v104, 16, v28
  v_and_b32 v105, 0xffff0000, v28
  v_lshlrev_b32 v106, 16, v29
  v_and_b32 v107, 0xffff0000, v29
  v_lshlrev_b32 v108, 16, v30
  v_and_b32 v109, 0xffff0000, v30
  v_lshlrev_b32 v110, 16, v31
  v_and_b32 v111, 0xffff0000, v31
  s_cmp_lg_u32 s20, 0
  s_cbranch_scc1 Lgo_15
  s_waitcnt vmcnt(0)
  v_cmp_gt_i32 vcc, s29, v3
  s_cbranch_vccz Lgo_15
  s_nop 3
Lpoll_16:
  buffer_load_dword v3, v2, s[4:7], 0 offen sc1
  s_sub_u32 s24, s24, 1
  s_cbranch_scc1 L_FAIL
  s_waitcnt vmcnt(0)
  v_cmp_gt_i32 vcc, s29, v3
  s_cbranch_vccz Lpolld_17
  s_sleep 1
  s_branch Lpoll_16
Lpolld_17:
Lgo_15:
  s_barrier
  s_add_u32 s40, s27, 0
  buffer_load_dwordx4 v[112:115], v1, s[4:7], s40 offen sc1
  s_add_u32 s40, s27, 16384
  buffer_load_dwordx4 v[116:119], v1, s[4:7], s40 offen sc1
  s_add_u32 s40, s27, 131072
  buffer_load_dwordx4 v[120:123], v1, s[4:7], s40 offen sc1
  s_add_u32 s40, s27, 147456
  buffer_load_dwordx4 v[124:127], v1, s[4:7], s40 offen sc1
  s_add_u32 s40, s27, 262144
  buffer_load_dwordx4 v[128:131], v1, s[4:7], s40 offen sc1
  s_add_u32 s40, s27, 278528
  buffer_load_dwordx4 v[132:135], v1, s[4:7], s40 offen sc1
  s_add_u32 s40, s27, 393216
  buffer_load_dwordx4 v[136:139], v1, s[4:7], s40 offen sc1
  s_add_u32 s40, s27, 409600
  buffer_load_dwordx4 v[140:143], v1, s[4:7], s40 offen sc1
  s_add_u32 m0, s30, 0
  s_add_u32 s40, s26, 65536
  buffer_load_dwordx4 v10, s[16:19], s40 offen nt lds
  s_add_u32 m0, s30, 1024
  s_add_u32 s40, s26, 69632
  buffer_load_dwordx4 v10, s[16:19], s40 offen nt lds
  s_waitcnt vmcnt(9)
  v_dot2c_f32_bf16 v96, v112, v48
  v_dot2c_f32_bf16 v97, v112, v49
  v_dot2c_f32_bf16 v98, v113, v50
  v_dot2c_f32_bf16 v99, v113, v51
  v_dot2c_f32_bf16 v100, v114, v52
  v_dot2c_f32_bf16 v101, v114, v53
  v_dot2c_f32_bf16 v102, v115, v54
  v_dot2c_f32_bf16 v103, v115, v55
  s_waitcnt vmcnt(8)
  v_dot2c_f32_bf16 v104, v116, v56
  v_dot2c_f32_bf16 v105, v116, v57
  v_dot2c_f32_bf16 v106, v117, v58
  v_dot2c_f32_bf16 v107, v117, v59
  v_dot2c_f32_bf16 v108, v118, v60
  v_dot2c_f32_bf16 v109, v118, v61
  v_dot2c_f32_bf16 v110, v119, v62
  v_dot2c_f32_bf16 v111, v119, v63
  s_waitcnt vmcnt(7)
  v_dot2c_f32_bf16 v96, v120, v48
  v_dot2c_f32_bf16 v97, v120, v49
  v_dot2c_f32_bf16 v98, v121, v50
  v_dot2c_f32_bf16 v99, v121, v51
  v_dot2c_f32_bf16 v100, v122, v52
  v_dot2c_f32_bf16 v101, v122, v53
  v_dot2c_f32_bf16 v102, v123, v54
  v_dot2c_f32_bf16 v103, v123, v55
  s_waitcnt vmcnt(6)
  v_dot2c_f32_bf16 v104, v124, v56
  v_dot2c_f32_bf16 v105, v124, v57
  v_dot2c_f32_bf16 v106, v125, v58
  v_dot2c_f32_bf16 v107, v125, v59
  v_dot2c_f32_bf16 v108, v126, v60
  v_dot2c_f32_bf16 v109, v126, v61
  v_dot2c_f32_bf16 v110, v127, v62
  v_dot2c_f32_bf16 v111, v127, v63
  s_waitcnt vmcnt(5)
  v_dot2c_f32_bf16 v96, v128, v48
  v_dot2c_f32_bf16 v97, v128, v49
  v_dot2c_f32_bf16 v98, v129, v50
  v_dot2c_f32_bf16 v99, v129, v51
  v_dot2c_f32_bf16 v100, v130, v52
  v_dot2c_f32_bf16 v101, v130, v53
  v_dot2c_f32_bf16 v102, v131, v54
  v_dot2c_f32_bf16 v103, v131, v55
  s_waitcnt vmcnt(4)
  v_dot2c_f32_bf16 v104, v132, v56
  v_dot2c_f32_bf16 v105, v132, v57
  v_dot2c_f32_bf16 v106, v133, v58
  v_dot2c_f32_bf16 v107, v133, v59
  v_dot2c_f32_bf16 v108, v134, v60
  v_dot2c_f32_bf16 v109, v134, v61
  v_dot2c_f32_bf16 v110, v135, v62
  v_dot2c_f32_bf16 v111, v135, v63
  s_waitcnt vmcnt(3)
  v_dot2c_f32_bf16 v96, v136, v48
  v_dot2c_f32_bf16 v97, v136, v49
  v_dot2c_f32_bf16 v98, v137, v50
  v_dot2c_f32_bf16 v99, v137, v51
  v_dot2c_f32_bf16 v100, v138, v52
  v_dot2c_f32_bf16 v101, v138, v53
  v_dot2c_f32_bf16 v102, v139, v54
  v_dot2c_f32_bf16 v103, v139, v55
  s_waitcnt vmcnt(2)
  v_dot2c_f32_bf16 v104, v140, v56
  v_dot2c_f32_bf16 v105, v140, v57
  v_dot2c_f32_bf16 v106, v141, v58
  v_dot2c_f32_bf16 v107, v141, v59
  v_dot2c_f32_bf16 v108, v142, v60
  v_dot2c_f32_bf16 v109, v142, v61
  v_dot2c_f32_bf16 v110, v143, v62
  v_dot2c_f32_bf16 v111, v143, v63
  s_nop 2
  v_pk_add_f32 v[32:33], v[96:97], v[98:99]
  v_pk_add_f32 v[32:33], v[32:33], v[100:101]
  v_pk_add_f32 v[32:33], v[32:33], v[102:103]
  v_pk_add_f32 v[32:33], v[32:33], v[104:105]
  v_pk_add_f32 v[32:33], v[32:33], v[106:107]
  v_pk_add_f32 v[32:33], v[32:33], v[108:109]
  v_pk_add_f32 v[32:33], v[32:33], v[110:111]
  v_add_f32 v32, v32, v33
  s_nop 1
  v_add_f32_dpp v32, v32, v32 row_ror:4 row_mask:0xf bank_mask:0xf
  s_nop 1
  v_add_f32_dpp v32, v32, v32 row_ror:8 row_mask:0xf bank_mask:0xf
  v_mov_b32 v33, v32
  s_nop 1
  v_permlane16_swap_b32 v33, v32
  v_add_f32 v32, v32, v33
  v_mov_b32 v33, v32
  s_nop 1
  v_permlane32_swap_b32 v33, v32
  v_add_f32 v32, v32, v33
  v_mul_f32 v32, 0x3b800000, v32
  v_pk_add_f32 v[112:113], v[96:97], v[32:33] op_sel_hi:[1,0] neg_lo:[0,1] neg_hi:[0,1]
  v_pk_add_f32 v[114:115], v[98:99], v[32:33] op_sel_hi:[1,0] neg_lo:[0,1] neg_hi:[0,1]
  v_pk_add_f32 v[116:117], v[100:101], v[32:33] op_sel_hi:[1,0] neg_lo:[0,1] neg_hi:[0,1]
  v_pk_add_f32 v[118:119], v[102:103], v[32:33] op_sel_hi:[1,0] neg_lo:[0,1] neg_hi:[0,1]
  v_pk_add_f32 v[120:121], v[104:105], v[32:33] op_sel_hi:[1,0] neg_lo:[0,1] neg_hi:[0,1]
  v_pk_add_f32 v[122:123], v[106:107], v[32:33] op_sel_hi:[1,0] neg_lo:[0,1] neg_hi:[0,1]
  v_pk_add_f32 v[124:125], v[108:109], v[32:33] op_sel_hi:[1,0] neg_lo:[0,1] neg_hi:[0,1]
  v_pk_add_f32 v[126:127], v[110:111], v[32:33] op_sel_hi:[1,0] neg_lo:[0,1] neg_hi:[0,1]
  v_pk_mul_f32 v[34:35], v[112:113], v[112:113]
  v_pk_fma_f32 v[34:35], v[114:115], v[114:115], v[34:35]
  v_pk_fma_f32 v[34:35], v[116:117], v[116:117], v[34:35]
  v_pk_fma_f32 v[34:35], v[118:119], v[118:119], v[34:35]
  v_pk_fma_f32 v[34:35], v[120:121], v[120:121], v[34:35]
  v_pk_fma_f32 v[34:35], v[122:123], v[122:123], v[34:35]
  v_pk_fma_f32 v[34:35], v[124:125], v[124:125], v[34:35]
  v_pk_fma_f32 v[34:35], v[126:127], v[126:127], v[34:35]
  v_add_f32 v34, v34, v35
  s_nop 1
  v_add_f32_dpp v34, v34, v34 row_ror:4 row_mask:0xf bank_mask:0xf
  s_nop 1
  v_add_f32_dpp v34, v34, v34 row_ror:8 row_mask:0xf bank_mask:0xf
  v_mov_b32 v35, v34
  s_nop 1
  v_permlane16_swap_b32 v35, v34
  v_add_f32 v34, v34, v35
  v_mov_b32 v35, v34
  s_nop 1
  v_permlane32_swap_b32 v35, v34
  v_add_f32 v34, v34, v35
  v_mov_b32 v33, v34
  ds_write_b64 v12, v[32:33]
  v_cvt_pk_bf16_f32 v16, v96, v97
  v_cvt_pk_bf16_f32 v17, v98, v99
  v_cvt_pk_bf16_f32 v18, v100, v101
  v_cvt_pk_bf16_f32 v19, v102, v103
  v_cvt_pk_bf16_f32 v20, v104, v105
  v_cvt_pk_bf16_f32 v21, v106, v107
  v_cvt_pk_bf16_f32 v22, v108, v109
  v_cvt_pk_bf16_f32 v23, v110, v111
  s_waitcnt lgkmcnt(0)
  s_barrier
  ds_read2_b64 v[36:39], v13 offset0:0 offset1:4
  ds_read2_b64 v[40:43], v13 offset0:8 offset1:12
  s_add_u32 s40, s27, 1048576
  buffer_store_dwordx4 v[16:19], v1, s[4:7], s40 offen sc1
  s_add_u32 s40, s27, 1064960
  buffer_store_dwordx4 v[20:23], v1, s[4:7], s40 offen sc1
  s_waitcnt lgkmcnt(0)
  v_pk_add_f32 v[34:35], v[36:37], v[38:39]
  v_pk_add_f32 v[44:45], v[40:41], v[42:43]
  v_pk_add_f32 v[34:35], v[34:35], v[44:45]
  v_mul_f32 v34, 0x3e800000, v34
  v_mul_f32 v35, 0x3b800000, v35
  v_sub_f32 v36, v36, v34
  v_sub_f32 v38, v38, v34
  v_sub_f32 v40, v40, v34
  v_sub_f32 v42, v42, v34
  v_fmac_f32 v35, v36, v36
  v_fmac_f32 v35, v38, v38
  v_fmac_f32 v35, v40, v40
  v_fmac_f32 v35, v42, v42
  v_mul_f32 v35, 0x3e800000, v35
  v_add_f32 v35, 0x3727c5ac, v35
  v_rsq_f32 v44, v35
  v_sub_f32 v32, v32, v34
  v_mul_f32 v32, v32, v44
  v_pk_fma_f32 v[112:113], v[112:113], v[44:45], v[32:33] op_sel_hi:[1,0,0]
  v_pk_fma_f32 v[114:115], v[114:115], v[44:45], v[32:33] op_sel_hi:[1,0,0]
  v_pk_fma_f32 v[116:117], v[116:117], v[44:45], v[32:33] op_sel_hi:[1,0,0]
  v_pk_fma_f32 v[118:119], v[118:119], v[44:45], v[32:33] op_sel_hi:[1,0,0]
  v_pk_fma_f32 v[112:113], v[112:113], v[80:81], v[64:65]
  v_pk_fma_f32 v[114:115], v[114:115], v[82:83], v[66:67]
  v_pk_fma_f32 v[116:117], v[116:117], v[84:85], v[68:69]
  v_pk_fma_f32 v[118:119], v[118:119], v[86:87], v[70:71]
  v_cvt_pk_bf16_f32 v128, v112, v113
  v_cvt_pk_bf16_f32 v129, v114, v115
  v_cvt_pk_bf16_f32 v130, v116, v117
  v_cvt_pk_bf16_f32 v131, v118, v119
  s_add_u32 s40, s27, 917504
  buffer_store_dwordx4 v[128:131], v1, s[4:7], s40 offen sc1
  v_pk_fma_f32 v[120:121], v[120:121], v[44:45], v[32:33] op_sel_hi:[1,0,0]
  v_pk_fma_f32 v[122:123], v[122:123], v[44:45], v[32:33] op_sel_hi:[1,0,0]
  v_pk_fma_f32 v[124:125], v[124:125], v[44:45], v[32:33] op_sel_hi:[1,0,0]
  v_pk_fma_f32 v[126:127], v[126:127], v[44:45], v[32:33] op_sel_hi:[1,0,0]
  v_pk_fma_f32 v[120:121], v[120:121], v[88:89], v[72:73]
  v_pk_fma_f32 v[122:123], v[122:123], v[90:91], v[74:75]
  v_pk_fma_f32 v[124:125], v[124:125], v[92:93], v[76:77]
  v_pk_fma_f32 v[126:127], v[126:127], v[94:95], v[78:79]
  v_cvt_pk_bf16_f32 v132, v120, v121
  v_cvt_pk_bf16_f32 v133, v122, v123
  v_cvt_pk_bf16_f32 v134, v124, v125
  v_cvt_pk_bf16_f32 v135, v126, v127
  s_add_u32 s40, s27, 933888
  buffer_store_dwordx4 v[132:135], v1, s[4:7], s40 offen sc1
  buffer_load_dword v3, v2, s[4:7], s31 offen sc1
  s_waitcnt vmcnt(5)
  ds_read_b64 v[24:25], v11 offset:0
  ds_read_b64 v[26:27], v11 offset:128
  ds_read_b64 v[28:29], v11 offset:256
  ds_read_b64 v[30:31], v11 offset:384
  s_waitcnt vmcnt(1) lgkmcnt(0)
  s_barrier
  s_cmp_lg_u32 s20, 0
  s_cbranch_scc1 Lnosig_18
  s_mov_b32 s63, s29
  s_atomic_smax s63, s[4:5], s62 glc
Lnosig_18:
  s_add_u32 s25, s25, 1
  s_add_u32 s29, s29, 1
  s_add_u32 s26, s26, 65536
  s_add_u32 s27, s27, 2097152
  s_xor_b32 s27, s27, 0x2000
  s_cmp_lt_u32 s25, 64
  s_cbranch_scc1 L_LN2_top
  s_branch L_END
L_FIN:
  s_load_dwordx2 s[16:17], s[0:1], 104
  s_mov_b32 s18, 4194304
  s_mov_b32 s19, 0x20000
  s_waitcnt lgkmcnt(0)
  s_mov_b32 s25, 0
  s_mov_b32 s29, 1
  s_mov_b32 s26, 0
  s_cmp_eq_u32 s20, 0
  s_cselect_b32 s31, 0, 2147483392
  s_lshl_b32 s40, s21, 8
  s_lshl_b32 s41, s20, 15
  s_add_u32 s40, s40, s41
  v_and_b32 v6, 15, v0
  v_lshl_add_u32 v1, v6, 4, s40
  v_lshrrev_b32 v6, 4, v0
  v_lshl_add_u32 v1, v6, 11, v1
  v_and_b32 v6, 3, v0
  v_lshrrev_b32 v7, 5, v0
  v_lshrrev_b32 v8, 2, v0
  s_lshl_b32 s40, s20, 10
  v_lshl_add_u32 v5, v8, 4, s40
  s_lshl_b32 s40, s21, 13
  s_lshl_b32 s41, s20, 9
  s_add_u32 s40, s40, s41
  v_and_b32 v9, 31, v0
  v_lshl_add_u32 v10, v9, 4, s40
  v_lshl_add_u32 v10, v7, 11, v10
  v_min_u32 v16, 63, v0
  v_lshlrev_b32 v16, 7, v16
  v_add_u32 v16, 1424384, v16
  s_nop 1
Lpoll_20:
  buffer_load_dword v17, v16, s[4:7], 0 offen sc1
  s_sub_u32 s24, s24, 1
  s_cbranch_scc1 L_FAIL
  s_waitcnt vmcnt(0)
  v_cmp_gt_i32 vcc, 0, v17
  s_cbranch_vccz Lpolld_21
  s_sleep 1
  s_branch Lpoll_20
Lpolld_21:
Ltab_19:
  v_lshrrev_b32 v17, 8, v17
  v_and_b32 v18, 3, v0
  v_lshl_or_b32 v17, v17, 2, v18
  s_nop 1
  v_min_u32_dpp v17, v17, v17 row_ror:8 row_mask:0xf bank_mask:0xf
  s_nop 1
  v_min_u32_dpp v17, v17, v17 row_ror:4 row_mask:0xf bank_mask:0xf
  v_mov_b32 v18, v17
  s_nop 1
  v_permlane16_swap_b32 v18, v17
  v_min_u32 v17, v17, v18
  v_mov_b32 v18, v17
  s_nop 1
  v_permlane32_swap_b32 v18, v17
  v_min_u32 v17, v17, v18
  s_nop 1
  v_min_u32_dpp v17, v17, v17 row_ror:2 row_mask:0xf bank_mask:0xf
  s_nop 1
  v_min_u32_dpp v17, v17, v17 row_ror:1 row_mask:0xf bank_mask:0xf
  s_nop 0
  v_readfirstlane_b32 s27, v17
  s_and_b32 s27, s27, 3
  s_lshl_b32 s27, s27, 13
  s_and_b32 s27, s27, 0x2000
  s_xor_b32 s27, s27, 20979712
  v_min_u32 v2, 63, v0
  v_lshlrev_b32 v2, 7, v2
  v_add_u32 v2, 1380352, v2
  s_nop 1
Lpoll_22:
  buffer_load_dword v3, v2, s[4:7], 0 offen sc1
  s_sub_u32 s24, s24, 1
  s_cbranch_scc1 L_FAIL
  s_waitcnt vmcnt(0)
  v_cmp_gt_i32 vcc, 1, v3
  s_cbranch_vccz Lpolld_23
  s_sleep 2
  s_branch Lpoll_22
Lpolld_23:
  s_mov_b32 s40, 1593344
  buffer_load_dwordx4 v[48:51], v5, s[4:7], s40 offen offset:0 sc1
  buffer_load_dwordx4 v[52:55], v5, s[4:7], s40 offen offset:256 sc1
  buffer_load_dwordx4 v[56:59], v5, s[4:7], s40 offen offset:512 sc1
  buffer_load_dwordx4 v[60:63], v5, s[4:7], s40 offen offset:768 sc1
  s_waitcnt vmcnt(0)
  v_lshrrev_b32 v48, 16, v48
  v_lshrrev_b32 v50, 16, v50
  v_lshrrev_b32 v52, 16, v52
  v_lshrrev_b32 v54, 16, v54
  v_lshrrev_b32 v56, 16, v56
  v_lshrrev_b32 v58, 16, v58
  v_lshrrev_b32 v60, 16, v60
  v_lshrrev_b32 v62, 16, v62
  v_min_u32 v2, 23, v0
  v_lshlrev_b32 v2, 7, v2
  v_add_u32 v2, 1421312, v2
  s_mul_i32 s30, s20, 2176
  v_mul_u32_u24 v11, 544, v6
  v_lshl_add_u32 v11, v8, 3, v11
  v_add_u32 v11, s30, v11
  v_mul_u32_u24 v12, 544, v7
  v_lshl_add_u32 v12, v9, 4, v12
  v_add_u32 v12, s30, v12
  buffer_load_dword v3, v2, s[4:7], s31 offen sc1
  s_nop 0
L_FIN_top:
  s_cmp_lg_u32 s20, 0
  s_cbranch_scc1 Lgo_24
  s_waitcnt vmcnt(0)
  v_cmp_gt_i32 vcc, s29, v3
  s_cbranch_vccz Lgo_24
  s_nop 3
Lpoll_25:
  buffer_load_dword v3, v2, s[4:7], 0 offen sc1
  s_sub_u32 s24, s24, 1
  s_cbranch_scc1 L_FAIL
  s_waitcnt vmcnt(0)
  v_cmp_gt_i32 vcc, s29, v3
  s_cbranch_vccz Lpolld_26
  s_sleep 1
  s_branch Lpoll_25
Lpolld_26:
Lgo_24:
  s_barrier
  s_add_u32 s40, s27, 1048576
  buffer_load_dwordx4 v[16:19], v1, s[4:7], s40 offen sc1
  s_add_u32 s40, s27, 1064960
  buffer_load_dwordx4 v[20:23], v1, s[4:7], s40 offen sc1
  s_add_u32 s40, s27, 524288
  buffer_load_dwordx4 v[112:115], v1, s[4:7], s40 offen sc1
  s_add_u32 s40, s27, 540672
  buffer_load_dwordx4 v[116:119], v1, s[4:7], s40 offen sc1
  s_add_u32 s40, s27, 655360
  buffer_load_dwordx4 v[120:123], v1, s[4:7], s40 offen sc1
  s_add_u32 s40, s27, 671744
  buffer_load_dwordx4 v[124:127], v1, s[4:7], s40 offen sc1
  s_add_u32 s40, s27, 786432
  buffer_load_dwordx4 v[128:131], v1, s[4:7], s40 offen sc1
  s_add_u32 s40, s27, 802816
  buffer_load_dwordx4 v[132:135], v1, s[4:7], s40 offen sc1
  s_waitcnt vmcnt(6)
  v_lshlrev_b32 v96, 16, v16
  v_and_b32 v97, 0xffff0000, v16
  v_lshlrev_b32 v98, 16, v17
  v_and_b32 v99, 0xffff0000, v17
  v_lshlrev_b32 v100, 16, v18
  v_and_b32 v101, 0xffff0000, v18
  v_lshlrev_b32 v102, 16, v19
  v_and_b32 v103, 0xffff0000, v19
  v_lshlrev_b32 v104, 16, v20
  v_and_b32 v105, 0xffff0000, v20
  v_lshlrev_b32 v106, 16, v21
  v_and_b32 v107, 0xffff0000, v21
  v_lshlrev_b32 v108, 16, v22
  v_and_b32 v109, 0xffff0000, v22
  v_lshlrev_b32 v110, 16, v23
  v_and_b32 v111, 0xffff0000, v23
  s_waitcnt vmcnt(5)
  v_dot2c_f32_bf16 v96, v112, v48
  v_dot2c_f32_bf16 v97, v112, v49
  v_dot2c_f32_bf16 v98, v113, v50
  v_dot2c_f32_bf16 v99, v113, v51
  v_dot2c_f32_bf16 v100, v114, v52
  v_dot2c_f32_bf16 v101, v114, v53
  v_dot2c_f32_bf16 v102, v115, v54
  v_dot2c_f32_bf16 v103, v115, v55
  s_waitcnt vmcnt(4)
  v_dot2c_f32_bf16 v104, v116, v56
  v_dot2c_f32_bf16 v105, v116, v57
  v_dot2c_f32_bf16 v106, v117, v58
  v_dot2c_f32_bf16 v107, v117, v59
  v_dot2c_f32_bf16 v108, v118, v60
  v_dot2c_f32_bf16 v109, v118, v61
  v_dot2c_f32_bf16 v110, v119, v62
  v_dot2c_f32_bf16 v111, v119, v63
  s_waitcnt vmcnt(3)
  v_dot2c_f32_bf16 v96, v120, v48
  v_dot2c_f32_bf16 v97, v120, v49
  v_dot2c_f32_bf16 v98, v121, v50
  v_dot2c_f32_bf16 v99, v121, v51
  v_dot2c_f32_bf16 v100, v122, v52
  v_dot2c_f32_bf16 v101, v122, v53
  v_dot2c_f32_bf16 v102, v123, v54
  v_dot2c_f32_bf16 v103, v123, v55
  s_waitcnt vmcnt(2)
  v_dot2c_f32_bf16 v104, v124, v56
  v_dot2c_f32_bf16 v105, v124, v57
  v_dot2c_f32_bf16 v106, v125, v58
  v_dot2c_f32_bf16 v107, v125, v59
  v_dot2c_f32_bf16 v108, v126, v60
  v_dot2c_f32_bf16 v109, v126, v61
  v_dot2c_f32_bf16 v110, v127, v62
  v_dot2c_f32_bf16 v111, v127, v63
  s_waitcnt vmcnt(1)
  v_dot2c_f32_bf16 v96, v128, v48
  v_dot2c_f32_bf16 v97, v128, v49
  v_dot2c_f32_bf16 v98, v129, v50
  v_dot2c_f32_bf16 v99, v129, v51
  v_dot2c_f32_bf16 v100, v130, v52
  v_dot2c_f32_bf16 v101, v130, v53
  v_dot2c_f32_bf16 v102, v131, v54
  v_dot2c_f32_bf16 v103, v131, v55
  s_waitcnt vmcnt(0)
  v_dot2c_f32_bf16 v104, v132, v56
  v_dot2c_f32_bf16 v105, v132, v57
  v_dot2c_f32_bf16 v106, v133, v58
  v_dot2c_f32_bf16 v107, v133, v59
  v_dot2c_f32_bf16 v108, v134, v60
  v_dot2c_f32_bf16 v109, v134, v61
  v_dot2c_f32_bf16 v110, v135, v62
  v_dot2c_f32_bf16 v111, v135, v63
  s_nop 2
  buffer_load_dword v3, v2, s[4:7], s31 offen sc1
  v_cvt_pk_bf16_f32 v16, v96, v97
  v_cvt_pk_bf16_f32 v17, v98, v99
  v_cvt_pk_bf16_f32 v18, v100, v101
  v_cvt_pk_bf16_f32 v19, v102, v103
  v_cvt_pk_bf16_f32 v20, v104, v105
  v_cvt_pk_bf16_f32 v21, v106, v107
  v_cvt_pk_bf16_f32 v22, v108, v109
  v_cvt_pk_bf16_f32 v23, v110, v111
  ds_write_b64 v11, v[16:17] offset:0
  ds_write_b64 v11, v[18:19] offset:128
  ds_write_b64 v11, v[20:21] offset:256
  ds_write_b64 v11, v[22:23] offset:384
  ds_read_b128 v[112:115], v12 offset:0
  ds_read_b128 v[116:119], v12 offset:1088
  s_add_u32 s40, s26, 0
  s_waitcnt lgkmcnt(1)
  buffer_store_dwordx4 v[112:115], v10, s[16:19], s40 offen
  s_add_u32 s40, s26, 4096
  s_waitcnt lgkmcnt(0)
  buffer_store_dwordx4 v[116:119], v10, s[16:19], s40 offen
  s_add_u32 s25, s25, 1
  s_add_u32 s29, s29, 1
  s_add_u32 s26, s26, 65536
  s_add_u32 s27, s27, 2097152
  s_xor_b32 s27, s27, 0x2000
  s_cmp_lt_u32 s25, 64
  s_cbranch_scc1 L_FIN_top
  s_branch L_END
L_QKV:
  v_lshrrev_b32 v60, 3, v0
  v_and_b32 v61, 6, v60
  v_xor_b32 v61, v61, v0
  v_and_b32 v61, 7, v61
  v_lshlrev_b32 v61, 4, v61
  v_lshl_add_u32 v1, v60, 11, v61
  s_lshl_b32 s40, s20, 14
  v_add_u32 v1, s40, v1
  s_lshl_b32 s32, s20, 10
  v_and_b32 v60, 6, v0
  v_lshrrev_b32 v61, 4, v0
  v_xor_b32 v60, v60, v61
  v_lshlrev_b32 v60, 4, v60
  v_and_b32 v61, 15, v0
  v_lshl_add_u32 v77, v61, 7, v60
  v_xor_b32 v78, 64, v77
  s_and_b32 s43, s21, 1
  s_lshr_b32 s44, s21, 1
  s_lshl_b32 s44, s44, 8
  s_add_u32 s45, s44, 128
  s_lshl_b32 s46, s43, 7
  s_add_u32 s46, s46, s44
  s_xor_b32 s46, s46, 256
  s_load_dwordx4 s[48:51], s[0:1], 16
  s_waitcnt lgkmcnt(0)
  s_cmp_eq_u32 s43, 0
  s_cselect_b32 s8, s48, s50
  s_cselect_b32 s9, s49, s51
  s_mov_b32 s10, 8388608
  s_mov_b32 s11, 0x20000
  s_lshr_b32 s40, s44, 8
  s_and_b32 s40, s40, 3
  s_cmp_eq_u32 s40, 1
  s_cselect_b64 vcc, -1, 0
  v_bfe_u32 v4, v0, 5, 1
  v_mul_u32_u24 v4, 32768, v4
  v_bfe_u32 v5, v0, 4, 1
  v_mul_u32_u24 v5, 16384, v5
  v_add_u32 v4, v4, v5
  v_bfe_u32 v5, v0, 3, 1
  v_mul_u32_u24 v5, 8192, v5
  v_add_u32 v4, v4, v5
  v_lshrrev_b32 v5, 3, v0
  v_and_b32 v5, 6, v5
  v_xor_b32 v5, v5, v0
  v_and_b32 v5, 7, v5
  v_lshl_add_u32 v4, v5, 4, v4
  s_lshr_b32 s40, s20, 1
  s_mul_i32 s40, s40, 2097152
  s_and_b32 s41, s20, 1
  s_mul_i32 s41, s41, 65536
  s_add_u32 s40, s40, s41
  v_add_u32 v4, s40, v4
  v_bfe_u32 v5, v0, 3, 2
  v_xor_b32 v5, s20, v5
  v_lshlrev_b32 v5, 5, v5
  v_lshrrev_b32 v6, 2, v0
  v_lshl_add_u32 v6, v6, 7, v5
  v_and_b32 v5, 3, v0
  v_lshl_add_u32 v6, v5, 3, v6
  v_add_u32 v7, 0x10000, v6
  v_add_u32 v8, s44, v4
  v_add_u32 v9, s45, v4
  v_add_u32 v10, s46, v4
  v_lshrrev_b32 v2, 3, v0
  v_lshlrev_b32 v2, 7, v2
  v_and_b32 v3, 7, v0
  v_lshl_add_u32 v2, v3, 2, v2
  v_add_u32 v2, 1388544, v2
  v_min_u32 v64, 63, v0
  v_lshlrev_b32 v64, 7, v64
  v_add_u32 v64, 1424384, v64
  s_lshl_b32 s41, s20, 10
  s_add_u32 m0, s41, 0
  s_mov_b32 s42, 0
  s_cbranch_vccnz Lpace_27
  s_waitcnt vmcnt(6)
Lpace_27:
  buffer_load_dwordx4 v8, s[8:11], s42 offen lds
  s_add_u32 m0, s41, 4096
  s_mov_b32 s42, 0
  s_cbranch_vccnz Lpace_28
  s_waitcnt vmcnt(6)
Lpace_28:
  buffer_load_dwordx4 v9, s[8:11], s42 offen lds
  s_add_u32 m0, s41, 8192
  s_mov_b32 s42, 131072
  s_cbranch_vccnz Lpace_29
  s_waitcnt vmcnt(6)
Lpace_29:
  buffer_load_dwordx4 v8, s[8:11], s42 offen lds
  s_add_u32 m0, s41, 12288
  s_mov_b32 s42, 131072
  s_cbranch_vccnz Lpace_30
  s_waitcnt vmcnt(6)
Lpace_30:
  buffer_load_dwordx4 v9, s[8:11], s42 offen lds
  s_add_u32 m0, s41, 16384
  s_mov_b32 s42, 262144
  s_cbranch_vccnz Lpace_31
  s_waitcnt vmcnt(6)
Lpace_31:
  buffer_load_dwordx4 v8, s[8:11], s42 offen lds
  s_add_u32 m0, s41, 20480
  s_mov_b32 s42, 262144
  s_cbranch_vccnz Lpace_32
  s_waitcnt vmcnt(6)
Lpace_32:
  buffer_load_dwordx4 v9, s[8:11], s42 offen lds
  s_add_u32 m0, s41, 24576
  s_mov_b32 s42, 393216
  s_cbranch_vccnz Lpace_33
  s_waitcnt vmcnt(6)
Lpace_33:
  buffer_load_dwordx4 v8, s[8:11], s42 offen lds
  s_add_u32 m0, s41, 28672
  s_mov_b32 s42, 393216
  s_cbranch_vccnz Lpace_34
  s_waitcnt vmcnt(6)
Lpace_34:
  buffer_load_dwordx4 v9, s[8:11], s42 offen lds
  s_add_u32 m0, s41, 32768
  s_mov_b32 s42, 524288
  s_cbranch_vccnz Lpace_35
  s_waitcnt vmcnt(6)
Lpace_35:
  buffer_load_dwordx4 v8, s[8:11], s42 offen lds
  s_add_u32 m0, s41, 36864
  s_mov_b32 s42, 524288
  s_cbranch_vccnz Lpace_36
  s_waitcnt vmcnt(6)
Lpace_36:
  buffer_load_dwordx4 v9, s[8:11], s42 offen lds
  s_add_u32 m0, s41, 40960
  s_mov_b32 s42, 655360
  s_cbranch_vccnz Lpace_37
  s_waitcnt vmcnt(6)
Lpace_37:
  buffer_load_dwordx4 v8, s[8:11], s42 offen lds
  s_add_u32 m0, s41, 45056
  s_mov_b32 s42, 655360
  s_cbranch_vccnz Lpace_38
  s_waitcnt vmcnt(6)
Lpace_38:
  buffer_load_dwordx4 v9, s[8:11], s42 offen lds
  s_add_u32 m0, s41, 49152
  s_mov_b32 s42, 786432
  s_cbranch_vccnz Lpace_39
  s_waitcnt vmcnt(6)
Lpace_39:
  buffer_load_dwordx4 v8, s[8:11], s42 offen lds
  s_add_u32 m0, s41, 53248
  s_mov_b32 s42, 786432
  s_cbranch_vccnz Lpace_40
  s_waitcnt vmcnt(6)
Lpace_40:
  buffer_load_dwordx4 v9, s[8:11], s42 offen lds
  s_add_u32 m0, s41, 57344
  s_mov_b32 s42, 917504
  s_cbranch_vccnz Lpace_41
  s_waitcnt vmcnt(6)
Lpace_41:
  buffer_load_dwordx4 v8, s[8:11], s42 offen lds
  s_add_u32 m0, s41, 61440
  s_mov_b32 s42, 917504
  s_cbranch_vccnz Lpace_42
  s_waitcnt vmcnt(6)
Lpace_42:
  buffer_load_dwordx4 v9, s[8:11], s42 offen lds
  s_add_u32 m0, s41, 65536
  s_mov_b32 s42, 1048576
  s_cbranch_vccnz Lpace_43
  s_waitcnt vmcnt(6)
Lpace_43:
  buffer_load_dwordx4 v8, s[8:11], s42 offen lds
  s_add_u32 m0, s41, 69632
  s_mov_b32 s42, 1048576
  s_cbranch_vccnz Lpace_44
  s_waitcnt vmcnt(6)
Lpace_44:
  buffer_load_dwordx4 v9, s[8:11], s42 offen lds
  s_add_u32 m0, s41, 73728
  s_mov_b32 s42, 1179648
  s_cbranch_vccnz Lpace_45
  s_waitcnt vmcnt(6)
Lpace_45:
  buffer_load_dwordx4 v8, s[8:11], s42 offen lds
  s_add_u32 m0, s41, 77824
  s_mov_b32 s42, 1179648
  s_cbranch_vccnz Lpace_46
  s_waitcnt vmcnt(6)
Lpace_46:
  buffer_load_dwordx4 v9, s[8:11], s42 offen lds
  s_add_u32 m0, s41, 81920
  s_mov_b32 s42, 1310720
  s_cbranch_vccnz Lpace_47
  s_waitcnt vmcnt(6)
Lpace_47:
  buffer_load_dwordx4 v8, s[8:11], s42 offen lds
  s_add_u32 m0, s41, 86016
  s_mov_b32 s42, 1310720
  s_cbranch_vccnz Lpace_48
  s_waitcnt vmcnt(6)
Lpace_48:
  buffer_load_dwordx4 v9, s[8:11], s42 offen lds
  s_add_u32 m0, s41, 90112
  s_mov_b32 s42, 1441792
  s_cbranch_vccnz Lpace_49
  s_waitcnt vmcnt(6)
Lpace_49:
  buffer_load_dwordx4 v8, s[8:11], s42 offen lds
  s_add_u32 m0, s41, 94208
  s_mov_b32 s42, 1441792
  s_cbranch_vccnz Lpace_50
  s_waitcnt vmcnt(6)
Lpace_50:
  buffer_load_dwordx4 v9, s[8:11], s42 offen lds
  s_add_u32 m0, s41, 98304
  s_mov_b32 s42, 1572864
  s_cbranch_vccnz Lpace_51
  s_waitcnt vmcnt(6)
Lpace_51:
  buffer_load_dwordx4 v8, s[8:11], s42 offen lds
  s_add_u32 m0, s41, 102400
  s_mov_b32 s42, 1572864
  s_cbranch_vccnz Lpace_52
  s_waitcnt vmcnt(6)
Lpace_52:
  buffer_load_dwordx4 v9, s[8:11], s42 offen lds
  s_add_u32 m0, s41, 106496
  s_mov_b32 s42, 1703936
  s_cbranch_vccnz Lpace_53
  s_waitcnt vmcnt(6)
Lpace_53:
  buffer_load_dwordx4 v8, s[8:11], s42 offen lds
  s_add_u32 m0, s41, 110592
  s_mov_b32 s42, 1703936
  s_cbranch_vccnz Lpace_54
  s_waitcnt vmcnt(6)
Lpace_54:
  buffer_load_dwordx4 v9, s[8:11], s42 offen lds
  s_waitcnt vmcnt(24) lgkmcnt(0)
  s_barrier
  s_add_u32 m0, s41, 114688
  s_mov_b32 s42, 1835008
  s_cbranch_vccnz Lpace_55
  s_waitcnt vmcnt(6)
Lpace_55:
  buffer_load_dwordx4 v8, s[8:11], s42 offen lds
  s_add_u32 m0, s41, 118784
  s_mov_b32 s42, 1835008
  s_cbranch_vccnz Lpace_56
  s_waitcnt vmcnt(6)
Lpace_56:
  buffer_load_dwordx4 v9, s[8:11], s42 offen lds
  s_add_u32 m0, s41, 122880
  s_mov_b32 s42, 1966080
  s_cbranch_vccnz Lpace_57
  s_waitcnt vmcnt(6)
Lpace_57:
  buffer_load_dwordx4 v8, s[8:11], s42 offen lds
  s_add_u32 m0, s41, 126976
  s_mov_b32 s42, 1966080
  s_cbranch_vccnz Lpace_58
  s_waitcnt vmcnt(6)
Lpace_58:
  buffer_load_dwordx4 v9, s[8:11], s42 offen lds
  ds_read_b64_tr_b16 a[0:1], v6 offset:0
  ds_read_b64_tr_b16 a[2:3], v6 offset:2048
  ds_read_b64_tr_b16 a[128:129], v6 offset:4096
  ds_read_b64_tr_b16 a[130:131], v6 offset:6144
  ds_read_b64_tr_b16 a[4:5], v6 offset:8192
  ds_read_b64_tr_b16 a[6:7], v6 offset:10240
  ds_read_b64_tr_b16 a[132:133], v6 offset:12288
  ds_read_b64_tr_b16 a[134:135], v6 offset:14336
  s_waitcnt vmcnt(24) lgkmcnt(0)
  s_barrier
  s_add_u32 m0, s41, 0
  s_mov_b32 s42, 4194304
  s_cbranch_vccnz Lpace_59
  s_waitcnt vmcnt(6)
Lpace_59:
  buffer_load_dwordx4 v8, s[8:11], s42 offen lds
  s_add_u32 m0, s41, 4096
  s_mov_b32 s42, 4194304
  s_cbranch_vccnz Lpace_60
  s_waitcnt vmcnt(6)
Lpace_60:
  buffer_load_dwordx4 v9, s[8:11], s42 offen lds
  s_add_u32 m0, s41, 8192
  s_mov_b32 s42, 4325376
  s_cbranch_vccnz Lpace_61
  s_waitcnt vmcnt(6)
Lpace_61:
  buffer_load_dwordx4 v8, s[8:11], s42 offen lds
  s_add_u32 m0, s41, 12288
  s_mov_b32 s42, 4325376
  s_cbranch_vccnz Lpace_62
  s_waitcnt vmcnt(6)
Lpace_62:
  buffer_load_dwordx4 v9, s[8:11], s42 offen lds
  ds_read_b64_tr_b16 a[8:9], v6 offset:16384
  ds_read_b64_tr_b16 a[10:11], v6 offset:18432
  ds_read_b64_tr_b16 a[136:137], v6 offset:20480
  ds_read_b64_tr_b16 a[138:139], v6 offset:22528
  ds_read_b64_tr_b16 a[12:13], v6 offset:24576
  ds_read_b64_tr_b16 a[14:15], v6 offset:26624
  ds_read_b64_tr_b16 a[140:141], v6 offset:28672
  ds_read_b64_tr_b16 a[142:143], v6 offset:30720
  s_waitcnt vmcnt(24) lgkmcnt(0)
  s_barrier
  s_add_u32 m0, s41, 16384
  s_mov_b32 s42, 4456448
  s_cbranch_vccnz Lpace_63
  s_waitcnt vmcnt(6)
Lpace_63:
  buffer_load_dwordx4 v8, s[8:11], s42 offen lds
  s_add_u32 m0, s41, 20480
  s_mov_b32 s42, 4456448
  s_cbranch_vccnz Lpace_64
  s_waitcnt vmcnt(6)
Lpace_64:
  buffer_load_dwordx4 v9, s[8:11], s42 offen lds
  s_add_u32 m0, s41, 24576
  s_mov_b32 s42, 4587520
  s_cbranch_vccnz Lpace_65
  s_waitcnt vmcnt(6)
Lpace_65:
  buffer_load_dwordx4 v8, s[8:11], s42 offen lds
  s_add_u32 m0, s41, 28672
  s_mov_b32 s42, 4587520
  s_cbranch_vccnz Lpace_66
  s_waitcnt vmcnt(6)
Lpace_66:
  buffer_load_dwordx4 v9, s[8:11], s42 offen lds
  ds_read_b64_tr_b16 a[16:17], v6 offset:32768
  ds_read_b64_tr_b16 a[18:19], v6 offset:34816
  ds_read_b64_tr_b16 a[144:145], v6 offset:36864
  ds_read_b64_tr_b16 a[146:147], v6 offset:38912
  ds_read_b64_tr_b16 a[20:21], v6 offset:40960
  ds_read_b64_tr_b16 a[22:23], v6 offset:43008
  ds_read_b64_tr_b16 a[148:149], v6 offset:45056
  ds_read_b64_tr_b16 a[150:151], v6 offset:47104
  s_waitcnt vmcnt(24) lgkmcnt(0)
  s_barrier
  s_add_u32 m0, s41, 32768
  s_mov_b32 s42, 4718592
  s_cbranch_vccnz Lpace_67
  s_waitcnt vmcnt(6)
Lpace_67:
  buffer_load_dwordx4 v8, s[8:11], s42 offen lds
  s_add_u32 m0, s41, 36864
  s_mov_b32 s42, 4718592
  s_cbranch_vccnz Lpace_68
  s_waitcnt vmcnt(6)
Lpace_68:
  buffer_load_dwordx4 v9, s[8:11], s42 offen lds
  s_add_u32 m0, s41, 40960
  s_mov_b32 s42, 4849664
  s_cbranch_vccnz Lpace_69
  s_waitcnt vmcnt(6)
Lpace_69:
  buffer_load_dwordx4 v8, s[8:11], s42 offen lds
  s_add_u32 m0, s41, 45056
  s_mov_b32 s42, 4849664
  s_cbranch_vccnz Lpace_70
  s_waitcnt vmcnt(6)
Lpace_70:
  buffer_load_dwordx4 v9, s[8:11], s42 offen lds
  ds_read_b64_tr_b16 a[24:25], v6 offset:49152
  ds_read_b64_tr_b16 a[26:27], v6 offset:51200
  ds_read_b64_tr_b16 a[152:153], v6 offset:53248
  ds_read_b64_tr_b16 a[154:155], v6 offset:55296
  ds_read_b64_tr_b16 a[28:29], v6 offset:57344
  ds_read_b64_tr_b16 a[30:31], v6 offset:59392
  ds_read_b64_tr_b16 a[156:157], v6 offset:61440
  ds_read_b64_tr_b16 a[158:159], v6 offset:63488
  s_waitcnt vmcnt(24) lgkmcnt(0)
  s_barrier
  s_add_u32 m0, s41, 49152
  s_mov_b32 s42, 4980736
  s_cbranch_vccnz Lpace_71
  s_waitcnt vmcnt(6)
Lpace_71:
  buffer_load_dwordx4 v8, s[8:11], s42 offen lds
  s_add_u32 m0, s41, 53248
  s_mov_b32 s42, 4980736
  s_cbranch_vccnz Lpace_72
  s_waitcnt vmcnt(6)
Lpace_72:
  buffer_load_dwordx4 v9, s[8:11], s42 offen lds
  s_add_u32 m0, s41, 57344
  s_mov_b32 s42, 5111808
  s_cbranch_vccnz Lpace_73
  s_waitcnt vmcnt(6)
Lpace_73:
  buffer_load_dwordx4 v8, s[8:11], s42 offen lds
  s_add_u32 m0, s41, 61440
  s_mov_b32 s42, 5111808
  s_cbranch_vccnz Lpace_74
  s_waitcnt vmcnt(6)
Lpace_74:
  buffer_load_dwordx4 v9, s[8:11], s42 offen lds
  ds_read_b64_tr_b16 a[32:33], v7 offset:0
  ds_read_b64_tr_b16 a[34:35], v7 offset:2048
  ds_read_b64_tr_b16 a[160:161], v7 offset:4096
  ds_read_b64_tr_b16 a[162:163], v7 offset:6144
  ds_read_b64_tr_b16 a[36:37], v7 offset:8192
  ds_read_b64_tr_b16 a[38:39], v7 offset:10240
  ds_read_b64_tr_b16 a[164:165], v7 offset:12288
  ds_read_b64_tr_b16 a[166:167], v7 offset:14336
  s_waitcnt vmcnt(24) lgkmcnt(0)
  s_barrier
  s_add_u32 m0, s41, 65536
  s_mov_b32 s42, 5242880
  s_cbranch_vccnz Lpace_75
  s_waitcnt vmcnt(6)
Lpace_75:
  buffer_load_dwordx4 v8, s[8:11], s42 offen lds
  s_add_u32 m0, s41, 69632
  s_mov_b32 s42, 5242880
  s_cbranch_vccnz Lpace_76
  s_waitcnt vmcnt(6)
Lpace_76:
  buffer_load_dwordx4 v9, s[8:11], s42 offen lds
  s_add_u32 m0, s41, 73728
  s_mov_b32 s42, 5373952
  s_cbranch_vccnz Lpace_77
  s_waitcnt vmcnt(6)
Lpace_77:
  buffer_load_dwordx4 v8, s[8:11], s42 offen lds
  s_add_u32 m0, s41, 77824
  s_mov_b32 s42, 5373952
  s_cbranch_vccnz Lpace_78
  s_waitcnt vmcnt(6)
Lpace_78:
  buffer_load_dwordx4 v9, s[8:11], s42 offen lds
  ds_read_b64_tr_b16 a[40:41], v7 offset:16384
  ds_read_b64_tr_b16 a[42:43], v7 offset:18432
  ds_read_b64_tr_b16 a[168:169], v7 offset:20480
  ds_read_b64_tr_b16 a[170:171], v7 offset:22528
  ds_read_b64_tr_b16 a[44:45], v7 offset:24576
  ds_read_b64_tr_b16 a[46:47], v7 offset:26624
  ds_read_b64_tr_b16 a[172:173], v7 offset:28672
  ds_read_b64_tr_b16 a[174:175], v7 offset:30720
  s_waitcnt vmcnt(24) lgkmcnt(0)
  s_barrier
  s_add_u32 m0, s41, 81920
  s_mov_b32 s42, 5505024
  s_cbranch_vccnz Lpace_79
  s_waitcnt vmcnt(6)
Lpace_79:
  buffer_load_dwordx4 v8, s[8:11], s42 offen lds
  s_add_u32 m0, s41, 86016
  s_mov_b32 s42, 5505024
  s_cbranch_vccnz Lpace_80
  s_waitcnt vmcnt(6)
Lpace_80:
  buffer_load_dwordx4 v9, s[8:11], s42 offen lds
  s_add_u32 m0, s41, 90112
  s_mov_b32 s42, 5636096
  s_cbranch_vccnz Lpace_81
  s_waitcnt vmcnt(6)
Lpace_81:
  buffer_load_dwordx4 v8, s[8:11], s42 offen lds
  s_add_u32 m0, s41, 94208
  s_mov_b32 s42, 5636096
  s_cbranch_vccnz Lpace_82
  s_waitcnt vmcnt(6)
Lpace_82:
  buffer_load_dwordx4 v9, s[8:11], s42 offen lds
  ds_read_b64_tr_b16 a[48:49], v7 offset:32768
  ds_read_b64_tr_b16 a[50:51], v7 offset:34816
  ds_read_b64_tr_b16 a[176:177], v7 offset:36864
  ds_read_b64_tr_b16 a[178:179], v7 offset:38912
  ds_read_b64_tr_b16 a[52:53], v7 offset:40960
  ds_read_b64_tr_b16 a[54:55], v7 offset:43008
  ds_read_b64_tr_b16 a[180:181], v7 offset:45056
  ds_read_b64_tr_b16 a[182:183], v7 offset:47104
  s_waitcnt vmcnt(24) lgkmcnt(0)
  s_barrier
  s_add_u32 m0, s41, 98304
  s_mov_b32 s42, 5767168
  s_cbranch_vccnz Lpace_83
  s_waitcnt vmcnt(6)
Lpace_83:
  buffer_load_dwordx4 v8, s[8:11], s42 offen lds
  s_add_u32 m0, s41, 102400
  s_mov_b32 s42, 5767168
  s_cbranch_vccnz Lpace_84
  s_waitcnt vmcnt(6)
Lpace_84:
  buffer_load_dwordx4 v9, s[8:11], s42 offen lds
  s_add_u32 m0, s41, 106496
  s_mov_b32 s42, 5898240
  s_cbranch_vccnz Lpace_85
  s_waitcnt vmcnt(6)
Lpace_85:
  buffer_load_dwordx4 v8, s[8:11], s42 offen lds
  s_add_u32 m0, s41, 110592
  s_mov_b32 s42, 5898240
  s_cbranch_vccnz Lpace_86
  s_waitcnt vmcnt(6)
Lpace_86:
  buffer_load_dwordx4 v9, s[8:11], s42 offen lds
  ds_read_b64_tr_b16 a[56:57], v7 offset:49152
  ds_read_b64_tr_b16 a[58:59], v7 offset:51200
  ds_read_b64_tr_b16 a[184:185], v7 offset:53248
  ds_read_b64_tr_b16 a[186:187], v7 offset:55296
  ds_read_b64_tr_b16 a[60:61], v7 offset:57344
  ds_read_b64_tr_b16 a[62:63], v7 offset:59392
  ds_read_b64_tr_b16 a[188:189], v7 offset:61440
  ds_read_b64_tr_b16 a[190:191], v7 offset:63488
  s_waitcnt vmcnt(24) lgkmcnt(0)
  s_barrier
  s_add_u32 m0, s41, 114688
  s_mov_b32 s42, 6029312
  s_cbranch_vccnz Lpace_87
  s_waitcnt vmcnt(6)
Lpace_87:
  buffer_load_dwordx4 v8, s[8:11], s42 offen lds
  s_add_u32 m0, s41, 118784
  s_mov_b32 s42, 6029312
  s_cbranch_vccnz Lpace_88
  s_waitcnt vmcnt(6)
Lpace_88:
  buffer_load_dwordx4 v9, s[8:11], s42 offen lds
  s_add_u32 m0, s41, 122880
  s_mov_b32 s42, 6160384
  s_cbranch_vccnz Lpace_89
  s_waitcnt vmcnt(6)
Lpace_89:
  buffer_load_dwordx4 v8, s[8:11], s42 offen lds
  s_add_u32 m0, s41, 126976
  s_mov_b32 s42, 6160384
  s_cbranch_vccnz Lpace_90
  s_waitcnt vmcnt(6)
Lpace_90:
  buffer_load_dwordx4 v9, s[8:11], s42 offen lds
  ds_read_b64_tr_b16 a[64:65], v6 offset:0
  ds_read_b64_tr_b16 a[66:67], v6 offset:2048
  ds_read_b64_tr_b16 a[192:193], v6 offset:4096
  ds_read_b64_tr_b16 a[194:195], v6 offset:6144
  ds_read_b64_tr_b16 a[68:69], v6 offset:8192
  ds_read_b64_tr_b16 a[70:71], v6 offset:10240
  ds_read_b64_tr_b16 a[196:197], v6 offset:12288
  ds_read_b64_tr_b16 a[198:199], v6 offset:14336
  s_waitcnt vmcnt(24) lgkmcnt(0)
  s_barrier
  s_load_dwordx2 s[8:9], s[0:1], 32
  s_mov_b32 s10, 8388608
  s_mov_b32 s11, 0x20000
  s_waitcnt lgkmcnt(0)
  s_add_u32 m0, s41, 0
  s_mov_b32 s42, 0
  s_cbranch_vccnz Lpace_91
  s_waitcnt vmcnt(6)
Lpace_91:
  buffer_load_dwordx4 v10, s[8:11], s42 offen lds
  s_add_u32 m0, s41, 4096
  s_mov_b32 s42, 131072
  s_cbranch_vccnz Lpace_92
  s_waitcnt vmcnt(6)
Lpace_92:
  buffer_load_dwordx4 v10, s[8:11], s42 offen lds
  s_add_u32 m0, s41, 8192
  s_mov_b32 s42, 262144
  s_cbranch_vccnz Lpace_93
  s_waitcnt vmcnt(6)
Lpace_93:
  buffer_load_dwordx4 v10, s[8:11], s42 offen lds
  s_add_u32 m0, s41, 12288
  s_mov_b32 s42, 393216
  s_cbranch_vccnz Lpace_94
  s_waitcnt vmcnt(6)
Lpace_94:
  buffer_load_dwordx4 v10, s[8:11], s42 offen lds
  ds_read_b64_tr_b16 a[72:73], v6 offset:16384
  ds_read_b64_tr_b16 a[74:75], v6 offset:18432
  ds_read_b64_tr_b16 a[200:201], v6 offset:20480
  ds_read_b64_tr_b16 a[202:203], v6 offset:22528
  ds_read_b64_tr_b16 a[76:77], v6 offset:24576
  ds_read_b64_tr_b16 a[78:79], v6 offset:26624
  ds_read_b64_tr_b16 a[204:205], v6 offset:28672
  ds_read_b64_tr_b16 a[206:207], v6 offset:30720
  s_waitcnt vmcnt(24) lgkmcnt(0)
  s_barrier
  s_add_u32 m0, s41, 16384
  s_mov_b32 s42, 524288
  s_cbranch_vccnz Lpace_95
  s_waitcnt vmcnt(6)
Lpace_95:
  buffer_load_dwordx4 v10, s[8:11], s42 offen lds
  s_add_u32 m0, s41, 20480
  s_mov_b32 s42, 655360
  s_cbranch_vccnz Lpace_96
  s_waitcnt vmcnt(6)
Lpace_96:
  buffer_load_dwordx4 v10, s[8:11], s42 offen lds
  s_add_u32 m0, s41, 24576
  s_mov_b32 s42, 786432
  s_cbranch_vccnz Lpace_97
  s_waitcnt vmcnt(6)
Lpace_97:
  buffer_load_dwordx4 v10, s[8:11], s42 offen lds
  s_add_u32 m0, s41, 28672
  s_mov_b32 s42, 917504
  s_cbranch_vccnz Lpace_98
  s_waitcnt vmcnt(6)
Lpace_98:
  buffer_load_dwordx4 v10, s[8:11], s42 offen lds
  ds_read_b64_tr_b16 a[80:81], v6 offset:32768
  ds_read_b64_tr_b16 a[82:83], v6 offset:34816
  ds_read_b64_tr_b16 a[208:209], v6 offset:36864
  ds_read_b64_tr_b16 a[210:211], v6 offset:38912
  ds_read_b64_tr_b16 a[84:85], v6 offset:40960
  ds_read_b64_tr_b16 a[86:87], v6 offset:43008
  ds_read_b64_tr_b16 a[212:213], v6 offset:45056
  ds_read_b64_tr_b16 a[214:215], v6 offset:47104
  s_cmp_lg_u32 s20, 0
  s_cbranch_scc1 L_QKV_noinit
Lini_99:
  s_load_dwordx16 s[64:79], s[12:13], 128 glc
  s_load_dwordx16 s[80:95], s[12:13], 192 glc
  s_sub_u32 s24, s24, 1
  s_cbranch_scc1 L_FAIL
  s_waitcnt lgkmcnt(0)
  s_and_b64 s[64:65], s[64:65], s[66:67]
  s_and_b64 s[64:65], s[64:65], s[68:69]
  s_and_b64 s[64:65], s[64:65], s[70:71]
  s_and_b64 s[64:65], s[64:65], s[72:73]
  s_and_b64 s[64:65], s[64:65], s[74:75]
  s_and_b64 s[64:65], s[64:65], s[76:77]
  s_and_b64 s[64:65], s[64:65], s[78:79]
  s_and_b64 s[64:65], s[64:65], s[80:81]
  s_and_b64 s[64:65], s[64:65], s[82:83]
  s_and_b64 s[64:65], s[64:65], s[84:85]
  s_and_b64 s[64:65], s[64:65], s[86:87]
  s_and_b64 s[64:65], s[64:65], s[88:89]
  s_and_b64 s[64:65], s[64:65], s[90:91]
  s_and_b64 s[64:65], s[64:65], s[92:93]
  s_and_b64 s[64:65], s[64:65], s[94:95]
  s_and_b32 s64, s64, s65
  s_cbranch_scc0 Lini_99
L_QKV_noinit:
  s_waitcnt vmcnt(24) lgkmcnt(0)
  s_barrier
  s_add_u32 m0, s41, 32768
  s_mov_b32 s42, 1048576
  s_cbranch_vccnz Lpace_100
  s_waitcnt vmcnt(6)
Lpace_100:
  buffer_load_dwordx4 v10, s[8:11], s42 offen lds
  s_add_u32 m0, s41, 36864
  s_mov_b32 s42, 1179648
  s_cbranch_vccnz Lpace_101
  s_waitcnt vmcnt(6)
Lpace_101:
  buffer_load_dwordx4 v10, s[8:11], s42 offen lds
  s_add_u32 m0, s41, 40960
  s_mov_b32 s42, 1310720
  s_cbranch_vccnz Lpace_102
  s_waitcnt vmcnt(6)
Lpace_102:
  buffer_load_dwordx4 v10, s[8:11], s42 offen lds
  s_add_u32 m0, s41, 45056
  s_mov_b32 s42, 1441792
  s_cbranch_vccnz Lpace_103
  s_waitcnt vmcnt(6)
Lpace_103:
  buffer_load_dwordx4 v10, s[8:11], s42 offen lds
  ds_read_b64_tr_b16 a[88:89], v6 offset:49152
  ds_read_b64_tr_b16 a[90:91], v6 offset:51200
  ds_read_b64_tr_b16 a[216:217], v6 offset:53248
  ds_read_b64_tr_b16 a[218:219], v6 offset:55296
  ds_read_b64_tr_b16 a[92:93], v6 offset:57344
  ds_read_b64_tr_b16 a[94:95], v6 offset:59392
  ds_read_b64_tr_b16 a[220:221], v6 offset:61440
  ds_read_b64_tr_b16 a[222:223], v6 offset:63488
  s_waitcnt vmcnt(24) lgkmcnt(0)
  s_barrier
  s_add_u32 m0, s41, 49152
  s_mov_b32 s42, 1572864
  s_cbranch_vccnz Lpace_104
  s_waitcnt vmcnt(6)
Lpace_104:
  buffer_load_dwordx4 v10, s[8:11], s42 offen lds
  s_add_u32 m0, s41, 53248
  s_mov_b32 s42, 1703936
  s_cbranch_vccnz Lpace_105
  s_waitcnt vmcnt(6)
Lpace_105:
  buffer_load_dwordx4 v10, s[8:11], s42 offen lds
  s_add_u32 m0, s41, 57344
  s_mov_b32 s42, 1835008
  s_cbranch_vccnz Lpace_106
  s_waitcnt vmcnt(6)
Lpace_106:
  buffer_load_dwordx4 v10, s[8:11], s42 offen lds
  s_add_u32 m0, s41, 61440
  s_mov_b32 s42, 1966080
  s_cbranch_vccnz Lpace_107
  s_waitcnt vmcnt(6)
Lpace_107:
  buffer_load_dwordx4 v10, s[8:11], s42 offen lds
  ds_read_b64_tr_b16 a[96:97], v7 offset:0
  ds_read_b64_tr_b16 a[98:99], v7 offset:2048
  ds_read_b64_tr_b16 a[224:225], v7 offset:4096
  ds_read_b64_tr_b16 a[226:227], v7 offset:6144
  ds_read_b64_tr_b16 a[100:101], v7 offset:8192
  ds_read_b64_tr_b16 a[102:103], v7 offset:10240
  ds_read_b64_tr_b16 a[228:229], v7 offset:12288
  ds_read_b64_tr_b16 a[230:231], v7 offset:14336
  s_waitcnt vmcnt(24) lgkmcnt(0)
  s_barrier
  s_add_u32 m0, s41, 65536
  s_mov_b32 s42, 4194304
  s_cbranch_vccnz Lpace_108
  s_waitcnt vmcnt(6)
Lpace_108:
  buffer_load_dwordx4 v10, s[8:11], s42 offen lds
  s_add_u32 m0, s41, 69632
  s_mov_b32 s42, 4325376
  s_cbranch_vccnz Lpace_109
  s_waitcnt vmcnt(6)
Lpace_109:
  buffer_load_dwordx4 v10, s[8:11], s42 offen lds
  s_add_u32 m0, s41, 73728
  s_mov_b32 s42, 4456448
  s_cbranch_vccnz Lpace_110
  s_waitcnt vmcnt(6)
Lpace_110:
  buffer_load_dwordx4 v10, s[8:11], s42 offen lds
  s_add_u32 m0, s41, 77824
  s_mov_b32 s42, 4587520
  s_cbranch_vccnz Lpace_111
  s_waitcnt vmcnt(6)
Lpace_111:
  buffer_load_dwordx4 v10, s[8:11], s42 offen lds
  ds_read_b64_tr_b16 a[104:105], v7 offset:16384
  ds_read_b64_tr_b16 a[106:107], v7 offset:18432
  ds_read_b64_tr_b16 a[232:233], v7 offset:20480
  ds_read_b64_tr_b16 a[234:235], v7 offset:22528
  ds_read_b64_tr_b16 a[108:109], v7 offset:24576
  ds_read_b64_tr_b16 a[110:111], v7 offset:26624
  ds_read_b64_tr_b16 a[236:237], v7 offset:28672
  ds_read_b64_tr_b16 a[238:239], v7 offset:30720
  s_waitcnt vmcnt(24) lgkmcnt(0)
  s_barrier
  s_add_u32 m0, s41, 81920
  s_mov_b32 s42, 4718592
  s_cbranch_vccnz Lpace_112
  s_waitcnt vmcnt(6)
Lpace_112:
  buffer_load_dwordx4 v10, s[8:11], s42 offen lds
  s_add_u32 m0, s41, 86016
  s_mov_b32 s42, 4849664
  s_cbranch_vccnz Lpace_113
  s_waitcnt vmcnt(6)
Lpace_113:
  buffer_load_dwordx4 v10, s[8:11], s42 offen lds
  s_add_u32 m0, s41, 90112
  s_mov_b32 s42, 4980736
  s_cbranch_vccnz Lpace_114
  s_waitcnt vmcnt(6)
Lpace_114:
  buffer_load_dwordx4 v10, s[8:11], s42 offen lds
  s_add_u32 m0, s41, 94208
  s_mov_b32 s42, 5111808
  s_cbranch_vccnz Lpace_115
  s_waitcnt vmcnt(6)
Lpace_115:
  buffer_load_dwordx4 v10, s[8:11], s42 offen lds
  ds_read_b64_tr_b16 a[112:113], v7 offset:32768
  ds_read_b64_tr_b16 a[114:115], v7 offset:34816
  ds_read_b64_tr_b16 a[240:241], v7 offset:36864
  ds_read_b64_tr_b16 a[242:243], v7 offset:38912
  ds_read_b64_tr_b16 a[116:117], v7 offset:40960
  ds_read_b64_tr_b16 a[118:119], v7 offset:43008
  ds_read_b64_tr_b16 a[244:245], v7 offset:45056
  ds_read_b64_tr_b16 a[246:247], v7 offset:47104
  s_waitcnt vmcnt(24) lgkmcnt(0)
  s_barrier
  s_add_u32 m0, s41, 98304
  s_mov_b32 s42, 5242880
  s_cbranch_vccnz Lpace_116
  s_waitcnt vmcnt(6)
Lpace_116:
  buffer_load_dwordx4 v10, s[8:11], s42 offen lds
  s_add_u32 m0, s41, 102400
  s_mov_b32 s42, 5373952
  s_cbranch_vccnz Lpace_117
  s_waitcnt vmcnt(6)
Lpace_117:
  buffer_load_dwordx4 v10, s[8:11], s42 offen lds
  s_add_u32 m0, s41, 106496
  s_mov_b32 s42, 5505024
  s_cbranch_vccnz Lpace_118
  s_waitcnt vmcnt(6)
Lpace_118:
  buffer_load_dwordx4 v10, s[8:11], s42 offen lds
  s_add_u32 m0, s41, 110592
  s_mov_b32 s42, 5636096
  s_cbranch_vccnz Lpace_119
  s_waitcnt vmcnt(6)
Lpace_119:
  buffer_load_dwordx4 v10, s[8:11], s42 offen lds
  ds_read_b64_tr_b16 a[120:121], v7 offset:49152
  ds_read_b64_tr_b16 a[122:123], v7 offset:51200
  ds_read_b64_tr_b16 a[248:249], v7 offset:53248
  ds_read_b64_tr_b16 a[250:251], v7 offset:55296
  ds_read_b64_tr_b16 a[124:125], v7 offset:57344
  ds_read_b64_tr_b16 a[126:127], v7 offset:59392
  ds_read_b64_tr_b16 a[252:253], v7 offset:61440
  ds_read_b64_tr_b16 a[254:255], v7 offset:63488
  s_waitcnt vmcnt(24) lgkmcnt(0)
  s_barrier
  s_add_u32 m0, s41, 114688
  s_mov_b32 s42, 5767168
  s_cbranch_vccnz Lpace_120
  s_waitcnt vmcnt(6)
Lpace_120:
  buffer_load_dwordx4 v10, s[8:11], s42 offen lds
  s_add_u32 m0, s41, 118784
  s_mov_b32 s42, 5898240
  s_cbranch_vccnz Lpace_121
  s_waitcnt vmcnt(6)
Lpace_121:
  buffer_load_dwordx4 v10, s[8:11], s42 offen lds
  s_add_u32 m0, s41, 122880
  s_mov_b32 s42, 6029312
  s_cbranch_vccnz Lpace_122
  s_waitcnt vmcnt(6)
Lpace_122:
  buffer_load_dwordx4 v10, s[8:11], s42 offen lds
  s_add_u32 m0, s41, 126976
  s_mov_b32 s42, 6160384
  s_cbranch_vccnz Lpace_123
  s_waitcnt vmcnt(6)
Lpace_123:
  buffer_load_dwordx4 v10, s[8:11], s42 offen lds
  ds_read_b64_tr_b16 v[128:129], v6 offset:0
  ds_read_b64_tr_b16 v[130:131], v6 offset:2048
  ds_read_b64_tr_b16 v[132:133], v6 offset:4096
  ds_read_b64_tr_b16 v[134:135], v6 offset:6144
  ds_read_b64_tr_b16 v[136:137], v6 offset:8192
  ds_read_b64_tr_b16 v[138:139], v6 offset:10240
  ds_read_b64_tr_b16 v[140:141], v6 offset:12288
  ds_read_b64_tr_b16 v[142:143], v6 offset:14336
  s_waitcnt vmcnt(24) lgkmcnt(0)
  s_barrier
  ds_read_b64_tr_b16 v[144:145], v6 offset:16384
  ds_read_b64_tr_b16 v[146:147], v6 offset:18432
  ds_read_b64_tr_b16 v[148:149], v6 offset:20480
  ds_read_b64_tr_b16 v[150:151], v6 offset:22528
  ds_read_b64_tr_b16 v[152:153], v6 offset:24576
  ds_read_b64_tr_b16 v[154:155], v6 offset:26624
  ds_read_b64_tr_b16 v[156:157], v6 offset:28672
  ds_read_b64_tr_b16 v[158:159], v6 offset:30720
  s_waitcnt vmcnt(20) lgkmcnt(0)
  s_barrier
  ds_read_b64_tr_b16 v[160:161], v6 offset:32768
  ds_read_b64_tr_b16 v[162:163], v6 offset:34816
  ds_read_b64_tr_b16 v[164:165], v6 offset:36864
  ds_read_b64_tr_b16 v[166:167], v6 offset:38912
  ds_read_b64_tr_b16 v[168:169], v6 offset:40960
  ds_read_b64_tr_b16 v[170:171], v6 offset:43008
  ds_read_b64_tr_b16 v[172:173], v6 offset:45056
  ds_read_b64_tr_b16 v[174:175], v6 offset:47104
  s_waitcnt vmcnt(16) lgkmcnt(0)
  s_barrier
  ds_read_b64_tr_b16 v[176:177], v6 offset:49152
  ds_read_b64_tr_b16 v[178:179], v6 offset:51200
  ds_read_b64_tr_b16 v[180:181], v6 offset:53248
  ds_read_b64_tr_b16 v[182:183], v6 offset:55296
  ds_read_b64_tr_b16 v[184:185], v6 offset:57344
  ds_read_b64_tr_b16 v[186:187], v6 offset:59392
  ds_read_b64_tr_b16 v[188:189], v6 offset:61440
  ds_read_b64_tr_b16 v[190:191], v6 offset:63488
  s_waitcnt vmcnt(12) lgkmcnt(0)
  s_barrier
  ds_read_b64_tr_b16 v[192:193], v7 offset:0
  ds_read_b64_tr_b16 v[194:195], v7 offset:2048
  ds_read_b64_tr_b16 v[196:197], v7 offset:4096
  ds_read_b64_tr_b16 v[198:199], v7 offset:6144
  ds_read_b64_tr_b16 v[200:201], v7 offset:8192
  ds_read_b64_tr_b16 v[202:203], v7 offset:10240
  ds_read_b64_tr_b16 v[204:205], v7 offset:12288
  ds_read_b64_tr_b16 v[206:207], v7 offset:14336
  s_waitcnt vmcnt(8) lgkmcnt(0)
  s_barrier
  buffer_load_dword v3, v2, s[4:7], 0 offen sc1
  buffer_load_dword v65, v64, s[4:7], 0 offen sc1
  ds_read_b64_tr_b16 v[208:209], v7 offset:16384
  ds_read_b64_tr_b16 v[210:211], v7 offset:18432
  ds_read_b64_tr_b16 v[212:213], v7 offset:20480
  ds_read_b64_tr_b16 v[214:215], v7 offset:22528
  ds_read_b64_tr_b16 v[216:217], v7 offset:24576
  ds_read_b64_tr_b16 v[218:219], v7 offset:26624
  ds_read_b64_tr_b16 v[220:221], v7 offset:28672
  ds_read_b64_tr_b16 v[222:223], v7 offset:30720
  s_waitcnt vmcnt(6) lgkmcnt(0)
  s_barrier
  ds_read_b64_tr_b16 v[224:225], v7 offset:32768
  ds_read_b64_tr_b16 v[226:227], v7 offset:34816
  ds_read_b64_tr_b16 v[228:229], v7 offset:36864
  ds_read_b64_tr_b16 v[230:231], v7 offset:38912
  ds_read_b64_tr_b16 v[232:233], v7 offset:40960
  ds_read_b64_tr_b16 v[234:235], v7 offset:43008
  ds_read_b64_tr_b16 v[236:237], v7 offset:45056
  ds_read_b64_tr_b16 v[238:239], v7 offset:47104
  s_waitcnt vmcnt(2) lgkmcnt(0)
  s_barrier
  ds_read_b64_tr_b16 v[240:241], v7 offset:49152
  ds_read_b64_tr_b16 v[242:243], v7 offset:51200
  ds_read_b64_tr_b16 v[244:245], v7 offset:53248
  ds_read_b64_tr_b16 v[246:247], v7 offset:55296
  ds_read_b64_tr_b16 v[248:249], v7 offset:57344
  ds_read_b64_tr_b16 v[250:251], v7 offset:59392
  ds_read_b64_tr_b16 v[252:253], v7 offset:61440
  ds_read_b64_tr_b16 v[254:255], v7 offset:63488
  s_waitcnt lgkmcnt(0)
  s_barrier
  s_lshr_b32 s62, s21, 2
  s_lshl_b32 s62, s62, 7
  s_and_b32 s40, s21, 3
  s_lshl_b32 s40, s40, 2
  s_add_u32 s62, s62, s40
  s_add_u32 s62, s62, 1396736
  s_mov_b32 s27, 6291456
  s_lshr_b32 s40, s21, 1
  s_mul_i32 s40, s40, 65536
  s_mov_b32 s31, 0
  s_and_b32 s41, s21, 1
  s_lshl_b32 s42, s20, 11
  s_add_u32 s42, s42, s40
  s_lshl_b32 s40, s41, 14
  s_add_u32 s40, s40, s42
  v_lshl_add_u32 v76, v0, 4, s40
  s_lshl_b32 s40, s41, 10
  s_add_u32 s40, s40, s42
  s_add_u32 s40, s40, 32768
  s_xor_b32 s40, s40, 65536
  v_lshl_add_u32 v83, v0, 4, s40
  s_mov_b32 s25, 0
  s_mov_b32 s37, 2147483392
  s_mov_b32 s30, 0
  s_mov_b32 s34, s32
  s_mov_b32 s35, s27
  v_mov_b32 v81, v77
  v_mov_b32 v82, v78
  s_waitcnt vmcnt(0)
  v_cmp_gt_i32 vcc, 1, v3
  s_cbranch_vccz L_QKV_rows
  s_nop 3
Lpoll_124:
  buffer_load_dword v3, v2, s[4:7], 0 offen sc1
  s_sub_u32 s24, s24, 1
  s_cbranch_scc1 L_FAIL
  s_waitcnt vmcnt(0)
  v_cmp_gt_i32 vcc, 1, v3
  s_cbranch_vccz Lpolld_125
  s_sleep 1
  s_branch Lpoll_124
Lpolld_125:
L_QKV_rows:
  v_cmp_gt_i32 vcc, 0, v65
  s_cbranch_vccz Ltab_126
  s_nop 3
Lpoll_127:
  buffer_load_dword v65, v64, s[4:7], 0 offen sc1
  s_sub_u32 s24, s24, 1
  s_cbranch_scc1 L_FAIL
  s_waitcnt vmcnt(0)
  v_cmp_gt_i32 vcc, 0, v65
  s_cbranch_vccz Lpolld_128
  s_sleep 1
  s_branch Lpoll_127
Lpolld_128:
Ltab_126:
  v_lshrrev_b32 v65, 8, v65
  v_and_b32 v66, 3, v0
  v_lshl_or_b32 v65, v65, 2, v66
  s_nop 1
  v_min_u32_dpp v65, v65, v65 row_ror:8 row_mask:0xf bank_mask:0xf
  s_nop 1
  v_min_u32_dpp v65, v65, v65 row_ror:4 row_mask:0xf bank_mask:0xf
  v_mov_b32 v66, v65
  s_nop 1
  v_permlane16_swap_b32 v66, v65
  v_min_u32 v65, v65, v66
  v_mov_b32 v66, v65
  s_nop 1
  v_permlane32_swap_b32 v66, v65
  v_min_u32 v65, v65, v66
  s_nop 1
  v_min_u32_dpp v65, v65, v65 row_ror:2 row_mask:0xf bank_mask:0xf
  s_nop 1
  v_min_u32_dpp v65, v65, v65 row_ror:1 row_mask:0xf bank_mask:0xf
  s_nop 0
  v_readfirstlane_b32 s40, v65
  s_and_b32 s40, s40, 3
  s_lshl_b32 s40, s40, 13
  s_and_b32 s40, s40, 0x2000
  s_xor_b32 s40, s40, 20971520
  s_add_u32 s31, s31, s40
  s_add_u32 m0, s34, 0
  s_nop 0
  buffer_load_dwordx4 v1, s[4:7], s35 offen offset:0 sc1 lds
  s_add_u32 m0, s34, 3968
  s_nop 0
  buffer_load_dwordx4 v1, s[4:7], s35 offen offset:128 sc1 lds
  s_add_u32 m0, s34, 7936
  s_nop 0
  buffer_load_dwordx4 v1, s[4:7], s35 offen offset:256 sc1 lds
  s_add_u32 m0, s34, 11904
  s_nop 0
  buffer_load_dwordx4 v1, s[4:7], s35 offen offset:384 sc1 lds
  s_add_u32 m0, s34, 15872
  s_nop 0
  buffer_load_dwordx4 v1, s[4:7], s35 offen offset:512 sc1 lds
  s_add_u32 m0, s34, 19840
  s_nop 0
  buffer_load_dwordx4 v1, s[4:7], s35 offen offset:640 sc1 lds
  s_add_u32 m0, s34, 23808
  s_nop 0
  buffer_load_dwordx4 v1, s[4:7], s35 offen offset:768 sc1 lds
  s_add_u32 m0, s34, 27776
  s_nop 0
  buffer_load_dwordx4 v1, s[4:7], s35 offen offset:896 sc1 lds
  s_add_u32 m0, s34, 31744
  s_nop 0
  buffer_load_dwordx4 v1, s[4:7], s35 offen offset:1024 sc1 lds
  s_add_u32 m0, s34, 35712
  s_nop 0
  buffer_load_dwordx4 v1, s[4:7], s35 offen offset:1152 sc1 lds
  s_add_u32 m0, s34, 39680
  s_nop 0
  buffer_load_dwordx4 v1, s[4:7], s35 offen offset:1280 sc1 lds
  s_add_u32 m0, s34, 43648
  s_nop 0
  buffer_load_dwordx4 v1, s[4:7], s35 offen offset:1408 sc1 lds
  s_add_u32 m0, s34, 47616
  s_nop 0
  buffer_load_dwordx4 v1, s[4:7], s35 offen offset:1536 sc1 lds
  s_add_u32 m0, s34, 51584
  s_nop 0
  buffer_load_dwordx4 v1, s[4:7], s35 offen offset:1664 sc1 lds
  s_add_u32 m0, s34, 55552
  s_nop 0
  buffer_load_dwordx4 v1, s[4:7], s35 offen offset:1792 sc1 lds
  s_add_u32 m0, s34, 59520
  s_nop 0
  buffer_load_dwordx4 v1, s[4:7], s35 offen offset:1920 sc1 lds
  s_waitcnt vmcnt(13)
  s_barrier
  ds_read_b128 v[4:7], v81 offset:0
  ds_read_b128 v[8:11], v81 offset:2048
  ds_read_b128 v[12:15], v82 offset:0
  ds_read_b128 v[16:19], v82 offset:2048
  ds_read_b128 v[20:23], v81 offset:4096
  ds_read_b128 v[24:27], v81 offset:6144
L_QKV_top:
  s_waitcnt lgkmcnt(4)
  v_cvt_pk_bf16_f32 v60, v36, v37
  v_cvt_pk_bf16_f32 v61, v38, v39
  v_mfma_f32_16x16x32_bf16 v[36:39], a[0:3], v[4:7], 0
  v_cvt_pk_bf16_f32 v62, v44, v45
  v_cvt_pk_bf16_f32 v63, v46, v47
  v_mfma_f32_16x16x32_bf16 v[44:47], a[128:131], v[4:7], 0
  v_cvt_pk_bf16_f32 v64, v40, v41
  v_cvt_pk_bf16_f32 v65, v42, v43
  v_mfma_f32_16x16x32_bf16 v[40:43], a[0:3], v[8:11], 0
  v_cvt_pk_bf16_f32 v66, v48, v49
  v_cvt_pk_bf16_f32 v67, v50, v51
  v_mfma_f32_16x16x32_bf16 v[48:51], a[128:131], v[8:11], 0
  v_cvt_pk_bf16_f32 v68, v52, v53
  v_cvt_pk_bf16_f32 v69, v54, v55
  v_mfma_f32_16x16x32_bf16 v[52:55], v[4:7], v[128:131], 0
  ds_read_b128 v[28:31], v82 offset:4096
  v_cvt_pk_bf16_f32 v70, v56, v57
  v_cvt_pk_bf16_f32 v71, v58, v59
  v_mfma_f32_16x16x32_bf16 v[56:59], v[8:11], v[128:131], 0
  ds_read_b128 v[32:35], v82 offset:6144
  s_waitcnt lgkmcnt(4)
  v_mfma_f32_16x16x32_bf16 v[36:39], a[4:7], v[12:15], v[36:39]
  ds_read_b128 v[4:7], v81 offset:8192
  v_mfma_f32_16x16x32_bf16 v[44:47], a[132:135], v[12:15], v[44:47]
  ds_read_b128 v[8:11], v81 offset:10240
  v_mfma_f32_16x16x32_bf16 v[40:43], a[4:7], v[16:19], v[40:43]
  buffer_store_dwordx4 v[60:63], v76, s[4:7], s37 offen offset:0 sc1
  v_mfma_f32_16x16x32_bf16 v[48:51], a[132:135], v[16:19], v[48:51]
  buffer_store_dwordx4 v[64:67], v76, s[4:7], s37 offen offset:1024 sc1
  v_mfma_f32_16x16x32_bf16 v[52:55], v[12:15], v[132:135], v[52:55]
  v_mfma_f32_16x16x32_bf16 v[56:59], v[16:19], v[132:135], v[56:59]
  s_waitcnt lgkmcnt(4)
  v_mfma_f32_16x16x32_bf16 v[36:39], a[8:11], v[20:23], v[36:39]
  ds_read_b128 v[12:15], v82 offset:8192
  v_mfma_f32_16x16x32_bf16 v[44:47], a[136:139], v[20:23], v[44:47]
  ds_read_b128 v[16:19], v82 offset:10240
  v_mfma_f32_16x16x32_bf16 v[40:43], a[8:11], v[24:27], v[40:43]
  buffer_store_dwordx4 v[68:71], v83, s[4:7], s37 offen sc1
  v_mfma_f32_16x16x32_bf16 v[48:51], a[136:139], v[24:27], v[48:51]
  v_cmp_gt_i32 vcc, 1, v3
  v_mfma_f32_16x16x32_bf16 v[52:55], v[20:23], v[136:139], v[52:55]
  v_mfma_f32_16x16x32_bf16 v[56:59], v[24:27], v[136:139], v[56:59]
  s_xor_b32 s34, s34, 0x10000
  s_add_u32 s35, s35, 65536
  s_cbranch_vccz L_QKV_have
  s_nop 4
Lpoll_129:
  buffer_load_dword v3, v2, s[4:7], s30 offen sc1
  s_sub_u32 s24, s24, 1
  s_cbranch_scc1 L_FAIL
  s_waitcnt vmcnt(0)
  v_cmp_gt_i32 vcc, 1, v3
  s_cbranch_vccz Lpolld_130
  s_sleep 1
  s_branch Lpoll_129
Lpolld_130:
L_QKV_have:
  s_waitcnt vmcnt(11)
  s_barrier
  s_waitcnt lgkmcnt(4)
  v_mfma_f32_16x16x32_bf16 v[36:39], a[12:15], v[28:31], v[36:39]
  ds_read_b128 v[20:23], v81 offset:12288
  v_mfma_f32_16x16x32_bf16 v[44:47], a[140:143], v[28:31], v[44:47]
  ds_read_b128 v[24:27], v81 offset:14336
  v_mfma_f32_16x16x32_bf16 v[40:43], a[12:15], v[32:35], v[40:43]
  s_add_u32 m0, s34, 0
  s_nop 0
  buffer_load_dwordx4 v1, s[4:7], s35 offen offset:0 sc1 lds
  v_mfma_f32_16x16x32_bf16 v[48:51], a[140:143], v[32:35], v[48:51]
  v_mfma_f32_16x16x32_bf16 v[52:55], v[28:31], v[140:143], v[52:55]
  v_mfma_f32_16x16x32_bf16 v[56:59], v[32:35], v[140:143], v[56:59]
  s_waitcnt lgkmcnt(4)
  v_mfma_f32_16x16x32_bf16 v[36:39], a[16:19], v[4:7], v[36:39]
  ds_read_b128 v[28:31], v82 offset:12288
  v_mfma_f32_16x16x32_bf16 v[44:47], a[144:147], v[4:7], v[44:47]
  ds_read_b128 v[32:35], v82 offset:14336
  v_mfma_f32_16x16x32_bf16 v[40:43], a[16:19], v[8:11], v[40:43]
  s_add_u32 m0, s34, 3968
  s_nop 0
  buffer_load_dwordx4 v1, s[4:7], s35 offen offset:128 sc1 lds
  v_mfma_f32_16x16x32_bf16 v[48:51], a[144:147], v[8:11], v[48:51]
  v_mfma_f32_16x16x32_bf16 v[52:55], v[4:7], v[144:147], v[52:55]
  v_mfma_f32_16x16x32_bf16 v[56:59], v[8:11], v[144:147], v[56:59]
  s_waitcnt lgkmcnt(4)
  v_mfma_f32_16x16x32_bf16 v[36:39], a[20:23], v[12:15], v[36:39]
  ds_read_b128 v[4:7], v81 offset:16384
  v_mfma_f32_16x16x32_bf16 v[44:47], a[148:151], v[12:15], v[44:47]
  ds_read_b128 v[8:11], v81 offset:18432
  v_mfma_f32_16x16x32_bf16 v[40:43], a[20:23], v[16:19], v[40:43]
  s_add_u32 m0, s34, 7936
  s_nop 0
  buffer_load_dwordx4 v1, s[4:7], s35 offen offset:256 sc1 lds
  v_mfma_f32_16x16x32_bf16 v[48:51], a[148:151], v[16:19], v[48:51]
  v_mfma_f32_16x16x32_bf16 v[52:55], v[12:15], v[148:151], v[52:55]
  v_mfma_f32_16x16x32_bf16 v[56:59], v[16:19], v[148:151], v[56:59]
  s_waitcnt lgkmcnt(4)
  v_mfma_f32_16x16x32_bf16 v[36:39], a[24:27], v[20:23], v[36:39]
  ds_read_b128 v[12:15], v82 offset:16384
  v_mfma_f32_16x16x32_bf16 v[44:47], a[152:155], v[20:23], v[44:47]
  ds_read_b128 v[16:19], v82 offset:18432
  v_mfma_f32_16x16x32_bf16 v[40:43], a[24:27], v[24:27], v[40:43]
  s_add_u32 m0, s34, 11904
  s_nop 0
  buffer_load_dwordx4 v1, s[4:7], s35 offen offset:384 sc1 lds
  v_mfma_f32_16x16x32_bf16 v[48:51], a[152:155], v[24:27], v[48:51]
  v_mfma_f32_16x16x32_bf16 v[52:55], v[20:23], v[152:155], v[52:55]
  v_mfma_f32_16x16x32_bf16 v[56:59], v[24:27], v[152:155], v[56:59]
  s_waitcnt lgkmcnt(4)
  v_mfma_f32_16x16x32_bf16 v[36:39], a[28:31], v[28:31], v[36:39]
  ds_read_b128 v[20:23], v81 offset:20480
  v_mfma_f32_16x16x32_bf16 v[44:47], a[156:159], v[28:31], v[44:47]
  ds_read_b128 v[24:27], v81 offset:22528
  v_mfma_f32_16x16x32_bf16 v[40:43], a[28:31], v[32:35], v[40:43]
  s_add_u32 m0, s34, 15872
  s_nop 0
  buffer_load_dwordx4 v1, s[4:7], s35 offen offset:512 sc1 lds
  v_mfma_f32_16x16x32_bf16 v[48:51], a[156:159], v[32:35], v[48:51]
  v_mfma_f32_16x16x32_bf16 v[52:55], v[28:31], v[156:159], v[52:55]
  v_mfma_f32_16x16x32_bf16 v[56:59], v[32:35], v[156:159], v[56:59]
  s_waitcnt lgkmcnt(4)
  v_mfma_f32_16x16x32_bf16 v[36:39], a[32:35], v[4:7], v[36:39]
  ds_read_b128 v[28:31], v82 offset:20480
  v_mfma_f32_16x16x32_bf16 v[44:47], a[160:163], v[4:7], v[44:47]
  ds_read_b128 v[32:35], v82 offset:22528
  v_mfma_f32_16x16x32_bf16 v[40:43], a[32:35], v[8:11], v[40:43]
  s_add_u32 m0, s34, 19840
  s_nop 0
  buffer_load_dwordx4 v1, s[4:7], s35 offen offset:640 sc1 lds
  v_mfma_f32_16x16x32_bf16 v[48:51], a[160:163], v[8:11], v[48:51]
  v_mfma_f32_16x16x32_bf16 v[52:55], v[4:7], v[160:163], v[52:55]
  v_mfma_f32_16x16x32_bf16 v[56:59], v[8:11], v[160:163], v[56:59]
  s_waitcnt lgkmcnt(4)
  v_mfma_f32_16x16x32_bf16 v[36:39], a[36:39], v[12:15], v[36:39]
  ds_read_b128 v[4:7], v81 offset:24576
  v_mfma_f32_16x16x32_bf16 v[44:47], a[164:167], v[12:15], v[44:47]
  ds_read_b128 v[8:11], v81 offset:26624
  v_mfma_f32_16x16x32_bf16 v[40:43], a[36:39], v[16:19], v[40:43]
  s_add_u32 m0, s34, 23808
  s_nop 0
  buffer_load_dwordx4 v1, s[4:7], s35 offen offset:768 sc1 lds
  v_mfma_f32_16x16x32_bf16 v[48:51], a[164:167], v[16:19], v[48:51]
  v_mfma_f32_16x16x32_bf16 v[52:55], v[12:15], v[164:167], v[52:55]
  v_mfma_f32_16x16x32_bf16 v[56:59], v[16:19], v[164:167], v[56:59]
  s_waitcnt lgkmcnt(4)
  v_mfma_f32_16x16x32_bf16 v[36:39], a[40:43], v[20:23], v[36:39]
  ds_read_b128 v[12:15], v82 offset:24576
  v_mfma_f32_16x16x32_bf16 v[44:47], a[168:171], v[20:23], v[44:47]
  ds_read_b128 v[16:19], v82 offset:26624
  v_mfma_f32_16x16x32_bf16 v[40:43], a[40:43], v[24:27], v[40:43]
  s_add_u32 m0, s34, 27776
  s_nop 0
  buffer_load_dwordx4 v1, s[4:7], s35 offen offset:896 sc1 lds
  v_mfma_f32_16x16x32_bf16 v[48:51], a[168:171], v[24:27], v[48:51]
  v_mfma_f32_16x16x32_bf16 v[52:55], v[20:23], v[168:171], v[52:55]
  v_mfma_f32_16x16x32_bf16 v[56:59], v[24:27], v[168:171], v[56:59]
  s_waitcnt lgkmcnt(4)
  v_mfma_f32_16x16x32_bf16 v[36:39], a[44:47], v[28:31], v[36:39]
  ds_read_b128 v[20:23], v81 offset:28672
  v_mfma_f32_16x16x32_bf16 v[44:47], a[172:175], v[28:31], v[44:47]
  ds_read_b128 v[24:27], v81 offset:30720
  v_mfma_f32_16x16x32_bf16 v[40:43], a[44:47], v[32:35], v[40:43]
  s_add_u32 m0, s34, 31744
  s_nop 0
  buffer_load_dwordx4 v1, s[4:7], s35 offen offset:1024 sc1 lds
  v_mfma_f32_16x16x32_bf16 v[48:51], a[172:175], v[32:35], v[48:51]
  v_mfma_f32_16x16x32_bf16 v[52:55], v[28:31], v[172:175], v[52:55]
  v_mfma_f32_16x16x32_bf16 v[56:59], v[32:35], v[172:175], v[56:59]
  s_waitcnt vmcnt(9)
  s_barrier
  s_cmp_lg_u32 s20, 0
  s_cbranch_scc1 Lnosig_131
  s_mov_b32 s63, s25
  s_atomic_smax s63, s[4:5], s62 glc
Lnosig_131:
  s_waitcnt lgkmcnt(4)
  v_mfma_f32_16x16x32_bf16 v[36:39], a[48:51], v[4:7], v[36:39]
  ds_read_b128 v[28:31], v82 offset:28672
  v_mfma_f32_16x16x32_bf16 v[44:47], a[176:179], v[4:7], v[44:47]
  ds_read_b128 v[32:35], v82 offset:30720
  v_mfma_f32_16x16x32_bf16 v[40:43], a[48:51], v[8:11], v[40:43]
  s_add_u32 m0, s34, 35712
  s_nop 0
  buffer_load_dwordx4 v1, s[4:7], s35 offen offset:1152 sc1 lds
  v_mfma_f32_16x16x32_bf16 v[48:51], a[176:179], v[8:11], v[48:51]
  v_mfma_f32_16x16x32_bf16 v[52:55], v[4:7], v[176:179], v[52:55]
  v_mfma_f32_16x16x32_bf16 v[56:59], v[8:11], v[176:179], v[56:59]
  s_waitcnt lgkmcnt(4)
  v_mfma_f32_16x16x32_bf16 v[36:39], a[52:55], v[12:15], v[36:39]
  ds_read_b128 v[4:7], v81 offset:32768
  v_mfma_f32_16x16x32_bf16 v[44:47], a[180:183], v[12:15], v[44:47]
  ds_read_b128 v[8:11], v81 offset:34816
  v_mfma_f32_16x16x32_bf16 v[40:43], a[52:55], v[16:19], v[40:43]
  s_add_u32 m0, s34, 39680
  s_nop 0
  buffer_load_dwordx4 v1, s[4:7], s35 offen offset:1280 sc1 lds
  v_mfma_f32_16x16x32_bf16 v[48:51], a[180:183], v[16:19], v[48:51]
  v_mfma_f32_16x16x32_bf16 v[52:55], v[12:15], v[180:183], v[52:55]
  v_mfma_f32_16x16x32_bf16 v[56:59], v[16:19], v[180:183], v[56:59]
  s_waitcnt lgkmcnt(4)
  v_mfma_f32_16x16x32_bf16 v[36:39], a[56:59], v[20:23], v[36:39]
  ds_read_b128 v[12:15], v82 offset:32768
  v_mfma_f32_16x16x32_bf16 v[44:47], a[184:187], v[20:23], v[44:47]
  ds_read_b128 v[16:19], v82 offset:34816
  v_mfma_f32_16x16x32_bf16 v[40:43], a[56:59], v[24:27], v[40:43]
  s_add_u32 m0, s34, 43648
  s_nop 0
  buffer_load_dwordx4 v1, s[4:7], s35 offen offset:1408 sc1 lds
  v_mfma_f32_16x16x32_bf16 v[48:51], a[184:187], v[24:27], v[48:51]
  v_mfma_f32_16x16x32_bf16 v[52:55], v[20:23], v[184:187], v[52:55]
  v_mfma_f32_16x16x32_bf16 v[56:59], v[24:27], v[184:187], v[56:59]
  s_waitcnt lgkmcnt(4)
  v_mfma_f32_16x16x32_bf16 v[36:39], a[60:63], v[28:31], v[36:39]
  ds_read_b128 v[20:23], v81 offset:36864
  v_mfma_f32_16x16x32_bf16 v[44:47], a[188:191], v[28:31], v[44:47]
  ds_read_b128 v[24:27], v81 offset:38912
  v_mfma_f32_16x16x32_bf16 v[40:43], a[60:63], v[32:35], v[40:43]
  s_add_u32 m0, s34, 47616
  s_nop 0
  buffer_load_dwordx4 v1, s[4:7], s35 offen offset:1536 sc1 lds
  v_mfma_f32_16x16x32_bf16 v[48:51], a[188:191], v[32:35], v[48:51]
  v_mfma_f32_16x16x32_bf16 v[52:55], v[28:31], v[188:191], v[52:55]
  v_mfma_f32_16x16x32_bf16 v[56:59], v[32:35], v[188:191], v[56:59]
  s_waitcnt lgkmcnt(4)
  v_mfma_f32_16x16x32_bf16 v[36:39], a[64:67], v[4:7], v[36:39]
  ds_read_b128 v[28:31], v82 offset:36864
  v_mfma_f32_16x16x32_bf16 v[44:47], a[192:195], v[4:7], v[44:47]
  ds_read_b128 v[32:35], v82 offset:38912
  v_mfma_f32_16x16x32_bf16 v[40:43], a[64:67], v[8:11], v[40:43]
  s_add_u32 m0, s34, 51584
  s_nop 0
  buffer_load_dwordx4 v1, s[4:7], s35 offen offset:1664 sc1 lds
  v_mfma_f32_16x16x32_bf16 v[48:51], a[192:195], v[8:11], v[48:51]
  v_mfma_f32_16x16x32_bf16 v[52:55], v[4:7], v[192:195], v[52:55]
  v_mfma_f32_16x16x32_bf16 v[56:59], v[8:11], v[192:195], v[56:59]
  s_waitcnt lgkmcnt(4)
  v_mfma_f32_16x16x32_bf16 v[36:39], a[68:71], v[12:15], v[36:39]
  ds_read_b128 v[4:7], v81 offset:40960
  v_mfma_f32_16x16x32_bf16 v[44:47], a[196:199], v[12:15], v[44:47]
  ds_read_b128 v[8:11], v81 offset:43008
  v_mfma_f32_16x16x32_bf16 v[40:43], a[68:71], v[16:19], v[40:43]
  s_add_u32 m0, s34, 55552
  s_nop 0
  buffer_load_dwordx4 v1, s[4:7], s35 offen offset:1792 sc1 lds
  v_mfma_f32_16x16x32_bf16 v[48:51], a[196:199], v[16:19], v[48:51]
  v_mfma_f32_16x16x32_bf16 v[52:55], v[12:15], v[196:199], v[52:55]
  v_mfma_f32_16x16x32_bf16 v[56:59], v[16:19], v[196:199], v[56:59]
  s_waitcnt lgkmcnt(4)
  v_mfma_f32_16x16x32_bf16 v[36:39], a[72:75], v[20:23], v[36:39]
  ds_read_b128 v[12:15], v82 offset:40960
  v_mfma_f32_16x16x32_bf16 v[44:47], a[200:203], v[20:23], v[44:47]
  ds_read_b128 v[16:19], v82 offset:43008
  v_mfma_f32_16x16x32_bf16 v[40:43], a[72:75], v[24:27], v[40:43]
  s_add_u32 m0, s34, 59520
  s_nop 0
  buffer_load_dwordx4 v1, s[4:7], s35 offen offset:1920 sc1 lds
  v_mfma_f32_16x16x32_bf16 v[48:51], a[200:203], v[24:27], v[48:51]
  v_mfma_f32_16x16x32_bf16 v[52:55], v[20:23], v[200:203], v[52:55]
  v_mfma_f32_16x16x32_bf16 v[56:59], v[24:27], v[200:203], v[56:59]
  s_waitcnt lgkmcnt(4)
  v_mfma_f32_16x16x32_bf16 v[36:39], a[76:79], v[28:31], v[36:39]
  ds_read_b128 v[20:23], v81 offset:45056
  v_mfma_f32_16x16x32_bf16 v[44:47], a[204:207], v[28:31], v[44:47]
  ds_read_b128 v[24:27], v81 offset:47104
  v_mfma_f32_16x16x32_bf16 v[40:43], a[76:79], v[32:35], v[40:43]
  v_mfma_f32_16x16x32_bf16 v[48:51], a[204:207], v[32:35], v[48:51]
  v_mfma_f32_16x16x32_bf16 v[52:55], v[28:31], v[204:207], v[52:55]
  v_mfma_f32_16x16x32_bf16 v[56:59], v[32:35], v[204:207], v[56:59]
  s_waitcnt lgkmcnt(4)
  v_mfma_f32_16x16x32_bf16 v[36:39], a[80:83], v[4:7], v[36:39]
  ds_read_b128 v[28:31], v82 offset:45056
  v_mfma_f32_16x16x32_bf16 v[44:47], a[208:211], v[4:7], v[44:47]
  ds_read_b128 v[32:35], v82 offset:47104
  v_mfma_f32_16x16x32_bf16 v[40:43], a[80:83], v[8:11], v[40:43]
  s_add_u32 s30, s25, 2
  s_and_b32 s30, s30, 56
  s_lshl_b32 s30, s30, 7
  buffer_load_dword v3, v2, s[4:7], s30 offen sc1
  v_mfma_f32_16x16x32_bf16 v[48:51], a[208:211], v[8:11], v[48:51]
  v_mfma_f32_16x16x32_bf16 v[52:55], v[4:7], v[208:211], v[52:55]
  v_mfma_f32_16x16x32_bf16 v[56:59], v[8:11], v[208:211], v[56:59]
  s_waitcnt lgkmcnt(4)
  v_mfma_f32_16x16x32_bf16 v[36:39], a[84:87], v[12:15], v[36:39]
  ds_read_b128 v[4:7], v81 offset:49152
  v_mfma_f32_16x16x32_bf16 v[44:47], a[212:215], v[12:15], v[44:47]
  ds_read_b128 v[8:11], v81 offset:51200
  v_mfma_f32_16x16x32_bf16 v[40:43], a[84:87], v[16:19], v[40:43]
  v_mfma_f32_16x16x32_bf16 v[48:51], a[212:215], v[16:19], v[48:51]
  v_mfma_f32_16x16x32_bf16 v[52:55], v[12:15], v[212:215], v[52:55]
  v_mfma_f32_16x16x32_bf16 v[56:59], v[16:19], v[212:215], v[56:59]
  s_waitcnt lgkmcnt(4)
  v_mfma_f32_16x16x32_bf16 v[36:39], a[88:91], v[20:23], v[36:39]
  ds_read_b128 v[12:15], v82 offset:49152
  v_mfma_f32_16x16x32_bf16 v[44:47], a[216:219], v[20:23], v[44:47]
  ds_read_b128 v[16:19], v82 offset:51200
  v_mfma_f32_16x16x32_bf16 v[40:43], a[88:91], v[24:27], v[40:43]
  v_mfma_f32_16x16x32_bf16 v[48:51], a[216:219], v[24:27], v[48:51]
  v_mfma_f32_16x16x32_bf16 v[52:55], v[20:23], v[216:219], v[52:55]
  v_mfma_f32_16x16x32_bf16 v[56:59], v[24:27], v[216:219], v[56:59]
  s_waitcnt lgkmcnt(4)
  v_mfma_f32_16x16x32_bf16 v[36:39], a[92:95], v[28:31], v[36:39]
  ds_read_b128 v[20:23], v81 offset:53248
  v_mfma_f32_16x16x32_bf16 v[44:47], a[220:223], v[28:31], v[44:47]
  ds_read_b128 v[24:27], v81 offset:55296
  v_mfma_f32_16x16x32_bf16 v[40:43], a[92:95], v[32:35], v[40:43]
  v_mfma_f32_16x16x32_bf16 v[48:51], a[220:223], v[32:35], v[48:51]
  v_mfma_f32_16x16x32_bf16 v[52:55], v[28:31], v[220:223], v[52:55]
  v_mfma_f32_16x16x32_bf16 v[56:59], v[32:35], v[220:223], v[56:59]
  s_waitcnt lgkmcnt(4)
  v_mfma_f32_16x16x32_bf16 v[36:39], a[96:99], v[4:7], v[36:39]
  ds_read_b128 v[28:31], v82 offset:53248
  v_mfma_f32_16x16x32_bf16 v[44:47], a[224:227], v[4:7], v[44:47]
  ds_read_b128 v[32:35], v82 offset:55296
  v_mfma_f32_16x16x32_bf16 v[40:43], a[96:99], v[8:11], v[40:43]
  v_mfma_f32_16x16x32_bf16 v[48:51], a[224:227], v[8:11], v[48:51]
  v_mfma_f32_16x16x32_bf16 v[52:55], v[4:7], v[224:227], v[52:55]
  v_mfma_f32_16x16x32_bf16 v[56:59], v[8:11], v[224:227], v[56:59]
  s_waitcnt lgkmcnt(4)
  v_mfma_f32_16x16x32_bf16 v[36:39], a[100:103], v[12:15], v[36:39]
  ds_read_b128 v[4:7], v81 offset:57344
  v_mfma_f32_16x16x32_bf16 v[44:47], a[228:231], v[12:15], v[44:47]
  ds_read_b128 v[8:11], v81 offset:59392
  v_mfma_f32_16x16x32_bf16 v[40:43], a[100:103], v[16:19], v[40:43]
  v_mfma_f32_16x16x32_bf16 v[48:51], a[228:231], v[16:19], v[48:51]
  v_mfma_f32_16x16x32_bf16 v[52:55], v[12:15], v[228:231], v[52:55]
  v_mfma_f32_16x16x32_bf16 v[56:59], v[16:19], v[228:231], v[56:59]
  s_waitcnt lgkmcnt(4)
  v_mfma_f32_16x16x32_bf16 v[36:39], a[104:107], v[20:23], v[36:39]
  ds_read_b128 v[12:15], v82 offset:57344
  v_mfma_f32_16x16x32_bf16 v[44:47], a[232:235], v[20:23], v[44:47]
  ds_read_b128 v[16:19], v82 offset:59392
  v_mfma_f32_16x16x32_bf16 v[40:43], a[104:107], v[24:27], v[40:43]
  v_mfma_f32_16x16x32_bf16 v[48:51], a[232:235], v[24:27], v[48:51]
  v_mfma_f32_16x16x32_bf16 v[52:55], v[20:23], v[232:235], v[52:55]
  v_mfma_f32_16x16x32_bf16 v[56:59], v[24:27], v[232:235], v[56:59]
  s_waitcnt lgkmcnt(4)
  v_mfma_f32_16x16x32_bf16 v[36:39], a[108:111], v[28:31], v[36:39]
  ds_read_b128 v[20:23], v81 offset:61440
  v_mfma_f32_16x16x32_bf16 v[44:47], a[236:239], v[28:31], v[44:47]
  ds_read_b128 v[24:27], v81 offset:63488
  v_mfma_f32_16x16x32_bf16 v[40:43], a[108:111], v[32:35], v[40:43]
  v_mfma_f32_16x16x32_bf16 v[48:51], a[236:239], v[32:35], v[48:51]
  v_mfma_f32_16x16x32_bf16 v[52:55], v[28:31], v[236:239], v[52:55]
  v_mfma_f32_16x16x32_bf16 v[56:59], v[32:35], v[236:239], v[56:59]
  s_waitcnt lgkmcnt(4)
  v_mfma_f32_16x16x32_bf16 v[36:39], a[112:115], v[4:7], v[36:39]
  ds_read_b128 v[28:31], v82 offset:61440
  v_mfma_f32_16x16x32_bf16 v[44:47], a[240:243], v[4:7], v[44:47]
  ds_read_b128 v[32:35], v82 offset:63488
  v_mfma_f32_16x16x32_bf16 v[40:43], a[112:115], v[8:11], v[40:43]
  v_mfma_f32_16x16x32_bf16 v[48:51], a[240:243], v[8:11], v[48:51]
  v_mfma_f32_16x16x32_bf16 v[52:55], v[4:7], v[240:243], v[52:55]
  v_mfma_f32_16x16x32_bf16 v[56:59], v[8:11], v[240:243], v[56:59]
  s_waitcnt vmcnt(0)
  s_barrier
  v_xor_b32 v81, 0x10000, v81
  v_xor_b32 v82, 0x10000, v82
  s_waitcnt lgkmcnt(4)
  v_mfma_f32_16x16x32_bf16 v[36:39], a[116:119], v[12:15], v[36:39]
  ds_read_b128 v[4:7], v81 offset:0
  v_mfma_f32_16x16x32_bf16 v[44:47], a[244:247], v[12:15], v[44:47]
  ds_read_b128 v[8:11], v81 offset:2048
  v_mfma_f32_16x16x32_bf16 v[40:43], a[116:119], v[16:19], v[40:43]
  v_mfma_f32_16x16x32_bf16 v[48:51], a[244:247], v[16:19], v[48:51]
  v_mfma_f32_16x16x32_bf16 v[52:55], v[12:15], v[244:247], v[52:55]
  v_mfma_f32_16x16x32_bf16 v[56:59], v[16:19], v[244:247], v[56:59]
  s_waitcnt lgkmcnt(4)
  v_mfma_f32_16x16x32_bf16 v[36:39], a[120:123], v[20:23], v[36:39]
  ds_read_b128 v[12:15], v82 offset:0
  v_mfma_f32_16x16x32_bf16 v[44:47], a[248:251], v[20:23], v[44:47]
  ds_read_b128 v[16:19], v82 offset:2048
  v_mfma_f32_16x16x32_bf16 v[40:43], a[120:123], v[24:27], v[40:43]
  v_mfma_f32_16x16x32_bf16 v[48:51], a[248:251], v[24:27], v[48:51]
  v_mfma_f32_16x16x32_bf16 v[52:55], v[20:23], v[248:251], v[52:55]
  v_mfma_f32_16x16x32_bf16 v[56:59], v[24:27], v[248:251], v[56:59]
  s_waitcnt lgkmcnt(4)
  v_mfma_f32_16x16x32_bf16 v[36:39], a[124:127], v[28:31], v[36:39]
  ds_read_b128 v[20:23], v81 offset:4096
  v_mfma_f32_16x16x32_bf16 v[44:47], a[252:255], v[28:31], v[44:47]
  ds_read_b128 v[24:27], v81 offset:6144
  v_mfma_f32_16x16x32_bf16 v[40:43], a[124:127], v[32:35], v[40:43]
  v_mfma_f32_16x16x32_bf16 v[48:51], a[252:255], v[32:35], v[48:51]
  v_mfma_f32_16x16x32_bf16 v[52:55], v[28:31], v[252:255], v[52:55]
  v_mfma_f32_16x16x32_bf16 v[56:59], v[32:35], v[252:255], v[56:59]
  s_mov_b32 s37, s31
  s_add_u32 s31, s31, 2097152
  s_xor_b32 s31, s31, 0x2000
  s_add_u32 s25, s25, 1
  s_cmp_lt_u32 s25, 64
  s_cbranch_scc1 L_QKV_top
  v_cvt_pk_bf16_f32 v60, v36, v37
  v_cvt_pk_bf16_f32 v61, v38, v39
  v_cvt_pk_bf16_f32 v62, v44, v45
  v_cvt_pk_bf16_f32 v63, v46, v47
  v_cvt_pk_bf16_f32 v64, v40, v41
  v_cvt_pk_bf16_f32 v65, v42, v43
  v_cvt_pk_bf16_f32 v66, v48, v49
  v_cvt_pk_bf16_f32 v67, v50, v51
  v_cvt_pk_bf16_f32 v68, v52, v53
  v_cvt_pk_bf16_f32 v69, v54, v55
  v_cvt_pk_bf16_f32 v70, v56, v57
  v_cvt_pk_bf16_f32 v71, v58, v59
  buffer_store_dwordx4 v[60:63], v76, s[4:7], s37 offen offset:0 sc1
  buffer_store_dwordx4 v[64:67], v76, s[4:7], s37 offen offset:1024 sc1
  buffer_store_dwordx4 v[68:71], v83, s[4:7], s37 offen sc1
  s_waitcnt vmcnt(0) lgkmcnt(0)
  s_barrier
  s_cmp_lg_u32 s20, 0
  s_cbranch_scc1 Lnosig_132
  s_mov_b32 s63, s25
  s_atomic_smax s63, s[4:5], s62 glc
Lnosig_132:
  s_branch L_END
L_WO:
  v_lshlrev_b32 v1, 4, v0
  s_lshl_b32 s32, s20, 12
  s_min_u32 s33, s32, 0x2000
  v_mov_b32 v69, v1
  v_add_u32 v70, 0x10000, v69
  s_load_dwordx2 s[8:9], s[0:1], 40
  s_mov_b32 s10, 8388608
  s_mov_b32 s11, 0x20000
  s_waitcnt lgkmcnt(0)
  s_lshr_b32 s44, s21, 3
  s_mul_i32 s44, s44, 2097152
  s_and_b32 s45, s21, 7
  s_lshl_b32 s45, s45, 8
  s_add_u32 s44, s44, s45
  s_add_u32 s45, s44, 128
  v_bfe_u32 v4, v0, 5, 1
  v_mul_u32_u24 v4, 8192, v4
  v_bfe_u32 v5, v0, 4, 1
  v_mul_u32_u24 v5, 4096, v5
  v_add_u32 v4, v4, v5
  v_bfe_u32 v5, v0, 3, 1
  v_mul_u32_u24 v5, 2048, v5
  v_add_u32 v4, v4, v5
  v_lshrrev_b32 v5, 3, v0
  v_and_b32 v5, 6, v5
  v_xor_b32 v5, v5, v0
  v_and_b32 v5, 7, v5
  v_lshl_add_u32 v4, v5, 4, v4
  s_lshr_b32 s40, s20, 1
  s_mul_i32 s40, s40, 131072
  s_and_b32 s41, s20, 1
  s_mul_i32 s41, s41, 16384
  s_add_u32 s40, s40, s41
  v_add_u32 v4, s40, v4
  v_bfe_u32 v5, v0, 3, 2
  v_xor_b32 v5, s20, v5
  v_lshlrev_b32 v5, 5, v5
  v_lshrrev_b32 v6, 2, v0
  v_lshl_add_u32 v6, v6, 7, v5
  v_and_b32 v5, 3, v0
  v_lshl_add_u32 v6, v5, 3, v6
  v_add_u32 v7, 0x10000, v6
  v_add_u32 v8, s44, v4
  v_add_u32 v9, s45, v4
  s_lshl_b32 s41, s20, 10
  s_add_u32 m0, s41, 0
  s_mov_b32 s42, 0
  buffer_load_dwordx4 v8, s[8:11], s42 offen nt lds
  s_add_u32 m0, s41, 4096
  s_mov_b32 s42, 0
  buffer_load_dwordx4 v9, s[8:11], s42 offen nt lds
  s_add_u32 m0, s41, 8192
  s_mov_b32 s42, 32768
  buffer_load_dwordx4 v8, s[8:11], s42 offen nt lds
  s_add_u32 m0, s41, 12288
  s_mov_b32 s42, 32768
  buffer_load_dwordx4 v9, s[8:11], s42 offen nt lds
  s_add_u32 m0, s41, 16384
  s_mov_b32 s42, 65536
  buffer_load_dwordx4 v8, s[8:11], s42 offen nt lds
  s_add_u32 m0, s41, 20480
  s_mov_b32 s42, 65536
  buffer_load_dwordx4 v9, s[8:11], s42 offen nt lds
  s_add_u32 m0, s41, 24576
  s_mov_b32 s42, 98304
  buffer_load_dwordx4 v8, s[8:11], s42 offen nt lds
  s_add_u32 m0, s41, 28672
  s_mov_b32 s42, 98304
  buffer_load_dwordx4 v9, s[8:11], s42 offen nt lds
  s_add_u32 m0, s41, 32768
  s_mov_b32 s42, 262144
  buffer_load_dwordx4 v8, s[8:11], s42 offen nt lds
  s_add_u32 m0, s41, 36864
  s_mov_b32 s42, 262144
  buffer_load_dwordx4 v9, s[8:11], s42 offen nt lds
  s_add_u32 m0, s41, 40960
  s_mov_b32 s42, 294912
  buffer_load_dwordx4 v8, s[8:11], s42 offen nt lds
  s_add_u32 m0, s41, 45056
  s_mov_b32 s42, 294912
  buffer_load_dwordx4 v9, s[8:11], s42 offen nt lds
  s_add_u32 m0, s41, 49152
  s_mov_b32 s42, 327680
  buffer_load_dwordx4 v8, s[8:11], s42 offen nt lds
  s_add_u32 m0, s41, 53248
  s_mov_b32 s42, 327680
  buffer_load_dwordx4 v9, s[8:11], s42 offen nt lds
  s_add_u32 m0, s41, 57344
  s_mov_b32 s42, 360448
  buffer_load_dwordx4 v8, s[8:11], s42 offen nt lds
  s_add_u32 m0, s41, 61440
  s_mov_b32 s42, 360448
  buffer_load_dwordx4 v9, s[8:11], s42 offen nt lds
  s_add_u32 m0, s41, 65536
  s_mov_b32 s42, 524288
  buffer_load_dwordx4 v8, s[8:11], s42 offen nt lds
  s_add_u32 m0, s41, 69632
  s_mov_b32 s42, 524288
  buffer_load_dwordx4 v9, s[8:11], s42 offen nt lds
  s_add_u32 m0, s41, 73728
  s_mov_b32 s42, 557056
  buffer_load_dwordx4 v8, s[8:11], s42 offen nt lds
  s_add_u32 m0, s41, 77824
  s_mov_b32 s42, 557056
  buffer_load_dwordx4 v9, s[8:11], s42 offen nt lds
  s_add_u32 m0, s41, 81920
  s_mov_b32 s42, 589824
  buffer_load_dwordx4 v8, s[8:11], s42 offen nt lds
  s_add_u32 m0, s41, 86016
  s_mov_b32 s42, 589824
  buffer_load_dwordx4 v9, s[8:11], s42 offen nt lds
  s_add_u32 m0, s41, 90112
  s_mov_b32 s42, 622592
  buffer_load_dwordx4 v8, s[8:11], s42 offen nt lds
  s_add_u32 m0, s41, 94208
  s_mov_b32 s42, 622592
  buffer_load_dwordx4 v9, s[8:11], s42 offen nt lds
  s_add_u32 m0, s41, 98304
  s_mov_b32 s42, 786432
  buffer_load_dwordx4 v8, s[8:11], s42 offen nt lds
  s_add_u32 m0, s41, 102400
  s_mov_b32 s42, 786432
  buffer_load_dwordx4 v9, s[8:11], s42 offen nt lds
  s_add_u32 m0, s41, 106496
  s_mov_b32 s42, 819200
  buffer_load_dwordx4 v8, s[8:11], s42 offen nt lds
  s_add_u32 m0, s41, 110592
  s_mov_b32 s42, 819200
  buffer_load_dwordx4 v9, s[8:11], s42 offen nt lds
  s_waitcnt vmcnt(24) lgkmcnt(0)
  s_barrier
  s_add_u32 m0, s41, 114688
  s_mov_b32 s42, 851968
  buffer_load_dwordx4 v8, s[8:11], s42 offen nt lds
  s_add_u32 m0, s41, 118784
  s_mov_b32 s42, 851968
  buffer_load_dwordx4 v9, s[8:11], s42 offen nt lds
  s_add_u32 m0, s41, 122880
  s_mov_b32 s42, 884736
  buffer_load_dwordx4 v8, s[8:11], s42 offen nt lds
  s_add_u32 m0, s41, 126976
  s_mov_b32 s42, 884736
  buffer_load_dwordx4 v9, s[8:11], s42 offen nt lds
  ds_read_b64_tr_b16 a[0:1], v6 offset:0
  ds_read_b64_tr_b16 a[2:3], v6 offset:2048
  ds_read_b64_tr_b16 a[128:129], v6 offset:4096
  ds_read_b64_tr_b16 a[130:131], v6 offset:6144
  ds_read_b64_tr_b16 a[4:5], v6 offset:8192
  ds_read_b64_tr_b16 a[6:7], v6 offset:10240
  ds_read_b64_tr_b16 a[132:133], v6 offset:12288
  ds_read_b64_tr_b16 a[134:135], v6 offset:14336
  s_waitcnt vmcnt(24) lgkmcnt(0)
  s_barrier
  s_add_u32 m0, s41, 0
  s_mov_b32 s42, 1048576
  buffer_load_dwordx4 v8, s[8:11], s42 offen nt lds
  s_add_u32 m0, s41, 4096
  s_mov_b32 s42, 1048576
  buffer_load_dwordx4 v9, s[8:11], s42 offen nt lds
  s_add_u32 m0, s41, 8192
  s_mov_b32 s42, 1081344
  buffer_load_dwordx4 v8, s[8:11], s42 offen nt lds
  s_add_u32 m0, s41, 12288
  s_mov_b32 s42, 1081344
  buffer_load_dwordx4 v9, s[8:11], s42 offen nt lds
  ds_read_b64_tr_b16 a[8:9], v6 offset:16384
  ds_read_b64_tr_b16 a[10:11], v6 offset:18432
  ds_read_b64_tr_b16 a[136:137], v6 offset:20480
  ds_read_b64_tr_b16 a[138:139], v6 offset:22528
  ds_read_b64_tr_b16 a[12:13], v6 offset:24576
  ds_read_b64_tr_b16 a[14:15], v6 offset:26624
  ds_read_b64_tr_b16 a[140:141], v6 offset:28672
  ds_read_b64_tr_b16 a[142:143], v6 offset:30720
  s_waitcnt vmcnt(24) lgkmcnt(0)
  s_barrier
  s_add_u32 m0, s41, 16384
  s_mov_b32 s42, 1114112
  buffer_load_dwordx4 v8, s[8:11], s42 offen nt lds
  s_add_u32 m0, s41, 20480
  s_mov_b32 s42, 1114112
  buffer_load_dwordx4 v9, s[8:11], s42 offen nt lds
  s_add_u32 m0, s41, 24576
  s_mov_b32 s42, 1146880
  buffer_load_dwordx4 v8, s[8:11], s42 offen nt lds
  s_add_u32 m0, s41, 28672
  s_mov_b32 s42, 1146880
  buffer_load_dwordx4 v9, s[8:11], s42 offen nt lds
  ds_read_b64_tr_b16 a[16:17], v6 offset:32768
  ds_read_b64_tr_b16 a[18:19], v6 offset:34816
  ds_read_b64_tr_b16 a[144:145], v6 offset:36864
  ds_read_b64_tr_b16 a[146:147], v6 offset:38912
  ds_read_b64_tr_b16 a[20:21], v6 offset:40960
  ds_read_b64_tr_b16 a[22:23], v6 offset:43008
  ds_read_b64_tr_b16 a[148:149], v6 offset:45056
  ds_read_b64_tr_b16 a[150:151], v6 offset:47104
  s_waitcnt vmcnt(24) lgkmcnt(0)
  s_barrier
  s_add_u32 m0, s41, 32768
  s_mov_b32 s42, 1310720
  buffer_load_dwordx4 v8, s[8:11], s42 offen nt lds
  s_add_u32 m0, s41, 36864
  s_mov_b32 s42, 1310720
  buffer_load_dwordx4 v9, s[8:11], s42 offen nt lds
  s_add_u32 m0, s41, 40960
  s_mov_b32 s42, 1343488
  buffer_load_dwordx4 v8, s[8:11], s42 offen nt lds
  s_add_u32 m0, s41, 45056
  s_mov_b32 s42, 1343488
  buffer_load_dwordx4 v9, s[8:11], s42 offen nt lds
  ds_read_b64_tr_b16 a[24:25], v6 offset:49152
  ds_read_b64_tr_b16 a[26:27], v6 offset:51200
  ds_read_b64_tr_b16 a[152:153], v6 offset:53248
  ds_read_b64_tr_b16 a[154:155], v6 offset:55296
  ds_read_b64_tr_b16 a[28:29], v6 offset:57344
  ds_read_b64_tr_b16 a[30:31], v6 offset:59392
  ds_read_b64_tr_b16 a[156:157], v6 offset:61440
  ds_read_b64_tr_b16 a[158:159], v6 offset:63488
  s_waitcnt vmcnt(24) lgkmcnt(0)
  s_barrier
  s_add_u32 m0, s41, 49152
  s_mov_b32 s42, 1376256
  buffer_load_dwordx4 v8, s[8:11], s42 offen nt lds
  s_add_u32 m0, s41, 53248
  s_mov_b32 s42, 1376256
  buffer_load_dwordx4 v9, s[8:11], s42 offen nt lds
  s_add_u32 m0, s41, 57344
  s_mov_b32 s42, 1409024
  buffer_load_dwordx4 v8, s[8:11], s42 offen nt lds
  s_add_u32 m0, s41, 61440
  s_mov_b32 s42, 1409024
  buffer_load_dwordx4 v9, s[8:11], s42 offen nt lds
  ds_read_b64_tr_b16 a[32:33], v7 offset:0
  ds_read_b64_tr_b16 a[34:35], v7 offset:2048
  ds_read_b64_tr_b16 a[160:161], v7 offset:4096
  ds_read_b64_tr_b16 a[162:163], v7 offset:6144
  ds_read_b64_tr_b16 a[36:37], v7 offset:8192
  ds_read_b64_tr_b16 a[38:39], v7 offset:10240
  ds_read_b64_tr_b16 a[164:165], v7 offset:12288
  ds_read_b64_tr_b16 a[166:167], v7 offset:14336
  s_waitcnt vmcnt(24) lgkmcnt(0)
  s_barrier
  s_add_u32 m0, s41, 65536
  s_mov_b32 s42, 1572864
  buffer_load_dwordx4 v8, s[8:11], s42 offen nt lds
  s_add_u32 m0, s41, 69632
  s_mov_b32 s42, 1572864
  buffer_load_dwordx4 v9, s[8:11], s42 offen nt lds
  s_add_u32 m0, s41, 73728
  s_mov_b32 s42, 1605632
  buffer_load_dwordx4 v8, s[8:11], s42 offen nt lds
  s_add_u32 m0, s41, 77824
  s_mov_b32 s42, 1605632
  buffer_load_dwordx4 v9, s[8:11], s42 offen nt lds
  ds_read_b64_tr_b16 a[40:41], v7 offset:16384
  ds_read_b64_tr_b16 a[42:43], v7 offset:18432
  ds_read_b64_tr_b16 a[168:169], v7 offset:20480
  ds_read_b64_tr_b16 a[170:171], v7 offset:22528
  ds_read_b64_tr_b16 a[44:45], v7 offset:24576
  ds_read_b64_tr_b16 a[46:47], v7 offset:26624
  ds_read_b64_tr_b16 a[172:173], v7 offset:28672
  ds_read_b64_tr_b16 a[174:175], v7 offset:30720
  s_waitcnt vmcnt(24) lgkmcnt(0)
  s_barrier
  s_add_u32 m0, s41, 81920
  s_mov_b32 s42, 1638400
  buffer_load_dwordx4 v8, s[8:11], s42 offen nt lds
  s_add_u32 m0, s41, 86016
  s_mov_b32 s42, 1638400
  buffer_load_dwordx4 v9, s[8:11], s42 offen nt lds
  s_add_u32 m0, s41, 90112
  s_mov_b32 s42, 1671168
  buffer_load_dwordx4 v8, s[8:11], s42 offen nt lds
  s_add_u32 m0, s41, 94208
  s_mov_b32 s42, 1671168
  buffer_load_dwordx4 v9, s[8:11], s42 offen nt lds
  ds_read_b64_tr_b16 a[48:49], v7 offset:32768
  ds_read_b64_tr_b16 a[50:51], v7 offset:34816
  ds_read_b64_tr_b16 a[176:177], v7 offset:36864
  ds_read_b64_tr_b16 a[178:179], v7 offset:38912
  ds_read_b64_tr_b16 a[52:53], v7 offset:40960
  ds_read_b64_tr_b16 a[54:55], v7 offset:43008
  ds_read_b64_tr_b16 a[180:181], v7 offset:45056
  ds_read_b64_tr_b16 a[182:183], v7 offset:47104
  s_waitcnt vmcnt(24) lgkmcnt(0)
  s_barrier
  s_add_u32 m0, s41, 98304
  s_mov_b32 s42, 1835008
  buffer_load_dwordx4 v8, s[8:11], s42 offen nt lds
  s_add_u32 m0, s41, 102400
  s_mov_b32 s42, 1835008
  buffer_load_dwordx4 v9, s[8:11], s42 offen nt lds
  s_add_u32 m0, s41, 106496
  s_mov_b32 s42, 1867776
  buffer_load_dwordx4 v8, s[8:11], s42 offen nt lds
  s_add_u32 m0, s41, 110592
  s_mov_b32 s42, 1867776
  buffer_load_dwordx4 v9, s[8:11], s42 offen nt lds
  ds_read_b64_tr_b16 a[56:57], v7 offset:49152
  ds_read_b64_tr_b16 a[58:59], v7 offset:51200
  ds_read_b64_tr_b16 a[184:185], v7 offset:53248
  ds_read_b64_tr_b16 a[186:187], v7 offset:55296
  ds_read_b64_tr_b16 a[60:61], v7 offset:57344
  ds_read_b64_tr_b16 a[62:63], v7 offset:59392
  ds_read_b64_tr_b16 a[188:189], v7 offset:61440
  ds_read_b64_tr_b16 a[190:191], v7 offset:63488
  s_waitcnt vmcnt(24) lgkmcnt(0)
  s_barrier
  s_add_u32 m0, s41, 114688
  s_mov_b32 s42, 1900544
  buffer_load_dwordx4 v8, s[8:11], s42 offen nt lds
  s_add_u32 m0, s41, 118784
  s_mov_b32 s42, 1900544
  buffer_load_dwordx4 v9, s[8:11], s42 offen nt lds
  s_add_u32 m0, s41, 122880
  s_mov_b32 s42, 1933312
  buffer_load_dwordx4 v8, s[8:11], s42 offen nt lds
  s_add_u32 m0, s41, 126976
  s_mov_b32 s42, 1933312
  buffer_load_dwordx4 v9, s[8:11], s42 offen nt lds
  ds_read_b64_tr_b16 a[64:65], v6 offset:0
  ds_read_b64_tr_b16 a[66:67], v6 offset:2048
  ds_read_b64_tr_b16 a[192:193], v6 offset:4096
  ds_read_b64_tr_b16 a[194:195], v6 offset:6144
  ds_read_b64_tr_b16 a[68:69], v6 offset:8192
  ds_read_b64_tr_b16 a[70:71], v6 offset:10240
  ds_read_b64_tr_b16 a[196:197], v6 offset:12288
  ds_read_b64_tr_b16 a[198:199], v6 offset:14336
  s_waitcnt vmcnt(24) lgkmcnt(0)
  s_barrier
  ds_read_b64_tr_b16 a[72:73], v6 offset:16384
  ds_read_b64_tr_b16 a[74:75], v6 offset:18432
  ds_read_b64_tr_b16 a[200:201], v6 offset:20480
  ds_read_b64_tr_b16 a[202:203], v6 offset:22528
  ds_read_b64_tr_b16 a[76:77], v6 offset:24576
  ds_read_b64_tr_b16 a[78:79], v6 offset:26624
  ds_read_b64_tr_b16 a[204:205], v6 offset:28672
  ds_read_b64_tr_b16 a[206:207], v6 offset:30720
  s_waitcnt vmcnt(20) lgkmcnt(0)
  s_barrier
  ds_read_b64_tr_b16 a[80:81], v6 offset:32768
  ds_read_b64_tr_b16 a[82:83], v6 offset:34816
  ds_read_b64_tr_b16 a[208:209], v6 offset:36864
  ds_read_b64_tr_b16 a[210:211], v6 offset:38912
  ds_read_b64_tr_b16 a[84:85], v6 offset:40960
  ds_read_b64_tr_b16 a[86:87], v6 offset:43008
  ds_read_b64_tr_b16 a[212:213], v6 offset:45056
  ds_read_b64_tr_b16 a[214:215], v6 offset:47104
  s_waitcnt vmcnt(16) lgkmcnt(0)
  s_barrier
  ds_read_b64_tr_b16 a[88:89], v6 offset:49152
  ds_read_b64_tr_b16 a[90:91], v6 offset:51200
  ds_read_b64_tr_b16 a[216:217], v6 offset:53248
  ds_read_b64_tr_b16 a[218:219], v6 offset:55296
  ds_read_b64_tr_b16 a[92:93], v6 offset:57344
  ds_read_b64_tr_b16 a[94:95], v6 offset:59392
  ds_read_b64_tr_b16 a[220:221], v6 offset:61440
  ds_read_b64_tr_b16 a[222:223], v6 offset:63488
  s_waitcnt vmcnt(12) lgkmcnt(0)
  s_barrier
  ds_read_b64_tr_b16 a[96:97], v7 offset:0
  ds_read_b64_tr_b16 a[98:99], v7 offset:2048
  ds_read_b64_tr_b16 a[224:225], v7 offset:4096
  ds_read_b64_tr_b16 a[226:227], v7 offset:6144
  ds_read_b64_tr_b16 a[100:101], v7 offset:8192
  ds_read_b64_tr_b16 a[102:103], v7 offset:10240
  ds_read_b64_tr_b16 a[228:229], v7 offset:12288
  ds_read_b64_tr_b16 a[230:231], v7 offset:14336
  s_waitcnt vmcnt(8) lgkmcnt(0)
  s_barrier
  ds_read_b64_tr_b16 a[104:105], v7 offset:16384
  ds_read_b64_tr_b16 a[106:107], v7 offset:18432
  ds_read_b64_tr_b16 a[232:233], v7 offset:20480
  ds_read_b64_tr_b16 a[234:235], v7 offset:22528
  ds_read_b64_tr_b16 a[108:109], v7 offset:24576
  ds_read_b64_tr_b16 a[110:111], v7 offset:26624
  ds_read_b64_tr_b16 a[236:237], v7 offset:28672
  ds_read_b64_tr_b16 a[238:239], v7 offset:30720
  s_waitcnt vmcnt(4) lgkmcnt(0)
  s_barrier
  ds_read_b64_tr_b16 a[112:113], v7 offset:32768
  ds_read_b64_tr_b16 a[114:115], v7 offset:34816
  ds_read_b64_tr_b16 a[240:241], v7 offset:36864
  ds_read_b64_tr_b16 a[242:243], v7 offset:38912
  ds_read_b64_tr_b16 a[116:117], v7 offset:40960
  ds_read_b64_tr_b16 a[118:119], v7 offset:43008
  ds_read_b64_tr_b16 a[244:245], v7 offset:45056
  ds_read_b64_tr_b16 a[246:247], v7 offset:47104
  s_waitcnt vmcnt(0) lgkmcnt(0)
  s_barrier
  ds_read_b64_tr_b16 a[120:121], v7 offset:49152
  ds_read_b64_tr_b16 a[122:123], v7 offset:51200
  ds_read_b64_tr_b16 a[248:249], v7 offset:53248
  ds_read_b64_tr_b16 a[250:251], v7 offset:55296
  ds_read_b64_tr_b16 a[124:125], v7 offset:57344
  ds_read_b64_tr_b16 a[126:127], v7 offset:59392
  ds_read_b64_tr_b16 a[252:253], v7 offset:61440
  ds_read_b64_tr_b16 a[254:255], v7 offset:63488
  s_waitcnt lgkmcnt(0)
  s_barrier
  s_and_b32 s43, s21, 24
  v_min_u32 v2, 7, v0
  v_add_u32 v2, s43, v2
  v_lshlrev_b32 v2, 7, v2
  v_add_u32 v2, 1404928, v2
  s_lshl_b32 s62, s21, 7
  s_add_u32 s62, s62, 1409024
  v_min_u32 v52, 63, v0
  v_lshlrev_b32 v52, 7, v52
  v_add_u32 v52, 1424384, v52
  s_nop 1
Lpoll_134:
  buffer_load_dword v53, v52, s[4:7], 0 offen sc1
  s_sub_u32 s24, s24, 1
  s_cbranch_scc1 L_FAIL
  s_waitcnt vmcnt(0)
  v_cmp_gt_i32 vcc, 0, v53
  s_cbranch_vccz Lpolld_135
  s_sleep 1
  s_branch Lpoll_134
Lpolld_135:
Ltab_133:
  v_lshrrev_b32 v53, 8, v53
  v_and_b32 v54, 3, v0
  v_lshl_or_b32 v53, v53, 2, v54
  s_nop 1
  v_min_u32_dpp v53, v53, v53 row_ror:8 row_mask:0xf bank_mask:0xf
  s_nop 1
  v_min_u32_dpp v53, v53, v53 row_ror:4 row_mask:0xf bank_mask:0xf
  v_mov_b32 v54, v53
  s_nop 1
  v_permlane16_swap_b32 v54, v53
  v_min_u32 v53, v53, v54
  v_mov_b32 v54, v53
  s_nop 1
  v_permlane32_swap_b32 v54, v53
  v_min_u32 v53, v53, v54
  s_nop 1
  v_min_u32_dpp v53, v53, v53 row_ror:2 row_mask:0xf bank_mask:0xf
  s_nop 1
  v_min_u32_dpp v53, v53, v53 row_ror:1 row_mask:0xf bank_mask:0xf
  s_nop 0
  v_readfirstlane_b32 s38, v53
  s_and_b32 s38, s38, 3
  s_lshl_b32 s38, s38, 13
  s_and_b32 s38, s38, 0x2000
  s_xor_b32 s38, s38, 20979712
  s_xor_b32 s27, s38, 0x2000
  s_lshr_b32 s40, s20, 1
  s_add_u32 s40, s40, s43
  s_mul_i32 s40, s40, 65536
  s_and_b32 s41, s20, 1
  s_lshl_b32 s41, s41, 12
  s_add_u32 s40, s40, s41
  s_add_u32 s40, s40, 49152
  s_add_u32 s27, s27, s40
  s_lshl_b32 s40, s21, 14
  s_add_u32 s40, s40, s38
  s_add_u32 s31, s40, 0
  s_lshl_b32 s40, s20, 11
  v_and_b32 v68, 3, v0
  v_lshlrev_b32 v68, 4, v68
  v_lshrrev_b32 v52, 4, v0
  v_lshl_add_u32 v68, v52, 6, v68
  v_bfe_u32 v52, v0, 2, 2
  v_lshl_add_u32 v68, v52, 8, v68
  v_add_u32 v68, s40, v68
  v_lshlrev_b32 v71, 2, v0
  v_add_u32 v71, 131072, v71
  s_mov_b32 s25, 0
  s_mov_b32 s26, 0
  s_mov_b32 s29, 1
  s_mov_b32 s30, 0
  s_mov_b32 s28, 0
L_WO_top:
  s_cmp_eq_u32 s28, 1
  s_cbranch_scc1 L_WO_go
  s_cmp_eq_u32 s28, 2
  s_cbranch_scc1 L_WO_mid
  s_cmp_lg_u32 s20, 0
  s_cbranch_scc1 L_WO_park
  buffer_load_dword v3, v2, s[4:7], s30 offen sc1
  s_waitcnt vmcnt(1)
  s_barrier
  s_mov_b32 s63, s25
  s_atomic_smax s63, s[4:5], s62 glc
Lnosig_136:
  s_cmp_ge_u32 s25, 64
  s_cbranch_scc1 L_END
  s_waitcnt vmcnt(0)
  v_cmp_gt_i32 vcc, s29, v3
  s_cbranch_vccz L_WO_issue
  s_nop 3
Lpoll_137:
  buffer_load_dword v3, v2, s[4:7], s30 offen sc1
  s_sub_u32 s24, s24, 1
  s_cbranch_scc1 L_FAIL
  s_waitcnt vmcnt(0)
  v_cmp_gt_i32 vcc, s29, v3
  s_cbranch_vccz Lpolld_138
  s_sleep 1
  s_branch Lpoll_137
Lpolld_138:
  s_branch L_WO_issue
L_WO_park:
  s_waitcnt vmcnt(0)
  s_barrier
  s_cmp_ge_u32 s25, 64
  s_cbranch_scc1 L_END
L_WO_issue:
  s_barrier
L_WO_mid:
  s_mov_b32 s34, s26
  s_mov_b32 s35, s27
  s_add_u32 s36, s32, 0
  s_add_u32 m0, s34, s36
  s_add_u32 s36, s35, 0
  buffer_load_dwordx4 v1, s[4:7], s36 offen offset:0 sc1 lds
  s_nop 0
  buffer_load_dwordx4 v1, s[4:7], s36 offen offset:1024 sc1 lds
  s_nop 0
  buffer_load_dwordx4 v1, s[4:7], s36 offen offset:2048 sc1 lds
  s_nop 0
  buffer_load_dwordx4 v1, s[4:7], s36 offen offset:3072 sc1 lds
  s_nop 0
  s_add_u32 s36, s32, 16384
  s_add_u32 m0, s34, s36
  s_add_u32 s36, s35, 131072
  buffer_load_dwordx4 v1, s[4:7], s36 offen offset:0 sc1 lds
  s_nop 0
  buffer_load_dwordx4 v1, s[4:7], s36 offen offset:1024 sc1 lds
  s_nop 0
  buffer_load_dwordx4 v1, s[4:7], s36 offen offset:2048 sc1 lds
  s_nop 0
  buffer_load_dwordx4 v1, s[4:7], s36 offen offset:3072 sc1 lds
  s_nop 0
  s_add_u32 s36, s32, 32768
  s_add_u32 m0, s34, s36
  s_add_u32 s36, s35, 262144
  buffer_load_dwordx4 v1, s[4:7], s36 offen offset:0 sc1 lds
  s_nop 0
  buffer_load_dwordx4 v1, s[4:7], s36 offen offset:1024 sc1 lds
  s_nop 0
  buffer_load_dwordx4 v1, s[4:7], s36 offen offset:2048 sc1 lds
  s_nop 0
  buffer_load_dwordx4 v1, s[4:7], s36 offen offset:3072 sc1 lds
  s_nop 0
  s_cmp_eq_u32 s28, 0
  s_cbranch_scc1 L_WO_go
  s_mov_b32 s28, 0
  s_waitcnt vmcnt(12)
  s_barrier
  s_cmp_lg_u32 s20, 0
  s_cbranch_scc1 Lnosig_139
  s_mov_b32 s63, s25
  s_atomic_smax s63, s[4:5], s62 glc
Lnosig_139:
L_WO_go:
  v_add_u32 v73, s26, v69
  v_add_u32 v74, s26, v70
  s_sub_u32 s26, 65536, s26
  s_add_u32 s27, s27, 2097152
  s_xor_b32 s27, s27, 0x2000
  s_add_u32 s29, s29, 1
  s_waitcnt vmcnt(8)
  s_barrier
  ds_read_b128 v[4:7], v73 offset:0
  ds_read_b128 v[8:11], v73 offset:1024
  ds_read_b128 v[12:15], v73 offset:2048
  ds_read_b128 v[16:19], v73 offset:3072
  ds_read_b128 v[20:23], v73 offset:4096
  ds_read_b128 v[24:27], v73 offset:5120
  s_waitcnt lgkmcnt(4)
  v_mfma_f32_16x16x32_bf16 v[36:39], a[0:3], v[4:7], 0
  ds_read_b128 v[28:31], v73 offset:6144
  v_mfma_f32_16x16x32_bf16 v[40:43], a[0:3], v[8:11], 0
  ds_read_b128 v[32:35], v73 offset:7168
  v_mfma_f32_16x16x32_bf16 v[44:47], a[128:131], v[4:7], 0
  s_add_u32 s36, s32, 49152
  s_add_u32 m0, s34, s36
  s_add_u32 s36, s35, 393216
  buffer_load_dwordx4 v1, s[4:7], s36 offen offset:0 sc1 lds
  v_mfma_f32_16x16x32_bf16 v[48:51], a[128:131], v[8:11], 0
  s_waitcnt lgkmcnt(4)
  v_mfma_f32_16x16x32_bf16 v[36:39], a[4:7], v[12:15], v[36:39]
  ds_read_b128 v[4:7], v73 offset:8192
  v_mfma_f32_16x16x32_bf16 v[40:43], a[4:7], v[16:19], v[40:43]
  ds_read_b128 v[8:11], v73 offset:9216
  v_mfma_f32_16x16x32_bf16 v[44:47], a[132:135], v[12:15], v[44:47]
  buffer_load_dwordx4 v1, s[4:7], s36 offen offset:1024 sc1 lds
  v_mfma_f32_16x16x32_bf16 v[48:51], a[132:135], v[16:19], v[48:51]
  s_waitcnt lgkmcnt(4)
  v_mfma_f32_16x16x32_bf16 v[36:39], a[8:11], v[20:23], v[36:39]
  ds_read_b128 v[12:15], v73 offset:10240
  v_mfma_f32_16x16x32_bf16 v[40:43], a[8:11], v[24:27], v[40:43]
  ds_read_b128 v[16:19], v73 offset:11264
  v_mfma_f32_16x16x32_bf16 v[44:47], a[136:139], v[20:23], v[44:47]
  buffer_load_dwordx4 v1, s[4:7], s36 offen offset:2048 sc1 lds
  v_mfma_f32_16x16x32_bf16 v[48:51], a[136:139], v[24:27], v[48:51]
  s_waitcnt lgkmcnt(4)
  v_mfma_f32_16x16x32_bf16 v[36:39], a[12:15], v[28:31], v[36:39]
  ds_read_b128 v[20:23], v73 offset:12288
  v_mfma_f32_16x16x32_bf16 v[40:43], a[12:15], v[32:35], v[40:43]
  ds_read_b128 v[24:27], v73 offset:13312
  v_mfma_f32_16x16x32_bf16 v[44:47], a[140:143], v[28:31], v[44:47]
  buffer_load_dwordx4 v1, s[4:7], s36 offen offset:3072 sc1 lds
  v_mfma_f32_16x16x32_bf16 v[48:51], a[140:143], v[32:35], v[48:51]
  s_waitcnt lgkmcnt(4)
  v_mfma_f32_16x16x32_bf16 v[36:39], a[16:19], v[4:7], v[36:39]
  ds_read_b128 v[28:31], v73 offset:14336
  v_mfma_f32_16x16x32_bf16 v[40:43], a[16:19], v[8:11], v[40:43]
  ds_read_b128 v[32:35], v73 offset:15360
  v_mfma_f32_16x16x32_bf16 v[44:47], a[144:147], v[4:7], v[44:47]
  v_mfma_f32_16x16x32_bf16 v[48:51], a[144:147], v[8:11], v[48:51]
  s_waitcnt vmcnt(8)
  s_barrier
  s_mov_b32 s34, s26
  s_mov_b32 s35, s27
  s_waitcnt lgkmcnt(4)
  v_mfma_f32_16x16x32_bf16 v[36:39], a[20:23], v[12:15], v[36:39]
  ds_read_b128 v[4:7], v73 offset:16384
  v_mfma_f32_16x16x32_bf16 v[40:43], a[20:23], v[16:19], v[40:43]
  ds_read_b128 v[8:11], v73 offset:17408
  v_mfma_f32_16x16x32_bf16 v[44:47], a[148:151], v[12:15], v[44:47]
  v_mfma_f32_16x16x32_bf16 v[48:51], a[148:151], v[16:19], v[48:51]
  s_waitcnt lgkmcnt(4)
  v_mfma_f32_16x16x32_bf16 v[36:39], a[24:27], v[20:23], v[36:39]
  ds_read_b128 v[12:15], v73 offset:18432
  v_mfma_f32_16x16x32_bf16 v[40:43], a[24:27], v[24:27], v[40:43]
  ds_read_b128 v[16:19], v73 offset:19456
  v_mfma_f32_16x16x32_bf16 v[44:47], a[152:155], v[20:23], v[44:47]
  v_mfma_f32_16x16x32_bf16 v[48:51], a[152:155], v[24:27], v[48:51]
  s_waitcnt lgkmcnt(4)
  v_mfma_f32_16x16x32_bf16 v[36:39], a[28:31], v[28:31], v[36:39]
  ds_read_b128 v[20:23], v73 offset:20480
  v_mfma_f32_16x16x32_bf16 v[40:43], a[28:31], v[32:35], v[40:43]
  ds_read_b128 v[24:27], v73 offset:21504
  v_mfma_f32_16x16x32_bf16 v[44:47], a[156:159], v[28:31], v[44:47]
  v_mfma_f32_16x16x32_bf16 v[48:51], a[156:159], v[32:35], v[48:51]
  s_waitcnt lgkmcnt(4)
  v_mfma_f32_16x16x32_bf16 v[36:39], a[32:35], v[4:7], v[36:39]
  ds_read_b128 v[28:31], v73 offset:22528
  v_mfma_f32_16x16x32_bf16 v[40:43], a[32:35], v[8:11], v[40:43]
  ds_read_b128 v[32:35], v73 offset:23552
  v_mfma_f32_16x16x32_bf16 v[44:47], a[160:163], v[4:7], v[44:47]
  v_mfma_f32_16x16x32_bf16 v[48:51], a[160:163], v[8:11], v[48:51]
  s_waitcnt lgkmcnt(4)
  v_mfma_f32_16x16x32_bf16 v[36:39], a[36:39], v[12:15], v[36:39]
  ds_read_b128 v[4:7], v73 offset:24576
  v_mfma_f32_16x16x32_bf16 v[40:43], a[36:39], v[16:19], v[40:43]
  ds_read_b128 v[8:11], v73 offset:25600
  v_mfma_f32_16x16x32_bf16 v[44:47], a[164:167], v[12:15], v[44:47]
  v_mfma_f32_16x16x32_bf16 v[48:51], a[164:167], v[16:19], v[48:51]
  s_waitcnt lgkmcnt(4)
  v_mfma_f32_16x16x32_bf16 v[36:39], a[40:43], v[20:23], v[36:39]
  ds_read_b128 v[12:15], v73 offset:26624
  v_mfma_f32_16x16x32_bf16 v[40:43], a[40:43], v[24:27], v[40:43]
  ds_read_b128 v[16:19], v73 offset:27648
  v_mfma_f32_16x16x32_bf16 v[44:47], a[168:171], v[20:23], v[44:47]
  v_mfma_f32_16x16x32_bf16 v[48:51], a[168:171], v[24:27], v[48:51]
  s_waitcnt lgkmcnt(4)
  v_mfma_f32_16x16x32_bf16 v[36:39], a[44:47], v[28:31], v[36:39]
  ds_read_b128 v[20:23], v73 offset:28672
  v_mfma_f32_16x16x32_bf16 v[40:43], a[44:47], v[32:35], v[40:43]
  ds_read_b128 v[24:27], v73 offset:29696
  v_mfma_f32_16x16x32_bf16 v[44:47], a[172:175], v[28:31], v[44:47]
  v_mfma_f32_16x16x32_bf16 v[48:51], a[172:175], v[32:35], v[48:51]
  s_lshl_b32 s40, s20, 8
  s_add_u32 m0, s40, 131072
  s_cmp_eq_u32 s20, 0
  s_cselect_b32 s40, s30, 2147483392
  buffer_load_dword v2, s[4:7], s40 offen sc1 lds
  s_waitcnt lgkmcnt(4)
  v_mfma_f32_16x16x32_bf16 v[36:39], a[48:51], v[4:7], v[36:39]
  ds_read_b128 v[28:31], v73 offset:30720
  v_mfma_f32_16x16x32_bf16 v[40:43], a[48:51], v[8:11], v[40:43]
  ds_read_b128 v[32:35], v73 offset:31744
  v_mfma_f32_16x16x32_bf16 v[44:47], a[176:179], v[4:7], v[44:47]
  v_mfma_f32_16x16x32_bf16 v[48:51], a[176:179], v[8:11], v[48:51]
  s_waitcnt vmcnt(5)
  s_barrier
  s_lshl_b32 s40, s20, 1
  s_add_u32 s40, s40, 1
  s_cmp_lg_u32 s40, s28
  s_cbranch_scc1 L_WO_s2
  s_mov_b32 s63, s25
  s_atomic_smax s63, s[4:5], s62 glc
Lnosig_140:
L_WO_s2:
  s_waitcnt lgkmcnt(4)
  v_mfma_f32_16x16x32_bf16 v[36:39], a[52:55], v[12:15], v[36:39]
  ds_read_b128 v[4:7], v73 offset:32768
  v_mfma_f32_16x16x32_bf16 v[40:43], a[52:55], v[16:19], v[40:43]
  ds_read_b128 v[8:11], v73 offset:33792
  v_mfma_f32_16x16x32_bf16 v[44:47], a[180:183], v[12:15], v[44:47]
  v_mfma_f32_16x16x32_bf16 v[48:51], a[180:183], v[16:19], v[48:51]
  s_waitcnt lgkmcnt(4)
  v_mfma_f32_16x16x32_bf16 v[36:39], a[56:59], v[20:23], v[36:39]
  ds_read_b128 v[12:15], v73 offset:34816
  v_mfma_f32_16x16x32_bf16 v[40:43], a[56:59], v[24:27], v[40:43]
  ds_read_b128 v[16:19], v73 offset:35840
  v_mfma_f32_16x16x32_bf16 v[44:47], a[184:187], v[20:23], v[44:47]
  v_mfma_f32_16x16x32_bf16 v[48:51], a[184:187], v[24:27], v[48:51]
  s_waitcnt lgkmcnt(4)
  v_mfma_f32_16x16x32_bf16 v[36:39], a[60:63], v[28:31], v[36:39]
  ds_read_b128 v[20:23], v73 offset:36864
  v_mfma_f32_16x16x32_bf16 v[40:43], a[60:63], v[32:35], v[40:43]
  ds_read_b128 v[24:27], v73 offset:37888
  v_mfma_f32_16x16x32_bf16 v[44:47], a[188:191], v[28:31], v[44:47]
  v_mfma_f32_16x16x32_bf16 v[48:51], a[188:191], v[32:35], v[48:51]
  s_waitcnt lgkmcnt(4)
  v_mfma_f32_16x16x32_bf16 v[36:39], a[64:67], v[4:7], v[36:39]
  ds_read_b128 v[28:31], v73 offset:38912
  v_mfma_f32_16x16x32_bf16 v[40:43], a[64:67], v[8:11], v[40:43]
  ds_read_b128 v[32:35], v73 offset:39936
  v_mfma_f32_16x16x32_bf16 v[44:47], a[192:195], v[4:7], v[44:47]
  v_mfma_f32_16x16x32_bf16 v[48:51], a[192:195], v[8:11], v[48:51]
  s_waitcnt lgkmcnt(4)
  v_mfma_f32_16x16x32_bf16 v[36:39], a[68:71], v[12:15], v[36:39]
  ds_read_b128 v[4:7], v73 offset:40960
  v_mfma_f32_16x16x32_bf16 v[40:43], a[68:71], v[16:19], v[40:43]
  ds_read_b128 v[8:11], v73 offset:41984
  v_mfma_f32_16x16x32_bf16 v[44:47], a[196:199], v[12:15], v[44:47]
  v_mfma_f32_16x16x32_bf16 v[48:51], a[196:199], v[16:19], v[48:51]
  s_waitcnt lgkmcnt(4)
  v_mfma_f32_16x16x32_bf16 v[36:39], a[72:75], v[20:23], v[36:39]
  ds_read_b128 v[12:15], v73 offset:43008
  v_mfma_f32_16x16x32_bf16 v[40:43], a[72:75], v[24:27], v[40:43]
  ds_read_b128 v[16:19], v73 offset:44032
  v_mfma_f32_16x16x32_bf16 v[44:47], a[200:203], v[20:23], v[44:47]
  v_mfma_f32_16x16x32_bf16 v[48:51], a[200:203], v[24:27], v[48:51]
  s_waitcnt vmcnt(0)
  s_barrier
  ds_read_b32 v3, v71
  s_waitcnt lgkmcnt(4)
  v_mfma_f32_16x16x32_bf16 v[36:39], a[76:79], v[28:31], v[36:39]
  ds_read_b128 v[20:23], v73 offset:45056
  v_mfma_f32_16x16x32_bf16 v[40:43], a[76:79], v[32:35], v[40:43]
  ds_read_b128 v[24:27], v73 offset:46080
  v_mfma_f32_16x16x32_bf16 v[44:47], a[204:207], v[28:31], v[44:47]
  v_mfma_f32_16x16x32_bf16 v[48:51], a[204:207], v[32:35], v[48:51]
  s_waitcnt lgkmcnt(4)
  v_mfma_f32_16x16x32_bf16 v[36:39], a[80:83], v[4:7], v[36:39]
  ds_read_b128 v[28:31], v73 offset:47104
  v_mfma_f32_16x16x32_bf16 v[40:43], a[80:83], v[8:11], v[40:43]
  ds_read_b128 v[32:35], v73 offset:48128
  v_mfma_f32_16x16x32_bf16 v[44:47], a[208:211], v[4:7], v[44:47]
  v_mfma_f32_16x16x32_bf16 v[48:51], a[208:211], v[8:11], v[48:51]
  s_waitcnt lgkmcnt(4)
  v_cmp_gt_i32 vcc, s29, v3
  s_mov_b32 s28, 0
  s_cbranch_vccnz L_WO_nopf
  s_cmp_ge_u32 s25, 63
  s_cbranch_scc1 L_WO_nopf
  s_mov_b32 s28, 1
  s_waitcnt lgkmcnt(4)
  v_mfma_f32_16x16x32_bf16 v[36:39], a[84:87], v[12:15], v[36:39]
  ds_read_b128 v[4:7], v73 offset:49152
  v_mfma_f32_16x16x32_bf16 v[40:43], a[84:87], v[16:19], v[40:43]
  ds_read_b128 v[8:11], v73 offset:50176
  v_mfma_f32_16x16x32_bf16 v[44:47], a[212:215], v[12:15], v[44:47]
  s_add_u32 s36, s32, 0
  s_add_u32 m0, s34, s36
  s_add_u32 s36, s35, 0
  buffer_load_dwordx4 v1, s[4:7], s36 offen offset:0 sc1 lds
  v_mfma_f32_16x16x32_bf16 v[48:51], a[212:215], v[16:19], v[48:51]
  buffer_load_dwordx4 v1, s[4:7], s36 offen offset:1024 sc1 lds
  s_waitcnt lgkmcnt(4)
  v_mfma_f32_16x16x32_bf16 v[36:39], a[88:91], v[20:23], v[36:39]
  ds_read_b128 v[12:15], v73 offset:51200
  v_mfma_f32_16x16x32_bf16 v[40:43], a[88:91], v[24:27], v[40:43]
  ds_read_b128 v[16:19], v73 offset:52224
  v_mfma_f32_16x16x32_bf16 v[44:47], a[216:219], v[20:23], v[44:47]
  buffer_load_dwordx4 v1, s[4:7], s36 offen offset:2048 sc1 lds
  v_mfma_f32_16x16x32_bf16 v[48:51], a[216:219], v[24:27], v[48:51]
  buffer_load_dwordx4 v1, s[4:7], s36 offen offset:3072 sc1 lds
  s_waitcnt lgkmcnt(4)
  v_mfma_f32_16x16x32_bf16 v[36:39], a[92:95], v[28:31], v[36:39]
  ds_read_b128 v[20:23], v73 offset:53248
  v_mfma_f32_16x16x32_bf16 v[40:43], a[92:95], v[32:35], v[40:43]
  ds_read_b128 v[24:27], v73 offset:54272
  v_mfma_f32_16x16x32_bf16 v[44:47], a[220:223], v[28:31], v[44:47]
  s_add_u32 s36, s32, 16384
  s_add_u32 m0, s34, s36
  s_add_u32 s36, s35, 131072
  buffer_load_dwordx4 v1, s[4:7], s36 offen offset:0 sc1 lds
  v_mfma_f32_16x16x32_bf16 v[48:51], a[220:223], v[32:35], v[48:51]
  buffer_load_dwordx4 v1, s[4:7], s36 offen offset:1024 sc1 lds
  s_waitcnt lgkmcnt(4)
  v_mfma_f32_16x16x32_bf16 v[36:39], a[96:99], v[4:7], v[36:39]
  ds_read_b128 v[28:31], v73 offset:55296
  v_mfma_f32_16x16x32_bf16 v[40:43], a[96:99], v[8:11], v[40:43]
  ds_read_b128 v[32:35], v73 offset:56320
  v_mfma_f32_16x16x32_bf16 v[44:47], a[224:227], v[4:7], v[44:47]
  buffer_load_dwordx4 v1, s[4:7], s36 offen offset:2048 sc1 lds
  v_mfma_f32_16x16x32_bf16 v[48:51], a[224:227], v[8:11], v[48:51]
  buffer_load_dwordx4 v1, s[4:7], s36 offen offset:3072 sc1 lds
  s_waitcnt lgkmcnt(4)
  v_mfma_f32_16x16x32_bf16 v[36:39], a[100:103], v[12:15], v[36:39]
  ds_read_b128 v[4:7], v73 offset:57344
  v_mfma_f32_16x16x32_bf16 v[40:43], a[100:103], v[16:19], v[40:43]
  ds_read_b128 v[8:11], v73 offset:58368
  v_mfma_f32_16x16x32_bf16 v[44:47], a[228:231], v[12:15], v[44:47]
  s_add_u32 s36, s32, 32768
  s_add_u32 m0, s34, s36
  s_add_u32 s36, s35, 262144
  buffer_load_dwordx4 v1, s[4:7], s36 offen offset:0 sc1 lds
  v_mfma_f32_16x16x32_bf16 v[48:51], a[228:231], v[16:19], v[48:51]
  buffer_load_dwordx4 v1, s[4:7], s36 offen offset:1024 sc1 lds
  s_waitcnt lgkmcnt(4)
  v_mfma_f32_16x16x32_bf16 v[36:39], a[104:107], v[20:23], v[36:39]
  ds_read_b128 v[12:15], v73 offset:59392
  v_mfma_f32_16x16x32_bf16 v[40:43], a[104:107], v[24:27], v[40:43]
  ds_read_b128 v[16:19], v73 offset:60416
  v_mfma_f32_16x16x32_bf16 v[44:47], a[232:235], v[20:23], v[44:47]
  buffer_load_dwordx4 v1, s[4:7], s36 offen offset:2048 sc1 lds
  v_mfma_f32_16x16x32_bf16 v[48:51], a[232:235], v[24:27], v[48:51]
  buffer_load_dwordx4 v1, s[4:7], s36 offen offset:3072 sc1 lds
  s_waitcnt lgkmcnt(4)
  v_mfma_f32_16x16x32_bf16 v[36:39], a[108:111], v[28:31], v[36:39]
  ds_read_b128 v[20:23], v73 offset:61440
  v_mfma_f32_16x16x32_bf16 v[40:43], a[108:111], v[32:35], v[40:43]
  ds_read_b128 v[24:27], v73 offset:62464
  v_mfma_f32_16x16x32_bf16 v[44:47], a[236:239], v[28:31], v[44:47]
  v_mfma_f32_16x16x32_bf16 v[48:51], a[236:239], v[32:35], v[48:51]
  s_waitcnt lgkmcnt(4)
  v_mfma_f32_16x16x32_bf16 v[36:39], a[112:115], v[4:7], v[36:39]
  ds_read_b128 v[28:31], v73 offset:63488
  v_mfma_f32_16x16x32_bf16 v[40:43], a[112:115], v[8:11], v[40:43]
  ds_read_b128 v[32:35], v73 offset:64512
  v_mfma_f32_16x16x32_bf16 v[44:47], a[240:243], v[4:7], v[44:47]
  v_mfma_f32_16x16x32_bf16 v[48:51], a[240:243], v[8:11], v[48:51]
  s_waitcnt lgkmcnt(4)
  v_mfma_f32_16x16x32_bf16 v[36:39], a[116:119], v[12:15], v[36:39]
  v_mfma_f32_16x16x32_bf16 v[40:43], a[116:119], v[16:19], v[40:43]
  v_mfma_f32_16x16x32_bf16 v[44:47], a[244:247], v[12:15], v[44:47]
  v_mfma_f32_16x16x32_bf16 v[48:51], a[244:247], v[16:19], v[48:51]
  s_waitcnt lgkmcnt(2)
  v_mfma_f32_16x16x32_bf16 v[36:39], a[120:123], v[20:23], v[36:39]
  v_mfma_f32_16x16x32_bf16 v[40:43], a[120:123], v[24:27], v[40:43]
  v_mfma_f32_16x16x32_bf16 v[44:47], a[248:251], v[20:23], v[44:47]
  v_mfma_f32_16x16x32_bf16 v[48:51], a[248:251], v[24:27], v[48:51]
  s_waitcnt lgkmcnt(0)
  v_mfma_f32_16x16x32_bf16 v[36:39], a[124:127], v[28:31], v[36:39]
  v_mfma_f32_16x16x32_bf16 v[40:43], a[124:127], v[32:35], v[40:43]
  v_mfma_f32_16x16x32_bf16 v[44:47], a[252:255], v[28:31], v[44:47]
  v_mfma_f32_16x16x32_bf16 v[48:51], a[252:255], v[32:35], v[48:51]
  s_nop 7
  s_branch L_WO_epi
L_WO_nopf:
  s_waitcnt lgkmcnt(4)
  v_mfma_f32_16x16x32_bf16 v[36:39], a[84:87], v[12:15], v[36:39]
  ds_read_b128 v[4:7], v73 offset:49152
  v_mfma_f32_16x16x32_bf16 v[40:43], a[84:87], v[16:19], v[40:43]
  ds_read_b128 v[8:11], v73 offset:50176
  v_mfma_f32_16x16x32_bf16 v[44:47], a[212:215], v[12:15], v[44:47]
  v_mfma_f32_16x16x32_bf16 v[48:51], a[212:215], v[16:19], v[48:51]
  s_waitcnt lgkmcnt(4)
  v_mfma_f32_16x16x32_bf16 v[36:39], a[88:91], v[20:23], v[36:39]
  ds_read_b128 v[12:15], v73 offset:51200
  v_mfma_f32_16x16x32_bf16 v[40:43], a[88:91], v[24:27], v[40:43]
  ds_read_b128 v[16:19], v73 offset:52224
  v_mfma_f32_16x16x32_bf16 v[44:47], a[216:219], v[20:23], v[44:47]
  v_mfma_f32_16x16x32_bf16 v[48:51], a[216:219], v[24:27], v[48:51]
  s_waitcnt lgkmcnt(4)
  v_mfma_f32_16x16x32_bf16 v[36:39], a[92:95], v[28:31], v[36:39]
  ds_read_b128 v[20:23], v73 offset:53248
  v_mfma_f32_16x16x32_bf16 v[40:43], a[92:95], v[32:35], v[40:43]
  ds_read_b128 v[24:27], v73 offset:54272
  v_mfma_f32_16x16x32_bf16 v[44:47], a[220:223], v[28:31], v[44:47]
  v_mfma_f32_16x16x32_bf16 v[48:51], a[220:223], v[32:35], v[48:51]
  s_barrier
  s_lshl_b32 s40, s20, 8
  s_add_u32 m0, s40, 131072
  s_cmp_eq_u32 s20, 0
  s_cselect_b32 s40, s30, 2147483392
  buffer_load_dword v2, s[4:7], s40 offen sc1 lds
  s_waitcnt lgkmcnt(4)
  v_mfma_f32_16x16x32_bf16 v[36:39], a[96:99], v[4:7], v[36:39]
  ds_read_b128 v[28:31], v73 offset:55296
  v_mfma_f32_16x16x32_bf16 v[40:43], a[96:99], v[8:11], v[40:43]
  ds_read_b128 v[32:35], v73 offset:56320
  v_mfma_f32_16x16x32_bf16 v[44:47], a[224:227], v[4:7], v[44:47]
  v_mfma_f32_16x16x32_bf16 v[48:51], a[224:227], v[8:11], v[48:51]
  s_waitcnt lgkmcnt(4)
  v_mfma_f32_16x16x32_bf16 v[36:39], a[100:103], v[12:15], v[36:39]
  ds_read_b128 v[4:7], v73 offset:57344
  v_mfma_f32_16x16x32_bf16 v[40:43], a[100:103], v[16:19], v[40:43]
  ds_read_b128 v[8:11], v73 offset:58368
  v_mfma_f32_16x16x32_bf16 v[44:47], a[228:231], v[12:15], v[44:47]
  v_mfma_f32_16x16x32_bf16 v[48:51], a[228:231], v[16:19], v[48:51]
  s_waitcnt lgkmcnt(4)
  v_mfma_f32_16x16x32_bf16 v[36:39], a[104:107], v[20:23], v[36:39]
  ds_read_b128 v[12:15], v73 offset:59392
  v_mfma_f32_16x16x32_bf16 v[40:43], a[104:107], v[24:27], v[40:43]
  ds_read_b128 v[16:19], v73 offset:60416
  v_mfma_f32_16x16x32_bf16 v[44:47], a[232:235], v[20:23], v[44:47]
  v_mfma_f32_16x16x32_bf16 v[48:51], a[232:235], v[24:27], v[48:51]
  s_waitcnt lgkmcnt(4)
  v_mfma_f32_16x16x32_bf16 v[36:39], a[108:111], v[28:31], v[36:39]
  ds_read_b128 v[20:23], v73 offset:61440
  v_mfma_f32_16x16x32_bf16 v[40:43], a[108:111], v[32:35], v[40:43]
  ds_read_b128 v[24:27], v73 offset:62464
  v_mfma_f32_16x16x32_bf16 v[44:47], a[236:239], v[28:31], v[44:47]
  v_mfma_f32_16x16x32_bf16 v[48:51], a[236:239], v[32:35], v[48:51]
  s_waitcnt lgkmcnt(4)
  v_mfma_f32_16x16x32_bf16 v[36:39], a[112:115], v[4:7], v[36:39]
  ds_read_b128 v[28:31], v73 offset:63488
  v_mfma_f32_16x16x32_bf16 v[40:43], a[112:115], v[8:11], v[40:43]
  ds_read_b128 v[32:35], v73 offset:64512
  v_mfma_f32_16x16x32_bf16 v[44:47], a[240:243], v[4:7], v[44:47]
  v_mfma_f32_16x16x32_bf16 v[48:51], a[240:243], v[8:11], v[48:51]
  s_waitcnt lgkmcnt(4)
  v_mfma_f32_16x16x32_bf16 v[36:39], a[116:119], v[12:15], v[36:39]
  v_mfma_f32_16x16x32_bf16 v[40:43], a[116:119], v[16:19], v[40:43]
  v_mfma_f32_16x16x32_bf16 v[44:47], a[244:247], v[12:15], v[44:47]
  v_mfma_f32_16x16x32_bf16 v[48:51], a[244:247], v[16:19], v[48:51]
  s_waitcnt vmcnt(0)
  s_barrier
  ds_read_b32 v3, v71
  s_waitcnt lgkmcnt(2)
  v_mfma_f32_16x16x32_bf16 v[36:39], a[120:123], v[20:23], v[36:39]
  v_mfma_f32_16x16x32_bf16 v[40:43], a[120:123], v[24:27], v[40:43]
  v_mfma_f32_16x16x32_bf16 v[44:47], a[248:251], v[20:23], v[44:47]
  v_mfma_f32_16x16x32_bf16 v[48:51], a[248:251], v[24:27], v[48:51]
  s_waitcnt lgkmcnt(0)
  v_mfma_f32_16x16x32_bf16 v[36:39], a[124:127], v[28:31], v[36:39]
  v_mfma_f32_16x16x32_bf16 v[40:43], a[124:127], v[32:35], v[40:43]
  v_mfma_f32_16x16x32_bf16 v[44:47], a[252:255], v[28:31], v[44:47]
  v_mfma_f32_16x16x32_bf16 v[48:51], a[252:255], v[32:35], v[48:51]
  v_cmp_gt_i32 vcc, s29, v3
  s_cmp_eq_u64 vcc, 0
  s_cselect_b32 s28, 2, 0
  s_cmp_lt_u32 s25, 63
  s_cselect_b32 s28, s28, 0
L_WO_epi:
  v_cvt_pk_bf16_f32 v52, v36, v37
  v_cvt_pk_bf16_f32 v53, v38, v39
  v_cvt_pk_bf16_f32 v54, v44, v45
  v_cvt_pk_bf16_f32 v55, v46, v47
  buffer_store_dwordx4 v[52:55], v68, s[4:7], s31 offen offset:0 sc1
  v_cvt_pk_bf16_f32 v56, v40, v41
  v_cvt_pk_bf16_f32 v57, v42, v43
  v_cvt_pk_bf16_f32 v58, v48, v49
  v_cvt_pk_bf16_f32 v59, v50, v51
  buffer_store_dwordx4 v[56:59], v68, s[4:7], s31 offen offset:1024 sc1
  s_add_u32 s25, s25, 1
  s_add_u32 s31, s31, 2097152
  s_xor_b32 s31, s31, 0x2000
  s_branch L_WO_top
L_F1:
  v_lshlrev_b32 v1, 4, v0
  s_lshl_b32 s32, s20, 12
  s_min_u32 s33, s32, 0x2000
  v_mov_b32 v69, v1
  v_add_u32 v70, 0x10000, v69
  v_and_b32 v1, 3, v0
  v_lshlrev_b32 v1, 4, v1
  v_lshrrev_b32 v52, 4, v0
  v_lshl_add_u32 v1, v52, 6, v1
  v_bfe_u32 v52, v0, 2, 2
  v_lshl_add_u32 v1, v52, 8, v1
  s_load_dwordx2 s[8:9], s[0:1], 64
  s_mov_b32 s10, 7340032
  s_mov_b32 s11, 0x20000
  s_waitcnt lgkmcnt(0)
  s_lshl_b32 s44, s21, 7
  v_bfe_u32 v4, v0, 5, 1
  v_mul_u32_u24 v4, 28672, v4
  v_bfe_u32 v5, v0, 4, 1
  v_mul_u32_u24 v5, 14336, v5
  v_add_u32 v4, v4, v5
  v_bfe_u32 v5, v0, 3, 1
  v_mul_u32_u24 v5, 7168, v5
  v_add_u32 v4, v4, v5
  v_lshrrev_b32 v5, 3, v0
  v_and_b32 v5, 6, v5
  v_xor_b32 v5, v5, v0
  v_and_b32 v5, 7, v5
  v_lshl_add_u32 v4, v5, 4, v4
  s_lshr_b32 s40, s20, 1
  s_mul_i32 s40, s40, 458752
  s_and_b32 s41, s20, 1
  s_mul_i32 s41, s41, 57344
  s_add_u32 s40, s40, s41
  v_add_u32 v4, s40, v4
  v_bfe_u32 v5, v0, 3, 2
  v_xor_b32 v5, s20, v5
  v_lshlrev_b32 v5, 5, v5
  v_lshrrev_b32 v6, 2, v0
  v_lshl_add_u32 v6, v6, 7, v5
  v_and_b32 v5, 3, v0
  v_lshl_add_u32 v6, v5, 3, v6
  v_add_u32 v7, 0x10000, v6
  v_add_u32 v8, s44, v4
  v_add_u32 v9, s44, v4
  s_lshl_b32 s41, s20, 10
  s_add_u32 m0, s41, 0
  s_mov_b32 s42, 0
  buffer_load_dwordx4 v8, s[8:11], s42 offen nt lds
  s_add_u32 m0, s41, 4096
  s_mov_b32 s42, 114688
  buffer_load_dwordx4 v8, s[8:11], s42 offen nt lds
  s_add_u32 m0, s41, 8192
  s_mov_b32 s42, 229376
  buffer_load_dwordx4 v8, s[8:11], s42 offen nt lds
  s_add_u32 m0, s41, 12288
  s_mov_b32 s42, 344064
  buffer_load_dwordx4 v8, s[8:11], s42 offen nt lds
  s_add_u32 m0, s41, 16384
  s_mov_b32 s42, 917504
  buffer_load_dwordx4 v8, s[8:11], s42 offen nt lds
  s_add_u32 m0, s41, 20480
  s_mov_b32 s42, 1032192
  buffer_load_dwordx4 v8, s[8:11], s42 offen nt lds
  s_add_u32 m0, s41, 24576
  s_mov_b32 s42, 1146880
  buffer_load_dwordx4 v8, s[8:11], s42 offen nt lds
  s_add_u32 m0, s41, 28672
  s_mov_b32 s42, 1261568
  buffer_load_dwordx4 v8, s[8:11], s42 offen nt lds
  s_add_u32 m0, s41, 32768
  s_mov_b32 s42, 1835008
  buffer_load_dwordx4 v8, s[8:11], s42 offen nt lds
  s_add_u32 m0, s41, 36864
  s_mov_b32 s42, 1949696
  buffer_load_dwordx4 v8, s[8:11], s42 offen nt lds
  s_add_u32 m0, s41, 40960
  s_mov_b32 s42, 2064384
  buffer_load_dwordx4 v8, s[8:11], s42 offen nt lds
  s_add_u32 m0, s41, 45056
  s_mov_b32 s42, 2179072
  buffer_load_dwordx4 v8, s[8:11], s42 offen nt lds
  s_add_u32 m0, s41, 49152
  s_mov_b32 s42, 2752512
  buffer_load_dwordx4 v8, s[8:11], s42 offen nt lds
  s_add_u32 m0, s41, 53248
  s_mov_b32 s42, 2867200
  buffer_load_dwordx4 v8, s[8:11], s42 offen nt lds
  s_add_u32 m0, s41, 57344
  s_mov_b32 s42, 2981888
  buffer_load_dwordx4 v8, s[8:11], s42 offen nt lds
  s_add_u32 m0, s41, 61440
  s_mov_b32 s42, 3096576
  buffer_load_dwordx4 v8, s[8:11], s42 offen nt lds
  s_add_u32 m0, s41, 65536
  s_mov_b32 s42, 3670016
  buffer_load_dwordx4 v8, s[8:11], s42 offen nt lds
  s_add_u32 m0, s41, 69632
  s_mov_b32 s42, 3784704
  buffer_load_dwordx4 v8, s[8:11], s42 offen nt lds
  s_add_u32 m0, s41, 73728
  s_mov_b32 s42, 3899392
  buffer_load_dwordx4 v8, s[8:11], s42 offen nt lds
  s_add_u32 m0, s41, 77824
  s_mov_b32 s42, 4014080
  buffer_load_dwordx4 v8, s[8:11], s42 offen nt lds
  s_add_u32 m0, s41, 81920
  s_mov_b32 s42, 4587520
  buffer_load_dwordx4 v8, s[8:11], s42 offen nt lds
  s_add_u32 m0, s41, 86016
  s_mov_b32 s42, 4702208
  buffer_load_dwordx4 v8, s[8:11], s42 offen nt lds
  s_add_u32 m0, s41, 90112
  s_mov_b32 s42, 4816896
  buffer_load_dwordx4 v8, s[8:11], s42 offen nt lds
  s_add_u32 m0, s41, 94208
  s_mov_b32 s42, 4931584
  buffer_load_dwordx4 v8, s[8:11], s42 offen nt lds
  s_add_u32 m0, s41, 98304
  s_mov_b32 s42, 5505024
  buffer_load_dwordx4 v8, s[8:11], s42 offen nt lds
  s_add_u32 m0, s41, 102400
  s_mov_b32 s42, 5619712
  buffer_load_dwordx4 v8, s[8:11], s42 offen nt lds
  s_add_u32 m0, s41, 106496
  s_mov_b32 s42, 5734400
  buffer_load_dwordx4 v8, s[8:11], s42 offen nt lds
  s_add_u32 m0, s41, 110592
  s_mov_b32 s42, 5849088
  buffer_load_dwordx4 v8, s[8:11], s42 offen nt lds
  s_waitcnt vmcnt(24) lgkmcnt(0)
  s_barrier
  s_add_u32 m0, s41, 114688
  s_mov_b32 s42, 6422528
  buffer_load_dwordx4 v8, s[8:11], s42 offen nt lds
  s_add_u32 m0, s41, 118784
  s_mov_b32 s42, 6537216
  buffer_load_dwordx4 v8, s[8:11], s42 offen nt lds
  s_add_u32 m0, s41, 122880
  s_mov_b32 s42, 6651904
  buffer_load_dwordx4 v8, s[8:11], s42 offen nt lds
  s_add_u32 m0, s41, 126976
  s_mov_b32 s42, 6766592
  buffer_load_dwordx4 v8, s[8:11], s42 offen nt lds
  ds_read_b64_tr_b16 a[0:1], v6 offset:0
  ds_read_b64_tr_b16 a[2:3], v6 offset:2048
  ds_read_b64_tr_b16 a[4:5], v6 offset:4096
  ds_read_b64_tr_b16 a[6:7], v6 offset:6144
  ds_read_b64_tr_b16 a[8:9], v6 offset:8192
  ds_read_b64_tr_b16 a[10:11], v6 offset:10240
  ds_read_b64_tr_b16 a[12:13], v6 offset:12288
  ds_read_b64_tr_b16 a[14:15], v6 offset:14336
  s_waitcnt vmcnt(24) lgkmcnt(0)
  s_barrier
  s_load_dwordx2 s[8:9], s[0:1], 72
  s_mov_b32 s10, 7340032
  s_mov_b32 s11, 0x20000
  s_waitcnt lgkmcnt(0)
  s_add_u32 m0, s41, 0
  s_mov_b32 s42, 0
  buffer_load_dwordx4 v9, s[8:11], s42 offen nt lds
  s_add_u32 m0, s41, 4096
  s_mov_b32 s42, 114688
  buffer_load_dwordx4 v9, s[8:11], s42 offen nt lds
  s_add_u32 m0, s41, 8192
  s_mov_b32 s42, 229376
  buffer_load_dwordx4 v9, s[8:11], s42 offen nt lds
  s_add_u32 m0, s41, 12288
  s_mov_b32 s42, 344064
  buffer_load_dwordx4 v9, s[8:11], s42 offen nt lds
  ds_read_b64_tr_b16 a[16:17], v6 offset:16384
  ds_read_b64_tr_b16 a[18:19], v6 offset:18432
  ds_read_b64_tr_b16 a[20:21], v6 offset:20480
  ds_read_b64_tr_b16 a[22:23], v6 offset:22528
  ds_read_b64_tr_b16 a[24:25], v6 offset:24576
  ds_read_b64_tr_b16 a[26:27], v6 offset:26624
  ds_read_b64_tr_b16 a[28:29], v6 offset:28672
  ds_read_b64_tr_b16 a[30:31], v6 offset:30720
  s_waitcnt vmcnt(24) lgkmcnt(0)
  s_barrier
  s_add_u32 m0, s41, 16384
  s_mov_b32 s42, 917504
  buffer_load_dwordx4 v9, s[8:11], s42 offen nt lds
  s_add_u32 m0, s41, 20480
  s_mov_b32 s42, 1032192
  buffer_load_dwordx4 v9, s[8:11], s42 offen nt lds
  s_add_u32 m0, s41, 24576
  s_mov_b32 s42, 1146880
  buffer_load_dwordx4 v9, s[8:11], s42 offen nt lds
  s_add_u32 m0, s41, 28672
  s_mov_b32 s42, 1261568
  buffer_load_dwordx4 v9, s[8:11], s42 offen nt lds
  ds_read_b64_tr_b16 a[32:33], v6 offset:32768
  ds_read_b64_tr_b16 a[34:35], v6 offset:34816
  ds_read_b64_tr_b16 a[36:37], v6 offset:36864
  ds_read_b64_tr_b16 a[38:39], v6 offset:38912
  ds_read_b64_tr_b16 a[40:41], v6 offset:40960
  ds_read_b64_tr_b16 a[42:43], v6 offset:43008
  ds_read_b64_tr_b16 a[44:45], v6 offset:45056
  ds_read_b64_tr_b16 a[46:47], v6 offset:47104
  s_waitcnt vmcnt(24) lgkmcnt(0)
  s_barrier
  s_add_u32 m0, s41, 32768
  s_mov_b32 s42, 1835008
  buffer_load_dwordx4 v9, s[8:11], s42 offen nt lds
  s_add_u32 m0, s41, 36864
  s_mov_b32 s42, 1949696
  buffer_load_dwordx4 v9, s[8:11], s42 offen nt lds
  s_add_u32 m0, s41, 40960
  s_mov_b32 s42, 2064384
  buffer_load_dwordx4 v9, s[8:11], s42 offen nt lds
  s_add_u32 m0, s41, 45056
  s_mov_b32 s42, 2179072
  buffer_load_dwordx4 v9, s[8:11], s42 offen nt lds
  ds_read_b64_tr_b16 a[48:49], v6 offset:49152
  ds_read_b64_tr_b16 a[50:51], v6 offset:51200
  ds_read_b64_tr_b16 a[52:53], v6 offset:53248
  ds_read_b64_tr_b16 a[54:55], v6 offset:55296
  ds_read_b64_tr_b16 a[56:57], v6 offset:57344
  ds_read_b64_tr_b16 a[58:59], v6 offset:59392
  ds_read_b64_tr_b16 a[60:61], v6 offset:61440
  ds_read_b64_tr_b16 a[62:63], v6 offset:63488
  s_waitcnt vmcnt(24) lgkmcnt(0)
  s_barrier
  s_add_u32 m0, s41, 49152
  s_mov_b32 s42, 2752512
  buffer_load_dwordx4 v9, s[8:11], s42 offen nt lds
  s_add_u32 m0, s41, 53248
  s_mov_b32 s42, 2867200
  buffer_load_dwordx4 v9, s[8:11], s42 offen nt lds
  s_add_u32 m0, s41, 57344
  s_mov_b32 s42, 2981888
  buffer_load_dwordx4 v9, s[8:11], s42 offen nt lds
  s_add_u32 m0, s41, 61440
  s_mov_b32 s42, 3096576
  buffer_load_dwordx4 v9, s[8:11], s42 offen nt lds
  ds_read_b64_tr_b16 a[64:65], v7 offset:0
  ds_read_b64_tr_b16 a[66:67], v7 offset:2048
  ds_read_b64_tr_b16 a[68:69], v7 offset:4096
  ds_read_b64_tr_b16 a[70:71], v7 offset:6144
  ds_read_b64_tr_b16 a[72:73], v7 offset:8192
  ds_read_b64_tr_b16 a[74:75], v7 offset:10240
  ds_read_b64_tr_b16 a[76:77], v7 offset:12288
  ds_read_b64_tr_b16 a[78:79], v7 offset:14336
  s_waitcnt vmcnt(24) lgkmcnt(0)
  s_barrier
  s_add_u32 m0, s41, 65536
  s_mov_b32 s42, 3670016
  buffer_load_dwordx4 v9, s[8:11], s42 offen nt lds
  s_add_u32 m0, s41, 69632
  s_mov_b32 s42, 3784704
  buffer_load_dwordx4 v9, s[8:11], s42 offen nt lds
  s_add_u32 m0, s41, 73728
  s_mov_b32 s42, 3899392
  buffer_load_dwordx4 v9, s[8:11], s42 offen nt lds
  s_add_u32 m0, s41, 77824
  s_mov_b32 s42, 4014080
  buffer_load_dwordx4 v9, s[8:11], s42 offen nt lds
  ds_read_b64_tr_b16 a[80:81], v7 offset:16384
  ds_read_b64_tr_b16 a[82:83], v7 offset:18432
  ds_read_b64_tr_b16 a[84:85], v7 offset:20480
  ds_read_b64_tr_b16 a[86:87], v7 offset:22528
  ds_read_b64_tr_b16 a[88:89], v7 offset:24576
  ds_read_b64_tr_b16 a[90:91], v7 offset:26624
  ds_read_b64_tr_b16 a[92:93], v7 offset:28672
  ds_read_b64_tr_b16 a[94:95], v7 offset:30720
  s_waitcnt vmcnt(24) lgkmcnt(0)
  s_barrier
  s_add_u32 m0, s41, 81920
  s_mov_b32 s42, 4587520
  buffer_load_dwordx4 v9, s[8:11], s42 offen nt lds
  s_add_u32 m0, s41, 86016
  s_mov_b32 s42, 4702208
  buffer_load_dwordx4 v9, s[8:11], s42 offen nt lds
  s_add_u32 m0, s41, 90112
  s_mov_b32 s42, 4816896
  buffer_load_dwordx4 v9, s[8:11], s42 offen nt lds
  s_add_u32 m0, s41, 94208
  s_mov_b32 s42, 4931584
  buffer_load_dwordx4 v9, s[8:11], s42 offen nt lds
  ds_read_b64_tr_b16 a[96:97], v7 offset:32768
  ds_read_b64_tr_b16 a[98:99], v7 offset:34816
  ds_read_b64_tr_b16 a[100:101], v7 offset:36864
  ds_read_b64_tr_b16 a[102:103], v7 offset:38912
  ds_read_b64_tr_b16 a[104:105], v7 offset:40960
  ds_read_b64_tr_b16 a[106:107], v7 offset:43008
  ds_read_b64_tr_b16 a[108:109], v7 offset:45056
  ds_read_b64_tr_b16 a[110:111], v7 offset:47104
  s_waitcnt vmcnt(24) lgkmcnt(0)
  s_barrier
  s_add_u32 m0, s41, 98304
  s_mov_b32 s42, 5505024
  buffer_load_dwordx4 v9, s[8:11], s42 offen nt lds
  s_add_u32 m0, s41, 102400
  s_mov_b32 s42, 5619712
  buffer_load_dwordx4 v9, s[8:11], s42 offen nt lds
  s_add_u32 m0, s41, 106496
  s_mov_b32 s42, 5734400
  buffer_load_dwordx4 v9, s[8:11], s42 offen nt lds
  s_add_u32 m0, s41, 110592
  s_mov_b32 s42, 5849088
  buffer_load_dwordx4 v9, s[8:11], s42 offen nt lds
  ds_read_b64_tr_b16 a[112:113], v7 offset:49152
  ds_read_b64_tr_b16 a[114:115], v7 offset:51200
  ds_read_b64_tr_b16 a[116:117], v7 offset:53248
  ds_read_b64_tr_b16 a[118:119], v7 offset:55296
  ds_read_b64_tr_b16 a[120:121], v7 offset:57344
  ds_read_b64_tr_b16 a[122:123], v7 offset:59392
  ds_read_b64_tr_b16 a[124:125], v7 offset:61440
  ds_read_b64_tr_b16 a[126:127], v7 offset:63488
  s_waitcnt vmcnt(24) lgkmcnt(0)
  s_barrier
  s_add_u32 m0, s41, 114688
  s_mov_b32 s42, 6422528
  buffer_load_dwordx4 v9, s[8:11], s42 offen nt lds
  s_add_u32 m0, s41, 118784
  s_mov_b32 s42, 6537216
  buffer_load_dwordx4 v9, s[8:11], s42 offen nt lds
  s_add_u32 m0, s41, 122880
  s_mov_b32 s42, 6651904
  buffer_load_dwordx4 v9, s[8:11], s42 offen nt lds
  s_add_u32 m0, s41, 126976
  s_mov_b32 s42, 6766592
  buffer_load_dwordx4 v9, s[8:11], s42 offen nt lds
  ds_read_b64_tr_b16 a[128:129], v6 offset:0
  ds_read_b64_tr_b16 a[130:131], v6 offset:2048
  ds_read_b64_tr_b16 a[132:133], v6 offset:4096
  ds_read_b64_tr_b16 a[134:135], v6 offset:6144
  ds_read_b64_tr_b16 a[136:137], v6 offset:8192
  ds_read_b64_tr_b16 a[138:139], v6 offset:10240
  ds_read_b64_tr_b16 a[140:141], v6 offset:12288
  ds_read_b64_tr_b16 a[142:143], v6 offset:14336
  s_waitcnt vmcnt(24) lgkmcnt(0)
  s_barrier
  ds_read_b64_tr_b16 a[144:145], v6 offset:16384
  ds_read_b64_tr_b16 a[146:147], v6 offset:18432
  ds_read_b64_tr_b16 a[148:149], v6 offset:20480
  ds_read_b64_tr_b16 a[150:151], v6 offset:22528
  ds_read_b64_tr_b16 a[152:153], v6 offset:24576
  ds_read_b64_tr_b16 a[154:155], v6 offset:26624
  ds_read_b64_tr_b16 a[156:157], v6 offset:28672
  ds_read_b64_tr_b16 a[158:159], v6 offset:30720
  s_waitcnt vmcnt(20) lgkmcnt(0)
  s_barrier
  ds_read_b64_tr_b16 a[160:161], v6 offset:32768
  ds_read_b64_tr_b16 a[162:163], v6 offset:34816
  ds_read_b64_tr_b16 a[164:165], v6 offset:36864
  ds_read_b64_tr_b16 a[166:167], v6 offset:38912
  ds_read_b64_tr_b16 a[168:169], v6 offset:40960
  ds_read_b64_tr_b16 a[170:171], v6 offset:43008
  ds_read_b64_tr_b16 a[172:173], v6 offset:45056
  ds_read_b64_tr_b16 a[174:175], v6 offset:47104
  s_waitcnt vmcnt(16) lgkmcnt(0)
  s_barrier
  ds_read_b64_tr_b16 a[176:177], v6 offset:49152
  ds_read_b64_tr_b16 a[178:179], v6 offset:51200
  ds_read_b64_tr_b16 a[180:181], v6 offset:53248
  ds_read_b64_tr_b16 a[182:183], v6 offset:55296
  ds_read_b64_tr_b16 a[184:185], v6 offset:57344
  ds_read_b64_tr_b16 a[186:187], v6 offset:59392
  ds_read_b64_tr_b16 a[188:189], v6 offset:61440
  ds_read_b64_tr_b16 a[190:191], v6 offset:63488
  s_waitcnt vmcnt(12) lgkmcnt(0)
  s_barrier
  ds_read_b64_tr_b16 a[192:193], v7 offset:0
  ds_read_b64_tr_b16 a[194:195], v7 offset:2048
  ds_read_b64_tr_b16 a[196:197], v7 offset:4096
  ds_read_b64_tr_b16 a[198:199], v7 offset:6144
  ds_read_b64_tr_b16 a[200:201], v7 offset:8192
  ds_read_b64_tr_b16 a[202:203], v7 offset:10240
  ds_read_b64_tr_b16 a[204:205], v7 offset:12288
  ds_read_b64_tr_b16 a[206:207], v7 offset:14336
  s_waitcnt vmcnt(8) lgkmcnt(0)
  s_barrier
  ds_read_b64_tr_b16 a[208:209], v7 offset:16384
  ds_read_b64_tr_b16 a[210:211], v7 offset:18432
  ds_read_b64_tr_b16 a[212:213], v7 offset:20480
  ds_read_b64_tr_b16 a[214:215], v7 offset:22528
  ds_read_b64_tr_b16 a[216:217], v7 offset:24576
  ds_read_b64_tr_b16 a[218:219], v7 offset:26624
  ds_read_b64_tr_b16 a[220:221], v7 offset:28672
  ds_read_b64_tr_b16 a[222:223], v7 offset:30720
  s_waitcnt vmcnt(4) lgkmcnt(0)
  s_barrier
  ds_read_b64_tr_b16 a[224:225], v7 offset:32768
  ds_read_b64_tr_b16 a[226:227], v7 offset:34816
  ds_read_b64_tr_b16 a[228:229], v7 offset:36864
  ds_read_b64_tr_b16 a[230:231], v7 offset:38912
  ds_read_b64_tr_b16 a[232:233], v7 offset:40960
  ds_read_b64_tr_b16 a[234:235], v7 offset:43008
  ds_read_b64_tr_b16 a[236:237], v7 offset:45056
  ds_read_b64_tr_b16 a[238:239], v7 offset:47104
  s_waitcnt vmcnt(0) lgkmcnt(0)
  s_barrier
  ds_read_b64_tr_b16 a[240:241], v7 offset:49152
  ds_read_b64_tr_b16 a[242:243], v7 offset:51200
  ds_read_b64_tr_b16 a[244:245], v7 offset:53248
  ds_read_b64_tr_b16 a[246:247], v7 offset:55296
  ds_read_b64_tr_b16 a[248:249], v7 offset:57344
  ds_read_b64_tr_b16 a[250:251], v7 offset:59392
  ds_read_b64_tr_b16 a[252:253], v7 offset:61440
  ds_read_b64_tr_b16 a[254:255], v7 offset:63488
  s_waitcnt lgkmcnt(0)
  s_barrier
  v_min_u32 v2, 7, v0
  v_lshlrev_b32 v2, 7, v2
  v_add_u32 v2, 1413120, v2
  s_lshl_b32 s62, s21, 7
  s_add_u32 s62, s62, 1414144
  v_min_u32 v52, 63, v0
  v_lshlrev_b32 v52, 7, v52
  v_add_u32 v52, 1424384, v52
  s_nop 1
Lpoll_142:
  buffer_load_dword v53, v52, s[4:7], 0 offen sc1
  s_sub_u32 s24, s24, 1
  s_cbranch_scc1 L_FAIL
  s_waitcnt vmcnt(0)
  v_cmp_gt_i32 vcc, 0, v53
  s_cbranch_vccz Lpolld_143
  s_sleep 1
  s_branch Lpoll_142
Lpolld_143:
Ltab_141:
  v_lshrrev_b32 v53, 8, v53
  v_and_b32 v54, 3, v0
  v_lshl_or_b32 v53, v53, 2, v54
  s_nop 1
  v_min_u32_dpp v53, v53, v53 row_ror:8 row_mask:0xf bank_mask:0xf
  s_nop 1
  v_min_u32_dpp v53, v53, v53 row_ror:4 row_mask:0xf bank_mask:0xf
  v_mov_b32 v54, v53
  s_nop 1
  v_permlane16_swap_b32 v54, v53
  v_min_u32 v53, v53, v54
  v_mov_b32 v54, v53
  s_nop 1
  v_permlane32_swap_b32 v54, v53
  v_min_u32 v53, v53, v54
  s_nop 1
  v_min_u32_dpp v53, v53, v53 row_ror:2 row_mask:0xf bank_mask:0xf
  s_nop 1
  v_min_u32_dpp v53, v53, v53 row_ror:1 row_mask:0xf bank_mask:0xf
  s_nop 0
  v_readfirstlane_b32 s38, v53
  s_and_b32 s38, s38, 3
  s_lshl_b32 s38, s38, 13
  s_and_b32 s38, s38, 0x2000
  s_xor_b32 s38, s38, 20979712
  s_lshr_b32 s40, s20, 1
  s_lshl_b32 s40, s40, 14
  s_and_b32 s41, s20, 1
  s_lshl_b32 s41, s41, 12
  s_add_u32 s27, s40, s41
  s_lshr_b32 s40, s21, 1
  s_lshl_b32 s40, s40, 14
  s_and_b32 s41, s21, 1
  s_lshl_b32 s41, s41, 12
  s_add_u32 s31, s40, s41
  s_add_u32 s27, s27, s38
  s_add_u32 s27, s27, 917504
  s_add_u32 s31, s31, s38
  s_add_u32 s31, s31, 1179648
  s_lshr_b32 s40, s20, 1
  s_lshl_b32 s40, s40, 11
  s_and_b32 s41, s20, 1
  s_lshl_b32 s41, s41, 9
  s_add_u32 s40, s40, s41
  v_and_b32 v52, 31, v0
  v_lshl_add_u32 v68, v52, 4, s40
  v_lshrrev_b32 v52, 5, v0
  v_lshl_add_u32 v68, v52, 10, v68
  s_mov_b32 s37, 0xbfb8aa3b
  v_lshlrev_b32 v71, 2, v0
  v_add_u32 v71, 131072, v71
  s_mov_b32 s25, 0
  s_mov_b32 s26, 0
  s_mov_b32 s29, 1
  s_mov_b32 s30, 0
  s_mov_b32 s28, 0
L_F1_top:
  s_cmp_eq_u32 s28, 1
  s_cbranch_scc1 L_F1_go
  s_cmp_eq_u32 s28, 2
  s_cbranch_scc1 L_F1_mid
  s_cmp_lg_u32 s20, 0
  s_cbranch_scc1 L_F1_park
  buffer_load_dword v3, v2, s[4:7], s30 offen sc1
  s_waitcnt vmcnt(1)
  s_barrier
  s_mov_b32 s63, s25
  s_atomic_smax s63, s[4:5], s62 glc
Lnosig_144:
  s_cmp_ge_u32 s25, 64
  s_cbranch_scc1 L_END
  s_waitcnt vmcnt(0)
  v_cmp_gt_i32 vcc, s29, v3
  s_cbranch_vccz L_F1_issue
  s_nop 3
Lpoll_145:
  buffer_load_dword v3, v2, s[4:7], s30 offen sc1
  s_sub_u32 s24, s24, 1
  s_cbranch_scc1 L_FAIL
  s_waitcnt vmcnt(0)
  v_cmp_gt_i32 vcc, s29, v3
  s_cbranch_vccz Lpolld_146
  s_sleep 1
  s_branch Lpoll_145
Lpolld_146:
  s_branch L_F1_issue
L_F1_park:
  s_waitcnt vmcnt(0)
  s_barrier
  s_cmp_ge_u32 s25, 64
  s_cbranch_scc1 L_END
L_F1_issue:
  s_barrier
L_F1_mid:
  s_mov_b32 s34, s26
  s_mov_b32 s35, s27
  s_add_u32 s36, s32, 0
  s_add_u32 m0, s34, s36
  s_add_u32 s36, s35, 0
  buffer_load_dwordx4 v1, s[4:7], s36 offen offset:0 sc1 lds
  s_nop 0
  buffer_load_dwordx4 v1, s[4:7], s36 offen offset:1024 sc1 lds
  s_nop 0
  buffer_load_dwordx4 v1, s[4:7], s36 offen offset:2048 sc1 lds
  s_nop 0
  buffer_load_dwordx4 v1, s[4:7], s36 offen offset:3072 sc1 lds
  s_nop 0
  s_add_u32 s36, s32, 16384
  s_add_u32 m0, s34, s36
  s_add_u32 s36, s35, 32768
  buffer_load_dwordx4 v1, s[4:7], s36 offen offset:0 sc1 lds
  s_nop 0
  buffer_load_dwordx4 v1, s[4:7], s36 offen offset:1024 sc1 lds
  s_nop 0
  buffer_load_dwordx4 v1, s[4:7], s36 offen offset:2048 sc1 lds
  s_nop 0
  buffer_load_dwordx4 v1, s[4:7], s36 offen offset:3072 sc1 lds
  s_nop 0
  s_add_u32 s36, s32, 32768
  s_add_u32 m0, s34, s36
  s_add_u32 s36, s35, 65536
  buffer_load_dwordx4 v1, s[4:7], s36 offen offset:0 sc1 lds
  s_nop 0
  buffer_load_dwordx4 v1, s[4:7], s36 offen offset:1024 sc1 lds
  s_nop 0
  buffer_load_dwordx4 v1, s[4:7], s36 offen offset:2048 sc1 lds
  s_nop 0
  buffer_load_dwordx4 v1, s[4:7], s36 offen offset:3072 sc1 lds
  s_nop 0
  s_cmp_eq_u32 s28, 0
  s_cbranch_scc1 L_F1_go
  s_mov_b32 s28, 0
  s_waitcnt vmcnt(12)
  s_barrier
  s_cmp_lg_u32 s20, 0
  s_cbranch_scc1 Lnosig_147
  s_mov_b32 s63, s25
  s_atomic_smax s63, s[4:5], s62 glc
Lnosig_147:
L_F1_go:
  v_add_u32 v73, s26, v69
  v_add_u32 v74, s26, v70
  s_sub_u32 s26, 65536, s26
  s_add_u32 s27, s27, 2097152
  s_xor_b32 s27, s27, 0x2000
  s_add_u32 s29, s29, 1
  s_waitcnt vmcnt(8)
  s_barrier
  ds_read_b128 v[4:7], v73 offset:0
  ds_read_b128 v[8:11], v73 offset:1024
  ds_read_b128 v[12:15], v73 offset:2048
  ds_read_b128 v[16:19], v73 offset:3072
  ds_read_b128 v[20:23], v73 offset:4096
  ds_read_b128 v[24:27], v73 offset:5120
  s_waitcnt lgkmcnt(4)
  v_mfma_f32_16x16x32_bf16 v[36:39], a[0:3], v[4:7], 0
  ds_read_b128 v[28:31], v73 offset:6144
  v_mfma_f32_16x16x32_bf16 v[40:43], a[0:3], v[8:11], 0
  ds_read_b128 v[32:35], v73 offset:7168
  v_mfma_f32_16x16x32_bf16 v[44:47], a[128:131], v[4:7], 0
  s_add_u32 s36, s32, 49152
  s_add_u32 m0, s34, s36
  s_add_u32 s36, s35, 98304
  buffer_load_dwordx4 v1, s[4:7], s36 offen offset:0 sc1 lds
  v_mfma_f32_16x16x32_bf16 v[48:51], a[128:131], v[8:11], 0
  s_waitcnt lgkmcnt(4)
  v_mfma_f32_16x16x32_bf16 v[36:39], a[4:7], v[12:15], v[36:39]
  ds_read_b128 v[4:7], v73 offset:8192
  v_mfma_f32_16x16x32_bf16 v[40:43], a[4:7], v[16:19], v[40:43]
  ds_read_b128 v[8:11], v73 offset:9216
  v_mfma_f32_16x16x32_bf16 v[44:47], a[132:135], v[12:15], v[44:47]
  buffer_load_dwordx4 v1, s[4:7], s36 offen offset:1024 sc1 lds
  v_mfma_f32_16x16x32_bf16 v[48:51], a[132:135], v[16:19], v[48:51]
  s_waitcnt lgkmcnt(4)
  v_mfma_f32_16x16x32_bf16 v[36:39], a[8:11], v[20:23], v[36:39]
  ds_read_b128 v[12:15], v73 offset:10240
  v_mfma_f32_16x16x32_bf16 v[40:43], a[8:11], v[24:27], v[40:43]
  ds_read_b128 v[16:19], v73 offset:11264
  v_mfma_f32_16x16x32_bf16 v[44:47], a[136:139], v[20:23], v[44:47]
  buffer_load_dwordx4 v1, s[4:7], s36 offen offset:2048 sc1 lds
  v_mfma_f32_16x16x32_bf16 v[48:51], a[136:139], v[24:27], v[48:51]
  s_waitcnt lgkmcnt(4)
  v_mfma_f32_16x16x32_bf16 v[36:39], a[12:15], v[28:31], v[36:39]
  ds_read_b128 v[20:23], v73 offset:12288
  v_mfma_f32_16x16x32_bf16 v[40:43], a[12:15], v[32:35], v[40:43]
  ds_read_b128 v[24:27], v73 offset:13312
  v_mfma_f32_16x16x32_bf16 v[44:47], a[140:143], v[28:31], v[44:47]
  buffer_load_dwordx4 v1, s[4:7], s36 offen offset:3072 sc1 lds
  v_mfma_f32_16x16x32_bf16 v[48:51], a[140:143], v[32:35], v[48:51]
  s_waitcnt lgkmcnt(4)
  v_mfma_f32_16x16x32_bf16 v[36:39], a[16:19], v[4:7], v[36:39]
  ds_read_b128 v[28:31], v73 offset:14336
  v_mfma_f32_16x16x32_bf16 v[40:43], a[16:19], v[8:11], v[40:43]
  ds_read_b128 v[32:35], v73 offset:15360
  v_mfma_f32_16x16x32_bf16 v[44:47], a[144:147], v[4:7], v[44:47]
  v_mfma_f32_16x16x32_bf16 v[48:51], a[144:147], v[8:11], v[48:51]
  s_waitcnt vmcnt(8)
  s_barrier
  s_mov_b32 s34, s26
  s_mov_b32 s35, s27
  s_waitcnt lgkmcnt(4)
  v_mfma_f32_16x16x32_bf16 v[36:39], a[20:23], v[12:15], v[36:39]
  ds_read_b128 v[4:7], v73 offset:16384
  v_mfma_f32_16x16x32_bf16 v[40:43], a[20:23], v[16:19], v[40:43]
  ds_read_b128 v[8:11], v73 offset:17408
  v_mfma_f32_16x16x32_bf16 v[44:47], a[148:151], v[12:15], v[44:47]
  v_mfma_f32_16x16x32_bf16 v[48:51], a[148:151], v[16:19], v[48:51]
  s_waitcnt lgkmcnt(4)
  v_mfma_f32_16x16x32_bf16 v[36:39], a[24:27], v[20:23], v[36:39]
  ds_read_b128 v[12:15], v73 offset:18432
  v_mfma_f32_16x16x32_bf16 v[40:43], a[24:27], v[24:27], v[40:43]
  ds_read_b128 v[16:19], v73 offset:19456
  v_mfma_f32_16x16x32_bf16 v[44:47], a[152:155], v[20:23], v[44:47]
  v_mfma_f32_16x16x32_bf16 v[48:51], a[152:155], v[24:27], v[48:51]
  s_waitcnt lgkmcnt(4)
  v_mfma_f32_16x16x32_bf16 v[36:39], a[28:31], v[28:31], v[36:39]
  ds_read_b128 v[20:23], v73 offset:20480
  v_mfma_f32_16x16x32_bf16 v[40:43], a[28:31], v[32:35], v[40:43]
  ds_read_b128 v[24:27], v73 offset:21504
  v_mfma_f32_16x16x32_bf16 v[44:47], a[156:159], v[28:31], v[44:47]
  v_mfma_f32_16x16x32_bf16 v[48:51], a[156:159], v[32:35], v[48:51]
  s_waitcnt lgkmcnt(4)
  v_mfma_f32_16x16x32_bf16 v[36:39], a[32:35], v[4:7], v[36:39]
  ds_read_b128 v[28:31], v73 offset:22528
  v_mfma_f32_16x16x32_bf16 v[40:43], a[32:35], v[8:11], v[40:43]
  ds_read_b128 v[32:35], v73 offset:23552
  v_mfma_f32_16x16x32_bf16 v[44:47], a[160:163], v[4:7], v[44:47]
  v_mfma_f32_16x16x32_bf16 v[48:51], a[160:163], v[8:11], v[48:51]
  s_waitcnt lgkmcnt(4)
  v_mfma_f32_16x16x32_bf16 v[36:39], a[36:39], v[12:15], v[36:39]
  ds_read_b128 v[4:7], v73 offset:24576
  v_mfma_f32_16x16x32_bf16 v[40:43], a[36:39], v[16:19], v[40:43]
  ds_read_b128 v[8:11], v73 offset:25600
  v_mfma_f32_16x16x32_bf16 v[44:47], a[164:167], v[12:15], v[44:47]
  v_mfma_f32_16x16x32_bf16 v[48:51], a[164:167], v[16:19], v[48:51]
  s_waitcnt lgkmcnt(4)
  v_mfma_f32_16x16x32_bf16 v[36:39], a[40:43], v[20:23], v[36:39]
  ds_read_b128 v[12:15], v73 offset:26624
  v_mfma_f32_16x16x32_bf16 v[40:43], a[40:43], v[24:27], v[40:43]
  ds_read_b128 v[16:19], v73 offset:27648
  v_mfma_f32_16x16x32_bf16 v[44:47], a[168:171], v[20:23], v[44:47]
  v_mfma_f32_16x16x32_bf16 v[48:51], a[168:171], v[24:27], v[48:51]
  s_waitcnt lgkmcnt(4)
  v_mfma_f32_16x16x32_bf16 v[36:39], a[44:47], v[28:31], v[36:39]
  ds_read_b128 v[20:23], v73 offset:28672
  v_mfma_f32_16x16x32_bf16 v[40:43], a[44:47], v[32:35], v[40:43]
  ds_read_b128 v[24:27], v73 offset:29696
  v_mfma_f32_16x16x32_bf16 v[44:47], a[172:175], v[28:31], v[44:47]
  v_mfma_f32_16x16x32_bf16 v[48:51], a[172:175], v[32:35], v[48:51]
  s_lshl_b32 s40, s20, 8
  s_add_u32 m0, s40, 131072
  s_cmp_eq_u32 s20, 0
  s_cselect_b32 s40, s30, 2147483392
  buffer_load_dword v2, s[4:7], s40 offen sc1 lds
  s_waitcnt lgkmcnt(4)
  v_mfma_f32_16x16x32_bf16 v[36:39], a[48:51], v[4:7], v[36:39]
  ds_read_b128 v[28:31], v73 offset:30720
  v_mfma_f32_16x16x32_bf16 v[40:43], a[48:51], v[8:11], v[40:43]
  ds_read_b128 v[32:35], v73 offset:31744
  v_mfma_f32_16x16x32_bf16 v[44:47], a[176:179], v[4:7], v[44:47]
  v_mfma_f32_16x16x32_bf16 v[48:51], a[176:179], v[8:11], v[48:51]
  s_waitcnt vmcnt(5)
  s_barrier
  s_lshl_b32 s40, s20, 1
  s_add_u32 s40, s40, 1
  s_cmp_lg_u32 s40, s28
  s_cbranch_scc1 L_F1_s2
  s_mov_b32 s63, s25
  s_atomic_smax s63, s[4:5], s62 glc
Lnosig_148:
L_F1_s2:
  s_waitcnt lgkmcnt(4)
  v_mfma_f32_16x16x32_bf16 v[36:39], a[52:55], v[12:15], v[36:39]
  ds_read_b128 v[4:7], v73 offset:32768
  v_mfma_f32_16x16x32_bf16 v[40:43], a[52:55], v[16:19], v[40:43]
  ds_read_b128 v[8:11], v73 offset:33792
  v_mfma_f32_16x16x32_bf16 v[44:47], a[180:183], v[12:15], v[44:47]
  v_mfma_f32_16x16x32_bf16 v[48:51], a[180:183], v[16:19], v[48:51]
  s_waitcnt lgkmcnt(4)
  v_mfma_f32_16x16x32_bf16 v[36:39], a[56:59], v[20:23], v[36:39]
  ds_read_b128 v[12:15], v73 offset:34816
  v_mfma_f32_16x16x32_bf16 v[40:43], a[56:59], v[24:27], v[40:43]
  ds_read_b128 v[16:19], v73 offset:35840
  v_mfma_f32_16x16x32_bf16 v[44:47], a[184:187], v[20:23], v[44:47]
  v_mfma_f32_16x16x32_bf16 v[48:51], a[184:187], v[24:27], v[48:51]
  s_waitcnt lgkmcnt(4)
  v_mfma_f32_16x16x32_bf16 v[36:39], a[60:63], v[28:31], v[36:39]
  ds_read_b128 v[20:23], v73 offset:36864
  v_mfma_f32_16x16x32_bf16 v[40:43], a[60:63], v[32:35], v[40:43]
  ds_read_b128 v[24:27], v73 offset:37888
  v_mfma_f32_16x16x32_bf16 v[44:47], a[188:191], v[28:31], v[44:47]
  v_mfma_f32_16x16x32_bf16 v[48:51], a[188:191], v[32:35], v[48:51]
  s_waitcnt lgkmcnt(4)
  v_mfma_f32_16x16x32_bf16 v[36:39], a[64:67], v[4:7], v[36:39]
  ds_read_b128 v[28:31], v73 offset:38912
  v_mfma_f32_16x16x32_bf16 v[40:43], a[64:67], v[8:11], v[40:43]
  ds_read_b128 v[32:35], v73 offset:39936
  v_mfma_f32_16x16x32_bf16 v[44:47], a[192:195], v[4:7], v[44:47]
  v_mfma_f32_16x16x32_bf16 v[48:51], a[192:195], v[8:11], v[48:51]
  s_waitcnt lgkmcnt(4)
  v_mfma_f32_16x16x32_bf16 v[36:39], a[68:71], v[12:15], v[36:39]
  ds_read_b128 v[4:7], v73 offset:40960
  v_mfma_f32_16x16x32_bf16 v[40:43], a[68:71], v[16:19], v[40:43]
  ds_read_b128 v[8:11], v73 offset:41984
  v_mfma_f32_16x16x32_bf16 v[44:47], a[196:199], v[12:15], v[44:47]
  v_mfma_f32_16x16x32_bf16 v[48:51], a[196:199], v[16:19], v[48:51]
  s_waitcnt lgkmcnt(4)
  v_mfma_f32_16x16x32_bf16 v[36:39], a[72:75], v[20:23], v[36:39]
  ds_read_b128 v[12:15], v73 offset:43008
  v_mfma_f32_16x16x32_bf16 v[40:43], a[72:75], v[24:27], v[40:43]
  ds_read_b128 v[16:19], v73 offset:44032
  v_mfma_f32_16x16x32_bf16 v[44:47], a[200:203], v[20:23], v[44:47]
  v_mfma_f32_16x16x32_bf16 v[48:51], a[200:203], v[24:27], v[48:51]
  s_waitcnt vmcnt(0)
  s_barrier
  ds_read_b32 v3, v71
  s_waitcnt lgkmcnt(4)
  v_mfma_f32_16x16x32_bf16 v[36:39], a[76:79], v[28:31], v[36:39]
  ds_read_b128 v[20:23], v73 offset:45056
  v_mfma_f32_16x16x32_bf16 v[40:43], a[76:79], v[32:35], v[40:43]
  ds_read_b128 v[24:27], v73 offset:46080
  v_mfma_f32_16x16x32_bf16 v[44:47], a[204:207], v[28:31], v[44:47]
  v_mfma_f32_16x16x32_bf16 v[48:51], a[204:207], v[32:35], v[48:51]
  s_waitcnt lgkmcnt(4)
  v_mfma_f32_16x16x32_bf16 v[36:39], a[80:83], v[4:7], v[36:39]
  ds_read_b128 v[28:31], v73 offset:47104
  v_mfma_f32_16x16x32_bf16 v[40:43], a[80:83], v[8:11], v[40:43]
  ds_read_b128 v[32:35], v73 offset:48128
  v_mfma_f32_16x16x32_bf16 v[44:47], a[208:211], v[4:7], v[44:47]
  v_mfma_f32_16x16x32_bf16 v[48:51], a[208:211], v[8:11], v[48:51]
  s_waitcnt lgkmcnt(4)
  v_cmp_gt_i32 vcc, s29, v3
  s_mov_b32 s28, 0
  s_cbranch_vccnz L_F1_nopf
  s_cmp_ge_u32 s25, 63
  s_cbranch_scc1 L_F1_nopf
  s_mov_b32 s28, 1
  s_waitcnt lgkmcnt(4)
  v_mfma_f32_16x16x32_bf16 v[36:39], a[84:87], v[12:15], v[36:39]
  ds_read_b128 v[4:7], v73 offset:49152
  v_mfma_f32_16x16x32_bf16 v[40:43], a[84:87], v[16:19], v[40:43]
  ds_read_b128 v[8:11], v73 offset:50176
  v_mfma_f32_16x16x32_bf16 v[44:47], a[212:215], v[12:15], v[44:47]
  s_add_u32 s36, s32, 0
  s_add_u32 m0, s34, s36
  s_add_u32 s36, s35, 0
  buffer_load_dwordx4 v1, s[4:7], s36 offen offset:0 sc1 lds
  v_mfma_f32_16x16x32_bf16 v[48:51], a[212:215], v[16:19], v[48:51]
  buffer_load_dwordx4 v1, s[4:7], s36 offen offset:1024 sc1 lds
  s_waitcnt lgkmcnt(4)
  v_mfma_f32_16x16x32_bf16 v[36:39], a[88:91], v[20:23], v[36:39]
  ds_read_b128 v[12:15], v73 offset:51200
  v_mfma_f32_16x16x32_bf16 v[40:43], a[88:91], v[24:27], v[40:43]
  ds_read_b128 v[16:19], v73 offset:52224
  v_mfma_f32_16x16x32_bf16 v[44:47], a[216:219], v[20:23], v[44:47]
  buffer_load_dwordx4 v1, s[4:7], s36 offen offset:2048 sc1 lds
  v_mfma_f32_16x16x32_bf16 v[48:51], a[216:219], v[24:27], v[48:51]
  buffer_load_dwordx4 v1, s[4:7], s36 offen offset:3072 sc1 lds
  s_waitcnt lgkmcnt(4)
  v_mfma_f32_16x16x32_bf16 v[36:39], a[92:95], v[28:31], v[36:39]
  ds_read_b128 v[20:23], v73 offset:53248
  v_mfma_f32_16x16x32_bf16 v[40:43], a[92:95], v[32:35], v[40:43]
  ds_read_b128 v[24:27], v73 offset:54272
  v_mfma_f32_16x16x32_bf16 v[44:47], a[220:223], v[28:31], v[44:47]
  s_add_u32 s36, s32, 16384
  s_add_u32 m0, s34, s36
  s_add_u32 s36, s35, 32768
  buffer_load_dwordx4 v1, s[4:7], s36 offen offset:0 sc1 lds
  v_mfma_f32_16x16x32_bf16 v[48:51], a[220:223], v[32:35], v[48:51]
  buffer_load_dwordx4 v1, s[4:7], s36 offen offset:1024 sc1 lds
  s_waitcnt lgkmcnt(4)
  v_mfma_f32_16x16x32_bf16 v[36:39], a[96:99], v[4:7], v[36:39]
  ds_read_b128 v[28:31], v73 offset:55296
  v_mfma_f32_16x16x32_bf16 v[40:43], a[96:99], v[8:11], v[40:43]
  ds_read_b128 v[32:35], v73 offset:56320
  v_mfma_f32_16x16x32_bf16 v[44:47], a[224:227], v[4:7], v[44:47]
  buffer_load_dwordx4 v1, s[4:7], s36 offen offset:2048 sc1 lds
  v_mfma_f32_16x16x32_bf16 v[48:51], a[224:227], v[8:11], v[48:51]
  buffer_load_dwordx4 v1, s[4:7], s36 offen offset:3072 sc1 lds
  s_waitcnt lgkmcnt(4)
  v_mfma_f32_16x16x32_bf16 v[36:39], a[100:103], v[12:15], v[36:39]
  ds_read_b128 v[4:7], v73 offset:57344
  v_mfma_f32_16x16x32_bf16 v[40:43], a[100:103], v[16:19], v[40:43]
  ds_read_b128 v[8:11], v73 offset:58368
  v_mfma_f32_16x16x32_bf16 v[44:47], a[228:231], v[12:15], v[44:47]
  s_add_u32 s36, s32, 32768
  s_add_u32 m0, s34, s36
  s_add_u32 s36, s35, 65536
  buffer_load_dwordx4 v1, s[4:7], s36 offen offset:0 sc1 lds
  v_mfma_f32_16x16x32_bf16 v[48:51], a[228:231], v[16:19], v[48:51]
  buffer_load_dwordx4 v1, s[4:7], s36 offen offset:1024 sc1 lds
  s_waitcnt lgkmcnt(4)
  v_mfma_f32_16x16x32_bf16 v[36:39], a[104:107], v[20:23], v[36:39]
  ds_read_b128 v[12:15], v73 offset:59392
  v_mfma_f32_16x16x32_bf16 v[40:43], a[104:107], v[24:27], v[40:43]
  ds_read_b128 v[16:19], v73 offset:60416
  v_mfma_f32_16x16x32_bf16 v[44:47], a[232:235], v[20:23], v[44:47]
  buffer_load_dwordx4 v1, s[4:7], s36 offen offset:2048 sc1 lds
  v_mfma_f32_16x16x32_bf16 v[48:51], a[232:235], v[24:27], v[48:51]
  buffer_load_dwordx4 v1, s[4:7], s36 offen offset:3072 sc1 lds
  s_waitcnt lgkmcnt(4)
  v_mfma_f32_16x16x32_bf16 v[36:39], a[108:111], v[28:31], v[36:39]
  ds_read_b128 v[20:23], v73 offset:61440
  v_mfma_f32_16x16x32_bf16 v[40:43], a[108:111], v[32:35], v[40:43]
  ds_read_b128 v[24:27], v73 offset:62464
  v_mfma_f32_16x16x32_bf16 v[44:47], a[236:239], v[28:31], v[44:47]
  v_mfma_f32_16x16x32_bf16 v[48:51], a[236:239], v[32:35], v[48:51]
  s_waitcnt lgkmcnt(4)
  v_mfma_f32_16x16x32_bf16 v[36:39], a[112:115], v[4:7], v[36:39]
  ds_read_b128 v[28:31], v73 offset:63488
  v_mfma_f32_16x16x32_bf16 v[40:43], a[112:115], v[8:11], v[40:43]
  ds_read_b128 v[32:35], v73 offset:64512
  v_mfma_f32_16x16x32_bf16 v[44:47], a[240:243], v[4:7], v[44:47]
  v_mfma_f32_16x16x32_bf16 v[48:51], a[240:243], v[8:11], v[48:51]
  s_waitcnt lgkmcnt(4)
  v_mfma_f32_16x16x32_bf16 v[36:39], a[116:119], v[12:15], v[36:39]
  v_mfma_f32_16x16x32_bf16 v[40:43], a[116:119], v[16:19], v[40:43]
  v_mfma_f32_16x16x32_bf16 v[44:47], a[244:247], v[12:15], v[44:47]
  v_mfma_f32_16x16x32_bf16 v[48:51], a[244:247], v[16:19], v[48:51]
  s_waitcnt lgkmcnt(2)
  v_mfma_f32_16x16x32_bf16 v[36:39], a[120:123], v[20:23], v[36:39]
  v_mfma_f32_16x16x32_bf16 v[40:43], a[120:123], v[24:27], v[40:43]
  v_mfma_f32_16x16x32_bf16 v[44:47], a[248:251], v[20:23], v[44:47]
  v_mfma_f32_16x16x32_bf16 v[48:51], a[248:251], v[24:27], v[48:51]
  s_waitcnt lgkmcnt(0)
  v_mfma_f32_16x16x32_bf16 v[36:39], a[124:127], v[28:31], v[36:39]
  v_mfma_f32_16x16x32_bf16 v[40:43], a[124:127], v[32:35], v[40:43]
  v_mfma_f32_16x16x32_bf16 v[44:47], a[252:255], v[28:31], v[44:47]
  v_mfma_f32_16x16x32_bf16 v[48:51], a[252:255], v[32:35], v[48:51]
  s_nop 7
  s_branch L_F1_epi
L_F1_nopf:
  s_waitcnt lgkmcnt(4)
  v_mfma_f32_16x16x32_bf16 v[36:39], a[84:87], v[12:15], v[36:39]
  ds_read_b128 v[4:7], v73 offset:49152
  v_mfma_f32_16x16x32_bf16 v[40:43], a[84:87], v[16:19], v[40:43]
  ds_read_b128 v[8:11], v73 offset:50176
  v_mfma_f32_16x16x32_bf16 v[44:47], a[212:215], v[12:15], v[44:47]
  v_mfma_f32_16x16x32_bf16 v[48:51], a[212:215], v[16:19], v[48:51]
  s_waitcnt lgkmcnt(4)
  v_mfma_f32_16x16x32_bf16 v[36:39], a[88:91], v[20:23], v[36:39]
  ds_read_b128 v[12:15], v73 offset:51200
  v_mfma_f32_16x16x32_bf16 v[40:43], a[88:91], v[24:27], v[40:43]
  ds_read_b128 v[16:19], v73 offset:52224
  v_mfma_f32_16x16x32_bf16 v[44:47], a[216:219], v[20:23], v[44:47]
  v_mfma_f32_16x16x32_bf16 v[48:51], a[216:219], v[24:27], v[48:51]
  s_waitcnt lgkmcnt(4)
  v_mfma_f32_16x16x32_bf16 v[36:39], a[92:95], v[28:31], v[36:39]
  ds_read_b128 v[20:23], v73 offset:53248
  v_mfma_f32_16x16x32_bf16 v[40:43], a[92:95], v[32:35], v[40:43]
  ds_read_b128 v[24:27], v73 offset:54272
  v_mfma_f32_16x16x32_bf16 v[44:47], a[220:223], v[28:31], v[44:47]
  v_mfma_f32_16x16x32_bf16 v[48:51], a[220:223], v[32:35], v[48:51]
  s_barrier
  s_lshl_b32 s40, s20, 8
  s_add_u32 m0, s40, 131072
  s_cmp_eq_u32 s20, 0
  s_cselect_b32 s40, s30, 2147483392
  buffer_load_dword v2, s[4:7], s40 offen sc1 lds
  s_waitcnt lgkmcnt(4)
  v_mfma_f32_16x16x32_bf16 v[36:39], a[96:99], v[4:7], v[36:39]
  ds_read_b128 v[28:31], v73 offset:55296
  v_mfma_f32_16x16x32_bf16 v[40:43], a[96:99], v[8:11], v[40:43]
  ds_read_b128 v[32:35], v73 offset:56320
  v_mfma_f32_16x16x32_bf16 v[44:47], a[224:227], v[4:7], v[44:47]
  v_mfma_f32_16x16x32_bf16 v[48:51], a[224:227], v[8:11], v[48:51]
  s_waitcnt lgkmcnt(4)
  v_mfma_f32_16x16x32_bf16 v[36:39], a[100:103], v[12:15], v[36:39]
  ds_read_b128 v[4:7], v73 offset:57344
  v_mfma_f32_16x16x32_bf16 v[40:43], a[100:103], v[16:19], v[40:43]
  ds_read_b128 v[8:11], v73 offset:58368
  v_mfma_f32_16x16x32_bf16 v[44:47], a[228:231], v[12:15], v[44:47]
  v_mfma_f32_16x16x32_bf16 v[48:51], a[228:231], v[16:19], v[48:51]
  s_waitcnt lgkmcnt(4)
  v_mfma_f32_16x16x32_bf16 v[36:39], a[104:107], v[20:23], v[36:39]
  ds_read_b128 v[12:15], v73 offset:59392
  v_mfma_f32_16x16x32_bf16 v[40:43], a[104:107], v[24:27], v[40:43]
  ds_read_b128 v[16:19], v73 offset:60416
  v_mfma_f32_16x16x32_bf16 v[44:47], a[232:235], v[20:23], v[44:47]
  v_mfma_f32_16x16x32_bf16 v[48:51], a[232:235], v[24:27], v[48:51]
  s_waitcnt lgkmcnt(4)
  v_mfma_f32_16x16x32_bf16 v[36:39], a[108:111], v[28:31], v[36:39]
  ds_read_b128 v[20:23], v73 offset:61440
  v_mfma_f32_16x16x32_bf16 v[40:43], a[108:111], v[32:35], v[40:43]
  ds_read_b128 v[24:27], v73 offset:62464
  v_mfma_f32_16x16x32_bf16 v[44:47], a[236:239], v[28:31], v[44:47]
  v_mfma_f32_16x16x32_bf16 v[48:51], a[236:239], v[32:35], v[48:51]
  s_waitcnt lgkmcnt(4)
  v_mfma_f32_16x16x32_bf16 v[36:39], a[112:115], v[4:7], v[36:39]
  ds_read_b128 v[28:31], v73 offset:63488
  v_mfma_f32_16x16x32_bf16 v[40:43], a[112:115], v[8:11], v[40:43]
  ds_read_b128 v[32:35], v73 offset:64512
  v_mfma_f32_16x16x32_bf16 v[44:47], a[240:243], v[4:7], v[44:47]
  v_mfma_f32_16x16x32_bf16 v[48:51], a[240:243], v[8:11], v[48:51]
  s_waitcnt lgkmcnt(4)
  v_mfma_f32_16x16x32_bf16 v[36:39], a[116:119], v[12:15], v[36:39]
  v_mfma_f32_16x16x32_bf16 v[40:43], a[116:119], v[16:19], v[40:43]
  v_mfma_f32_16x16x32_bf16 v[44:47], a[244:247], v[12:15], v[44:47]
  v_mfma_f32_16x16x32_bf16 v[48:51], a[244:247], v[16:19], v[48:51]
  s_waitcnt vmcnt(0)
  s_barrier
  ds_read_b32 v3, v71
  s_waitcnt lgkmcnt(2)
  v_mfma_f32_16x16x32_bf16 v[36:39], a[120:123], v[20:23], v[36:39]
  v_mfma_f32_16x16x32_bf16 v[40:43], a[120:123], v[24:27], v[40:43]
  v_mfma_f32_16x16x32_bf16 v[44:47], a[248:251], v[20:23], v[44:47]
  v_mfma_f32_16x16x32_bf16 v[48:51], a[248:251], v[24:27], v[48:51]
  s_waitcnt lgkmcnt(0)
  v_mfma_f32_16x16x32_bf16 v[36:39], a[124:127], v[28:31], v[36:39]
  v_mfma_f32_16x16x32_bf16 v[40:43], a[124:127], v[32:35], v[40:43]
  v_mfma_f32_16x16x32_bf16 v[44:47], a[252:255], v[28:31], v[44:47]
  v_mfma_f32_16x16x32_bf16 v[48:51], a[252:255], v[32:35], v[48:51]
  v_cmp_gt_i32 vcc, s29, v3
  s_cmp_eq_u64 vcc, 0
  s_cselect_b32 s28, 2, 0
  s_cmp_lt_u32 s25, 63
  s_cselect_b32 s28, s28, 0
L_F1_epi:
  v_mul_f32 v52, s37, v36
  v_mul_f32 v53, s37, v37
  v_mul_f32 v54, s37, v38
  v_mul_f32 v55, s37, v39
  v_mul_f32 v56, s37, v40
  v_mul_f32 v57, s37, v41
  v_mul_f32 v58, s37, v42
  v_mul_f32 v59, s37, v43
  v_exp_f32 v52, v52
  v_exp_f32 v53, v53
  v_exp_f32 v54, v54
  v_exp_f32 v55, v55
  v_exp_f32 v56, v56
  v_exp_f32 v57, v57
  v_exp_f32 v58, v58
  v_exp_f32 v59, v59
  v_pk_mul_f32 v[36:37], v[36:37], v[44:45]
  v_pk_mul_f32 v[38:39], v[38:39], v[46:47]
  v_pk_mul_f32 v[40:41], v[40:41], v[48:49]
  v_pk_mul_f32 v[42:43], v[42:43], v[50:51]
  v_add_f32 v52, 1.0, v52
  v_add_f32 v53, 1.0, v53
  v_add_f32 v54, 1.0, v54
  v_add_f32 v55, 1.0, v55
  v_add_f32 v56, 1.0, v56
  v_add_f32 v57, 1.0, v57
  v_add_f32 v58, 1.0, v58
  v_add_f32 v59, 1.0, v59
  v_rcp_f32 v52, v52
  v_rcp_f32 v53, v53
  v_rcp_f32 v54, v54
  v_rcp_f32 v55, v55
  v_rcp_f32 v56, v56
  v_rcp_f32 v57, v57
  v_rcp_f32 v58, v58
  v_rcp_f32 v59, v59
  v_pk_mul_f32 v[36:37], v[36:37], v[52:53]
  v_pk_mul_f32 v[38:39], v[38:39], v[54:55]
  v_pk_mul_f32 v[40:41], v[40:41], v[56:57]
  v_pk_mul_f32 v[42:43], v[42:43], v[58:59]
  v_cvt_pk_bf16_f32 v60, v36, v37
  v_cvt_pk_bf16_f32 v61, v38, v39
  v_cvt_pk_bf16_f32 v62, v40, v41
  v_cvt_pk_bf16_f32 v63, v42, v43
  s_nop 0
  v_permlane32_swap_b32 v60, v62
  v_permlane32_swap_b32 v61, v63
  buffer_store_dwordx4 v[60:63], v68, s[4:7], s31 offen sc1
  s_add_u32 s25, s25, 1
  s_add_u32 s31, s31, 2097152
  s_xor_b32 s31, s31, 0x2000
  s_branch L_F1_top
L_F2:
  v_lshlrev_b32 v1, 4, v0
  s_lshl_b32 s32, s20, 12
  s_min_u32 s33, s32, 0x2000
  v_mov_b32 v69, v1
  v_add_u32 v70, 0x10000, v69
  s_load_dwordx2 s[8:9], s[0:1], 80
  s_mov_b32 s10, 7340032
  s_mov_b32 s11, 0x20000
  s_waitcnt lgkmcnt(0)
  s_lshr_b32 s44, s21, 3
  s_mul_i32 s44, s44, 2490368
  s_and_b32 s45, s21, 7
  s_lshl_b32 s45, s45, 8
  s_add_u32 s44, s44, s45
  s_add_u32 s45, s44, 128
  s_cmp_ge_u32 s21, 16
  s_cselect_b32 s40, 131072, 0
  s_sub_u32 s44, s44, s40
  s_sub_u32 s45, s45, s40
  v_bfe_u32 v4, v0, 5, 1
  v_mul_u32_u24 v4, 8192, v4
  v_bfe_u32 v5, v0, 4, 1
  v_mul_u32_u24 v5, 4096, v5
  v_add_u32 v4, v4, v5
  v_bfe_u32 v5, v0, 3, 1
  v_mul_u32_u24 v5, 2048, v5
  v_add_u32 v4, v4, v5
  v_lshrrev_b32 v5, 3, v0
  v_and_b32 v5, 6, v5
  v_xor_b32 v5, v5, v0
  v_and_b32 v5, 7, v5
  v_lshl_add_u32 v4, v5, 4, v4
  s_lshr_b32 s40, s20, 1
  s_mul_i32 s40, s40, 16384
  s_and_b32 s41, s20, 1
  s_mul_i32 s41, s41, 32768
  s_add_u32 s40, s40, s41
  v_add_u32 v4, s40, v4
  v_bfe_u32 v5, v0, 3, 2
  v_xor_b32 v5, s20, v5
  v_lshlrev_b32 v5, 5, v5
  v_lshrrev_b32 v6, 2, v0
  v_lshl_add_u32 v6, v6, 7, v5
  v_and_b32 v5, 3, v0
  v_lshl_add_u32 v6, v5, 3, v6
  v_add_u32 v7, 0x10000, v6
  v_add_u32 v8, s44, v4
  v_add_u32 v9, s45, v4
  s_lshl_b32 s41, s20, 10
  s_add_u32 m0, s41, 0
  s_mov_b32 s42, 0
  buffer_load_dwordx4 v8, s[8:11], s42 offen nt lds
  s_add_u32 m0, s41, 4096
  s_mov_b32 s42, 0
  buffer_load_dwordx4 v9, s[8:11], s42 offen nt lds
  s_add_u32 m0, s41, 8192
  s_mov_b32 s42, 65536
  buffer_load_dwordx4 v8, s[8:11], s42 offen nt lds
  s_add_u32 m0, s41, 12288
  s_mov_b32 s42, 65536
  buffer_load_dwordx4 v9, s[8:11], s42 offen nt lds
  s_add_u32 m0, s41, 16384
  s_mov_b32 s42, 131072
  buffer_load_dwordx4 v8, s[8:11], s42 offen nt lds
  s_add_u32 m0, s41, 20480
  s_mov_b32 s42, 131072
  buffer_load_dwordx4 v9, s[8:11], s42 offen nt lds
  s_add_u32 m0, s41, 24576
  s_mov_b32 s42, 196608
  buffer_load_dwordx4 v8, s[8:11], s42 offen nt lds
  s_add_u32 m0, s41, 28672
  s_mov_b32 s42, 196608
  buffer_load_dwordx4 v9, s[8:11], s42 offen nt lds
  s_add_u32 m0, s41, 32768
  s_mov_b32 s42, 262144
  buffer_load_dwordx4 v8, s[8:11], s42 offen nt lds
  s_add_u32 m0, s41, 36864
  s_mov_b32 s42, 262144
  buffer_load_dwordx4 v9, s[8:11], s42 offen nt lds
  s_add_u32 m0, s41, 40960
  s_mov_b32 s42, 327680
  buffer_load_dwordx4 v8, s[8:11], s42 offen nt lds
  s_add_u32 m0, s41, 45056
  s_mov_b32 s42, 327680
  buffer_load_dwordx4 v9, s[8:11], s42 offen nt lds
  s_add_u32 m0, s41, 49152
  s_mov_b32 s42, 393216
  buffer_load_dwordx4 v8, s[8:11], s42 offen nt lds
  s_add_u32 m0, s41, 53248
  s_mov_b32 s42, 393216
  buffer_load_dwordx4 v9, s[8:11], s42 offen nt lds
  s_add_u32 m0, s41, 57344
  s_mov_b32 s42, 458752
  buffer_load_dwordx4 v8, s[8:11], s42 offen nt lds
  s_add_u32 m0, s41, 61440
  s_mov_b32 s42, 458752
  buffer_load_dwordx4 v9, s[8:11], s42 offen nt lds
  s_add_u32 m0, s41, 65536
  s_mov_b32 s42, 524288
  buffer_load_dwordx4 v8, s[8:11], s42 offen nt lds
  s_add_u32 m0, s41, 69632
  s_mov_b32 s42, 524288
  buffer_load_dwordx4 v9, s[8:11], s42 offen nt lds
  s_add_u32 m0, s41, 73728
  s_mov_b32 s42, 589824
  buffer_load_dwordx4 v8, s[8:11], s42 offen nt lds
  s_add_u32 m0, s41, 77824
  s_mov_b32 s42, 589824
  buffer_load_dwordx4 v9, s[8:11], s42 offen nt lds
  s_add_u32 m0, s41, 81920
  s_mov_b32 s42, 655360
  buffer_load_dwordx4 v8, s[8:11], s42 offen nt lds
  s_add_u32 m0, s41, 86016
  s_mov_b32 s42, 655360
  buffer_load_dwordx4 v9, s[8:11], s42 offen nt lds
  s_add_u32 m0, s41, 90112
  s_mov_b32 s42, 720896
  buffer_load_dwordx4 v8, s[8:11], s42 offen nt lds
  s_add_u32 m0, s41, 94208
  s_mov_b32 s42, 720896
  buffer_load_dwordx4 v9, s[8:11], s42 offen nt lds
  s_add_u32 m0, s41, 98304
  s_mov_b32 s42, 786432
  buffer_load_dwordx4 v8, s[8:11], s42 offen nt lds
  s_add_u32 m0, s41, 102400
  s_mov_b32 s42, 786432
  buffer_load_dwordx4 v9, s[8:11], s42 offen nt lds
  s_add_u32 m0, s41, 106496
  s_mov_b32 s42, 851968
  buffer_load_dwordx4 v8, s[8:11], s42 offen nt lds
  s_add_u32 m0, s41, 110592
  s_mov_b32 s42, 851968
  buffer_load_dwordx4 v9, s[8:11], s42 offen nt lds
  s_waitcnt vmcnt(24) lgkmcnt(0)
  s_barrier
  s_add_u32 m0, s41, 114688
  s_mov_b32 s42, 917504
  buffer_load_dwordx4 v8, s[8:11], s42 offen nt lds
  s_add_u32 m0, s41, 118784
  s_mov_b32 s42, 917504
  buffer_load_dwordx4 v9, s[8:11], s42 offen nt lds
  s_add_u32 m0, s41, 122880
  s_mov_b32 s42, 983040
  buffer_load_dwordx4 v8, s[8:11], s42 offen nt lds
  s_add_u32 m0, s41, 126976
  s_mov_b32 s42, 983040
  buffer_load_dwordx4 v9, s[8:11], s42 offen nt lds
  ds_read_b64_tr_b16 a[0:1], v6 offset:0
  ds_read_b64_tr_b16 a[2:3], v6 offset:2048
  ds_read_b64_tr_b16 a[152:153], v6 offset:4096
  ds_read_b64_tr_b16 a[154:155], v6 offset:6144
  ds_read_b64_tr_b16 a[4:5], v6 offset:8192
  ds_read_b64_tr_b16 a[6:7], v6 offset:10240
  ds_read_b64_tr_b16 a[156:157], v6 offset:12288
  ds_read_b64_tr_b16 a[158:159], v6 offset:14336
  s_waitcnt vmcnt(24) lgkmcnt(0)
  s_barrier
  s_add_u32 m0, s41, 0
  s_mov_b32 s42, 1048576
  buffer_load_dwordx4 v8, s[8:11], s42 offen nt lds
  s_add_u32 m0, s41, 4096
  s_mov_b32 s42, 1048576
  buffer_load_dwordx4 v9, s[8:11], s42 offen nt lds
  s_add_u32 m0, s41, 8192
  s_mov_b32 s42, 1114112
  buffer_load_dwordx4 v8, s[8:11], s42 offen nt lds
  s_add_u32 m0, s41, 12288
  s_mov_b32 s42, 1114112
  buffer_load_dwordx4 v9, s[8:11], s42 offen nt lds
  ds_read_b64_tr_b16 a[8:9], v6 offset:16384
  ds_read_b64_tr_b16 a[10:11], v6 offset:18432
  ds_read_b64_tr_b16 a[160:161], v6 offset:20480
  ds_read_b64_tr_b16 a[162:163], v6 offset:22528
  ds_read_b64_tr_b16 a[12:13], v6 offset:24576
  ds_read_b64_tr_b16 a[14:15], v6 offset:26624
  ds_read_b64_tr_b16 a[164:165], v6 offset:28672
  ds_read_b64_tr_b16 a[166:167], v6 offset:30720
  s_waitcnt vmcnt(24) lgkmcnt(0)
  s_barrier
  s_add_u32 m0, s41, 16384
  s_mov_b32 s42, 1179648
  buffer_load_dwordx4 v8, s[8:11], s42 offen nt lds
  s_add_u32 m0, s41, 20480
  s_mov_b32 s42, 1179648
  buffer_load_dwordx4 v9, s[8:11], s42 offen nt lds
  s_add_u32 m0, s41, 24576
  s_mov_b32 s42, 1245184
  buffer_load_dwordx4 v8, s[8:11], s42 offen nt lds
  s_add_u32 m0, s41, 28672
  s_mov_b32 s42, 1245184
  buffer_load_dwordx4 v9, s[8:11], s42 offen nt lds
  ds_read_b64_tr_b16 a[16:17], v6 offset:32768
  ds_read_b64_tr_b16 a[18:19], v6 offset:34816
  ds_read_b64_tr_b16 a[168:169], v6 offset:36864
  ds_read_b64_tr_b16 a[170:171], v6 offset:38912
  ds_read_b64_tr_b16 a[20:21], v6 offset:40960
  ds_read_b64_tr_b16 a[22:23], v6 offset:43008
  ds_read_b64_tr_b16 a[172:173], v6 offset:45056
  ds_read_b64_tr_b16 a[174:175], v6 offset:47104
  s_waitcnt vmcnt(24) lgkmcnt(0)
  s_barrier
  s_add_u32 m0, s41, 32768
  s_mov_b32 s42, 1310720
  buffer_load_dwordx4 v8, s[8:11], s42 offen nt lds
  s_add_u32 m0, s41, 36864
  s_mov_b32 s42, 1310720
  buffer_load_dwordx4 v9, s[8:11], s42 offen nt lds
  s_add_u32 m0, s41, 40960
  s_mov_b32 s42, 1376256
  buffer_load_dwordx4 v8, s[8:11], s42 offen nt lds
  s_add_u32 m0, s41, 45056
  s_mov_b32 s42, 1376256
  buffer_load_dwordx4 v9, s[8:11], s42 offen nt lds
  ds_read_b64_tr_b16 a[24:25], v6 offset:49152
  ds_read_b64_tr_b16 a[26:27], v6 offset:51200
  ds_read_b64_tr_b16 a[176:177], v6 offset:53248
  ds_read_b64_tr_b16 a[178:179], v6 offset:55296
  ds_read_b64_tr_b16 a[28:29], v6 offset:57344
  ds_read_b64_tr_b16 a[30:31], v6 offset:59392
  ds_read_b64_tr_b16 a[180:181], v6 offset:61440
  ds_read_b64_tr_b16 a[182:183], v6 offset:63488
  s_waitcnt vmcnt(24) lgkmcnt(0)
  s_barrier
  s_add_u32 m0, s41, 49152
  s_mov_b32 s42, 1441792
  buffer_load_dwordx4 v8, s[8:11], s42 offen nt lds
  s_add_u32 m0, s41, 53248
  s_mov_b32 s42, 1441792
  buffer_load_dwordx4 v9, s[8:11], s42 offen nt lds
  s_add_u32 m0, s41, 57344
  s_mov_b32 s42, 1507328
  buffer_load_dwordx4 v8, s[8:11], s42 offen nt lds
  s_add_u32 m0, s41, 61440
  s_mov_b32 s42, 1507328
  buffer_load_dwordx4 v9, s[8:11], s42 offen nt lds
  ds_read_b64_tr_b16 a[32:33], v7 offset:0
  ds_read_b64_tr_b16 a[34:35], v7 offset:2048
  ds_read_b64_tr_b16 a[184:185], v7 offset:4096
  ds_read_b64_tr_b16 a[186:187], v7 offset:6144
  ds_read_b64_tr_b16 a[36:37], v7 offset:8192
  ds_read_b64_tr_b16 a[38:39], v7 offset:10240
  ds_read_b64_tr_b16 a[188:189], v7 offset:12288
  ds_read_b64_tr_b16 a[190:191], v7 offset:14336
  s_waitcnt vmcnt(24) lgkmcnt(0)
  s_barrier
  s_add_u32 m0, s41, 65536
  s_mov_b32 s42, 1572864
  buffer_load_dwordx4 v8, s[8:11], s42 offen nt lds
  s_add_u32 m0, s41, 69632
  s_mov_b32 s42, 1572864
  buffer_load_dwordx4 v9, s[8:11], s42 offen nt lds
  s_add_u32 m0, s41, 73728
  s_mov_b32 s42, 1638400
  buffer_load_dwordx4 v8, s[8:11], s42 offen nt lds
  s_add_u32 m0, s41, 77824
  s_mov_b32 s42, 1638400
  buffer_load_dwordx4 v9, s[8:11], s42 offen nt lds
  ds_read_b64_tr_b16 a[40:41], v7 offset:16384
  ds_read_b64_tr_b16 a[42:43], v7 offset:18432
  ds_read_b64_tr_b16 a[192:193], v7 offset:20480
  ds_read_b64_tr_b16 a[194:195], v7 offset:22528
  ds_read_b64_tr_b16 a[44:45], v7 offset:24576
  ds_read_b64_tr_b16 a[46:47], v7 offset:26624
  ds_read_b64_tr_b16 a[196:197], v7 offset:28672
  ds_read_b64_tr_b16 a[198:199], v7 offset:30720
  s_waitcnt vmcnt(24) lgkmcnt(0)
  s_barrier
  s_add_u32 m0, s41, 81920
  s_mov_b32 s42, 1703936
  buffer_load_dwordx4 v8, s[8:11], s42 offen nt lds
  s_add_u32 m0, s41, 86016
  s_mov_b32 s42, 1703936
  buffer_load_dwordx4 v9, s[8:11], s42 offen nt lds
  s_add_u32 m0, s41, 90112
  s_mov_b32 s42, 1769472
  buffer_load_dwordx4 v8, s[8:11], s42 offen nt lds
  s_add_u32 m0, s41, 94208
  s_mov_b32 s42, 1769472
  buffer_load_dwordx4 v9, s[8:11], s42 offen nt lds
  ds_read_b64_tr_b16 a[48:49], v7 offset:32768
  ds_read_b64_tr_b16 a[50:51], v7 offset:34816
  ds_read_b64_tr_b16 a[200:201], v7 offset:36864
  ds_read_b64_tr_b16 a[202:203], v7 offset:38912
  ds_read_b64_tr_b16 a[52:53], v7 offset:40960
  ds_read_b64_tr_b16 a[54:55], v7 offset:43008
  ds_read_b64_tr_b16 a[204:205], v7 offset:45056
  ds_read_b64_tr_b16 a[206:207], v7 offset:47104
  s_waitcnt vmcnt(24) lgkmcnt(0)
  s_barrier
  s_add_u32 m0, s41, 98304
  s_mov_b32 s42, 1835008
  buffer_load_dwordx4 v8, s[8:11], s42 offen nt lds
  s_add_u32 m0, s41, 102400
  s_mov_b32 s42, 1835008
  buffer_load_dwordx4 v9, s[8:11], s42 offen nt lds
  s_add_u32 m0, s41, 106496
  s_mov_b32 s42, 1900544
  buffer_load_dwordx4 v8, s[8:11], s42 offen nt lds
  s_add_u32 m0, s41, 110592
  s_mov_b32 s42, 1900544
  buffer_load_dwordx4 v9, s[8:11], s42 offen nt lds
  ds_read_b64_tr_b16 a[56:57], v7 offset:49152
  ds_read_b64_tr_b16 a[58:59], v7 offset:51200
  ds_read_b64_tr_b16 a[208:209], v7 offset:53248
  ds_read_b64_tr_b16 a[210:211], v7 offset:55296
  ds_read_b64_tr_b16 a[60:61], v7 offset:57344
  ds_read_b64_tr_b16 a[62:63], v7 offset:59392
  ds_read_b64_tr_b16 a[212:213], v7 offset:61440
  ds_read_b64_tr_b16 a[214:215], v7 offset:63488
  s_waitcnt vmcnt(24) lgkmcnt(0)
  s_barrier
  s_add_u32 m0, s41, 114688
  s_mov_b32 s42, 1966080
  buffer_load_dwordx4 v8, s[8:11], s42 offen nt lds
  s_add_u32 m0, s41, 118784
  s_mov_b32 s42, 1966080
  buffer_load_dwordx4 v9, s[8:11], s42 offen nt lds
  s_add_u32 m0, s41, 122880
  s_mov_b32 s42, 2031616
  buffer_load_dwordx4 v8, s[8:11], s42 offen nt lds
  s_add_u32 m0, s41, 126976
  s_mov_b32 s42, 2031616
  buffer_load_dwordx4 v9, s[8:11], s42 offen nt lds
  ds_read_b64_tr_b16 a[64:65], v6 offset:0
  ds_read_b64_tr_b16 a[66:67], v6 offset:2048
  ds_read_b64_tr_b16 a[216:217], v6 offset:4096
  ds_read_b64_tr_b16 a[218:219], v6 offset:6144
  ds_read_b64_tr_b16 a[68:69], v6 offset:8192
  ds_read_b64_tr_b16 a[70:71], v6 offset:10240
  ds_read_b64_tr_b16 a[220:221], v6 offset:12288
  ds_read_b64_tr_b16 a[222:223], v6 offset:14336
  s_waitcnt vmcnt(24) lgkmcnt(0)
  s_barrier
  s_add_u32 m0, s41, 0
  s_mov_b32 s42, 2097152
  buffer_load_dwordx4 v8, s[8:11], s42 offen nt lds
  s_add_u32 m0, s41, 4096
  s_mov_b32 s42, 2097152
  buffer_load_dwordx4 v9, s[8:11], s42 offen nt lds
  s_add_u32 m0, s41, 8192
  s_mov_b32 s42, 2162688
  buffer_load_dwordx4 v8, s[8:11], s42 offen nt lds
  s_add_u32 m0, s41, 12288
  s_mov_b32 s42, 2162688
  buffer_load_dwordx4 v9, s[8:11], s42 offen nt lds
  ds_read_b64_tr_b16 a[72:73], v6 offset:16384
  ds_read_b64_tr_b16 a[74:75], v6 offset:18432
  ds_read_b64_tr_b16 a[224:225], v6 offset:20480
  ds_read_b64_tr_b16 a[226:227], v6 offset:22528
  ds_read_b64_tr_b16 a[76:77], v6 offset:24576
  ds_read_b64_tr_b16 a[78:79], v6 offset:26624
  ds_read_b64_tr_b16 a[228:229], v6 offset:28672
  ds_read_b64_tr_b16 a[230:231], v6 offset:30720
  s_waitcnt vmcnt(24) lgkmcnt(0)
  s_barrier
  s_add_u32 m0, s41, 16384
  s_mov_b32 s42, 2228224
  buffer_load_dwordx4 v8, s[8:11], s42 offen nt lds
  s_add_u32 m0, s41, 20480
  s_mov_b32 s42, 2228224
  buffer_load_dwordx4 v9, s[8:11], s42 offen nt lds
  s_add_u32 m0, s41, 24576
  s_mov_b32 s42, 2293760
  buffer_load_dwordx4 v8, s[8:11], s42 offen nt lds
  s_add_u32 m0, s41, 28672
  s_mov_b32 s42, 2293760
  buffer_load_dwordx4 v9, s[8:11], s42 offen nt lds
  ds_read_b64_tr_b16 a[80:81], v6 offset:32768
  ds_read_b64_tr_b16 a[82:83], v6 offset:34816
  ds_read_b64_tr_b16 a[232:233], v6 offset:36864
  ds_read_b64_tr_b16 a[234:235], v6 offset:38912
  ds_read_b64_tr_b16 a[84:85], v6 offset:40960
  ds_read_b64_tr_b16 a[86:87], v6 offset:43008
  ds_read_b64_tr_b16 a[236:237], v6 offset:45056
  ds_read_b64_tr_b16 a[238:239], v6 offset:47104
  s_waitcnt vmcnt(24) lgkmcnt(0)
  s_barrier
  s_add_u32 m0, s41, 32768
  s_mov_b32 s42, 2359296
  buffer_load_dwordx4 v8, s[8:11], s42 offen nt lds
  s_add_u32 m0, s41, 36864
  s_mov_b32 s42, 2359296
  buffer_load_dwordx4 v9, s[8:11], s42 offen nt lds
  s_add_u32 m0, s41, 40960
  s_mov_b32 s42, 2424832
  buffer_load_dwordx4 v8, s[8:11], s42 offen nt lds
  s_add_u32 m0, s41, 45056
  s_mov_b32 s42, 2424832
  buffer_load_dwordx4 v9, s[8:11], s42 offen nt lds
  ds_read_b64_tr_b16 a[88:89], v6 offset:49152
  ds_read_b64_tr_b16 a[90:91], v6 offset:51200
  ds_read_b64_tr_b16 a[240:241], v6 offset:53248
  ds_read_b64_tr_b16 a[242:243], v6 offset:55296
  ds_read_b64_tr_b16 a[92:93], v6 offset:57344
  ds_read_b64_tr_b16 a[94:95], v6 offset:59392
  ds_read_b64_tr_b16 a[244:245], v6 offset:61440
  ds_read_b64_tr_b16 a[246:247], v6 offset:63488
  s_waitcnt vmcnt(24) lgkmcnt(0)
  s_barrier
  ds_read_b64_tr_b16 a[96:97], v7 offset:0
  ds_read_b64_tr_b16 a[98:99], v7 offset:2048
  ds_read_b64_tr_b16 a[248:249], v7 offset:4096
  ds_read_b64_tr_b16 a[250:251], v7 offset:6144
  ds_read_b64_tr_b16 a[100:101], v7 offset:8192
  ds_read_b64_tr_b16 a[102:103], v7 offset:10240
  ds_read_b64_tr_b16 a[252:253], v7 offset:12288
  ds_read_b64_tr_b16 a[254:255], v7 offset:14336
  s_waitcnt vmcnt(20) lgkmcnt(0)
  s_barrier
  ds_read_b64_tr_b16 a[104:105], v7 offset:16384
  ds_read_b64_tr_b16 a[106:107], v7 offset:18432
  ds_read_b64_tr_b16 v[128:129], v7 offset:20480
  ds_read_b64_tr_b16 v[130:131], v7 offset:22528
  ds_read_b64_tr_b16 a[108:109], v7 offset:24576
  ds_read_b64_tr_b16 a[110:111], v7 offset:26624
  ds_read_b64_tr_b16 v[132:133], v7 offset:28672
  ds_read_b64_tr_b16 v[134:135], v7 offset:30720
  s_waitcnt vmcnt(16) lgkmcnt(0)
  s_barrier
  ds_read_b64_tr_b16 a[112:113], v7 offset:32768
  ds_read_b64_tr_b16 a[114:115], v7 offset:34816
  ds_read_b64_tr_b16 v[136:137], v7 offset:36864
  ds_read_b64_tr_b16 v[138:139], v7 offset:38912
  ds_read_b64_tr_b16 a[116:117], v7 offset:40960
  ds_read_b64_tr_b16 a[118:119], v7 offset:43008
  ds_read_b64_tr_b16 v[140:141], v7 offset:45056
  ds_read_b64_tr_b16 v[142:143], v7 offset:47104
  s_waitcnt vmcnt(12) lgkmcnt(0)
  s_barrier
  ds_read_b64_tr_b16 a[120:121], v7 offset:49152
  ds_read_b64_tr_b16 a[122:123], v7 offset:51200
  ds_read_b64_tr_b16 v[144:145], v7 offset:53248
  ds_read_b64_tr_b16 v[146:147], v7 offset:55296
  ds_read_b64_tr_b16 a[124:125], v7 offset:57344
  ds_read_b64_tr_b16 a[126:127], v7 offset:59392
  ds_read_b64_tr_b16 v[148:149], v7 offset:61440
  ds_read_b64_tr_b16 v[150:151], v7 offset:63488
  s_waitcnt vmcnt(8) lgkmcnt(0)
  s_barrier
  ds_read_b64_tr_b16 a[128:129], v6 offset:0
  ds_read_b64_tr_b16 a[130:131], v6 offset:2048
  ds_read_b64_tr_b16 v[152:153], v6 offset:4096
  ds_read_b64_tr_b16 v[154:155], v6 offset:6144
  ds_read_b64_tr_b16 a[132:133], v6 offset:8192
  ds_read_b64_tr_b16 a[134:135], v6 offset:10240
  ds_read_b64_tr_b16 v[156:157], v6 offset:12288
  ds_read_b64_tr_b16 v[158:159], v6 offset:14336
  s_waitcnt vmcnt(4) lgkmcnt(0)
  s_barrier
  ds_read_b64_tr_b16 a[136:137], v6 offset:16384
  ds_read_b64_tr_b16 a[138:139], v6 offset:18432
  ds_read_b64_tr_b16 v[160:161], v6 offset:20480
  ds_read_b64_tr_b16 v[162:163], v6 offset:22528
  ds_read_b64_tr_b16 a[140:141], v6 offset:24576
  ds_read_b64_tr_b16 a[142:143], v6 offset:26624
  ds_read_b64_tr_b16 v[164:165], v6 offset:28672
  ds_read_b64_tr_b16 v[166:167], v6 offset:30720
  s_waitcnt vmcnt(0) lgkmcnt(0)
  s_barrier
  ds_read_b64_tr_b16 a[144:145], v6 offset:32768
  ds_read_b64_tr_b16 a[146:147], v6 offset:34816
  ds_read_b64_tr_b16 v[168:169], v6 offset:36864
  ds_read_b64_tr_b16 v[170:171], v6 offset:38912
  ds_read_b64_tr_b16 a[148:149], v6 offset:40960
  ds_read_b64_tr_b16 a[150:151], v6 offset:43008
  ds_read_b64_tr_b16 v[172:173], v6 offset:45056
  ds_read_b64_tr_b16 v[174:175], v6 offset:47104
  s_waitcnt lgkmcnt(0)
  s_barrier
  s_cmp_lt_u32 s21, 16
  s_cbranch_scc1 L_F2_keep
  v_accvgpr_write_b32 a0, 0
  v_accvgpr_write_b32 a1, 0
  v_accvgpr_write_b32 a2, 0
  v_accvgpr_write_b32 a3, 0
  v_accvgpr_write_b32 a4, 0
  v_accvgpr_write_b32 a5, 0
  v_accvgpr_write_b32 a6, 0
  v_accvgpr_write_b32 a7, 0
  v_accvgpr_write_b32 a152, 0
  v_accvgpr_write_b32 a153, 0
  v_accvgpr_write_b32 a154, 0
  v_accvgpr_write_b32 a155, 0
  v_accvgpr_write_b32 a156, 0
  v_accvgpr_write_b32 a157, 0
  v_accvgpr_write_b32 a158, 0
  v_accvgpr_write_b32 a159, 0
  s_nop 1
L_F2_keep:
  v_min_u32 v52, 63, v0
  v_lshlrev_b32 v52, 7, v52
  v_add_u32 v52, 1424384, v52
  s_nop 1
Lpoll_150:
  buffer_load_dword v53, v52, s[4:7], 0 offen sc1
  s_sub_u32 s24, s24, 1
  s_cbranch_scc1 L_FAIL
  s_waitcnt vmcnt(0)
  v_cmp_gt_i32 vcc, 0, v53
  s_cbranch_vccz Lpolld_151
  s_sleep 1
  s_branch Lpoll_150
Lpolld_151:
Ltab_149:
  v_lshrrev_b32 v53, 8, v53
  v_and_b32 v54, 3, v0
  v_lshl_or_b32 v53, v53, 2, v54
  s_nop 1
  v_min_u32_dpp v53, v53, v53 row_ror:8 row_mask:0xf bank_mask:0xf
  s_nop 1
  v_min_u32_dpp v53, v53, v53 row_ror:4 row_mask:0xf bank_mask:0xf
  v_mov_b32 v54, v53
  s_nop 1
  v_permlane16_swap_b32 v54, v53
  v_min_u32 v53, v53, v54
  v_mov_b32 v54, v53
  s_nop 1
  v_permlane32_swap_b32 v54, v53
  v_min_u32 v53, v53, v54
  s_nop 1
  v_min_u32_dpp v53, v53, v53 row_ror:2 row_mask:0xf bank_mask:0xf
  s_nop 1
  v_min_u32_dpp v53, v53, v53 row_ror:1 row_mask:0xf bank_mask:0xf
  s_nop 0
  v_readfirstlane_b32 s38, v53
  s_and_b32 s38, s38, 3
  s_lshl_b32 s38, s38, 13
  s_and_b32 s38, s38, 0x2000
  s_xor_b32 s38, s38, 20979712
  s_lshr_b32 s43, s21, 3
  s_mul_i32 s43, s43, 19
  s_min_u32 s43, s43, 37
  v_min_u32 v2, 18, v0
  v_add_u32 v2, s43, v2
  v_lshlrev_b32 v2, 7, v2
  v_add_u32 v2, 1414144, v2
  s_add_u32 s44, s43, s20
  s_min_u32 s45, s20, 2
  s_add_u32 s45, s45, s43
  s_lshr_b32 s40, s44, 1
  s_lshl_b32 s40, s40, 14
  s_and_b32 s41, s44, 1
  s_lshl_b32 s41, s41, 12
  s_add_u32 s27, s40, s41
  s_lshr_b32 s40, s45, 1
  s_lshl_b32 s40, s40, 14
  s_and_b32 s41, s45, 1
  s_lshl_b32 s41, s41, 12
  s_add_u32 s39, s40, s41
  s_sub_u32 s39, s39, s27
  s_add_u32 s27, s27, s38
  s_add_u32 s27, s27, 1179648
  s_lshl_b32 s62, s21, 7
  s_add_u32 s62, s62, 1421312
  s_lshl_b32 s40, s21, 14
  s_add_u32 s40, s40, s38
  s_add_u32 s31, s40, 524288
  s_lshl_b32 s40, s20, 11
  v_and_b32 v68, 3, v0
  v_lshlrev_b32 v68, 4, v68
  v_lshrrev_b32 v52, 4, v0
  v_lshl_add_u32 v68, v52, 6, v68
  v_bfe_u32 v52, v0, 2, 2
  v_lshl_add_u32 v68, v52, 8, v68
  v_add_u32 v68, s40, v68
  v_lshlrev_b32 v71, 2, v0
  v_add_u32 v71, 155648, v71
  s_mov_b32 s25, 0
  s_mov_b32 s26, 0
  s_mov_b32 s29, 1
  s_mov_b32 s30, 0
  s_mov_b32 s28, 0
L_F2_top:
  s_cmp_eq_u32 s28, 1
  s_cbranch_scc1 L_F2_go
  s_cmp_eq_u32 s28, 2
  s_cbranch_scc1 L_F2_mid
  s_cmp_lg_u32 s20, 0
  s_cbranch_scc1 L_F2_park
  buffer_load_dword v3, v2, s[4:7], s30 offen sc1
  s_waitcnt vmcnt(1)
  s_barrier
  s_mov_b32 s63, s25
  s_atomic_smax s63, s[4:5], s62 glc
Lnosig_152:
  s_cmp_ge_u32 s25, 64
  s_cbranch_scc1 L_END
  s_waitcnt vmcnt(0)
  v_cmp_gt_i32 vcc, s29, v3
  s_cbranch_vccz L_F2_issue
  s_nop 3
Lpoll_153:
  buffer_load_dword v3, v2, s[4:7], s30 offen sc1
  s_sub_u32 s24, s24, 1
  s_cbranch_scc1 L_FAIL
  s_waitcnt vmcnt(0)
  v_cmp_gt_i32 vcc, s29, v3
  s_cbranch_vccz Lpolld_154
  s_sleep 1
  s_branch Lpoll_153
Lpolld_154:
  s_branch L_F2_issue
L_F2_park:
  s_waitcnt vmcnt(0)
  s_barrier
  s_cmp_ge_u32 s25, 64
  s_cbranch_scc1 L_END
L_F2_issue:
  s_barrier
L_F2_mid:
  s_mov_b32 s34, s26
  s_mov_b32 s35, s27
  s_add_u32 s36, s32, 0
  s_add_u32 m0, s34, s36
  s_add_u32 s36, s35, 0
  buffer_load_dwordx4 v1, s[4:7], s36 offen offset:0 sc1 lds
  s_nop 0
  buffer_load_dwordx4 v1, s[4:7], s36 offen offset:1024 sc1 lds
  s_nop 0
  buffer_load_dwordx4 v1, s[4:7], s36 offen offset:2048 sc1 lds
  s_nop 0
  buffer_load_dwordx4 v1, s[4:7], s36 offen offset:3072 sc1 lds
  s_nop 0
  s_add_u32 s36, s32, 16384
  s_add_u32 m0, s34, s36
  s_add_u32 s36, s35, 32768
  buffer_load_dwordx4 v1, s[4:7], s36 offen offset:0 sc1 lds
  s_nop 0
  buffer_load_dwordx4 v1, s[4:7], s36 offen offset:1024 sc1 lds
  s_nop 0
  buffer_load_dwordx4 v1, s[4:7], s36 offen offset:2048 sc1 lds
  s_nop 0
  buffer_load_dwordx4 v1, s[4:7], s36 offen offset:3072 sc1 lds
  s_nop 0
  s_add_u32 s36, s32, 32768
  s_add_u32 m0, s34, s36
  s_add_u32 s36, s35, 65536
  buffer_load_dwordx4 v1, s[4:7], s36 offen offset:0 sc1 lds
  s_nop 0
  buffer_load_dwordx4 v1, s[4:7], s36 offen offset:1024 sc1 lds
  s_nop 0
  buffer_load_dwordx4 v1, s[4:7], s36 offen offset:2048 sc1 lds
  s_nop 0
  buffer_load_dwordx4 v1, s[4:7], s36 offen offset:3072 sc1 lds
  s_nop 0
  s_cmp_eq_u32 s28, 0
  s_cbranch_scc1 L_F2_go
  s_mov_b32 s28, 0
  s_waitcnt vmcnt(12)
  s_barrier
  s_cmp_lg_u32 s20, 0
  s_cbranch_scc1 Lnosig_155
  s_mov_b32 s63, s25
  s_atomic_smax s63, s[4:5], s62 glc
Lnosig_155:
L_F2_go:
  v_add_u32 v73, s26, v69
  v_add_u32 v74, s26, v70
  s_sub_u32 s26, 77824, s26
  s_add_u32 s27, s27, 2097152
  s_xor_b32 s27, s27, 0x2000
  s_add_u32 s29, s29, 1
  s_waitcnt vmcnt(8)
  s_barrier
  ds_read_b128 v[4:7], v73 offset:0
  ds_read_b128 v[8:11], v73 offset:1024
  ds_read_b128 v[12:15], v73 offset:2048
  ds_read_b128 v[16:19], v73 offset:3072
  ds_read_b128 v[20:23], v73 offset:4096
  ds_read_b128 v[24:27], v73 offset:5120
  s_waitcnt lgkmcnt(4)
  v_mfma_f32_16x16x32_bf16 v[36:39], a[0:3], v[4:7], 0
  ds_read_b128 v[28:31], v73 offset:6144
  v_mfma_f32_16x16x32_bf16 v[40:43], a[0:3], v[8:11], 0
  ds_read_b128 v[32:35], v73 offset:7168
  v_mfma_f32_16x16x32_bf16 v[44:47], a[152:155], v[4:7], 0
  s_add_u32 s36, s32, 49152
  s_add_u32 m0, s34, s36
  s_add_u32 s36, s35, 98304
  buffer_load_dwordx4 v1, s[4:7], s36 offen offset:0 sc1 lds
  v_mfma_f32_16x16x32_bf16 v[48:51], a[152:155], v[8:11], 0
  buffer_load_dwordx4 v1, s[4:7], s36 offen offset:1024 sc1 lds
  s_waitcnt lgkmcnt(4)
  v_mfma_f32_16x16x32_bf16 v[36:39], a[4:7], v[12:15], v[36:39]
  ds_read_b128 v[4:7], v73 offset:8192
  v_mfma_f32_16x16x32_bf16 v[40:43], a[4:7], v[16:19], v[40:43]
  ds_read_b128 v[8:11], v73 offset:9216
  v_mfma_f32_16x16x32_bf16 v[44:47], a[156:159], v[12:15], v[44:47]
  buffer_load_dwordx4 v1, s[4:7], s36 offen offset:2048 sc1 lds
  v_mfma_f32_16x16x32_bf16 v[48:51], a[156:159], v[16:19], v[48:51]
  buffer_load_dwordx4 v1, s[4:7], s36 offen offset:3072 sc1 lds
  s_waitcnt lgkmcnt(4)
  v_mfma_f32_16x16x32_bf16 v[36:39], a[8:11], v[20:23], v[36:39]
  ds_read_b128 v[12:15], v73 offset:10240
  v_mfma_f32_16x16x32_bf16 v[40:43], a[8:11], v[24:27], v[40:43]
  ds_read_b128 v[16:19], v73 offset:11264
  v_mfma_f32_16x16x32_bf16 v[44:47], a[160:163], v[20:23], v[44:47]
  s_add_u32 s36, s33, 65536
  s_add_u32 m0, s34, s36
  s_add_u32 s36, s35, 131072
  s_add_u32 s36, s36, s39
  buffer_load_dwordx4 v1, s[4:7], s36 offen offset:0 sc1 lds
  v_mfma_f32_16x16x32_bf16 v[48:51], a[160:163], v[24:27], v[48:51]
  buffer_load_dwordx4 v1, s[4:7], s36 offen offset:1024 sc1 lds
  s_waitcnt lgkmcnt(4)
  v_mfma_f32_16x16x32_bf16 v[36:39], a[12:15], v[28:31], v[36:39]
  ds_read_b128 v[20:23], v73 offset:12288
  v_mfma_f32_16x16x32_bf16 v[40:43], a[12:15], v[32:35], v[40:43]
  ds_read_b128 v[24:27], v73 offset:13312
  v_mfma_f32_16x16x32_bf16 v[44:47], a[164:167], v[28:31], v[44:47]
  buffer_load_dwordx4 v1, s[4:7], s36 offen offset:2048 sc1 lds
  v_mfma_f32_16x16x32_bf16 v[48:51], a[164:167], v[32:35], v[48:51]
  buffer_load_dwordx4 v1, s[4:7], s36 offen offset:3072 sc1 lds
  s_waitcnt lgkmcnt(4)
  v_mfma_f32_16x16x32_bf16 v[36:39], a[16:19], v[4:7], v[36:39]
  ds_read_b128 v[28:31], v73 offset:14336
  v_mfma_f32_16x16x32_bf16 v[40:43], a[16:19], v[8:11], v[40:43]
  ds_read_b128 v[32:35], v73 offset:15360
  v_mfma_f32_16x16x32_bf16 v[44:47], a[168:171], v[4:7], v[44:47]
  v_mfma_f32_16x16x32_bf16 v[48:51], a[168:171], v[8:11], v[48:51]
  s_waitcnt vmcnt(12)
  s_barrier
  s_mov_b32 s34, s26
  s_mov_b32 s35, s27
  s_waitcnt lgkmcnt(4)
  v_mfma_f32_16x16x32_bf16 v[36:39], a[20:23], v[12:15], v[36:39]
  ds_read_b128 v[4:7], v73 offset:16384
  v_mfma_f32_16x16x32_bf16 v[40:43], a[20:23], v[16:19], v[40:43]
  ds_read_b128 v[8:11], v73 offset:17408
  v_mfma_f32_16x16x32_bf16 v[44:47], a[172:175], v[12:15], v[44:47]
  v_mfma_f32_16x16x32_bf16 v[48:51], a[172:175], v[16:19], v[48:51]
  s_waitcnt lgkmcnt(4)
  v_mfma_f32_16x16x32_bf16 v[36:39], a[24:27], v[20:23], v[36:39]
  ds_read_b128 v[12:15], v73 offset:18432
  v_mfma_f32_16x16x32_bf16 v[40:43], a[24:27], v[24:27], v[40:43]
  ds_read_b128 v[16:19], v73 offset:19456
  v_mfma_f32_16x16x32_bf16 v[44:47], a[176:179], v[20:23], v[44:47]
  v_mfma_f32_16x16x32_bf16 v[48:51], a[176:179], v[24:27], v[48:51]
  s_waitcnt lgkmcnt(4)
  v_mfma_f32_16x16x32_bf16 v[36:39], a[28:31], v[28:31], v[36:39]
  ds_read_b128 v[20:23], v73 offset:20480
  v_mfma_f32_16x16x32_bf16 v[40:43], a[28:31], v[32:35], v[40:43]
  ds_read_b128 v[24:27], v73 offset:21504
  v_mfma_f32_16x16x32_bf16 v[44:47], a[180:183], v[28:31], v[44:47]
  v_mfma_f32_16x16x32_bf16 v[48:51], a[180:183], v[32:35], v[48:51]
  s_waitcnt lgkmcnt(4)
  v_mfma_f32_16x16x32_bf16 v[36:39], a[32:35], v[4:7], v[36:39]
  ds_read_b128 v[28:31], v73 offset:22528
  v_mfma_f32_16x16x32_bf16 v[40:43], a[32:35], v[8:11], v[40:43]
  ds_read_b128 v[32:35], v73 offset:23552
  v_mfma_f32_16x16x32_bf16 v[44:47], a[184:187], v[4:7], v[44:47]
  v_mfma_f32_16x16x32_bf16 v[48:51], a[184:187], v[8:11], v[48:51]
  s_waitcnt lgkmcnt(4)
  v_mfma_f32_16x16x32_bf16 v[36:39], a[36:39], v[12:15], v[36:39]
  ds_read_b128 v[4:7], v73 offset:24576
  v_mfma_f32_16x16x32_bf16 v[40:43], a[36:39], v[16:19], v[40:43]
  ds_read_b128 v[8:11], v73 offset:25600
  v_mfma_f32_16x16x32_bf16 v[44:47], a[188:191], v[12:15], v[44:47]
  v_mfma_f32_16x16x32_bf16 v[48:51], a[188:191], v[16:19], v[48:51]
  s_waitcnt lgkmcnt(4)
  v_mfma_f32_16x16x32_bf16 v[36:39], a[40:43], v[20:23], v[36:39]
  ds_read_b128 v[12:15], v73 offset:26624
  v_mfma_f32_16x16x32_bf16 v[40:43], a[40:43], v[24:27], v[40:43]
  ds_read_b128 v[16:19], v73 offset:27648
  v_mfma_f32_16x16x32_bf16 v[44:47], a[192:195], v[20:23], v[44:47]
  v_mfma_f32_16x16x32_bf16 v[48:51], a[192:195], v[24:27], v[48:51]
  s_waitcnt lgkmcnt(4)
  v_mfma_f32_16x16x32_bf16 v[36:39], a[44:47], v[28:31], v[36:39]
  ds_read_b128 v[20:23], v73 offset:28672
  v_mfma_f32_16x16x32_bf16 v[40:43], a[44:47], v[32:35], v[40:43]
  ds_read_b128 v[24:27], v73 offset:29696
  v_mfma_f32_16x16x32_bf16 v[44:47], a[196:199], v[28:31], v[44:47]
  v_mfma_f32_16x16x32_bf16 v[48:51], a[196:199], v[32:35], v[48:51]
  s_lshl_b32 s40, s20, 8
  s_add_u32 m0, s40, 155648
  s_cmp_eq_u32 s20, 0
  s_cselect_b32 s40, s30, 2147483392
  buffer_load_dword v2, s[4:7], s40 offen sc1 lds
  s_waitcnt lgkmcnt(4)
  v_mfma_f32_16x16x32_bf16 v[36:39], a[48:51], v[4:7], v[36:39]
  ds_read_b128 v[28:31], v73 offset:30720
  v_mfma_f32_16x16x32_bf16 v[40:43], a[48:51], v[8:11], v[40:43]
  ds_read_b128 v[32:35], v73 offset:31744
  v_mfma_f32_16x16x32_bf16 v[44:47], a[200:203], v[4:7], v[44:47]
  v_mfma_f32_16x16x32_bf16 v[48:51], a[200:203], v[8:11], v[48:51]
  s_waitcnt vmcnt(9)
  s_barrier
  s_lshl_b32 s40, s20, 1
  s_add_u32 s40, s40, 1
  s_cmp_lg_u32 s40, s28
  s_cbranch_scc1 L_F2_s2
  s_mov_b32 s63, s25
  s_atomic_smax s63, s[4:5], s62 glc
Lnosig_156:
L_F2_s2:
  s_waitcnt lgkmcnt(4)
  v_mfma_f32_16x16x32_bf16 v[36:39], a[52:55], v[12:15], v[36:39]
  ds_read_b128 v[4:7], v73 offset:32768
  v_mfma_f32_16x16x32_bf16 v[40:43], a[52:55], v[16:19], v[40:43]
  ds_read_b128 v[8:11], v73 offset:33792
  v_mfma_f32_16x16x32_bf16 v[44:47], a[204:207], v[12:15], v[44:47]
  v_mfma_f32_16x16x32_bf16 v[48:51], a[204:207], v[16:19], v[48:51]
  s_waitcnt lgkmcnt(4)
  v_mfma_f32_16x16x32_bf16 v[36:39], a[56:59], v[20:23], v[36:39]
  ds_read_b128 v[12:15], v73 offset:34816
  v_mfma_f32_16x16x32_bf16 v[40:43], a[56:59], v[24:27], v[40:43]
  ds_read_b128 v[16:19], v73 offset:35840
  v_mfma_f32_16x16x32_bf16 v[44:47], a[208:211], v[20:23], v[44:47]
  v_mfma_f32_16x16x32_bf16 v[48:51], a[208:211], v[24:27], v[48:51]
  s_waitcnt lgkmcnt(4)
  v_mfma_f32_16x16x32_bf16 v[36:39], a[60:63], v[28:31], v[36:39]
  ds_read_b128 v[20:23], v73 offset:36864
  v_mfma_f32_16x16x32_bf16 v[40:43], a[60:63], v[32:35], v[40:43]
  ds_read_b128 v[24:27], v73 offset:37888
  v_mfma_f32_16x16x32_bf16 v[44:47], a[212:215], v[28:31], v[44:47]
  v_mfma_f32_16x16x32_bf16 v[48:51], a[212:215], v[32:35], v[48:51]
  s_waitcnt lgkmcnt(4)
  v_mfma_f32_16x16x32_bf16 v[36:39], a[64:67], v[4:7], v[36:39]
  ds_read_b128 v[28:31], v73 offset:38912
  v_mfma_f32_16x16x32_bf16 v[40:43], a[64:67], v[8:11], v[40:43]
  ds_read_b128 v[32:35], v73 offset:39936
  v_mfma_f32_16x16x32_bf16 v[44:47], a[216:219], v[4:7], v[44:47]
  v_mfma_f32_16x16x32_bf16 v[48:51], a[216:219], v[8:11], v[48:51]
  s_waitcnt lgkmcnt(4)
  v_mfma_f32_16x16x32_bf16 v[36:39], a[68:71], v[12:15], v[36:39]
  ds_read_b128 v[4:7], v73 offset:40960
  v_mfma_f32_16x16x32_bf16 v[40:43], a[68:71], v[16:19], v[40:43]
  ds_read_b128 v[8:11], v73 offset:41984
  v_mfma_f32_16x16x32_bf16 v[44:47], a[220:223], v[12:15], v[44:47]
  v_mfma_f32_16x16x32_bf16 v[48:51], a[220:223], v[16:19], v[48:51]
  s_waitcnt lgkmcnt(4)
  v_mfma_f32_16x16x32_bf16 v[36:39], a[72:75], v[20:23], v[36:39]
  ds_read_b128 v[12:15], v73 offset:43008
  v_mfma_f32_16x16x32_bf16 v[40:43], a[72:75], v[24:27], v[40:43]
  ds_read_b128 v[16:19], v73 offset:44032
  v_mfma_f32_16x16x32_bf16 v[44:47], a[224:227], v[20:23], v[44:47]
  v_mfma_f32_16x16x32_bf16 v[48:51], a[224:227], v[24:27], v[48:51]
  s_waitcnt vmcnt(0)
  s_barrier
  ds_read_b32 v3, v71
  s_waitcnt lgkmcnt(4)
  v_mfma_f32_16x16x32_bf16 v[36:39], a[76:79], v[28:31], v[36:39]
  ds_read_b128 v[20:23], v73 offset:45056
  v_mfma_f32_16x16x32_bf16 v[40:43], a[76:79], v[32:35], v[40:43]
  ds_read_b128 v[24:27], v73 offset:46080
  v_mfma_f32_16x16x32_bf16 v[44:47], a[228:231], v[28:31], v[44:47]
  v_mfma_f32_16x16x32_bf16 v[48:51], a[228:231], v[32:35], v[48:51]
  s_waitcnt lgkmcnt(4)
  v_mfma_f32_16x16x32_bf16 v[36:39], a[80:83], v[4:7], v[36:39]
  ds_read_b128 v[28:31], v73 offset:47104
  v_mfma_f32_16x16x32_bf16 v[40:43], a[80:83], v[8:11], v[40:43]
  ds_read_b128 v[32:35], v73 offset:48128
  v_mfma_f32_16x16x32_bf16 v[44:47], a[232:235], v[4:7], v[44:47]
  v_mfma_f32_16x16x32_bf16 v[48:51], a[232:235], v[8:11], v[48:51]
  s_waitcnt lgkmcnt(4)
  v_cmp_gt_i32 vcc, s29, v3
  s_mov_b32 s28, 0
  s_cbranch_vccnz L_F2_nopf
  s_cmp_ge_u32 s25, 63
  s_cbranch_scc1 L_F2_nopf
  s_mov_b32 s28, 1
  s_waitcnt lgkmcnt(4)
  v_mfma_f32_16x16x32_bf16 v[36:39], a[84:87], v[12:15], v[36:39]
  ds_read_b128 v[4:7], v73 offset:49152
  v_mfma_f32_16x16x32_bf16 v[40:43], a[84:87], v[16:19], v[40:43]
  ds_read_b128 v[8:11], v73 offset:50176
  v_mfma_f32_16x16x32_bf16 v[44:47], a[236:239], v[12:15], v[44:47]
  s_add_u32 s36, s32, 0
  s_add_u32 m0, s34, s36
  s_add_u32 s36, s35, 0
  buffer_load_dwordx4 v1, s[4:7], s36 offen offset:0 sc1 lds
  v_mfma_f32_16x16x32_bf16 v[48:51], a[236:239], v[16:19], v[48:51]
  s_waitcnt lgkmcnt(4)
  v_mfma_f32_16x16x32_bf16 v[36:39], a[88:91], v[20:23], v[36:39]
  ds_read_b128 v[12:15], v73 offset:51200
  v_mfma_f32_16x16x32_bf16 v[40:43], a[88:91], v[24:27], v[40:43]
  ds_read_b128 v[16:19], v73 offset:52224
  v_mfma_f32_16x16x32_bf16 v[44:47], a[240:243], v[20:23], v[44:47]
  buffer_load_dwordx4 v1, s[4:7], s36 offen offset:1024 sc1 lds
  v_mfma_f32_16x16x32_bf16 v[48:51], a[240:243], v[24:27], v[48:51]
  s_waitcnt lgkmcnt(4)
  v_mfma_f32_16x16x32_bf16 v[36:39], a[92:95], v[28:31], v[36:39]
  ds_read_b128 v[20:23], v73 offset:53248
  v_mfma_f32_16x16x32_bf16 v[40:43], a[92:95], v[32:35], v[40:43]
  ds_read_b128 v[24:27], v73 offset:54272
  v_mfma_f32_16x16x32_bf16 v[44:47], a[244:247], v[28:31], v[44:47]
  buffer_load_dwordx4 v1, s[4:7], s36 offen offset:2048 sc1 lds
  v_mfma_f32_16x16x32_bf16 v[48:51], a[244:247], v[32:35], v[48:51]
  s_waitcnt lgkmcnt(4)
  v_mfma_f32_16x16x32_bf16 v[36:39], a[96:99], v[4:7], v[36:39]
  ds_read_b128 v[28:31], v73 offset:55296
  v_mfma_f32_16x16x32_bf16 v[40:43], a[96:99], v[8:11], v[40:43]
  ds_read_b128 v[32:35], v73 offset:56320
  v_mfma_f32_16x16x32_bf16 v[44:47], a[248:251], v[4:7], v[44:47]
  buffer_load_dwordx4 v1, s[4:7], s36 offen offset:3072 sc1 lds
  v_mfma_f32_16x16x32_bf16 v[48:51], a[248:251], v[8:11], v[48:51]
  s_waitcnt lgkmcnt(4)
  v_mfma_f32_16x16x32_bf16 v[36:39], a[100:103], v[12:15], v[36:39]
  ds_read_b128 v[4:7], v73 offset:57344
  v_mfma_f32_16x16x32_bf16 v[40:43], a[100:103], v[16:19], v[40:43]
  ds_read_b128 v[8:11], v73 offset:58368
  v_mfma_f32_16x16x32_bf16 v[44:47], a[252:255], v[12:15], v[44:47]
  s_add_u32 s36, s32, 16384
  s_add_u32 m0, s34, s36
  s_add_u32 s36, s35, 32768
  buffer_load_dwordx4 v1, s[4:7], s36 offen offset:0 sc1 lds
  v_mfma_f32_16x16x32_bf16 v[48:51], a[252:255], v[16:19], v[48:51]
  s_waitcnt lgkmcnt(4)
  v_mfma_f32_16x16x32_bf16 v[36:39], a[104:107], v[20:23], v[36:39]
  ds_read_b128 v[12:15], v73 offset:59392
  v_mfma_f32_16x16x32_bf16 v[40:43], a[104:107], v[24:27], v[40:43]
  ds_read_b128 v[16:19], v73 offset:60416
  v_mfma_f32_16x16x32_bf16 v[44:47], v[128:131], v[20:23], v[44:47]
  buffer_load_dwordx4 v1, s[4:7], s36 offen offset:1024 sc1 lds
  v_mfma_f32_16x16x32_bf16 v[48:51], v[128:131], v[24:27], v[48:51]
  s_waitcnt lgkmcnt(4)
  v_mfma_f32_16x16x32_bf16 v[36:39], a[108:111], v[28:31], v[36:39]
  ds_read_b128 v[20:23], v73 offset:61440
  v_mfma_f32_16x16x32_bf16 v[40:43], a[108:111], v[32:35], v[40:43]
  ds_read_b128 v[24:27], v73 offset:62464
  v_mfma_f32_16x16x32_bf16 v[44:47], v[132:135], v[28:31], v[44:47]
  buffer_load_dwordx4 v1, s[4:7], s36 offen offset:2048 sc1 lds
  v_mfma_f32_16x16x32_bf16 v[48:51], v[132:135], v[32:35], v[48:51]
  s_waitcnt lgkmcnt(4)
  v_mfma_f32_16x16x32_bf16 v[36:39], a[112:115], v[4:7], v[36:39]
  ds_read_b128 v[28:31], v73 offset:63488
  v_mfma_f32_16x16x32_bf16 v[40:43], a[112:115], v[8:11], v[40:43]
  ds_read_b128 v[32:35], v73 offset:64512
  v_mfma_f32_16x16x32_bf16 v[44:47], v[136:139], v[4:7], v[44:47]
  buffer_load_dwordx4 v1, s[4:7], s36 offen offset:3072 sc1 lds
  v_mfma_f32_16x16x32_bf16 v[48:51], v[136:139], v[8:11], v[48:51]
  s_waitcnt lgkmcnt(4)
  v_mfma_f32_16x16x32_bf16 v[36:39], a[116:119], v[12:15], v[36:39]
  ds_read_b128 v[4:7], v74 offset:0
  v_mfma_f32_16x16x32_bf16 v[40:43], a[116:119], v[16:19], v[40:43]
  ds_read_b128 v[8:11], v74 offset:1024
  v_mfma_f32_16x16x32_bf16 v[44:47], v[140:143], v[12:15], v[44:47]
  s_add_u32 s36, s32, 32768
  s_add_u32 m0, s34, s36
  s_add_u32 s36, s35, 65536
  buffer_load_dwordx4 v1, s[4:7], s36 offen offset:0 sc1 lds
  v_mfma_f32_16x16x32_bf16 v[48:51], v[140:143], v[16:19], v[48:51]
  s_waitcnt lgkmcnt(4)
  v_mfma_f32_16x16x32_bf16 v[36:39], a[120:123], v[20:23], v[36:39]
  ds_read_b128 v[12:15], v74 offset:2048
  v_mfma_f32_16x16x32_bf16 v[40:43], a[120:123], v[24:27], v[40:43]
  ds_read_b128 v[16:19], v74 offset:3072
  v_mfma_f32_16x16x32_bf16 v[44:47], v[144:147], v[20:23], v[44:47]
  buffer_load_dwordx4 v1, s[4:7], s36 offen offset:1024 sc1 lds
  v_mfma_f32_16x16x32_bf16 v[48:51], v[144:147], v[24:27], v[48:51]
  s_waitcnt lgkmcnt(4)
  v_mfma_f32_16x16x32_bf16 v[36:39], a[124:127], v[28:31], v[36:39]
  ds_read_b128 v[20:23], v74 offset:4096
  v_mfma_f32_16x16x32_bf16 v[40:43], a[124:127], v[32:35], v[40:43]
  ds_read_b128 v[24:27], v74 offset:5120
  v_mfma_f32_16x16x32_bf16 v[44:47], v[148:151], v[28:31], v[44:47]
  buffer_load_dwordx4 v1, s[4:7], s36 offen offset:2048 sc1 lds
  v_mfma_f32_16x16x32_bf16 v[48:51], v[148:151], v[32:35], v[48:51]
  s_waitcnt lgkmcnt(4)
  v_mfma_f32_16x16x32_bf16 v[36:39], a[128:131], v[4:7], v[36:39]
  ds_read_b128 v[28:31], v74 offset:6144
  v_mfma_f32_16x16x32_bf16 v[40:43], a[128:131], v[8:11], v[40:43]
  ds_read_b128 v[32:35], v74 offset:7168
  v_mfma_f32_16x16x32_bf16 v[44:47], v[152:155], v[4:7], v[44:47]
  buffer_load_dwordx4 v1, s[4:7], s36 offen offset:3072 sc1 lds
  v_mfma_f32_16x16x32_bf16 v[48:51], v[152:155], v[8:11], v[48:51]
  s_waitcnt lgkmcnt(4)
  v_mfma_f32_16x16x32_bf16 v[36:39], a[132:135], v[12:15], v[36:39]
  ds_read_b128 v[4:7], v74 offset:8192
  v_mfma_f32_16x16x32_bf16 v[40:43], a[132:135], v[16:19], v[40:43]
  ds_read_b128 v[8:11], v74 offset:9216
  v_mfma_f32_16x16x32_bf16 v[44:47], v[156:159], v[12:15], v[44:47]
  v_mfma_f32_16x16x32_bf16 v[48:51], v[156:159], v[16:19], v[48:51]
  s_waitcnt lgkmcnt(4)
  v_mfma_f32_16x16x32_bf16 v[36:39], a[136:139], v[20:23], v[36:39]
  ds_read_b128 v[12:15], v74 offset:10240
  v_mfma_f32_16x16x32_bf16 v[40:43], a[136:139], v[24:27], v[40:43]
  ds_read_b128 v[16:19], v74 offset:11264
  v_mfma_f32_16x16x32_bf16 v[44:47], v[160:163], v[20:23], v[44:47]
  v_mfma_f32_16x16x32_bf16 v[48:51], v[160:163], v[24:27], v[48:51]
  s_waitcnt lgkmcnt(4)
  v_mfma_f32_16x16x32_bf16 v[36:39], a[140:143], v[28:31], v[36:39]
  v_mfma_f32_16x16x32_bf16 v[40:43], a[140:143], v[32:35], v[40:43]
  v_mfma_f32_16x16x32_bf16 v[44:47], v[164:167], v[28:31], v[44:47]
  v_mfma_f32_16x16x32_bf16 v[48:51], v[164:167], v[32:35], v[48:51]
  s_waitcnt lgkmcnt(2)
  v_mfma_f32_16x16x32_bf16 v[36:39], a[144:147], v[4:7], v[36:39]
  v_mfma_f32_16x16x32_bf16 v[40:43], a[144:147], v[8:11], v[40:43]
  v_mfma_f32_16x16x32_bf16 v[44:47], v[168:171], v[4:7], v[44:47]
  v_mfma_f32_16x16x32_bf16 v[48:51], v[168:171], v[8:11], v[48:51]
  s_waitcnt lgkmcnt(0)
  v_mfma_f32_16x16x32_bf16 v[36:39], a[148:151], v[12:15], v[36:39]
  v_mfma_f32_16x16x32_bf16 v[40:43], a[148:151], v[16:19], v[40:43]
  v_mfma_f32_16x16x32_bf16 v[44:47], v[172:175], v[12:15], v[44:47]
  v_mfma_f32_16x16x32_bf16 v[48:51], v[172:175], v[16:19], v[48:51]
  s_nop 7
  s_branch L_F2_epi
L_F2_nopf:
  s_waitcnt lgkmcnt(4)
  v_mfma_f32_16x16x32_bf16 v[36:39], a[84:87], v[12:15], v[36:39]
  ds_read_b128 v[4:7], v73 offset:49152
  v_mfma_f32_16x16x32_bf16 v[40:43], a[84:87], v[16:19], v[40:43]
  ds_read_b128 v[8:11], v73 offset:50176
  v_mfma_f32_16x16x32_bf16 v[44:47], a[236:239], v[12:15], v[44:47]
  v_mfma_f32_16x16x32_bf16 v[48:51], a[236:239], v[16:19], v[48:51]
  s_waitcnt lgkmcnt(4)
  v_mfma_f32_16x16x32_bf16 v[36:39], a[88:91], v[20:23], v[36:39]
  ds_read_b128 v[12:15], v73 offset:51200
  v_mfma_f32_16x16x32_bf16 v[40:43], a[88:91], v[24:27], v[40:43]
  ds_read_b128 v[16:19], v73 offset:52224
  v_mfma_f32_16x16x32_bf16 v[44:47], a[240:243], v[20:23], v[44:47]
  v_mfma_f32_16x16x32_bf16 v[48:51], a[240:243], v[24:27], v[48:51]
  s_waitcnt lgkmcnt(4)
  v_mfma_f32_16x16x32_bf16 v[36:39], a[92:95], v[28:31], v[36:39]
  ds_read_b128 v[20:23], v73 offset:53248
  v_mfma_f32_16x16x32_bf16 v[40:43], a[92:95], v[32:35], v[40:43]
  ds_read_b128 v[24:27], v73 offset:54272
  v_mfma_f32_16x16x32_bf16 v[44:47], a[244:247], v[28:31], v[44:47]
  v_mfma_f32_16x16x32_bf16 v[48:51], a[244:247], v[32:35], v[48:51]
  s_waitcnt lgkmcnt(4)
  v_mfma_f32_16x16x32_bf16 v[36:39], a[96:99], v[4:7], v[36:39]
  ds_read_b128 v[28:31], v73 offset:55296
  v_mfma_f32_16x16x32_bf16 v[40:43], a[96:99], v[8:11], v[40:43]
  ds_read_b128 v[32:35], v73 offset:56320
  v_mfma_f32_16x16x32_bf16 v[44:47], a[248:251], v[4:7], v[44:47]
  v_mfma_f32_16x16x32_bf16 v[48:51], a[248:251], v[8:11], v[48:51]
  s_waitcnt lgkmcnt(4)
  v_mfma_f32_16x16x32_bf16 v[36:39], a[100:103], v[12:15], v[36:39]
  ds_read_b128 v[4:7], v73 offset:57344
  v_mfma_f32_16x16x32_bf16 v[40:43], a[100:103], v[16:19], v[40:43]
  ds_read_b128 v[8:11], v73 offset:58368
  v_mfma_f32_16x16x32_bf16 v[44:47], a[252:255], v[12:15], v[44:47]
  v_mfma_f32_16x16x32_bf16 v[48:51], a[252:255], v[16:19], v[48:51]
  s_waitcnt lgkmcnt(4)
  v_mfma_f32_16x16x32_bf16 v[36:39], a[104:107], v[20:23], v[36:39]
  ds_read_b128 v[12:15], v73 offset:59392
  v_mfma_f32_16x16x32_bf16 v[40:43], a[104:107], v[24:27], v[40:43]
  ds_read_b128 v[16:19], v73 offset:60416
  v_mfma_f32_16x16x32_bf16 v[44:47], v[128:131], v[20:23], v[44:47]
  v_mfma_f32_16x16x32_bf16 v[48:51], v[128:131], v[24:27], v[48:51]
  s_waitcnt lgkmcnt(4)
  v_mfma_f32_16x16x32_bf16 v[36:39], a[108:111], v[28:31], v[36:39]
  ds_read_b128 v[20:23], v73 offset:61440
  v_mfma_f32_16x16x32_bf16 v[40:43], a[108:111], v[32:35], v[40:43]
  ds_read_b128 v[24:27], v73 offset:62464
  v_mfma_f32_16x16x32_bf16 v[44:47], v[132:135], v[28:31], v[44:47]
  v_mfma_f32_16x16x32_bf16 v[48:51], v[132:135], v[32:35], v[48:51]
  s_waitcnt lgkmcnt(4)
  v_mfma_f32_16x16x32_bf16 v[36:39], a[112:115], v[4:7], v[36:39]
  ds_read_b128 v[28:31], v73 offset:63488
  v_mfma_f32_16x16x32_bf16 v[40:43], a[112:115], v[8:11], v[40:43]
  ds_read_b128 v[32:35], v73 offset:64512
  v_mfma_f32_16x16x32_bf16 v[44:47], v[136:139], v[4:7], v[44:47]
  v_mfma_f32_16x16x32_bf16 v[48:51], v[136:139], v[8:11], v[48:51]
  s_waitcnt lgkmcnt(4)
  v_mfma_f32_16x16x32_bf16 v[36:39], a[116:119], v[12:15], v[36:39]
  ds_read_b128 v[4:7], v74 offset:0
  v_mfma_f32_16x16x32_bf16 v[40:43], a[116:119], v[16:19], v[40:43]
  ds_read_b128 v[8:11], v74 offset:1024
  v_mfma_f32_16x16x32_bf16 v[44:47], v[140:143], v[12:15], v[44:47]
  v_mfma_f32_16x16x32_bf16 v[48:51], v[140:143], v[16:19], v[48:51]
  s_barrier
  s_lshl_b32 s40, s20, 8
  s_add_u32 m0, s40, 155648
  s_cmp_eq_u32 s20, 0
  s_cselect_b32 s40, s30, 2147483392
  buffer_load_dword v2, s[4:7], s40 offen sc1 lds
  s_waitcnt lgkmcnt(4)
  v_mfma_f32_16x16x32_bf16 v[36:39], a[120:123], v[20:23], v[36:39]
  ds_read_b128 v[12:15], v74 offset:2048
  v_mfma_f32_16x16x32_bf16 v[40:43], a[120:123], v[24:27], v[40:43]
  ds_read_b128 v[16:19], v74 offset:3072
  v_mfma_f32_16x16x32_bf16 v[44:47], v[144:147], v[20:23], v[44:47]
  v_mfma_f32_16x16x32_bf16 v[48:51], v[144:147], v[24:27], v[48:51]
  s_waitcnt lgkmcnt(4)
  v_mfma_f32_16x16x32_bf16 v[36:39], a[124:127], v[28:31], v[36:39]
  ds_read_b128 v[20:23], v74 offset:4096
  v_mfma_f32_16x16x32_bf16 v[40:43], a[124:127], v[32:35], v[40:43]
  ds_read_b128 v[24:27], v74 offset:5120
  v_mfma_f32_16x16x32_bf16 v[44:47], v[148:151], v[28:31], v[44:47]
  v_mfma_f32_16x16x32_bf16 v[48:51], v[148:151], v[32:35], v[48:51]
  s_waitcnt lgkmcnt(4)
  v_mfma_f32_16x16x32_bf16 v[36:39], a[128:131], v[4:7], v[36:39]
  ds_read_b128 v[28:31], v74 offset:6144
  v_mfma_f32_16x16x32_bf16 v[40:43], a[128:131], v[8:11], v[40:43]
  ds_read_b128 v[32:35], v74 offset:7168
  v_mfma_f32_16x16x32_bf16 v[44:47], v[152:155], v[4:7], v[44:47]
  v_mfma_f32_16x16x32_bf16 v[48:51], v[152:155], v[8:11], v[48:51]
  s_waitcnt lgkmcnt(4)
  v_mfma_f32_16x16x32_bf16 v[36:39], a[132:135], v[12:15], v[36:39]
  ds_read_b128 v[4:7], v74 offset:8192
  v_mfma_f32_16x16x32_bf16 v[40:43], a[132:135], v[16:19], v[40:43]
  ds_read_b128 v[8:11], v74 offset:9216
  v_mfma_f32_16x16x32_bf16 v[44:47], v[156:159], v[12:15], v[44:47]
  v_mfma_f32_16x16x32_bf16 v[48:51], v[156:159], v[16:19], v[48:51]
  s_waitcnt lgkmcnt(4)
  v_mfma_f32_16x16x32_bf16 v[36:39], a[136:139], v[20:23], v[36:39]
  ds_read_b128 v[12:15], v74 offset:10240
  v_mfma_f32_16x16x32_bf16 v[40:43], a[136:139], v[24:27], v[40:43]
  ds_read_b128 v[16:19], v74 offset:11264
  v_mfma_f32_16x16x32_bf16 v[44:47], v[160:163], v[20:23], v[44:47]
  v_mfma_f32_16x16x32_bf16 v[48:51], v[160:163], v[24:27], v[48:51]
  s_waitcnt lgkmcnt(4)
  v_mfma_f32_16x16x32_bf16 v[36:39], a[140:143], v[28:31], v[36:39]
  v_mfma_f32_16x16x32_bf16 v[40:43], a[140:143], v[32:35], v[40:43]
  v_mfma_f32_16x16x32_bf16 v[44:47], v[164:167], v[28:31], v[44:47]
  v_mfma_f32_16x16x32_bf16 v[48:51], v[164:167], v[32:35], v[48:51]
  s_waitcnt vmcnt(0)
  s_barrier
  ds_read_b32 v3, v71
  s_waitcnt lgkmcnt(2)
  v_mfma_f32_16x16x32_bf16 v[36:39], a[144:147], v[4:7], v[36:39]
  v_mfma_f32_16x16x32_bf16 v[40:43], a[144:147], v[8:11], v[40:43]
  v_mfma_f32_16x16x32_bf16 v[44:47], v[168:171], v[4:7], v[44:47]
  v_mfma_f32_16x16x32_bf16 v[48:51], v[168:171], v[8:11], v[48:51]
  s_waitcnt lgkmcnt(0)
  v_mfma_f32_16x16x32_bf16 v[36:39], a[148:151], v[12:15], v[36:39]
  v_mfma_f32_16x16x32_bf16 v[40:43], a[148:151], v[16:19], v[40:43]
  v_mfma_f32_16x16x32_bf16 v[44:47], v[172:175], v[12:15], v[44:47]
  v_mfma_f32_16x16x32_bf16 v[48:51], v[172:175], v[16:19], v[48:51]
  v_cmp_gt_i32 vcc, s29, v3
  s_cmp_eq_u64 vcc, 0
  s_cselect_b32 s28, 2, 0
  s_cmp_lt_u32 s25, 63
  s_cselect_b32 s28, s28, 0
L_F2_epi:
  v_cvt_pk_bf16_f32 v52, v36, v37
  v_cvt_pk_bf16_f32 v53, v38, v39
  v_cvt_pk_bf16_f32 v54, v44, v45
  v_cvt_pk_bf16_f32 v55, v46, v47
  buffer_store_dwordx4 v[52:55], v68, s[4:7], s31 offen offset:0 sc1
  v_cvt_pk_bf16_f32 v56, v40, v41
  v_cvt_pk_bf16_f32 v57, v42, v43
  v_cvt_pk_bf16_f32 v58, v48, v49
  v_cvt_pk_bf16_f32 v59, v50, v51
  buffer_store_dwordx4 v[56:59], v68, s[4:7], s31 offen offset:1024 sc1
  s_add_u32 s25, s25, 1
  s_add_u32 s31, s31, 2097152
  s_xor_b32 s31, s31, 0x2000
  s_branch L_F2_top
L_WOF:
  s_load_dwordx2 s[8:9], s[0:1], 40
  s_mov_b32 s10, 8388608
  s_mov_b32 s11, 0x20000
  s_waitcnt lgkmcnt(0)
  v_bfe_u32 v1, v0, 5, 1
  v_mul_u32_u24 v1, 131072, v1
  v_bfe_u32 v2, v0, 4, 1
  v_mul_u32_u24 v2, 8192, v2
  v_add_u32 v1, v1, v2
  v_bfe_u32 v2, v0, 3, 1
  v_mul_u32_u24 v2, 2048, v2
  v_add_u32 v1, v1, v2
  v_lshrrev_b32 v2, 3, v0
  v_and_b32 v2, 6, v2
  v_xor_b32 v2, v2, v0
  v_and_b32 v2, 7, v2
  v_lshl_add_u32 v1, v2, 4, v1
  v_bfe_u32 v2, v0, 3, 2
  v_xor_b32 v2, 0, v2
  v_lshlrev_b32 v2, 5, v2
  v_lshrrev_b32 v4, 2, v0
  v_lshl_add_u32 v4, v4, 7, v2
  v_and_b32 v2, 3, v0
  v_lshl_add_u32 v4, v2, 3, v4
  s_and_b32 s43, s21, 3
  s_lshl_b32 s43, s43, 2
  s_add_u32 s43, s43, s20
  s_lshr_b32 s44, s21, 2
  s_lshl_b32 s40, s43, 19
  s_lshl_b32 s41, s44, 7
  s_add_u32 s40, s40, s41
  v_add_u32 v1, s40, v1
  s_lshl_b32 s41, s20, 15
  v_add_u32 v4, s41, v4
  s_lshl_b32 s40, s44, 19
  s_lshl_b32 s45, s43, 14
  s_add_u32 s40, s40, s45
  v_lshl_add_u32 v3, v0, 4, s40
  v_xor_b32 v5, 32, v4
  v_xor_b32 v6, 64, v4
  v_xor_b32 v7, 96, v4
  s_add_u32 m0, s41, 0
  s_mov_b32 s42, 0
  buffer_load_dwordx4 v1, s[8:11], s42 offen nt lds
  s_add_u32 m0, s41, 1024
  s_mov_b32 s42, 16384
  buffer_load_dwordx4 v1, s[8:11], s42 offen nt lds
  s_add_u32 m0, s41, 2048
  s_mov_b32 s42, 4096
  buffer_load_dwordx4 v1, s[8:11], s42 offen nt lds
  s_add_u32 m0, s41, 3072
  s_mov_b32 s42, 20480
  buffer_load_dwordx4 v1, s[8:11], s42 offen nt lds
  s_add_u32 m0, s41, 4096
  s_mov_b32 s42, 32768
  buffer_load_dwordx4 v1, s[8:11], s42 offen nt lds
  s_add_u32 m0, s41, 5120
  s_mov_b32 s42, 49152
  buffer_load_dwordx4 v1, s[8:11], s42 offen nt lds
  s_add_u32 m0, s41, 6144
  s_mov_b32 s42, 36864
  buffer_load_dwordx4 v1, s[8:11], s42 offen nt lds
  s_add_u32 m0, s41, 7168
  s_mov_b32 s42, 53248
  buffer_load_dwordx4 v1, s[8:11], s42 offen nt lds
  s_add_u32 m0, s41, 8192
  s_mov_b32 s42, 65536
  buffer_load_dwordx4 v1, s[8:11], s42 offen nt lds
  s_add_u32 m0, s41, 9216
  s_mov_b32 s42, 81920
  buffer_load_dwordx4 v1, s[8:11], s42 offen nt lds
  s_add_u32 m0, s41, 10240
  s_mov_b32 s42, 69632
  buffer_load_dwordx4 v1, s[8:11], s42 offen nt lds
  s_add_u32 m0, s41, 11264
  s_mov_b32 s42, 86016
  buffer_load_dwordx4 v1, s[8:11], s42 offen nt lds
  s_add_u32 m0, s41, 12288
  s_mov_b32 s42, 98304
  buffer_load_dwordx4 v1, s[8:11], s42 offen nt lds
  s_add_u32 m0, s41, 13312
  s_mov_b32 s42, 114688
  buffer_load_dwordx4 v1, s[8:11], s42 offen nt lds
  s_add_u32 m0, s41, 14336
  s_mov_b32 s42, 102400
  buffer_load_dwordx4 v1, s[8:11], s42 offen nt lds
  s_add_u32 m0, s41, 15360
  s_mov_b32 s42, 118784
  buffer_load_dwordx4 v1, s[8:11], s42 offen nt lds
  s_add_u32 m0, s41, 16384
  s_mov_b32 s42, 262144
  buffer_load_dwordx4 v1, s[8:11], s42 offen nt lds
  s_add_u32 m0, s41, 17408
  s_mov_b32 s42, 278528
  buffer_load_dwordx4 v1, s[8:11], s42 offen nt lds
  s_add_u32 m0, s41, 18432
  s_mov_b32 s42, 266240
  buffer_load_dwordx4 v1, s[8:11], s42 offen nt lds
  s_add_u32 m0, s41, 19456
  s_mov_b32 s42, 282624
  buffer_load_dwordx4 v1, s[8:11], s42 offen nt lds
  s_add_u32 m0, s41, 20480
  s_mov_b32 s42, 294912
  buffer_load_dwordx4 v1, s[8:11], s42 offen nt lds
  s_add_u32 m0, s41, 21504
  s_mov_b32 s42, 311296
  buffer_load_dwordx4 v1, s[8:11], s42 offen nt lds
  s_add_u32 m0, s41, 22528
  s_mov_b32 s42, 299008
  buffer_load_dwordx4 v1, s[8:11], s42 offen nt lds
  s_add_u32 m0, s41, 23552
  s_mov_b32 s42, 315392
  buffer_load_dwordx4 v1, s[8:11], s42 offen nt lds
  s_add_u32 m0, s41, 24576
  s_mov_b32 s42, 327680
  buffer_load_dwordx4 v1, s[8:11], s42 offen nt lds
  s_add_u32 m0, s41, 25600
  s_mov_b32 s42, 344064
  buffer_load_dwordx4 v1, s[8:11], s42 offen nt lds
  s_add_u32 m0, s41, 26624
  s_mov_b32 s42, 331776
  buffer_load_dwordx4 v1, s[8:11], s42 offen nt lds
  s_add_u32 m0, s41, 27648
  s_mov_b32 s42, 348160
  buffer_load_dwordx4 v1, s[8:11], s42 offen nt lds
  s_add_u32 m0, s41, 28672
  s_mov_b32 s42, 360448
  buffer_load_dwordx4 v1, s[8:11], s42 offen nt lds
  s_add_u32 m0, s41, 29696
  s_mov_b32 s42, 376832
  buffer_load_dwordx4 v1, s[8:11], s42 offen nt lds
  s_add_u32 m0, s41, 30720
  s_mov_b32 s42, 364544
  buffer_load_dwordx4 v1, s[8:11], s42 offen nt lds
  s_add_u32 m0, s41, 31744
  s_mov_b32 s42, 380928
  buffer_load_dwordx4 v1, s[8:11], s42 offen nt lds
  s_waitcnt vmcnt(24)
  ds_read_b64_tr_b16 v[8:9], v4 offset:0
  ds_read_b64_tr_b16 v[10:11], v4 offset:2048
  ds_read_b64_tr_b16 v[12:13], v4 offset:4096
  ds_read_b64_tr_b16 v[14:15], v4 offset:6144
  ds_read_b64_tr_b16 v[16:17], v5 offset:0
  ds_read_b64_tr_b16 v[18:19], v5 offset:2048
  ds_read_b64_tr_b16 v[20:21], v5 offset:4096
  ds_read_b64_tr_b16 v[22:23], v5 offset:6144
  ds_read_b64_tr_b16 v[24:25], v6 offset:0
  ds_read_b64_tr_b16 v[26:27], v6 offset:2048
  ds_read_b64_tr_b16 v[28:29], v6 offset:4096
  ds_read_b64_tr_b16 v[30:31], v6 offset:6144
  ds_read_b64_tr_b16 v[32:33], v7 offset:0
  ds_read_b64_tr_b16 v[34:35], v7 offset:2048
  ds_read_b64_tr_b16 v[36:37], v7 offset:4096
  ds_read_b64_tr_b16 v[38:39], v7 offset:6144
  s_mov_b32 s42, 10485760
  s_waitcnt lgkmcnt(12)
  buffer_store_dwordx4 v[8:11], v3, s[4:7], s42 offen offset:0 sc1
  buffer_store_dwordx4 v[12:15], v3, s[4:7], s42 offen offset:1024 sc1
  s_mov_b32 s42, 10485760
  s_waitcnt lgkmcnt(8)
  buffer_store_dwordx4 v[16:19], v3, s[4:7], s42 offen offset:2048 sc1
  buffer_store_dwordx4 v[20:23], v3, s[4:7], s42 offen offset:3072 sc1
  s_mov_b32 s42, 10747904
  s_waitcnt lgkmcnt(4)
  buffer_store_dwordx4 v[24:27], v3, s[4:7], s42 offen offset:0 sc1
  buffer_store_dwordx4 v[28:31], v3, s[4:7], s42 offen offset:1024 sc1
  s_mov_b32 s42, 10747904
  s_waitcnt lgkmcnt(0)
  buffer_store_dwordx4 v[32:35], v3, s[4:7], s42 offen offset:2048 sc1
  buffer_store_dwordx4 v[36:39], v3, s[4:7], s42 offen offset:3072 sc1
  s_waitcnt vmcnt(24)
  ds_read_b64_tr_b16 v[40:41], v4 offset:8192
  ds_read_b64_tr_b16 v[42:43], v4 offset:10240
  ds_read_b64_tr_b16 v[44:45], v4 offset:12288
  ds_read_b64_tr_b16 v[46:47], v4 offset:14336
  ds_read_b64_tr_b16 v[48:49], v5 offset:8192
  ds_read_b64_tr_b16 v[50:51], v5 offset:10240
  ds_read_b64_tr_b16 v[52:53], v5 offset:12288
  ds_read_b64_tr_b16 v[54:55], v5 offset:14336
  ds_read_b64_tr_b16 v[56:57], v6 offset:8192
  ds_read_b64_tr_b16 v[58:59], v6 offset:10240
  ds_read_b64_tr_b16 v[60:61], v6 offset:12288
  ds_read_b64_tr_b16 v[62:63], v6 offset:14336
  ds_read_b64_tr_b16 v[64:65], v7 offset:8192
  ds_read_b64_tr_b16 v[66:67], v7 offset:10240
  ds_read_b64_tr_b16 v[68:69], v7 offset:12288
  ds_read_b64_tr_b16 v[70:71], v7 offset:14336
  s_mov_b32 s42, 10489856
  s_waitcnt lgkmcnt(12)
  buffer_store_dwordx4 v[40:43], v3, s[4:7], s42 offen offset:0 sc1
  buffer_store_dwordx4 v[44:47], v3, s[4:7], s42 offen offset:1024 sc1
  s_mov_b32 s42, 10489856
  s_waitcnt lgkmcnt(8)
  buffer_store_dwordx4 v[48:51], v3, s[4:7], s42 offen offset:2048 sc1
  buffer_store_dwordx4 v[52:55], v3, s[4:7], s42 offen offset:3072 sc1
  s_mov_b32 s42, 10752000
  s_waitcnt lgkmcnt(4)
  buffer_store_dwordx4 v[56:59], v3, s[4:7], s42 offen offset:0 sc1
  buffer_store_dwordx4 v[60:63], v3, s[4:7], s42 offen offset:1024 sc1
  s_mov_b32 s42, 10752000
  s_waitcnt lgkmcnt(0)
  buffer_store_dwordx4 v[64:67], v3, s[4:7], s42 offen offset:2048 sc1
  buffer_store_dwordx4 v[68:71], v3, s[4:7], s42 offen offset:3072 sc1
  s_waitcnt vmcnt(24)
  ds_read_b64_tr_b16 v[72:73], v4 offset:16384
  ds_read_b64_tr_b16 v[74:75], v4 offset:18432
  ds_read_b64_tr_b16 v[76:77], v4 offset:20480
  ds_read_b64_tr_b16 v[78:79], v4 offset:22528
  ds_read_b64_tr_b16 v[80:81], v5 offset:16384
  ds_read_b64_tr_b16 v[82:83], v5 offset:18432
  ds_read_b64_tr_b16 v[84:85], v5 offset:20480
  ds_read_b64_tr_b16 v[86:87], v5 offset:22528
  ds_read_b64_tr_b16 v[88:89], v6 offset:16384
  ds_read_b64_tr_b16 v[90:91], v6 offset:18432
  ds_read_b64_tr_b16 v[92:93], v6 offset:20480
  ds_read_b64_tr_b16 v[94:95], v6 offset:22528
  ds_read_b64_tr_b16 v[96:97], v7 offset:16384
  ds_read_b64_tr_b16 v[98:99], v7 offset:18432
  ds_read_b64_tr_b16 v[100:101], v7 offset:20480
  ds_read_b64_tr_b16 v[102:103], v7 offset:22528
  s_mov_b32 s42, 10493952
  s_waitcnt lgkmcnt(12)
  buffer_store_dwordx4 v[72:75], v3, s[4:7], s42 offen offset:0 sc1
  buffer_store_dwordx4 v[76:79], v3, s[4:7], s42 offen offset:1024 sc1
  s_mov_b32 s42, 10493952
  s_waitcnt lgkmcnt(8)
  buffer_store_dwordx4 v[80:83], v3, s[4:7], s42 offen offset:2048 sc1
  buffer_store_dwordx4 v[84:87], v3, s[4:7], s42 offen offset:3072 sc1
  s_mov_b32 s42, 10756096
  s_waitcnt lgkmcnt(4)
  buffer_store_dwordx4 v[88:91], v3, s[4:7], s42 offen offset:0 sc1
  buffer_store_dwordx4 v[92:95], v3, s[4:7], s42 offen offset:1024 sc1
  s_mov_b32 s42, 10756096
  s_waitcnt lgkmcnt(0)
  buffer_store_dwordx4 v[96:99], v3, s[4:7], s42 offen offset:2048 sc1
  buffer_store_dwordx4 v[100:103], v3, s[4:7], s42 offen offset:3072 sc1
  s_waitcnt vmcnt(24)
  ds_read_b64_tr_b16 v[104:105], v4 offset:24576
  ds_read_b64_tr_b16 v[106:107], v4 offset:26624
  ds_read_b64_tr_b16 v[108:109], v4 offset:28672
  ds_read_b64_tr_b16 v[110:111], v4 offset:30720
  ds_read_b64_tr_b16 v[112:113], v5 offset:24576
  ds_read_b64_tr_b16 v[114:115], v5 offset:26624
  ds_read_b64_tr_b16 v[116:117], v5 offset:28672
  ds_read_b64_tr_b16 v[118:119], v5 offset:30720
  ds_read_b64_tr_b16 v[120:121], v6 offset:24576
  ds_read_b64_tr_b16 v[122:123], v6 offset:26624
  ds_read_b64_tr_b16 v[124:125], v6 offset:28672
  ds_read_b64_tr_b16 v[126:127], v6 offset:30720
  ds_read_b64_tr_b16 v[128:129], v7 offset:24576
  ds_read_b64_tr_b16 v[130:131], v7 offset:26624
  ds_read_b64_tr_b16 v[132:133], v7 offset:28672
  ds_read_b64_tr_b16 v[134:135], v7 offset:30720
  s_mov_b32 s42, 10498048
  s_waitcnt lgkmcnt(12)
  buffer_store_dwordx4 v[104:107], v3, s[4:7], s42 offen offset:0 sc1
  buffer_store_dwordx4 v[108:111], v3, s[4:7], s42 offen offset:1024 sc1
  s_mov_b32 s42, 10498048
  s_waitcnt lgkmcnt(8)
  buffer_store_dwordx4 v[112:115], v3, s[4:7], s42 offen offset:2048 sc1
  buffer_store_dwordx4 v[116:119], v3, s[4:7], s42 offen offset:3072 sc1
  s_mov_b32 s42, 10760192
  s_waitcnt lgkmcnt(4)
  buffer_store_dwordx4 v[120:123], v3, s[4:7], s42 offen offset:0 sc1
  buffer_store_dwordx4 v[124:127], v3, s[4:7], s42 offen offset:1024 sc1
  s_mov_b32 s42, 10760192
  s_waitcnt lgkmcnt(0)
  buffer_store_dwordx4 v[128:131], v3, s[4:7], s42 offen offset:2048 sc1
  buffer_store_dwordx4 v[132:135], v3, s[4:7], s42 offen offset:3072 sc1
  v_min_u32 v1, 31, v0
  v_lshlrev_b32 v1, 2, v1
  v_add_u32 v1, 128, v1
  s_nop 1
Lpoll_157:
  buffer_load_dword v2, v1, s[12:15], 0 offen sc1
  s_sub_u32 s24, s24, 1
  s_cbranch_scc1 L_FAIL
  s_waitcnt vmcnt(0)
  v_cmp_gt_i32 vcc, 1, v2
  s_cbranch_vccz Lpolld_158
  s_sleep 2
  s_branch Lpoll_157
Lpolld_158:
  s_barrier
  s_lshl_b32 s40, s21, 7
  s_add_u32 s40, s40, 1432576
  s_cmp_lg_u32 s20, 0
  s_cbranch_scc1 Lnosig_159
  s_mov_b32 s63, 1
  s_atomic_smax s63, s[4:5], s40 glc
Lnosig_159:
  s_branch L_LN1
L_QK:
  v_bfe_u32 v76, v0, 3, 2
  v_xor_b32 v76, s20, v76
  v_lshlrev_b32 v76, 5, v76
  v_lshrrev_b32 v4, 2, v0
  v_lshl_add_u32 v4, v4, 7, v76
  v_and_b32 v76, 3, v0
  v_lshl_add_u32 v4, v76, 3, v4
  s_lshl_b32 s40, s20, 15
  v_add_u32 v4, s40, v4
  v_lshl_add_u32 v85, v0, 4, s40
  s_lshl_b32 s40, s20, 12
  s_add_u32 s40, s40, 131072
  v_lshl_add_u32 v1, v0, 4, s40
  s_lshr_b32 s54, s21, 4
  s_lshl_b32 s52, s54, 22
  s_sub_u32 s53, 0, s52
  v_xor_b32 v5, 32768, v4
  v_xor_b32 v2, 4096, v1
  v_xor_b32 v6, 65536, v4
  v_xor_b32 v3, 8192, v1
  v_xor_b32 v7, 98304, v4
  v_xor_b32 v84, 12288, v1
  v_bfe_u32 v8, v0, 5, 1
  v_mul_u32_u24 v8, 16384, v8
  v_bfe_u32 v76, v0, 4, 1
  v_mul_u32_u24 v76, 32768, v76
  v_add_u32 v8, v8, v76
  v_bfe_u32 v76, v0, 3, 1
  v_mul_u32_u24 v76, 131072, v76
  v_add_u32 v8, v8, v76
  v_lshrrev_b32 v76, 3, v0
  v_and_b32 v76, 6, v76
  v_xor_b32 v76, v76, v0
  v_and_b32 v76, 7, v76
  v_lshl_add_u32 v8, v76, 4, v8
  s_lshl_b32 s40, s20, 19
  v_add_u32 v8, s40, v8
  s_lshl_b32 s44, s21, 8
  s_add_u32 s45, s44, 128
  v_add_u32 v9, s44, v8
  v_add_u32 v10, s44, v8
  v_add_u32 v11, s45, v8
  v_add_u32 v12, s45, v8
  s_lshl_b32 s41, s20, 15
  s_and_b32 s40, s21, 3
  s_cmp_eq_u32 s40, 1
  s_cselect_b64 vcc, -1, 0
  s_load_dwordx2 s[8:9], s[0:1], 24
  s_mov_b32 s10, 8388608
  s_mov_b32 s11, 0x20000
  s_waitcnt lgkmcnt(0)
  s_add_u32 m0, s41, 0
  s_add_u32 s42, s52, 0
  buffer_load_dwordx4 v9, s[8:11], s42 offen lds
  s_add_u32 m0, s41, 1024
  s_add_u32 s42, s52, 65536
  buffer_load_dwordx4 v9, s[8:11], s42 offen lds
  s_add_u32 m0, s41, 2048
  s_add_u32 s42, s52, 8192
  buffer_load_dwordx4 v9, s[8:11], s42 offen lds
  s_add_u32 m0, s41, 3072
  s_add_u32 s42, s52, 73728
  buffer_load_dwordx4 v9, s[8:11], s42 offen lds
  s_add_u32 m0, s41, 4096
  s_add_u32 s42, s52, 262144
  buffer_load_dwordx4 v9, s[8:11], s42 offen lds
  s_add_u32 m0, s41, 5120
  s_add_u32 s42, s52, 327680
  buffer_load_dwordx4 v9, s[8:11], s42 offen lds
  s_add_u32 m0, s41, 6144
  s_add_u32 s42, s52, 270336
  buffer_load_dwordx4 v9, s[8:11], s42 offen lds
  s_add_u32 m0, s41, 7168
  s_add_u32 s42, s52, 335872
  buffer_load_dwordx4 v9, s[8:11], s42 offen lds
  s_add_u32 m0, s41, 8192
  s_add_u32 s42, s52, 2097152
  buffer_load_dwordx4 v9, s[8:11], s42 offen lds
  s_add_u32 m0, s41, 9216
  s_add_u32 s42, s52, 2162688
  buffer_load_dwordx4 v9, s[8:11], s42 offen lds
  s_add_u32 m0, s41, 10240
  s_add_u32 s42, s52, 2105344
  buffer_load_dwordx4 v9, s[8:11], s42 offen lds
  s_add_u32 m0, s41, 11264
  s_add_u32 s42, s52, 2170880
  buffer_load_dwordx4 v9, s[8:11], s42 offen lds
  s_add_u32 m0, s41, 12288
  s_add_u32 s42, s52, 2359296
  buffer_load_dwordx4 v9, s[8:11], s42 offen lds
  s_add_u32 m0, s41, 13312
  s_add_u32 s42, s52, 2424832
  buffer_load_dwordx4 v9, s[8:11], s42 offen lds
  s_add_u32 m0, s41, 14336
  s_add_u32 s42, s52, 2367488
  buffer_load_dwordx4 v9, s[8:11], s42 offen lds
  s_add_u32 m0, s41, 15360
  s_add_u32 s42, s52, 2433024
  buffer_load_dwordx4 v9, s[8:11], s42 offen lds
  s_add_u32 m0, s41, 16384
  s_add_u32 s42, s53, 4194304
  buffer_load_dwordx4 v9, s[8:11], s42 offen lds
  s_add_u32 m0, s41, 17408
  s_add_u32 s42, s53, 4259840
  buffer_load_dwordx4 v9, s[8:11], s42 offen lds
  s_add_u32 m0, s41, 18432
  s_add_u32 s42, s53, 4202496
  buffer_load_dwordx4 v9, s[8:11], s42 offen lds
  s_add_u32 m0, s41, 19456
  s_add_u32 s42, s53, 4268032
  buffer_load_dwordx4 v9, s[8:11], s42 offen lds
  s_add_u32 m0, s41, 20480
  s_add_u32 s42, s53, 4456448
  buffer_load_dwordx4 v9, s[8:11], s42 offen lds
  s_add_u32 m0, s41, 21504
  s_add_u32 s42, s53, 4521984
  buffer_load_dwordx4 v9, s[8:11], s42 offen lds
  s_add_u32 m0, s41, 22528
  s_add_u32 s42, s53, 4464640
  buffer_load_dwordx4 v9, s[8:11], s42 offen lds
  s_add_u32 m0, s41, 23552
  s_add_u32 s42, s53, 4530176
  buffer_load_dwordx4 v9, s[8:11], s42 offen lds
  s_waitcnt vmcnt(16) lgkmcnt(0)
  s_barrier
  s_add_u32 m0, s41, 24576
  s_add_u32 s42, s53, 6291456
  buffer_load_dwordx4 v9, s[8:11], s42 offen lds
  s_add_u32 m0, s41, 25600
  s_add_u32 s42, s53, 6356992
  buffer_load_dwordx4 v9, s[8:11], s42 offen lds
  s_add_u32 m0, s41, 26624
  s_add_u32 s42, s53, 6299648
  buffer_load_dwordx4 v9, s[8:11], s42 offen lds
  s_add_u32 m0, s41, 27648
  s_add_u32 s42, s53, 6365184
  buffer_load_dwordx4 v9, s[8:11], s42 offen lds
  s_add_u32 m0, s41, 28672
  s_add_u32 s42, s53, 6553600
  buffer_load_dwordx4 v9, s[8:11], s42 offen lds
  s_add_u32 m0, s41, 29696
  s_add_u32 s42, s53, 6619136
  buffer_load_dwordx4 v9, s[8:11], s42 offen lds
  s_add_u32 m0, s41, 30720
  s_add_u32 s42, s53, 6561792
  buffer_load_dwordx4 v9, s[8:11], s42 offen lds
  s_add_u32 m0, s41, 31744
  s_add_u32 s42, s53, 6627328
  buffer_load_dwordx4 v9, s[8:11], s42 offen lds
  ds_read_b64_tr_b16 v[128:129], v4 offset:0
  ds_read_b64_tr_b16 v[130:131], v4 offset:2048
  ds_read_b64_tr_b16 v[132:133], v4 offset:4096
  ds_read_b64_tr_b16 v[134:135], v4 offset:6144
  ds_read_b64_tr_b16 v[144:145], v5 offset:0
  ds_read_b64_tr_b16 v[146:147], v5 offset:2048
  ds_read_b64_tr_b16 v[148:149], v5 offset:4096
  ds_read_b64_tr_b16 v[150:151], v5 offset:6144
  ds_read_b64_tr_b16 v[160:161], v6 offset:0
  ds_read_b64_tr_b16 v[162:163], v6 offset:2048
  ds_read_b64_tr_b16 v[164:165], v6 offset:4096
  ds_read_b64_tr_b16 v[166:167], v6 offset:6144
  ds_read_b64_tr_b16 v[176:177], v7 offset:0
  ds_read_b64_tr_b16 v[178:179], v7 offset:2048
  ds_read_b64_tr_b16 v[180:181], v7 offset:4096
  ds_read_b64_tr_b16 v[182:183], v7 offset:6144
  s_waitcnt vmcnt(16) lgkmcnt(0)
  s_barrier
  s_load_dwordx2 s[8:9], s[0:1], 16
  s_mov_b32 s10, 8388608
  s_mov_b32 s11, 0x20000
  s_waitcnt lgkmcnt(0)
  s_add_u32 m0, s41, 0
  s_add_u32 s42, s52, 0
  buffer_load_dwordx4 v10, s[8:11], s42 offen lds
  s_add_u32 m0, s41, 1024
  s_add_u32 s42, s52, 65536
  buffer_load_dwordx4 v10, s[8:11], s42 offen lds
  s_add_u32 m0, s41, 2048
  s_add_u32 s42, s52, 8192
  buffer_load_dwordx4 v10, s[8:11], s42 offen lds
  s_add_u32 m0, s41, 3072
  s_add_u32 s42, s52, 73728
  buffer_load_dwordx4 v10, s[8:11], s42 offen lds
  s_add_u32 m0, s41, 4096
  s_add_u32 s42, s52, 262144
  buffer_load_dwordx4 v10, s[8:11], s42 offen lds
  s_add_u32 m0, s41, 5120
  s_add_u32 s42, s52, 327680
  buffer_load_dwordx4 v10, s[8:11], s42 offen lds
  s_add_u32 m0, s41, 6144
  s_add_u32 s42, s52, 270336
  buffer_load_dwordx4 v10, s[8:11], s42 offen lds
  s_add_u32 m0, s41, 7168
  s_add_u32 s42, s52, 335872
  buffer_load_dwordx4 v10, s[8:11], s42 offen lds
  ds_read_b64_tr_b16 v[136:137], v4 offset:8192
  ds_read_b64_tr_b16 v[138:139], v4 offset:10240
  ds_read_b64_tr_b16 v[140:141], v4 offset:12288
  ds_read_b64_tr_b16 v[142:143], v4 offset:14336
  ds_read_b64_tr_b16 v[152:153], v5 offset:8192
  ds_read_b64_tr_b16 v[154:155], v5 offset:10240
  ds_read_b64_tr_b16 v[156:157], v5 offset:12288
  ds_read_b64_tr_b16 v[158:159], v5 offset:14336
  ds_read_b64_tr_b16 v[168:169], v6 offset:8192
  ds_read_b64_tr_b16 v[170:171], v6 offset:10240
  ds_read_b64_tr_b16 v[172:173], v6 offset:12288
  ds_read_b64_tr_b16 v[174:175], v6 offset:14336
  ds_read_b64_tr_b16 v[184:185], v7 offset:8192
  ds_read_b64_tr_b16 v[186:187], v7 offset:10240
  ds_read_b64_tr_b16 v[188:189], v7 offset:12288
  ds_read_b64_tr_b16 v[190:191], v7 offset:14336
  s_waitcnt vmcnt(16) lgkmcnt(0)
  s_barrier
  s_add_u32 m0, s41, 8192
  s_add_u32 s42, s52, 2097152
  buffer_load_dwordx4 v10, s[8:11], s42 offen lds
  s_add_u32 m0, s41, 9216
  s_add_u32 s42, s52, 2162688
  buffer_load_dwordx4 v10, s[8:11], s42 offen lds
  s_add_u32 m0, s41, 10240
  s_add_u32 s42, s52, 2105344
  buffer_load_dwordx4 v10, s[8:11], s42 offen lds
  s_add_u32 m0, s41, 11264
  s_add_u32 s42, s52, 2170880
  buffer_load_dwordx4 v10, s[8:11], s42 offen lds
  s_add_u32 m0, s41, 12288
  s_add_u32 s42, s52, 2359296
  buffer_load_dwordx4 v10, s[8:11], s42 offen lds
  s_add_u32 m0, s41, 13312
  s_add_u32 s42, s52, 2424832
  buffer_load_dwordx4 v10, s[8:11], s42 offen lds
  s_add_u32 m0, s41, 14336
  s_add_u32 s42, s52, 2367488
  buffer_load_dwordx4 v10, s[8:11], s42 offen lds
  s_add_u32 m0, s41, 15360
  s_add_u32 s42, s52, 2433024
  buffer_load_dwordx4 v10, s[8:11], s42 offen lds
  ds_read_b64_tr_b16 v[192:193], v4 offset:16384
  ds_read_b64_tr_b16 v[194:195], v4 offset:18432
  ds_read_b64_tr_b16 v[196:197], v4 offset:20480
  ds_read_b64_tr_b16 v[198:199], v4 offset:22528
  ds_read_b64_tr_b16 v[208:209], v5 offset:16384
  ds_read_b64_tr_b16 v[210:211], v5 offset:18432
  ds_read_b64_tr_b16 v[212:213], v5 offset:20480
  ds_read_b64_tr_b16 v[214:215], v5 offset:22528
  ds_read_b64_tr_b16 v[224:225], v6 offset:16384
  ds_read_b64_tr_b16 v[226:227], v6 offset:18432
  ds_read_b64_tr_b16 v[228:229], v6 offset:20480
  ds_read_b64_tr_b16 v[230:231], v6 offset:22528
  ds_read_b64_tr_b16 v[240:241], v7 offset:16384
  ds_read_b64_tr_b16 v[242:243], v7 offset:18432
  ds_read_b64_tr_b16 v[244:245], v7 offset:20480
  ds_read_b64_tr_b16 v[246:247], v7 offset:22528
  s_waitcnt vmcnt(16) lgkmcnt(0)
  s_barrier
  s_add_u32 m0, s41, 16384
  s_add_u32 s42, s53, 4194304
  buffer_load_dwordx4 v10, s[8:11], s42 offen lds
  s_add_u32 m0, s41, 17408
  s_add_u32 s42, s53, 4259840
  buffer_load_dwordx4 v10, s[8:11], s42 offen lds
  s_add_u32 m0, s41, 18432
  s_add_u32 s42, s53, 4202496
  buffer_load_dwordx4 v10, s[8:11], s42 offen lds
  s_add_u32 m0, s41, 19456
  s_add_u32 s42, s53, 4268032
  buffer_load_dwordx4 v10, s[8:11], s42 offen lds
  s_add_u32 m0, s41, 20480
  s_add_u32 s42, s53, 4456448
  buffer_load_dwordx4 v10, s[8:11], s42 offen lds
  s_add_u32 m0, s41, 21504
  s_add_u32 s42, s53, 4521984
  buffer_load_dwordx4 v10, s[8:11], s42 offen lds
  s_add_u32 m0, s41, 22528
  s_add_u32 s42, s53, 4464640
  buffer_load_dwordx4 v10, s[8:11], s42 offen lds
  s_add_u32 m0, s41, 23552
  s_add_u32 s42, s53, 4530176
  buffer_load_dwordx4 v10, s[8:11], s42 offen lds
  ds_read_b64_tr_b16 v[200:201], v4 offset:24576
  ds_read_b64_tr_b16 v[202:203], v4 offset:26624
  ds_read_b64_tr_b16 v[204:205], v4 offset:28672
  ds_read_b64_tr_b16 v[206:207], v4 offset:30720
  ds_read_b64_tr_b16 v[216:217], v5 offset:24576
  ds_read_b64_tr_b16 v[218:219], v5 offset:26624
  ds_read_b64_tr_b16 v[220:221], v5 offset:28672
  ds_read_b64_tr_b16 v[222:223], v5 offset:30720
  ds_read_b64_tr_b16 v[232:233], v6 offset:24576
  ds_read_b64_tr_b16 v[234:235], v6 offset:26624
  ds_read_b64_tr_b16 v[236:237], v6 offset:28672
  ds_read_b64_tr_b16 v[238:239], v6 offset:30720
  ds_read_b64_tr_b16 v[248:249], v7 offset:24576
  ds_read_b64_tr_b16 v[250:251], v7 offset:26624
  ds_read_b64_tr_b16 v[252:253], v7 offset:28672
  ds_read_b64_tr_b16 v[254:255], v7 offset:30720
  s_waitcnt vmcnt(16) lgkmcnt(0)
  s_barrier
  s_add_u32 m0, s41, 24576
  s_add_u32 s42, s53, 6291456
  buffer_load_dwordx4 v10, s[8:11], s42 offen lds
  s_add_u32 m0, s41, 25600
  s_add_u32 s42, s53, 6356992
  buffer_load_dwordx4 v10, s[8:11], s42 offen lds
  s_add_u32 m0, s41, 26624
  s_add_u32 s42, s53, 6299648
  buffer_load_dwordx4 v10, s[8:11], s42 offen lds
  s_add_u32 m0, s41, 27648
  s_add_u32 s42, s53, 6365184
  buffer_load_dwordx4 v10, s[8:11], s42 offen lds
  s_add_u32 m0, s41, 28672
  s_add_u32 s42, s53, 6553600
  buffer_load_dwordx4 v10, s[8:11], s42 offen lds
  s_add_u32 m0, s41, 29696
  s_add_u32 s42, s53, 6619136
  buffer_load_dwordx4 v10, s[8:11], s42 offen lds
  s_add_u32 m0, s41, 30720
  s_add_u32 s42, s53, 6561792
  buffer_load_dwordx4 v10, s[8:11], s42 offen lds
  s_add_u32 m0, s41, 31744
  s_add_u32 s42, s53, 6627328
  buffer_load_dwordx4 v10, s[8:11], s42 offen lds
  ds_read_b64_tr_b16 a[0:1], v4 offset:0
  ds_read_b64_tr_b16 a[2:3], v4 offset:2048
  ds_read_b64_tr_b16 a[4:5], v4 offset:4096
  ds_read_b64_tr_b16 a[6:7], v4 offset:6144
  ds_read_b64_tr_b16 a[16:17], v5 offset:0
  ds_read_b64_tr_b16 a[18:19], v5 offset:2048
  ds_read_b64_tr_b16 a[20:21], v5 offset:4096
  ds_read_b64_tr_b16 a[22:23], v5 offset:6144
  ds_read_b64_tr_b16 a[32:33], v6 offset:0
  ds_read_b64_tr_b16 a[34:35], v6 offset:2048
  ds_read_b64_tr_b16 a[36:37], v6 offset:4096
  ds_read_b64_tr_b16 a[38:39], v6 offset:6144
  ds_read_b64_tr_b16 a[48:49], v7 offset:0
  ds_read_b64_tr_b16 a[50:51], v7 offset:2048
  ds_read_b64_tr_b16 a[52:53], v7 offset:4096
  ds_read_b64_tr_b16 a[54:55], v7 offset:6144
  s_waitcnt vmcnt(16) lgkmcnt(0)
  s_barrier
  s_load_dwordx2 s[8:9], s[0:1], 16
  s_mov_b32 s10, 8388608
  s_mov_b32 s11, 0x20000
  s_waitcnt lgkmcnt(0)
  s_add_u32 m0, s41, 0
  s_add_u32 s42, s52, 0
  buffer_load_dwordx4 v11, s[8:11], s42 offen lds
  s_add_u32 m0, s41, 1024
  s_add_u32 s42, s52, 65536
  buffer_load_dwordx4 v11, s[8:11], s42 offen lds
  s_add_u32 m0, s41, 2048
  s_add_u32 s42, s52, 8192
  buffer_load_dwordx4 v11, s[8:11], s42 offen lds
  s_add_u32 m0, s41, 3072
  s_add_u32 s42, s52, 73728
  buffer_load_dwordx4 v11, s[8:11], s42 offen lds
  s_add_u32 m0, s41, 4096
  s_add_u32 s42, s52, 262144
  buffer_load_dwordx4 v11, s[8:11], s42 offen lds
  s_add_u32 m0, s41, 5120
  s_add_u32 s42, s52, 327680
  buffer_load_dwordx4 v11, s[8:11], s42 offen lds
  s_add_u32 m0, s41, 6144
  s_add_u32 s42, s52, 270336
  buffer_load_dwordx4 v11, s[8:11], s42 offen lds
  s_add_u32 m0, s41, 7168
  s_add_u32 s42, s52, 335872
  buffer_load_dwordx4 v11, s[8:11], s42 offen lds
  ds_read_b64_tr_b16 a[8:9], v4 offset:8192
  ds_read_b64_tr_b16 a[10:11], v4 offset:10240
  ds_read_b64_tr_b16 a[12:13], v4 offset:12288
  ds_read_b64_tr_b16 a[14:15], v4 offset:14336
  ds_read_b64_tr_b16 a[24:25], v5 offset:8192
  ds_read_b64_tr_b16 a[26:27], v5 offset:10240
  ds_read_b64_tr_b16 a[28:29], v5 offset:12288
  ds_read_b64_tr_b16 a[30:31], v5 offset:14336
  ds_read_b64_tr_b16 a[40:41], v6 offset:8192
  ds_read_b64_tr_b16 a[42:43], v6 offset:10240
  ds_read_b64_tr_b16 a[44:45], v6 offset:12288
  ds_read_b64_tr_b16 a[46:47], v6 offset:14336
  ds_read_b64_tr_b16 a[56:57], v7 offset:8192
  ds_read_b64_tr_b16 a[58:59], v7 offset:10240
  ds_read_b64_tr_b16 a[60:61], v7 offset:12288
  ds_read_b64_tr_b16 a[62:63], v7 offset:14336
  s_waitcnt vmcnt(16) lgkmcnt(0)
  s_barrier
  s_add_u32 m0, s41, 8192
  s_add_u32 s42, s52, 2097152
  buffer_load_dwordx4 v11, s[8:11], s42 offen lds
  s_add_u32 m0, s41, 9216
  s_add_u32 s42, s52, 2162688
  buffer_load_dwordx4 v11, s[8:11], s42 offen lds
  s_add_u32 m0, s41, 10240
  s_add_u32 s42, s52, 2105344
  buffer_load_dwordx4 v11, s[8:11], s42 offen lds
  s_add_u32 m0, s41, 11264
  s_add_u32 s42, s52, 2170880
  buffer_load_dwordx4 v11, s[8:11], s42 offen lds
  s_add_u32 m0, s41, 12288
  s_add_u32 s42, s52, 2359296
  buffer_load_dwordx4 v11, s[8:11], s42 offen lds
  s_add_u32 m0, s41, 13312
  s_add_u32 s42, s52, 2424832
  buffer_load_dwordx4 v11, s[8:11], s42 offen lds
  s_add_u32 m0, s41, 14336
  s_add_u32 s42, s52, 2367488
  buffer_load_dwordx4 v11, s[8:11], s42 offen lds
  s_add_u32 m0, s41, 15360
  s_add_u32 s42, s52, 2433024
  buffer_load_dwordx4 v11, s[8:11], s42 offen lds
  ds_read_b64_tr_b16 a[64:65], v4 offset:16384
  ds_read_b64_tr_b16 a[66:67], v4 offset:18432
  ds_read_b64_tr_b16 a[68:69], v4 offset:20480
  ds_read_b64_tr_b16 a[70:71], v4 offset:22528
  ds_read_b64_tr_b16 a[80:81], v5 offset:16384
  ds_read_b64_tr_b16 a[82:83], v5 offset:18432
  ds_read_b64_tr_b16 a[84:85], v5 offset:20480
  ds_read_b64_tr_b16 a[86:87], v5 offset:22528
  ds_read_b64_tr_b16 a[96:97], v6 offset:16384
  ds_read_b64_tr_b16 a[98:99], v6 offset:18432
  ds_read_b64_tr_b16 a[100:101], v6 offset:20480
  ds_read_b64_tr_b16 a[102:103], v6 offset:22528
  ds_read_b64_tr_b16 a[112:113], v7 offset:16384
  ds_read_b64_tr_b16 a[114:115], v7 offset:18432
  ds_read_b64_tr_b16 a[116:117], v7 offset:20480
  ds_read_b64_tr_b16 a[118:119], v7 offset:22528
  s_cmp_lg_u32 s20, 0
  s_cbranch_scc1 Lchore_160
Lini_161:
  s_load_dwordx16 s[64:79], s[12:13], 128 glc
  s_load_dwordx16 s[80:95], s[12:13], 192 glc
  s_sub_u32 s24, s24, 1
  s_cbranch_scc1 L_FAIL
  s_waitcnt lgkmcnt(0)
  s_and_b64 s[64:65], s[64:65], s[66:67]
  s_and_b64 s[64:65], s[64:65], s[68:69]
  s_and_b64 s[64:65], s[64:65], s[70:71]
  s_and_b64 s[64:65], s[64:65], s[72:73]
  s_and_b64 s[64:65], s[64:65], s[74:75]
  s_and_b64 s[64:65], s[64:65], s[76:77]
  s_and_b64 s[64:65], s[64:65], s[78:79]
  s_and_b64 s[64:65], s[64:65], s[80:81]
  s_and_b64 s[64:65], s[64:65], s[82:83]
  s_and_b64 s[64:65], s[64:65], s[84:85]
  s_and_b64 s[64:65], s[64:65], s[86:87]
  s_and_b64 s[64:65], s[64:65], s[88:89]
  s_and_b64 s[64:65], s[64:65], s[90:91]
  s_and_b64 s[64:65], s[64:65], s[92:93]
  s_and_b64 s[64:65], s[64:65], s[94:95]
  s_and_b32 s64, s64, s65
  s_cbranch_scc0 Lini_161
  s_mov_b32 s46, 0xffff
  s_and_b32 s40, s21, 3
  s_lshl_b32 s40, s40, 13
  s_lshr_b32 s43, s21, 2
  s_lshl_b32 s43, s43, 10
  s_add_u32 s43, s43, s40
  s_add_u32 s43, s43, 1343488
  s_waitcnt lgkmcnt(0)
  s_memtime s[64:65]
  s_waitcnt lgkmcnt(0)
  s_load_dword s68, s[4:5], s43 glc
  s_waitcnt lgkmcnt(0)
  s_memtime s[66:67]
  s_waitcnt lgkmcnt(0)
  s_sub_u32 s64, s66, s64
  s_min_u32 s46, s46, s64
  s_getreg_b32 s55, hwreg(HW_REG_XCC_ID)
  s_and_b32 s55, s55, 15
  s_lshl_b32 s46, s46, 8
  s_or_b32 s46, s46, s55
  s_add_u32 s40, s21, 0
  s_lshl_b32 s40, s40, 7
  s_add_u32 s40, s40, 1424384
  s_mov_b32 s63, s46
  s_atomic_smax s63, s[4:5], s40 glc
Lnosig_162:
Lchore_160:
  s_waitcnt vmcnt(16) lgkmcnt(0)
  s_barrier
  s_add_u32 m0, s41, 16384
  s_add_u32 s42, s53, 4194304
  buffer_load_dwordx4 v11, s[8:11], s42 offen lds
  s_add_u32 m0, s41, 17408
  s_add_u32 s42, s53, 4259840
  buffer_load_dwordx4 v11, s[8:11], s42 offen lds
  s_add_u32 m0, s41, 18432
  s_add_u32 s42, s53, 4202496
  buffer_load_dwordx4 v11, s[8:11], s42 offen lds
  s_add_u32 m0, s41, 19456
  s_add_u32 s42, s53, 4268032
  buffer_load_dwordx4 v11, s[8:11], s42 offen lds
  s_add_u32 m0, s41, 20480
  s_add_u32 s42, s53, 4456448
  buffer_load_dwordx4 v11, s[8:11], s42 offen lds
  s_add_u32 m0, s41, 21504
  s_add_u32 s42, s53, 4521984
  buffer_load_dwordx4 v11, s[8:11], s42 offen lds
  s_add_u32 m0, s41, 22528
  s_add_u32 s42, s53, 4464640
  buffer_load_dwordx4 v11, s[8:11], s42 offen lds
  s_add_u32 m0, s41, 23552
  s_add_u32 s42, s53, 4530176
  buffer_load_dwordx4 v11, s[8:11], s42 offen lds
  ds_read_b64_tr_b16 a[72:73], v4 offset:24576
  ds_read_b64_tr_b16 a[74:75], v4 offset:26624
  ds_read_b64_tr_b16 a[76:77], v4 offset:28672
  ds_read_b64_tr_b16 a[78:79], v4 offset:30720
  ds_read_b64_tr_b16 a[88:89], v5 offset:24576
  ds_read_b64_tr_b16 a[90:91], v5 offset:26624
  ds_read_b64_tr_b16 a[92:93], v5 offset:28672
  ds_read_b64_tr_b16 a[94:95], v5 offset:30720
  ds_read_b64_tr_b16 a[104:105], v6 offset:24576
  ds_read_b64_tr_b16 a[106:107], v6 offset:26624
  ds_read_b64_tr_b16 a[108:109], v6 offset:28672
  ds_read_b64_tr_b16 a[110:111], v6 offset:30720
  ds_read_b64_tr_b16 a[120:121], v7 offset:24576
  ds_read_b64_tr_b16 a[122:123], v7 offset:26624
  ds_read_b64_tr_b16 a[124:125], v7 offset:28672
  ds_read_b64_tr_b16 a[126:127], v7 offset:30720
  s_waitcnt vmcnt(16) lgkmcnt(0)
  s_barrier
  s_add_u32 m0, s41, 24576
  s_add_u32 s42, s53, 6291456
  buffer_load_dwordx4 v11, s[8:11], s42 offen lds
  s_add_u32 m0, s41, 25600
  s_add_u32 s42, s53, 6356992
  buffer_load_dwordx4 v11, s[8:11], s42 offen lds
  s_add_u32 m0, s41, 26624
  s_add_u32 s42, s53, 6299648
  buffer_load_dwordx4 v11, s[8:11], s42 offen lds
  s_add_u32 m0, s41, 27648
  s_add_u32 s42, s53, 6365184
  buffer_load_dwordx4 v11, s[8:11], s42 offen lds
  s_add_u32 m0, s41, 28672
  s_add_u32 s42, s53, 6553600
  buffer_load_dwordx4 v11, s[8:11], s42 offen lds
  s_add_u32 m0, s41, 29696
  s_add_u32 s42, s53, 6619136
  buffer_load_dwordx4 v11, s[8:11], s42 offen lds
  s_add_u32 m0, s41, 30720
  s_add_u32 s42, s53, 6561792
  buffer_load_dwordx4 v11, s[8:11], s42 offen lds
  s_add_u32 m0, s41, 31744
  s_add_u32 s42, s53, 6627328
  buffer_load_dwordx4 v11, s[8:11], s42 offen lds
  ds_read_b64_tr_b16 a[128:129], v4 offset:0
  ds_read_b64_tr_b16 a[130:131], v4 offset:2048
  ds_read_b64_tr_b16 a[132:133], v4 offset:4096
  ds_read_b64_tr_b16 a[134:135], v4 offset:6144
  ds_read_b64_tr_b16 a[144:145], v5 offset:0
  ds_read_b64_tr_b16 a[146:147], v5 offset:2048
  ds_read_b64_tr_b16 a[148:149], v5 offset:4096
  ds_read_b64_tr_b16 a[150:151], v5 offset:6144
  ds_read_b64_tr_b16 a[160:161], v6 offset:0
  ds_read_b64_tr_b16 a[162:163], v6 offset:2048
  ds_read_b64_tr_b16 a[164:165], v6 offset:4096
  ds_read_b64_tr_b16 a[166:167], v6 offset:6144
  ds_read_b64_tr_b16 a[176:177], v7 offset:0
  ds_read_b64_tr_b16 a[178:179], v7 offset:2048
  ds_read_b64_tr_b16 a[180:181], v7 offset:4096
  ds_read_b64_tr_b16 a[182:183], v7 offset:6144
  s_waitcnt vmcnt(16) lgkmcnt(0)
  s_barrier
  s_load_dwordx2 s[8:9], s[0:1], 24
  s_mov_b32 s10, 8388608
  s_mov_b32 s11, 0x20000
  s_waitcnt lgkmcnt(0)
  s_add_u32 m0, s41, 0
  s_add_u32 s42, s52, 0
  buffer_load_dwordx4 v12, s[8:11], s42 offen lds
  s_add_u32 m0, s41, 1024
  s_add_u32 s42, s52, 65536
  buffer_load_dwordx4 v12, s[8:11], s42 offen lds
  s_add_u32 m0, s41, 2048
  s_add_u32 s42, s52, 8192
  buffer_load_dwordx4 v12, s[8:11], s42 offen lds
  s_add_u32 m0, s41, 3072
  s_add_u32 s42, s52, 73728
  buffer_load_dwordx4 v12, s[8:11], s42 offen lds
  s_add_u32 m0, s41, 4096
  s_add_u32 s42, s52, 262144
  buffer_load_dwordx4 v12, s[8:11], s42 offen lds
  s_add_u32 m0, s41, 5120
  s_add_u32 s42, s52, 327680
  buffer_load_dwordx4 v12, s[8:11], s42 offen lds
  s_add_u32 m0, s41, 6144
  s_add_u32 s42, s52, 270336
  buffer_load_dwordx4 v12, s[8:11], s42 offen lds
  s_add_u32 m0, s41, 7168
  s_add_u32 s42, s52, 335872
  buffer_load_dwordx4 v12, s[8:11], s42 offen lds
  ds_read_b64_tr_b16 a[136:137], v4 offset:8192
  ds_read_b64_tr_b16 a[138:139], v4 offset:10240
  ds_read_b64_tr_b16 a[140:141], v4 offset:12288
  ds_read_b64_tr_b16 a[142:143], v4 offset:14336
  ds_read_b64_tr_b16 a[152:153], v5 offset:8192
  ds_read_b64_tr_b16 a[154:155], v5 offset:10240
  ds_read_b64_tr_b16 a[156:157], v5 offset:12288
  ds_read_b64_tr_b16 a[158:159], v5 offset:14336
  ds_read_b64_tr_b16 a[168:169], v6 offset:8192
  ds_read_b64_tr_b16 a[170:171], v6 offset:10240
  ds_read_b64_tr_b16 a[172:173], v6 offset:12288
  ds_read_b64_tr_b16 a[174:175], v6 offset:14336
  ds_read_b64_tr_b16 a[184:185], v7 offset:8192
  ds_read_b64_tr_b16 a[186:187], v7 offset:10240
  ds_read_b64_tr_b16 a[188:189], v7 offset:12288
  ds_read_b64_tr_b16 a[190:191], v7 offset:14336
  s_waitcnt vmcnt(16) lgkmcnt(0)
  s_barrier
  s_add_u32 m0, s41, 8192
  s_add_u32 s42, s52, 2097152
  buffer_load_dwordx4 v12, s[8:11], s42 offen lds
  s_add_u32 m0, s41, 9216
  s_add_u32 s42, s52, 2162688
  buffer_load_dwordx4 v12, s[8:11], s42 offen lds
  s_add_u32 m0, s41, 10240
  s_add_u32 s42, s52, 2105344
  buffer_load_dwordx4 v12, s[8:11], s42 offen lds
  s_add_u32 m0, s41, 11264
  s_add_u32 s42, s52, 2170880
  buffer_load_dwordx4 v12, s[8:11], s42 offen lds
  s_add_u32 m0, s41, 12288
  s_add_u32 s42, s52, 2359296
  buffer_load_dwordx4 v12, s[8:11], s42 offen lds
  s_add_u32 m0, s41, 13312
  s_add_u32 s42, s52, 2424832
  buffer_load_dwordx4 v12, s[8:11], s42 offen lds
  s_add_u32 m0, s41, 14336
  s_add_u32 s42, s52, 2367488
  buffer_load_dwordx4 v12, s[8:11], s42 offen lds
  s_add_u32 m0, s41, 15360
  s_add_u32 s42, s52, 2433024
  buffer_load_dwordx4 v12, s[8:11], s42 offen lds
  ds_read_b64_tr_b16 a[192:193], v4 offset:16384
  ds_read_b64_tr_b16 a[194:195], v4 offset:18432
  ds_read_b64_tr_b16 a[196:197], v4 offset:20480
  ds_read_b64_tr_b16 a[198:199], v4 offset:22528
  ds_read_b64_tr_b16 a[208:209], v5 offset:16384
  ds_read_b64_tr_b16 a[210:211], v5 offset:18432
  ds_read_b64_tr_b16 a[212:213], v5 offset:20480
  ds_read_b64_tr_b16 a[214:215], v5 offset:22528
  ds_read_b64_tr_b16 a[224:225], v6 offset:16384
  ds_read_b64_tr_b16 a[226:227], v6 offset:18432
  ds_read_b64_tr_b16 a[228:229], v6 offset:20480
  ds_read_b64_tr_b16 a[230:231], v6 offset:22528
  ds_read_b64_tr_b16 a[240:241], v7 offset:16384
  ds_read_b64_tr_b16 a[242:243], v7 offset:18432
  ds_read_b64_tr_b16 a[244:245], v7 offset:20480
  ds_read_b64_tr_b16 a[246:247], v7 offset:22528
  s_waitcnt vmcnt(16) lgkmcnt(0)
  s_barrier
  s_add_u32 m0, s41, 16384
  s_add_u32 s42, s53, 4194304
  buffer_load_dwordx4 v12, s[8:11], s42 offen lds
  s_add_u32 m0, s41, 17408
  s_add_u32 s42, s53, 4259840
  buffer_load_dwordx4 v12, s[8:11], s42 offen lds
  s_add_u32 m0, s41, 18432
  s_add_u32 s42, s53, 4202496
  buffer_load_dwordx4 v12, s[8:11], s42 offen lds
  s_add_u32 m0, s41, 19456
  s_add_u32 s42, s53, 4268032
  buffer_load_dwordx4 v12, s[8:11], s42 offen lds
  s_add_u32 m0, s41, 20480
  s_add_u32 s42, s53, 4456448
  buffer_load_dwordx4 v12, s[8:11], s42 offen lds
  s_add_u32 m0, s41, 21504
  s_add_u32 s42, s53, 4521984
  buffer_load_dwordx4 v12, s[8:11], s42 offen lds
  s_add_u32 m0, s41, 22528
  s_add_u32 s42, s53, 4464640
  buffer_load_dwordx4 v12, s[8:11], s42 offen lds
  s_add_u32 m0, s41, 23552
  s_add_u32 s42, s53, 4530176
  buffer_load_dwordx4 v12, s[8:11], s42 offen lds
  ds_read_b64_tr_b16 a[200:201], v4 offset:24576
  ds_read_b64_tr_b16 a[202:203], v4 offset:26624
  ds_read_b64_tr_b16 a[204:205], v4 offset:28672
  ds_read_b64_tr_b16 a[206:207], v4 offset:30720
  ds_read_b64_tr_b16 a[216:217], v5 offset:24576
  ds_read_b64_tr_b16 a[218:219], v5 offset:26624
  ds_read_b64_tr_b16 a[220:221], v5 offset:28672
  ds_read_b64_tr_b16 a[222:223], v5 offset:30720
  ds_read_b64_tr_b16 a[232:233], v6 offset:24576
  ds_read_b64_tr_b16 a[234:235], v6 offset:26624
  ds_read_b64_tr_b16 a[236:237], v6 offset:28672
  ds_read_b64_tr_b16 a[238:239], v6 offset:30720
  ds_read_b64_tr_b16 a[248:249], v7 offset:24576
  ds_read_b64_tr_b16 a[250:251], v7 offset:26624
  ds_read_b64_tr_b16 a[252:253], v7 offset:28672
  ds_read_b64_tr_b16 a[254:255], v7 offset:30720
  s_waitcnt vmcnt(16) lgkmcnt(0)
  s_barrier
  s_add_u32 m0, s41, 24576
  s_add_u32 s42, s53, 6291456
  buffer_load_dwordx4 v12, s[8:11], s42 offen lds
  s_add_u32 m0, s41, 25600
  s_add_u32 s42, s53, 6356992
  buffer_load_dwordx4 v12, s[8:11], s42 offen lds
  s_add_u32 m0, s41, 26624
  s_add_u32 s42, s53, 6299648
  buffer_load_dwordx4 v12, s[8:11], s42 offen lds
  s_add_u32 m0, s41, 27648
  s_add_u32 s42, s53, 6365184
  buffer_load_dwordx4 v12, s[8:11], s42 offen lds
  s_add_u32 m0, s41, 28672
  s_add_u32 s42, s53, 6553600
  buffer_load_dwordx4 v12, s[8:11], s42 offen lds
  s_add_u32 m0, s41, 29696
  s_add_u32 s42, s53, 6619136
  buffer_load_dwordx4 v12, s[8:11], s42 offen lds
  s_add_u32 m0, s41, 30720
  s_add_u32 s42, s53, 6561792
  buffer_load_dwordx4 v12, s[8:11], s42 offen lds
  s_add_u32 m0, s41, 31744
  s_add_u32 s42, s53, 6627328
  buffer_load_dwordx4 v12, s[8:11], s42 offen lds
  ds_read_b64_tr_b16 v[20:21], v4 offset:0
  ds_read_b64_tr_b16 v[22:23], v4 offset:2048
  ds_read_b64_tr_b16 v[24:25], v4 offset:4096
  ds_read_b64_tr_b16 v[26:27], v4 offset:6144
  ds_read_b64_tr_b16 v[28:29], v5 offset:0
  ds_read_b64_tr_b16 v[30:31], v5 offset:2048
  ds_read_b64_tr_b16 v[32:33], v5 offset:4096
  ds_read_b64_tr_b16 v[34:35], v5 offset:6144
  ds_read_b64_tr_b16 v[36:37], v6 offset:0
  ds_read_b64_tr_b16 v[38:39], v6 offset:2048
  ds_read_b64_tr_b16 v[40:41], v6 offset:4096
  ds_read_b64_tr_b16 v[42:43], v6 offset:6144
  ds_read_b64_tr_b16 v[44:45], v7 offset:0
  ds_read_b64_tr_b16 v[46:47], v7 offset:2048
  ds_read_b64_tr_b16 v[48:49], v7 offset:4096
  ds_read_b64_tr_b16 v[50:51], v7 offset:6144
  s_waitcnt lgkmcnt(0)
  s_barrier
  ds_write_b128 v85, v[20:23] offset:0
  ds_write_b128 v85, v[24:27] offset:1024
  ds_write_b128 v85, v[28:31] offset:2048
  ds_write_b128 v85, v[32:35] offset:3072
  ds_write_b128 v85, v[36:39] offset:4096
  ds_write_b128 v85, v[40:43] offset:5120
  ds_write_b128 v85, v[44:47] offset:6144
  ds_write_b128 v85, v[48:51] offset:7168
  s_waitcnt vmcnt(16) lgkmcnt(0)
  s_barrier
  ds_read_b64_tr_b16 v[20:21], v4 offset:8192
  ds_read_b64_tr_b16 v[22:23], v4 offset:10240
  ds_read_b64_tr_b16 v[24:25], v4 offset:12288
  ds_read_b64_tr_b16 v[26:27], v4 offset:14336
  ds_read_b64_tr_b16 v[28:29], v5 offset:8192
  ds_read_b64_tr_b16 v[30:31], v5 offset:10240
  ds_read_b64_tr_b16 v[32:33], v5 offset:12288
  ds_read_b64_tr_b16 v[34:35], v5 offset:14336
  ds_read_b64_tr_b16 v[36:37], v6 offset:8192
  ds_read_b64_tr_b16 v[38:39], v6 offset:10240
  ds_read_b64_tr_b16 v[40:41], v6 offset:12288
  ds_read_b64_tr_b16 v[42:43], v6 offset:14336
  ds_read_b64_tr_b16 v[44:45], v7 offset:8192
  ds_read_b64_tr_b16 v[46:47], v7 offset:10240
  ds_read_b64_tr_b16 v[48:49], v7 offset:12288
  ds_read_b64_tr_b16 v[50:51], v7 offset:14336
  s_waitcnt lgkmcnt(0)
  s_barrier
  ds_write_b128 v85, v[20:23] offset:8192
  ds_write_b128 v85, v[24:27] offset:9216
  ds_write_b128 v85, v[28:31] offset:10240
  ds_write_b128 v85, v[32:35] offset:11264
  ds_write_b128 v85, v[36:39] offset:12288
  ds_write_b128 v85, v[40:43] offset:13312
  ds_write_b128 v85, v[44:47] offset:14336
  ds_write_b128 v85, v[48:51] offset:15360
  s_waitcnt vmcnt(8) lgkmcnt(0)
  s_barrier
  ds_read_b64_tr_b16 v[20:21], v4 offset:16384
  ds_read_b64_tr_b16 v[22:23], v4 offset:18432
  ds_read_b64_tr_b16 v[24:25], v4 offset:20480
  ds_read_b64_tr_b16 v[26:27], v4 offset:22528
  ds_read_b64_tr_b16 v[28:29], v5 offset:16384
  ds_read_b64_tr_b16 v[30:31], v5 offset:18432
  ds_read_b64_tr_b16 v[32:33], v5 offset:20480
  ds_read_b64_tr_b16 v[34:35], v5 offset:22528
  ds_read_b64_tr_b16 v[36:37], v6 offset:16384
  ds_read_b64_tr_b16 v[38:39], v6 offset:18432
  ds_read_b64_tr_b16 v[40:41], v6 offset:20480
  ds_read_b64_tr_b16 v[42:43], v6 offset:22528
  ds_read_b64_tr_b16 v[44:45], v7 offset:16384
  ds_read_b64_tr_b16 v[46:47], v7 offset:18432
  ds_read_b64_tr_b16 v[48:49], v7 offset:20480
  ds_read_b64_tr_b16 v[50:51], v7 offset:22528
  s_waitcnt lgkmcnt(0)
  s_barrier
  ds_write_b128 v85, v[20:23] offset:16384
  ds_write_b128 v85, v[24:27] offset:17408
  ds_write_b128 v85, v[28:31] offset:18432
  ds_write_b128 v85, v[32:35] offset:19456
  ds_write_b128 v85, v[36:39] offset:20480
  ds_write_b128 v85, v[40:43] offset:21504
  ds_write_b128 v85, v[44:47] offset:22528
  ds_write_b128 v85, v[48:51] offset:23552
  s_waitcnt vmcnt(0) lgkmcnt(0)
  s_barrier
  ds_read_b64_tr_b16 v[20:21], v4 offset:24576
  ds_read_b64_tr_b16 v[22:23], v4 offset:26624
  ds_read_b64_tr_b16 v[24:25], v4 offset:28672
  ds_read_b64_tr_b16 v[26:27], v4 offset:30720
  ds_read_b64_tr_b16 v[28:29], v5 offset:24576
  ds_read_b64_tr_b16 v[30:31], v5 offset:26624
  ds_read_b64_tr_b16 v[32:33], v5 offset:28672
  ds_read_b64_tr_b16 v[34:35], v5 offset:30720
  ds_read_b64_tr_b16 v[36:37], v6 offset:24576
  ds_read_b64_tr_b16 v[38:39], v6 offset:26624
  ds_read_b64_tr_b16 v[40:41], v6 offset:28672
  ds_read_b64_tr_b16 v[42:43], v6 offset:30720
  ds_read_b64_tr_b16 v[44:45], v7 offset:24576
  ds_read_b64_tr_b16 v[46:47], v7 offset:26624
  ds_read_b64_tr_b16 v[48:49], v7 offset:28672
  ds_read_b64_tr_b16 v[50:51], v7 offset:30720
  s_waitcnt lgkmcnt(0)
  s_barrier
  ds_write_b128 v85, v[20:23] offset:24576
  ds_write_b128 v85, v[24:27] offset:25600
  ds_write_b128 v85, v[28:31] offset:26624
  ds_write_b128 v85, v[32:35] offset:27648
  ds_write_b128 v85, v[36:39] offset:28672
  ds_write_b128 v85, v[40:43] offset:29696
  ds_write_b128 v85, v[44:47] offset:30720
  ds_write_b128 v85, v[48:51] offset:31744
  s_waitcnt lgkmcnt(0)
  s_getreg_b32 s55, hwreg(HW_REG_XCC_ID)
  s_and_b32 s55, s55, 15
  v_min_u32 v76, 63, v0
  v_lshlrev_b32 v76, 7, v76
  v_add_u32 v76, 1424384, v76
  s_nop 1
Lpoll_163:
  buffer_load_dword v77, v76, s[4:7], 0 offen sc1
  s_sub_u32 s24, s24, 1
  s_cbranch_scc1 L_FAIL
  s_waitcnt vmcnt(0)
  v_cmp_gt_i32 vcc, 0, v77
  s_cbranch_vccz Lpolld_164
  s_sleep 1
  s_branch Lpoll_163
Lpolld_164:
  v_and_b32 v78, 15, v77
  v_cmp_ne_u32 vcc, s55, v78
  s_lshl_b32 s40, s54, 4
  s_lshl_b32 s40, 0xffff, s40
  s_or_b32 s41, vcc_lo, vcc_hi
  s_and_b32 s40, s40, s41
  s_cselect_b32 s36, 0, 8192
  v_lshrrev_b32 v77, 8, v77
  v_and_b32 v78, 3, v0
  v_lshl_or_b32 v77, v77, 2, v78
  s_nop 1
  v_min_u32_dpp v77, v77, v77 row_ror:8 row_mask:0xf bank_mask:0xf
  s_nop 1
  v_min_u32_dpp v77, v77, v77 row_ror:4 row_mask:0xf bank_mask:0xf
  v_mov_b32 v78, v77
  s_nop 1
  v_permlane16_swap_b32 v78, v77
  v_min_u32 v77, v77, v78
  v_mov_b32 v78, v77
  s_nop 1
  v_permlane32_swap_b32 v78, v77
  v_min_u32 v77, v77, v78
  s_nop 1
  v_min_u32_dpp v77, v77, v77 row_ror:2 row_mask:0xf bank_mask:0xf
  s_nop 1
  v_min_u32_dpp v77, v77, v77 row_ror:1 row_mask:0xf bank_mask:0xf
  s_nop 0
  v_readfirstlane_b32 s26, v77
  s_and_b32 s26, s26, 3
  s_lshl_b32 s26, s26, 13
  s_lshr_b32 s40, s20, 1
  s_mul_i32 s40, s40, 32768
  s_and_b32 s41, s20, 1
  s_lshl_b32 s41, s41, 10
  s_add_u32 s40, s40, s41
  s_lshl_b32 s41, s54, 12
  s_add_u32 s40, s40, s41
  v_lshl_add_u32 v86, v0, 4, s40
  v_xor_b32 v87, 0x1000, v86
  v_and_b32 v76, 2, v0
  v_cmp_eq_u32 vcc, 0, v76
  v_mov_b32 v76, 0xeeee
  v_mov_b32 v77, 0x4444
  v_cndmask_b32 v88, v76, v77, vcc
  s_lshr_b32 s40, s21, 2
  s_mul_i32 s40, s40, 32768
  s_and_b32 s41, s21, 3
  s_lshl_b32 s41, s41, 11
  s_add_u32 s47, s40, s41
  s_lshl_b32 s41, s20, 9
  s_add_u32 s47, s47, s41
  v_lshl_add_u32 v92, v0, 3, s47
  s_lshl_b32 s41, s54, 12
  s_add_u32 s40, s41, 1310720
  s_add_u32 s40, s40, s26
  v_lshrrev_b32 v76, 2, v0
  v_lshl_add_u32 v76, v76, 7, s40
  v_and_b32 v77, 3, v0
  v_lshl_add_u32 v90, v77, 2, v76
  s_mov_b32 s57, s40
  s_cmp_eq_u32 s36, 0
  s_cselect_b32 s56, 1, s20
  s_and_b32 s41, s21, 15
  s_lshl_b32 s41, s41, 7
  s_lshl_b32 s40, s20, 2
  s_add_u32 s40, s40, s41
  s_add_u32 s40, s40, 2048
  s_mov_b32 s25, 0
  s_mov_b32 s60, 0
  s_mov_b32 s61, 0
  s_mov_b32 s51, -1
  v_mov_b32 v91, 2147483392
  s_mov_b64 exec, 1
  v_mov_b32 v91, s40
  s_mov_b64 exec, -1
  v_mov_b32 v80, -1
  v_mov_b32 v81, -1
  v_mov_b32 v82, -1
  v_mov_b32 v83, -1
  v_mov_b32 v112, 0
  v_mov_b32 v113, 0
  v_mov_b32 v114, 0
  v_mov_b32 v115, 0
  v_mov_b32 v116, 0
  v_mov_b32 v117, 0
  v_mov_b32 v118, 0
  v_mov_b32 v119, 0
  v_mov_b32 v120, 0
  v_mov_b32 v121, 0
  v_mov_b32 v106, 0
  v_mov_b32 v107, 0
  v_mov_b32 v108, 0x3f803f80
  v_mov_b32 v109, 0x3f803f80
  v_mov_b32 v110, 0x3f803f80
  v_mov_b32 v111, 0x3f803f80
  v_lshlrev_b32 v95, 4, v0
  s_lshl_b32 s58, s20, 12
  s_add_u32 s40, s58, 149504
  s_add_u32 s58, s58, 131072
  v_lshrrev_b32 v76, 4, v0
  v_bfe_u32 v77, v0, 2, 2
  v_xor_b32 v77, v76, v77
  v_lshl_add_u32 v123, v77, 3, s40
  v_and_b32 v77, 15, v0
  v_lshl_add_u32 v123, v77, 5, v123
  v_xor_b32 v76, v76, v0
  v_lshl_add_u32 v124, v76, 3, s40
  v_bfe_u32 v76, v0, 4, 1
  v_lshlrev_b32 v76, 1, v76
  v_and_b32 v77, 13, v0
  v_or_b32 v76, v76, v77
  v_lshl_add_u32 v122, v76, 4, s47
  v_lshrrev_b32 v76, 5, v0
  v_lshl_add_u32 v122, v76, 8, v122
  v_and_b32 v76, 2, v0
  v_cmp_eq_u32 vcc, 0, v76
  v_mov_b32 v77, 2147483392
  s_nop 0
  v_cndmask_b32 v122, v122, v77, vcc
  s_lshl_b32 s43, s21, 2
  s_add_u32 s43, s43, s20
  s_and_b32 s49, s20, 1
  s_lshl_b32 s49, s49, 10
  s_mul_i32 s32, s21, 65536
  s_lshl_b32 s40, s20, 11
  s_add_u32 s32, s32, s40
  s_and_b32 s40, s26, 0x2000
  s_xor_b32 s40, s40, 20971520
  s_add_u32 s32, s32, s40
  s_add_u32 s30, s32, s49
  s_add_u32 s30, s30, 49152
  s_lshr_b32 s59, s21, 1
  s_lshl_b32 s59, s59, 7
  s_add_u32 s59, s59, 1396736
  s_lshl_b32 s62, s21, 7
  s_add_u32 s62, s62, 1404928
  s_mov_b32 s38, 0x3e0293ee
  s_mov_b32 s39, s38
  v_xor_b32 v125, 4096, v124
  v_xor_b32 v126, 8192, v124
  v_xor_b32 v127, 12288, v124
  v_readfirstlane_b32 s88, v86
  s_xor_b32 s41, s47, 131072
  v_min_u32 v76, 3, v0
  v_lshl_add_u32 v87, v76, 7, s41
  v_lshrrev_b32 v76, 4, v0
  v_lshlrev_b32 v76, 2, v76
  v_and_b32 v77, 15, v0
  v_sub_u32 v76, v77, v76
  s_lshr_b32 s41, s49, 6
  v_add_u32 v76, s41, v76
  v_and_b32 v92, 0xfffffdff, v92
  v_mov_b32 v86, 0xd028965f
  v_cmp_le_i32 s[8:9], 0, v76
  v_cmp_le_i32 s[10:11], 1, v76
  v_cmp_le_i32 s[16:17], 2, v76
  v_cmp_le_i32 s[18:19], 3, v76
  v_cmp_le_i32 s[42:43], 16, v76
  v_cmp_le_i32 s[100:101], 17, v76
  v_cmp_le_i32 s[52:53], 18, v76
  v_cmp_le_i32 s[54:55], 19, v76
  s_xor_b32 s89, s88, 1024
  s_xor_b32 s90, s88, 32768
  s_xor_b32 s91, s88, 33792
  v_lshrrev_b32 v76, 4, v0
  v_lshl_add_u32 v76, v76, 7, s57
  v_and_b32 v77, 15, v0
  v_lshl_add_u32 v90, v77, 2, v76
  s_mov_b32 s25, 0
  s_add_u32 s27, s25, 32
  s_and_b32 s40, s27, 0x28
  s_mul_i32 s40, s40, 0x900
  s_and_b32 s40, s40, 0x6000
  s_xor_b32 s40, s40, s26
  s_lshl_b32 s27, s27, 16
  s_add_u32 s27, s27, s40
  s_lshl_b32 s37, s36, 1
  s_xor_b32 s37, s27, s37
  s_and_b32 s40, s25, 3
  s_lshl_b32 s40, s40, 18
  s_add_u32 s28, s40, s26
  s_lshr_b32 s40, s40, 5
  s_and_b32 s40, s40, 0x4000
  s_xor_b32 s28, s28, s40
  s_xor_b32 s29, s28, 0x4000
  s_xor_b32 s40, s28, 8192
  buffer_load_dword v89, v122, s[4:7], s40 offen sc1
  s_mov_b32 s25, 1
  s_add_u32 s27, s25, 32
  s_and_b32 s40, s27, 0x28
  s_mul_i32 s40, s40, 0x900
  s_and_b32 s40, s40, 0x6000
  s_xor_b32 s40, s40, s26
  s_lshl_b32 s27, s27, 16
  s_add_u32 s27, s27, s40
  s_lshl_b32 s37, s36, 1
  s_xor_b32 s37, s27, s37
  s_and_b32 s40, s25, 3
  s_lshl_b32 s40, s40, 18
  s_add_u32 s28, s40, s26
  s_lshr_b32 s40, s40, 5
  s_and_b32 s40, s40, 0x4000
  s_xor_b32 s28, s28, s40
  s_xor_b32 s29, s28, 0x4000
  s_xor_b32 s40, s28, 8192
  buffer_load_dword v89, v122, s[4:7], s40 offen sc1
  s_mov_b32 s25, 2
  s_add_u32 s27, s25, 32
  s_and_b32 s40, s27, 0x28
  s_mul_i32 s40, s40, 0x900
  s_and_b32 s40, s40, 0x6000
  s_xor_b32 s40, s40, s26
  s_lshl_b32 s27, s27, 16
  s_add_u32 s27, s27, s40
  s_lshl_b32 s37, s36, 1
  s_xor_b32 s37, s27, s37
  s_and_b32 s40, s25, 3
  s_lshl_b32 s40, s40, 18
  s_add_u32 s28, s40, s26
  s_lshr_b32 s40, s40, 5
  s_and_b32 s40, s40, 0x4000
  s_xor_b32 s28, s28, s40
  s_xor_b32 s29, s28, 0x4000
  s_xor_b32 s40, s28, 8192
  buffer_load_dword v89, v122, s[4:7], s40 offen sc1
  s_mov_b32 s25, 3
  s_add_u32 s27, s25, 32
  s_and_b32 s40, s27, 0x28
  s_mul_i32 s40, s40, 0x900
  s_and_b32 s40, s40, 0x6000
  s_xor_b32 s40, s40, s26
  s_lshl_b32 s27, s27, 16
  s_add_u32 s27, s27, s40
  s_lshl_b32 s37, s36, 1
  s_xor_b32 s37, s27, s37
  s_and_b32 s40, s25, 3
  s_lshl_b32 s40, s40, 18
  s_add_u32 s28, s40, s26
  s_lshr_b32 s40, s40, 5
  s_and_b32 s40, s40, 0x4000
  s_xor_b32 s28, s28, s40
  s_xor_b32 s29, s28, 0x4000
  s_xor_b32 s40, s28, 8192
  buffer_load_dword v89, v122, s[4:7], s40 offen sc1
  buffer_load_dword v89, v90, s[4:7], 0 offen offset:0 sc1
  s_mov_b32 s25, 0
  s_mov_b32 s33, 1
  s_mov_b64 s[44:45], 0
  s_mov_b64 s[46:47], 0
  s_cmp_lg_u32 s20, 1
  s_cbranch_scc1 Lskip_167
Lask_165:
  s_min_i32 s50, s44, s45
  s_min_i32 s50, s50, s46
  s_min_i32 s50, s50, s47
  s_cmp_ge_i32 s50, s33
  s_cbranch_scc1 Lhave_166
  s_load_dwordx4 s[44:47], s[4:5], s59 glc
  s_sub_u32 s24, s24, 1
  s_cbranch_scc1 L_FAIL
  s_waitcnt lgkmcnt(0)
  s_branch Lask_165
Lhave_166:
  s_add_u32 s33, s33, 2
  s_min_u32 s33, s33, 64
  s_cmp_ge_i32 s50, s33
  s_cbranch_scc1 Lskip_167
  s_load_dwordx4 s[44:47], s[4:5], s59 glc
Lskip_167:
  s_barrier
  s_add_u32 m0, s58, 16384
  s_add_u32 s31, s32, 16384
  buffer_load_dwordx4 v95, s[4:7], s31 offen offset:0 sc1 lds
  buffer_load_dwordx4 v95, s[4:7], s31 offen offset:1024 sc1 lds
  s_add_u32 m0, s58, 2048
  s_add_u32 s31, s32, 32768
  buffer_load_dwordx4 v95, s[4:7], s31 offen offset:0 sc1 lds
  buffer_load_dwordx4 v95, s[4:7], s31 offen offset:1024 sc1 lds
  s_mov_b32 m0, s58
  s_add_u32 s31, s32, s49
  buffer_load_dwordx4 v95, s[4:7], s31 offen offset:0 sc1 lds
  s_sub_u32 s31, s32, s49
  buffer_load_dwordx4 v95, s[4:7], s31 offen offset:1024 sc1 lds
  s_add_u32 s27, s25, 32
  s_and_b32 s40, s27, 0x28
  s_mul_i32 s40, s40, 0x900
  s_and_b32 s40, s40, 0x6000
  s_xor_b32 s40, s40, s26
  s_lshl_b32 s27, s27, 16
  s_add_u32 s27, s27, s40
  s_lshl_b32 s37, s36, 1
  s_xor_b32 s37, s27, s37
  s_and_b32 s40, s25, 3
  s_lshl_b32 s40, s40, 18
  s_add_u32 s28, s40, s26
  s_lshr_b32 s40, s40, 5
  s_and_b32 s40, s40, 0x4000
  s_xor_b32 s28, s28, s40
  s_xor_b32 s29, s28, 0x4000
  s_xor_b32 s34, s28, 0x84000
  s_xor_b32 s48, s28, 8192
  s_lshr_b32 s40, s49, 1
  s_add_u32 s29, s29, s40
  s_xor_b32 s35, s29, 512
  s_add_u32 s92, s37, s88
  s_add_u32 s96, s27, s88
  s_xor_b32 s96, s96, 0x1000
  s_add_u32 s93, s37, s89
  s_add_u32 s97, s27, s89
  s_xor_b32 s97, s97, 0x1000
  s_add_u32 s94, s37, s90
  s_add_u32 s98, s27, s90
  s_xor_b32 s98, s98, 0x1000
  s_add_u32 s95, s37, s91
  s_add_u32 s99, s27, s91
  s_xor_b32 s99, s99, 0x1000
L_QK_top:
  v_mov_b32_e64 v94, s25
  v_mov_b64 v[52:53], 0
  v_mov_b64 v[54:55], 0
  v_mov_b64 v[56:57], 0
  v_mov_b64 v[58:59], 0
  v_mov_b64 v[60:61], 0
  v_mov_b64 v[62:63], 0
  v_mov_b64 v[64:65], 0
  v_mov_b64 v[66:67], 0
  ds_read_b128 v[20:23], v85 offset:0
  ds_read_b128 v[24:27], v85 offset:1024
  ds_read_b128 v[28:31], v85 offset:8192
  ds_read_b128 v[32:35], v85 offset:9216
  ds_read_b128 v[36:39], v85 offset:2048
  ds_read_b128 v[40:43], v85 offset:3072
  ds_read_b128 v[44:47], v85 offset:10240
  ds_read_b128 v[48:51], v85 offset:11264
  s_waitcnt lgkmcnt(0)
  s_and_b32 s40, s25, 63
  s_cselect_b32 s40, s56, 1
  s_cmp_lg_u32 s40, 0
  s_cbranch_scc1 L_QK_park
  v_mov_b32 v76, -1
  s_sleep 4
  s_nop 0
  s_nop 0
L_QK_spin:
  s_sub_u32 s24, s24, 1
  s_nop 0
  s_nop 0
  s_cbranch_scc1 L_FAIL
  s_nop 0
  s_waitcnt vmcnt(40)
  buffer_load_dword v76, v90, s[4:7], 0 offen sc1
  s_nop 3
  v_cmp_gt_i32_e64 vcc, s25, v76
  s_cbranch_vccz L_QK_rel
  buffer_load_dword v76, v90, s[4:7], 0 offen sc1
  s_nop 3
  v_cmp_gt_i32 vcc, s25, v76
  s_cbranch_vccz L_QK_rel
  buffer_load_dword v76, v90, s[4:7], 0 offen sc1
  s_nop 3
  v_cmp_gt_i32 vcc, s25, v76
  s_cbranch_vccz L_QK_rel
  buffer_load_dword v76, v90, s[4:7], 0 offen sc1
  s_nop 3
  v_cmp_gt_i32_e64 vcc, s25, v76
  s_cbranch_vccnz L_QK_spin
L_QK_rel:
  s_barrier
  s_mov_b64 exec, -1
L_QK_go:
L_QKM_again:
  buffer_load_dwordx4 v[4:7], v95, s[4:7], s92 offen offset:0
  s_nop 0
  buffer_load_dwordx4 v[8:11], v95, s[4:7], s92 offen offset:2048
  s_nop 0
  buffer_load_dwordx4 v[12:15], v95, s[4:7], s93 offen offset:0
  s_nop 0
  buffer_load_dwordx4 v[16:19], v95, s[4:7], s93 offen offset:2048
  s_nop 0
  buffer_load_dwordx4 v[68:71], v95, s[4:7], s94 offen offset:0
  s_nop 0
  ds_read_b128 v[96:99], v1 offset:2048
  ds_read_b128 v[100:103], v1 offset:3072
  s_cmp_lg_u32 s20, 0
  s_nop 0
  s_cbranch_scc1 L_QK_sigd
  s_mov_b32 s63, s25
  s_waitcnt vmcnt(5)
  s_atomic_smax s63, s[4:5], s62 glc
L_QK_sigd:
  s_waitcnt vmcnt(4)
  v_cmp_eq_u32_e64 vcc, -1, v4
  s_cbranch_vccnz L_QKM_g0
L_QKM_ok0:
  v_smfmac_f32_16x16x64_bf16 v[52:55], v[4:7], a[0:7], v88
  buffer_load_dwordx4 v[72:75], v95, s[4:7], s94 offen offset:2048
  v_smfmac_f32_16x16x64_bf16 v[60:63], v[4:7], v[128:135], v88
  s_waitcnt vmcnt(4)
  v_cmp_eq_u32 vcc, -1, v8
  v_smfmac_f32_16x16x64_bf16 v[56:59], v[4:7], a[128:135], v88
  v_smfmac_f32_16x16x64_bf16 v[64:67], v[4:7], v[20:27], v88
  s_cbranch_vccnz L_QKM_g1
L_QKM_ok1:
  v_smfmac_f32_16x16x64_bf16 v[52:55], v[8:11], a[8:15], v88
  buffer_load_dwordx4 v[4:7], v95, s[4:7], s95 offen offset:0
  ds_read_b128 v[20:23], v85 offset:4096
  v_smfmac_f32_16x16x64_bf16 v[60:63], v[8:11], v[136:143], v88
  s_nop 0
  s_waitcnt vmcnt(4)
  v_cmp_eq_u32_e64 vcc, -1, v12
  v_smfmac_f32_16x16x64_bf16 v[56:59], v[8:11], a[136:143], v88
  ds_read_b128 v[24:27], v85 offset:5120
  v_smfmac_f32_16x16x64_bf16 v[64:67], v[8:11], v[28:35], v88
  s_cbranch_vccnz L_QKM_g2
L_QKM_ok2:
  v_smfmac_f32_16x16x64_bf16 v[52:55], v[12:15], a[16:23], v88
  buffer_load_dwordx4 v[8:11], v95, s[4:7], s95 offen offset:2048
  ds_read_b128 v[28:31], v85 offset:12288
  v_smfmac_f32_16x16x64_bf16 v[60:63], v[12:15], v[144:151], v88
  s_waitcnt vmcnt(4)
  v_cmp_eq_u32 vcc, -1, v16
  v_smfmac_f32_16x16x64_bf16 v[56:59], v[12:15], a[144:151], v88
  ds_read_b128 v[32:35], v85 offset:13312
  v_smfmac_f32_16x16x64_bf16 v[64:67], v[12:15], v[36:43], v88
  s_cbranch_vccnz L_QKM_g3
L_QKM_ok3:
  v_smfmac_f32_16x16x64_bf16 v[52:55], v[16:19], a[24:31], v88
  buffer_load_dwordx4 v[12:15], v95, s[4:7], s96 offen offset:0
  ds_read_b128 v[36:39], v85 offset:6144
  v_smfmac_f32_16x16x64_bf16 v[60:63], v[16:19], v[152:159], v88
  s_waitcnt vmcnt(4)
  v_cmp_eq_u32 vcc, -1, v68
  v_smfmac_f32_16x16x64_bf16 v[56:59], v[16:19], a[152:159], v88
  ds_read_b128 v[40:43], v85 offset:7168
  v_smfmac_f32_16x16x64_bf16 v[64:67], v[16:19], v[44:51], v88
  s_cbranch_vccnz L_QKM_g4
L_QKM_ok4:
  v_smfmac_f32_16x16x64_bf16 v[52:55], v[68:71], a[32:39], v88
  buffer_load_dwordx4 v[16:19], v95, s[4:7], s96 offen offset:2048
  ds_read_b128 v[44:47], v85 offset:14336
  v_smfmac_f32_16x16x64_bf16 v[60:63], v[68:71], v[160:167], v88
  s_waitcnt vmcnt(4)
  v_cmp_eq_u32 vcc, -1, v72
  v_smfmac_f32_16x16x64_bf16 v[56:59], v[68:71], a[160:167], v88
  ds_read_b128 v[48:51], v85 offset:15360
  s_waitcnt lgkmcnt(6)
  v_smfmac_f32_16x16x64_bf16 v[64:67], v[68:71], v[20:27], v88
  s_cbranch_vccnz L_QKM_g5
L_QKM_ok5:
  v_smfmac_f32_16x16x64_bf16 v[52:55], v[72:75], a[40:47], v88
  buffer_load_dwordx4 v[68:71], v95, s[4:7], s97 offen offset:0
  ds_read_b128 v[20:23], v85 offset:16384
  v_smfmac_f32_16x16x64_bf16 v[60:63], v[72:75], v[168:175], v88
  s_waitcnt vmcnt(4)
  v_cmp_eq_u32_e64 vcc, -1, v4
  v_smfmac_f32_16x16x64_bf16 v[56:59], v[72:75], a[168:175], v88
  ds_read_b128 v[24:27], v85 offset:17408
  s_nop 0
  s_waitcnt lgkmcnt(6)
  v_smfmac_f32_16x16x64_bf16 v[64:67], v[72:75], v[28:35], v88
  s_cbranch_vccnz L_QKM_g6
L_QKM_ok6:
  v_smfmac_f32_16x16x64_bf16 v[52:55], v[4:7], a[48:55], v88
  buffer_load_dwordx4 v[72:75], v95, s[4:7], s97 offen offset:2048
  ds_read_b128 v[28:31], v85 offset:24576
  v_smfmac_f32_16x16x64_bf16 v[60:63], v[4:7], v[176:183], v88
  s_waitcnt vmcnt(4)
  v_cmp_eq_u32 vcc, -1, v8
  v_smfmac_f32_16x16x64_bf16 v[56:59], v[4:7], a[176:183], v88
  ds_read_b128 v[32:35], v85 offset:25600
  s_waitcnt lgkmcnt(6)
  v_smfmac_f32_16x16x64_bf16 v[64:67], v[4:7], v[36:43], v88
  s_cbranch_vccnz L_QKM_g7
L_QKM_ok7:
  v_smfmac_f32_16x16x64_bf16 v[52:55], v[8:11], a[56:63], v88
  buffer_load_dwordx4 v[4:7], v95, s[4:7], s98 offen offset:0
  ds_read_b128 v[36:39], v85 offset:18432
  v_smfmac_f32_16x16x64_bf16 v[60:63], v[8:11], v[184:191], v88
  s_waitcnt vmcnt(4)
  v_cmp_eq_u32 vcc, -1, v12
  v_smfmac_f32_16x16x64_bf16 v[56:59], v[8:11], a[184:191], v88
  ds_read_b128 v[40:43], v85 offset:19456
  s_waitcnt lgkmcnt(6)
  v_smfmac_f32_16x16x64_bf16 v[64:67], v[8:11], v[44:51], v88
  s_cbranch_vccnz L_QKM_g8
L_QKM_ok8:
  v_smfmac_f32_16x16x64_bf16 v[52:55], v[12:15], a[64:71], v88
  buffer_load_dwordx4 v[8:11], v95, s[4:7], s98 offen offset:2048
  ds_read_b128 v[44:47], v85 offset:26624
  v_smfmac_f32_16x16x64_bf16 v[60:63], v[12:15], v[192:199], v88
  s_waitcnt vmcnt(4)
  v_cmp_eq_u32_e64 vcc, -1, v16
  v_smfmac_f32_16x16x64_bf16 v[56:59], v[12:15], a[192:199], v88
  ds_read_b128 v[48:51], v85 offset:27648
  s_nop 0
  s_waitcnt lgkmcnt(6)
  v_smfmac_f32_16x16x64_bf16 v[64:67], v[12:15], v[20:27], v88
  s_cbranch_vccnz L_QKM_g9
L_QKM_ok9:
  v_smfmac_f32_16x16x64_bf16 v[52:55], v[16:19], a[72:79], v88
  buffer_load_dwordx4 v[12:15], v95, s[4:7], s99 offen offset:0
  ds_read_b128 v[20:23], v85 offset:20480
  v_smfmac_f32_16x16x64_bf16 v[60:63], v[16:19], v[200:207], v88
  s_waitcnt vmcnt(4)
  v_cmp_eq_u32 vcc, -1, v68
  v_smfmac_f32_16x16x64_bf16 v[56:59], v[16:19], a[200:207], v88
  ds_read_b128 v[24:27], v85 offset:21504
  s_waitcnt lgkmcnt(6)
  v_smfmac_f32_16x16x64_bf16 v[64:67], v[16:19], v[28:35], v88
  s_cbranch_vccnz L_QKM_g10
L_QKM_ok10:
  v_smfmac_f32_16x16x64_bf16 v[52:55], v[68:71], a[80:87], v88
  buffer_load_dwordx4 v[16:19], v95, s[4:7], s99 offen offset:2048
  ds_read_b128 v[28:31], v85 offset:28672
  v_smfmac_f32_16x16x64_bf16 v[60:63], v[68:71], v[208:215], v88
  s_waitcnt vmcnt(4)
  v_cmp_eq_u32 vcc, -1, v72
  v_smfmac_f32_16x16x64_bf16 v[56:59], v[68:71], a[208:215], v88
  ds_read_b128 v[32:35], v85 offset:29696
  s_waitcnt lgkmcnt(6)
  v_smfmac_f32_16x16x64_bf16 v[64:67], v[68:71], v[36:43], v88
  s_cbranch_vccnz L_QKM_g11
L_QKM_ok11:
  v_smfmac_f32_16x16x64_bf16 v[52:55], v[72:75], a[88:95], v88
  ds_read_b128 v[36:39], v85 offset:22528
  v_smfmac_f32_16x16x64_bf16 v[60:63], v[72:75], v[216:223], v88
  s_waitcnt vmcnt(3)
  v_cmp_eq_u32 vcc, -1, v4
  v_smfmac_f32_16x16x64_bf16 v[56:59], v[72:75], a[216:223], v88
  ds_read_b128 v[40:43], v85 offset:23552
  s_waitcnt lgkmcnt(6)
  v_smfmac_f32_16x16x64_bf16 v[64:67], v[72:75], v[44:51], v88
  s_cbranch_vccnz L_QKM_g12
L_QKM_ok12:
  v_smfmac_f32_16x16x64_bf16 v[52:55], v[4:7], a[96:103], v88
  ds_read_b128 v[44:47], v85 offset:30720
  v_smfmac_f32_16x16x64_bf16 v[60:63], v[4:7], v[224:231], v88
  s_waitcnt vmcnt(2)
  v_cmp_eq_u32 vcc, -1, v8
  v_smfmac_f32_16x16x64_bf16 v[56:59], v[4:7], a[224:231], v88
  ds_read_b128 v[48:51], v85 offset:31744
  s_waitcnt lgkmcnt(6)
  v_smfmac_f32_16x16x64_bf16 v[64:67], v[4:7], v[20:27], v88
  s_cbranch_vccnz L_QKM_g13
L_QKM_ok13:
  v_smfmac_f32_16x16x64_bf16 v[52:55], v[8:11], a[104:111], v88
  ds_read_b128 v[20:23], v1 offset:16384
  ds_read_b128 v[24:27], v1 offset:17408
  v_smfmac_f32_16x16x64_bf16 v[60:63], v[8:11], v[232:239], v88
  s_waitcnt vmcnt(1)
  v_cmp_eq_u32_e64 vcc, -1, v12
  v_smfmac_f32_16x16x64_bf16 v[56:59], v[8:11], a[232:239], v88
  ds_read_b128 v[68:71], v84 offset:16384
  s_nop 0
  s_waitcnt lgkmcnt(7)
  v_smfmac_f32_16x16x64_bf16 v[64:67], v[8:11], v[28:35], v88
  s_cbranch_vccnz L_QKM_g14
L_QKM_ok14:
  v_smfmac_f32_16x16x64_bf16 v[52:55], v[12:15], a[112:119], v88
  ds_read_b128 v[28:31], v2 offset:16384
  ds_read_b128 v[32:35], v2 offset:17408
  v_smfmac_f32_16x16x64_bf16 v[60:63], v[12:15], v[240:247], v88
  s_waitcnt vmcnt(0)
  v_cmp_eq_u32 vcc, -1, v16
  v_smfmac_f32_16x16x64_bf16 v[56:59], v[12:15], a[240:247], v88
  ds_read_b128 v[72:75], v84 offset:17408
  s_waitcnt lgkmcnt(8)
  v_smfmac_f32_16x16x64_bf16 v[64:67], v[12:15], v[36:43], v88
  s_cbranch_vccnz L_QKM_g15
L_QKM_ok15:
  v_smfmac_f32_16x16x64_bf16 v[52:55], v[16:19], a[120:127], v88
  ds_read_b128 v[36:39], v3 offset:16384
  v_smfmac_f32_16x16x64_bf16 v[60:63], v[16:19], v[248:255], v88
  ds_read_b128 v[40:43], v3 offset:17408
  v_smfmac_f32_16x16x64_bf16 v[56:59], v[16:19], a[248:255], v88
  s_waitcnt lgkmcnt(8)
  v_smfmac_f32_16x16x64_bf16 v[64:67], v[16:19], v[44:51], v88
L_QKM_join:
  s_nop 1
  v_pk_add_f32 v[52:53], v[52:53], v[54:55]
  s_nop 0
  v_pk_add_f32 v[60:61], v[60:61], v[62:63]
  v_cmp_u_f32 vcc, v52, v53
  v_cvt_pk_bf16_f32 v77, v52, v53
  v_cvt_pk_bf16_f32 v76, v60, v61
  ds_write_b64 v123, v[76:77] offset:0
  v_pk_add_f32 v[56:57], v[56:57], v[58:59]
  v_pk_add_f32 v[64:65], v[64:65], v[66:67]
  v_cvt_pk_bf16_f32 v79, v56, v57
  v_cvt_pk_bf16_f32 v78, v64, v65
  ds_write_b64 v123, v[78:79] offset:512
  ds_read_b64_tr_b16 v[4:5], v124 offset:0
  ds_read_b64_tr_b16 v[6:7], v124 offset:512
  s_cbranch_vccnz L_QKM_nan
L_QKM_done:
  s_waitcnt lgkmcnt(2)
  s_barrier
  ds_read_b64_tr_b16 v[8:9], v125 offset:0
  ds_read_b64_tr_b16 v[10:11], v125 offset:512
  s_waitcnt lgkmcnt(2)
  v_mfma_f32_16x16x32_bf16 v[52:55], v[20:23], v[4:7], 0
  ds_read_b64_tr_b16 v[12:13], v126 offset:0
  ds_read_b64_tr_b16 v[14:15], v126 offset:512
  v_mfma_f32_16x16x32_bf16 v[56:59], v[24:27], v[4:7], 0
  ds_read_b64_tr_b16 v[16:17], v127 offset:0
  ds_read_b64_tr_b16 v[18:19], v127 offset:512
  v_mfma_f32_16x16x32_bf16 v[60:63], v[4:7], v[4:7], 0
  s_waitcnt lgkmcnt(4)
  v_mfma_f32_16x16x32_bf16 v[52:55], v[28:31], v[8:11], v[52:55]
  v_mfma_f32_16x16x32_bf16 v[56:59], v[32:35], v[8:11], v[56:59]
  v_mfma_f32_16x16x32_bf16 v[60:63], v[8:11], v[8:11], v[60:63]
  s_waitcnt lgkmcnt(2)
  v_mfma_f32_16x16x32_bf16 v[52:55], v[36:39], v[12:15], v[52:55]
  v_mfma_f32_16x16x32_bf16 v[56:59], v[40:43], v[12:15], v[56:59]
  v_mfma_f32_16x16x32_bf16 v[60:63], v[12:15], v[12:15], v[60:63]
  s_waitcnt lgkmcnt(0)
  v_mfma_f32_16x16x32_bf16 v[52:55], v[68:71], v[16:19], v[52:55]
  buffer_load_dwordx2 v[104:105], v92, s[4:7], s29 offen sc1
  v_mfma_f32_16x16x32_bf16 v[56:59], v[72:75], v[16:19], v[56:59]
  v_mfma_f32_16x16x32_bf16 v[60:63], v[16:19], v[16:19], v[60:63]
  s_mov_b32 vcc_lo, 0xcccccccc
  s_mov_b32 vcc_hi, 0xcccccccc
  v_mov_b32 v79, s38
  s_nop 1
  v_max3_f32 v64, v52, v53, v54
  s_nop 0
  v_max3_f32 v65, v55, v56, v57
  v_max3_f32 v64, v64, v58, v59
  v_max3_f32 v65, v65, v60, v61
  v_max_f32 v66, v64, v65
  v_max_f32 v67, v64, v65
  v_cndmask_b32_dpp v60, v61, v60, vcc quad_perm:[2,3,2,3] row_mask:0xf bank_mask:0xf
  v_cndmask_b32_dpp v52, v56, v52, vcc quad_perm:[2,3,2,3] row_mask:0xf bank_mask:0xf
  v_permlane16_swap_b32 v66, v67
  v_max_f32 v64, v66, v67
  v_max_f32 v65, v66, v67
  v_cndmask_b32_dpp v53, v57, v53, vcc quad_perm:[2,3,2,3] row_mask:0xf bank_mask:0xf
  v_cndmask_b32_dpp v54, v58, v54, vcc quad_perm:[2,3,2,3] row_mask:0xf bank_mask:0xf
  v_permlane32_swap_b32 v64, v65
  v_max_f32 v64, v64, v65
  v_cndmask_b32_dpp v55, v59, v55, vcc quad_perm:[2,3,2,3] row_mask:0xf bank_mask:0xf
  s_nop 0
  v_mul_f32_dpp v64, v64, v79 quad_perm:[2,3,2,3] row_mask:0xf bank_mask:0xf
  v_pk_fma_f32 v[52:53], v[52:53], s[38:39], v[64:65] op_sel_hi:[1,1,0] neg_lo:[0,0,1] neg_hi:[0,0,1]
  v_pk_fma_f32 v[54:55], v[54:55], s[38:39], v[64:65] op_sel_hi:[1,1,0] neg_lo:[0,0,1] neg_hi:[0,0,1]
  v_exp_f32 v52, v52
  v_exp_f32 v53, v53
  v_exp_f32 v54, v54
  v_cvt_pk_bf16_f32 v76, v52, v53
  v_exp_f32 v55, v55
  v_fma_f32 v60, v60, s38, -v64
  v_cvt_pk_bf16_f32 v77, v54, v55
  v_mov_b32_dpp v78, v76 quad_perm:[0,1,0,1] row_mask:0xf bank_mask:0xf
  v_exp_f32 v60, v60
  v_mov_b32_dpp v79, v77 quad_perm:[0,1,0,1] row_mask:0xf bank_mask:0xf
  s_nop 0
  v_mov_b32_dpp v61, v60 quad_perm:[0,1,0,1] row_mask:0xf bank_mask:0xf
  v_mfma_f32_16x16x32_bf16 v[64:67], v[108:111], v[76:79], 0
  v_cvt_pk_bf16_f32 v114, v60, v61
  v_cvt_pk_bf16_f32 v119, v60, v61
  s_waitcnt vmcnt(0)
  v_mfma_f32_16x16x32_bf16 v[44:47], v[96:99], v[76:79], 0
  v_max_u32 v89, v104, v105
  v_cmp_eq_u32 vcc, -1, v89
  v_mfma_f32_16x16x32_bf16 v[64:67], v[108:111], v[114:117], v[64:67]
  v_mfma_f32_16x16x32_bf16 v[48:51], v[100:103], v[76:79], 0
  s_cbranch_vccnz L_QK_vbad0
L_QK_vok0:
  buffer_store_dword v94, v91, s[4:7], s57 offen
  v_mfma_f32_16x16x32_bf16 v[44:47], v[104:107], v[114:117], v[44:47]
  v_mfma_f32_16x16x32_bf16 v[48:51], v[104:107], v[118:121], v[48:51]
  s_nop 2
  v_rcp_f32_e64 v64, v64
  s_nop 2
  v_pk_mul_f32 v[44:45], v[44:45], v[64:65] op_sel_hi:[1,0]
  v_pk_mul_f32 v[46:47], v[46:47], v[64:65] op_sel_hi:[1,0]
  v_pk_mul_f32 v[48:49], v[48:49], v[64:65] op_sel_hi:[1,0]
  v_pk_mul_f32 v[50:51], v[50:51], v[64:65] op_sel_hi:[1,0]
  v_cvt_pk_bf16_f32 v52, v44, v45
  v_cvt_pk_bf16_f32 v53, v46, v47
  v_cvt_pk_bf16_f32 v54, v48, v49
  v_cvt_pk_bf16_f32 v55, v50, v51
  buffer_store_dwordx4 v[52:55], v122, s[4:7], s48 offen
  ds_read_b128 v[44:47], v1 offset:0
  ds_read_b128 v[48:51], v2 offset:1024
  s_add_u32 s32, s32, 2097152
  s_xor_b32 s32, s32, 0x2000
  s_add_u32 s33, s25, 2
  s_min_u32 s33, s33, 64
  s_waitcnt lgkmcnt(0)
  buffer_load_dwordx2 v[106:107], v92, s[4:7], s35 offen sc1
  buffer_store_dwordx4 v[52:55], v122, s[4:7], s28 offen sc1
  v_mfma_f32_16x16x32_bf16 v[56:59], v[20:23], v[44:47], 0
  v_mfma_f32_16x16x32_bf16 v[60:63], v[24:27], v[44:47], 0
  v_mfma_f32_16x16x32_bf16 v[64:67], v[4:7], v[44:47], 0
  ds_read_b128 v[20:23], v3 offset:0
  ds_read_b128 v[24:27], v2 offset:2048
  v_mfma_f32_16x16x32_bf16 v[56:59], v[28:31], v[48:51], v[56:59]
  v_mfma_f32_16x16x32_bf16 v[60:63], v[32:35], v[48:51], v[60:63]
  v_mfma_f32_16x16x32_bf16 v[64:67], v[8:11], v[48:51], v[64:67]
  ds_read_b128 v[28:31], v84 offset:1024
  ds_read_b128 v[32:35], v2 offset:3072
  s_waitcnt lgkmcnt(3)
  v_mfma_f32_16x16x32_bf16 v[56:59], v[36:39], v[20:23], v[56:59]
  v_mfma_f32_16x16x32_bf16 v[60:63], v[40:43], v[20:23], v[60:63]
  v_mfma_f32_16x16x32_bf16 v[64:67], v[12:15], v[20:23], v[64:67]
  s_nop 0
  s_waitcnt lgkmcnt(0)
  v_mfma_f32_16x16x32_bf16 v[56:59], v[68:71], v[28:31], v[56:59]
  v_mfma_f32_16x16x32_bf16 v[60:63], v[72:75], v[28:31], v[60:63]
  v_mfma_f32_16x16x32_bf16 v[64:67], v[16:19], v[28:31], v[64:67]
  s_cmp_lg_u32 s20, 1
  s_cbranch_scc1 Lskip_170
Lask_168:
  s_min_i32 s50, s44, s45
  s_min_i32 s50, s50, s46
  s_min_i32 s50, s50, s47
  s_cmp_ge_i32 s50, s33
  s_cbranch_scc1 Lhave_169
  s_load_dwordx4 s[44:47], s[4:5], s59 glc
  s_sub_u32 s24, s24, 1
  s_cbranch_scc1 L_FAIL
  s_waitcnt lgkmcnt(0)
  s_branch Lask_168
Lhave_169:
  s_add_u32 s33, s33, 2
  s_min_u32 s33, s33, 64
  s_cmp_ge_i32 s50, s33
  s_nop 0
  s_cbranch_scc1 Lskip_170
  s_load_dwordx4 s[44:47], s[4:5], s59 glc
Lskip_170:
  s_barrier
  v_cndmask_b32 v56, v86, v56, s[8:9]
  v_cndmask_b32 v57, v86, v57, s[10:11]
  v_cndmask_b32 v58, v86, v58, s[16:17]
  v_cndmask_b32 v59, v86, v59, s[18:19]
  v_cndmask_b32 v60, v86, v60, s[42:43]
  v_cndmask_b32 v61, v86, v61, s[100:101]
  buffer_load_dword v77, v87, s[4:7], s28 offen sc1
  v_cndmask_b32 v62, v86, v62, s[52:53]
  v_cndmask_b32 v63, v86, v63, s[54:55]
  s_add_u32 m0, s58, 16384
  s_add_u32 s31, s32, 16384
  buffer_load_dwordx4 v95, s[4:7], s31 offen offset:0 sc1 lds
  v_max3_f32 v72, v56, v57, v58
  v_max3_f32 v73, v59, v60, v61
  buffer_load_dwordx4 v95, s[4:7], s31 offen offset:1024 sc1 lds
  v_max3_f32 v72, v72, v62, v63
  v_max3_f32 v73, v73, v64, v65
  s_add_u32 m0, s58, 2048
  s_add_u32 s31, s32, 32768
  buffer_load_dwordx4 v95, s[4:7], s31 offen offset:0 sc1 lds
  v_max_f32 v74, v72, v73
  v_max_f32 v75, v72, v73
  buffer_load_dwordx4 v95, s[4:7], s31 offen offset:1024 sc1 lds
  s_nop 0
  v_permlane16_swap_b32 v74, v75
  v_max_f32 v72, v74, v75
  s_mov_b32 m0, s58
  s_add_u32 s31, s32, s49
  buffer_load_dwordx4 v95, s[4:7], s31 offen offset:0 sc1 lds
  v_max_f32 v73, v74, v75
  s_nop 1
  v_permlane32_swap_b32 v72, v73
  s_sub_u32 s31, s32, s49
  buffer_load_dwordx4 v95, s[4:7], s31 offen offset:1024 sc1 lds
  v_max_f32 v72, v72, v73
  v_mul_f32 v72, s38, v72
  buffer_store_dwordx4 v[80:83], v122, s[4:7], s34 offen sc1
  v_pk_fma_f32 v[56:57], v[56:57], s[38:39], v[72:73] op_sel_hi:[1,1,0] neg_lo:[0,0,1] neg_hi:[0,0,1]
  v_pk_fma_f32 v[58:59], v[58:59], s[38:39], v[72:73] op_sel_hi:[1,1,0] neg_lo:[0,0,1] neg_hi:[0,0,1]
  s_xor_b32 s40, s34, 8192
  buffer_store_dwordx4 v[80:83], v122, s[4:7], s40 offen
  v_pk_fma_f32 v[60:61], v[60:61], s[38:39], v[72:73] op_sel_hi:[1,1,0] neg_lo:[0,0,1] neg_hi:[0,0,1]
  v_pk_fma_f32 v[62:63], v[62:63], s[38:39], v[72:73] op_sel_hi:[1,1,0] neg_lo:[0,0,1] neg_hi:[0,0,1]
  v_pk_fma_f32 v[64:65], v[64:65], s[38:39], v[72:73] op_sel_hi:[1,1,0] neg_lo:[0,0,1] neg_hi:[0,0,1]
  v_exp_f32 v56, v56
  v_exp_f32 v57, v57
  v_exp_f32 v58, v58
  v_exp_f32 v59, v59
  v_exp_f32 v60, v60
  v_exp_f32 v61, v61
  v_exp_f32 v62, v62
  v_exp_f32 v63, v63
  v_exp_f32 v64, v64
  v_exp_f32 v65, v65
  s_waitcnt vmcnt(10)
  v_max_u32 v89, v106, v107
  v_cmp_eq_u32 vcc, -1, v89
  v_cvt_pk_bf16_f32 v36, v56, v57
  v_cvt_pk_bf16_f32 v37, v58, v59
  v_cvt_pk_bf16_f32 v38, v60, v61
  v_cvt_pk_bf16_f32 v39, v62, v63
  v_cvt_pk_bf16_f32 v114, v64, v65
  v_cvt_pk_bf16_f32 v119, v64, v65
  s_cbranch_vccnz L_QK_vbad1
L_QK_vok1:
  s_add_u32 s25, s25, 1
  s_xor_b32 s41, s30, 2048
  v_mfma_f32_16x16x32_bf16 v[40:43], v[108:111], v[36:39], 0
  s_add_u32 s27, s25, 32
  s_and_b32 s40, s27, 0x28
  s_mul_i32 s40, s40, 0x900
  v_mfma_f32_16x16x32_bf16 v[52:55], v[96:99], v[36:39], 0
  s_and_b32 s40, s40, 0x6000
  s_xor_b32 s40, s40, s26
  s_lshl_b32 s27, s27, 16
  v_mfma_f32_16x16x32_bf16 v[56:59], v[100:103], v[36:39], 0
  s_add_u32 s27, s27, s40
  s_lshl_b32 s37, s36, 1
  s_xor_b32 s37, s27, s37
  v_mfma_f32_16x16x32_bf16 v[60:63], v[24:27], v[36:39], 0
  s_and_b32 s40, s25, 3
  s_lshl_b32 s40, s40, 18
  s_add_u32 s28, s40, s26
  v_mfma_f32_16x16x32_bf16 v[64:67], v[32:35], v[36:39], 0
  s_lshr_b32 s40, s40, 5
  s_and_b32 s40, s40, 0x4000
  s_xor_b32 s28, s28, s40
  v_mfma_f32_16x16x32_bf16 v[40:43], v[108:111], v[114:117], v[40:43]
  s_xor_b32 s29, s28, 0x4000
  s_xor_b32 s34, s28, 0x84000
  s_xor_b32 s48, s28, 8192
  v_mfma_f32_16x16x32_bf16 v[52:55], v[104:107], v[114:117], v[52:55]
  s_lshr_b32 s40, s49, 1
  s_add_u32 s29, s29, s40
  s_xor_b32 s35, s29, 512
  v_mfma_f32_16x16x32_bf16 v[56:59], v[104:107], v[118:121], v[56:59]
  s_add_u32 s92, s37, s88
  s_add_u32 s96, s27, s88
  s_xor_b32 s96, s96, 0x1000
  v_mfma_f32_16x16x32_bf16 v[60:63], v[104:107], v[112:115], v[60:63]
  s_add_u32 s93, s37, s89
  s_add_u32 s97, s27, s89
  s_xor_b32 s97, s97, 0x1000
  v_mfma_f32_16x16x32_bf16 v[64:67], v[104:107], v[116:119], v[64:67]
  s_add_u32 s94, s37, s90
  s_add_u32 s98, s27, s90
  s_xor_b32 s98, s98, 0x1000
  s_add_u32 s95, s37, s91
  s_add_u32 s99, s27, s91
  s_xor_b32 s99, s99, 0x1000
  v_rcp_f32 v40, v40
  s_nop 0
  v_pk_mul_f32 v[52:53], v[52:53], v[40:41] op_sel_hi:[1,0]
  v_pk_mul_f32 v[54:55], v[54:55], v[40:41] op_sel_hi:[1,0]
  v_pk_mul_f32 v[56:57], v[56:57], v[40:41] op_sel_hi:[1,0]
  v_pk_mul_f32 v[58:59], v[58:59], v[40:41] op_sel_hi:[1,0]
  v_cvt_pk_bf16_f32 v4, v52, v53
  v_cvt_pk_bf16_f32 v5, v54, v55
  v_cvt_pk_bf16_f32 v6, v56, v57
  v_cvt_pk_bf16_f32 v7, v58, v59
  buffer_store_dwordx4 v[4:7], v95, s[4:7], s30 offen sc1
  v_pk_mul_f32 v[60:61], v[60:61], v[40:41] op_sel_hi:[1,0]
  v_pk_mul_f32 v[62:63], v[62:63], v[40:41] op_sel_hi:[1,0]
  v_pk_mul_f32 v[64:65], v[64:65], v[40:41] op_sel_hi:[1,0]
  v_pk_mul_f32 v[66:67], v[66:67], v[40:41] op_sel_hi:[1,0]
  v_cvt_pk_bf16_f32 v8, v60, v61
  v_cvt_pk_bf16_f32 v9, v62, v63
  v_cvt_pk_bf16_f32 v10, v64, v65
  v_cvt_pk_bf16_f32 v11, v66, v67
  buffer_store_dwordx4 v[8:11], v95, s[4:7], s41 offen sc1
  s_add_u32 s30, s30, 2097152
  s_xor_b32 s30, s30, 0x2000
  s_branch L_QK_top
L_QK_park:
  s_waitcnt vmcnt(0)
  s_cmp_lt_u32 s25, 64
  s_cbranch_scc1 L_QK_rel
  s_barrier
  s_cmp_lg_u32 s20, 0
  s_cbranch_scc1 Lnosig_171
  s_mov_b32 s63, s25
  s_atomic_smax s63, s[4:5], s62 glc
Lnosig_171:
  s_branch L_END
L_QKM_nan:
  s_cmp_eq_u32 s51, s25
  s_cbranch_scc1 L_QKM_done
  s_mov_b32 s51, s25
  s_add_u32 s60, s60, 0x10000
  s_waitcnt vmcnt(0) lgkmcnt(0)
L_QKM_v0:
  s_sub_u32 s24, s24, 1
  s_cbranch_scc1 L_FAIL
  buffer_load_dwordx4 v[4:7], v95, s[4:7], s92 offen offset:0 sc1
  buffer_load_dwordx4 v[8:11], v95, s[4:7], s92 offen offset:2048 sc1
  buffer_load_dwordx4 v[12:15], v95, s[4:7], s93 offen offset:0 sc1
  buffer_load_dwordx4 v[16:19], v95, s[4:7], s93 offen offset:2048 sc1
  v_mov_b32 v89, 0
  s_waitcnt vmcnt(0)
  v_max3_u32 v89, v4, v5, v89
  v_max3_u32 v89, v6, v7, v89
  v_max3_u32 v89, v8, v9, v89
  v_max3_u32 v89, v10, v11, v89
  v_max3_u32 v89, v12, v13, v89
  v_max3_u32 v89, v14, v15, v89
  v_max3_u32 v89, v16, v17, v89
  v_max3_u32 v89, v18, v19, v89
  v_cmp_eq_u32 vcc, -1, v89
  s_cbranch_vccnz L_QKM_v0
L_QKM_v4:
  s_sub_u32 s24, s24, 1
  s_cbranch_scc1 L_FAIL
  buffer_load_dwordx4 v[68:71], v95, s[4:7], s94 offen offset:0 sc1
  buffer_load_dwordx4 v[72:75], v95, s[4:7], s94 offen offset:2048 sc1
  buffer_load_dwordx4 v[4:7], v95, s[4:7], s95 offen offset:0 sc1
  buffer_load_dwordx4 v[8:11], v95, s[4:7], s95 offen offset:2048 sc1
  v_mov_b32 v89, 0
  s_waitcnt vmcnt(0)
  v_max3_u32 v89, v68, v69, v89
  v_max3_u32 v89, v70, v71, v89
  v_max3_u32 v89, v72, v73, v89
  v_max3_u32 v89, v74, v75, v89
  v_max3_u32 v89, v4, v5, v89
  v_max3_u32 v89, v6, v7, v89
  v_max3_u32 v89, v8, v9, v89
  v_max3_u32 v89, v10, v11, v89
  v_cmp_eq_u32 vcc, -1, v89
  s_cbranch_vccnz L_QKM_v4
L_QKM_v8:
  s_sub_u32 s24, s24, 1
  s_cbranch_scc1 L_FAIL
  buffer_load_dwordx4 v[12:15], v95, s[4:7], s96 offen offset:0 sc1
  buffer_load_dwordx4 v[16:19], v95, s[4:7], s96 offen offset:2048 sc1
  buffer_load_dwordx4 v[68:71], v95, s[4:7], s97 offen offset:0 sc1
  buffer_load_dwordx4 v[72:75], v95, s[4:7], s97 offen offset:2048 sc1
  v_mov_b32 v89, 0
  s_waitcnt vmcnt(0)
  v_max3_u32 v89, v12, v13, v89
  v_max3_u32 v89, v14, v15, v89
  v_max3_u32 v89, v16, v17, v89
  v_max3_u32 v89, v18, v19, v89
  v_max3_u32 v89, v68, v69, v89
  v_max3_u32 v89, v70, v71, v89
  v_max3_u32 v89, v72, v73, v89
  v_max3_u32 v89, v74, v75, v89
  v_cmp_eq_u32 vcc, -1, v89
  s_cbranch_vccnz L_QKM_v8
L_QKM_v12:
  s_sub_u32 s24, s24, 1
  s_cbranch_scc1 L_FAIL
  buffer_load_dwordx4 v[4:7], v95, s[4:7], s98 offen offset:0 sc1
  buffer_load_dwordx4 v[8:11], v95, s[4:7], s98 offen offset:2048 sc1
  buffer_load_dwordx4 v[12:15], v95, s[4:7], s99 offen offset:0 sc1
  buffer_load_dwordx4 v[16:19], v95, s[4:7], s99 offen offset:2048 sc1
  v_mov_b32 v89, 0
  s_waitcnt vmcnt(0)
  v_max3_u32 v89, v4, v5, v89
  v_max3_u32 v89, v6, v7, v89
  v_max3_u32 v89, v8, v9, v89
  v_max3_u32 v89, v10, v11, v89
  v_max3_u32 v89, v12, v13, v89
  v_max3_u32 v89, v14, v15, v89
  v_max3_u32 v89, v16, v17, v89
  v_max3_u32 v89, v18, v19, v89
  v_cmp_eq_u32 vcc, -1, v89
  s_cbranch_vccnz L_QKM_v12
  v_mov_b64 v[52:53], 0
  v_mov_b64 v[54:55], 0
  v_mov_b64 v[56:57], 0
  v_mov_b64 v[58:59], 0
  v_mov_b64 v[60:61], 0
  v_mov_b64 v[62:63], 0
  v_mov_b64 v[64:65], 0
  v_mov_b64 v[66:67], 0
  ds_read_b128 v[20:23], v85 offset:0
  ds_read_b128 v[24:27], v85 offset:1024
  ds_read_b128 v[28:31], v85 offset:8192
  ds_read_b128 v[32:35], v85 offset:9216
  ds_read_b128 v[36:39], v85 offset:2048
  ds_read_b128 v[40:43], v85 offset:3072
  ds_read_b128 v[44:47], v85 offset:10240
  ds_read_b128 v[48:51], v85 offset:11264
  s_waitcnt lgkmcnt(0)
L_QKMS_again:
  buffer_load_dwordx4 v[4:7], v95, s[4:7], s92 offen offset:0 sc1
  s_nop 0
  buffer_load_dwordx4 v[8:11], v95, s[4:7], s92 offen offset:2048 sc1
  s_nop 0
  buffer_load_dwordx4 v[12:15], v95, s[4:7], s93 offen offset:0 sc1
  s_nop 0
  buffer_load_dwordx4 v[16:19], v95, s[4:7], s93 offen offset:2048 sc1
  s_nop 0
  buffer_load_dwordx4 v[68:71], v95, s[4:7], s94 offen offset:0 sc1
  s_nop 0
  s_waitcnt vmcnt(4)
  buffer_load_dwordx4 v[72:75], v95, s[4:7], s94 offen offset:2048 sc1
  v_smfmac_f32_16x16x64_bf16 v[52:55], v[4:7], a[0:7], v88
  v_smfmac_f32_16x16x64_bf16 v[60:63], v[4:7], v[128:135], v88
  s_waitcnt vmcnt(4)
  v_smfmac_f32_16x16x64_bf16 v[56:59], v[4:7], a[128:135], v88
  v_smfmac_f32_16x16x64_bf16 v[64:67], v[4:7], v[20:27], v88
  buffer_load_dwordx4 v[4:7], v95, s[4:7], s95 offen offset:0 sc1
  v_smfmac_f32_16x16x64_bf16 v[52:55], v[8:11], a[8:15], v88
  ds_read_b128 v[20:23], v85 offset:4096
  v_smfmac_f32_16x16x64_bf16 v[60:63], v[8:11], v[136:143], v88
  ds_read_b128 v[24:27], v85 offset:5120
  s_waitcnt vmcnt(4)
  v_smfmac_f32_16x16x64_bf16 v[56:59], v[8:11], a[136:143], v88
  v_smfmac_f32_16x16x64_bf16 v[64:67], v[8:11], v[28:35], v88
  buffer_load_dwordx4 v[8:11], v95, s[4:7], s95 offen offset:2048 sc1
  v_smfmac_f32_16x16x64_bf16 v[52:55], v[12:15], a[16:23], v88
  ds_read_b128 v[28:31], v85 offset:12288
  v_smfmac_f32_16x16x64_bf16 v[60:63], v[12:15], v[144:151], v88
  ds_read_b128 v[32:35], v85 offset:13312
  s_waitcnt vmcnt(4)
  v_smfmac_f32_16x16x64_bf16 v[56:59], v[12:15], a[144:151], v88
  v_smfmac_f32_16x16x64_bf16 v[64:67], v[12:15], v[36:43], v88
  buffer_load_dwordx4 v[12:15], v95, s[4:7], s96 offen offset:0 sc1
  v_smfmac_f32_16x16x64_bf16 v[52:55], v[16:19], a[24:31], v88
  ds_read_b128 v[36:39], v85 offset:6144
  v_smfmac_f32_16x16x64_bf16 v[60:63], v[16:19], v[152:159], v88
  ds_read_b128 v[40:43], v85 offset:7168
  s_waitcnt vmcnt(4)
  v_smfmac_f32_16x16x64_bf16 v[56:59], v[16:19], a[152:159], v88
  v_smfmac_f32_16x16x64_bf16 v[64:67], v[16:19], v[44:51], v88
  buffer_load_dwordx4 v[16:19], v95, s[4:7], s96 offen offset:2048 sc1
  v_smfmac_f32_16x16x64_bf16 v[52:55], v[68:71], a[32:39], v88
  ds_read_b128 v[44:47], v85 offset:14336
  v_smfmac_f32_16x16x64_bf16 v[60:63], v[68:71], v[160:167], v88
  ds_read_b128 v[48:51], v85 offset:15360
  s_waitcnt vmcnt(4)
  v_smfmac_f32_16x16x64_bf16 v[56:59], v[68:71], a[160:167], v88
  s_waitcnt lgkmcnt(6)
  v_smfmac_f32_16x16x64_bf16 v[64:67], v[68:71], v[20:27], v88
  buffer_load_dwordx4 v[68:71], v95, s[4:7], s97 offen offset:0 sc1
  v_smfmac_f32_16x16x64_bf16 v[52:55], v[72:75], a[40:47], v88
  ds_read_b128 v[20:23], v85 offset:16384
  v_smfmac_f32_16x16x64_bf16 v[60:63], v[72:75], v[168:175], v88
  ds_read_b128 v[24:27], v85 offset:17408
  s_waitcnt vmcnt(4)
  v_smfmac_f32_16x16x64_bf16 v[56:59], v[72:75], a[168:175], v88
  s_waitcnt lgkmcnt(6)
  v_smfmac_f32_16x16x64_bf16 v[64:67], v[72:75], v[28:35], v88
  buffer_load_dwordx4 v[72:75], v95, s[4:7], s97 offen offset:2048 sc1
  v_smfmac_f32_16x16x64_bf16 v[52:55], v[4:7], a[48:55], v88
  ds_read_b128 v[28:31], v85 offset:24576
  v_smfmac_f32_16x16x64_bf16 v[60:63], v[4:7], v[176:183], v88
  ds_read_b128 v[32:35], v85 offset:25600
  s_waitcnt vmcnt(4)
  v_smfmac_f32_16x16x64_bf16 v[56:59], v[4:7], a[176:183], v88
  s_waitcnt lgkmcnt(6)
  v_smfmac_f32_16x16x64_bf16 v[64:67], v[4:7], v[36:43], v88
  buffer_load_dwordx4 v[4:7], v95, s[4:7], s98 offen offset:0 sc1
  v_smfmac_f32_16x16x64_bf16 v[52:55], v[8:11], a[56:63], v88
  ds_read_b128 v[36:39], v85 offset:18432
  v_smfmac_f32_16x16x64_bf16 v[60:63], v[8:11], v[184:191], v88
  ds_read_b128 v[40:43], v85 offset:19456
  s_waitcnt vmcnt(4)
  v_smfmac_f32_16x16x64_bf16 v[56:59], v[8:11], a[184:191], v88
  s_waitcnt lgkmcnt(6)
  v_smfmac_f32_16x16x64_bf16 v[64:67], v[8:11], v[44:51], v88
  buffer_load_dwordx4 v[8:11], v95, s[4:7], s98 offen offset:2048 sc1
  v_smfmac_f32_16x16x64_bf16 v[52:55], v[12:15], a[64:71], v88
  ds_read_b128 v[44:47], v85 offset:26624
  v_smfmac_f32_16x16x64_bf16 v[60:63], v[12:15], v[192:199], v88
  ds_read_b128 v[48:51], v85 offset:27648
  s_waitcnt vmcnt(4)
  v_smfmac_f32_16x16x64_bf16 v[56:59], v[12:15], a[192:199], v88
  s_waitcnt lgkmcnt(6)
  v_smfmac_f32_16x16x64_bf16 v[64:67], v[12:15], v[20:27], v88
  buffer_load_dwordx4 v[12:15], v95, s[4:7], s99 offen offset:0 sc1
  v_smfmac_f32_16x16x64_bf16 v[52:55], v[16:19], a[72:79], v88
  ds_read_b128 v[20:23], v85 offset:20480
  v_smfmac_f32_16x16x64_bf16 v[60:63], v[16:19], v[200:207], v88
  ds_read_b128 v[24:27], v85 offset:21504
  s_waitcnt vmcnt(4)
  v_smfmac_f32_16x16x64_bf16 v[56:59], v[16:19], a[200:207], v88
  s_waitcnt lgkmcnt(6)
  v_smfmac_f32_16x16x64_bf16 v[64:67], v[16:19], v[28:35], v88
  buffer_load_dwordx4 v[16:19], v95, s[4:7], s99 offen offset:2048 sc1
  v_smfmac_f32_16x16x64_bf16 v[52:55], v[68:71], a[80:87], v88
  ds_read_b128 v[28:31], v85 offset:28672
  v_smfmac_f32_16x16x64_bf16 v[60:63], v[68:71], v[208:215], v88
  ds_read_b128 v[32:35], v85 offset:29696
  s_waitcnt vmcnt(4)
  v_smfmac_f32_16x16x64_bf16 v[56:59], v[68:71], a[208:215], v88
  s_waitcnt lgkmcnt(6)
  v_smfmac_f32_16x16x64_bf16 v[64:67], v[68:71], v[36:43], v88
  ds_read_b128 v[36:39], v85 offset:22528
  v_smfmac_f32_16x16x64_bf16 v[52:55], v[72:75], a[88:95], v88
  ds_read_b128 v[40:43], v85 offset:23552
  v_smfmac_f32_16x16x64_bf16 v[60:63], v[72:75], v[216:223], v88
  s_waitcnt vmcnt(3)
  v_smfmac_f32_16x16x64_bf16 v[56:59], v[72:75], a[216:223], v88
  s_waitcnt lgkmcnt(6)
  v_smfmac_f32_16x16x64_bf16 v[64:67], v[72:75], v[44:51], v88
  ds_read_b128 v[44:47], v85 offset:30720
  v_smfmac_f32_16x16x64_bf16 v[52:55], v[4:7], a[96:103], v88
  ds_read_b128 v[48:51], v85 offset:31744
  v_smfmac_f32_16x16x64_bf16 v[60:63], v[4:7], v[224:231], v88
  s_waitcnt vmcnt(2)
  v_smfmac_f32_16x16x64_bf16 v[56:59], v[4:7], a[224:231], v88
  s_waitcnt lgkmcnt(6)
  v_smfmac_f32_16x16x64_bf16 v[64:67], v[4:7], v[20:27], v88
  ds_read_b128 v[20:23], v1 offset:16384
  v_smfmac_f32_16x16x64_bf16 v[52:55], v[8:11], a[104:111], v88
  ds_read_b128 v[24:27], v1 offset:17408
  v_smfmac_f32_16x16x64_bf16 v[60:63], v[8:11], v[232:239], v88
  ds_read_b128 v[68:71], v84 offset:16384
  s_waitcnt vmcnt(1)
  v_smfmac_f32_16x16x64_bf16 v[56:59], v[8:11], a[232:239], v88
  s_waitcnt lgkmcnt(7)
  v_smfmac_f32_16x16x64_bf16 v[64:67], v[8:11], v[28:35], v88
  ds_read_b128 v[28:31], v2 offset:16384
  v_smfmac_f32_16x16x64_bf16 v[52:55], v[12:15], a[112:119], v88
  ds_read_b128 v[32:35], v2 offset:17408
  v_smfmac_f32_16x16x64_bf16 v[60:63], v[12:15], v[240:247], v88
  ds_read_b128 v[72:75], v84 offset:17408
  s_waitcnt vmcnt(0)
  v_smfmac_f32_16x16x64_bf16 v[56:59], v[12:15], a[240:247], v88
  s_waitcnt lgkmcnt(8)
  v_smfmac_f32_16x16x64_bf16 v[64:67], v[12:15], v[36:43], v88
  ds_read_b128 v[36:39], v3 offset:16384
  v_smfmac_f32_16x16x64_bf16 v[52:55], v[16:19], a[120:127], v88
  ds_read_b128 v[40:43], v3 offset:17408
  v_smfmac_f32_16x16x64_bf16 v[60:63], v[16:19], v[248:255], v88
  v_smfmac_f32_16x16x64_bf16 v[56:59], v[16:19], a[248:255], v88
  s_waitcnt lgkmcnt(8)
  v_smfmac_f32_16x16x64_bf16 v[64:67], v[16:19], v[44:51], v88
  s_nop 7
  s_branch L_QKM_join
L_QKM_g0:
  s_sub_u32 s24, s24, 1
  s_cbranch_scc1 L_FAIL
  s_add_u32 s60, s60, 1
  buffer_load_dwordx4 v[4:7], v95, s[4:7], s92 offen offset:0 sc1
  s_waitcnt vmcnt(0)
  v_cmp_eq_u32 vcc, -1, v4
  s_cbranch_vccnz L_QKM_g0
  v_mov_b32 v89, 0
  v_max3_u32 v89, v8, v12, v89
  v_max3_u32 v89, v16, v68, v89
  v_cmp_eq_u32 vcc, -1, v89
  s_cbranch_vccz L_QKM_ok0
  buffer_load_dwordx4 v[8:11], v95, s[4:7], s92 offen offset:2048 sc1
  s_nop 0
  buffer_load_dwordx4 v[12:15], v95, s[4:7], s93 offen offset:0 sc1
  s_nop 0
  buffer_load_dwordx4 v[16:19], v95, s[4:7], s93 offen offset:2048 sc1
  s_nop 0
  buffer_load_dwordx4 v[68:71], v95, s[4:7], s94 offen offset:0 sc1
  s_nop 0
  s_branch L_QKM_ok0
L_QKM_g1:
  s_sub_u32 s24, s24, 1
  s_cbranch_scc1 L_FAIL
  s_add_u32 s60, s60, 1
  buffer_load_dwordx4 v[8:11], v95, s[4:7], s92 offen offset:2048 sc1
  s_waitcnt vmcnt(0)
  v_cmp_eq_u32 vcc, -1, v8
  s_cbranch_vccnz L_QKM_g1
  v_mov_b32 v89, 0
  v_max3_u32 v89, v12, v16, v89
  v_max3_u32 v89, v68, v72, v89
  v_cmp_eq_u32 vcc, -1, v89
  s_cbranch_vccz L_QKM_ok1
  buffer_load_dwordx4 v[12:15], v95, s[4:7], s93 offen offset:0 sc1
  s_nop 0
  buffer_load_dwordx4 v[16:19], v95, s[4:7], s93 offen offset:2048 sc1
  s_nop 0
  buffer_load_dwordx4 v[68:71], v95, s[4:7], s94 offen offset:0 sc1
  s_nop 0
  buffer_load_dwordx4 v[72:75], v95, s[4:7], s94 offen offset:2048 sc1
  s_nop 0
  s_branch L_QKM_ok1
L_QKM_g2:
  s_sub_u32 s24, s24, 1
  s_cbranch_scc1 L_FAIL
  s_add_u32 s60, s60, 1
  buffer_load_dwordx4 v[12:15], v95, s[4:7], s93 offen offset:0 sc1
  s_waitcnt vmcnt(0)
  v_cmp_eq_u32 vcc, -1, v12
  s_cbranch_vccnz L_QKM_g2
  v_mov_b32 v89, 0
  v_max3_u32 v89, v16, v68, v89
  v_max3_u32 v89, v72, v4, v89
  v_cmp_eq_u32 vcc, -1, v89
  s_cbranch_vccz L_QKM_ok2
  buffer_load_dwordx4 v[16:19], v95, s[4:7], s93 offen offset:2048 sc1
  s_nop 0
  buffer_load_dwordx4 v[68:71], v95, s[4:7], s94 offen offset:0 sc1
  s_nop 0
  buffer_load_dwordx4 v[72:75], v95, s[4:7], s94 offen offset:2048 sc1
  s_nop 0
  buffer_load_dwordx4 v[4:7], v95, s[4:7], s95 offen offset:0 sc1
  s_nop 0
  s_branch L_QKM_ok2
L_QKM_g3:
  s_sub_u32 s24, s24, 1
  s_cbranch_scc1 L_FAIL
  s_add_u32 s60, s60, 1
  buffer_load_dwordx4 v[16:19], v95, s[4:7], s93 offen offset:2048 sc1
  s_waitcnt vmcnt(0)
  v_cmp_eq_u32 vcc, -1, v16
  s_cbranch_vccnz L_QKM_g3
  v_mov_b32 v89, 0
  v_max3_u32 v89, v68, v72, v89
  v_max3_u32 v89, v4, v8, v89
  v_cmp_eq_u32 vcc, -1, v89
  s_cbranch_vccz L_QKM_ok3
  buffer_load_dwordx4 v[68:71], v95, s[4:7], s94 offen offset:0 sc1
  s_nop 0
  buffer_load_dwordx4 v[72:75], v95, s[4:7], s94 offen offset:2048 sc1
  s_nop 0
  buffer_load_dwordx4 v[4:7], v95, s[4:7], s95 offen offset:0 sc1
  s_nop 0
  buffer_load_dwordx4 v[8:11], v95, s[4:7], s95 offen offset:2048 sc1
  s_nop 0
  s_branch L_QKM_ok3
L_QKM_g4:
  s_sub_u32 s24, s24, 1
  s_cbranch_scc1 L_FAIL
  s_add_u32 s60, s60, 1
  buffer_load_dwordx4 v[68:71], v95, s[4:7], s94 offen offset:0 sc1
  s_waitcnt vmcnt(0)
  v_cmp_eq_u32 vcc, -1, v68
  s_cbranch_vccnz L_QKM_g4
  v_mov_b32 v89, 0
  v_max3_u32 v89, v72, v4, v89
  v_max3_u32 v89, v8, v12, v89
  v_cmp_eq_u32 vcc, -1, v89
  s_cbranch_vccz L_QKM_ok4
  buffer_load_dwordx4 v[72:75], v95, s[4:7], s94 offen offset:2048 sc1
  s_nop 0
  buffer_load_dwordx4 v[4:7], v95, s[4:7], s95 offen offset:0 sc1
  s_nop 0
  buffer_load_dwordx4 v[8:11], v95, s[4:7], s95 offen offset:2048 sc1
  s_nop 0
  buffer_load_dwordx4 v[12:15], v95, s[4:7], s96 offen offset:0 sc1
  s_nop 0
  s_branch L_QKM_ok4
L_QKM_g5:
  s_sub_u32 s24, s24, 1
  s_cbranch_scc1 L_FAIL
  s_add_u32 s60, s60, 1
  buffer_load_dwordx4 v[72:75], v95, s[4:7], s94 offen offset:2048 sc1
  s_waitcnt vmcnt(0)
  v_cmp_eq_u32 vcc, -1, v72
  s_cbranch_vccnz L_QKM_g5
  v_mov_b32 v89, 0
  v_max3_u32 v89, v4, v8, v89
  v_max3_u32 v89, v12, v16, v89
  v_cmp_eq_u32 vcc, -1, v89
  s_cbranch_vccz L_QKM_ok5
  buffer_load_dwordx4 v[4:7], v95, s[4:7], s95 offen offset:0 sc1
  s_nop 0
  buffer_load_dwordx4 v[8:11], v95, s[4:7], s95 offen offset:2048 sc1
  s_nop 0
  buffer_load_dwordx4 v[12:15], v95, s[4:7], s96 offen offset:0 sc1
  s_nop 0
  buffer_load_dwordx4 v[16:19], v95, s[4:7], s96 offen offset:2048 sc1
  s_nop 0
  s_branch L_QKM_ok5
L_QKM_g6:
  s_sub_u32 s24, s24, 1
  s_cbranch_scc1 L_FAIL
  s_add_u32 s60, s60, 1
  buffer_load_dwordx4 v[4:7], v95, s[4:7], s95 offen offset:0 sc1
  s_waitcnt vmcnt(0)
  v_cmp_eq_u32 vcc, -1, v4
  s_cbranch_vccnz L_QKM_g6
  v_mov_b32 v89, 0
  v_max3_u32 v89, v8, v12, v89
  v_max3_u32 v89, v16, v68, v89
  v_cmp_eq_u32 vcc, -1, v89
  s_cbranch_vccz L_QKM_ok6
  buffer_load_dwordx4 v[8:11], v95, s[4:7], s95 offen offset:2048 sc1
  s_nop 0
  buffer_load_dwordx4 v[12:15], v95, s[4:7], s96 offen offset:0 sc1
  s_nop 0
  buffer_load_dwordx4 v[16:19], v95, s[4:7], s96 offen offset:2048 sc1
  s_nop 0
  buffer_load_dwordx4 v[68:71], v95, s[4:7], s97 offen offset:0 sc1
  s_nop 0
  s_branch L_QKM_ok6
L_QKM_g7:
  s_sub_u32 s24, s24, 1
  s_cbranch_scc1 L_FAIL
  s_add_u32 s60, s60, 1
  buffer_load_dwordx4 v[8:11], v95, s[4:7], s95 offen offset:2048 sc1
  s_waitcnt vmcnt(0)
  v_cmp_eq_u32 vcc, -1, v8
  s_cbranch_vccnz L_QKM_g7
  v_mov_b32 v89, 0
  v_max3_u32 v89, v12, v16, v89
  v_max3_u32 v89, v68, v72, v89
  v_cmp_eq_u32 vcc, -1, v89
  s_cbranch_vccz L_QKM_ok7
  buffer_load_dwordx4 v[12:15], v95, s[4:7], s96 offen offset:0 sc1
  s_nop 0
  buffer_load_dwordx4 v[16:19], v95, s[4:7], s96 offen offset:2048 sc1
  s_nop 0
  buffer_load_dwordx4 v[68:71], v95, s[4:7], s97 offen offset:0 sc1
  s_nop 0
  buffer_load_dwordx4 v[72:75], v95, s[4:7], s97 offen offset:2048 sc1
  s_nop 0
  s_branch L_QKM_ok7
L_QKM_g8:
  s_sub_u32 s24, s24, 1
  s_cbranch_scc1 L_FAIL
  s_add_u32 s60, s60, 256
  buffer_load_dwordx4 v[12:15], v95, s[4:7], s96 offen offset:0 sc1
  s_waitcnt vmcnt(0)
  v_cmp_eq_u32 vcc, -1, v12
  s_cbranch_vccnz L_QKM_g8
  v_mov_b32 v89, 0
  v_max3_u32 v89, v16, v68, v89
  v_max3_u32 v89, v72, v4, v89
  v_cmp_eq_u32 vcc, -1, v89
  s_cbranch_vccz L_QKM_ok8
  buffer_load_dwordx4 v[16:19], v95, s[4:7], s96 offen offset:2048 sc1
  s_nop 0
  buffer_load_dwordx4 v[68:71], v95, s[4:7], s97 offen offset:0 sc1
  s_nop 0
  buffer_load_dwordx4 v[72:75], v95, s[4:7], s97 offen offset:2048 sc1
  s_nop 0
  buffer_load_dwordx4 v[4:7], v95, s[4:7], s98 offen offset:0 sc1
  s_nop 0
  s_branch L_QKM_ok8
L_QKM_g9:
  s_sub_u32 s24, s24, 1
  s_cbranch_scc1 L_FAIL
  s_add_u32 s60, s60, 256
  buffer_load_dwordx4 v[16:19], v95, s[4:7], s96 offen offset:2048 sc1
  s_waitcnt vmcnt(0)
  v_cmp_eq_u32 vcc, -1, v16
  s_cbranch_vccnz L_QKM_g9
  v_mov_b32 v89, 0
  v_max3_u32 v89, v68, v72, v89
  v_max3_u32 v89, v4, v8, v89
  v_cmp_eq_u32 vcc, -1, v89
  s_cbranch_vccz L_QKM_ok9
  buffer_load_dwordx4 v[68:71], v95, s[4:7], s97 offen offset:0 sc1
  s_nop 0
  buffer_load_dwordx4 v[72:75], v95, s[4:7], s97 offen offset:2048 sc1
  s_nop 0
  buffer_load_dwordx4 v[4:7], v95, s[4:7], s98 offen offset:0 sc1
  s_nop 0
  buffer_load_dwordx4 v[8:11], v95, s[4:7], s98 offen offset:2048 sc1
  s_nop 0
  s_branch L_QKM_ok9
L_QKM_g10:
  s_sub_u32 s24, s24, 1
  s_cbranch_scc1 L_FAIL
  s_add_u32 s60, s60, 256
  buffer_load_dwordx4 v[68:71], v95, s[4:7], s97 offen offset:0 sc1
  s_waitcnt vmcnt(0)
  v_cmp_eq_u32 vcc, -1, v68
  s_cbranch_vccnz L_QKM_g10
  v_mov_b32 v89, 0
  v_max3_u32 v89, v72, v4, v89
  v_max3_u32 v89, v8, v12, v89
  v_cmp_eq_u32 vcc, -1, v89
  s_cbranch_vccz L_QKM_ok10
  buffer_load_dwordx4 v[72:75], v95, s[4:7], s97 offen offset:2048 sc1
  s_nop 0
  buffer_load_dwordx4 v[4:7], v95, s[4:7], s98 offen offset:0 sc1
  s_nop 0
  buffer_load_dwordx4 v[8:11], v95, s[4:7], s98 offen offset:2048 sc1
  s_nop 0
  buffer_load_dwordx4 v[12:15], v95, s[4:7], s99 offen offset:0 sc1
  s_nop 0
  s_branch L_QKM_ok10
L_QKM_g11:
  s_sub_u32 s24, s24, 1
  s_cbranch_scc1 L_FAIL
  s_add_u32 s60, s60, 256
  buffer_load_dwordx4 v[72:75], v95, s[4:7], s97 offen offset:2048 sc1
  s_waitcnt vmcnt(0)
  v_cmp_eq_u32 vcc, -1, v72
  s_cbranch_vccnz L_QKM_g11
  v_mov_b32 v89, 0
  v_max3_u32 v89, v4, v8, v89
  v_max3_u32 v89, v12, v16, v89
  v_cmp_eq_u32 vcc, -1, v89
  s_cbranch_vccz L_QKM_ok11
  buffer_load_dwordx4 v[4:7], v95, s[4:7], s98 offen offset:0 sc1
  s_nop 0
  buffer_load_dwordx4 v[8:11], v95, s[4:7], s98 offen offset:2048 sc1
  s_nop 0
  buffer_load_dwordx4 v[12:15], v95, s[4:7], s99 offen offset:0 sc1
  s_nop 0
  buffer_load_dwordx4 v[16:19], v95, s[4:7], s99 offen offset:2048 sc1
  s_nop 0
  s_branch L_QKM_ok11
L_QKM_g12:
  s_sub_u32 s24, s24, 1
  s_cbranch_scc1 L_FAIL
  s_add_u32 s60, s60, 256
  buffer_load_dwordx4 v[4:7], v95, s[4:7], s98 offen offset:0 sc1
  s_waitcnt vmcnt(0)
  v_cmp_eq_u32 vcc, -1, v4
  s_cbranch_vccnz L_QKM_g12
  v_mov_b32 v89, 0
  v_max3_u32 v89, v8, v12, v89
  v_max3_u32 v89, v16, v16, v89
  v_cmp_eq_u32 vcc, -1, v89
  s_cbranch_vccz L_QKM_ok12
  buffer_load_dwordx4 v[8:11], v95, s[4:7], s98 offen offset:2048 sc1
  s_nop 0
  buffer_load_dwordx4 v[12:15], v95, s[4:7], s99 offen offset:0 sc1
  s_nop 0
  buffer_load_dwordx4 v[16:19], v95, s[4:7], s99 offen offset:2048 sc1
  s_nop 0
  s_branch L_QKM_ok12
L_QKM_g13:
  s_sub_u32 s24, s24, 1
  s_cbranch_scc1 L_FAIL
  s_add_u32 s60, s60, 256
  buffer_load_dwordx4 v[8:11], v95, s[4:7], s98 offen offset:2048 sc1
  s_waitcnt vmcnt(0)
  v_cmp_eq_u32 vcc, -1, v8
  s_cbranch_vccnz L_QKM_g13
  v_mov_b32 v89, 0
  v_max3_u32 v89, v12, v16, v89
  v_cmp_eq_u32 vcc, -1, v89
  s_cbranch_vccz L_QKM_ok13
  buffer_load_dwordx4 v[12:15], v95, s[4:7], s99 offen offset:0 sc1
  s_nop 0
  buffer_load_dwordx4 v[16:19], v95, s[4:7], s99 offen offset:2048 sc1
  s_nop 0
  s_branch L_QKM_ok13
L_QKM_g14:
  s_sub_u32 s24, s24, 1
  s_cbranch_scc1 L_FAIL
  s_add_u32 s60, s60, 256
  buffer_load_dwordx4 v[12:15], v95, s[4:7], s99 offen offset:0 sc1
  s_waitcnt vmcnt(0)
  v_cmp_eq_u32 vcc, -1, v12
  s_cbranch_vccnz L_QKM_g14
  v_mov_b32 v89, 0
  v_max3_u32 v89, v16, v16, v89
  v_cmp_eq_u32 vcc, -1, v89
  s_cbranch_vccz L_QKM_ok14
  buffer_load_dwordx4 v[16:19], v95, s[4:7], s99 offen offset:2048 sc1
  s_nop 0
  s_branch L_QKM_ok14
L_QKM_g15:
  s_sub_u32 s24, s24, 1
  s_cbranch_scc1 L_FAIL
  s_add_u32 s60, s60, 256
  buffer_load_dwordx4 v[16:19], v95, s[4:7], s99 offen offset:2048 sc1
  s_waitcnt vmcnt(0)
  v_cmp_eq_u32 vcc, -1, v16
  s_cbranch_vccnz L_QKM_g15
  s_branch L_QKM_ok15
L_QK_vbad0:
  s_sub_u32 s24, s24, 1
  s_cbranch_scc1 L_FAIL
  s_add_u32 s61, s61, 1
  buffer_load_dwordx2 v[104:105], v92, s[4:7], s29 offen sc1
  s_waitcnt vmcnt(0)
  v_max_u32 v89, v104, v105
  v_cmp_eq_u32 vcc, -1, v89
  s_cbranch_vccnz L_QK_vbad0
  s_branch L_QK_vok0
L_QK_vbad1:
  s_sub_u32 s24, s24, 1
  s_cbranch_scc1 L_FAIL
  s_add_u32 s61, s61, 1
  buffer_load_dwordx2 v[106:107], v92, s[4:7], s35 offen sc1
  s_waitcnt vmcnt(0)
  v_max_u32 v89, v106, v107
  v_cmp_eq_u32 vcc, -1, v89
  s_cbranch_vccnz L_QK_vbad1
  s_branch L_QK_vok1
L_VO:
  v_bfe_u32 v76, v0, 3, 2
  v_xor_b32 v76, s20, v76
  v_lshlrev_b32 v76, 5, v76
  v_lshrrev_b32 v4, 2, v0
  v_lshl_add_u32 v4, v4, 7, v76
  v_and_b32 v76, 3, v0
  v_lshl_add_u32 v4, v76, 3, v4
  s_lshl_b32 s40, s20, 15
  v_add_u32 v4, s40, v4
  v_lshl_add_u32 v85, v0, 4, s40
  s_lshl_b32 s40, s20, 12
  s_add_u32 s40, s40, 131072
  v_lshl_add_u32 v1, v0, 4, s40
  s_lshr_b32 s54, s21, 4
  s_lshl_b32 s52, s54, 22
  s_sub_u32 s53, 0, s52
  v_xor_b32 v5, 32768, v4
  v_xor_b32 v2, 4096, v1
  v_xor_b32 v6, 65536, v4
  v_xor_b32 v3, 8192, v1
  v_xor_b32 v7, 98304, v4
  v_xor_b32 v84, 12288, v1
  v_bfe_u32 v8, v0, 5, 1
  v_mul_u32_u24 v8, 16384, v8
  v_bfe_u32 v76, v0, 4, 1
  v_mul_u32_u24 v76, 32768, v76
  v_add_u32 v8, v8, v76
  v_bfe_u32 v76, v0, 3, 1
  v_mul_u32_u24 v76, 131072, v76
  v_add_u32 v8, v8, v76
  v_lshrrev_b32 v76, 3, v0
  v_and_b32 v76, 6, v76
  v_xor_b32 v76, v76, v0
  v_and_b32 v76, 7, v76
  v_lshl_add_u32 v8, v76, 4, v8
  s_lshl_b32 s40, s20, 19
  v_add_u32 v8, s40, v8
  s_lshl_b32 s44, s21, 8
  s_add_u32 s45, s44, 128
  s_load_dwordx2 s[8:9], s[0:1], 32
  s_mov_b32 s10, 8388608
  s_mov_b32 s11, 0x20000
  s_waitcnt lgkmcnt(0)
  v_add_u32 v9, s44, v8
  v_add_u32 v10, s45, v8
  s_lshl_b32 s41, s20, 15
  s_and_b32 s40, s21, 3
  s_cmp_eq_u32 s40, 1
  s_cselect_b64 vcc, -1, 0
  s_add_u32 m0, s41, 0
  s_add_u32 s42, s52, 0
  buffer_load_dwordx4 v9, s[8:11], s42 offen lds
  s_add_u32 m0, s41, 1024
  s_add_u32 s42, s52, 65536
  buffer_load_dwordx4 v9, s[8:11], s42 offen lds
  s_add_u32 m0, s41, 2048
  s_add_u32 s42, s52, 8192
  buffer_load_dwordx4 v9, s[8:11], s42 offen lds
  s_add_u32 m0, s41, 3072
  s_add_u32 s42, s52, 73728
  buffer_load_dwordx4 v9, s[8:11], s42 offen lds
  s_add_u32 m0, s41, 4096
  s_add_u32 s42, s52, 262144
  buffer_load_dwordx4 v9, s[8:11], s42 offen lds
  s_add_u32 m0, s41, 5120
  s_add_u32 s42, s52, 327680
  buffer_load_dwordx4 v9, s[8:11], s42 offen lds
  s_add_u32 m0, s41, 6144
  s_add_u32 s42, s52, 270336
  buffer_load_dwordx4 v9, s[8:11], s42 offen lds
  s_add_u32 m0, s41, 7168
  s_add_u32 s42, s52, 335872
  buffer_load_dwordx4 v9, s[8:11], s42 offen lds
  s_add_u32 m0, s41, 8192
  s_add_u32 s42, s52, 2097152
  buffer_load_dwordx4 v9, s[8:11], s42 offen lds
  s_add_u32 m0, s41, 9216
  s_add_u32 s42, s52, 2162688
  buffer_load_dwordx4 v9, s[8:11], s42 offen lds
  s_add_u32 m0, s41, 10240
  s_add_u32 s42, s52, 2105344
  buffer_load_dwordx4 v9, s[8:11], s42 offen lds
  s_add_u32 m0, s41, 11264
  s_add_u32 s42, s52, 2170880
  buffer_load_dwordx4 v9, s[8:11], s42 offen lds
  s_add_u32 m0, s41, 12288
  s_add_u32 s42, s52, 2359296
  buffer_load_dwordx4 v9, s[8:11], s42 offen lds
  s_add_u32 m0, s41, 13312
  s_add_u32 s42, s52, 2424832
  buffer_load_dwordx4 v9, s[8:11], s42 offen lds
  s_add_u32 m0, s41, 14336
  s_add_u32 s42, s52, 2367488
  buffer_load_dwordx4 v9, s[8:11], s42 offen lds
  s_add_u32 m0, s41, 15360
  s_add_u32 s42, s52, 2433024
  buffer_load_dwordx4 v9, s[8:11], s42 offen lds
  s_add_u32 m0, s41, 16384
  s_add_u32 s42, s53, 4194304
  buffer_load_dwordx4 v9, s[8:11], s42 offen lds
  s_add_u32 m0, s41, 17408
  s_add_u32 s42, s53, 4259840
  buffer_load_dwordx4 v9, s[8:11], s42 offen lds
  s_add_u32 m0, s41, 18432
  s_add_u32 s42, s53, 4202496
  buffer_load_dwordx4 v9, s[8:11], s42 offen lds
  s_add_u32 m0, s41, 19456
  s_add_u32 s42, s53, 4268032
  buffer_load_dwordx4 v9, s[8:11], s42 offen lds
  s_add_u32 m0, s41, 20480
  s_add_u32 s42, s53, 4456448
  buffer_load_dwordx4 v9, s[8:11], s42 offen lds
  s_add_u32 m0, s41, 21504
  s_add_u32 s42, s53, 4521984
  buffer_load_dwordx4 v9, s[8:11], s42 offen lds
  s_add_u32 m0, s41, 22528
  s_add_u32 s42, s53, 4464640
  buffer_load_dwordx4 v9, s[8:11], s42 offen lds
  s_add_u32 m0, s41, 23552
  s_add_u32 s42, s53, 4530176
  buffer_load_dwordx4 v9, s[8:11], s42 offen lds
  s_waitcnt vmcnt(16) lgkmcnt(0)
  s_barrier
  s_add_u32 m0, s41, 24576
  s_add_u32 s42, s53, 6291456
  buffer_load_dwordx4 v9, s[8:11], s42 offen lds
  s_add_u32 m0, s41, 25600
  s_add_u32 s42, s53, 6356992
  buffer_load_dwordx4 v9, s[8:11], s42 offen lds
  s_add_u32 m0, s41, 26624
  s_add_u32 s42, s53, 6299648
  buffer_load_dwordx4 v9, s[8:11], s42 offen lds
  s_add_u32 m0, s41, 27648
  s_add_u32 s42, s53, 6365184
  buffer_load_dwordx4 v9, s[8:11], s42 offen lds
  s_add_u32 m0, s41, 28672
  s_add_u32 s42, s53, 6553600
  buffer_load_dwordx4 v9, s[8:11], s42 offen lds
  s_add_u32 m0, s41, 29696
  s_add_u32 s42, s53, 6619136
  buffer_load_dwordx4 v9, s[8:11], s42 offen lds
  s_add_u32 m0, s41, 30720
  s_add_u32 s42, s53, 6561792
  buffer_load_dwordx4 v9, s[8:11], s42 offen lds
  s_add_u32 m0, s41, 31744
  s_add_u32 s42, s53, 6627328
  buffer_load_dwordx4 v9, s[8:11], s42 offen lds
  ds_read_b64_tr_b16 v[128:129], v4 offset:0
  ds_read_b64_tr_b16 v[130:131], v4 offset:2048
  ds_read_b64_tr_b16 v[132:133], v4 offset:4096
  ds_read_b64_tr_b16 v[134:135], v4 offset:6144
  ds_read_b64_tr_b16 v[144:145], v5 offset:0
  ds_read_b64_tr_b16 v[146:147], v5 offset:2048
  ds_read_b64_tr_b16 v[148:149], v5 offset:4096
  ds_read_b64_tr_b16 v[150:151], v5 offset:6144
  ds_read_b64_tr_b16 v[160:161], v6 offset:0
  ds_read_b64_tr_b16 v[162:163], v6 offset:2048
  ds_read_b64_tr_b16 v[164:165], v6 offset:4096
  ds_read_b64_tr_b16 v[166:167], v6 offset:6144
  ds_read_b64_tr_b16 v[176:177], v7 offset:0
  ds_read_b64_tr_b16 v[178:179], v7 offset:2048
  ds_read_b64_tr_b16 v[180:181], v7 offset:4096
  ds_read_b64_tr_b16 v[182:183], v7 offset:6144
  s_waitcnt vmcnt(16) lgkmcnt(0)
  s_barrier
  s_add_u32 m0, s41, 0
  s_add_u32 s42, s52, 0
  buffer_load_dwordx4 v10, s[8:11], s42 offen lds
  s_add_u32 m0, s41, 1024
  s_add_u32 s42, s52, 65536
  buffer_load_dwordx4 v10, s[8:11], s42 offen lds
  s_add_u32 m0, s41, 2048
  s_add_u32 s42, s52, 8192
  buffer_load_dwordx4 v10, s[8:11], s42 offen lds
  s_add_u32 m0, s41, 3072
  s_add_u32 s42, s52, 73728
  buffer_load_dwordx4 v10, s[8:11], s42 offen lds
  s_add_u32 m0, s41, 4096
  s_add_u32 s42, s52, 262144
  buffer_load_dwordx4 v10, s[8:11], s42 offen lds
  s_add_u32 m0, s41, 5120
  s_add_u32 s42, s52, 327680
  buffer_load_dwordx4 v10, s[8:11], s42 offen lds
  s_add_u32 m0, s41, 6144
  s_add_u32 s42, s52, 270336
  buffer_load_dwordx4 v10, s[8:11], s42 offen lds
  s_add_u32 m0, s41, 7168
  s_add_u32 s42, s52, 335872
  buffer_load_dwordx4 v10, s[8:11], s42 offen lds
  ds_read_b64_tr_b16 v[136:137], v4 offset:8192
  ds_read_b64_tr_b16 v[138:139], v4 offset:10240
  ds_read_b64_tr_b16 v[140:141], v4 offset:12288
  ds_read_b64_tr_b16 v[142:143], v4 offset:14336
  ds_read_b64_tr_b16 v[152:153], v5 offset:8192
  ds_read_b64_tr_b16 v[154:155], v5 offset:10240
  ds_read_b64_tr_b16 v[156:157], v5 offset:12288
  ds_read_b64_tr_b16 v[158:159], v5 offset:14336
  ds_read_b64_tr_b16 v[168:169], v6 offset:8192
  ds_read_b64_tr_b16 v[170:171], v6 offset:10240
  ds_read_b64_tr_b16 v[172:173], v6 offset:12288
  ds_read_b64_tr_b16 v[174:175], v6 offset:14336
  ds_read_b64_tr_b16 v[184:185], v7 offset:8192
  ds_read_b64_tr_b16 v[186:187], v7 offset:10240
  ds_read_b64_tr_b16 v[188:189], v7 offset:12288
  ds_read_b64_tr_b16 v[190:191], v7 offset:14336
  s_waitcnt vmcnt(16) lgkmcnt(0)
  s_barrier
  s_add_u32 m0, s41, 8192
  s_add_u32 s42, s52, 2097152
  buffer_load_dwordx4 v10, s[8:11], s42 offen lds
  s_add_u32 m0, s41, 9216
  s_add_u32 s42, s52, 2162688
  buffer_load_dwordx4 v10, s[8:11], s42 offen lds
  s_add_u32 m0, s41, 10240
  s_add_u32 s42, s52, 2105344
  buffer_load_dwordx4 v10, s[8:11], s42 offen lds
  s_add_u32 m0, s41, 11264
  s_add_u32 s42, s52, 2170880
  buffer_load_dwordx4 v10, s[8:11], s42 offen lds
  s_add_u32 m0, s41, 12288
  s_add_u32 s42, s52, 2359296
  buffer_load_dwordx4 v10, s[8:11], s42 offen lds
  s_add_u32 m0, s41, 13312
  s_add_u32 s42, s52, 2424832
  buffer_load_dwordx4 v10, s[8:11], s42 offen lds
  s_add_u32 m0, s41, 14336
  s_add_u32 s42, s52, 2367488
  buffer_load_dwordx4 v10, s[8:11], s42 offen lds
  s_add_u32 m0, s41, 15360
  s_add_u32 s42, s52, 2433024
  buffer_load_dwordx4 v10, s[8:11], s42 offen lds
  ds_read_b64_tr_b16 v[192:193], v4 offset:16384
  ds_read_b64_tr_b16 v[194:195], v4 offset:18432
  ds_read_b64_tr_b16 v[196:197], v4 offset:20480
  ds_read_b64_tr_b16 v[198:199], v4 offset:22528
  ds_read_b64_tr_b16 v[208:209], v5 offset:16384
  ds_read_b64_tr_b16 v[210:211], v5 offset:18432
  ds_read_b64_tr_b16 v[212:213], v5 offset:20480
  ds_read_b64_tr_b16 v[214:215], v5 offset:22528
  ds_read_b64_tr_b16 v[224:225], v6 offset:16384
  ds_read_b64_tr_b16 v[226:227], v6 offset:18432
  ds_read_b64_tr_b16 v[228:229], v6 offset:20480
  ds_read_b64_tr_b16 v[230:231], v6 offset:22528
  ds_read_b64_tr_b16 v[240:241], v7 offset:16384
  ds_read_b64_tr_b16 v[242:243], v7 offset:18432
  ds_read_b64_tr_b16 v[244:245], v7 offset:20480
  ds_read_b64_tr_b16 v[246:247], v7 offset:22528
  s_waitcnt vmcnt(16) lgkmcnt(0)
  s_barrier
  s_add_u32 m0, s41, 16384
  s_add_u32 s42, s53, 4194304
  buffer_load_dwordx4 v10, s[8:11], s42 offen lds
  s_add_u32 m0, s41, 17408
  s_add_u32 s42, s53, 4259840
  buffer_load_dwordx4 v10, s[8:11], s42 offen lds
  s_add_u32 m0, s41, 18432
  s_add_u32 s42, s53, 4202496
  buffer_load_dwordx4 v10, s[8:11], s42 offen lds
  s_add_u32 m0, s41, 19456
  s_add_u32 s42, s53, 4268032
  buffer_load_dwordx4 v10, s[8:11], s42 offen lds
  s_add_u32 m0, s41, 20480
  s_add_u32 s42, s53, 4456448
  buffer_load_dwordx4 v10, s[8:11], s42 offen lds
  s_add_u32 m0, s41, 21504
  s_add_u32 s42, s53, 4521984
  buffer_load_dwordx4 v10, s[8:11], s42 offen lds
  s_add_u32 m0, s41, 22528
  s_add_u32 s42, s53, 4464640
  buffer_load_dwordx4 v10, s[8:11], s42 offen lds
  s_add_u32 m0, s41, 23552
  s_add_u32 s42, s53, 4530176
  buffer_load_dwordx4 v10, s[8:11], s42 offen lds
  ds_read_b64_tr_b16 v[200:201], v4 offset:24576
  ds_read_b64_tr_b16 v[202:203], v4 offset:26624
  ds_read_b64_tr_b16 v[204:205], v4 offset:28672
  ds_read_b64_tr_b16 v[206:207], v4 offset:30720
  ds_read_b64_tr_b16 v[216:217], v5 offset:24576
  ds_read_b64_tr_b16 v[218:219], v5 offset:26624
  ds_read_b64_tr_b16 v[220:221], v5 offset:28672
  ds_read_b64_tr_b16 v[222:223], v5 offset:30720
  ds_read_b64_tr_b16 v[232:233], v6 offset:24576
  ds_read_b64_tr_b16 v[234:235], v6 offset:26624
  ds_read_b64_tr_b16 v[236:237], v6 offset:28672
  ds_read_b64_tr_b16 v[238:239], v6 offset:30720
  ds_read_b64_tr_b16 v[248:249], v7 offset:24576
  ds_read_b64_tr_b16 v[250:251], v7 offset:26624
  ds_read_b64_tr_b16 v[252:253], v7 offset:28672
  ds_read_b64_tr_b16 v[254:255], v7 offset:30720
  s_cmp_lg_u32 s20, 0
  s_cbranch_scc1 Lchore_172
Lini_173:
  s_load_dwordx16 s[64:79], s[12:13], 128 glc
  s_load_dwordx16 s[80:95], s[12:13], 192 glc
  s_sub_u32 s24, s24, 1
  s_cbranch_scc1 L_FAIL
  s_waitcnt lgkmcnt(0)
  s_and_b64 s[64:65], s[64:65], s[66:67]
  s_and_b64 s[64:65], s[64:65], s[68:69]
  s_and_b64 s[64:65], s[64:65], s[70:71]
  s_and_b64 s[64:65], s[64:65], s[72:73]
  s_and_b64 s[64:65], s[64:65], s[74:75]
  s_and_b64 s[64:65], s[64:65], s[76:77]
  s_and_b64 s[64:65], s[64:65], s[78:79]
  s_and_b64 s[64:65], s[64:65], s[80:81]
  s_and_b64 s[64:65], s[64:65], s[82:83]
  s_and_b64 s[64:65], s[64:65], s[84:85]
  s_and_b64 s[64:65], s[64:65], s[86:87]
  s_and_b64 s[64:65], s[64:65], s[88:89]
  s_and_b64 s[64:65], s[64:65], s[90:91]
  s_and_b64 s[64:65], s[64:65], s[92:93]
  s_and_b64 s[64:65], s[64:65], s[94:95]
  s_and_b32 s64, s64, s65
  s_cbranch_scc0 Lini_173
  s_mov_b32 s46, 0xffff
  s_and_b32 s40, s21, 3
  s_lshl_b32 s40, s40, 13
  s_lshr_b32 s43, s21, 2
  s_lshl_b32 s43, s43, 10
  s_add_u32 s43, s43, s40
  s_add_u32 s43, s43, 1344000
  s_waitcnt lgkmcnt(0)
  s_memtime s[64:65]
  s_waitcnt lgkmcnt(0)
  s_load_dword s68, s[4:5], s43 glc
  s_waitcnt lgkmcnt(0)
  s_memtime s[66:67]
  s_waitcnt lgkmcnt(0)
  s_sub_u32 s64, s66, s64
  s_min_u32 s46, s46, s64
  s_getreg_b32 s55, hwreg(HW_REG_XCC_ID)
  s_and_b32 s55, s55, 15
  s_lshl_b32 s46, s46, 8
  s_or_b32 s46, s46, s55
  s_add_u32 s40, s21, 32
  s_lshl_b32 s40, s40, 7
  s_add_u32 s40, s40, 1424384
  s_mov_b32 s63, s46
  s_atomic_smax s63, s[4:5], s40 glc
Lnosig_174:
Lchore_172:
  s_waitcnt vmcnt(16) lgkmcnt(0)
  s_barrier
  s_add_u32 m0, s41, 24576
  s_add_u32 s42, s53, 6291456
  buffer_load_dwordx4 v10, s[8:11], s42 offen lds
  s_add_u32 m0, s41, 25600
  s_add_u32 s42, s53, 6356992
  buffer_load_dwordx4 v10, s[8:11], s42 offen lds
  s_add_u32 m0, s41, 26624
  s_add_u32 s42, s53, 6299648
  buffer_load_dwordx4 v10, s[8:11], s42 offen lds
  s_add_u32 m0, s41, 27648
  s_add_u32 s42, s53, 6365184
  buffer_load_dwordx4 v10, s[8:11], s42 offen lds
  s_add_u32 m0, s41, 28672
  s_add_u32 s42, s53, 6553600
  buffer_load_dwordx4 v10, s[8:11], s42 offen lds
  s_add_u32 m0, s41, 29696
  s_add_u32 s42, s53, 6619136
  buffer_load_dwordx4 v10, s[8:11], s42 offen lds
  s_add_u32 m0, s41, 30720
  s_add_u32 s42, s53, 6561792
  buffer_load_dwordx4 v10, s[8:11], s42 offen lds
  s_add_u32 m0, s41, 31744
  s_add_u32 s42, s53, 6627328
  buffer_load_dwordx4 v10, s[8:11], s42 offen lds
  ds_read_b64_tr_b16 v[20:21], v4 offset:0
  ds_read_b64_tr_b16 v[22:23], v4 offset:2048
  ds_read_b64_tr_b16 v[24:25], v4 offset:4096
  ds_read_b64_tr_b16 v[26:27], v4 offset:6144
  ds_read_b64_tr_b16 v[28:29], v5 offset:0
  ds_read_b64_tr_b16 v[30:31], v5 offset:2048
  ds_read_b64_tr_b16 v[32:33], v5 offset:4096
  ds_read_b64_tr_b16 v[34:35], v5 offset:6144
  ds_read_b64_tr_b16 v[36:37], v6 offset:0
  ds_read_b64_tr_b16 v[38:39], v6 offset:2048
  ds_read_b64_tr_b16 v[40:41], v6 offset:4096
  ds_read_b64_tr_b16 v[42:43], v6 offset:6144
  ds_read_b64_tr_b16 v[44:45], v7 offset:0
  ds_read_b64_tr_b16 v[46:47], v7 offset:2048
  ds_read_b64_tr_b16 v[48:49], v7 offset:4096
  ds_read_b64_tr_b16 v[50:51], v7 offset:6144
  s_waitcnt lgkmcnt(0)
  s_barrier
  ds_write_b128 v85, v[20:23] offset:0
  ds_write_b128 v85, v[24:27] offset:1024
  ds_write_b128 v85, v[28:31] offset:2048
  ds_write_b128 v85, v[32:35] offset:3072
  ds_write_b128 v85, v[36:39] offset:4096
  ds_write_b128 v85, v[40:43] offset:5120
  ds_write_b128 v85, v[44:47] offset:6144
  ds_write_b128 v85, v[48:51] offset:7168
  s_waitcnt vmcnt(16) lgkmcnt(0)
  s_barrier
  ds_read_b64_tr_b16 v[20:21], v4 offset:8192
  ds_read_b64_tr_b16 v[22:23], v4 offset:10240
  ds_read_b64_tr_b16 v[24:25], v4 offset:12288
  ds_read_b64_tr_b16 v[26:27], v4 offset:14336
  ds_read_b64_tr_b16 v[28:29], v5 offset:8192
  ds_read_b64_tr_b16 v[30:31], v5 offset:10240
  ds_read_b64_tr_b16 v[32:33], v5 offset:12288
  ds_read_b64_tr_b16 v[34:35], v5 offset:14336
  ds_read_b64_tr_b16 v[36:37], v6 offset:8192
  ds_read_b64_tr_b16 v[38:39], v6 offset:10240
  ds_read_b64_tr_b16 v[40:41], v6 offset:12288
  ds_read_b64_tr_b16 v[42:43], v6 offset:14336
  ds_read_b64_tr_b16 v[44:45], v7 offset:8192
  ds_read_b64_tr_b16 v[46:47], v7 offset:10240
  ds_read_b64_tr_b16 v[48:49], v7 offset:12288
  ds_read_b64_tr_b16 v[50:51], v7 offset:14336
  s_waitcnt lgkmcnt(0)
  s_barrier
  ds_write_b128 v85, v[20:23] offset:8192
  ds_write_b128 v85, v[24:27] offset:9216
  ds_write_b128 v85, v[28:31] offset:10240
  ds_write_b128 v85, v[32:35] offset:11264
  ds_write_b128 v85, v[36:39] offset:12288
  ds_write_b128 v85, v[40:43] offset:13312
  ds_write_b128 v85, v[44:47] offset:14336
  ds_write_b128 v85, v[48:51] offset:15360
  s_waitcnt vmcnt(8) lgkmcnt(0)
  s_barrier
  ds_read_b64_tr_b16 v[20:21], v4 offset:16384
  ds_read_b64_tr_b16 v[22:23], v4 offset:18432
  ds_read_b64_tr_b16 v[24:25], v4 offset:20480
  ds_read_b64_tr_b16 v[26:27], v4 offset:22528
  ds_read_b64_tr_b16 v[28:29], v5 offset:16384
  ds_read_b64_tr_b16 v[30:31], v5 offset:18432
  ds_read_b64_tr_b16 v[32:33], v5 offset:20480
  ds_read_b64_tr_b16 v[34:35], v5 offset:22528
  ds_read_b64_tr_b16 v[36:37], v6 offset:16384
  ds_read_b64_tr_b16 v[38:39], v6 offset:18432
  ds_read_b64_tr_b16 v[40:41], v6 offset:20480
  ds_read_b64_tr_b16 v[42:43], v6 offset:22528
  ds_read_b64_tr_b16 v[44:45], v7 offset:16384
  ds_read_b64_tr_b16 v[46:47], v7 offset:18432
  ds_read_b64_tr_b16 v[48:49], v7 offset:20480
  ds_read_b64_tr_b16 v[50:51], v7 offset:22528
  s_waitcnt lgkmcnt(0)
  s_barrier
  ds_write_b128 v85, v[20:23] offset:16384
  ds_write_b128 v85, v[24:27] offset:17408
  ds_write_b128 v85, v[28:31] offset:18432
  ds_write_b128 v85, v[32:35] offset:19456
  ds_write_b128 v85, v[36:39] offset:20480
  ds_write_b128 v85, v[40:43] offset:21504
  ds_write_b128 v85, v[44:47] offset:22528
  ds_write_b128 v85, v[48:51] offset:23552
  s_waitcnt vmcnt(0) lgkmcnt(0)
  s_barrier
  ds_read_b64_tr_b16 v[20:21], v4 offset:24576
  ds_read_b64_tr_b16 v[22:23], v4 offset:26624
  ds_read_b64_tr_b16 v[24:25], v4 offset:28672
  ds_read_b64_tr_b16 v[26:27], v4 offset:30720
  ds_read_b64_tr_b16 v[28:29], v5 offset:24576
  ds_read_b64_tr_b16 v[30:31], v5 offset:26624
  ds_read_b64_tr_b16 v[32:33], v5 offset:28672
  ds_read_b64_tr_b16 v[34:35], v5 offset:30720
  ds_read_b64_tr_b16 v[36:37], v6 offset:24576
  ds_read_b64_tr_b16 v[38:39], v6 offset:26624
  ds_read_b64_tr_b16 v[40:41], v6 offset:28672
  ds_read_b64_tr_b16 v[42:43], v6 offset:30720
  ds_read_b64_tr_b16 v[44:45], v7 offset:24576
  ds_read_b64_tr_b16 v[46:47], v7 offset:26624
  ds_read_b64_tr_b16 v[48:49], v7 offset:28672
  ds_read_b64_tr_b16 v[50:51], v7 offset:30720
  s_waitcnt lgkmcnt(0)
  s_barrier
  ds_write_b128 v85, v[20:23] offset:24576
  ds_write_b128 v85, v[24:27] offset:25600
  ds_write_b128 v85, v[28:31] offset:26624
  ds_write_b128 v85, v[32:35] offset:27648
  ds_write_b128 v85, v[36:39] offset:28672
  ds_write_b128 v85, v[40:43] offset:29696
  ds_write_b128 v85, v[44:47] offset:30720
  ds_write_b128 v85, v[48:51] offset:31744
  s_waitcnt lgkmcnt(0)
  s_lshr_b32 s40, s21, 1
  s_lshl_b32 s40, s40, 2
  v_min_u32 v76, 3, v0
  v_add_u32 v76, s40, v76
  v_lshlrev_b32 v76, 7, v76
  v_add_u32 v76, 1432576, v76
  s_nop 1
Lpoll_175:
  buffer_load_dword v77, v76, s[4:7], 0 offen sc1
  s_sub_u32 s24, s24, 1
  s_cbranch_scc1 L_FAIL
  s_waitcnt vmcnt(0)
  v_cmp_gt_i32 vcc, 1, v77
  s_cbranch_vccz Lpolld_176
  s_sleep 1
  s_branch Lpoll_175
Lpolld_176:
  s_lshl_b32 s40, s21, 18
  s_lshl_b32 s41, s20, 15
  s_add_u32 s40, s40, s41
  v_lshl_add_u32 v76, v0, 4, s40
  s_add_u32 s50, s21, s20
  s_and_b32 s50, s50, 3
  s_lshl_b32 s41, s54, 5
  s_add_u32 s41, s41, s50
  s_lshl_b32 s41, s41, 12
  s_xor_b32 s40, s41, 0
  s_add_u32 s40, s40, 10485760
  buffer_load_dwordx4 a[0:3], v76, s[4:7], s40 offen offset:0 sc1
  buffer_load_dwordx4 a[4:7], v76, s[4:7], s40 offen offset:1024 sc1
  buffer_load_dwordx4 a[8:11], v76, s[4:7], s40 offen offset:2048 sc1
  buffer_load_dwordx4 a[12:15], v76, s[4:7], s40 offen offset:3072 sc1
  s_waitcnt vmcnt(32)
  s_xor_b32 s40, s41, 4096
  s_add_u32 s40, s40, 10485760
  buffer_load_dwordx4 a[16:19], v76, s[4:7], s40 offen offset:0 sc1
  buffer_load_dwordx4 a[20:23], v76, s[4:7], s40 offen offset:1024 sc1
  buffer_load_dwordx4 a[24:27], v76, s[4:7], s40 offen offset:2048 sc1
  buffer_load_dwordx4 a[28:31], v76, s[4:7], s40 offen offset:3072 sc1
  s_waitcnt vmcnt(32)
  s_xor_b32 s40, s41, 8192
  s_add_u32 s40, s40, 10485760
  buffer_load_dwordx4 a[32:35], v76, s[4:7], s40 offen offset:0 sc1
  buffer_load_dwordx4 a[36:39], v76, s[4:7], s40 offen offset:1024 sc1
  buffer_load_dwordx4 a[40:43], v76, s[4:7], s40 offen offset:2048 sc1
  buffer_load_dwordx4 a[44:47], v76, s[4:7], s40 offen offset:3072 sc1
  s_waitcnt vmcnt(32)
  s_xor_b32 s40, s41, 12288
  s_add_u32 s40, s40, 10485760
  buffer_load_dwordx4 a[48:51], v76, s[4:7], s40 offen offset:0 sc1
  buffer_load_dwordx4 a[52:55], v76, s[4:7], s40 offen offset:1024 sc1
  buffer_load_dwordx4 a[56:59], v76, s[4:7], s40 offen offset:2048 sc1
  buffer_load_dwordx4 a[60:63], v76, s[4:7], s40 offen offset:3072 sc1
  s_waitcnt vmcnt(32)
  s_xor_b32 s40, s41, 16384
  s_add_u32 s40, s40, 10485760
  buffer_load_dwordx4 a[64:67], v76, s[4:7], s40 offen offset:0 sc1
  buffer_load_dwordx4 a[68:71], v76, s[4:7], s40 offen offset:1024 sc1
  buffer_load_dwordx4 a[72:75], v76, s[4:7], s40 offen offset:2048 sc1
  buffer_load_dwordx4 a[76:79], v76, s[4:7], s40 offen offset:3072 sc1
  s_waitcnt vmcnt(32)
  s_xor_b32 s40, s41, 20480
  s_add_u32 s40, s40, 10485760
  buffer_load_dwordx4 a[80:83], v76, s[4:7], s40 offen offset:0 sc1
  buffer_load_dwordx4 a[84:87], v76, s[4:7], s40 offen offset:1024 sc1
  buffer_load_dwordx4 a[88:91], v76, s[4:7], s40 offen offset:2048 sc1
  buffer_load_dwordx4 a[92:95], v76, s[4:7], s40 offen offset:3072 sc1
  s_waitcnt vmcnt(32)
  s_xor_b32 s40, s41, 24576
  s_add_u32 s40, s40, 10485760
  buffer_load_dwordx4 a[96:99], v76, s[4:7], s40 offen offset:0 sc1
  buffer_load_dwordx4 a[100:103], v76, s[4:7], s40 offen offset:1024 sc1
  buffer_load_dwordx4 a[104:107], v76, s[4:7], s40 offen offset:2048 sc1
  buffer_load_dwordx4 a[108:111], v76, s[4:7], s40 offen offset:3072 sc1
  s_waitcnt vmcnt(32)
  s_xor_b32 s40, s41, 28672
  s_add_u32 s40, s40, 10485760
  buffer_load_dwordx4 a[112:115], v76, s[4:7], s40 offen offset:0 sc1
  buffer_load_dwordx4 a[116:119], v76, s[4:7], s40 offen offset:1024 sc1
  buffer_load_dwordx4 a[120:123], v76, s[4:7], s40 offen offset:2048 sc1
  buffer_load_dwordx4 a[124:127], v76, s[4:7], s40 offen offset:3072 sc1
  s_waitcnt vmcnt(32)
  s_xor_b32 s40, s41, 131072
  s_add_u32 s40, s40, 10485760
  buffer_load_dwordx4 a[128:131], v76, s[4:7], s40 offen offset:0 sc1
  buffer_load_dwordx4 a[132:135], v76, s[4:7], s40 offen offset:1024 sc1
  buffer_load_dwordx4 a[136:139], v76, s[4:7], s40 offen offset:2048 sc1
  buffer_load_dwordx4 a[140:143], v76, s[4:7], s40 offen offset:3072 sc1
  s_waitcnt vmcnt(32)
  s_xor_b32 s40, s41, 135168
  s_add_u32 s40, s40, 10485760
  buffer_load_dwordx4 a[144:147], v76, s[4:7], s40 offen offset:0 sc1
  buffer_load_dwordx4 a[148:151], v76, s[4:7], s40 offen offset:1024 sc1
  buffer_load_dwordx4 a[152:155], v76, s[4:7], s40 offen offset:2048 sc1
  buffer_load_dwordx4 a[156:159], v76, s[4:7], s40 offen offset:3072 sc1
  s_waitcnt vmcnt(32)
  s_xor_b32 s40, s41, 139264
  s_add_u32 s40, s40, 10485760
  buffer_load_dwordx4 a[160:163], v76, s[4:7], s40 offen offset:0 sc1
  buffer_load_dwordx4 a[164:167], v76, s[4:7], s40 offen offset:1024 sc1
  buffer_load_dwordx4 a[168:171], v76, s[4:7], s40 offen offset:2048 sc1
  buffer_load_dwordx4 a[172:175], v76, s[4:7], s40 offen offset:3072 sc1
  s_waitcnt vmcnt(32)
  s_xor_b32 s40, s41, 143360
  s_add_u32 s40, s40, 10485760
  buffer_load_dwordx4 a[176:179], v76, s[4:7], s40 offen offset:0 sc1
  buffer_load_dwordx4 a[180:183], v76, s[4:7], s40 offen offset:1024 sc1
  buffer_load_dwordx4 a[184:187], v76, s[4:7], s40 offen offset:2048 sc1
  buffer_load_dwordx4 a[188:191], v76, s[4:7], s40 offen offset:3072 sc1
  s_waitcnt vmcnt(32)
  s_xor_b32 s40, s41, 147456
  s_add_u32 s40, s40, 10485760
  buffer_load_dwordx4 a[192:195], v76, s[4:7], s40 offen offset:0 sc1
  buffer_load_dwordx4 a[196:199], v76, s[4:7], s40 offen offset:1024 sc1
  buffer_load_dwordx4 a[200:203], v76, s[4:7], s40 offen offset:2048 sc1
  buffer_load_dwordx4 a[204:207], v76, s[4:7], s40 offen offset:3072 sc1
  s_waitcnt vmcnt(32)
  s_xor_b32 s40, s41, 151552
  s_add_u32 s40, s40, 10485760
  buffer_load_dwordx4 a[208:211], v76, s[4:7], s40 offen offset:0 sc1
  buffer_load_dwordx4 a[212:215], v76, s[4:7], s40 offen offset:1024 sc1
  buffer_load_dwordx4 a[216:219], v76, s[4:7], s40 offen offset:2048 sc1
  buffer_load_dwordx4 a[220:223], v76, s[4:7], s40 offen offset:3072 sc1
  s_waitcnt vmcnt(32)
  s_xor_b32 s40, s41, 155648
  s_add_u32 s40, s40, 10485760
  buffer_load_dwordx4 a[224:227], v76, s[4:7], s40 offen offset:0 sc1
  buffer_load_dwordx4 a[228:231], v76, s[4:7], s40 offen offset:1024 sc1
  buffer_load_dwordx4 a[232:235], v76, s[4:7], s40 offen offset:2048 sc1
  buffer_load_dwordx4 a[236:239], v76, s[4:7], s40 offen offset:3072 sc1
  s_waitcnt vmcnt(32)
  s_xor_b32 s40, s41, 159744
  s_add_u32 s40, s40, 10485760
  buffer_load_dwordx4 a[240:243], v76, s[4:7], s40 offen offset:0 sc1
  buffer_load_dwordx4 a[244:247], v76, s[4:7], s40 offen offset:1024 sc1
  buffer_load_dwordx4 a[248:251], v76, s[4:7], s40 offen offset:2048 sc1
  buffer_load_dwordx4 a[252:255], v76, s[4:7], s40 offen offset:3072 sc1
  s_waitcnt vmcnt(32)
  s_cmp_lg_u32 s20, 2
  s_cbranch_scc1 Lnotlb_177
  v_lshlrev_b32 v77, 21, v0
  s_mov_b32 s40, 0x1fff80
  buffer_load_dword v78, v77, s[4:7], s40 offen sc1
  s_add_u32 s40, s40, 134217728
  buffer_load_dword v78, v77, s[4:7], s40 offen sc1
  s_waitcnt vmcnt(0)
Lnotlb_177:
  s_getreg_b32 s55, hwreg(HW_REG_XCC_ID)
  s_and_b32 s55, s55, 15
  v_min_u32 v76, 63, v0
  v_lshlrev_b32 v76, 7, v76
  v_add_u32 v76, 1424384, v76
  s_nop 1
Lpoll_178:
  buffer_load_dword v77, v76, s[4:7], 0 offen sc1
  s_sub_u32 s24, s24, 1
  s_cbranch_scc1 L_FAIL
  s_waitcnt vmcnt(0)
  v_cmp_gt_i32 vcc, 0, v77
  s_cbranch_vccz Lpolld_179
  s_sleep 1
  s_branch Lpoll_178
Lpolld_179:
  v_and_b32 v78, 15, v77
  v_cmp_ne_u32 vcc, s55, v78
  s_lshl_b32 s40, s54, 4
  s_lshl_b32 s40, 0xffff, s40
  s_or_b32 s41, vcc_lo, vcc_hi
  s_and_b32 s40, s40, s41
  s_cselect_b32 s36, 0, 8192
  v_lshrrev_b32 v77, 8, v77
  v_and_b32 v78, 3, v0
  v_lshl_or_b32 v77, v77, 2, v78
  s_nop 1
  v_min_u32_dpp v77, v77, v77 row_ror:8 row_mask:0xf bank_mask:0xf
  s_nop 1
  v_min_u32_dpp v77, v77, v77 row_ror:4 row_mask:0xf bank_mask:0xf
  v_mov_b32 v78, v77
  s_nop 1
  v_permlane16_swap_b32 v78, v77
  v_min_u32 v77, v77, v78
  v_mov_b32 v78, v77
  s_nop 1
  v_permlane32_swap_b32 v78, v77
  v_min_u32 v77, v77, v78
  s_nop 1
  v_min_u32_dpp v77, v77, v77 row_ror:2 row_mask:0xf bank_mask:0xf
  s_nop 1
  v_min_u32_dpp v77, v77, v77 row_ror:1 row_mask:0xf bank_mask:0xf
  s_nop 0
  v_readfirstlane_b32 s26, v77
  s_and_b32 s26, s26, 3
  s_lshl_b32 s26, s26, 13
  s_lshr_b32 s40, s20, 1
  s_mul_i32 s40, s40, 32768
  s_and_b32 s41, s20, 1
  s_lshl_b32 s41, s41, 10
  s_add_u32 s40, s40, s41
  s_lshl_b32 s41, s54, 12
  s_add_u32 s40, s40, s41
  v_lshl_add_u32 v86, v0, 4, s40
  v_xor_b32 v87, 0x1000, v86
  v_and_b32 v76, 2, v0
  v_cmp_eq_u32 vcc, 0, v76
  v_mov_b32 v76, 0xeeee
  v_mov_b32 v77, 0x4444
  v_cndmask_b32 v88, v76, v77, vcc
  s_lshr_b32 s40, s21, 2
  s_mul_i32 s40, s40, 32768
  s_and_b32 s41, s21, 3
  s_lshl_b32 s41, s41, 11
  s_add_u32 s47, s40, s41
  s_lshl_b32 s41, s20, 9
  s_add_u32 s47, s47, s41
  v_lshl_add_u32 v92, v0, 3, s47
  s_lshl_b32 s41, s54, 12
  s_add_u32 s40, s41, 1310720
  s_add_u32 s40, s40, s26
  v_lshrrev_b32 v76, 2, v0
  v_lshl_add_u32 v76, v76, 7, s40
  v_and_b32 v77, 3, v0
  v_lshl_add_u32 v90, v77, 2, v76
  s_mov_b32 s57, s40
  s_cmp_eq_u32 s36, 0
  s_cselect_b32 s56, 1, s20
  s_and_b32 s41, s21, 15
  s_lshl_b32 s41, s41, 7
  s_lshl_b32 s40, s20, 2
  s_add_u32 s40, s40, s41
  s_add_u32 s40, s40, 0
  s_mov_b32 s25, 0
  s_mov_b32 s60, 0
  s_mov_b32 s61, 0
  s_mov_b32 s51, -1
  v_mov_b32 v91, 2147483392
  s_mov_b64 exec, 1
  v_mov_b32 v91, s40
  s_mov_b64 exec, -1
  v_mov_b32 v80, -1
  v_mov_b32 v81, -1
  v_mov_b32 v82, -1
  v_mov_b32 v83, -1
  s_mul_i32 s40, s20, 32768
  s_and_b32 s41, s50, 3
  s_lshl_b32 s41, s41, 10
  s_add_u32 s40, s40, s41
  v_lshl_add_u32 v111, v0, 4, s40
  v_xor_b32 v112, 0x400, v111
  v_xor_b32 v113, 0x800, v111
  v_xor_b32 v114, 0xc00, v111
  s_mul_i32 s58, s54, 131072
  s_and_b32 s41, s50, 4
  s_lshl_b32 s41, s41, 10
  s_add_u32 s58, s58, s41
  s_bfe_u32 s40, s21, 0x20002
  s_lshl_b32 s40, s40, 7
  s_and_b32 s41, s21, 3
  s_lshl_b32 s41, s41, 4
  s_add_u32 s40, s40, s41
  s_lshl_b32 s41, s20, 2
  s_add_u32 s41, s41, s40
  s_cmp_eq_u32 s20, 0
  s_cselect_b32 s40, s40, s41
  s_mov_b64 exec, 1
  v_mov_b32 v91, s40
  s_mov_b64 exec, -1
  s_mul_i32 s40, s20, 512
  v_add_u32 v90, s40, v90
  v_bfe_u32 v76, v0, 2, 2
  v_xor_b32 v76, s20, v76
  v_lshlrev_b32 v76, 3, v76
  v_lshl_add_u32 v76, v0, 5, v76
  v_add_u32 v95, 147456, v76
  s_and_b32 s40, s20, 1
  s_lshl_b32 s40, s40, 3
  v_bfe_u32 v4, v0, 2, 3
  v_add_u32 v4, s40, v4
  s_lshr_b32 s40, s20, 1
  s_lshl_b32 s40, s40, 3
  v_and_b32 v5, 3, v0
  v_add_u32 v5, s40, v5
  v_bfe_u32 v76, v4, 1, 1
  v_lshl_add_u32 v5, v76, 2, v5
  v_lshrrev_b32 v76, 2, v4
  v_and_b32 v77, 1, v4
  v_lshl_add_u32 v78, v76, 4, v5
  v_lshlrev_b32 v78, 5, v78
  v_mul_u32_u24 v77, 2064, v77
  v_add_u32 v78, v77, v78
  v_add_u32 v108, 147456, v78
  v_xor_b32 v109, 16, v108
  s_bfe_u32 s41, s21, 0x10002
  s_mul_i32 s41, s41, 32768
  s_lshr_b32 s40, s21, 3
  s_lshl_b32 s40, s40, 11
  s_add_u32 s40, s40, s41
  s_and_b32 s41, s21, 3
  s_lshl_b32 s41, s41, 9
  s_add_u32 s40, s40, s41
  s_lshl_b32 s41, s20, 7
  s_add_u32 s40, s40, s41
  v_lshl_add_u32 v110, v0, 2, s40
  s_mov_b32 exec_lo, 0
  v_mov_b32 v110, 2147483392
  s_mov_b64 exec, -1
  ds_read_b128 v[116:119], v85 offset:20480
  ds_read_b128 v[120:123], v85 offset:21504
  s_mov_b32 s59, 2147483392
  s_mov_b32 s25, 0
  s_add_u32 s27, s25, 32
  s_and_b32 s40, s27, 0x28
  s_mul_i32 s40, s40, 0x900
  s_and_b32 s40, s40, 0x6000
  s_xor_b32 s40, s40, s26
  s_lshl_b32 s27, s27, 16
  s_add_u32 s27, s27, s40
  s_lshl_b32 s37, s36, 1
  s_xor_b32 s37, s27, s37
  s_and_b32 s40, s25, 3
  s_lshl_b32 s40, s40, 18
  s_add_u32 s28, s40, s26
  s_lshr_b32 s40, s40, 5
  s_and_b32 s40, s40, 0x4000
  s_xor_b32 s28, s28, s40
  s_xor_b32 s29, s28, 0x4000
  s_xor_b32 s40, s29, 0
  buffer_load_dword v89, v92, s[4:7], s40 offen sc1
  s_xor_b32 s40, s27, 16384
  buffer_load_dword v89, v110, s[4:7], s40 offen sc1
  s_mov_b32 s25, 1
  s_add_u32 s27, s25, 32
  s_and_b32 s40, s27, 0x28
  s_mul_i32 s40, s40, 0x900
  s_and_b32 s40, s40, 0x6000
  s_xor_b32 s40, s40, s26
  s_lshl_b32 s27, s27, 16
  s_add_u32 s27, s27, s40
  s_lshl_b32 s37, s36, 1
  s_xor_b32 s37, s27, s37
  s_and_b32 s40, s25, 3
  s_lshl_b32 s40, s40, 18
  s_add_u32 s28, s40, s26
  s_lshr_b32 s40, s40, 5
  s_and_b32 s40, s40, 0x4000
  s_xor_b32 s28, s28, s40
  s_xor_b32 s29, s28, 0x4000
  s_xor_b32 s40, s29, 0
  buffer_load_dword v89, v92, s[4:7], s40 offen sc1
  s_xor_b32 s40, s27, 16384
  buffer_load_dword v89, v110, s[4:7], s40 offen sc1
  s_mov_b32 s25, 2
  s_add_u32 s27, s25, 32
  s_and_b32 s40, s27, 0x28
  s_mul_i32 s40, s40, 0x900
  s_and_b32 s40, s40, 0x6000
  s_xor_b32 s40, s40, s26
  s_lshl_b32 s27, s27, 16
  s_add_u32 s27, s27, s40
  s_lshl_b32 s37, s36, 1
  s_xor_b32 s37, s27, s37
  s_and_b32 s40, s25, 3
  s_lshl_b32 s40, s40, 18
  s_add_u32 s28, s40, s26
  s_lshr_b32 s40, s40, 5
  s_and_b32 s40, s40, 0x4000
  s_xor_b32 s28, s28, s40
  s_xor_b32 s29, s28, 0x4000
  s_xor_b32 s40, s29, 0
  buffer_load_dword v89, v92, s[4:7], s40 offen sc1
  s_xor_b32 s40, s27, 16384
  buffer_load_dword v89, v110, s[4:7], s40 offen sc1
  s_mov_b32 s25, 3
  s_add_u32 s27, s25, 32
  s_and_b32 s40, s27, 0x28
  s_mul_i32 s40, s40, 0x900
  s_and_b32 s40, s40, 0x6000
  s_xor_b32 s40, s40, s26
  s_lshl_b32 s27, s27, 16
  s_add_u32 s27, s27, s40
  s_lshl_b32 s37, s36, 1
  s_xor_b32 s37, s27, s37
  s_and_b32 s40, s25, 3
  s_lshl_b32 s40, s40, 18
  s_add_u32 s28, s40, s26
  s_lshr_b32 s40, s40, 5
  s_and_b32 s40, s40, 0x4000
  s_xor_b32 s28, s28, s40
  s_xor_b32 s29, s28, 0x4000
  s_xor_b32 s40, s29, 0
  buffer_load_dword v89, v92, s[4:7], s40 offen sc1
  s_xor_b32 s40, s27, 16384
  buffer_load_dword v89, v110, s[4:7], s40 offen sc1
  buffer_load_dword v89, v90, s[4:7], 0 offen offset:2048 sc1
  s_mov_b32 s25, 0
  v_mov_b64 v[52:53], 0
  v_mov_b64 v[54:55], 0
  v_mov_b64 v[56:57], 0
  v_mov_b64 v[58:59], 0
  ds_read_b128 v[20:23], v85 offset:0
  ds_read_b128 v[24:27], v85 offset:1024
  ds_read_b128 v[28:31], v85 offset:8192
  ds_read_b128 v[32:35], v85 offset:9216
  ds_read_b128 v[36:39], v85 offset:2048
  ds_read_b128 v[40:43], v85 offset:3072
  ds_read_b128 v[44:47], v85 offset:10240
  ds_read_b128 v[48:51], v85 offset:11264
L_VO_top:
  s_add_u32 s27, s25, 32
  s_and_b32 s40, s27, 0x28
  s_mul_i32 s40, s40, 0x900
  s_and_b32 s40, s40, 0x6000
  s_xor_b32 s40, s40, s26
  s_lshl_b32 s27, s27, 16
  s_add_u32 s27, s27, s40
  s_lshl_b32 s37, s36, 1
  s_xor_b32 s37, s27, s37
  s_and_b32 s40, s25, 3
  s_lshl_b32 s40, s40, 18
  s_add_u32 s28, s40, s26
  s_lshr_b32 s40, s40, 5
  s_and_b32 s40, s40, 0x4000
  s_xor_b32 s28, s28, s40
  s_xor_b32 s29, s28, 0x4000
  s_add_u32 s33, s25, 33
  s_and_b32 s40, s33, 0x28
  s_mul_i32 s40, s40, 0x900
  s_and_b32 s40, s40, 0x6000
  s_xor_b32 s40, s40, s26
  s_lshl_b32 s33, s33, 16
  s_add_u32 s33, s33, s40
  s_xor_b32 s49, s33, 16384
  s_add_u32 s34, s25, 35
  s_and_b32 s40, s34, 0x28
  s_mul_i32 s40, s40, 0x900
  s_and_b32 s40, s40, 0x6000
  s_xor_b32 s40, s40, s26
  s_lshl_b32 s34, s34, 16
  s_add_u32 s34, s34, s40
  s_cmp_lt_u32 s25, 61
  s_cselect_b32 s34, s34, 2147483392
  s_sleep 4
L_VO_retry:
  buffer_load_dwordx4 v[4:7], v86, s[4:7], s37 offen offset:0 sc1
  s_nop 0
  buffer_load_dwordx4 v[8:11], v86, s[4:7], s37 offen offset:2048 sc1
  s_nop 0
  s_waitcnt vmcnt(1) lgkmcnt(0)
  buffer_load_dwordx4 v[68:71], v87, s[4:7], s27 offen offset:0 sc1
  buffer_load_dwordx4 v[72:75], v87, s[4:7], s27 offen offset:2048 sc1
  v_smfmac_f32_16x16x64_bf16 v[52:55], v[4:7], v[128:135], v88
  ds_write_b128 v1, v[4:7] offset:0
  v_max3_u32 v89, v4, v5, v6
  v_smfmac_f32_16x16x64_bf16 v[56:59], v[4:7], v[20:27], v88
  v_max3_u32 v89, v6, v7, v89
  s_nop 0
  s_waitcnt vmcnt(2)
  ds_write_b128 v1, v[8:11] offset:1024
  v_max3_u32 v89, v8, v9, v89
  v_max3_u32 v89, v10, v11, v89
  v_cmp_eq_u32_e64 vcc, -1, v89
  s_cbranch_vccnz L_VO_bad
  s_waitcnt lgkmcnt(0)
  s_barrier
  ds_read_b128 v[12:15], v2 offset:0
  ds_read_b128 v[16:19], v2 offset:1024
  v_smfmac_f32_16x16x64_bf16 v[52:55], v[8:11], v[136:143], v88
  ds_read_b128 v[4:7], v3 offset:0
  ds_read_b128 v[20:23], v85 offset:4096
  v_smfmac_f32_16x16x64_bf16 v[56:59], v[8:11], v[28:35], v88
  ds_read_b128 v[24:27], v85 offset:5120
  s_waitcnt lgkmcnt(4)
  v_smfmac_f32_16x16x64_bf16 v[52:55], v[12:15], v[144:151], v88
  ds_read_b128 v[8:11], v3 offset:1024
  ds_read_b128 v[28:31], v85 offset:12288
  v_smfmac_f32_16x16x64_bf16 v[56:59], v[12:15], v[36:43], v88
  ds_read_b128 v[32:35], v85 offset:13312
  s_waitcnt lgkmcnt(6)
  v_smfmac_f32_16x16x64_bf16 v[52:55], v[16:19], v[152:159], v88
  ds_read_b128 v[12:15], v84 offset:0
  ds_read_b128 v[36:39], v85 offset:6144
  v_smfmac_f32_16x16x64_bf16 v[56:59], v[16:19], v[44:51], v88
  ds_read_b128 v[40:43], v85 offset:7168
  s_waitcnt lgkmcnt(6)
  v_smfmac_f32_16x16x64_bf16 v[52:55], v[4:7], v[160:167], v88
  ds_read_b128 v[16:19], v84 offset:1024
  ds_read_b128 v[44:47], v85 offset:14336
  v_smfmac_f32_16x16x64_bf16 v[56:59], v[4:7], v[20:27], v88
  ds_read_b128 v[48:51], v85 offset:15360
  s_waitcnt lgkmcnt(6)
  v_smfmac_f32_16x16x64_bf16 v[52:55], v[8:11], v[168:175], v88
  ds_read_b128 v[20:23], v85 offset:16384
  v_smfmac_f32_16x16x64_bf16 v[56:59], v[8:11], v[28:35], v88
  ds_read_b128 v[24:27], v85 offset:17408
  s_waitcnt lgkmcnt(5)
  v_smfmac_f32_16x16x64_bf16 v[52:55], v[12:15], v[176:183], v88
  ds_read_b128 v[28:31], v85 offset:24576
  v_smfmac_f32_16x16x64_bf16 v[56:59], v[12:15], v[36:43], v88
  ds_read_b128 v[32:35], v85 offset:25600
  s_waitcnt lgkmcnt(4)
  s_waitcnt vmcnt(0)
  ds_write_b128 v1, v[68:71] offset:2048
  v_smfmac_f32_16x16x64_bf16 v[52:55], v[16:19], v[184:191], v88
  ds_write_b128 v1, v[72:75] offset:3072
  v_max3_u32 v89, v68, v69, v70
  v_max3_u32 v89, v70, v71, v89
  v_max3_u32 v89, v72, v73, v89
  v_smfmac_f32_16x16x64_bf16 v[56:59], v[16:19], v[44:51], v88
  v_max3_u32 v89, v74, v75, v89
  v_cmp_eq_u32 vcc, -1, v89
  ds_read_b128 v[36:39], v85 offset:18432
  ds_read_b128 v[40:43], v85 offset:19456
  s_cbranch_vccnz L_VO_rbad
L_VO_rok:
  s_waitcnt lgkmcnt(6)
  s_waitcnt lgkmcnt(2)
  s_barrier
  v_smfmac_f32_16x16x64_bf16 v[52:55], v[68:71], v[192:199], v88
  ds_read_b128 v[12:15], v2 offset:2048
  ds_read_b128 v[16:19], v2 offset:3072
  v_smfmac_f32_16x16x64_bf16 v[56:59], v[68:71], v[20:27], v88
  ds_read_b128 v[44:47], v85 offset:26624
  ds_read_b128 v[48:51], v85 offset:27648
  v_smfmac_f32_16x16x64_bf16 v[52:55], v[72:75], v[200:207], v88
  ds_read_b128 v[4:7], v3 offset:2048
  v_smfmac_f32_16x16x64_bf16 v[56:59], v[72:75], v[28:35], v88
  s_waitcnt lgkmcnt(4)
  v_smfmac_f32_16x16x64_bf16 v[52:55], v[12:15], v[208:215], v88
  ds_read_b128 v[8:11], v3 offset:3072
  ds_read_b128 v[28:31], v85 offset:28672
  v_smfmac_f32_16x16x64_bf16 v[56:59], v[12:15], v[36:43], v88
  ds_read_b128 v[32:35], v85 offset:29696
  s_waitcnt lgkmcnt(4)
  v_smfmac_f32_16x16x64_bf16 v[52:55], v[16:19], v[216:223], v88
  ds_read_b128 v[12:15], v84 offset:2048
  ds_read_b128 v[36:39], v85 offset:22528
  v_smfmac_f32_16x16x64_bf16 v[56:59], v[16:19], v[44:51], v88
  ds_read_b128 v[40:43], v85 offset:23552
  s_waitcnt lgkmcnt(6)
  v_smfmac_f32_16x16x64_bf16 v[52:55], v[4:7], v[224:231], v88
  ds_read_b128 v[16:19], v84 offset:3072
  ds_read_b128 v[44:47], v85 offset:30720
  v_smfmac_f32_16x16x64_bf16 v[56:59], v[4:7], v[116:123], v88
  ds_read_b128 v[48:51], v85 offset:31744
  s_waitcnt lgkmcnt(6)
  v_smfmac_f32_16x16x64_bf16 v[52:55], v[8:11], v[232:239], v88
  v_smfmac_f32_16x16x64_bf16 v[56:59], v[8:11], v[28:35], v88
  s_waitcnt lgkmcnt(3)
  v_smfmac_f32_16x16x64_bf16 v[52:55], v[12:15], v[240:247], v88
  v_smfmac_f32_16x16x64_bf16 v[56:59], v[12:15], v[36:43], v88
  s_waitcnt lgkmcnt(0)
  v_smfmac_f32_16x16x64_bf16 v[52:55], v[16:19], v[248:255], v88
  v_smfmac_f32_16x16x64_bf16 v[56:59], v[16:19], v[44:51], v88
  s_nop 6
  v_pk_add_f32 v[52:53], v[52:53], v[54:55]
  v_pk_add_f32 v[56:57], v[56:57], v[58:59]
  v_cvt_pk_bf16_f32 v100, v52, v53
  v_cvt_pk_bf16_f32 v101, v56, v57
  s_cmp_eq_u32 s36, 0
  s_cbranch_scc1 Lwt_180
  buffer_store_dwordx2 v[100:101], v92, s[4:7], s29 offen
  s_branch Lwtd_181
Lwt_180:
  buffer_store_dwordx2 v[100:101], v92, s[4:7], s29 offen sc1
Lwtd_181:
  s_cmp_ge_u32 s25, 63
  s_cbranch_scc1 L_VO_end
  s_add_u32 s42, s28, s58
  s_xor_b32 s30, s42, s36
  s_xor_b32 s31, s30, 4096
  s_xor_b32 s32, s42, 131072
  s_xor_b32 s48, s32, 4096
  s_add_u32 s41, s25, 1
  v_mov_b32 v94, s41
  s_xor_b32 s35, s29, 0x84000
  buffer_load_dword v76, v110, s[4:7], s59 offen sc1
  buffer_store_dword v80, v110, s[4:7], s34 offen sc1
  s_xor_b32 s59, s34, 16384
  buffer_store_dword v80, v110, s[4:7], s59 offen sc1
  s_cmp_eq_u32 s36, 0
  s_cbranch_scc1 Lwt_182
  buffer_store_dwordx2 v[80:81], v92, s[4:7], s35 offen
  s_branch Lwtd_183
Lwt_182:
  buffer_store_dwordx2 v[80:81], v92, s[4:7], s35 offen sc1
Lwtd_183:
  v_mov_b64 v[60:61], 0
  v_mov_b64 v[62:63], 0
  v_mov_b64 v[64:65], 0
  v_mov_b64 v[66:67], 0
  v_mov_b64 v[52:53], 0
  v_mov_b64 v[54:55], 0
  v_mov_b64 v[56:57], 0
  v_mov_b64 v[58:59], 0
  ds_read_b128 v[20:23], v85 offset:0
  ds_read_b128 v[24:27], v85 offset:1024
  ds_read_b128 v[28:31], v85 offset:8192
  ds_read_b128 v[32:35], v85 offset:9216
  ds_read_b128 v[36:39], v85 offset:2048
  ds_read_b128 v[40:43], v85 offset:3072
  ds_read_b128 v[44:47], v85 offset:10240
  ds_read_b128 v[48:51], v85 offset:11264
  s_cmp_eq_u32 s36, 0
  s_nop 0
  s_cbranch_scc1 Ltrigd_185
  s_mov_b64 exec, 0xffff
  s_sleep 4
  s_nop 0
  s_nop 0
  s_nop 0
  buffer_load_dword v76, v90, s[4:7], 0 offen offset:2048 sc1
  s_sleep 1
  buffer_load_dword v77, v90, s[4:7], 0 offen offset:2048 sc1
  s_sleep 1
  buffer_load_dword v78, v90, s[4:7], 0 offen offset:2048 sc1
  s_sleep 1
Ltrig_184:
  s_sub_u32 s24, s24, 1
  s_cbranch_scc1 L_FAIL
  buffer_load_dword v79, v90, s[4:7], 0 offen offset:2048 sc1
  s_nop 0
  s_waitcnt vmcnt(3)
  v_cmp_gt_i32_e64 vcc, s25, v76
  s_cbranch_vccz Ltrigd_185
  buffer_load_dword v76, v90, s[4:7], 0 offen offset:2048 sc1
  s_waitcnt vmcnt(3)
  v_cmp_gt_i32 vcc, s25, v77
  s_cbranch_vccz Ltrigd_185
  buffer_load_dword v77, v90, s[4:7], 0 offen offset:2048 sc1
  s_waitcnt vmcnt(3)
  v_cmp_gt_i32 vcc, s25, v78
  s_cbranch_vccz Ltrigd_185
  buffer_load_dword v78, v90, s[4:7], 0 offen offset:2048 sc1
  s_waitcnt vmcnt(3)
  v_cmp_gt_i32_e64 vcc, s25, v79
  s_cbranch_vccnz Ltrig_184
Ltrigd_185:
  s_mov_b64 exec, -1
L_VOO_again:
  buffer_load_dwordx4 v[4:7], v111, s[4:7], s30 offen sc1
  s_nop 0
  buffer_load_dwordx4 v[8:11], v112, s[4:7], s30 offen sc1
  s_nop 0
  buffer_load_dwordx4 v[12:15], v113, s[4:7], s30 offen sc1
  s_nop 0
  buffer_load_dwordx4 v[16:19], v114, s[4:7], s30 offen sc1
  s_nop 0
  buffer_load_dwordx4 v[68:71], v111, s[4:7], s31 offen sc1
  s_nop 0
  buffer_load_dwordx4 v[72:75], v112, s[4:7], s31 offen sc1
  s_nop 0
  s_nop 0
  s_waitcnt vmcnt(5)
  v_cmp_eq_u32_e64 vcc, -1, v4
  s_cbranch_vccnz L_VOO_g0
L_VOO_ok0:
  buffer_load_dwordx4 v[96:99], v113, s[4:7], s31 offen sc1
  v_smfmac_f32_16x16x64_bf16 v[60:63], v[4:7], a[0:7], v88
  s_waitcnt vmcnt(5)
  v_cmp_eq_u32 vcc, -1, v8
  v_smfmac_f32_16x16x64_bf16 v[64:67], v[4:7], a[8:15], v88
  s_cbranch_vccnz L_VOO_g1
L_VOO_ok1:
  buffer_load_dwordx4 v[4:7], v114, s[4:7], s31 offen sc1
  v_smfmac_f32_16x16x64_bf16 v[60:63], v[8:11], a[16:23], v88
  s_waitcnt vmcnt(5)
  v_cmp_eq_u32 vcc, -1, v12
  v_smfmac_f32_16x16x64_bf16 v[64:67], v[8:11], a[24:31], v88
  s_cbranch_vccnz L_VOO_g2
L_VOO_ok2:
  buffer_load_dwordx4 v[8:11], v111, s[4:7], s32 offen sc1
  v_smfmac_f32_16x16x64_bf16 v[60:63], v[12:15], a[32:39], v88
  s_waitcnt vmcnt(5)
  v_cmp_eq_u32 vcc, -1, v16
  v_smfmac_f32_16x16x64_bf16 v[64:67], v[12:15], a[40:47], v88
  s_cbranch_vccnz L_VOO_g3
L_VOO_ok3:
  buffer_load_dwordx4 v[12:15], v112, s[4:7], s32 offen sc1
  v_smfmac_f32_16x16x64_bf16 v[60:63], v[16:19], a[48:55], v88
  s_waitcnt vmcnt(5)
  v_cmp_eq_u32 vcc, -1, v68
  v_smfmac_f32_16x16x64_bf16 v[64:67], v[16:19], a[56:63], v88
  s_cbranch_vccnz L_VOO_g4
L_VOO_ok4:
  buffer_load_dwordx4 v[16:19], v113, s[4:7], s32 offen sc1
  v_smfmac_f32_16x16x64_bf16 v[60:63], v[68:71], a[64:71], v88
  s_waitcnt vmcnt(5)
  v_cmp_eq_u32 vcc, -1, v72
  v_smfmac_f32_16x16x64_bf16 v[64:67], v[68:71], a[72:79], v88
  s_cbranch_vccnz L_VOO_g5
L_VOO_ok5:
  buffer_load_dwordx4 v[68:71], v114, s[4:7], s32 offen sc1
  v_smfmac_f32_16x16x64_bf16 v[60:63], v[72:75], a[80:87], v88
  s_nop 0
  s_waitcnt vmcnt(5)
  v_cmp_eq_u32_e64 vcc, -1, v96
  v_smfmac_f32_16x16x64_bf16 v[64:67], v[72:75], a[88:95], v88
  s_cbranch_vccnz L_VOO_g6
L_VOO_ok6:
  buffer_load_dwordx4 v[72:75], v111, s[4:7], s48 offen sc1
  v_smfmac_f32_16x16x64_bf16 v[60:63], v[96:99], a[96:103], v88
  s_waitcnt vmcnt(5)
  v_cmp_eq_u32 vcc, -1, v4
  v_smfmac_f32_16x16x64_bf16 v[64:67], v[96:99], a[104:111], v88
  s_cbranch_vccnz L_VOO_g7
L_VOO_ok7:
  buffer_load_dwordx4 v[96:99], v112, s[4:7], s48 offen sc1
  v_smfmac_f32_16x16x64_bf16 v[60:63], v[4:7], a[112:119], v88
  s_waitcnt vmcnt(5)
  v_cmp_eq_u32 vcc, -1, v8
  v_smfmac_f32_16x16x64_bf16 v[64:67], v[4:7], a[120:127], v88
  s_cbranch_vccnz L_VOO_g8
L_VOO_ok8:
  buffer_load_dwordx4 v[4:7], v113, s[4:7], s48 offen sc1
  v_smfmac_f32_16x16x64_bf16 v[60:63], v[8:11], a[128:135], v88
  s_waitcnt vmcnt(5)
  v_cmp_eq_u32 vcc, -1, v12
  v_smfmac_f32_16x16x64_bf16 v[64:67], v[8:11], a[136:143], v88
  s_cbranch_vccnz L_VOO_g9
L_VOO_ok9:
  buffer_load_dwordx4 v[8:11], v114, s[4:7], s48 offen sc1
  v_smfmac_f32_16x16x64_bf16 v[60:63], v[12:15], a[144:151], v88
  s_waitcnt vmcnt(5)
  v_cmp_eq_u32 vcc, -1, v16
  v_smfmac_f32_16x16x64_bf16 v[64:67], v[12:15], a[152:159], v88
  s_cbranch_vccnz L_VOO_g10
L_VOO_ok10:
  v_smfmac_f32_16x16x64_bf16 v[60:63], v[16:19], a[160:167], v88
  s_waitcnt vmcnt(4)
  v_cmp_eq_u32 vcc, -1, v68
  v_smfmac_f32_16x16x64_bf16 v[64:67], v[16:19], a[168:175], v88
  s_cbranch_vccnz L_VOO_g11
L_VOO_ok11:
  v_smfmac_f32_16x16x64_bf16 v[60:63], v[68:71], a[176:183], v88
  s_waitcnt vmcnt(3)
  v_cmp_eq_u32 vcc, -1, v72
  v_smfmac_f32_16x16x64_bf16 v[64:67], v[68:71], a[184:191], v88
  s_cbranch_vccnz L_VOO_g12
L_VOO_ok12:
  v_smfmac_f32_16x16x64_bf16 v[60:63], v[72:75], a[192:199], v88
  s_waitcnt vmcnt(2)
  v_cmp_eq_u32 vcc, -1, v96
  v_smfmac_f32_16x16x64_bf16 v[64:67], v[72:75], a[200:207], v88
  s_cbranch_vccnz L_VOO_g13
L_VOO_ok13:
  v_smfmac_f32_16x16x64_bf16 v[60:63], v[96:99], a[208:215], v88
  s_waitcnt vmcnt(1)
  v_cmp_eq_u32 vcc, -1, v4
  v_smfmac_f32_16x16x64_bf16 v[64:67], v[96:99], a[216:223], v88
  s_cbranch_vccnz L_VOO_g14
L_VOO_ok14:
  v_smfmac_f32_16x16x64_bf16 v[60:63], v[4:7], a[224:231], v88
  s_waitcnt vmcnt(0)
  v_cmp_eq_u32_e64 vcc, -1, v8
  v_smfmac_f32_16x16x64_bf16 v[64:67], v[4:7], a[232:239], v88
  s_cbranch_vccnz L_VOO_g15
L_VOO_ok15:
  v_smfmac_f32_16x16x64_bf16 v[60:63], v[8:11], a[240:247], v88
  v_smfmac_f32_16x16x64_bf16 v[64:67], v[8:11], a[248:255], v88
L_VOO_join:
  s_nop 6
  v_add_f32 v100, v60, v62
  v_add_f32 v101, v64, v66
  v_add_f32 v102, v61, v63
  v_add_f32 v103, v65, v67
  ds_write_b64 v95, v[100:101]
  ds_write_b64 v95, v[102:103] offset:2048
  buffer_store_dword v94, v91, s[4:7], s57 offen
  v_cmp_u_f32 vcc, v100, v102
  s_cbranch_vccnz L_VOO_nan
L_VOO_done:
  s_waitcnt lgkmcnt(0)
  s_barrier
  ds_read_b128 v[100:103], v108
  ds_read_b128 v[104:107], v109
  s_waitcnt lgkmcnt(1)
  v_pk_add_f32 v[100:101], v[100:101], v[102:103]
  s_waitcnt lgkmcnt(0)
  v_pk_add_f32 v[104:105], v[104:105], v[106:107]
  v_pk_add_f32 v[100:101], v[100:101], v[104:105]
  v_cvt_pk_bf16_f32 v100, v100, v101
  buffer_store_dword v100, v110, s[4:7], s49 offen
  buffer_store_dword v100, v110, s[4:7], s33 offen sc1
  s_add_u32 s25, s25, 1
  s_branch L_VO_top
L_VO_end:
  s_branch L_END
L_VO_bad:
  s_nop 7
  s_sub_u32 s24, s24, 1
  s_cbranch_scc1 L_FAIL
  s_add_u32 s60, s60, 1
  v_mov_b64 v[52:53], 0
  v_mov_b64 v[54:55], 0
  v_mov_b64 v[56:57], 0
  v_mov_b64 v[58:59], 0
  s_nop 1
  s_branch L_VO_retry
L_VO_rbad:
  s_sub_u32 s24, s24, 1
  s_cbranch_scc1 L_FAIL
  s_add_u32 s60, s60, 0x10000
  s_waitcnt lgkmcnt(0)
  buffer_load_dwordx4 v[68:71], v87, s[4:7], s27 offen offset:0 sc1
  buffer_load_dwordx4 v[72:75], v87, s[4:7], s27 offen offset:2048 sc1
  s_waitcnt vmcnt(0)
  ds_write_b128 v1, v[68:71] offset:2048
  ds_write_b128 v1, v[72:75] offset:3072
  v_max3_u32 v89, v68, v69, v70
  v_max3_u32 v89, v70, v71, v89
  v_max3_u32 v89, v72, v73, v89
  v_max3_u32 v89, v74, v75, v89
  v_cmp_eq_u32 vcc, -1, v89
  s_waitcnt lgkmcnt(0)
  s_cbranch_vccnz L_VO_rbad
  s_branch L_VO_rok
L_VOO_nan:
  s_cmp_eq_u32 s51, s25
  s_cbranch_scc1 L_VOO_done
  s_mov_b32 s51, s25
  s_add_u32 s61, s61, 0x10000
  s_waitcnt vmcnt(0) lgkmcnt(0)
L_VOO_v0:
  s_sub_u32 s24, s24, 1
  s_cbranch_scc1 L_FAIL
  buffer_load_dwordx4 v[4:7], v111, s[4:7], s30 offen sc1
  buffer_load_dwordx4 v[8:11], v112, s[4:7], s30 offen sc1
  buffer_load_dwordx4 v[12:15], v113, s[4:7], s30 offen sc1
  buffer_load_dwordx4 v[16:19], v114, s[4:7], s30 offen sc1
  v_mov_b32 v89, 0
  s_waitcnt vmcnt(0)
  v_max3_u32 v89, v4, v5, v89
  v_max3_u32 v89, v6, v7, v89
  v_max3_u32 v89, v8, v9, v89
  v_max3_u32 v89, v10, v11, v89
  v_max3_u32 v89, v12, v13, v89
  v_max3_u32 v89, v14, v15, v89
  v_max3_u32 v89, v16, v17, v89
  v_max3_u32 v89, v18, v19, v89
  v_cmp_eq_u32 vcc, -1, v89
  s_cbranch_vccnz L_VOO_v0
L_VOO_v4:
  s_sub_u32 s24, s24, 1
  s_cbranch_scc1 L_FAIL
  buffer_load_dwordx4 v[68:71], v111, s[4:7], s31 offen sc1
  buffer_load_dwordx4 v[72:75], v112, s[4:7], s31 offen sc1
  buffer_load_dwordx4 v[96:99], v113, s[4:7], s31 offen sc1
  buffer_load_dwordx4 v[4:7], v114, s[4:7], s31 offen sc1
  v_mov_b32 v89, 0
  s_waitcnt vmcnt(0)
  v_max3_u32 v89, v68, v69, v89
  v_max3_u32 v89, v70, v71, v89
  v_max3_u32 v89, v72, v73, v89
  v_max3_u32 v89, v74, v75, v89
  v_max3_u32 v89, v96, v97, v89
  v_max3_u32 v89, v98, v99, v89
  v_max3_u32 v89, v4, v5, v89
  v_max3_u32 v89, v6, v7, v89
  v_cmp_eq_u32 vcc, -1, v89
  s_cbranch_vccnz L_VOO_v4
L_VOO_v8:
  s_sub_u32 s24, s24, 1
  s_cbranch_scc1 L_FAIL
  buffer_load_dwordx4 v[8:11], v111, s[4:7], s32 offen sc1
  buffer_load_dwordx4 v[12:15], v112, s[4:7], s32 offen sc1
  buffer_load_dwordx4 v[16:19], v113, s[4:7], s32 offen sc1
  buffer_load_dwordx4 v[68:71], v114, s[4:7], s32 offen sc1
  v_mov_b32 v89, 0
  s_waitcnt vmcnt(0)
  v_max3_u32 v89, v8, v9, v89
  v_max3_u32 v89, v10, v11, v89
  v_max3_u32 v89, v12, v13, v89
  v_max3_u32 v89, v14, v15, v89
  v_max3_u32 v89, v16, v17, v89
  v_max3_u32 v89, v18, v19, v89
  v_max3_u32 v89, v68, v69, v89
  v_max3_u32 v89, v70, v71, v89
  v_cmp_eq_u32 vcc, -1, v89
  s_cbranch_vccnz L_VOO_v8
L_VOO_v12:
  s_sub_u32 s24, s24, 1
  s_cbranch_scc1 L_FAIL
  buffer_load_dwordx4 v[72:75], v111, s[4:7], s48 offen sc1
  buffer_load_dwordx4 v[96:99], v112, s[4:7], s48 offen sc1
  buffer_load_dwordx4 v[4:7], v113, s[4:7], s48 offen sc1
  buffer_load_dwordx4 v[8:11], v114, s[4:7], s48 offen sc1
  v_mov_b32 v89, 0
  s_waitcnt vmcnt(0)
  v_max3_u32 v89, v72, v73, v89
  v_max3_u32 v89, v74, v75, v89
  v_max3_u32 v89, v96, v97, v89
  v_max3_u32 v89, v98, v99, v89
  v_max3_u32 v89, v4, v5, v89
  v_max3_u32 v89, v6, v7, v89
  v_max3_u32 v89, v8, v9, v89
  v_max3_u32 v89, v10, v11, v89
  v_cmp_eq_u32 vcc, -1, v89
  s_cbranch_vccnz L_VOO_v12
  v_mov_b64 v[60:61], 0
  v_mov_b64 v[62:63], 0
  v_mov_b64 v[64:65], 0
  v_mov_b64 v[66:67], 0
L_VOOS_again:
  buffer_load_dwordx4 v[4:7], v111, s[4:7], s30 offen sc1
  s_nop 0
  buffer_load_dwordx4 v[8:11], v112, s[4:7], s30 offen sc1
  s_nop 0
  buffer_load_dwordx4 v[12:15], v113, s[4:7], s30 offen sc1
  s_nop 0
  buffer_load_dwordx4 v[16:19], v114, s[4:7], s30 offen sc1
  s_nop 0
  buffer_load_dwordx4 v[68:71], v111, s[4:7], s31 offen sc1
  s_nop 0
  buffer_load_dwordx4 v[72:75], v112, s[4:7], s31 offen sc1
  s_nop 0
  s_waitcnt vmcnt(5)
  buffer_load_dwordx4 v[96:99], v113, s[4:7], s31 offen sc1
  v_smfmac_f32_16x16x64_bf16 v[60:63], v[4:7], a[0:7], v88
  s_waitcnt vmcnt(5)
  v_smfmac_f32_16x16x64_bf16 v[64:67], v[4:7], a[8:15], v88
  buffer_load_dwordx4 v[4:7], v114, s[4:7], s31 offen sc1
  v_smfmac_f32_16x16x64_bf16 v[60:63], v[8:11], a[16:23], v88
  s_waitcnt vmcnt(5)
  v_smfmac_f32_16x16x64_bf16 v[64:67], v[8:11], a[24:31], v88
  buffer_load_dwordx4 v[8:11], v111, s[4:7], s32 offen sc1
  v_smfmac_f32_16x16x64_bf16 v[60:63], v[12:15], a[32:39], v88
  s_waitcnt vmcnt(5)
  v_smfmac_f32_16x16x64_bf16 v[64:67], v[12:15], a[40:47], v88
  buffer_load_dwordx4 v[12:15], v112, s[4:7], s32 offen sc1
  v_smfmac_f32_16x16x64_bf16 v[60:63], v[16:19], a[48:55], v88
  s_waitcnt vmcnt(5)
  v_smfmac_f32_16x16x64_bf16 v[64:67], v[16:19], a[56:63], v88
  buffer_load_dwordx4 v[16:19], v113, s[4:7], s32 offen sc1
  v_smfmac_f32_16x16x64_bf16 v[60:63], v[68:71], a[64:71], v88
  s_waitcnt vmcnt(5)
  v_smfmac_f32_16x16x64_bf16 v[64:67], v[68:71], a[72:79], v88
  buffer_load_dwordx4 v[68:71], v114, s[4:7], s32 offen sc1
  v_smfmac_f32_16x16x64_bf16 v[60:63], v[72:75], a[80:87], v88
  s_waitcnt vmcnt(5)
  v_smfmac_f32_16x16x64_bf16 v[64:67], v[72:75], a[88:95], v88
  buffer_load_dwordx4 v[72:75], v111, s[4:7], s48 offen sc1
  v_smfmac_f32_16x16x64_bf16 v[60:63], v[96:99], a[96:103], v88
  s_waitcnt vmcnt(5)
  v_smfmac_f32_16x16x64_bf16 v[64:67], v[96:99], a[104:111], v88
  buffer_load_dwordx4 v[96:99], v112, s[4:7], s48 offen sc1
  v_smfmac_f32_16x16x64_bf16 v[60:63], v[4:7], a[112:119], v88
  s_waitcnt vmcnt(5)
  v_smfmac_f32_16x16x64_bf16 v[64:67], v[4:7], a[120:127], v88
  buffer_load_dwordx4 v[4:7], v113, s[4:7], s48 offen sc1
  v_smfmac_f32_16x16x64_bf16 v[60:63], v[8:11], a[128:135], v88
  s_waitcnt vmcnt(5)
  v_smfmac_f32_16x16x64_bf16 v[64:67], v[8:11], a[136:143], v88
  buffer_load_dwordx4 v[8:11], v114, s[4:7], s48 offen sc1
  v_smfmac_f32_16x16x64_bf16 v[60:63], v[12:15], a[144:151], v88
  s_waitcnt vmcnt(5)
  v_smfmac_f32_16x16x64_bf16 v[64:67], v[12:15], a[152:159], v88
  v_smfmac_f32_16x16x64_bf16 v[60:63], v[16:19], a[160:167], v88
  s_waitcnt vmcnt(4)
  v_smfmac_f32_16x16x64_bf16 v[64:67], v[16:19], a[168:175], v88
  v_smfmac_f32_16x16x64_bf16 v[60:63], v[68:71], a[176:183], v88
  s_waitcnt vmcnt(3)
  v_smfmac_f32_16x16x64_bf16 v[64:67], v[68:71], a[184:191], v88
  v_smfmac_f32_16x16x64_bf16 v[60:63], v[72:75], a[192:199], v88
  s_waitcnt vmcnt(2)
  v_smfmac_f32_16x16x64_bf16 v[64:67], v[72:75], a[200:207], v88
  v_smfmac_f32_16x16x64_bf16 v[60:63], v[96:99], a[208:215], v88
  s_waitcnt vmcnt(1)
  v_smfmac_f32_16x16x64_bf16 v[64:67], v[96:99], a[216:223], v88
  v_smfmac_f32_16x16x64_bf16 v[60:63], v[4:7], a[224:231], v88
  s_waitcnt vmcnt(0)
  v_smfmac_f32_16x16x64_bf16 v[64:67], v[4:7], a[232:239], v88
  v_smfmac_f32_16x16x64_bf16 v[60:63], v[8:11], a[240:247], v88
  v_smfmac_f32_16x16x64_bf16 v[64:67], v[8:11], a[248:255], v88
  s_nop 7
  s_branch L_VOO_join
L_VOO_g0:
  s_sub_u32 s24, s24, 1
  s_cbranch_scc1 L_FAIL
  s_add_u32 s61, s61, 1
  buffer_load_dwordx4 v[4:7], v111, s[4:7], s30 offen sc1
  s_waitcnt vmcnt(0)
  v_cmp_eq_u32 vcc, -1, v4
  s_cbranch_vccnz L_VOO_g0
  v_mov_b32 v89, 0
  v_max3_u32 v89, v8, v12, v89
  v_max3_u32 v89, v16, v68, v89
  v_max3_u32 v89, v72, v72, v89
  v_cmp_eq_u32 vcc, -1, v89
  s_cbranch_vccz L_VOO_ok0
  buffer_load_dwordx4 v[8:11], v112, s[4:7], s30 offen sc1
  s_nop 0
  buffer_load_dwordx4 v[12:15], v113, s[4:7], s30 offen sc1
  s_nop 0
  buffer_load_dwordx4 v[16:19], v114, s[4:7], s30 offen sc1
  s_nop 0
  buffer_load_dwordx4 v[68:71], v111, s[4:7], s31 offen sc1
  s_nop 0
  buffer_load_dwordx4 v[72:75], v112, s[4:7], s31 offen sc1
  s_nop 0
  s_branch L_VOO_ok0
L_VOO_g1:
  s_sub_u32 s24, s24, 1
  s_cbranch_scc1 L_FAIL
  s_add_u32 s61, s61, 1
  buffer_load_dwordx4 v[8:11], v112, s[4:7], s30 offen sc1
  s_waitcnt vmcnt(0)
  v_cmp_eq_u32 vcc, -1, v8
  s_cbranch_vccnz L_VOO_g1
  v_mov_b32 v89, 0
  v_max3_u32 v89, v12, v16, v89
  v_max3_u32 v89, v68, v72, v89
  v_max3_u32 v89, v96, v96, v89
  v_cmp_eq_u32 vcc, -1, v89
  s_cbranch_vccz L_VOO_ok1
  buffer_load_dwordx4 v[12:15], v113, s[4:7], s30 offen sc1
  s_nop 0
  buffer_load_dwordx4 v[16:19], v114, s[4:7], s30 offen sc1
  s_nop 0
  buffer_load_dwordx4 v[68:71], v111, s[4:7], s31 offen sc1
  s_nop 0
  buffer_load_dwordx4 v[72:75], v112, s[4:7], s31 offen sc1
  s_nop 0
  buffer_load_dwordx4 v[96:99], v113, s[4:7], s31 offen sc1
  s_nop 0
  s_branch L_VOO_ok1
L_VOO_g2:
  s_sub_u32 s24, s24, 1
  s_cbranch_scc1 L_FAIL
  s_add_u32 s61, s61, 1
  buffer_load_dwordx4 v[12:15], v113, s[4:7], s30 offen sc1
  s_waitcnt vmcnt(0)
  v_cmp_eq_u32 vcc, -1, v12
  s_cbranch_vccnz L_VOO_g2
  v_mov_b32 v89, 0
  v_max3_u32 v89, v16, v68, v89
  v_max3_u32 v89, v72, v96, v89
  v_max3_u32 v89, v4, v4, v89
  v_cmp_eq_u32 vcc, -1, v89
  s_cbranch_vccz L_VOO_ok2
  buffer_load_dwordx4 v[16:19], v114, s[4:7], s30 offen sc1
  s_nop 0
  buffer_load_dwordx4 v[68:71], v111, s[4:7], s31 offen sc1
  s_nop 0
  buffer_load_dwordx4 v[72:75], v112, s[4:7], s31 offen sc1
  s_nop 0
  buffer_load_dwordx4 v[96:99], v113, s[4:7], s31 offen sc1
  s_nop 0
  buffer_load_dwordx4 v[4:7], v114, s[4:7], s31 offen sc1
  s_nop 0
  s_branch L_VOO_ok2
L_VOO_g3:
  s_sub_u32 s24, s24, 1
  s_cbranch_scc1 L_FAIL
  s_add_u32 s61, s61, 1
  buffer_load_dwordx4 v[16:19], v114, s[4:7], s30 offen sc1
  s_waitcnt vmcnt(0)
  v_cmp_eq_u32 vcc, -1, v16
  s_cbranch_vccnz L_VOO_g3
  v_mov_b32 v89, 0
  v_max3_u32 v89, v68, v72, v89
  v_max3_u32 v89, v96, v4, v89
  v_max3_u32 v89, v8, v8, v89
  v_cmp_eq_u32 vcc, -1, v89
  s_cbranch_vccz L_VOO_ok3
  buffer_load_dwordx4 v[68:71], v111, s[4:7], s31 offen sc1
  s_nop 0
  buffer_load_dwordx4 v[72:75], v112, s[4:7], s31 offen sc1
  s_nop 0
  buffer_load_dwordx4 v[96:99], v113, s[4:7], s31 offen sc1
  s_nop 0
  buffer_load_dwordx4 v[4:7], v114, s[4:7], s31 offen sc1
  s_nop 0
  buffer_load_dwordx4 v[8:11], v111, s[4:7], s32 offen sc1
  s_nop 0
  s_branch L_VOO_ok3
L_VOO_g4:
  s_sub_u32 s24, s24, 1
  s_cbranch_scc1 L_FAIL
  s_add_u32 s61, s61, 1
  buffer_load_dwordx4 v[68:71], v111, s[4:7], s31 offen sc1
  s_waitcnt vmcnt(0)
  v_cmp_eq_u32 vcc, -1, v68
  s_cbranch_vccnz L_VOO_g4
  v_mov_b32 v89, 0
  v_max3_u32 v89, v72, v96, v89
  v_max3_u32 v89, v4, v8, v89
  v_max3_u32 v89, v12, v12, v89
  v_cmp_eq_u32 vcc, -1, v89
  s_cbranch_vccz L_VOO_ok4
  buffer_load_dwordx4 v[72:75], v112, s[4:7], s31 offen sc1
  s_nop 0
  buffer_load_dwordx4 v[96:99], v113, s[4:7], s31 offen sc1
  s_nop 0
  buffer_load_dwordx4 v[4:7], v114, s[4:7], s31 offen sc1
  s_nop 0
  buffer_load_dwordx4 v[8:11], v111, s[4:7], s32 offen sc1
  s_nop 0
  buffer_load_dwordx4 v[12:15], v112, s[4:7], s32 offen sc1
  s_nop 0
  s_branch L_VOO_ok4
L_VOO_g5:
  s_sub_u32 s24, s24, 1
  s_cbranch_scc1 L_FAIL
  s_add_u32 s61, s61, 1
  buffer_load_dwordx4 v[72:75], v112, s[4:7], s31 offen sc1
  s_waitcnt vmcnt(0)
  v_cmp_eq_u32 vcc, -1, v72
  s_cbranch_vccnz L_VOO_g5
  v_mov_b32 v89, 0
  v_max3_u32 v89, v96, v4, v89
  v_max3_u32 v89, v8, v12, v89
  v_max3_u32 v89, v16, v16, v89
  v_cmp_eq_u32 vcc, -1, v89
  s_cbranch_vccz L_VOO_ok5
  buffer_load_dwordx4 v[96:99], v113, s[4:7], s31 offen sc1
  s_nop 0
  buffer_load_dwordx4 v[4:7], v114, s[4:7], s31 offen sc1
  s_nop 0
  buffer_load_dwordx4 v[8:11], v111, s[4:7], s32 offen sc1
  s_nop 0
  buffer_load_dwordx4 v[12:15], v112, s[4:7], s32 offen sc1
  s_nop 0
  buffer_load_dwordx4 v[16:19], v113, s[4:7], s32 offen sc1
  s_nop 0
  s_branch L_VOO_ok5
L_VOO_g6:
  s_sub_u32 s24, s24, 1
  s_cbranch_scc1 L_FAIL
  s_add_u32 s61, s61, 1
  buffer_load_dwordx4 v[96:99], v113, s[4:7], s31 offen sc1
  s_waitcnt vmcnt(0)
  v_cmp_eq_u32 vcc, -1, v96
  s_cbranch_vccnz L_VOO_g6
  v_mov_b32 v89, 0
  v_max3_u32 v89, v4, v8, v89
  v_max3_u32 v89, v12, v16, v89
  v_max3_u32 v89, v68, v68, v89
  v_cmp_eq_u32 vcc, -1, v89
  s_cbranch_vccz L_VOO_ok6
  buffer_load_dwordx4 v[4:7], v114, s[4:7], s31 offen sc1
  s_nop 0
  buffer_load_dwordx4 v[8:11], v111, s[4:7], s32 offen sc1
  s_nop 0
  buffer_load_dwordx4 v[12:15], v112, s[4:7], s32 offen sc1
  s_nop 0
  buffer_load_dwordx4 v[16:19], v113, s[4:7], s32 offen sc1
  s_nop 0
  buffer_load_dwordx4 v[68:71], v114, s[4:7], s32 offen sc1
  s_nop 0
  s_branch L_VOO_ok6
L_VOO_g7:
  s_sub_u32 s24, s24, 1
  s_cbranch_scc1 L_FAIL
  s_add_u32 s61, s61, 1
  buffer_load_dwordx4 v[4:7], v114, s[4:7], s31 offen sc1
  s_waitcnt vmcnt(0)
  v_cmp_eq_u32 vcc, -1, v4
  s_cbranch_vccnz L_VOO_g7
  v_mov_b32 v89, 0
  v_max3_u32 v89, v8, v12, v89
  v_max3_u32 v89, v16, v68, v89
  v_max3_u32 v89, v72, v72, v89
  v_cmp_eq_u32 vcc, -1, v89
  s_cbranch_vccz L_VOO_ok7
  buffer_load_dwordx4 v[8:11], v111, s[4:7], s32 offen sc1
  s_nop 0
  buffer_load_dwordx4 v[12:15], v112, s[4:7], s32 offen sc1
  s_nop 0
  buffer_load_dwordx4 v[16:19], v113, s[4:7], s32 offen sc1
  s_nop 0
  buffer_load_dwordx4 v[68:71], v114, s[4:7], s32 offen sc1
  s_nop 0
  buffer_load_dwordx4 v[72:75], v111, s[4:7], s48 offen sc1
  s_nop 0
  s_branch L_VOO_ok7
L_VOO_g8:
  s_sub_u32 s24, s24, 1
  s_cbranch_scc1 L_FAIL
  s_add_u32 s61, s61, 256
  buffer_load_dwordx4 v[8:11], v111, s[4:7], s32 offen sc1
  s_waitcnt vmcnt(0)
  v_cmp_eq_u32 vcc, -1, v8
  s_cbranch_vccnz L_VOO_g8
  v_mov_b32 v89, 0
  v_max3_u32 v89, v12, v16, v89
  v_max3_u32 v89, v68, v72, v89
  v_max3_u32 v89, v96, v96, v89
  v_cmp_eq_u32 vcc, -1, v89
  s_cbranch_vccz L_VOO_ok8
  buffer_load_dwordx4 v[12:15], v112, s[4:7], s32 offen sc1
  s_nop 0
  buffer_load_dwordx4 v[16:19], v113, s[4:7], s32 offen sc1
  s_nop 0
  buffer_load_dwordx4 v[68:71], v114, s[4:7], s32 offen sc1
  s_nop 0
  buffer_load_dwordx4 v[72:75], v111, s[4:7], s48 offen sc1
  s_nop 0
  buffer_load_dwordx4 v[96:99], v112, s[4:7], s48 offen sc1
  s_nop 0
  s_branch L_VOO_ok8
L_VOO_g9:
  s_sub_u32 s24, s24, 1
  s_cbranch_scc1 L_FAIL
  s_add_u32 s61, s61, 256
  buffer_load_dwordx4 v[12:15], v112, s[4:7], s32 offen sc1
  s_waitcnt vmcnt(0)
  v_cmp_eq_u32 vcc, -1, v12
  s_cbranch_vccnz L_VOO_g9
  v_mov_b32 v89, 0
  v_max3_u32 v89, v16, v68, v89
  v_max3_u32 v89, v72, v96, v89
  v_max3_u32 v89, v4, v4, v89
  v_cmp_eq_u32 vcc, -1, v89
  s_cbranch_vccz L_VOO_ok9
  buffer_load_dwordx4 v[16:19], v113, s[4:7], s32 offen sc1
  s_nop 0
  buffer_load_dwordx4 v[68:71], v114, s[4:7], s32 offen sc1
  s_nop 0
  buffer_load_dwordx4 v[72:75], v111, s[4:7], s48 offen sc1
  s_nop 0
  buffer_load_dwordx4 v[96:99], v112, s[4:7], s48 offen sc1
  s_nop 0
  buffer_load_dwordx4 v[4:7], v113, s[4:7], s48 offen sc1
  s_nop 0
  s_branch L_VOO_ok9
L_VOO_g10:
  s_sub_u32 s24, s24, 1
  s_cbranch_scc1 L_FAIL
  s_add_u32 s61, s61, 256
  buffer_load_dwordx4 v[16:19], v113, s[4:7], s32 offen sc1
  s_waitcnt vmcnt(0)
  v_cmp_eq_u32 vcc, -1, v16
  s_cbranch_vccnz L_VOO_g10
  v_mov_b32 v89, 0
  v_max3_u32 v89, v68, v72, v89
  v_max3_u32 v89, v96, v4, v89
  v_max3_u32 v89, v8, v8, v89
  v_cmp_eq_u32 vcc, -1, v89
  s_cbranch_vccz L_VOO_ok10
  buffer_load_dwordx4 v[68:71], v114, s[4:7], s32 offen sc1
  s_nop 0
  buffer_load_dwordx4 v[72:75], v111, s[4:7], s48 offen sc1
  s_nop 0
  buffer_load_dwordx4 v[96:99], v112, s[4:7], s48 offen sc1
  s_nop 0
  buffer_load_dwordx4 v[4:7], v113, s[4:7], s48 offen sc1
  s_nop 0
  buffer_load_dwordx4 v[8:11], v114, s[4:7], s48 offen sc1
  s_nop 0
  s_branch L_VOO_ok10
L_VOO_g11:
  s_sub_u32 s24, s24, 1
  s_cbranch_scc1 L_FAIL
  s_add_u32 s61, s61, 256
  buffer_load_dwordx4 v[68:71], v114, s[4:7], s32 offen sc1
  s_waitcnt vmcnt(0)
  v_cmp_eq_u32 vcc, -1, v68
  s_cbranch_vccnz L_VOO_g11
  v_mov_b32 v89, 0
  v_max3_u32 v89, v72, v96, v89
  v_max3_u32 v89, v4, v8, v89
  v_cmp_eq_u32 vcc, -1, v89
  s_cbranch_vccz L_VOO_ok11
  buffer_load_dwordx4 v[72:75], v111, s[4:7], s48 offen sc1
  s_nop 0
  buffer_load_dwordx4 v[96:99], v112, s[4:7], s48 offen sc1
  s_nop 0
  buffer_load_dwordx4 v[4:7], v113, s[4:7], s48 offen sc1
  s_nop 0
  buffer_load_dwordx4 v[8:11], v114, s[4:7], s48 offen sc1
  s_nop 0
  s_branch L_VOO_ok11
L_VOO_g12:
  s_sub_u32 s24, s24, 1
  s_cbranch_scc1 L_FAIL
  s_add_u32 s61, s61, 256
  buffer_load_dwordx4 v[72:75], v111, s[4:7], s48 offen sc1
  s_waitcnt vmcnt(0)
  v_cmp_eq_u32 vcc, -1, v72
  s_cbranch_vccnz L_VOO_g12
  v_mov_b32 v89, 0
  v_max3_u32 v89, v96, v4, v89
  v_max3_u32 v89, v8, v8, v89
  v_cmp_eq_u32 vcc, -1, v89
  s_cbranch_vccz L_VOO_ok12
  buffer_load_dwordx4 v[96:99], v112, s[4:7], s48 offen sc1
  s_nop 0
  buffer_load_dwordx4 v[4:7], v113, s[4:7], s48 offen sc1
  s_nop 0
  buffer_load_dwordx4 v[8:11], v114, s[4:7], s48 offen sc1
  s_nop 0
  s_branch L_VOO_ok12
L_VOO_g13:
  s_sub_u32 s24, s24, 1
  s_cbranch_scc1 L_FAIL
  s_add_u32 s61, s61, 256
  buffer_load_dwordx4 v[96:99], v112, s[4:7], s48 offen sc1
  s_waitcnt vmcnt(0)
  v_cmp_eq_u32 vcc, -1, v96
  s_cbranch_vccnz L_VOO_g13
  v_mov_b32 v89, 0
  v_max3_u32 v89, v4, v8, v89
  v_cmp_eq_u32 vcc, -1, v89
  s_cbranch_vccz L_VOO_ok13
  buffer_load_dwordx4 v[4:7], v113, s[4:7], s48 offen sc1
  s_nop 0
  buffer_load_dwordx4 v[8:11], v114, s[4:7], s48 offen sc1
  s_nop 0
  s_branch L_VOO_ok13
L_VOO_g14:
  s_sub_u32 s24, s24, 1
  s_cbranch_scc1 L_FAIL
  s_add_u32 s61, s61, 256
  buffer_load_dwordx4 v[4:7], v113, s[4:7], s48 offen sc1
  s_waitcnt vmcnt(0)
  v_cmp_eq_u32 vcc, -1, v4
  s_cbranch_vccnz L_VOO_g14
  v_mov_b32 v89, 0
  v_max3_u32 v89, v8, v8, v89
  v_cmp_eq_u32 vcc, -1, v89
  s_cbranch_vccz L_VOO_ok14
  buffer_load_dwordx4 v[8:11], v114, s[4:7], s48 offen sc1
  s_nop 0
  s_branch L_VOO_ok14
L_VOO_g15:
  s_sub_u32 s24, s24, 1
  s_cbranch_scc1 L_FAIL
  s_add_u32 s61, s61, 256
  buffer_load_dwordx4 v[8:11], v114, s[4:7], s48 offen sc1
  s_waitcnt vmcnt(0)
  v_cmp_eq_u32 vcc, -1, v8
  s_cbranch_vccnz L_VOO_g15
  s_branch L_VOO_ok15
L_LAST:
  s_endpgm
.section .rodata,"a"
.p2align 6
.amdhsa_kernel adaLN_cond__memory_aug_recurrent_mem_tr__glu_gated_swiglu__prompt_kernel
  .amdhsa_next_free_vgpr 512
  .amdhsa_next_free_sgpr 102
  .amdhsa_accum_offset 256
  .amdhsa_group_segment_fixed_size 0
  .amdhsa_kernarg_size 128
  .amdhsa_user_sgpr_count 2
  .amdhsa_user_sgpr_kernarg_segment_ptr 1
  .amdhsa_system_sgpr_workgroup_id_x 1
  .amdhsa_float_denorm_mode_32 3
.end_amdhsa_kernel
```

```asm
; @launch grid=(256,1,1) block=(256,1,1) lds=163840
.amdgcn_target "amdgcn-amd-amdhsa--gfx950"
.text
.globl adaLN_cond__memory_aug_recurrent_mem_tr__glu_gated_swiglu__prompt_kernel
.p2align 8
.type adaLN_cond__memory_aug_recurrent_mem_tr__glu_gated_swiglu__prompt_kernel,@function
adaLN_cond__memory_aug_recurrent_mem_tr__glu_gated_swiglu__prompt_kernel:
  s_cmp_ge_u32 s2, 256
  s_cbranch_scc1 L_END
  s_load_dwordx2 s[4:5], s[0:1], 120
  s_load_dwordx2 s[12:13], s[0:1], 112
  v_lshrrev_b32 v1, 6, v0
  v_and_b32 v0, 63, v0
  v_readfirstlane_b32 s20, v1
  s_mov_b32 s6, 163610624
  s_mov_b32 s7, 0x20000
  s_mov_b32 s14, 256
  s_mov_b32 s15, 0x20000
  s_mov_b32 s24, 300000
  s_and_b32 s40, s2, 7
  s_mov_b32 s42, 0x3020100
  s_mov_b32 s43, 0x3020100
  s_cmp_eq_u32 s40, 1
  s_cselect_b32 s42, 0x1b161514, s42
  s_cselect_b32 s43, 0x1b1a1918, s43
  s_cmp_eq_u32 s40, 2
  s_cselect_b32 s42, 0xb0a0908, s42
  s_cselect_b32 s43, 0xb0a0908, s43
  s_cmp_eq_u32 s40, 3
  s_cselect_b32 s42, 0x1f1e1d1c, s42
  s_cselect_b32 s43, 0x1f1e1d1c, s43
  s_cmp_eq_u32 s40, 4
  s_cselect_b32 s42, 0x7060504, s42
  s_cselect_b32 s43, 0x7060504, s43
  s_cmp_eq_u32 s40, 5
  s_cselect_b32 s42, 0x13121110, s42
  s_cselect_b32 s43, 0x13121110, s43
  s_cmp_eq_u32 s40, 6
  s_cselect_b32 s42, 0xf0e0d0c, s42
  s_cselect_b32 s43, 0xf0e0d0c, s43
  s_cmp_eq_u32 s40, 7
  s_cselect_b32 s42, 0x1a191817, s42
  s_cselect_b32 s43, 0x17161514, s43
  s_lshr_b32 s40, s2, 6
  s_lshl_b32 s40, s40, 3
  s_lshr_b32 s42, s42, s40
  s_lshr_b32 s43, s43, s40
  s_bfe_u32 s41, s2, 0x30003
  s_and_b32 s42, s42, 31
  s_lshl_b32 s42, s42, 3
  s_add_u32 s3, s42, s41
  s_bfe_u32 s22, s43, 0x30002
  s_and_b32 s43, s43, 3
  s_lshl_b32 s43, s43, 3
  s_add_u32 s23, s43, s41
  s_waitcnt lgkmcnt(0)
  s_add_u32 s4, s4, 6291455
  s_addc_u32 s5, s5, 0
  s_and_b32 s4, s4, 0xffe00000
  s_cmp_lg_u32 s20, 3
  s_cbranch_scc1 L_NOPRE
  s_getpc_b64 s[40:41]
L_PC:
  s_lshr_b32 s42, s2, 3
  v_lshlrev_b32 v1, 12, v0
  s_lshl_b32 s42, s42, 7
  v_add_u32 v1, s42, v1
  v_min_u32 v1, L_LAST-L_PC, v1
  global_load_dword v255, v1, s[40:41]
L_NOPRE:
  s_cmp_ge_u32 s22, 4
  s_cbranch_scc1 L_TRAIL
  s_lshr_b32 s40, s22, 1
  s_bitcmp1_b32 s22, 0
  s_cbranch_scc0 L_REC
  s_lshl_b32 s40, s40, 5
  s_add_u32 s21, s40, s23
  s_branch L_QKV
L_REC:
  s_lshl_b32 s40, s40, 4
  s_lshr_b32 s41, s23, 1
  s_add_u32 s21, s40, s41
  s_bitcmp1_b32 s23, 0
  s_cbranch_scc1 L_VO
  s_branch L_QK
L_TRAIL:
  s_mov_b32 s21, s23
  s_cmp_eq_u32 s22, 6
  s_cbranch_scc1 L_MOD
  s_sub_u32 s40, s22, 4
  s_lshl_b32 s40, s40, 5
  s_add_u32 s21, s40, s23
  s_cmp_lg_u32 s22, 7
  s_cbranch_scc1 L_WOF
L_INIT:
  s_lshl_b32 s40, s23, 2
  s_add_u32 s40, s40, s20
  s_lshl_b32 s40, s40, 12
  s_add_u32 s41, s40, 1310720
  s_add_u32 s43, s40, 1900544
  s_add_u32 s42, s40, 0x80000
  v_lshlrev_b32 v1, 4, v0
  v_mov_b32 v4, -1
  v_mov_b32 v5, -1
  v_mov_b32 v6, -1
  v_mov_b32 v7, -1
  s_cmp_lt_u32 s23, 16
  s_cselect_b32 s41, s41, s43
  s_cmp_lt_u32 s23, 24
  s_cselect_b32 s41, s41, 2147483392
  buffer_store_dwordx4 v[4:7], v1, s[4:7], s41 offen offset:0 sc1
  buffer_store_dwordx4 v[4:7], v1, s[4:7], s41 offen offset:1024 sc1
  buffer_store_dwordx4 v[4:7], v1, s[4:7], s41 offen offset:2048 sc1
  buffer_store_dwordx4 v[4:7], v1, s[4:7], s41 offen offset:3072 sc1
  buffer_store_dwordx4 v[4:7], v1, s[4:7], s40 offen offset:0 sc1
  buffer_store_dwordx4 v[4:7], v1, s[4:7], s40 offen offset:1024 sc1
  buffer_store_dwordx4 v[4:7], v1, s[4:7], s40 offen offset:2048 sc1
  buffer_store_dwordx4 v[4:7], v1, s[4:7], s40 offen offset:3072 sc1
  buffer_store_dwordx4 v[4:7], v1, s[4:7], s42 offen offset:0 sc1
  buffer_store_dwordx4 v[4:7], v1, s[4:7], s42 offen offset:1024 sc1
  buffer_store_dwordx4 v[4:7], v1, s[4:7], s42 offen offset:2048 sc1
  buffer_store_dwordx4 v[4:7], v1, s[4:7], s42 offen offset:3072 sc1
  s_load_dwordx2 s[16:17], s[0:1], 8
  s_mov_b32 s18, 16384
  s_mov_b32 s19, 0x20000
  s_waitcnt lgkmcnt(0)
  s_and_b32 s40, s20, 1
  s_lshl_b32 s40, s40, 3
  v_bfe_u32 v8, v0, 2, 3
  v_add_u32 v8, s40, v8
  s_lshr_b32 s40, s20, 1
  s_lshl_b32 s40, s40, 3
  v_and_b32 v9, 3, v0
  v_add_u32 v9, s40, v9
  v_bfe_u32 v10, v8, 1, 1
  v_lshl_add_u32 v9, v10, 2, v9
  v_lshrrev_b32 v10, 2, v8
  v_and_b32 v11, 1, v8
  v_lshl_add_u32 v10, v10, 1, v11
  s_lshl_b32 s40, s23, 6
  v_lshl_add_u32 v10, v10, 11, s40
  v_lshl_add_u32 v10, v9, 1, v10
  buffer_load_ushort v11, v10, s[16:19], 0 offen
  buffer_load_ushort v12, v10, s[16:19], 0 offen offset:32
  s_bfe_u32 s41, s23, 0x10002
  s_mul_i32 s41, s41, 32768
  s_lshr_b32 s40, s23, 3
  s_lshl_b32 s40, s40, 11
  s_add_u32 s40, s40, s41
  s_and_b32 s41, s23, 3
  s_lshl_b32 s41, s41, 9
  s_add_u32 s40, s40, s41
  s_lshl_b32 s41, s20, 7
  s_add_u32 s40, s40, s41
  s_add_u32 s40, s40, 2097152
  s_add_u32 s41, s40, 0x4000
  v_and_b32 v8, 31, v0
  v_lshlrev_b32 v8, 2, v8
  v_lshrrev_b32 v9, 5, v0
  v_lshl_add_u32 v8, v9, 13, v8
  s_waitcnt vmcnt(0)
  v_lshl_or_b32 v11, v12, 16, v11
  v_min_u32 v11, -2, v11
  buffer_store_dword v11, v8, s[4:7], s40 offen sc1
  buffer_store_dword v11, v8, s[4:7], s41 offen sc1
  s_lshl_b32 s40, s23, 2
  s_add_u32 s40, s40, 128
  s_cmp_eq_u32 s20, 0
  s_cselect_b32 s40, s40, 2147483392
  v_mov_b32 v2, 2147483392
  s_mov_b64 exec, 1
  v_mov_b32 v2, s40
  s_mov_b64 exec, -1
  v_mov_b32 v3, 1
  s_waitcnt vmcnt(0)
  s_barrier
  buffer_store_dword v3, v2, s[12:15], 0 offen sc1
  s_branch L_LN1
L_MOD:
  s_load_dwordx2 s[16:17], s[0:1], 88
  s_mov_b32 s18, 2048
  s_mov_b32 s19, 0x20000
  s_waitcnt lgkmcnt(0)
  s_load_dwordx2 s[8:9], s[0:1], 96
  s_mov_b32 s10, 12582912
  s_mov_b32 s11, 0x20000
  s_waitcnt lgkmcnt(0)
  s_lshl_b32 s40, s20, 9
  v_lshl_add_u32 v1, v0, 3, s40
  buffer_load_dwordx2 v[8:9], v1, s[16:19], 0 offen
  v_bfe_u32 v2, v0, 5, 1
  v_mul_u32_u24 v2, 98304, v2
  v_bfe_u32 v3, v0, 4, 1
  v_mul_u32_u24 v3, 24576, v3
  v_add_u32 v2, v2, v3
  v_bfe_u32 v3, v0, 3, 1
  v_mul_u32_u24 v3, 12288, v3
  v_add_u32 v2, v2, v3
  v_lshrrev_b32 v3, 3, v0
  v_and_b32 v3, 6, v3
  v_xor_b32 v3, v3, v0
  v_and_b32 v3, 7, v3
  v_lshl_add_u32 v2, v3, 4, v2
  s_lshr_b32 s40, s20, 1
  s_mul_i32 s40, s40, 49152
  s_and_b32 s41, s20, 1
  s_mul_i32 s41, s41, 196608
  s_add_u32 s40, s40, s41
  s_lshl_b32 s41, s21, 7
  s_add_u32 s40, s40, s41
  v_add_u32 v2, s40, v2
  s_lshl_b32 s41, s20, 10
  s_add_u32 m0, s41, 0
  s_mov_b32 s42, 0
  buffer_load_dwordx4 v2, s[8:11], s42 offen nt lds
  s_add_u32 m0, s41, 4096
  s_mov_b32 s42, 393216
  buffer_load_dwordx4 v2, s[8:11], s42 offen nt lds
  s_add_u32 m0, s41, 8192
  s_mov_b32 s42, 786432
  buffer_load_dwordx4 v2, s[8:11], s42 offen nt lds
  s_add_u32 m0, s41, 12288
  s_mov_b32 s42, 1179648
  buffer_load_dwordx4 v2, s[8:11], s42 offen nt lds
  s_add_u32 m0, s41, 16384
  s_mov_b32 s42, 1572864
  buffer_load_dwordx4 v2, s[8:11], s42 offen nt lds
  s_add_u32 m0, s41, 20480
  s_mov_b32 s42, 1966080
  buffer_load_dwordx4 v2, s[8:11], s42 offen nt lds
  s_add_u32 m0, s41, 24576
  s_mov_b32 s42, 2359296
  buffer_load_dwordx4 v2, s[8:11], s42 offen nt lds
  s_add_u32 m0, s41, 28672
  s_mov_b32 s42, 2752512
  buffer_load_dwordx4 v2, s[8:11], s42 offen nt lds
  s_add_u32 m0, s41, 32768
  s_mov_b32 s42, 3145728
  buffer_load_dwordx4 v2, s[8:11], s42 offen nt lds
  s_add_u32 m0, s41, 36864
  s_mov_b32 s42, 3538944
  buffer_load_dwordx4 v2, s[8:11], s42 offen nt lds
  s_add_u32 m0, s41, 40960
  s_mov_b32 s42, 3932160
  buffer_load_dwordx4 v2, s[8:11], s42 offen nt lds
  s_add_u32 m0, s41, 45056
  s_mov_b32 s42, 4325376
  buffer_load_dwordx4 v2, s[8:11], s42 offen nt lds
  s_add_u32 m0, s41, 49152
  s_mov_b32 s42, 4718592
  buffer_load_dwordx4 v2, s[8:11], s42 offen nt lds
  s_add_u32 m0, s41, 53248
  s_mov_b32 s42, 5111808
  buffer_load_dwordx4 v2, s[8:11], s42 offen nt lds
  s_add_u32 m0, s41, 57344
  s_mov_b32 s42, 5505024
  buffer_load_dwordx4 v2, s[8:11], s42 offen nt lds
  s_add_u32 m0, s41, 61440
  s_mov_b32 s42, 5898240
  buffer_load_dwordx4 v2, s[8:11], s42 offen nt lds
  s_add_u32 m0, s41, 65536
  s_mov_b32 s42, 6291456
  buffer_load_dwordx4 v2, s[8:11], s42 offen nt lds
  s_add_u32 m0, s41, 69632
  s_mov_b32 s42, 6684672
  buffer_load_dwordx4 v2, s[8:11], s42 offen nt lds
  s_add_u32 m0, s41, 73728
  s_mov_b32 s42, 7077888
  buffer_load_dwordx4 v2, s[8:11], s42 offen nt lds
  s_add_u32 m0, s41, 77824
  s_mov_b32 s42, 7471104
  buffer_load_dwordx4 v2, s[8:11], s42 offen nt lds
  s_add_u32 m0, s41, 81920
  s_mov_b32 s42, 7864320
  buffer_load_dwordx4 v2, s[8:11], s42 offen nt lds
  s_add_u32 m0, s41, 86016
  s_mov_b32 s42, 8257536
  buffer_load_dwordx4 v2, s[8:11], s42 offen nt lds
  s_add_u32 m0, s41, 90112
  s_mov_b32 s42, 8650752
  buffer_load_dwordx4 v2, s[8:11], s42 offen nt lds
  s_add_u32 m0, s41, 94208
  s_mov_b32 s42, 9043968
  buffer_load_dwordx4 v2, s[8:11], s42 offen nt lds
  s_add_u32 m0, s41, 98304
  s_mov_b32 s42, 9437184
  buffer_load_dwordx4 v2, s[8:11], s42 offen nt lds
  s_add_u32 m0, s41, 102400
  s_mov_b32 s42, 9830400
  buffer_load_dwordx4 v2, s[8:11], s42 offen nt lds
  s_add_u32 m0, s41, 106496
  s_mov_b32 s42, 10223616
  buffer_load_dwordx4 v2, s[8:11], s42 offen nt lds
  s_add_u32 m0, s41, 110592
  s_mov_b32 s42, 10616832
  buffer_load_dwordx4 v2, s[8:11], s42 offen nt lds
  s_add_u32 m0, s41, 114688
  s_mov_b32 s42, 11010048
  buffer_load_dwordx4 v2, s[8:11], s42 offen nt lds
  s_add_u32 m0, s41, 118784
  s_mov_b32 s42, 11403264
  buffer_load_dwordx4 v2, s[8:11], s42 offen nt lds
  s_add_u32 m0, s41, 122880
  s_mov_b32 s42, 11796480
  buffer_load_dwordx4 v2, s[8:11], s42 offen nt lds
  s_add_u32 m0, s41, 126976
  s_mov_b32 s42, 12189696
  buffer_load_dwordx4 v2, s[8:11], s42 offen nt lds
  v_bfe_u32 v3, v0, 3, 2
  v_xor_b32 v3, s20, v3
  v_lshlrev_b32 v3, 5, v3
  v_lshrrev_b32 v4, 2, v0
  v_lshl_add_u32 v4, v4, 7, v3
  v_and_b32 v3, 3, v0
  v_lshl_add_u32 v4, v3, 3, v4
  v_add_u32 v5, 0x10000, v4
  v_lshrrev_b32 v6, 4, v0
  v_lshlrev_b32 v6, 4, v6
  v_add_u32 v6, 0x20000, v6
  v_add_u32 v1, 0x20000, v1
  s_mov_b32 s37, 0xbfb8aa3b
  s_waitcnt vmcnt(32)
  v_lshlrev_b32 v10, 16, v8
  v_and_b32 v11, 0xffff0000, v8
  v_lshlrev_b32 v12, 16, v9
  v_and_b32 v13, 0xffff0000, v9
  v_mul_f32 v14, s37, v10
  v_mul_f32 v15, s37, v11
  v_mul_f32 v16, s37, v12
  v_mul_f32 v17, s37, v13
  v_exp_f32 v14, v14
  v_exp_f32 v15, v15
  v_exp_f32 v16, v16
  v_exp_f32 v17, v17
  v_add_f32 v14, 1.0, v14
  v_add_f32 v15, 1.0, v15
  v_add_f32 v16, 1.0, v16
  v_add_f32 v17, 1.0, v17
  v_rcp_f32 v14, v14
  v_rcp_f32 v15, v15
  v_rcp_f32 v16, v16
  v_rcp_f32 v17, v17
  v_mul_f32 v10, v10, v14
  v_mul_f32 v11, v11, v15
  v_mul_f32 v12, v12, v16
  v_mul_f32 v13, v13, v17
  v_cvt_pk_bf16_f32 v8, v10, v11
  v_cvt_pk_bf16_f32 v9, v12, v13
  ds_write_b64 v1, v[8:9]
  s_waitcnt vmcnt(28) lgkmcnt(0)
  s_barrier
  ds_read_b64_tr_b16 v[24:25], v4 offset:0
  ds_read_b64_tr_b16 v[26:27], v4 offset:2048
  ds_read_b128 v[28:31], v6 offset:0
  ds_read_b64_tr_b16 v[32:33], v4 offset:4096
  ds_read_b64_tr_b16 v[34:35], v4 offset:6144
  ds_read_b128 v[36:39], v6 offset:64
  ds_read_b64_tr_b16 v[40:41], v4 offset:8192
  ds_read_b64_tr_b16 v[42:43], v4 offset:10240
  ds_read_b128 v[44:47], v6 offset:128
  ds_read_b64_tr_b16 v[48:49], v4 offset:12288
  ds_read_b64_tr_b16 v[50:51], v4 offset:14336
  ds_read_b128 v[52:55], v6 offset:192
  s_waitcnt lgkmcnt(9)
  v_mfma_f32_16x16x32_bf16 v[20:23], v[24:27], v[28:31], 0
  s_waitcnt lgkmcnt(6)
  v_mfma_f32_16x16x32_bf16 v[20:23], v[32:35], v[36:39], v[20:23]
  s_waitcnt lgkmcnt(3)
  v_mfma_f32_16x16x32_bf16 v[20:23], v[40:43], v[44:47], v[20:23]
  s_waitcnt lgkmcnt(0)
  v_mfma_f32_16x16x32_bf16 v[20:23], v[48:51], v[52:55], v[20:23]
  s_waitcnt vmcnt(24) lgkmcnt(0)
  s_barrier
  ds_read_b64_tr_b16 v[24:25], v4 offset:16384
  ds_read_b64_tr_b16 v[26:27], v4 offset:18432
  ds_read_b128 v[28:31], v6 offset:256
  ds_read_b64_tr_b16 v[32:33], v4 offset:20480
  ds_read_b64_tr_b16 v[34:35], v4 offset:22528
  ds_read_b128 v[36:39], v6 offset:320
  ds_read_b64_tr_b16 v[40:41], v4 offset:24576
  ds_read_b64_tr_b16 v[42:43], v4 offset:26624
  ds_read_b128 v[44:47], v6 offset:384
  ds_read_b64_tr_b16 v[48:49], v4 offset:28672
  ds_read_b64_tr_b16 v[50:51], v4 offset:30720
  ds_read_b128 v[52:55], v6 offset:448
  s_waitcnt lgkmcnt(9)
  v_mfma_f32_16x16x32_bf16 v[20:23], v[24:27], v[28:31], v[20:23]
  s_waitcnt lgkmcnt(6)
  v_mfma_f32_16x16x32_bf16 v[20:23], v[32:35], v[36:39], v[20:23]
  s_waitcnt lgkmcnt(3)
  v_mfma_f32_16x16x32_bf16 v[20:23], v[40:43], v[44:47], v[20:23]
  s_waitcnt lgkmcnt(0)
  v_mfma_f32_16x16x32_bf16 v[20:23], v[48:51], v[52:55], v[20:23]
  s_waitcnt vmcnt(20) lgkmcnt(0)
  s_barrier
  ds_read_b64_tr_b16 v[24:25], v4 offset:32768
  ds_read_b64_tr_b16 v[26:27], v4 offset:34816
  ds_read_b128 v[28:31], v6 offset:512
  ds_read_b64_tr_b16 v[32:33], v4 offset:36864
  ds_read_b64_tr_b16 v[34:35], v4 offset:38912
  ds_read_b128 v[36:39], v6 offset:576
  ds_read_b64_tr_b16 v[40:41], v4 offset:40960
  ds_read_b64_tr_b16 v[42:43], v4 offset:43008
  ds_read_b128 v[44:47], v6 offset:640
  ds_read_b64_tr_b16 v[48:49], v4 offset:45056
  ds_read_b64_tr_b16 v[50:51], v4 offset:47104
  ds_read_b128 v[52:55], v6 offset:704
  s_waitcnt lgkmcnt(9)
  v_mfma_f32_16x16x32_bf16 v[20:23], v[24:27], v[28:31], v[20:23]
  s_waitcnt lgkmcnt(6)
  v_mfma_f32_16x16x32_bf16 v[20:23], v[32:35], v[36:39], v[20:23]
  s_waitcnt lgkmcnt(3)
  v_mfma_f32_16x16x32_bf16 v[20:23], v[40:43], v[44:47], v[20:23]
  s_waitcnt lgkmcnt(0)
  v_mfma_f32_16x16x32_bf16 v[20:23], v[48:51], v[52:55], v[20:23]
  s_waitcnt vmcnt(16) lgkmcnt(0)
  s_barrier
  ds_read_b64_tr_b16 v[24:25], v4 offset:49152
  ds_read_b64_tr_b16 v[26:27], v4 offset:51200
  ds_read_b128 v[28:31], v6 offset:768
  ds_read_b64_tr_b16 v[32:33], v4 offset:53248
  ds_read_b64_tr_b16 v[34:35], v4 offset:55296
  ds_read_b128 v[36:39], v6 offset:832
  ds_read_b64_tr_b16 v[40:41], v4 offset:57344
  ds_read_b64_tr_b16 v[42:43], v4 offset:59392
  ds_read_b128 v[44:47], v6 offset:896
  ds_read_b64_tr_b16 v[48:49], v4 offset:61440
  ds_read_b64_tr_b16 v[50:51], v4 offset:63488
  ds_read_b128 v[52:55], v6 offset:960
  s_waitcnt lgkmcnt(9)
  v_mfma_f32_16x16x32_bf16 v[20:23], v[24:27], v[28:31], v[20:23]
  s_waitcnt lgkmcnt(6)
  v_mfma_f32_16x16x32_bf16 v[20:23], v[32:35], v[36:39], v[20:23]
  s_waitcnt lgkmcnt(3)
  v_mfma_f32_16x16x32_bf16 v[20:23], v[40:43], v[44:47], v[20:23]
  s_waitcnt lgkmcnt(0)
  v_mfma_f32_16x16x32_bf16 v[20:23], v[48:51], v[52:55], v[20:23]
  s_waitcnt vmcnt(12) lgkmcnt(0)
  s_barrier
  ds_read_b64_tr_b16 v[24:25], v5 offset:0
  ds_read_b64_tr_b16 v[26:27], v5 offset:2048
  ds_read_b128 v[28:31], v6 offset:1024
  ds_read_b64_tr_b16 v[32:33], v5 offset:4096
  ds_read_b64_tr_b16 v[34:35], v5 offset:6144
  ds_read_b128 v[36:39], v6 offset:1088
  ds_read_b64_tr_b16 v[40:41], v5 offset:8192
  ds_read_b64_tr_b16 v[42:43], v5 offset:10240
  ds_read_b128 v[44:47], v6 offset:1152
  ds_read_b64_tr_b16 v[48:49], v5 offset:12288
  ds_read_b64_tr_b16 v[50:51], v5 offset:14336
  ds_read_b128 v[52:55], v6 offset:1216
  s_waitcnt lgkmcnt(9)
  v_mfma_f32_16x16x32_bf16 v[20:23], v[24:27], v[28:31], v[20:23]
  s_waitcnt lgkmcnt(6)
  v_mfma_f32_16x16x32_bf16 v[20:23], v[32:35], v[36:39], v[20:23]
  s_waitcnt lgkmcnt(3)
  v_mfma_f32_16x16x32_bf16 v[20:23], v[40:43], v[44:47], v[20:23]
  s_waitcnt lgkmcnt(0)
  v_mfma_f32_16x16x32_bf16 v[20:23], v[48:51], v[52:55], v[20:23]
  s_waitcnt vmcnt(8) lgkmcnt(0)
  s_barrier
  ds_read_b64_tr_b16 v[24:25], v5 offset:16384
  ds_read_b64_tr_b16 v[26:27], v5 offset:18432
  ds_read_b128 v[28:31], v6 offset:1280
  ds_read_b64_tr_b16 v[32:33], v5 offset:20480
  ds_read_b64_tr_b16 v[34:35], v5 offset:22528
  ds_read_b128 v[36:39], v6 offset:1344
  ds_read_b64_tr_b16 v[40:41], v5 offset:24576
  ds_read_b64_tr_b16 v[42:43], v5 offset:26624
  ds_read_b128 v[44:47], v6 offset:1408
  ds_read_b64_tr_b16 v[48:49], v5 offset:28672
  ds_read_b64_tr_b16 v[50:51], v5 offset:30720
  ds_read_b128 v[52:55], v6 offset:1472
  s_waitcnt lgkmcnt(9)
  v_mfma_f32_16x16x32_bf16 v[20:23], v[24:27], v[28:31], v[20:23]
  s_waitcnt lgkmcnt(6)
  v_mfma_f32_16x16x32_bf16 v[20:23], v[32:35], v[36:39], v[20:23]
  s_waitcnt lgkmcnt(3)
  v_mfma_f32_16x16x32_bf16 v[20:23], v[40:43], v[44:47], v[20:23]
  s_waitcnt lgkmcnt(0)
  v_mfma_f32_16x16x32_bf16 v[20:23], v[48:51], v[52:55], v[20:23]
  s_waitcnt vmcnt(4) lgkmcnt(0)
  s_barrier
  ds_read_b64_tr_b16 v[24:25], v5 offset:32768
  ds_read_b64_tr_b16 v[26:27], v5 offset:34816
  ds_read_b128 v[28:31], v6 offset:1536
  ds_read_b64_tr_b16 v[32:33], v5 offset:36864
  ds_read_b64_tr_b16 v[34:35], v5 offset:38912
  ds_read_b128 v[36:39], v6 offset:1600
  ds_read_b64_tr_b16 v[40:41], v5 offset:40960
  ds_read_b64_tr_b16 v[42:43], v5 offset:43008
  ds_read_b128 v[44:47], v6 offset:1664
  ds_read_b64_tr_b16 v[48:49], v5 offset:45056
  ds_read_b64_tr_b16 v[50:51], v5 offset:47104
  ds_read_b128 v[52:55], v6 offset:1728
  s_waitcnt lgkmcnt(9)
  v_mfma_f32_16x16x32_bf16 v[20:23], v[24:27], v[28:31], v[20:23]
  s_waitcnt lgkmcnt(6)
  v_mfma_f32_16x16x32_bf16 v[20:23], v[32:35], v[36:39], v[20:23]
  s_waitcnt lgkmcnt(3)
  v_mfma_f32_16x16x32_bf16 v[20:23], v[40:43], v[44:47], v[20:23]
  s_waitcnt lgkmcnt(0)
  v_mfma_f32_16x16x32_bf16 v[20:23], v[48:51], v[52:55], v[20:23]
  s_waitcnt vmcnt(0) lgkmcnt(0)
  s_barrier
  ds_read_b64_tr_b16 v[24:25], v5 offset:49152
  ds_read_b64_tr_b16 v[26:27], v5 offset:51200
  ds_read_b128 v[28:31], v6 offset:1792
  ds_read_b64_tr_b16 v[32:33], v5 offset:53248
  ds_read_b64_tr_b16 v[34:35], v5 offset:55296
  ds_read_b128 v[36:39], v6 offset:1856
  ds_read_b64_tr_b16 v[40:41], v5 offset:57344
  ds_read_b64_tr_b16 v[42:43], v5 offset:59392
  ds_read_b128 v[44:47], v6 offset:1920
  ds_read_b64_tr_b16 v[48:49], v5 offset:61440
  ds_read_b64_tr_b16 v[50:51], v5 offset:63488
  ds_read_b128 v[52:55], v6 offset:1984
  s_waitcnt lgkmcnt(9)
  v_mfma_f32_16x16x32_bf16 v[20:23], v[24:27], v[28:31], v[20:23]
  s_waitcnt lgkmcnt(6)
  v_mfma_f32_16x16x32_bf16 v[20:23], v[32:35], v[36:39], v[20:23]
  s_waitcnt lgkmcnt(3)
  v_mfma_f32_16x16x32_bf16 v[20:23], v[40:43], v[44:47], v[20:23]
  s_waitcnt lgkmcnt(0)
  v_mfma_f32_16x16x32_bf16 v[20:23], v[48:51], v[52:55], v[20:23]
  s_lshl_b32 s40, s21, 8
  s_lshl_b32 s41, s20, 6
  s_add_u32 s40, s40, s41
  s_add_u32 s40, s40, 1572864
  v_and_b32 v2, 15, v0
  v_cmp_eq_u32 vcc, 0, v2
  v_mov_b32 v3, 2147483392
  s_nop 0
  v_cndmask_b32 v1, v3, v0, vcc
  v_cvt_pk_bf16_f32 v8, v20, v21
  v_cvt_pk_bf16_f32 v9, v22, v23
  v_lshlrev_b32 v20, 16, v8
  v_and_b32 v21, 0xffff0000, v8
  v_lshlrev_b32 v22, 16, v9
  v_and_b32 v23, 0xffff0000, v9
  buffer_store_dwordx4 v[20:23], v1, s[4:7], s40 offen sc1
  v_min_u32 v2, 31, v0
  v_lshlrev_b32 v2, 2, v2
  v_add_u32 v2, 128, v2
  s_nop 1
Lpoll_1:
  buffer_load_dword v3, v2, s[12:15], 0 offen sc1
  s_sub_u32 s24, s24, 1
  s_cbranch_scc1 L_FAIL
  s_waitcnt vmcnt(0)
  v_cmp_gt_i32 vcc, 1, v3
  s_cbranch_vccz Lpolld_2
  s_sleep 2
  s_branch Lpoll_1
Lpolld_2:
  s_lshl_b32 s40, s21, 7
  s_add_u32 s40, s40, 1376256
  v_mov_b32 v2, 2147483392
  s_mov_b64 exec, 1
  v_mov_b32 v2, s40
  s_mov_b64 exec, -1
  v_mov_b32 v3, 1
  s_barrier
  s_cmp_lg_u32 s20, 0
  s_cbranch_scc1 L_MOD_done
  buffer_store_dword v3, v2, s[4:7], 0 offen sc1
L_MOD_done:
  s_cmp_ge_u32 s21, 32
  s_cbranch_scc1 L_MOD_back
L_LN1:
  s_load_dwordx2 s[16:17], s[0:1], 0
  s_mov_b32 s18, 4194304
  s_mov_b32 s19, 0x20000
  s_waitcnt lgkmcnt(0)
  s_sub_u32 s43, 7, s22
  s_lshl_b32 s43, s43, 5
  s_add_u32 s43, s43, s23
  s_lshl_b32 s43, s43, 2
  s_add_u32 s43, s43, s20
  s_lshl_b32 s44, s43, 13
  s_add_u32 s45, s44, 4096
  v_lshlrev_b32 v1, 3, v0
  v_lshlrev_b32 v2, 4, v0
  buffer_load_dwordx2 v[8:9], v1, s[16:19], s44 offen offset:0 nt
  buffer_load_dwordx2 v[10:11], v1, s[16:19], s44 offen offset:512 nt
  buffer_load_dwordx2 v[12:13], v1, s[16:19], s44 offen offset:1024 nt
  buffer_load_dwordx2 v[14:15], v1, s[16:19], s44 offen offset:1536 nt
  buffer_load_dwordx2 v[16:17], v1, s[16:19], s44 offen offset:2048 nt
  buffer_load_dwordx2 v[18:19], v1, s[16:19], s44 offen offset:2560 nt
  buffer_load_dwordx2 v[20:21], v1, s[16:19], s44 offen offset:3072 nt
  buffer_load_dwordx2 v[22:23], v1, s[16:19], s44 offen offset:3584 nt
  buffer_load_dwordx2 v[24:25], v1, s[16:19], s45 offen offset:0 nt
  buffer_load_dwordx2 v[26:27], v1, s[16:19], s45 offen offset:512 nt
  buffer_load_dwordx2 v[28:29], v1, s[16:19], s45 offen offset:1024 nt
  buffer_load_dwordx2 v[30:31], v1, s[16:19], s45 offen offset:1536 nt
  buffer_load_dwordx2 v[32:33], v1, s[16:19], s45 offen offset:2048 nt
  buffer_load_dwordx2 v[34:35], v1, s[16:19], s45 offen offset:2560 nt
  buffer_load_dwordx2 v[36:37], v1, s[16:19], s45 offen offset:3072 nt
  buffer_load_dwordx2 v[38:39], v1, s[16:19], s45 offen offset:3584 nt
  s_waitcnt vmcnt(0)
  v_lshlrev_b32 v40, 16, v8
  v_and_b32 v41, 0xffff0000, v8
  v_lshlrev_b32 v42, 16, v9
  v_and_b32 v43, 0xffff0000, v9
  v_lshlrev_b32 v44, 16, v10
  v_and_b32 v45, 0xffff0000, v10
  v_lshlrev_b32 v46, 16, v11
  v_and_b32 v47, 0xffff0000, v11
  v_lshlrev_b32 v48, 16, v12
  v_and_b32 v49, 0xffff0000, v12
  v_lshlrev_b32 v50, 16, v13
  v_and_b32 v51, 0xffff0000, v13
  v_lshlrev_b32 v52, 16, v14
  v_and_b32 v53, 0xffff0000, v14
  v_lshlrev_b32 v54, 16, v15
  v_and_b32 v55, 0xffff0000, v15
  v_lshlrev_b32 v56, 16, v16
  v_and_b32 v57, 0xffff0000, v16
  v_lshlrev_b32 v58, 16, v17
  v_and_b32 v59, 0xffff0000, v17
  v_lshlrev_b32 v60, 16, v18
  v_and_b32 v61, 0xffff0000, v18
  v_lshlrev_b32 v62, 16, v19
  v_and_b32 v63, 0xffff0000, v19
  v_lshlrev_b32 v64, 16, v20
  v_and_b32 v65, 0xffff0000, v20
  v_lshlrev_b32 v66, 16, v21
  v_and_b32 v67, 0xffff0000, v21
  v_lshlrev_b32 v68, 16, v22
  v_and_b32 v69, 0xffff0000, v22
  v_lshlrev_b32 v70, 16, v23
  v_and_b32 v71, 0xffff0000, v23
  v_lshlrev_b32 v72, 16, v24
  v_and_b32 v73, 0xffff0000, v24
  v_lshlrev_b32 v74, 16, v25
  v_and_b32 v75, 0xffff0000, v25
  v_lshlrev_b32 v76, 16, v26
  v_and_b32 v77, 0xffff0000, v26
  v_lshlrev_b32 v78, 16, v27
  v_and_b32 v79, 0xffff0000, v27
  v_lshlrev_b32 v80, 16, v28
  v_and_b32 v81, 0xffff0000, v28
  v_lshlrev_b32 v82, 16, v29
  v_and_b32 v83, 0xffff0000, v29
  v_lshlrev_b32 v84, 16, v30
  v_and_b32 v85, 0xffff0000, v30
  v_lshlrev_b32 v86, 16, v31
  v_and_b32 v87, 0xffff0000, v31
  v_lshlrev_b32 v88, 16, v32
  v_and_b32 v89, 0xffff0000, v32
  v_lshlrev_b32 v90, 16, v33
  v_and_b32 v91, 0xffff0000, v33
  v_lshlrev_b32 v92, 16, v34
  v_and_b32 v93, 0xffff0000, v34
  v_lshlrev_b32 v94, 16, v35
  v_and_b32 v95, 0xffff0000, v35
  v_lshlrev_b32 v96, 16, v36
  v_and_b32 v97, 0xffff0000, v36
  v_lshlrev_b32 v98, 16, v37
  v_and_b32 v99, 0xffff0000, v37
  v_lshlrev_b32 v100, 16, v38
  v_and_b32 v101, 0xffff0000, v38
  v_lshlrev_b32 v102, 16, v39
  v_and_b32 v103, 0xffff0000, v39
  v_pk_add_f32 v[104:105], v[40:41], v[42:43]
  v_pk_add_f32 v[108:109], v[56:57], v[58:59]
  v_pk_add_f32 v[112:113], v[72:73], v[74:75]
  v_pk_add_f32 v[116:117], v[88:89], v[90:91]
  v_pk_add_f32 v[104:105], v[104:105], v[44:45]
  v_pk_add_f32 v[108:109], v[108:109], v[60:61]
  v_pk_add_f32 v[112:113], v[112:113], v[76:77]
  v_pk_add_f32 v[116:117], v[116:117], v[92:93]
  v_pk_add_f32 v[104:105], v[104:105], v[46:47]
  v_pk_add_f32 v[108:109], v[108:109], v[62:63]
  v_pk_add_f32 v[112:113], v[112:113], v[78:79]
  v_pk_add_f32 v[116:117], v[116:117], v[94:95]
  v_pk_add_f32 v[104:105], v[104:105], v[48:49]
  v_pk_add_f32 v[108:109], v[108:109], v[64:65]
  v_pk_add_f32 v[112:113], v[112:113], v[80:81]
  v_pk_add_f32 v[116:117], v[116:117], v[96:97]
  v_pk_add_f32 v[104:105], v[104:105], v[50:51]
  v_pk_add_f32 v[108:109], v[108:109], v[66:67]
  v_pk_add_f32 v[112:113], v[112:113], v[82:83]
  v_pk_add_f32 v[116:117], v[116:117], v[98:99]
  v_pk_add_f32 v[104:105], v[104:105], v[52:53]
  v_pk_add_f32 v[108:109], v[108:109], v[68:69]
  v_pk_add_f32 v[112:113], v[112:113], v[84:85]
  v_pk_add_f32 v[116:117], v[116:117], v[100:101]
  v_pk_add_f32 v[104:105], v[104:105], v[54:55]
  v_pk_add_f32 v[108:109], v[108:109], v[70:71]
  v_pk_add_f32 v[112:113], v[112:113], v[86:87]
  v_pk_add_f32 v[116:117], v[116:117], v[102:103]
  v_add_f32 v104, v104, v105
  v_add_f32 v108, v108, v109
  v_add_f32 v112, v112, v113
  v_add_f32 v116, v116, v117
  v_add_f32_dpp v104, v104, v104 row_ror:8 row_mask:0xf bank_mask:0xf
  v_add_f32_dpp v108, v108, v108 row_ror:8 row_mask:0xf bank_mask:0xf
  v_add_f32_dpp v112, v112, v112 row_ror:8 row_mask:0xf bank_mask:0xf
  v_add_f32_dpp v116, v116, v116 row_ror:8 row_mask:0xf bank_mask:0xf
  v_add_f32_dpp v104, v104, v104 row_ror:4 row_mask:0xf bank_mask:0xf
  v_add_f32_dpp v108, v108, v108 row_ror:4 row_mask:0xf bank_mask:0xf
  v_add_f32_dpp v112, v112, v112 row_ror:4 row_mask:0xf bank_mask:0xf
  v_add_f32_dpp v116, v116, v116 row_ror:4 row_mask:0xf bank_mask:0xf
  v_add_f32_dpp v104, v104, v104 row_ror:2 row_mask:0xf bank_mask:0xf
  v_add_f32_dpp v108, v108, v108 row_ror:2 row_mask:0xf bank_mask:0xf
  v_add_f32_dpp v112, v112, v112 row_ror:2 row_mask:0xf bank_mask:0xf
  v_add_f32_dpp v116, v116, v116 row_ror:2 row_mask:0xf bank_mask:0xf
  v_add_f32_dpp v104, v104, v104 row_ror:1 row_mask:0xf bank_mask:0xf
  v_add_f32_dpp v108, v108, v108 row_ror:1 row_mask:0xf bank_mask:0xf
  v_add_f32_dpp v112, v112, v112 row_ror:1 row_mask:0xf bank_mask:0xf
  v_add_f32_dpp v116, v116, v116 row_ror:1 row_mask:0xf bank_mask:0xf
  v_mov_b32 v105, v104
  v_mov_b32 v109, v108
  v_mov_b32 v113, v112
  v_mov_b32 v117, v116
  v_permlane16_swap_b32 v105, v104
  v_permlane16_swap_b32 v109, v108
  v_permlane16_swap_b32 v113, v112
  v_permlane16_swap_b32 v117, v116
  v_add_f32 v104, v104, v105
  v_add_f32 v108, v108, v109
  v_add_f32 v112, v112, v113
  v_add_f32 v116, v116, v117
  v_mov_b32 v105, v104
  v_mov_b32 v109, v108
  v_mov_b32 v113, v112
  v_mov_b32 v117, v116
  v_permlane32_swap_b32 v105, v104
  v_permlane32_swap_b32 v109, v108
  v_permlane32_swap_b32 v113, v112
  v_permlane32_swap_b32 v117, v116
  v_add_f32 v104, v104, v105
  v_add_f32 v108, v108, v109
  v_add_f32 v112, v112, v113
  v_add_f32 v116, v116, v117
  v_mul_f32 v104, 0xba800000, v104
  v_mul_f32 v108, 0xba800000, v108
  v_mul_f32 v112, 0xba800000, v112
  v_mul_f32 v116, 0xba800000, v116
  v_pk_add_f32 v[40:41], v[40:41], v[104:105] op_sel_hi:[1,0]
  v_pk_add_f32 v[56:57], v[56:57], v[108:109] op_sel_hi:[1,0]
  v_pk_add_f32 v[72:73], v[72:73], v[112:113] op_sel_hi:[1,0]
  v_pk_add_f32 v[88:89], v[88:89], v[116:117] op_sel_hi:[1,0]
  v_pk_add_f32 v[42:43], v[42:43], v[104:105] op_sel_hi:[1,0]
  v_pk_add_f32 v[58:59], v[58:59], v[108:109] op_sel_hi:[1,0]
  v_pk_add_f32 v[74:75], v[74:75], v[112:113] op_sel_hi:[1,0]
  v_pk_add_f32 v[90:91], v[90:91], v[116:117] op_sel_hi:[1,0]
  v_pk_add_f32 v[44:45], v[44:45], v[104:105] op_sel_hi:[1,0]
  v_pk_add_f32 v[60:61], v[60:61], v[108:109] op_sel_hi:[1,0]
  v_pk_add_f32 v[76:77], v[76:77], v[112:113] op_sel_hi:[1,0]
  v_pk_add_f32 v[92:93], v[92:93], v[116:117] op_sel_hi:[1,0]
  v_pk_add_f32 v[46:47], v[46:47], v[104:105] op_sel_hi:[1,0]
  v_pk_add_f32 v[62:63], v[62:63], v[108:109] op_sel_hi:[1,0]
  v_pk_add_f32 v[78:79], v[78:79], v[112:113] op_sel_hi:[1,0]
  v_pk_add_f32 v[94:95], v[94:95], v[116:117] op_sel_hi:[1,0]
  v_pk_add_f32 v[48:49], v[48:49], v[104:105] op_sel_hi:[1,0]
  v_pk_add_f32 v[64:65], v[64:65], v[108:109] op_sel_hi:[1,0]
  v_pk_add_f32 v[80:81], v[80:81], v[112:113] op_sel_hi:[1,0]
  v_pk_add_f32 v[96:97], v[96:97], v[116:117] op_sel_hi:[1,0]
  v_pk_add_f32 v[50:51], v[50:51], v[104:105] op_sel_hi:[1,0]
  v_pk_add_f32 v[66:67], v[66:67], v[108:109] op_sel_hi:[1,0]
  v_pk_add_f32 v[82:83], v[82:83], v[112:113] op_sel_hi:[1,0]
  v_pk_add_f32 v[98:99], v[98:99], v[116:117] op_sel_hi:[1,0]
  v_pk_add_f32 v[52:53], v[52:53], v[104:105] op_sel_hi:[1,0]
  v_pk_add_f32 v[68:69], v[68:69], v[108:109] op_sel_hi:[1,0]
  v_pk_add_f32 v[84:85], v[84:85], v[112:113] op_sel_hi:[1,0]
  v_pk_add_f32 v[100:101], v[100:101], v[116:117] op_sel_hi:[1,0]
  v_pk_add_f32 v[54:55], v[54:55], v[104:105] op_sel_hi:[1,0]
  v_pk_add_f32 v[70:71], v[70:71], v[108:109] op_sel_hi:[1,0]
  v_pk_add_f32 v[86:87], v[86:87], v[112:113] op_sel_hi:[1,0]
  v_pk_add_f32 v[102:103], v[102:103], v[116:117] op_sel_hi:[1,0]
  v_pk_mul_f32 v[104:105], v[40:41], v[40:41]
  v_pk_mul_f32 v[108:109], v[56:57], v[56:57]
  v_pk_mul_f32 v[112:113], v[72:73], v[72:73]
  v_pk_mul_f32 v[116:117], v[88:89], v[88:89]
  v_pk_fma_f32 v[104:105], v[42:43], v[42:43], v[104:105]
  v_pk_fma_f32 v[108:109], v[58:59], v[58:59], v[108:109]
  v_pk_fma_f32 v[112:113], v[74:75], v[74:75], v[112:113]
  v_pk_fma_f32 v[116:117], v[90:91], v[90:91], v[116:117]
  v_pk_fma_f32 v[104:105], v[44:45], v[44:45], v[104:105]
  v_pk_fma_f32 v[108:109], v[60:61], v[60:61], v[108:109]
  v_pk_fma_f32 v[112:113], v[76:77], v[76:77], v[112:113]
  v_pk_fma_f32 v[116:117], v[92:93], v[92:93], v[116:117]
  v_pk_fma_f32 v[104:105], v[46:47], v[46:47], v[104:105]
  v_pk_fma_f32 v[108:109], v[62:63], v[62:63], v[108:109]
  v_pk_fma_f32 v[112:113], v[78:79], v[78:79], v[112:113]
  v_pk_fma_f32 v[116:117], v[94:95], v[94:95], v[116:117]
  v_pk_fma_f32 v[104:105], v[48:49], v[48:49], v[104:105]
  v_pk_fma_f32 v[108:109], v[64:65], v[64:65], v[108:109]
  v_pk_fma_f32 v[112:113], v[80:81], v[80:81], v[112:113]
  v_pk_fma_f32 v[116:117], v[96:97], v[96:97], v[116:117]
  v_pk_fma_f32 v[104:105], v[50:51], v[50:51], v[104:105]
  v_pk_fma_f32 v[108:109], v[66:67], v[66:67], v[108:109]
  v_pk_fma_f32 v[112:113], v[82:83], v[82:83], v[112:113]
  v_pk_fma_f32 v[116:117], v[98:99], v[98:99], v[116:117]
  v_pk_fma_f32 v[104:105], v[52:53], v[52:53], v[104:105]
  v_pk_fma_f32 v[108:109], v[68:69], v[68:69], v[108:109]
  v_pk_fma_f32 v[112:113], v[84:85], v[84:85], v[112:113]
  v_pk_fma_f32 v[116:117], v[100:101], v[100:101], v[116:117]
  v_pk_fma_f32 v[104:105], v[54:55], v[54:55], v[104:105]
  v_pk_fma_f32 v[108:109], v[70:71], v[70:71], v[108:109]
  v_pk_fma_f32 v[112:113], v[86:87], v[86:87], v[112:113]
  v_pk_fma_f32 v[116:117], v[102:103], v[102:103], v[116:117]
  v_add_f32 v104, v104, v105
  v_add_f32 v108, v108, v109
  v_add_f32 v112, v112, v113
  v_add_f32 v116, v116, v117
  v_add_f32_dpp v104, v104, v104 row_ror:8 row_mask:0xf bank_mask:0xf
  v_add_f32_dpp v108, v108, v108 row_ror:8 row_mask:0xf bank_mask:0xf
  v_add_f32_dpp v112, v112, v112 row_ror:8 row_mask:0xf bank_mask:0xf
  v_add_f32_dpp v116, v116, v116 row_ror:8 row_mask:0xf bank_mask:0xf
  v_add_f32_dpp v104, v104, v104 row_ror:4 row_mask:0xf bank_mask:0xf
  v_add_f32_dpp v108, v108, v108 row_ror:4 row_mask:0xf bank_mask:0xf
  v_add_f32_dpp v112, v112, v112 row_ror:4 row_mask:0xf bank_mask:0xf
  v_add_f32_dpp v116, v116, v116 row_ror:4 row_mask:0xf bank_mask:0xf
  v_add_f32_dpp v104, v104, v104 row_ror:2 row_mask:0xf bank_mask:0xf
  v_add_f32_dpp v108, v108, v108 row_ror:2 row_mask:0xf bank_mask:0xf
  v_add_f32_dpp v112, v112, v112 row_ror:2 row_mask:0xf bank_mask:0xf
  v_add_f32_dpp v116, v116, v116 row_ror:2 row_mask:0xf bank_mask:0xf
  v_add_f32_dpp v104, v104, v104 row_ror:1 row_mask:0xf bank_mask:0xf
  v_add_f32_dpp v108, v108, v108 row_ror:1 row_mask:0xf bank_mask:0xf
  v_add_f32_dpp v112, v112, v112 row_ror:1 row_mask:0xf bank_mask:0xf
  v_add_f32_dpp v116, v116, v116 row_ror:1 row_mask:0xf bank_mask:0xf
  v_mov_b32 v105, v104
  v_mov_b32 v109, v108
  v_mov_b32 v113, v112
  v_mov_b32 v117, v116
  v_permlane16_swap_b32 v105, v104
  v_permlane16_swap_b32 v109, v108
  v_permlane16_swap_b32 v113, v112
  v_permlane16_swap_b32 v117, v116
  v_add_f32 v104, v104, v105
  v_add_f32 v108, v108, v109
  v_add_f32 v112, v112, v113
  v_add_f32 v116, v116, v117
  v_mov_b32 v105, v104
  v_mov_b32 v109, v108
  v_mov_b32 v113, v112
  v_mov_b32 v117, v116
  v_permlane32_swap_b32 v105, v104
  v_permlane32_swap_b32 v109, v108
  v_permlane32_swap_b32 v113, v112
  v_permlane32_swap_b32 v117, v116
  v_add_f32 v104, v104, v105
  v_add_f32 v108, v108, v109
  v_add_f32 v112, v112, v113
  v_add_f32 v116, v116, v117
  v_mul_f32 v104, 0x3a800000, v104
  v_mul_f32 v108, 0x3a800000, v108
  v_mul_f32 v112, 0x3a800000, v112
  v_mul_f32 v116, 0x3a800000, v116
  v_add_f32 v104, 0x3727c5ac, v104
  v_add_f32 v108, 0x3727c5ac, v108
  v_add_f32 v112, 0x3727c5ac, v112
  v_add_f32 v116, 0x3727c5ac, v116
  v_rsq_f32 v104, v104
  v_rsq_f32 v108, v108
  v_rsq_f32 v112, v112
  v_rsq_f32 v116, v116
  v_pk_mul_f32 v[40:41], v[40:41], v[104:105] op_sel_hi:[1,0]
  v_pk_mul_f32 v[56:57], v[56:57], v[108:109] op_sel_hi:[1,0]
  v_pk_mul_f32 v[72:73], v[72:73], v[112:113] op_sel_hi:[1,0]
  v_pk_mul_f32 v[88:89], v[88:89], v[116:117] op_sel_hi:[1,0]
  v_pk_mul_f32 v[42:43], v[42:43], v[104:105] op_sel_hi:[1,0]
  v_pk_mul_f32 v[58:59], v[58:59], v[108:109] op_sel_hi:[1,0]
  v_pk_mul_f32 v[74:75], v[74:75], v[112:113] op_sel_hi:[1,0]
  v_pk_mul_f32 v[90:91], v[90:91], v[116:117] op_sel_hi:[1,0]
  v_pk_mul_f32 v[44:45], v[44:45], v[104:105] op_sel_hi:[1,0]
  v_pk_mul_f32 v[60:61], v[60:61], v[108:109] op_sel_hi:[1,0]
  v_pk_mul_f32 v[76:77], v[76:77], v[112:113] op_sel_hi:[1,0]
  v_pk_mul_f32 v[92:93], v[92:93], v[116:117] op_sel_hi:[1,0]
  v_pk_mul_f32 v[46:47], v[46:47], v[104:105] op_sel_hi:[1,0]
  v_pk_mul_f32 v[62:63], v[62:63], v[108:109] op_sel_hi:[1,0]
  v_pk_mul_f32 v[78:79], v[78:79], v[112:113] op_sel_hi:[1,0]
  v_pk_mul_f32 v[94:95], v[94:95], v[116:117] op_sel_hi:[1,0]
  v_pk_mul_f32 v[48:49], v[48:49], v[104:105] op_sel_hi:[1,0]
  v_pk_mul_f32 v[64:65], v[64:65], v[108:109] op_sel_hi:[1,0]
  v_pk_mul_f32 v[80:81], v[80:81], v[112:113] op_sel_hi:[1,0]
  v_pk_mul_f32 v[96:97], v[96:97], v[116:117] op_sel_hi:[1,0]
  v_pk_mul_f32 v[50:51], v[50:51], v[104:105] op_sel_hi:[1,0]
  v_pk_mul_f32 v[66:67], v[66:67], v[108:109] op_sel_hi:[1,0]
  v_pk_mul_f32 v[82:83], v[82:83], v[112:113] op_sel_hi:[1,0]
  v_pk_mul_f32 v[98:99], v[98:99], v[116:117] op_sel_hi:[1,0]
  v_pk_mul_f32 v[52:53], v[52:53], v[104:105] op_sel_hi:[1,0]
  v_pk_mul_f32 v[68:69], v[68:69], v[108:109] op_sel_hi:[1,0]
  v_pk_mul_f32 v[84:85], v[84:85], v[112:113] op_sel_hi:[1,0]
  v_pk_mul_f32 v[100:101], v[100:101], v[116:117] op_sel_hi:[1,0]
  v_pk_mul_f32 v[54:55], v[54:55], v[104:105] op_sel_hi:[1,0]
  v_pk_mul_f32 v[70:71], v[70:71], v[108:109] op_sel_hi:[1,0]
  v_pk_mul_f32 v[86:87], v[86:87], v[112:113] op_sel_hi:[1,0]
  v_pk_mul_f32 v[102:103], v[102:103], v[116:117] op_sel_hi:[1,0]
  v_min_u32 v3, 31, v0
  v_lshlrev_b32 v3, 2, v3
  v_add_u32 v3, 128, v3
  s_nop 1
Lpoll_3:
  buffer_load_dword v4, v3, s[12:15], 0 offen sc1
  s_sub_u32 s24, s24, 1
  s_cbranch_scc1 L_FAIL
  s_waitcnt vmcnt(0)
  v_cmp_gt_i32 vcc, 1, v4
  s_cbranch_vccz Lpolld_4
  s_sleep 2
  s_branch Lpoll_3
Lpolld_4:
  v_min_u32 v3, 31, v0
  v_lshlrev_b32 v3, 7, v3
  v_add_u32 v3, 1376256, v3
  s_nop 1
Lpoll_5:
  buffer_load_dword v4, v3, s[4:7], 0 offen sc1
  s_sub_u32 s24, s24, 1
  s_cbranch_scc1 L_FAIL
  s_waitcnt vmcnt(0)
  v_cmp_gt_i32 vcc, 1, v4
  s_cbranch_vccz Lpolld_6
  s_sleep 2
  s_branch Lpoll_5
Lpolld_6:
  s_mov_b32 s40, 1572864
  buffer_load_dwordx4 v[136:139], v2, s[4:7], s40 offen offset:0 sc1
  buffer_load_dwordx4 v[140:143], v2, s[4:7], s40 offen offset:1024 sc1
  buffer_load_dwordx4 v[144:147], v2, s[4:7], s40 offen offset:2048 sc1
  buffer_load_dwordx4 v[148:151], v2, s[4:7], s40 offen offset:3072 sc1
  s_mov_b32 s40, 1576960
  buffer_load_dwordx4 v[120:123], v2, s[4:7], s40 offen offset:0 sc1
  buffer_load_dwordx4 v[124:127], v2, s[4:7], s40 offen offset:1024 sc1
  buffer_load_dwordx4 v[128:131], v2, s[4:7], s40 offen offset:2048 sc1
  buffer_load_dwordx4 v[132:135], v2, s[4:7], s40 offen offset:3072 sc1
  s_waitcnt vmcnt(0)
  v_add_f32 v120, 1.0, v120
  v_add_f32 v121, 1.0, v121
  v_add_f32 v122, 1.0, v122
  v_add_f32 v123, 1.0, v123
  v_add_f32 v124, 1.0, v124
  v_add_f32 v125, 1.0, v125
  v_add_f32 v126, 1.0, v126
  v_add_f32 v127, 1.0, v127
  v_add_f32 v128, 1.0, v128
  v_add_f32 v129, 1.0, v129
  v_add_f32 v130, 1.0, v130
  v_add_f32 v131, 1.0, v131
  v_add_f32 v132, 1.0, v132
  v_add_f32 v133, 1.0, v133
  v_add_f32 v134, 1.0, v134
  v_add_f32 v135, 1.0, v135
  s_add_u32 s44, s44, 6291456
  s_add_u32 s45, s45, 6291456
  v_pk_fma_f32 v[40:41], v[40:41], v[120:121], v[136:137]
  v_pk_fma_f32 v[42:43], v[42:43], v[122:123], v[138:139]
  v_pk_fma_f32 v[44:45], v[44:45], v[124:125], v[140:141]
  v_pk_fma_f32 v[46:47], v[46:47], v[126:127], v[142:143]
  v_pk_fma_f32 v[48:49], v[48:49], v[128:129], v[144:145]
  v_pk_fma_f32 v[50:51], v[50:51], v[130:131], v[146:147]
  v_pk_fma_f32 v[52:53], v[52:53], v[132:133], v[148:149]
  v_pk_fma_f32 v[54:55], v[54:55], v[134:135], v[150:151]
  v_cvt_pk_bf16_f32 v8, v40, v41
  v_cvt_pk_bf16_f32 v9, v42, v43
  v_cvt_pk_bf16_f32 v10, v44, v45
  v_cvt_pk_bf16_f32 v11, v46, v47
  v_cvt_pk_bf16_f32 v12, v48, v49
  v_cvt_pk_bf16_f32 v13, v50, v51
  v_cvt_pk_bf16_f32 v14, v52, v53
  v_cvt_pk_bf16_f32 v15, v54, v55
  buffer_store_dwordx4 v[8:11], v2, s[4:7], s44 offen offset:0 sc1
  buffer_store_dwordx4 v[12:15], v2, s[4:7], s44 offen offset:1024 sc1
  v_pk_fma_f32 v[56:57], v[56:57], v[120:121], v[136:137]
  v_pk_fma_f32 v[58:59], v[58:59], v[122:123], v[138:139]
  v_pk_fma_f32 v[60:61], v[60:61], v[124:125], v[140:141]
  v_pk_fma_f32 v[62:63], v[62:63], v[126:127], v[142:143]
  v_pk_fma_f32 v[64:65], v[64:65], v[128:129], v[144:145]
  v_pk_fma_f32 v[66:67], v[66:67], v[130:131], v[146:147]
  v_pk_fma_f32 v[68:69], v[68:69], v[132:133], v[148:149]
  v_pk_fma_f32 v[70:71], v[70:71], v[134:135], v[150:151]
  v_cvt_pk_bf16_f32 v16, v56, v57
  v_cvt_pk_bf16_f32 v17, v58, v59
  v_cvt_pk_bf16_f32 v18, v60, v61
  v_cvt_pk_bf16_f32 v19, v62, v63
  v_cvt_pk_bf16_f32 v20, v64, v65
  v_cvt_pk_bf16_f32 v21, v66, v67
  v_cvt_pk_bf16_f32 v22, v68, v69
  v_cvt_pk_bf16_f32 v23, v70, v71
  buffer_store_dwordx4 v[16:19], v2, s[4:7], s44 offen offset:2048 sc1
  buffer_store_dwordx4 v[20:23], v2, s[4:7], s44 offen offset:3072 sc1
  v_pk_fma_f32 v[72:73], v[72:73], v[120:121], v[136:137]
  v_pk_fma_f32 v[74:75], v[74:75], v[122:123], v[138:139]
  v_pk_fma_f32 v[76:77], v[76:77], v[124:125], v[140:141]
  v_pk_fma_f32 v[78:79], v[78:79], v[126:127], v[142:143]
  v_pk_fma_f32 v[80:81], v[80:81], v[128:129], v[144:145]
  v_pk_fma_f32 v[82:83], v[82:83], v[130:131], v[146:147]
  v_pk_fma_f32 v[84:85], v[84:85], v[132:133], v[148:149]
  v_pk_fma_f32 v[86:87], v[86:87], v[134:135], v[150:151]
  v_cvt_pk_bf16_f32 v24, v72, v73
  v_cvt_pk_bf16_f32 v25, v74, v75
  v_cvt_pk_bf16_f32 v26, v76, v77
  v_cvt_pk_bf16_f32 v27, v78, v79
  v_cvt_pk_bf16_f32 v28, v80, v81
  v_cvt_pk_bf16_f32 v29, v82, v83
  v_cvt_pk_bf16_f32 v30, v84, v85
  v_cvt_pk_bf16_f32 v31, v86, v87
  buffer_store_dwordx4 v[24:27], v2, s[4:7], s45 offen offset:0 sc1
  buffer_store_dwordx4 v[28:31], v2, s[4:7], s45 offen offset:1024 sc1
  v_pk_fma_f32 v[88:89], v[88:89], v[120:121], v[136:137]
  v_pk_fma_f32 v[90:91], v[90:91], v[122:123], v[138:139]
  v_pk_fma_f32 v[92:93], v[92:93], v[124:125], v[140:141]
  v_pk_fma_f32 v[94:95], v[94:95], v[126:127], v[142:143]
  v_pk_fma_f32 v[96:97], v[96:97], v[128:129], v[144:145]
  v_pk_fma_f32 v[98:99], v[98:99], v[130:131], v[146:147]
  v_pk_fma_f32 v[100:101], v[100:101], v[132:133], v[148:149]
  v_pk_fma_f32 v[102:103], v[102:103], v[134:135], v[150:151]
  v_cvt_pk_bf16_f32 v32, v88, v89
  v_cvt_pk_bf16_f32 v33, v90, v91
  v_cvt_pk_bf16_f32 v34, v92, v93
  v_cvt_pk_bf16_f32 v35, v94, v95
  v_cvt_pk_bf16_f32 v36, v96, v97
  v_cvt_pk_bf16_f32 v37, v98, v99
  v_cvt_pk_bf16_f32 v38, v100, v101
  v_cvt_pk_bf16_f32 v39, v102, v103
  buffer_store_dwordx4 v[32:35], v2, s[4:7], s45 offen offset:2048 sc1
  buffer_store_dwordx4 v[36:39], v2, s[4:7], s45 offen offset:3072 sc1
  s_lshr_b32 s40, s43, 3
  s_lshl_b32 s40, s40, 7
  s_and_b32 s41, s43, 7
  s_lshl_b32 s41, s41, 2
  s_add_u32 s40, s40, s41
  s_add_u32 s40, s40, 1388544
  v_mov_b32 v3, 2147483392
  s_mov_b64 exec, 1
  v_mov_b32 v3, s40
  s_mov_b64 exec, -1
  v_mov_b32 v4, 1
  s_waitcnt vmcnt(0)
  buffer_store_dword v4, v3, s[4:7], 0 offen sc1
  s_cmp_lg_u32 s20, 2
  s_cbranch_scc1 Lnotlb_7
  v_lshlrev_b32 v1, 21, v0
  s_mov_b32 s40, 0x1fff80
  buffer_load_dword v2, v1, s[4:7], s40 offen sc1
  s_add_u32 s40, s40, 134217728
  buffer_load_dword v2, v1, s[4:7], s40 offen sc1
  s_waitcnt vmcnt(0)
Lnotlb_7:
  s_mov_b32 s40, 1404928
  s_cmp_lt_u32 s22, 6
  s_cselect_b32 s40, 1404928, s40
  v_mov_b32 v1, s40
  s_nop 1
Lpoll_8:
  buffer_load_dword v2, v1, s[4:7], 0 offen sc1
  s_sub_u32 s24, s24, 1
  s_cbranch_scc1 L_FAIL
  s_waitcnt vmcnt(0)
  v_cmp_gt_i32 vcc, 0, v2
  s_cbranch_vccz Lpolld_9
  s_sleep 8
  s_branch Lpoll_8
Lpolld_9:
  s_and_b32 s40, s22, 1
  s_add_u32 s40, s40, 1
  s_lshl_b32 s40, s40, 5
  s_add_u32 s21, s40, s23
  s_cmp_lt_u32 s22, 6
  s_cbranch_scc0 L_MOD
L_MOD_back:
L_ROLE:
  s_sub_u32 s21, s3, 128
  s_cmp_lt_u32 s3, 160
  s_cbranch_scc1 L_WO
  s_sub_u32 s21, s3, 160
  s_cmp_lt_u32 s3, 216
  s_cbranch_scc1 L_F1
  s_sub_u32 s21, s3, 216
  s_cmp_lt_u32 s3, 224
  s_cbranch_scc1 L_LN2
  s_sub_u32 s21, s3, 224
  s_cmp_lt_u32 s3, 248
  s_cbranch_scc1 L_F2
  s_sub_u32 s21, s3, 248
  s_branch L_FIN
L_FAIL:
  s_mov_b64 exec, -1
  s_lshl_b32 s40, s2, 8
  s_add_u32 s40, s40, s25
  s_add_u32 s40, s40, 0x70000000
  v_mov_b32 v1, 60
  v_mov_b32 v2, s40
  buffer_store_dword v2, v1, s[12:15], 0 offen
L_END:
  s_endpgm
L_LN2:
  s_load_dwordx2 s[16:17], s[0:1], 0
  s_mov_b32 s18, 4194304
  s_mov_b32 s19, 0x20000
  s_waitcnt lgkmcnt(0)
  s_mov_b32 s25, 0
  s_mov_b32 s29, 1
  s_mov_b32 s26, 0
  s_cmp_eq_u32 s20, 0
  s_cselect_b32 s31, 0, 2147483392
  s_lshl_b32 s40, s21, 8
  s_lshl_b32 s41, s20, 15
  s_add_u32 s40, s40, s41
  v_and_b32 v6, 15, v0
  v_lshl_add_u32 v1, v6, 4, s40
  v_lshrrev_b32 v6, 4, v0
  v_lshl_add_u32 v1, v6, 11, v1
  v_and_b32 v6, 3, v0
  v_lshrrev_b32 v7, 5, v0
  v_lshrrev_b32 v8, 2, v0
  s_lshl_b32 s40, s20, 10
  v_lshl_add_u32 v5, v8, 4, s40
  s_lshl_b32 s40, s21, 13
  s_lshl_b32 s41, s20, 9
  s_add_u32 s40, s40, s41
  v_and_b32 v9, 31, v0
  v_lshl_add_u32 v10, v9, 4, s40
  v_lshl_add_u32 v10, v7, 11, v10
  v_min_u32 v16, 63, v0
  v_lshlrev_b32 v16, 7, v16
  v_add_u32 v16, 1424384, v16
  s_nop 1
Lpoll_11:
  buffer_load_dword v17, v16, s[4:7], 0 offen sc1
  s_sub_u32 s24, s24, 1
  s_cbranch_scc1 L_FAIL
  s_waitcnt vmcnt(0)
  v_cmp_gt_i32 vcc, 0, v17
  s_cbranch_vccz Lpolld_12
  s_sleep 1
  s_branch Lpoll_11
Lpolld_12:
Ltab_10:
  v_lshrrev_b32 v17, 8, v17
  v_and_b32 v18, 3, v0
  v_lshl_or_b32 v17, v17, 2, v18
  s_nop 1
  v_min_u32_dpp v17, v17, v17 row_ror:8 row_mask:0xf bank_mask:0xf
  s_nop 1
  v_min_u32_dpp v17, v17, v17 row_ror:4 row_mask:0xf bank_mask:0xf
  v_mov_b32 v18, v17
  s_nop 1
  v_permlane16_swap_b32 v18, v17
  v_min_u32 v17, v17, v18
  v_mov_b32 v18, v17
  s_nop 1
  v_permlane32_swap_b32 v18, v17
  v_min_u32 v17, v17, v18
  s_nop 1
  v_min_u32_dpp v17, v17, v17 row_ror:2 row_mask:0xf bank_mask:0xf
  s_nop 1
  v_min_u32_dpp v17, v17, v17 row_ror:1 row_mask:0xf bank_mask:0xf
  s_nop 0
  v_readfirstlane_b32 s27, v17
  s_and_b32 s27, s27, 3
  s_lshl_b32 s27, s27, 13
  s_and_b32 s27, s27, 0x2000
  s_xor_b32 s27, s27, 20979712
  v_min_u32 v2, 63, v0
  v_lshlrev_b32 v2, 7, v2
  v_add_u32 v2, 1380352, v2
  s_nop 1
Lpoll_13:
  buffer_load_dword v3, v2, s[4:7], 0 offen sc1
  s_sub_u32 s24, s24, 1
  s_cbranch_scc1 L_FAIL
  s_waitcnt vmcnt(0)
  v_cmp_gt_i32 vcc, 1, v3
  s_cbranch_vccz Lpolld_14
  s_sleep 2
  s_branch Lpoll_13
Lpolld_14:
  s_mov_b32 s40, 1585152
  buffer_load_dwordx4 v[64:67], v5, s[4:7], s40 offen offset:0 sc1
  buffer_load_dwordx4 v[68:71], v5, s[4:7], s40 offen offset:256 sc1
  buffer_load_dwordx4 v[72:75], v5, s[4:7], s40 offen offset:512 sc1
  buffer_load_dwordx4 v[76:79], v5, s[4:7], s40 offen offset:768 sc1
  s_mov_b32 s40, 1589248
  buffer_load_dwordx4 v[80:83], v5, s[4:7], s40 offen offset:0 sc1
  buffer_load_dwordx4 v[84:87], v5, s[4:7], s40 offen offset:256 sc1
  buffer_load_dwordx4 v[88:91], v5, s[4:7], s40 offen offset:512 sc1
  buffer_load_dwordx4 v[92:95], v5, s[4:7], s40 offen offset:768 sc1
  s_mov_b32 s40, 1581056
  buffer_load_dwordx4 v[48:51], v5, s[4:7], s40 offen offset:0 sc1
  buffer_load_dwordx4 v[52:55], v5, s[4:7], s40 offen offset:256 sc1
  buffer_load_dwordx4 v[56:59], v5, s[4:7], s40 offen offset:512 sc1
  buffer_load_dwordx4 v[60:63], v5, s[4:7], s40 offen offset:768 sc1
  s_waitcnt vmcnt(0)
  v_lshrrev_b32 v48, 16, v48
  v_lshrrev_b32 v50, 16, v50
  v_lshrrev_b32 v52, 16, v52
  v_lshrrev_b32 v54, 16, v54
  v_lshrrev_b32 v56, 16, v56
  v_lshrrev_b32 v58, 16, v58
  v_lshrrev_b32 v60, 16, v60
  v_lshrrev_b32 v62, 16, v62
  v_add_f32 v80, 1.0, v80
  v_add_f32 v81, 1.0, v81
  v_add_f32 v82, 1.0, v82
  v_add_f32 v83, 1.0, v83
  v_add_f32 v84, 1.0, v84
  v_add_f32 v85, 1.0, v85
  v_add_f32 v86, 1.0, v86
  v_add_f32 v87, 1.0, v87
  v_add_f32 v88, 1.0, v88
  v_add_f32 v89, 1.0, v89
  v_add_f32 v90, 1.0, v90
  v_add_f32 v91, 1.0, v91
  v_add_f32 v92, 1.0, v92
  v_add_f32 v93, 1.0, v93
  v_add_f32 v94, 1.0, v94
  v_add_f32 v95, 1.0, v95
  v_min_u32 v2, 31, v0
  v_lshlrev_b32 v2, 7, v2
  v_add_u32 v2, 1409024, v2
  s_lshl_b32 s62, s21, 7
  s_add_u32 s62, s62, 1413120
  s_lshl_b32 s30, s20, 11
  v_lshl_add_u32 v11, v6, 9, s30
  v_lshl_add_u32 v11, v8, 3, v11
  s_lshl_b32 s40, s20, 5
  s_add_u32 s40, s40, 8192
  v_lshl_add_u32 v12, v6, 3, s40
  v_lshlrev_b32 v13, 3, v6
  v_add_u32 v13, 8192, v13
  s_add_u32 m0, s30, 0
  s_add_u32 s40, s26, 0
  buffer_load_dwordx4 v10, s[16:19], s40 offen nt lds
  s_add_u32 m0, s30, 1024
  s_add_u32 s40, s26, 4096
  buffer_load_dwordx4 v10, s[16:19], s40 offen nt lds
  buffer_load_dword v3, v2, s[4:7], s31 offen sc1
  s_waitcnt vmcnt(1)
  ds_read_b64 v[24:25], v11 offset:0
  ds_read_b64 v[26:27], v11 offset:128
  ds_read_b64 v[28:29], v11 offset:256
  ds_read_b64 v[30:31], v11 offset:384
  s_waitcnt lgkmcnt(0)
L_LN2_top:
  v_lshlrev_b32 v96, 16, v24
  v_and_b32 v97, 0xffff0000, v24
  v_lshlrev_b32 v98, 16, v25
  v_and_b32 v99, 0xffff0000, v25
  v_lshlrev_b32 v100, 16, v26
  v_and_b32 v101, 0xffff0000, v26
  v_lshlrev_b32 v102, 16, v27
  v_and_b32 v103, 0xffff0000, v27
  v_lshlrev_b32 v104, 16, v28
  v_and_b32 v105, 0xffff0000, v28
  v_lshlrev_b32 v106, 16, v29
  v_and_b32 v107, 0xffff0000, v29
  v_lshlrev_b32 v108, 16, v30
  v_and_b32 v109, 0xffff0000, v30
  v_lshlrev_b32 v110, 16, v31
  v_and_b32 v111, 0xffff0000, v31
  s_cmp_lg_u32 s20, 0
  s_cbranch_scc1 Lgo_15
  s_waitcnt vmcnt(0)
  v_cmp_gt_i32 vcc, s29, v3
  s_cbranch_vccz Lgo_15
  s_nop 3
Lpoll_16:
  buffer_load_dword v3, v2, s[4:7], 0 offen sc1
  s_sub_u32 s24, s24, 1
  s_cbranch_scc1 L_FAIL
  s_waitcnt vmcnt(0)
  v_cmp_gt_i32 vcc, s29, v3
  s_cbranch_vccz Lpolld_17
  s_sleep 1
  s_branch Lpoll_16
Lpolld_17:
Lgo_15:
  s_barrier
  s_add_u32 s40, s27, 0
  buffer_load_dwordx4 v[112:115], v1, s[4:7], s40 offen sc1
  s_add_u32 s40, s27, 16384
  buffer_load_dwordx4 v[116:119], v1, s[4:7], s40 offen sc1
  s_add_u32 s40, s27, 131072
  buffer_load_dwordx4 v[120:123], v1, s[4:7], s40 offen sc1
  s_add_u32 s40, s27, 147456
  buffer_load_dwordx4 v[124:127], v1, s[4:7], s40 offen sc1
  s_add_u32 s40, s27, 262144
  buffer_load_dwordx4 v[128:131], v1, s[4:7], s40 offen sc1
  s_add_u32 s40, s27, 278528
  buffer_load_dwordx4 v[132:135], v1, s[4:7], s40 offen sc1
  s_add_u32 s40, s27, 393216
  buffer_load_dwordx4 v[136:139], v1, s[4:7], s40 offen sc1
  s_add_u32 s40, s27, 409600
  buffer_load_dwordx4 v[140:143], v1, s[4:7], s40 offen sc1
  s_add_u32 m0, s30, 0
  s_add_u32 s40, s26, 65536
  buffer_load_dwordx4 v10, s[16:19], s40 offen nt lds
  s_add_u32 m0, s30, 1024
  s_add_u32 s40, s26, 69632
  buffer_load_dwordx4 v10, s[16:19], s40 offen nt lds
  s_waitcnt vmcnt(9)
  v_dot2c_f32_bf16 v96, v112, v48
  v_dot2c_f32_bf16 v97, v112, v49
  v_dot2c_f32_bf16 v98, v113, v50
  v_dot2c_f32_bf16 v99, v113, v51
  v_dot2c_f32_bf16 v100, v114, v52
  v_dot2c_f32_bf16 v101, v114, v53
  v_dot2c_f32_bf16 v102, v115, v54
  v_dot2c_f32_bf16 v103, v115, v55
  s_waitcnt vmcnt(8)
  v_dot2c_f32_bf16 v104, v116, v56
  v_dot2c_f32_bf16 v105, v116, v57
  v_dot2c_f32_bf16 v106, v117, v58
  v_dot2c_f32_bf16 v107, v117, v59
  v_dot2c_f32_bf16 v108, v118, v60
  v_dot2c_f32_bf16 v109, v118, v61
  v_dot2c_f32_bf16 v110, v119, v62
  v_dot2c_f32_bf16 v111, v119, v63
  s_waitcnt vmcnt(7)
  v_dot2c_f32_bf16 v96, v120, v48
  v_dot2c_f32_bf16 v97, v120, v49
  v_dot2c_f32_bf16 v98, v121, v50
  v_dot2c_f32_bf16 v99, v121, v51
  v_dot2c_f32_bf16 v100, v122, v52
  v_dot2c_f32_bf16 v101, v122, v53
  v_dot2c_f32_bf16 v102, v123, v54
  v_dot2c_f32_bf16 v103, v123, v55
  s_waitcnt vmcnt(6)
  v_dot2c_f32_bf16 v104, v124, v56
  v_dot2c_f32_bf16 v105, v124, v57
  v_dot2c_f32_bf16 v106, v125, v58
  v_dot2c_f32_bf16 v107, v125, v59
  v_dot2c_f32_bf16 v108, v126, v60
  v_dot2c_f32_bf16 v109, v126, v61
  v_dot2c_f32_bf16 v110, v127, v62
  v_dot2c_f32_bf16 v111, v127, v63
  s_waitcnt vmcnt(5)
  v_dot2c_f32_bf16 v96, v128, v48
  v_dot2c_f32_bf16 v97, v128, v49
  v_dot2c_f32_bf16 v98, v129, v50
  v_dot2c_f32_bf16 v99, v129, v51
  v_dot2c_f32_bf16 v100, v130, v52
  v_dot2c_f32_bf16 v101, v130, v53
  v_dot2c_f32_bf16 v102, v131, v54
  v_dot2c_f32_bf16 v103, v131, v55
  s_waitcnt vmcnt(4)
  v_dot2c_f32_bf16 v104, v132, v56
  v_dot2c_f32_bf16 v105, v132, v57
  v_dot2c_f32_bf16 v106, v133, v58
  v_dot2c_f32_bf16 v107, v133, v59
  v_dot2c_f32_bf16 v108, v134, v60
  v_dot2c_f32_bf16 v109, v134, v61
  v_dot2c_f32_bf16 v110, v135, v62
  v_dot2c_f32_bf16 v111, v135, v63
  s_waitcnt vmcnt(3)
  v_dot2c_f32_bf16 v96, v136, v48
  v_dot2c_f32_bf16 v97, v136, v49
  v_dot2c_f32_bf16 v98, v137, v50
  v_dot2c_f32_bf16 v99, v137, v51
  v_dot2c_f32_bf16 v100, v138, v52
  v_dot2c_f32_bf16 v101, v138, v53
  v_dot2c_f32_bf16 v102, v139, v54
  v_dot2c_f32_bf16 v103, v139, v55
  s_waitcnt vmcnt(2)
  v_dot2c_f32_bf16 v104, v140, v56
  v_dot2c_f32_bf16 v105, v140, v57
  v_dot2c_f32_bf16 v106, v141, v58
  v_dot2c_f32_bf16 v107, v141, v59
  v_dot2c_f32_bf16 v108, v142, v60
  v_dot2c_f32_bf16 v109, v142, v61
  v_dot2c_f32_bf16 v110, v143, v62
  v_dot2c_f32_bf16 v111, v143, v63
  s_nop 2
  v_pk_add_f32 v[32:33], v[96:97], v[98:99]
  v_pk_add_f32 v[32:33], v[32:33], v[100:101]
  v_pk_add_f32 v[32:33], v[32:33], v[102:103]
  v_pk_add_f32 v[32:33], v[32:33], v[104:105]
  v_pk_add_f32 v[32:33], v[32:33], v[106:107]
  v_pk_add_f32 v[32:33], v[32:33], v[108:109]
  v_pk_add_f32 v[32:33], v[32:33], v[110:111]
  v_add_f32 v32, v32, v33
  s_nop 1
  v_add_f32_dpp v32, v32, v32 row_ror:4 row_mask:0xf bank_mask:0xf
  s_nop 1
  v_add_f32_dpp v32, v32, v32 row_ror:8 row_mask:0xf bank_mask:0xf
  v_mov_b32 v33, v32
  s_nop 1
  v_permlane16_swap_b32 v33, v32
  v_add_f32 v32, v32, v33
  v_mov_b32 v33, v32
  s_nop 1
  v_permlane32_swap_b32 v33, v32
  v_add_f32 v32, v32, v33
  v_mul_f32 v32, 0x3b800000, v32
  v_pk_add_f32 v[112:113], v[96:97], v[32:33] op_sel_hi:[1,0] neg_lo:[0,1] neg_hi:[0,1]
  v_pk_add_f32 v[114:115], v[98:99], v[32:33] op_sel_hi:[1,0] neg_lo:[0,1] neg_hi:[0,1]
  v_pk_add_f32 v[116:117], v[100:101], v[32:33] op_sel_hi:[1,0] neg_lo:[0,1] neg_hi:[0,1]
  v_pk_add_f32 v[118:119], v[102:103], v[32:33] op_sel_hi:[1,0] neg_lo:[0,1] neg_hi:[0,1]
  v_pk_add_f32 v[120:121], v[104:105], v[32:33] op_sel_hi:[1,0] neg_lo:[0,1] neg_hi:[0,1]
  v_pk_add_f32 v[122:123], v[106:107], v[32:33] op_sel_hi:[1,0] neg_lo:[0,1] neg_hi:[0,1]
  v_pk_add_f32 v[124:125], v[108:109], v[32:33] op_sel_hi:[1,0] neg_lo:[0,1] neg_hi:[0,1]
  v_pk_add_f32 v[126:127], v[110:111], v[32:33] op_sel_hi:[1,0] neg_lo:[0,1] neg_hi:[0,1]
  v_pk_mul_f32 v[34:35], v[112:113], v[112:113]
  v_pk_fma_f32 v[34:35], v[114:115], v[114:115], v[34:35]
  v_pk_fma_f32 v[34:35], v[116:117], v[116:117], v[34:35]
  v_pk_fma_f32 v[34:35], v[118:119], v[118:119], v[34:35]
  v_pk_fma_f32 v[34:35], v[120:121], v[120:121], v[34:35]
  v_pk_fma_f32 v[34:35], v[122:123], v[122:123], v[34:35]
  v_pk_fma_f32 v[34:35], v[124:125], v[124:125], v[34:35]
  v_pk_fma_f32 v[34:35], v[126:127], v[126:127], v[34:35]
  v_add_f32 v34, v34, v35
  s_nop 1
  v_add_f32_dpp v34, v34, v34 row_ror:4 row_mask:0xf bank_mask:0xf
  s_nop 1
  v_add_f32_dpp v34, v34, v34 row_ror:8 row_mask:0xf bank_mask:0xf
  v_mov_b32 v35, v34
  s_nop 1
  v_permlane16_swap_b32 v35, v34
  v_add_f32 v34, v34, v35
  v_mov_b32 v35, v34
  s_nop 1
  v_permlane32_swap_b32 v35, v34
  v_add_f32 v34, v34, v35
  v_mov_b32 v33, v34
  ds_write_b64 v12, v[32:33]
  v_cvt_pk_bf16_f32 v16, v96, v97
  v_cvt_pk_bf16_f32 v17, v98, v99
  v_cvt_pk_bf16_f32 v18, v100, v101
  v_cvt_pk_bf16_f32 v19, v102, v103
  v_cvt_pk_bf16_f32 v20, v104, v105
  v_cvt_pk_bf16_f32 v21, v106, v107
  v_cvt_pk_bf16_f32 v22, v108, v109
  v_cvt_pk_bf16_f32 v23, v110, v111
  s_waitcnt lgkmcnt(0)
  s_barrier
  ds_read2_b64 v[36:39], v13 offset0:0 offset1:4
  ds_read2_b64 v[40:43], v13 offset0:8 offset1:12
  s_add_u32 s40, s27, 1048576
  buffer_store_dwordx4 v[16:19], v1, s[4:7], s40 offen sc1
  s_add_u32 s40, s27, 1064960
  buffer_store_dwordx4 v[20:23], v1, s[4:7], s40 offen sc1
  s_waitcnt lgkmcnt(0)
  v_pk_add_f32 v[34:35], v[36:37], v[38:39]
  v_pk_add_f32 v[44:45], v[40:41], v[42:43]
  v_pk_add_f32 v[34:35], v[34:35], v[44:45]
  v_mul_f32 v34, 0x3e800000, v34
  v_mul_f32 v35, 0x3b800000, v35
  v_sub_f32 v36, v36, v34
  v_sub_f32 v38, v38, v34
  v_sub_f32 v40, v40, v34
  v_sub_f32 v42, v42, v34
  v_fmac_f32 v35, v36, v36
  v_fmac_f32 v35, v38, v38
  v_fmac_f32 v35, v40, v40
  v_fmac_f32 v35, v42, v42
  v_mul_f32 v35, 0x3e800000, v35
  v_add_f32 v35, 0x3727c5ac, v35
  v_rsq_f32 v44, v35
  v_sub_f32 v32, v32, v34
  v_mul_f32 v32, v32, v44
  v_pk_fma_f32 v[112:113], v[112:113], v[44:45], v[32:33] op_sel_hi:[1,0,0]
  v_pk_fma_f32 v[114:115], v[114:115], v[44:45], v[32:33] op_sel_hi:[1,0,0]
  v_pk_fma_f32 v[116:117], v[116:117], v[44:45], v[32:33] op_sel_hi:[1,0,0]
  v_pk_fma_f32 v[118:119], v[118:119], v[44:45], v[32:33] op_sel_hi:[1,0,0]
  v_pk_fma_f32 v[112:113], v[112:113], v[80:81], v[64:65]
  v_pk_fma_f32 v[114:115], v[114:115], v[82:83], v[66:67]
  v_pk_fma_f32 v[116:117], v[116:117], v[84:85], v[68:69]
  v_pk_fma_f32 v[118:119], v[118:119], v[86:87], v[70:71]
  v_cvt_pk_bf16_f32 v128, v112, v113
  v_cvt_pk_bf16_f32 v129, v114, v115
  v_cvt_pk_bf16_f32 v130, v116, v117
  v_cvt_pk_bf16_f32 v131, v118, v119
  s_add_u32 s40, s27, 917504
  buffer_store_dwordx4 v[128:131], v1, s[4:7], s40 offen sc1
  v_pk_fma_f32 v[120:121], v[120:121], v[44:45], v[32:33] op_sel_hi:[1,0,0]
  v_pk_fma_f32 v[122:123], v[122:123], v[44:45], v[32:33] op_sel_hi:[1,0,0]
  v_pk_fma_f32 v[124:125], v[124:125], v[44:45], v[32:33] op_sel_hi:[1,0,0]
  v_pk_fma_f32 v[126:127], v[126:127], v[44:45], v[32:33] op_sel_hi:[1,0,0]
  v_pk_fma_f32 v[120:121], v[120:121], v[88:89], v[72:73]
  v_pk_fma_f32 v[122:123], v[122:123], v[90:91], v[74:75]
  v_pk_fma_f32 v[124:125], v[124:125], v[92:93], v[76:77]
  v_pk_fma_f32 v[126:127], v[126:127], v[94:95], v[78:79]
  v_cvt_pk_bf16_f32 v132, v120, v121
  v_cvt_pk_bf16_f32 v133, v122, v123
  v_cvt_pk_bf16_f32 v134, v124, v125
  v_cvt_pk_bf16_f32 v135, v126, v127
  s_add_u32 s40, s27, 933888
  buffer_store_dwordx4 v[132:135], v1, s[4:7], s40 offen sc1
  buffer_load_dword v3, v2, s[4:7], s31 offen sc1
  s_waitcnt vmcnt(5)
  ds_read_b64 v[24:25], v11 offset:0
  ds_read_b64 v[26:27], v11 offset:128
  ds_read_b64 v[28:29], v11 offset:256
  ds_read_b64 v[30:31], v11 offset:384
  s_waitcnt vmcnt(1) lgkmcnt(0)
  s_barrier
  s_cmp_lg_u32 s20, 0
  s_cbranch_scc1 Lnosig_18
  s_mov_b32 s63, s29
  s_atomic_smax s63, s[4:5], s62 glc
Lnosig_18:
  s_add_u32 s25, s25, 1
  s_add_u32 s29, s29, 1
  s_add_u32 s26, s26, 65536
  s_add_u32 s27, s27, 2097152
  s_xor_b32 s27, s27, 0x2000
  s_cmp_lt_u32 s25, 64
  s_cbranch_scc1 L_LN2_top
  s_branch L_END
L_FIN:
  s_load_dwordx2 s[16:17], s[0:1], 104
  s_mov_b32 s18, 4194304
  s_mov_b32 s19, 0x20000
  s_waitcnt lgkmcnt(0)
  s_mov_b32 s25, 0
  s_mov_b32 s29, 1
  s_mov_b32 s26, 0
  s_cmp_eq_u32 s20, 0
  s_cselect_b32 s31, 0, 2147483392
  s_lshl_b32 s40, s21, 8
  s_lshl_b32 s41, s20, 15
  s_add_u32 s40, s40, s41
  v_and_b32 v6, 15, v0
  v_lshl_add_u32 v1, v6, 4, s40
  v_lshrrev_b32 v6, 4, v0
  v_lshl_add_u32 v1, v6, 11, v1
  v_and_b32 v6, 3, v0
  v_lshrrev_b32 v7, 5, v0
  v_lshrrev_b32 v8, 2, v0
  s_lshl_b32 s40, s20, 10
  v_lshl_add_u32 v5, v8, 4, s40
  s_lshl_b32 s40, s21, 13
  s_lshl_b32 s41, s20, 9
  s_add_u32 s40, s40, s41
  v_and_b32 v9, 31, v0
  v_lshl_add_u32 v10, v9, 4, s40
  v_lshl_add_u32 v10, v7, 11, v10
  v_min_u32 v16, 63, v0
  v_lshlrev_b32 v16, 7, v16
  v_add_u32 v16, 1424384, v16
  s_nop 1
Lpoll_20:
  buffer_load_dword v17, v16, s[4:7], 0 offen sc1
  s_sub_u32 s24, s24, 1
  s_cbranch_scc1 L_FAIL
  s_waitcnt vmcnt(0)
  v_cmp_gt_i32 vcc, 0, v17
  s_cbranch_vccz Lpolld_21
  s_sleep 1
  s_branch Lpoll_20
Lpolld_21:
Ltab_19:
  v_lshrrev_b32 v17, 8, v17
  v_and_b32 v18, 3, v0
  v_lshl_or_b32 v17, v17, 2, v18
  s_nop 1
  v_min_u32_dpp v17, v17, v17 row_ror:8 row_mask:0xf bank_mask:0xf
  s_nop 1
  v_min_u32_dpp v17, v17, v17 row_ror:4 row_mask:0xf bank_mask:0xf
  v_mov_b32 v18, v17
  s_nop 1
  v_permlane16_swap_b32 v18, v17
  v_min_u32 v17, v17, v18
  v_mov_b32 v18, v17
  s_nop 1
  v_permlane32_swap_b32 v18, v17
  v_min_u32 v17, v17, v18
  s_nop 1
  v_min_u32_dpp v17, v17, v17 row_ror:2 row_mask:0xf bank_mask:0xf
  s_nop 1
  v_min_u32_dpp v17, v17, v17 row_ror:1 row_mask:0xf bank_mask:0xf
  s_nop 0
  v_readfirstlane_b32 s27, v17
  s_and_b32 s27, s27, 3
  s_lshl_b32 s27, s27, 13
  s_and_b32 s27, s27, 0x2000
  s_xor_b32 s27, s27, 20979712
  v_min_u32 v2, 63, v0
  v_lshlrev_b32 v2, 7, v2
  v_add_u32 v2, 1380352, v2
  s_nop 1
Lpoll_22:
  buffer_load_dword v3, v2, s[4:7], 0 offen sc1
  s_sub_u32 s24, s24, 1
  s_cbranch_scc1 L_FAIL
  s_waitcnt vmcnt(0)
  v_cmp_gt_i32 vcc, 1, v3
  s_cbranch_vccz Lpolld_23
  s_sleep 2
  s_branch Lpoll_22
Lpolld_23:
  s_mov_b32 s40, 1593344
  buffer_load_dwordx4 v[48:51], v5, s[4:7], s40 offen offset:0 sc1
  buffer_load_dwordx4 v[52:55], v5, s[4:7], s40 offen offset:256 sc1
  buffer_load_dwordx4 v[56:59], v5, s[4:7], s40 offen offset:512 sc1
  buffer_load_dwordx4 v[60:63], v5, s[4:7], s40 offen offset:768 sc1
  s_waitcnt vmcnt(0)
  v_lshrrev_b32 v48, 16, v48
  v_lshrrev_b32 v50, 16, v50
  v_lshrrev_b32 v52, 16, v52
  v_lshrrev_b32 v54, 16, v54
  v_lshrrev_b32 v56, 16, v56
  v_lshrrev_b32 v58, 16, v58
  v_lshrrev_b32 v60, 16, v60
  v_lshrrev_b32 v62, 16, v62
  v_min_u32 v2, 23, v0
  v_lshlrev_b32 v2, 7, v2
  v_add_u32 v2, 1421312, v2
  s_mul_i32 s30, s20, 2176
  v_mul_u32_u24 v11, 544, v6
  v_lshl_add_u32 v11, v8, 3, v11
  v_add_u32 v11, s30, v11
  v_mul_u32_u24 v12, 544, v7
  v_lshl_add_u32 v12, v9, 4, v12
  v_add_u32 v12, s30, v12
  buffer_load_dword v3, v2, s[4:7], s31 offen sc1
  s_nop 0
L_FIN_top:
  s_cmp_lg_u32 s20, 0
  s_cbranch_scc1 Lgo_24
  s_waitcnt vmcnt(0)
  v_cmp_gt_i32 vcc, s29, v3
  s_cbranch_vccz Lgo_24
  s_nop 3
Lpoll_25:
  buffer_load_dword v3, v2, s[4:7], 0 offen sc1
  s_sub_u32 s24, s24, 1
  s_cbranch_scc1 L_FAIL
  s_waitcnt vmcnt(0)
  v_cmp_gt_i32 vcc, s29, v3
  s_cbranch_vccz Lpolld_26
  s_sleep 1
  s_branch Lpoll_25
Lpolld_26:
Lgo_24:
  s_barrier
  s_add_u32 s40, s27, 1048576
  buffer_load_dwordx4 v[16:19], v1, s[4:7], s40 offen sc1
  s_add_u32 s40, s27, 1064960
  buffer_load_dwordx4 v[20:23], v1, s[4:7], s40 offen sc1
  s_add_u32 s40, s27, 524288
  buffer_load_dwordx4 v[112:115], v1, s[4:7], s40 offen sc1
  s_add_u32 s40, s27, 540672
  buffer_load_dwordx4 v[116:119], v1, s[4:7], s40 offen sc1
  s_add_u32 s40, s27, 655360
  buffer_load_dwordx4 v[120:123], v1, s[4:7], s40 offen sc1
  s_add_u32 s40, s27, 671744
  buffer_load_dwordx4 v[124:127], v1, s[4:7], s40 offen sc1
  s_add_u32 s40, s27, 786432
  buffer_load_dwordx4 v[128:131], v1, s[4:7], s40 offen sc1
  s_add_u32 s40, s27, 802816
  buffer_load_dwordx4 v[132:135], v1, s[4:7], s40 offen sc1
  s_waitcnt vmcnt(6)
  v_lshlrev_b32 v96, 16, v16
  v_and_b32 v97, 0xffff0000, v16
  v_lshlrev_b32 v98, 16, v17
  v_and_b32 v99, 0xffff0000, v17
  v_lshlrev_b32 v100, 16, v18
  v_and_b32 v101, 0xffff0000, v18
  v_lshlrev_b32 v102, 16, v19
  v_and_b32 v103, 0xffff0000, v19
  v_lshlrev_b32 v104, 16, v20
  v_and_b32 v105, 0xffff0000, v20
  v_lshlrev_b32 v106, 16, v21
  v_and_b32 v107, 0xffff0000, v21
  v_lshlrev_b32 v108, 16, v22
  v_and_b32 v109, 0xffff0000, v22
  v_lshlrev_b32 v110, 16, v23
  v_and_b32 v111, 0xffff0000, v23
  s_waitcnt vmcnt(5)
  v_dot2c_f32_bf16 v96, v112, v48
  v_dot2c_f32_bf16 v97, v112, v49
  v_dot2c_f32_bf16 v98, v113, v50
  v_dot2c_f32_bf16 v99, v113, v51
  v_dot2c_f32_bf16 v100, v114, v52
  v_dot2c_f32_bf16 v101, v114, v53
  v_dot2c_f32_bf16 v102, v115, v54
  v_dot2c_f32_bf16 v103, v115, v55
  s_waitcnt vmcnt(4)
  v_dot2c_f32_bf16 v104, v116, v56
  v_dot2c_f32_bf16 v105, v116, v57
  v_dot2c_f32_bf16 v106, v117, v58
  v_dot2c_f32_bf16 v107, v117, v59
  v_dot2c_f32_bf16 v108, v118, v60
  v_dot2c_f32_bf16 v109, v118, v61
  v_dot2c_f32_bf16 v110, v119, v62
  v_dot2c_f32_bf16 v111, v119, v63
  s_waitcnt vmcnt(3)
  v_dot2c_f32_bf16 v96, v120, v48
  v_dot2c_f32_bf16 v97, v120, v49
  v_dot2c_f32_bf16 v98, v121, v50
  v_dot2c_f32_bf16 v99, v121, v51
  v_dot2c_f32_bf16 v100, v122, v52
  v_dot2c_f32_bf16 v101, v122, v53
  v_dot2c_f32_bf16 v102, v123, v54
  v_dot2c_f32_bf16 v103, v123, v55
  s_waitcnt vmcnt(2)
  v_dot2c_f32_bf16 v104, v124, v56
  v_dot2c_f32_bf16 v105, v124, v57
  v_dot2c_f32_bf16 v106, v125, v58
  v_dot2c_f32_bf16 v107, v125, v59
  v_dot2c_f32_bf16 v108, v126, v60
  v_dot2c_f32_bf16 v109, v126, v61
  v_dot2c_f32_bf16 v110, v127, v62
  v_dot2c_f32_bf16 v111, v127, v63
  s_waitcnt vmcnt(1)
  v_dot2c_f32_bf16 v96, v128, v48
  v_dot2c_f32_bf16 v97, v128, v49
  v_dot2c_f32_bf16 v98, v129, v50
  v_dot2c_f32_bf16 v99, v129, v51
  v_dot2c_f32_bf16 v100, v130, v52
  v_dot2c_f32_bf16 v101, v130, v53
  v_dot2c_f32_bf16 v102, v131, v54
  v_dot2c_f32_bf16 v103, v131, v55
  s_waitcnt vmcnt(0)
  v_dot2c_f32_bf16 v104, v132, v56
  v_dot2c_f32_bf16 v105, v132, v57
  v_dot2c_f32_bf16 v106, v133, v58
  v_dot2c_f32_bf16 v107, v133, v59
  v_dot2c_f32_bf16 v108, v134, v60
  v_dot2c_f32_bf16 v109, v134, v61
  v_dot2c_f32_bf16 v110, v135, v62
  v_dot2c_f32_bf16 v111, v135, v63
  s_nop 2
  buffer_load_dword v3, v2, s[4:7], s31 offen sc1
  v_cvt_pk_bf16_f32 v16, v96, v97
  v_cvt_pk_bf16_f32 v17, v98, v99
  v_cvt_pk_bf16_f32 v18, v100, v101
  v_cvt_pk_bf16_f32 v19, v102, v103
  v_cvt_pk_bf16_f32 v20, v104, v105
  v_cvt_pk_bf16_f32 v21, v106, v107
  v_cvt_pk_bf16_f32 v22, v108, v109
  v_cvt_pk_bf16_f32 v23, v110, v111
  ds_write_b64 v11, v[16:17] offset:0
  ds_write_b64 v11, v[18:19] offset:128
  ds_write_b64 v11, v[20:21] offset:256
  ds_write_b64 v11, v[22:23] offset:384
  ds_read_b128 v[112:115], v12 offset:0
  ds_read_b128 v[116:119], v12 offset:1088
  s_add_u32 s40, s26, 0
  s_waitcnt lgkmcnt(1)
  buffer_store_dwordx4 v[112:115], v10, s[16:19], s40 offen
  s_add_u32 s40, s26, 4096
  s_waitcnt lgkmcnt(0)
  buffer_store_dwordx4 v[116:119], v10, s[16:19], s40 offen
  s_add_u32 s25, s25, 1
  s_add_u32 s29, s29, 1
  s_add_u32 s26, s26, 65536
  s_add_u32 s27, s27, 2097152
  s_xor_b32 s27, s27, 0x2000
  s_cmp_lt_u32 s25, 64
  s_cbranch_scc1 L_FIN_top
  s_branch L_END
L_QKV:
  v_lshrrev_b32 v60, 3, v0
  v_and_b32 v61, 6, v60
  v_xor_b32 v61, v61, v0
  v_and_b32 v61, 7, v61
  v_lshlrev_b32 v61, 4, v61
  v_lshl_add_u32 v1, v60, 11, v61
  s_lshl_b32 s40, s20, 14
  v_add_u32 v1, s40, v1
  s_lshl_b32 s32, s20, 10
  v_and_b32 v60, 6, v0
  v_lshrrev_b32 v61, 4, v0
  v_xor_b32 v60, v60, v61
  v_lshlrev_b32 v60, 4, v60
  v_and_b32 v61, 15, v0
  v_lshl_add_u32 v77, v61, 7, v60
  v_xor_b32 v78, 64, v77
  s_and_b32 s43, s21, 1
  s_lshr_b32 s44, s21, 1
  s_lshl_b32 s44, s44, 8
  s_add_u32 s45, s44, 128
  s_lshl_b32 s46, s43, 7
  s_add_u32 s46, s46, s44
  s_xor_b32 s46, s46, 256
  s_load_dwordx4 s[48:51], s[0:1], 16
  s_waitcnt lgkmcnt(0)
  s_cmp_eq_u32 s43, 0
  s_cselect_b32 s8, s48, s50
  s_cselect_b32 s9, s49, s51
  s_mov_b32 s10, 8388608
  s_mov_b32 s11, 0x20000
  s_lshr_b32 s40, s44, 8
  s_and_b32 s40, s40, 3
  s_cmp_eq_u32 s40, 1
  s_cselect_b64 vcc, -1, 0
  v_bfe_u32 v4, v0, 5, 1
  v_mul_u32_u24 v4, 32768, v4
  v_bfe_u32 v5, v0, 4, 1
  v_mul_u32_u24 v5, 16384, v5
  v_add_u32 v4, v4, v5
  v_bfe_u32 v5, v0, 3, 1
  v_mul_u32_u24 v5, 8192, v5
  v_add_u32 v4, v4, v5
  v_lshrrev_b32 v5, 3, v0
  v_and_b32 v5, 6, v5
  v_xor_b32 v5, v5, v0
  v_and_b32 v5, 7, v5
  v_lshl_add_u32 v4, v5, 4, v4
  s_lshr_b32 s40, s20, 1
  s_mul_i32 s40, s40, 2097152
  s_and_b32 s41, s20, 1
  s_mul_i32 s41, s41, 65536
  s_add_u32 s40, s40, s41
  v_add_u32 v4, s40, v4
  v_bfe_u32 v5, v0, 3, 2
  v_xor_b32 v5, s20, v5
  v_lshlrev_b32 v5, 5, v5
  v_lshrrev_b32 v6, 2, v0
  v_lshl_add_u32 v6, v6, 7, v5
  v_and_b32 v5, 3, v0
  v_lshl_add_u32 v6, v5, 3, v6
  v_add_u32 v7, 0x10000, v6
  v_add_u32 v8, s44, v4
  v_add_u32 v9, s45, v4
  v_add_u32 v10, s46, v4
  v_lshrrev_b32 v2, 3, v0
  v_lshlrev_b32 v2, 7, v2
  v_and_b32 v3, 7, v0
  v_lshl_add_u32 v2, v3, 2, v2
  v_add_u32 v2, 1388544, v2
  v_min_u32 v64, 63, v0
  v_lshlrev_b32 v64, 7, v64
  v_add_u32 v64, 1424384, v64
  s_lshl_b32 s41, s20, 10
  s_add_u32 m0, s41, 0
  s_mov_b32 s42, 0
  s_cbranch_vccnz Lpace_27
  s_waitcnt vmcnt(6)
Lpace_27:
  buffer_load_dwordx4 v8, s[8:11], s42 offen lds
  s_add_u32 m0, s41, 4096
  s_mov_b32 s42, 0
  s_cbranch_vccnz Lpace_28
  s_waitcnt vmcnt(6)
Lpace_28:
  buffer_load_dwordx4 v9, s[8:11], s42 offen lds
  s_add_u32 m0, s41, 8192
  s_mov_b32 s42, 131072
  s_cbranch_vccnz Lpace_29
  s_waitcnt vmcnt(6)
Lpace_29:
  buffer_load_dwordx4 v8, s[8:11], s42 offen lds
  s_add_u32 m0, s41, 12288
  s_mov_b32 s42, 131072
  s_cbranch_vccnz Lpace_30
  s_waitcnt vmcnt(6)
Lpace_30:
  buffer_load_dwordx4 v9, s[8:11], s42 offen lds
  s_add_u32 m0, s41, 16384
  s_mov_b32 s42, 262144
  s_cbranch_vccnz Lpace_31
  s_waitcnt vmcnt(6)
Lpace_31:
  buffer_load_dwordx4 v8, s[8:11], s42 offen lds
  s_add_u32 m0, s41, 20480
  s_mov_b32 s42, 262144
  s_cbranch_vccnz Lpace_32
  s_waitcnt vmcnt(6)
Lpace_32:
  buffer_load_dwordx4 v9, s[8:11], s42 offen lds
  s_add_u32 m0, s41, 24576
  s_mov_b32 s42, 393216
  s_cbranch_vccnz Lpace_33
  s_waitcnt vmcnt(6)
Lpace_33:
  buffer_load_dwordx4 v8, s[8:11], s42 offen lds
  s_add_u32 m0, s41, 28672
  s_mov_b32 s42, 393216
  s_cbranch_vccnz Lpace_34
  s_waitcnt vmcnt(6)
Lpace_34:
  buffer_load_dwordx4 v9, s[8:11], s42 offen lds
  s_add_u32 m0, s41, 32768
  s_mov_b32 s42, 524288
  s_cbranch_vccnz Lpace_35
  s_waitcnt vmcnt(6)
Lpace_35:
  buffer_load_dwordx4 v8, s[8:11], s42 offen lds
  s_add_u32 m0, s41, 36864
  s_mov_b32 s42, 524288
  s_cbranch_vccnz Lpace_36
  s_waitcnt vmcnt(6)
Lpace_36:
  buffer_load_dwordx4 v9, s[8:11], s42 offen lds
  s_add_u32 m0, s41, 40960
  s_mov_b32 s42, 655360
  s_cbranch_vccnz Lpace_37
  s_waitcnt vmcnt(6)
Lpace_37:
  buffer_load_dwordx4 v8, s[8:11], s42 offen lds
  s_add_u32 m0, s41, 45056
  s_mov_b32 s42, 655360
  s_cbranch_vccnz Lpace_38
  s_waitcnt vmcnt(6)
Lpace_38:
  buffer_load_dwordx4 v9, s[8:11], s42 offen lds
  s_add_u32 m0, s41, 49152
  s_mov_b32 s42, 786432
  s_cbranch_vccnz Lpace_39
  s_waitcnt vmcnt(6)
Lpace_39:
  buffer_load_dwordx4 v8, s[8:11], s42 offen lds
  s_add_u32 m0, s41, 53248
  s_mov_b32 s42, 786432
  s_cbranch_vccnz Lpace_40
  s_waitcnt vmcnt(6)
Lpace_40:
  buffer_load_dwordx4 v9, s[8:11], s42 offen lds
  s_add_u32 m0, s41, 57344
  s_mov_b32 s42, 917504
  s_cbranch_vccnz Lpace_41
  s_waitcnt vmcnt(6)
Lpace_41:
  buffer_load_dwordx4 v8, s[8:11], s42 offen lds
  s_add_u32 m0, s41, 61440
  s_mov_b32 s42, 917504
  s_cbranch_vccnz Lpace_42
  s_waitcnt vmcnt(6)
Lpace_42:
  buffer_load_dwordx4 v9, s[8:11], s42 offen lds
  s_add_u32 m0, s41, 65536
  s_mov_b32 s42, 1048576
  s_cbranch_vccnz Lpace_43
  s_waitcnt vmcnt(6)
Lpace_43:
  buffer_load_dwordx4 v8, s[8:11], s42 offen lds
  s_add_u32 m0, s41, 69632
  s_mov_b32 s42, 1048576
  s_cbranch_vccnz Lpace_44
  s_waitcnt vmcnt(6)
Lpace_44:
  buffer_load_dwordx4 v9, s[8:11], s42 offen lds
  s_add_u32 m0, s41, 73728
  s_mov_b32 s42, 1179648
  s_cbranch_vccnz Lpace_45
  s_waitcnt vmcnt(6)
Lpace_45:
  buffer_load_dwordx4 v8, s[8:11], s42 offen lds
  s_add_u32 m0, s41, 77824
  s_mov_b32 s42, 1179648
  s_cbranch_vccnz Lpace_46
  s_waitcnt vmcnt(6)
Lpace_46:
  buffer_load_dwordx4 v9, s[8:11], s42 offen lds
  s_add_u32 m0, s41, 81920
  s_mov_b32 s42, 1310720
  s_cbranch_vccnz Lpace_47
  s_waitcnt vmcnt(6)
Lpace_47:
  buffer_load_dwordx4 v8, s[8:11], s42 offen lds
  s_add_u32 m0, s41, 86016
  s_mov_b32 s42, 1310720
  s_cbranch_vccnz Lpace_48
  s_waitcnt vmcnt(6)
Lpace_48:
  buffer_load_dwordx4 v9, s[8:11], s42 offen lds
  s_add_u32 m0, s41, 90112
  s_mov_b32 s42, 1441792
  s_cbranch_vccnz Lpace_49
  s_waitcnt vmcnt(6)
Lpace_49:
  buffer_load_dwordx4 v8, s[8:11], s42 offen lds
  s_add_u32 m0, s41, 94208
  s_mov_b32 s42, 1441792
  s_cbranch_vccnz Lpace_50
  s_waitcnt vmcnt(6)
Lpace_50:
  buffer_load_dwordx4 v9, s[8:11], s42 offen lds
  s_add_u32 m0, s41, 98304
  s_mov_b32 s42, 1572864
  s_cbranch_vccnz Lpace_51
  s_waitcnt vmcnt(6)
Lpace_51:
  buffer_load_dwordx4 v8, s[8:11], s42 offen lds
  s_add_u32 m0, s41, 102400
  s_mov_b32 s42, 1572864
  s_cbranch_vccnz Lpace_52
  s_waitcnt vmcnt(6)
Lpace_52:
  buffer_load_dwordx4 v9, s[8:11], s42 offen lds
  s_add_u32 m0, s41, 106496
  s_mov_b32 s42, 1703936
  s_cbranch_vccnz Lpace_53
  s_waitcnt vmcnt(6)
Lpace_53:
  buffer_load_dwordx4 v8, s[8:11], s42 offen lds
  s_add_u32 m0, s41, 110592
  s_mov_b32 s42, 1703936
  s_cbranch_vccnz Lpace_54
  s_waitcnt vmcnt(6)
Lpace_54:
  buffer_load_dwordx4 v9, s[8:11], s42 offen lds
  s_waitcnt vmcnt(24) lgkmcnt(0)
  s_barrier
  s_add_u32 m0, s41, 114688
  s_mov_b32 s42, 1835008
  s_cbranch_vccnz Lpace_55
  s_waitcnt vmcnt(6)
Lpace_55:
  buffer_load_dwordx4 v8, s[8:11], s42 offen lds
  s_add_u32 m0, s41, 118784
  s_mov_b32 s42, 1835008
  s_cbranch_vccnz Lpace_56
  s_waitcnt vmcnt(6)
Lpace_56:
  buffer_load_dwordx4 v9, s[8:11], s42 offen lds
  s_add_u32 m0, s41, 122880
  s_mov_b32 s42, 1966080
  s_cbranch_vccnz Lpace_57
  s_waitcnt vmcnt(6)
Lpace_57:
  buffer_load_dwordx4 v8, s[8:11], s42 offen lds
  s_add_u32 m0, s41, 126976
  s_mov_b32 s42, 1966080
  s_cbranch_vccnz Lpace_58
  s_waitcnt vmcnt(6)
Lpace_58:
  buffer_load_dwordx4 v9, s[8:11], s42 offen lds
  ds_read_b64_tr_b16 a[0:1], v6 offset:0
  ds_read_b64_tr_b16 a[2:3], v6 offset:2048
  ds_read_b64_tr_b16 a[128:129], v6 offset:4096
  ds_read_b64_tr_b16 a[130:131], v6 offset:6144
  ds_read_b64_tr_b16 a[4:5], v6 offset:8192
  ds_read_b64_tr_b16 a[6:7], v6 offset:10240
  ds_read_b64_tr_b16 a[132:133], v6 offset:12288
  ds_read_b64_tr_b16 a[134:135], v6 offset:14336
  s_waitcnt vmcnt(24) lgkmcnt(0)
  s_barrier
  s_add_u32 m0, s41, 0
  s_mov_b32 s42, 4194304
  s_cbranch_vccnz Lpace_59
  s_waitcnt vmcnt(6)
Lpace_59:
  buffer_load_dwordx4 v8, s[8:11], s42 offen lds
  s_add_u32 m0, s41, 4096
  s_mov_b32 s42, 4194304
  s_cbranch_vccnz Lpace_60
  s_waitcnt vmcnt(6)
Lpace_60:
  buffer_load_dwordx4 v9, s[8:11], s42 offen lds
  s_add_u32 m0, s41, 8192
  s_mov_b32 s42, 4325376
  s_cbranch_vccnz Lpace_61
  s_waitcnt vmcnt(6)
Lpace_61:
  buffer_load_dwordx4 v8, s[8:11], s42 offen lds
  s_add_u32 m0, s41, 12288
  s_mov_b32 s42, 4325376
  s_cbranch_vccnz Lpace_62
  s_waitcnt vmcnt(6)
Lpace_62:
  buffer_load_dwordx4 v9, s[8:11], s42 offen lds
  ds_read_b64_tr_b16 a[8:9], v6 offset:16384
  ds_read_b64_tr_b16 a[10:11], v6 offset:18432
  ds_read_b64_tr_b16 a[136:137], v6 offset:20480
  ds_read_b64_tr_b16 a[138:139], v6 offset:22528
  ds_read_b64_tr_b16 a[12:13], v6 offset:24576
  ds_read_b64_tr_b16 a[14:15], v6 offset:26624
  ds_read_b64_tr_b16 a[140:141], v6 offset:28672
  ds_read_b64_tr_b16 a[142:143], v6 offset:30720
  s_waitcnt vmcnt(24) lgkmcnt(0)
  s_barrier
  s_add_u32 m0, s41, 16384
  s_mov_b32 s42, 4456448
  s_cbranch_vccnz Lpace_63
  s_waitcnt vmcnt(6)
Lpace_63:
  buffer_load_dwordx4 v8, s[8:11], s42 offen lds
  s_add_u32 m0, s41, 20480
  s_mov_b32 s42, 4456448
  s_cbranch_vccnz Lpace_64
  s_waitcnt vmcnt(6)
Lpace_64:
  buffer_load_dwordx4 v9, s[8:11], s42 offen lds
  s_add_u32 m0, s41, 24576
  s_mov_b32 s42, 4587520
  s_cbranch_vccnz Lpace_65
  s_waitcnt vmcnt(6)
Lpace_65:
  buffer_load_dwordx4 v8, s[8:11], s42 offen lds
  s_add_u32 m0, s41, 28672
  s_mov_b32 s42, 4587520
  s_cbranch_vccnz Lpace_66
  s_waitcnt vmcnt(6)
Lpace_66:
  buffer_load_dwordx4 v9, s[8:11], s42 offen lds
  ds_read_b64_tr_b16 a[16:17], v6 offset:32768
  ds_read_b64_tr_b16 a[18:19], v6 offset:34816
  ds_read_b64_tr_b16 a[144:145], v6 offset:36864
  ds_read_b64_tr_b16 a[146:147], v6 offset:38912
  ds_read_b64_tr_b16 a[20:21], v6 offset:40960
  ds_read_b64_tr_b16 a[22:23], v6 offset:43008
  ds_read_b64_tr_b16 a[148:149], v6 offset:45056
  ds_read_b64_tr_b16 a[150:151], v6 offset:47104
  s_waitcnt vmcnt(24) lgkmcnt(0)
  s_barrier
  s_add_u32 m0, s41, 32768
  s_mov_b32 s42, 4718592
  s_cbranch_vccnz Lpace_67
  s_waitcnt vmcnt(6)
Lpace_67:
  buffer_load_dwordx4 v8, s[8:11], s42 offen lds
  s_add_u32 m0, s41, 36864
  s_mov_b32 s42, 4718592
  s_cbranch_vccnz Lpace_68
  s_waitcnt vmcnt(6)
Lpace_68:
  buffer_load_dwordx4 v9, s[8:11], s42 offen lds
  s_add_u32 m0, s41, 40960
  s_mov_b32 s42, 4849664
  s_cbranch_vccnz Lpace_69
  s_waitcnt vmcnt(6)
Lpace_69:
  buffer_load_dwordx4 v8, s[8:11], s42 offen lds
  s_add_u32 m0, s41, 45056
  s_mov_b32 s42, 4849664
  s_cbranch_vccnz Lpace_70
  s_waitcnt vmcnt(6)
Lpace_70:
  buffer_load_dwordx4 v9, s[8:11], s42 offen lds
  ds_read_b64_tr_b16 a[24:25], v6 offset:49152
  ds_read_b64_tr_b16 a[26:27], v6 offset:51200
  ds_read_b64_tr_b16 a[152:153], v6 offset:53248
  ds_read_b64_tr_b16 a[154:155], v6 offset:55296
  ds_read_b64_tr_b16 a[28:29], v6 offset:57344
  ds_read_b64_tr_b16 a[30:31], v6 offset:59392
  ds_read_b64_tr_b16 a[156:157], v6 offset:61440
  ds_read_b64_tr_b16 a[158:159], v6 offset:63488
  s_waitcnt vmcnt(24) lgkmcnt(0)
  s_barrier
  s_add_u32 m0, s41, 49152
  s_mov_b32 s42, 4980736
  s_cbranch_vccnz Lpace_71
  s_waitcnt vmcnt(6)
Lpace_71:
  buffer_load_dwordx4 v8, s[8:11], s42 offen lds
  s_add_u32 m0, s41, 53248
  s_mov_b32 s42, 4980736
  s_cbranch_vccnz Lpace_72
  s_waitcnt vmcnt(6)
Lpace_72:
  buffer_load_dwordx4 v9, s[8:11], s42 offen lds
  s_add_u32 m0, s41, 57344
  s_mov_b32 s42, 5111808
  s_cbranch_vccnz Lpace_73
  s_waitcnt vmcnt(6)
Lpace_73:
  buffer_load_dwordx4 v8, s[8:11], s42 offen lds
  s_add_u32 m0, s41, 61440
  s_mov_b32 s42, 5111808
  s_cbranch_vccnz Lpace_74
  s_waitcnt vmcnt(6)
Lpace_74:
  buffer_load_dwordx4 v9, s[8:11], s42 offen lds
  ds_read_b64_tr_b16 a[32:33], v7 offset:0
  ds_read_b64_tr_b16 a[34:35], v7 offset:2048
  ds_read_b64_tr_b16 a[160:161], v7 offset:4096
  ds_read_b64_tr_b16 a[162:163], v7 offset:6144
  ds_read_b64_tr_b16 a[36:37], v7 offset:8192
  ds_read_b64_tr_b16 a[38:39], v7 offset:10240
  ds_read_b64_tr_b16 a[164:165], v7 offset:12288
  ds_read_b64_tr_b16 a[166:167], v7 offset:14336
  s_waitcnt vmcnt(24) lgkmcnt(0)
  s_barrier
  s_add_u32 m0, s41, 65536
  s_mov_b32 s42, 5242880
  s_cbranch_vccnz Lpace_75
  s_waitcnt vmcnt(6)
Lpace_75:
  buffer_load_dwordx4 v8, s[8:11], s42 offen lds
  s_add_u32 m0, s41, 69632
  s_mov_b32 s42, 5242880
  s_cbranch_vccnz Lpace_76
  s_waitcnt vmcnt(6)
Lpace_76:
  buffer_load_dwordx4 v9, s[8:11], s42 offen lds
  s_add_u32 m0, s41, 73728
  s_mov_b32 s42, 5373952
  s_cbranch_vccnz Lpace_77
  s_waitcnt vmcnt(6)
Lpace_77:
  buffer_load_dwordx4 v8, s[8:11], s42 offen lds
  s_add_u32 m0, s41, 77824
  s_mov_b32 s42, 5373952
  s_cbranch_vccnz Lpace_78
  s_waitcnt vmcnt(6)
Lpace_78:
  buffer_load_dwordx4 v9, s[8:11], s42 offen lds
  ds_read_b64_tr_b16 a[40:41], v7 offset:16384
  ds_read_b64_tr_b16 a[42:43], v7 offset:18432
  ds_read_b64_tr_b16 a[168:169], v7 offset:20480
  ds_read_b64_tr_b16 a[170:171], v7 offset:22528
  ds_read_b64_tr_b16 a[44:45], v7 offset:24576
  ds_read_b64_tr_b16 a[46:47], v7 offset:26624
  ds_read_b64_tr_b16 a[172:173], v7 offset:28672
  ds_read_b64_tr_b16 a[174:175], v7 offset:30720
  s_waitcnt vmcnt(24) lgkmcnt(0)
  s_barrier
  s_add_u32 m0, s41, 81920
  s_mov_b32 s42, 5505024
  s_cbranch_vccnz Lpace_79
  s_waitcnt vmcnt(6)
Lpace_79:
  buffer_load_dwordx4 v8, s[8:11], s42 offen lds
  s_add_u32 m0, s41, 86016
  s_mov_b32 s42, 5505024
  s_cbranch_vccnz Lpace_80
  s_waitcnt vmcnt(6)
Lpace_80:
  buffer_load_dwordx4 v9, s[8:11], s42 offen lds
  s_add_u32 m0, s41, 90112
  s_mov_b32 s42, 5636096
  s_cbranch_vccnz Lpace_81
  s_waitcnt vmcnt(6)
Lpace_81:
  buffer_load_dwordx4 v8, s[8:11], s42 offen lds
  s_add_u32 m0, s41, 94208
  s_mov_b32 s42, 5636096
  s_cbranch_vccnz Lpace_82
  s_waitcnt vmcnt(6)
Lpace_82:
  buffer_load_dwordx4 v9, s[8:11], s42 offen lds
  ds_read_b64_tr_b16 a[48:49], v7 offset:32768
  ds_read_b64_tr_b16 a[50:51], v7 offset:34816
  ds_read_b64_tr_b16 a[176:177], v7 offset:36864
  ds_read_b64_tr_b16 a[178:179], v7 offset:38912
  ds_read_b64_tr_b16 a[52:53], v7 offset:40960
  ds_read_b64_tr_b16 a[54:55], v7 offset:43008
  ds_read_b64_tr_b16 a[180:181], v7 offset:45056
  ds_read_b64_tr_b16 a[182:183], v7 offset:47104
  s_waitcnt vmcnt(24) lgkmcnt(0)
  s_barrier
  s_add_u32 m0, s41, 98304
  s_mov_b32 s42, 5767168
  s_cbranch_vccnz Lpace_83
  s_waitcnt vmcnt(6)
Lpace_83:
  buffer_load_dwordx4 v8, s[8:11], s42 offen lds
  s_add_u32 m0, s41, 102400
  s_mov_b32 s42, 5767168
  s_cbranch_vccnz Lpace_84
  s_waitcnt vmcnt(6)
Lpace_84:
  buffer_load_dwordx4 v9, s[8:11], s42 offen lds
  s_add_u32 m0, s41, 106496
  s_mov_b32 s42, 5898240
  s_cbranch_vccnz Lpace_85
  s_waitcnt vmcnt(6)
Lpace_85:
  buffer_load_dwordx4 v8, s[8:11], s42 offen lds
  s_add_u32 m0, s41, 110592
  s_mov_b32 s42, 5898240
  s_cbranch_vccnz Lpace_86
  s_waitcnt vmcnt(6)
Lpace_86:
  buffer_load_dwordx4 v9, s[8:11], s42 offen lds
  ds_read_b64_tr_b16 a[56:57], v7 offset:49152
  ds_read_b64_tr_b16 a[58:59], v7 offset:51200
  ds_read_b64_tr_b16 a[184:185], v7 offset:53248
  ds_read_b64_tr_b16 a[186:187], v7 offset:55296
  ds_read_b64_tr_b16 a[60:61], v7 offset:57344
  ds_read_b64_tr_b16 a[62:63], v7 offset:59392
  ds_read_b64_tr_b16 a[188:189], v7 offset:61440
  ds_read_b64_tr_b16 a[190:191], v7 offset:63488
  s_waitcnt vmcnt(24) lgkmcnt(0)
  s_barrier
  s_add_u32 m0, s41, 114688
  s_mov_b32 s42, 6029312
  s_cbranch_vccnz Lpace_87
  s_waitcnt vmcnt(6)
Lpace_87:
  buffer_load_dwordx4 v8, s[8:11], s42 offen lds
  s_add_u32 m0, s41, 118784
  s_mov_b32 s42, 6029312
  s_cbranch_vccnz Lpace_88
  s_waitcnt vmcnt(6)
Lpace_88:
  buffer_load_dwordx4 v9, s[8:11], s42 offen lds
  s_add_u32 m0, s41, 122880
  s_mov_b32 s42, 6160384
  s_cbranch_vccnz Lpace_89
  s_waitcnt vmcnt(6)
Lpace_89:
  buffer_load_dwordx4 v8, s[8:11], s42 offen lds
  s_add_u32 m0, s41, 126976
  s_mov_b32 s42, 6160384
  s_cbranch_vccnz Lpace_90
  s_waitcnt vmcnt(6)
Lpace_90:
  buffer_load_dwordx4 v9, s[8:11], s42 offen lds
  ds_read_b64_tr_b16 a[64:65], v6 offset:0
  ds_read_b64_tr_b16 a[66:67], v6 offset:2048
  ds_read_b64_tr_b16 a[192:193], v6 offset:4096
  ds_read_b64_tr_b16 a[194:195], v6 offset:6144
  ds_read_b64_tr_b16 a[68:69], v6 offset:8192
  ds_read_b64_tr_b16 a[70:71], v6 offset:10240
  ds_read_b64_tr_b16 a[196:197], v6 offset:12288
  ds_read_b64_tr_b16 a[198:199], v6 offset:14336
  s_waitcnt vmcnt(24) lgkmcnt(0)
  s_barrier
  s_load_dwordx2 s[8:9], s[0:1], 32
  s_mov_b32 s10, 8388608
  s_mov_b32 s11, 0x20000
  s_waitcnt lgkmcnt(0)
  s_add_u32 m0, s41, 0
  s_mov_b32 s42, 0
  s_cbranch_vccnz Lpace_91
  s_waitcnt vmcnt(6)
Lpace_91:
  buffer_load_dwordx4 v10, s[8:11], s42 offen lds
  s_add_u32 m0, s41, 4096
  s_mov_b32 s42, 131072
  s_cbranch_vccnz Lpace_92
  s_waitcnt vmcnt(6)
Lpace_92:
  buffer_load_dwordx4 v10, s[8:11], s42 offen lds
  s_add_u32 m0, s41, 8192
  s_mov_b32 s42, 262144
  s_cbranch_vccnz Lpace_93
  s_waitcnt vmcnt(6)
Lpace_93:
  buffer_load_dwordx4 v10, s[8:11], s42 offen lds
  s_add_u32 m0, s41, 12288
  s_mov_b32 s42, 393216
  s_cbranch_vccnz Lpace_94
  s_waitcnt vmcnt(6)
Lpace_94:
  buffer_load_dwordx4 v10, s[8:11], s42 offen lds
  ds_read_b64_tr_b16 a[72:73], v6 offset:16384
  ds_read_b64_tr_b16 a[74:75], v6 offset:18432
  ds_read_b64_tr_b16 a[200:201], v6 offset:20480
  ds_read_b64_tr_b16 a[202:203], v6 offset:22528
  ds_read_b64_tr_b16 a[76:77], v6 offset:24576
  ds_read_b64_tr_b16 a[78:79], v6 offset:26624
  ds_read_b64_tr_b16 a[204:205], v6 offset:28672
  ds_read_b64_tr_b16 a[206:207], v6 offset:30720
  s_waitcnt vmcnt(24) lgkmcnt(0)
  s_barrier
  s_add_u32 m0, s41, 16384
  s_mov_b32 s42, 524288
  s_cbranch_vccnz Lpace_95
  s_waitcnt vmcnt(6)
Lpace_95:
  buffer_load_dwordx4 v10, s[8:11], s42 offen lds
  s_add_u32 m0, s41, 20480
  s_mov_b32 s42, 655360
  s_cbranch_vccnz Lpace_96
  s_waitcnt vmcnt(6)
Lpace_96:
  buffer_load_dwordx4 v10, s[8:11], s42 offen lds
  s_add_u32 m0, s41, 24576
  s_mov_b32 s42, 786432
  s_cbranch_vccnz Lpace_97
  s_waitcnt vmcnt(6)
Lpace_97:
  buffer_load_dwordx4 v10, s[8:11], s42 offen lds
  s_add_u32 m0, s41, 28672
  s_mov_b32 s42, 917504
  s_cbranch_vccnz Lpace_98
  s_waitcnt vmcnt(6)
Lpace_98:
  buffer_load_dwordx4 v10, s[8:11], s42 offen lds
  ds_read_b64_tr_b16 a[80:81], v6 offset:32768
  ds_read_b64_tr_b16 a[82:83], v6 offset:34816
  ds_read_b64_tr_b16 a[208:209], v6 offset:36864
  ds_read_b64_tr_b16 a[210:211], v6 offset:38912
  ds_read_b64_tr_b16 a[84:85], v6 offset:40960
  ds_read_b64_tr_b16 a[86:87], v6 offset:43008
  ds_read_b64_tr_b16 a[212:213], v6 offset:45056
  ds_read_b64_tr_b16 a[214:215], v6 offset:47104
  s_cmp_lg_u32 s20, 0
  s_cbranch_scc1 L_QKV_noinit
Lini_99:
  s_load_dwordx16 s[64:79], s[12:13], 128 glc
  s_load_dwordx16 s[80:95], s[12:13], 192 glc
  s_sub_u32 s24, s24, 1
  s_cbranch_scc1 L_FAIL
  s_waitcnt lgkmcnt(0)
  s_and_b64 s[64:65], s[64:65], s[66:67]
  s_and_b64 s[64:65], s[64:65], s[68:69]
  s_and_b64 s[64:65], s[64:65], s[70:71]
  s_and_b64 s[64:65], s[64:65], s[72:73]
  s_and_b64 s[64:65], s[64:65], s[74:75]
  s_and_b64 s[64:65], s[64:65], s[76:77]
  s_and_b64 s[64:65], s[64:65], s[78:79]
  s_and_b64 s[64:65], s[64:65], s[80:81]
  s_and_b64 s[64:65], s[64:65], s[82:83]
  s_and_b64 s[64:65], s[64:65], s[84:85]
  s_and_b64 s[64:65], s[64:65], s[86:87]
  s_and_b64 s[64:65], s[64:65], s[88:89]
  s_and_b64 s[64:65], s[64:65], s[90:91]
  s_and_b64 s[64:65], s[64:65], s[92:93]
  s_and_b64 s[64:65], s[64:65], s[94:95]
  s_and_b32 s64, s64, s65
  s_cbranch_scc0 Lini_99
L_QKV_noinit:
  s_waitcnt vmcnt(24) lgkmcnt(0)
  s_barrier
  s_add_u32 m0, s41, 32768
  s_mov_b32 s42, 1048576
  s_cbranch_vccnz Lpace_100
  s_waitcnt vmcnt(6)
Lpace_100:
  buffer_load_dwordx4 v10, s[8:11], s42 offen lds
  s_add_u32 m0, s41, 36864
  s_mov_b32 s42, 1179648
  s_cbranch_vccnz Lpace_101
  s_waitcnt vmcnt(6)
Lpace_101:
  buffer_load_dwordx4 v10, s[8:11], s42 offen lds
  s_add_u32 m0, s41, 40960
  s_mov_b32 s42, 1310720
  s_cbranch_vccnz Lpace_102
  s_waitcnt vmcnt(6)
Lpace_102:
  buffer_load_dwordx4 v10, s[8:11], s42 offen lds
  s_add_u32 m0, s41, 45056
  s_mov_b32 s42, 1441792
  s_cbranch_vccnz Lpace_103
  s_waitcnt vmcnt(6)
Lpace_103:
  buffer_load_dwordx4 v10, s[8:11], s42 offen lds
  ds_read_b64_tr_b16 a[88:89], v6 offset:49152
  ds_read_b64_tr_b16 a[90:91], v6 offset:51200
  ds_read_b64_tr_b16 a[216:217], v6 offset:53248
  ds_read_b64_tr_b16 a[218:219], v6 offset:55296
  ds_read_b64_tr_b16 a[92:93], v6 offset:57344
  ds_read_b64_tr_b16 a[94:95], v6 offset:59392
  ds_read_b64_tr_b16 a[220:221], v6 offset:61440
  ds_read_b64_tr_b16 a[222:223], v6 offset:63488
  s_waitcnt vmcnt(24) lgkmcnt(0)
  s_barrier
  s_add_u32 m0, s41, 49152
  s_mov_b32 s42, 1572864
  s_cbranch_vccnz Lpace_104
  s_waitcnt vmcnt(6)
Lpace_104:
  buffer_load_dwordx4 v10, s[8:11], s42 offen lds
  s_add_u32 m0, s41, 53248
  s_mov_b32 s42, 1703936
  s_cbranch_vccnz Lpace_105
  s_waitcnt vmcnt(6)
Lpace_105:
  buffer_load_dwordx4 v10, s[8:11], s42 offen lds
  s_add_u32 m0, s41, 57344
  s_mov_b32 s42, 1835008
  s_cbranch_vccnz Lpace_106
  s_waitcnt vmcnt(6)
Lpace_106:
  buffer_load_dwordx4 v10, s[8:11], s42 offen lds
  s_add_u32 m0, s41, 61440
  s_mov_b32 s42, 1966080
  s_cbranch_vccnz Lpace_107
  s_waitcnt vmcnt(6)
Lpace_107:
  buffer_load_dwordx4 v10, s[8:11], s42 offen lds
  ds_read_b64_tr_b16 a[96:97], v7 offset:0
  ds_read_b64_tr_b16 a[98:99], v7 offset:2048
  ds_read_b64_tr_b16 a[224:225], v7 offset:4096
  ds_read_b64_tr_b16 a[226:227], v7 offset:6144
  ds_read_b64_tr_b16 a[100:101], v7 offset:8192
  ds_read_b64_tr_b16 a[102:103], v7 offset:10240
  ds_read_b64_tr_b16 a[228:229], v7 offset:12288
  ds_read_b64_tr_b16 a[230:231], v7 offset:14336
  s_waitcnt vmcnt(24) lgkmcnt(0)
  s_barrier
  s_add_u32 m0, s41, 65536
  s_mov_b32 s42, 4194304
  s_cbranch_vccnz Lpace_108
  s_waitcnt vmcnt(6)
Lpace_108:
  buffer_load_dwordx4 v10, s[8:11], s42 offen lds
  s_add_u32 m0, s41, 69632
  s_mov_b32 s42, 4325376
  s_cbranch_vccnz Lpace_109
  s_waitcnt vmcnt(6)
Lpace_109:
  buffer_load_dwordx4 v10, s[8:11], s42 offen lds
  s_add_u32 m0, s41, 73728
  s_mov_b32 s42, 4456448
  s_cbranch_vccnz Lpace_110
  s_waitcnt vmcnt(6)
Lpace_110:
  buffer_load_dwordx4 v10, s[8:11], s42 offen lds
  s_add_u32 m0, s41, 77824
  s_mov_b32 s42, 4587520
  s_cbranch_vccnz Lpace_111
  s_waitcnt vmcnt(6)
Lpace_111:
  buffer_load_dwordx4 v10, s[8:11], s42 offen lds
  ds_read_b64_tr_b16 a[104:105], v7 offset:16384
  ds_read_b64_tr_b16 a[106:107], v7 offset:18432
  ds_read_b64_tr_b16 a[232:233], v7 offset:20480
  ds_read_b64_tr_b16 a[234:235], v7 offset:22528
  ds_read_b64_tr_b16 a[108:109], v7 offset:24576
  ds_read_b64_tr_b16 a[110:111], v7 offset:26624
  ds_read_b64_tr_b16 a[236:237], v7 offset:28672
  ds_read_b64_tr_b16 a[238:239], v7 offset:30720
  s_waitcnt vmcnt(24) lgkmcnt(0)
  s_barrier
  s_add_u32 m0, s41, 81920
  s_mov_b32 s42, 4718592
  s_cbranch_vccnz Lpace_112
  s_waitcnt vmcnt(6)
Lpace_112:
  buffer_load_dwordx4 v10, s[8:11], s42 offen lds
  s_add_u32 m0, s41, 86016
  s_mov_b32 s42, 4849664
  s_cbranch_vccnz Lpace_113
  s_waitcnt vmcnt(6)
Lpace_113:
  buffer_load_dwordx4 v10, s[8:11], s42 offen lds
  s_add_u32 m0, s41, 90112
  s_mov_b32 s42, 4980736
  s_cbranch_vccnz Lpace_114
  s_waitcnt vmcnt(6)
Lpace_114:
  buffer_load_dwordx4 v10, s[8:11], s42 offen lds
  s_add_u32 m0, s41, 94208
  s_mov_b32 s42, 5111808
  s_cbranch_vccnz Lpace_115
  s_waitcnt vmcnt(6)
Lpace_115:
  buffer_load_dwordx4 v10, s[8:11], s42 offen lds
  ds_read_b64_tr_b16 a[112:113], v7 offset:32768
  ds_read_b64_tr_b16 a[114:115], v7 offset:34816
  ds_read_b64_tr_b16 a[240:241], v7 offset:36864
  ds_read_b64_tr_b16 a[242:243], v7 offset:38912
  ds_read_b64_tr_b16 a[116:117], v7 offset:40960
  ds_read_b64_tr_b16 a[118:119], v7 offset:43008
  ds_read_b64_tr_b16 a[244:245], v7 offset:45056
  ds_read_b64_tr_b16 a[246:247], v7 offset:47104
  s_waitcnt vmcnt(24) lgkmcnt(0)
  s_barrier
  s_add_u32 m0, s41, 98304
  s_mov_b32 s42, 5242880
  s_cbranch_vccnz Lpace_116
  s_waitcnt vmcnt(6)
Lpace_116:
  buffer_load_dwordx4 v10, s[8:11], s42 offen lds
  s_add_u32 m0, s41, 102400
  s_mov_b32 s42, 5373952
  s_cbranch_vccnz Lpace_117
  s_waitcnt vmcnt(6)
Lpace_117:
  buffer_load_dwordx4 v10, s[8:11], s42 offen lds
  s_add_u32 m0, s41, 106496
  s_mov_b32 s42, 5505024
  s_cbranch_vccnz Lpace_118
  s_waitcnt vmcnt(6)
Lpace_118:
  buffer_load_dwordx4 v10, s[8:11], s42 offen lds
  s_add_u32 m0, s41, 110592
  s_mov_b32 s42, 5636096
  s_cbranch_vccnz Lpace_119
  s_waitcnt vmcnt(6)
Lpace_119:
  buffer_load_dwordx4 v10, s[8:11], s42 offen lds
  ds_read_b64_tr_b16 a[120:121], v7 offset:49152
  ds_read_b64_tr_b16 a[122:123], v7 offset:51200
  ds_read_b64_tr_b16 a[248:249], v7 offset:53248
  ds_read_b64_tr_b16 a[250:251], v7 offset:55296
  ds_read_b64_tr_b16 a[124:125], v7 offset:57344
  ds_read_b64_tr_b16 a[126:127], v7 offset:59392
  ds_read_b64_tr_b16 a[252:253], v7 offset:61440
  ds_read_b64_tr_b16 a[254:255], v7 offset:63488
  s_waitcnt vmcnt(24) lgkmcnt(0)
  s_barrier
  s_add_u32 m0, s41, 114688
  s_mov_b32 s42, 5767168
  s_cbranch_vccnz Lpace_120
  s_waitcnt vmcnt(6)
Lpace_120:
  buffer_load_dwordx4 v10, s[8:11], s42 offen lds
  s_add_u32 m0, s41, 118784
  s_mov_b32 s42, 5898240
  s_cbranch_vccnz Lpace_121
  s_waitcnt vmcnt(6)
Lpace_121:
  buffer_load_dwordx4 v10, s[8:11], s42 offen lds
  s_add_u32 m0, s41, 122880
  s_mov_b32 s42, 6029312
  s_cbranch_vccnz Lpace_122
  s_waitcnt vmcnt(6)
Lpace_122:
  buffer_load_dwordx4 v10, s[8:11], s42 offen lds
  s_add_u32 m0, s41, 126976
  s_mov_b32 s42, 6160384
  s_cbranch_vccnz Lpace_123
  s_waitcnt vmcnt(6)
Lpace_123:
  buffer_load_dwordx4 v10, s[8:11], s42 offen lds
  ds_read_b64_tr_b16 v[128:129], v6 offset:0
  ds_read_b64_tr_b16 v[130:131], v6 offset:2048
  ds_read_b64_tr_b16 v[132:133], v6 offset:4096
  ds_read_b64_tr_b16 v[134:135], v6 offset:6144
  ds_read_b64_tr_b16 v[136:137], v6 offset:8192
  ds_read_b64_tr_b16 v[138:139], v6 offset:10240
  ds_read_b64_tr_b16 v[140:141], v6 offset:12288
  ds_read_b64_tr_b16 v[142:143], v6 offset:14336
  s_waitcnt vmcnt(24) lgkmcnt(0)
  s_barrier
  ds_read_b64_tr_b16 v[144:145], v6 offset:16384
  ds_read_b64_tr_b16 v[146:147], v6 offset:18432
  ds_read_b64_tr_b16 v[148:149], v6 offset:20480
  ds_read_b64_tr_b16 v[150:151], v6 offset:22528
  ds_read_b64_tr_b16 v[152:153], v6 offset:24576
  ds_read_b64_tr_b16 v[154:155], v6 offset:26624
  ds_read_b64_tr_b16 v[156:157], v6 offset:28672
  ds_read_b64_tr_b16 v[158:159], v6 offset:30720
  s_waitcnt vmcnt(20) lgkmcnt(0)
  s_barrier
  ds_read_b64_tr_b16 v[160:161], v6 offset:32768
  ds_read_b64_tr_b16 v[162:163], v6 offset:34816
  ds_read_b64_tr_b16 v[164:165], v6 offset:36864
  ds_read_b64_tr_b16 v[166:167], v6 offset:38912
  ds_read_b64_tr_b16 v[168:169], v6 offset:40960
  ds_read_b64_tr_b16 v[170:171], v6 offset:43008
  ds_read_b64_tr_b16 v[172:173], v6 offset:45056
  ds_read_b64_tr_b16 v[174:175], v6 offset:47104
  s_waitcnt vmcnt(16) lgkmcnt(0)
  s_barrier
  ds_read_b64_tr_b16 v[176:177], v6 offset:49152
  ds_read_b64_tr_b16 v[178:179], v6 offset:51200
  ds_read_b64_tr_b16 v[180:181], v6 offset:53248
  ds_read_b64_tr_b16 v[182:183], v6 offset:55296
  ds_read_b64_tr_b16 v[184:185], v6 offset:57344
  ds_read_b64_tr_b16 v[186:187], v6 offset:59392
  ds_read_b64_tr_b16 v[188:189], v6 offset:61440
  ds_read_b64_tr_b16 v[190:191], v6 offset:63488
  s_waitcnt vmcnt(12) lgkmcnt(0)
  s_barrier
  ds_read_b64_tr_b16 v[192:193], v7 offset:0
  ds_read_b64_tr_b16 v[194:195], v7 offset:2048
  ds_read_b64_tr_b16 v[196:197], v7 offset:4096
  ds_read_b64_tr_b16 v[198:199], v7 offset:6144
  ds_read_b64_tr_b16 v[200:201], v7 offset:8192
  ds_read_b64_tr_b16 v[202:203], v7 offset:10240
  ds_read_b64_tr_b16 v[204:205], v7 offset:12288
  ds_read_b64_tr_b16 v[206:207], v7 offset:14336
  s_waitcnt vmcnt(8) lgkmcnt(0)
  s_barrier
  buffer_load_dword v3, v2, s[4:7], 0 offen sc1
  buffer_load_dword v65, v64, s[4:7], 0 offen sc1
  ds_read_b64_tr_b16 v[208:209], v7 offset:16384
  ds_read_b64_tr_b16 v[210:211], v7 offset:18432
  ds_read_b64_tr_b16 v[212:213], v7 offset:20480
  ds_read_b64_tr_b16 v[214:215], v7 offset:22528
  ds_read_b64_tr_b16 v[216:217], v7 offset:24576
  ds_read_b64_tr_b16 v[218:219], v7 offset:26624
  ds_read_b64_tr_b16 v[220:221], v7 offset:28672
  ds_read_b64_tr_b16 v[222:223], v7 offset:30720
  s_waitcnt vmcnt(6) lgkmcnt(0)
  s_barrier
  ds_read_b64_tr_b16 v[224:225], v7 offset:32768
  ds_read_b64_tr_b16 v[226:227], v7 offset:34816
  ds_read_b64_tr_b16 v[228:229], v7 offset:36864
  ds_read_b64_tr_b16 v[230:231], v7 offset:38912
  ds_read_b64_tr_b16 v[232:233], v7 offset:40960
  ds_read_b64_tr_b16 v[234:235], v7 offset:43008
  ds_read_b64_tr_b16 v[236:237], v7 offset:45056
  ds_read_b64_tr_b16 v[238:239], v7 offset:47104
  s_waitcnt vmcnt(2) lgkmcnt(0)
  s_barrier
  ds_read_b64_tr_b16 v[240:241], v7 offset:49152
  ds_read_b64_tr_b16 v[242:243], v7 offset:51200
  ds_read_b64_tr_b16 v[244:245], v7 offset:53248
  ds_read_b64_tr_b16 v[246:247], v7 offset:55296
  ds_read_b64_tr_b16 v[248:249], v7 offset:57344
  ds_read_b64_tr_b16 v[250:251], v7 offset:59392
  ds_read_b64_tr_b16 v[252:253], v7 offset:61440
  ds_read_b64_tr_b16 v[254:255], v7 offset:63488
  s_waitcnt lgkmcnt(0)
  s_barrier
  s_lshr_b32 s62, s21, 2
  s_lshl_b32 s62, s62, 7
  s_and_b32 s40, s21, 3
  s_lshl_b32 s40, s40, 2
  s_add_u32 s62, s62, s40
  s_add_u32 s62, s62, 1396736
  s_mov_b32 s27, 6291456
  s_lshr_b32 s40, s21, 1
  s_mul_i32 s40, s40, 65536
  s_mov_b32 s31, 0
  s_and_b32 s41, s21, 1
  s_lshl_b32 s42, s20, 11
  s_add_u32 s42, s42, s40
  s_lshl_b32 s40, s41, 14
  s_add_u32 s40, s40, s42
  v_lshl_add_u32 v76, v0, 4, s40
  s_lshl_b32 s40, s41, 10
  s_add_u32 s40, s40, s42
  s_add_u32 s40, s40, 32768
  s_xor_b32 s40, s40, 65536
  v_lshl_add_u32 v83, v0, 4, s40
  s_mov_b32 s25, 0
  s_mov_b32 s37, 2147483392
  s_mov_b32 s30, 0
  s_mov_b32 s34, s32
  s_mov_b32 s35, s27
  v_mov_b32 v81, v77
  v_mov_b32 v82, v78
  s_waitcnt vmcnt(0)
  v_cmp_gt_i32 vcc, 1, v3
  s_cbranch_vccz L_QKV_rows
  s_nop 3
Lpoll_124:
  buffer_load_dword v3, v2, s[4:7], 0 offen sc1
  s_sub_u32 s24, s24, 1
  s_cbranch_scc1 L_FAIL
  s_waitcnt vmcnt(0)
  v_cmp_gt_i32 vcc, 1, v3
  s_cbranch_vccz Lpolld_125
  s_sleep 1
  s_branch Lpoll_124
Lpolld_125:
L_QKV_rows:
  v_cmp_gt_i32 vcc, 0, v65
  s_cbranch_vccz Ltab_126
  s_nop 3
Lpoll_127:
  buffer_load_dword v65, v64, s[4:7], 0 offen sc1
  s_sub_u32 s24, s24, 1
  s_cbranch_scc1 L_FAIL
  s_waitcnt vmcnt(0)
  v_cmp_gt_i32 vcc, 0, v65
  s_cbranch_vccz Lpolld_128
  s_sleep 1
  s_branch Lpoll_127
Lpolld_128:
Ltab_126:
  v_lshrrev_b32 v65, 8, v65
  v_and_b32 v66, 3, v0
  v_lshl_or_b32 v65, v65, 2, v66
  s_nop 1
  v_min_u32_dpp v65, v65, v65 row_ror:8 row_mask:0xf bank_mask:0xf
  s_nop 1
  v_min_u32_dpp v65, v65, v65 row_ror:4 row_mask:0xf bank_mask:0xf
  v_mov_b32 v66, v65
  s_nop 1
  v_permlane16_swap_b32 v66, v65
  v_min_u32 v65, v65, v66
  v_mov_b32 v66, v65
  s_nop 1
  v_permlane32_swap_b32 v66, v65
  v_min_u32 v65, v65, v66
  s_nop 1
  v_min_u32_dpp v65, v65, v65 row_ror:2 row_mask:0xf bank_mask:0xf
  s_nop 1
  v_min_u32_dpp v65, v65, v65 row_ror:1 row_mask:0xf bank_mask:0xf
  s_nop 0
  v_readfirstlane_b32 s40, v65
  s_and_b32 s40, s40, 3
  s_lshl_b32 s40, s40, 13
  s_and_b32 s40, s40, 0x2000
  s_xor_b32 s40, s40, 20971520
  s_add_u32 s31, s31, s40
  s_add_u32 m0, s34, 0
  s_nop 0
  buffer_load_dwordx4 v1, s[4:7], s35 offen offset:0 sc1 lds
  s_add_u32 m0, s34, 3968
  s_nop 0
  buffer_load_dwordx4 v1, s[4:7], s35 offen offset:128 sc1 lds
  s_add_u32 m0, s34, 7936
  s_nop 0
  buffer_load_dwordx4 v1, s[4:7], s35 offen offset:256 sc1 lds
  s_add_u32 m0, s34, 11904
  s_nop 0
  buffer_load_dwordx4 v1, s[4:7], s35 offen offset:384 sc1 lds
  s_add_u32 m0, s34, 15872
  s_nop 0
  buffer_load_dwordx4 v1, s[4:7], s35 offen offset:512 sc1 lds
  s_add_u32 m0, s34, 19840
  s_nop 0
  buffer_load_dwordx4 v1, s[4:7], s35 offen offset:640 sc1 lds
  s_add_u32 m0, s34, 23808
  s_nop 0
  buffer_load_dwordx4 v1, s[4:7], s35 offen offset:768 sc1 lds
  s_add_u32 m0, s34, 27776
  s_nop 0
  buffer_load_dwordx4 v1, s[4:7], s35 offen offset:896 sc1 lds
  s_add_u32 m0, s34, 31744
  s_nop 0
  buffer_load_dwordx4 v1, s[4:7], s35 offen offset:1024 sc1 lds
  s_add_u32 m0, s34, 35712
  s_nop 0
  buffer_load_dwordx4 v1, s[4:7], s35 offen offset:1152 sc1 lds
  s_add_u32 m0, s34, 39680
  s_nop 0
  buffer_load_dwordx4 v1, s[4:7], s35 offen offset:1280 sc1 lds
  s_add_u32 m0, s34, 43648
  s_nop 0
  buffer_load_dwordx4 v1, s[4:7], s35 offen offset:1408 sc1 lds
  s_add_u32 m0, s34, 47616
  s_nop 0
  buffer_load_dwordx4 v1, s[4:7], s35 offen offset:1536 sc1 lds
  s_add_u32 m0, s34, 51584
  s_nop 0
  buffer_load_dwordx4 v1, s[4:7], s35 offen offset:1664 sc1 lds
  s_add_u32 m0, s34, 55552
  s_nop 0
  buffer_load_dwordx4 v1, s[4:7], s35 offen offset:1792 sc1 lds
  s_add_u32 m0, s34, 59520
  s_nop 0
  buffer_load_dwordx4 v1, s[4:7], s35 offen offset:1920 sc1 lds
  s_waitcnt vmcnt(13)
  s_barrier
  ds_read_b128 v[4:7], v81 offset:0
  ds_read_b128 v[8:11], v81 offset:2048
  ds_read_b128 v[12:15], v82 offset:0
  ds_read_b128 v[16:19], v82 offset:2048
  ds_read_b128 v[20:23], v81 offset:4096
  ds_read_b128 v[24:27], v81 offset:6144
  s_nop 0
  s_nop 0
  s_nop 0
  s_nop 0
  s_nop 0
  s_nop 0
  s_nop 0
L_QKV_top:
  s_waitcnt lgkmcnt(4)
  v_cvt_pk_bf16_f32 v60, v36, v37
  v_cvt_pk_bf16_f32 v61, v38, v39
  v_mfma_f32_16x16x32_bf16 v[36:39], a[0:3], v[4:7], 0
  v_cvt_pk_bf16_f32 v62, v44, v45
  v_cvt_pk_bf16_f32 v63, v46, v47
  v_mfma_f32_16x16x32_bf16 v[44:47], a[128:131], v[4:7], 0
  v_cvt_pk_bf16_f32 v64, v40, v41
  v_cvt_pk_bf16_f32 v65, v42, v43
  v_mfma_f32_16x16x32_bf16 v[40:43], a[0:3], v[8:11], 0
  v_cvt_pk_bf16_f32 v66, v48, v49
  v_cvt_pk_bf16_f32 v67, v50, v51
  v_mfma_f32_16x16x32_bf16 v[48:51], a[128:131], v[8:11], 0
  v_cvt_pk_bf16_f32 v68, v52, v53
  v_cvt_pk_bf16_f32 v69, v54, v55
  v_mfma_f32_16x16x32_bf16 v[52:55], v[4:7], v[128:131], 0
  ds_read_b128 v[28:31], v82 offset:4096
  v_cvt_pk_bf16_f32 v70, v56, v57
  v_cvt_pk_bf16_f32 v71, v58, v59
  v_mfma_f32_16x16x32_bf16 v[56:59], v[8:11], v[128:131], 0
  ds_read_b128 v[32:35], v82 offset:6144
  s_waitcnt lgkmcnt(4)
  v_mfma_f32_16x16x32_bf16 v[36:39], a[4:7], v[12:15], v[36:39]
  ds_read_b128 v[4:7], v81 offset:8192
  v_mfma_f32_16x16x32_bf16 v[44:47], a[132:135], v[12:15], v[44:47]
  ds_read_b128 v[8:11], v81 offset:10240
  v_mfma_f32_16x16x32_bf16 v[40:43], a[4:7], v[16:19], v[40:43]
  buffer_store_dwordx4 v[60:63], v76, s[4:7], s37 offen offset:0 sc1
  v_mfma_f32_16x16x32_bf16 v[48:51], a[132:135], v[16:19], v[48:51]
  buffer_store_dwordx4 v[64:67], v76, s[4:7], s37 offen offset:1024 sc1
  v_mfma_f32_16x16x32_bf16 v[52:55], v[12:15], v[132:135], v[52:55]
  v_mfma_f32_16x16x32_bf16 v[56:59], v[16:19], v[132:135], v[56:59]
  s_nop 0
  s_waitcnt lgkmcnt(4)
  v_mfma_f32_16x16x32_bf16 v[36:39], a[8:11], v[20:23], v[36:39]
  ds_read_b128 v[12:15], v82 offset:8192
  v_mfma_f32_16x16x32_bf16 v[44:47], a[136:139], v[20:23], v[44:47]
  ds_read_b128 v[16:19], v82 offset:10240
  v_mfma_f32_16x16x32_bf16 v[40:43], a[8:11], v[24:27], v[40:43]
  buffer_store_dwordx4 v[68:71], v83, s[4:7], s37 offen sc1
  v_mfma_f32_16x16x32_bf16 v[48:51], a[136:139], v[24:27], v[48:51]
  v_cmp_gt_i32_e64 vcc, 1, v3
  v_mfma_f32_16x16x32_bf16 v[52:55], v[20:23], v[136:139], v[52:55]
  v_mfma_f32_16x16x32_bf16 v[56:59], v[24:27], v[136:139], v[56:59]
  s_xor_b32 s34, s34, 0x10000
  s_add_u32 s35, s35, 65536
  s_cbranch_vccz L_QKV_have
  s_nop 4
Lpoll_129:
  buffer_load_dword v3, v2, s[4:7], s30 offen sc1
  s_sub_u32 s24, s24, 1
  s_cbranch_scc1 L_FAIL
  s_waitcnt vmcnt(0)
  v_cmp_gt_i32 vcc, 1, v3
  s_cbranch_vccz Lpolld_130
  s_sleep 1
  s_branch Lpoll_129
Lpolld_130:
L_QKV_have:
  s_waitcnt vmcnt(11)
  s_barrier
  s_waitcnt lgkmcnt(4)
  v_mfma_f32_16x16x32_bf16 v[36:39], a[12:15], v[28:31], v[36:39]
  ds_read_b128 v[20:23], v81 offset:12288
  v_mfma_f32_16x16x32_bf16 v[44:47], a[140:143], v[28:31], v[44:47]
  ds_read_b128 v[24:27], v81 offset:14336
  v_mfma_f32_16x16x32_bf16 v[40:43], a[12:15], v[32:35], v[40:43]
  s_add_u32 m0, s34, 0
  s_nop 0
  buffer_load_dwordx4 v1, s[4:7], s35 offen offset:0 sc1 lds
  v_mfma_f32_16x16x32_bf16 v[48:51], a[140:143], v[32:35], v[48:51]
  v_mfma_f32_16x16x32_bf16 v[52:55], v[28:31], v[140:143], v[52:55]
  v_mfma_f32_16x16x32_bf16 v[56:59], v[32:35], v[140:143], v[56:59]
  s_waitcnt lgkmcnt(4)
  v_mfma_f32_16x16x32_bf16 v[36:39], a[16:19], v[4:7], v[36:39]
  ds_read_b128 v[28:31], v82 offset:12288
  v_mfma_f32_16x16x32_bf16 v[44:47], a[144:147], v[4:7], v[44:47]
  ds_read_b128 v[32:35], v82 offset:14336
  v_mfma_f32_16x16x32_bf16 v[40:43], a[16:19], v[8:11], v[40:43]
  s_add_u32 m0, s34, 3968
  s_nop 0
  buffer_load_dwordx4 v1, s[4:7], s35 offen offset:128 sc1 lds
  v_mfma_f32_16x16x32_bf16 v[48:51], a[144:147], v[8:11], v[48:51]
  v_mfma_f32_16x16x32_bf16 v[52:55], v[4:7], v[144:147], v[52:55]
  v_mfma_f32_16x16x32_bf16 v[56:59], v[8:11], v[144:147], v[56:59]
  s_waitcnt lgkmcnt(4)
  v_mfma_f32_16x16x32_bf16 v[36:39], a[20:23], v[12:15], v[36:39]
  ds_read_b128 v[4:7], v81 offset:16384
  v_mfma_f32_16x16x32_bf16 v[44:47], a[148:151], v[12:15], v[44:47]
  ds_read_b128 v[8:11], v81 offset:18432
  v_mfma_f32_16x16x32_bf16 v[40:43], a[20:23], v[16:19], v[40:43]
  s_add_u32 m0, s34, 7936
  s_nop 0
  buffer_load_dwordx4 v1, s[4:7], s35 offen offset:256 sc1 lds
  v_mfma_f32_16x16x32_bf16 v[48:51], a[148:151], v[16:19], v[48:51]
  v_mfma_f32_16x16x32_bf16 v[52:55], v[12:15], v[148:151], v[52:55]
  v_mfma_f32_16x16x32_bf16 v[56:59], v[16:19], v[148:151], v[56:59]
  s_waitcnt lgkmcnt(4)
  v_mfma_f32_16x16x32_bf16 v[36:39], a[24:27], v[20:23], v[36:39]
  ds_read_b128 v[12:15], v82 offset:16384
  v_mfma_f32_16x16x32_bf16 v[44:47], a[152:155], v[20:23], v[44:47]
  ds_read_b128 v[16:19], v82 offset:18432
  v_mfma_f32_16x16x32_bf16 v[40:43], a[24:27], v[24:27], v[40:43]
  s_add_u32 m0, s34, 11904
  s_nop 0
  buffer_load_dwordx4 v1, s[4:7], s35 offen offset:384 sc1 lds
  v_mfma_f32_16x16x32_bf16 v[48:51], a[152:155], v[24:27], v[48:51]
  v_mfma_f32_16x16x32_bf16 v[52:55], v[20:23], v[152:155], v[52:55]
  v_mfma_f32_16x16x32_bf16 v[56:59], v[24:27], v[152:155], v[56:59]
  s_waitcnt lgkmcnt(4)
  v_mfma_f32_16x16x32_bf16 v[36:39], a[28:31], v[28:31], v[36:39]
  ds_read_b128 v[20:23], v81 offset:20480
  v_mfma_f32_16x16x32_bf16 v[44:47], a[156:159], v[28:31], v[44:47]
  ds_read_b128 v[24:27], v81 offset:22528
  v_mfma_f32_16x16x32_bf16 v[40:43], a[28:31], v[32:35], v[40:43]
  s_add_u32 m0, s34, 15872
  s_nop 0
  buffer_load_dwordx4 v1, s[4:7], s35 offen offset:512 sc1 lds
  v_mfma_f32_16x16x32_bf16 v[48:51], a[156:159], v[32:35], v[48:51]
  v_mfma_f32_16x16x32_bf16 v[52:55], v[28:31], v[156:159], v[52:55]
  v_mfma_f32_16x16x32_bf16 v[56:59], v[32:35], v[156:159], v[56:59]
  s_waitcnt lgkmcnt(4)
  v_mfma_f32_16x16x32_bf16 v[36:39], a[32:35], v[4:7], v[36:39]
  ds_read_b128 v[28:31], v82 offset:20480
  v_mfma_f32_16x16x32_bf16 v[44:47], a[160:163], v[4:7], v[44:47]
  ds_read_b128 v[32:35], v82 offset:22528
  v_mfma_f32_16x16x32_bf16 v[40:43], a[32:35], v[8:11], v[40:43]
  s_add_u32 m0, s34, 19840
  s_nop 0
  buffer_load_dwordx4 v1, s[4:7], s35 offen offset:640 sc1 lds
  v_mfma_f32_16x16x32_bf16 v[48:51], a[160:163], v[8:11], v[48:51]
  v_mfma_f32_16x16x32_bf16 v[52:55], v[4:7], v[160:163], v[52:55]
  v_mfma_f32_16x16x32_bf16 v[56:59], v[8:11], v[160:163], v[56:59]
  s_waitcnt lgkmcnt(4)
  v_mfma_f32_16x16x32_bf16 v[36:39], a[36:39], v[12:15], v[36:39]
  ds_read_b128 v[4:7], v81 offset:24576
  v_mfma_f32_16x16x32_bf16 v[44:47], a[164:167], v[12:15], v[44:47]
  ds_read_b128 v[8:11], v81 offset:26624
  v_mfma_f32_16x16x32_bf16 v[40:43], a[36:39], v[16:19], v[40:43]
  s_add_u32 m0, s34, 23808
  s_nop 0
  buffer_load_dwordx4 v1, s[4:7], s35 offen offset:768 sc1 lds
  v_mfma_f32_16x16x32_bf16 v[48:51], a[164:167], v[16:19], v[48:51]
  v_mfma_f32_16x16x32_bf16 v[52:55], v[12:15], v[164:167], v[52:55]
  v_mfma_f32_16x16x32_bf16 v[56:59], v[16:19], v[164:167], v[56:59]
  s_waitcnt lgkmcnt(4)
  v_mfma_f32_16x16x32_bf16 v[36:39], a[40:43], v[20:23], v[36:39]
  ds_read_b128 v[12:15], v82 offset:24576
  v_mfma_f32_16x16x32_bf16 v[44:47], a[168:171], v[20:23], v[44:47]
  ds_read_b128 v[16:19], v82 offset:26624
  v_mfma_f32_16x16x32_bf16 v[40:43], a[40:43], v[24:27], v[40:43]
  s_add_u32 m0, s34, 27776
  s_nop 0
  buffer_load_dwordx4 v1, s[4:7], s35 offen offset:896 sc1 lds
  v_mfma_f32_16x16x32_bf16 v[48:51], a[168:171], v[24:27], v[48:51]
  v_mfma_f32_16x16x32_bf16 v[52:55], v[20:23], v[168:171], v[52:55]
  v_mfma_f32_16x16x32_bf16 v[56:59], v[24:27], v[168:171], v[56:59]
  s_waitcnt lgkmcnt(4)
  v_mfma_f32_16x16x32_bf16 v[36:39], a[44:47], v[28:31], v[36:39]
  ds_read_b128 v[20:23], v81 offset:28672
  v_mfma_f32_16x16x32_bf16 v[44:47], a[172:175], v[28:31], v[44:47]
  ds_read_b128 v[24:27], v81 offset:30720
  v_mfma_f32_16x16x32_bf16 v[40:43], a[44:47], v[32:35], v[40:43]
  s_add_u32 m0, s34, 31744
  s_nop 0
  buffer_load_dwordx4 v1, s[4:7], s35 offen offset:1024 sc1 lds
  v_mfma_f32_16x16x32_bf16 v[48:51], a[172:175], v[32:35], v[48:51]
  v_mfma_f32_16x16x32_bf16 v[52:55], v[28:31], v[172:175], v[52:55]
  v_mfma_f32_16x16x32_bf16 v[56:59], v[32:35], v[172:175], v[56:59]
  s_waitcnt vmcnt(9)
  s_barrier
  s_cmp_lg_u32 s20, 0
  s_cbranch_scc1 Lnosig_131
  s_mov_b32 s63, s25
  s_atomic_smax s63, s[4:5], s62 glc
Lnosig_131:
  s_waitcnt lgkmcnt(4)
  v_mfma_f32_16x16x32_bf16 v[36:39], a[48:51], v[4:7], v[36:39]
  ds_read_b128 v[28:31], v82 offset:28672
  v_mfma_f32_16x16x32_bf16 v[44:47], a[176:179], v[4:7], v[44:47]
  ds_read_b128 v[32:35], v82 offset:30720
  v_mfma_f32_16x16x32_bf16 v[40:43], a[48:51], v[8:11], v[40:43]
  s_add_u32 m0, s34, 35712
  s_nop 0
  buffer_load_dwordx4 v1, s[4:7], s35 offen offset:1152 sc1 lds
  v_mfma_f32_16x16x32_bf16 v[48:51], a[176:179], v[8:11], v[48:51]
  v_mfma_f32_16x16x32_bf16 v[52:55], v[4:7], v[176:179], v[52:55]
  v_mfma_f32_16x16x32_bf16 v[56:59], v[8:11], v[176:179], v[56:59]
  s_waitcnt lgkmcnt(4)
  v_mfma_f32_16x16x32_bf16 v[36:39], a[52:55], v[12:15], v[36:39]
  ds_read_b128 v[4:7], v81 offset:32768
  v_mfma_f32_16x16x32_bf16 v[44:47], a[180:183], v[12:15], v[44:47]
  ds_read_b128 v[8:11], v81 offset:34816
  v_mfma_f32_16x16x32_bf16 v[40:43], a[52:55], v[16:19], v[40:43]
  s_add_u32 m0, s34, 39680
  s_nop 0
  buffer_load_dwordx4 v1, s[4:7], s35 offen offset:1280 sc1 lds
  v_mfma_f32_16x16x32_bf16 v[48:51], a[180:183], v[16:19], v[48:51]
  v_mfma_f32_16x16x32_bf16 v[52:55], v[12:15], v[180:183], v[52:55]
  v_mfma_f32_16x16x32_bf16 v[56:59], v[16:19], v[180:183], v[56:59]
  s_waitcnt lgkmcnt(4)
  v_mfma_f32_16x16x32_bf16 v[36:39], a[56:59], v[20:23], v[36:39]
  ds_read_b128 v[12:15], v82 offset:32768
  v_mfma_f32_16x16x32_bf16 v[44:47], a[184:187], v[20:23], v[44:47]
  ds_read_b128 v[16:19], v82 offset:34816
  v_mfma_f32_16x16x32_bf16 v[40:43], a[56:59], v[24:27], v[40:43]
  s_add_u32 m0, s34, 43648
  s_nop 0
  buffer_load_dwordx4 v1, s[4:7], s35 offen offset:1408 sc1 lds
  v_mfma_f32_16x16x32_bf16 v[48:51], a[184:187], v[24:27], v[48:51]
  v_mfma_f32_16x16x32_bf16 v[52:55], v[20:23], v[184:187], v[52:55]
  v_mfma_f32_16x16x32_bf16 v[56:59], v[24:27], v[184:187], v[56:59]
  s_waitcnt lgkmcnt(4)
  v_mfma_f32_16x16x32_bf16 v[36:39], a[60:63], v[28:31], v[36:39]
  ds_read_b128 v[20:23], v81 offset:36864
  v_mfma_f32_16x16x32_bf16 v[44:47], a[188:191], v[28:31], v[44:47]
  ds_read_b128 v[24:27], v81 offset:38912
  v_mfma_f32_16x16x32_bf16 v[40:43], a[60:63], v[32:35], v[40:43]
  s_add_u32 m0, s34, 47616
  s_nop 0
  buffer_load_dwordx4 v1, s[4:7], s35 offen offset:1536 sc1 lds
  v_mfma_f32_16x16x32_bf16 v[48:51], a[188:191], v[32:35], v[48:51]
  v_mfma_f32_16x16x32_bf16 v[52:55], v[28:31], v[188:191], v[52:55]
  v_mfma_f32_16x16x32_bf16 v[56:59], v[32:35], v[188:191], v[56:59]
  s_waitcnt lgkmcnt(4)
  v_mfma_f32_16x16x32_bf16 v[36:39], a[64:67], v[4:7], v[36:39]
  ds_read_b128 v[28:31], v82 offset:36864
  v_mfma_f32_16x16x32_bf16 v[44:47], a[192:195], v[4:7], v[44:47]
  ds_read_b128 v[32:35], v82 offset:38912
  v_mfma_f32_16x16x32_bf16 v[40:43], a[64:67], v[8:11], v[40:43]
  s_add_u32 m0, s34, 51584
  s_nop 0
  buffer_load_dwordx4 v1, s[4:7], s35 offen offset:1664 sc1 lds
  v_mfma_f32_16x16x32_bf16 v[48:51], a[192:195], v[8:11], v[48:51]
  v_mfma_f32_16x16x32_bf16 v[52:55], v[4:7], v[192:195], v[52:55]
  v_mfma_f32_16x16x32_bf16 v[56:59], v[8:11], v[192:195], v[56:59]
  s_waitcnt lgkmcnt(4)
  v_mfma_f32_16x16x32_bf16 v[36:39], a[68:71], v[12:15], v[36:39]
  ds_read_b128 v[4:7], v81 offset:40960
  v_mfma_f32_16x16x32_bf16 v[44:47], a[196:199], v[12:15], v[44:47]
  ds_read_b128 v[8:11], v81 offset:43008
  v_mfma_f32_16x16x32_bf16 v[40:43], a[68:71], v[16:19], v[40:43]
  s_add_u32 m0, s34, 55552
  s_nop 0
  buffer_load_dwordx4 v1, s[4:7], s35 offen offset:1792 sc1 lds
  v_mfma_f32_16x16x32_bf16 v[48:51], a[196:199], v[16:19], v[48:51]
  v_mfma_f32_16x16x32_bf16 v[52:55], v[12:15], v[196:199], v[52:55]
  v_mfma_f32_16x16x32_bf16 v[56:59], v[16:19], v[196:199], v[56:59]
  s_waitcnt lgkmcnt(4)
  v_mfma_f32_16x16x32_bf16 v[36:39], a[72:75], v[20:23], v[36:39]
  ds_read_b128 v[12:15], v82 offset:40960
  v_mfma_f32_16x16x32_bf16 v[44:47], a[200:203], v[20:23], v[44:47]
  ds_read_b128 v[16:19], v82 offset:43008
  v_mfma_f32_16x16x32_bf16 v[40:43], a[72:75], v[24:27], v[40:43]
  s_add_u32 m0, s34, 59520
  s_nop 0
  buffer_load_dwordx4 v1, s[4:7], s35 offen offset:1920 sc1 lds
  v_mfma_f32_16x16x32_bf16 v[48:51], a[200:203], v[24:27], v[48:51]
  v_mfma_f32_16x16x32_bf16 v[52:55], v[20:23], v[200:203], v[52:55]
  v_mfma_f32_16x16x32_bf16 v[56:59], v[24:27], v[200:203], v[56:59]
  s_waitcnt lgkmcnt(4)
  v_mfma_f32_16x16x32_bf16 v[36:39], a[76:79], v[28:31], v[36:39]
  ds_read_b128 v[20:23], v81 offset:45056
  v_mfma_f32_16x16x32_bf16 v[44:47], a[204:207], v[28:31], v[44:47]
  ds_read_b128 v[24:27], v81 offset:47104
  v_mfma_f32_16x16x32_bf16 v[40:43], a[76:79], v[32:35], v[40:43]
  v_mfma_f32_16x16x32_bf16 v[48:51], a[204:207], v[32:35], v[48:51]
  v_mfma_f32_16x16x32_bf16 v[52:55], v[28:31], v[204:207], v[52:55]
  v_mfma_f32_16x16x32_bf16 v[56:59], v[32:35], v[204:207], v[56:59]
  s_waitcnt lgkmcnt(4)
  v_mfma_f32_16x16x32_bf16 v[36:39], a[80:83], v[4:7], v[36:39]
  ds_read_b128 v[28:31], v82 offset:45056
  v_mfma_f32_16x16x32_bf16 v[44:47], a[208:211], v[4:7], v[44:47]
  ds_read_b128 v[32:35], v82 offset:47104
  v_mfma_f32_16x16x32_bf16 v[40:43], a[80:83], v[8:11], v[40:43]
  s_add_u32 s30, s25, 2
  s_and_b32 s30, s30, 56
  s_lshl_b32 s30, s30, 7
  buffer_load_dword v3, v2, s[4:7], s30 offen sc1
  v_mfma_f32_16x16x32_bf16 v[48:51], a[208:211], v[8:11], v[48:51]
  v_mfma_f32_16x16x32_bf16 v[52:55], v[4:7], v[208:211], v[52:55]
  v_mfma_f32_16x16x32_bf16 v[56:59], v[8:11], v[208:211], v[56:59]
  s_waitcnt lgkmcnt(4)
  v_mfma_f32_16x16x32_bf16 v[36:39], a[84:87], v[12:15], v[36:39]
  ds_read_b128 v[4:7], v81 offset:49152
  v_mfma_f32_16x16x32_bf16 v[44:47], a[212:215], v[12:15], v[44:47]
  ds_read_b128 v[8:11], v81 offset:51200
  v_mfma_f32_16x16x32_bf16 v[40:43], a[84:87], v[16:19], v[40:43]
  v_mfma_f32_16x16x32_bf16 v[48:51], a[212:215], v[16:19], v[48:51]
  v_mfma_f32_16x16x32_bf16 v[52:55], v[12:15], v[212:215], v[52:55]
  v_mfma_f32_16x16x32_bf16 v[56:59], v[16:19], v[212:215], v[56:59]
  s_waitcnt lgkmcnt(4)
  v_mfma_f32_16x16x32_bf16 v[36:39], a[88:91], v[20:23], v[36:39]
  ds_read_b128 v[12:15], v82 offset:49152
  v_mfma_f32_16x16x32_bf16 v[44:47], a[216:219], v[20:23], v[44:47]
  ds_read_b128 v[16:19], v82 offset:51200
  v_mfma_f32_16x16x32_bf16 v[40:43], a[88:91], v[24:27], v[40:43]
  v_mfma_f32_16x16x32_bf16 v[48:51], a[216:219], v[24:27], v[48:51]
  v_mfma_f32_16x16x32_bf16 v[52:55], v[20:23], v[216:219], v[52:55]
  v_mfma_f32_16x16x32_bf16 v[56:59], v[24:27], v[216:219], v[56:59]
  s_waitcnt lgkmcnt(4)
  v_mfma_f32_16x16x32_bf16 v[36:39], a[92:95], v[28:31], v[36:39]
  ds_read_b128 v[20:23], v81 offset:53248
  v_mfma_f32_16x16x32_bf16 v[44:47], a[220:223], v[28:31], v[44:47]
  ds_read_b128 v[24:27], v81 offset:55296
  v_mfma_f32_16x16x32_bf16 v[40:43], a[92:95], v[32:35], v[40:43]
  v_mfma_f32_16x16x32_bf16 v[48:51], a[220:223], v[32:35], v[48:51]
  v_mfma_f32_16x16x32_bf16 v[52:55], v[28:31], v[220:223], v[52:55]
  v_mfma_f32_16x16x32_bf16 v[56:59], v[32:35], v[220:223], v[56:59]
  s_waitcnt lgkmcnt(4)
  v_mfma_f32_16x16x32_bf16 v[36:39], a[96:99], v[4:7], v[36:39]
  ds_read_b128 v[28:31], v82 offset:53248
  v_mfma_f32_16x16x32_bf16 v[44:47], a[224:227], v[4:7], v[44:47]
  ds_read_b128 v[32:35], v82 offset:55296
  v_mfma_f32_16x16x32_bf16 v[40:43], a[96:99], v[8:11], v[40:43]
  v_mfma_f32_16x16x32_bf16 v[48:51], a[224:227], v[8:11], v[48:51]
  v_mfma_f32_16x16x32_bf16 v[52:55], v[4:7], v[224:227], v[52:55]
  v_mfma_f32_16x16x32_bf16 v[56:59], v[8:11], v[224:227], v[56:59]
  s_waitcnt lgkmcnt(4)
  v_mfma_f32_16x16x32_bf16 v[36:39], a[100:103], v[12:15], v[36:39]
  ds_read_b128 v[4:7], v81 offset:57344
  v_mfma_f32_16x16x32_bf16 v[44:47], a[228:231], v[12:15], v[44:47]
  ds_read_b128 v[8:11], v81 offset:59392
  v_mfma_f32_16x16x32_bf16 v[40:43], a[100:103], v[16:19], v[40:43]
  v_mfma_f32_16x16x32_bf16 v[48:51], a[228:231], v[16:19], v[48:51]
  v_mfma_f32_16x16x32_bf16 v[52:55], v[12:15], v[228:231], v[52:55]
  v_mfma_f32_16x16x32_bf16 v[56:59], v[16:19], v[228:231], v[56:59]
  s_waitcnt lgkmcnt(4)
  v_mfma_f32_16x16x32_bf16 v[36:39], a[104:107], v[20:23], v[36:39]
  ds_read_b128 v[12:15], v82 offset:57344
  v_mfma_f32_16x16x32_bf16 v[44:47], a[232:235], v[20:23], v[44:47]
  ds_read_b128 v[16:19], v82 offset:59392
  v_mfma_f32_16x16x32_bf16 v[40:43], a[104:107], v[24:27], v[40:43]
  v_mfma_f32_16x16x32_bf16 v[48:51], a[232:235], v[24:27], v[48:51]
  v_mfma_f32_16x16x32_bf16 v[52:55], v[20:23], v[232:235], v[52:55]
  v_mfma_f32_16x16x32_bf16 v[56:59], v[24:27], v[232:235], v[56:59]
  s_waitcnt lgkmcnt(4)
  v_mfma_f32_16x16x32_bf16 v[36:39], a[108:111], v[28:31], v[36:39]
  ds_read_b128 v[20:23], v81 offset:61440
  v_mfma_f32_16x16x32_bf16 v[44:47], a[236:239], v[28:31], v[44:47]
  ds_read_b128 v[24:27], v81 offset:63488
  v_mfma_f32_16x16x32_bf16 v[40:43], a[108:111], v[32:35], v[40:43]
  v_mfma_f32_16x16x32_bf16 v[48:51], a[236:239], v[32:35], v[48:51]
  v_mfma_f32_16x16x32_bf16 v[52:55], v[28:31], v[236:239], v[52:55]
  v_mfma_f32_16x16x32_bf16 v[56:59], v[32:35], v[236:239], v[56:59]
  s_waitcnt lgkmcnt(4)
  v_mfma_f32_16x16x32_bf16 v[36:39], a[112:115], v[4:7], v[36:39]
  ds_read_b128 v[28:31], v82 offset:61440
  v_mfma_f32_16x16x32_bf16 v[44:47], a[240:243], v[4:7], v[44:47]
  ds_read_b128 v[32:35], v82 offset:63488
  v_mfma_f32_16x16x32_bf16 v[40:43], a[112:115], v[8:11], v[40:43]
  v_mfma_f32_16x16x32_bf16 v[48:51], a[240:243], v[8:11], v[48:51]
  v_mfma_f32_16x16x32_bf16 v[52:55], v[4:7], v[240:243], v[52:55]
  v_mfma_f32_16x16x32_bf16 v[56:59], v[8:11], v[240:243], v[56:59]
  s_waitcnt vmcnt(0)
  s_barrier
  v_xor_b32 v81, 0x10000, v81
  v_xor_b32 v82, 0x10000, v82
  s_waitcnt lgkmcnt(4)
  v_mfma_f32_16x16x32_bf16 v[36:39], a[116:119], v[12:15], v[36:39]
  ds_read_b128 v[4:7], v81 offset:0
  v_mfma_f32_16x16x32_bf16 v[44:47], a[244:247], v[12:15], v[44:47]
  ds_read_b128 v[8:11], v81 offset:2048
  v_mfma_f32_16x16x32_bf16 v[40:43], a[116:119], v[16:19], v[40:43]
  v_mfma_f32_16x16x32_bf16 v[48:51], a[244:247], v[16:19], v[48:51]
  v_mfma_f32_16x16x32_bf16 v[52:55], v[12:15], v[244:247], v[52:55]
  v_mfma_f32_16x16x32_bf16 v[56:59], v[16:19], v[244:247], v[56:59]
  s_waitcnt lgkmcnt(4)
  v_mfma_f32_16x16x32_bf16 v[36:39], a[120:123], v[20:23], v[36:39]
  ds_read_b128 v[12:15], v82 offset:0
  v_mfma_f32_16x16x32_bf16 v[44:47], a[248:251], v[20:23], v[44:47]
  ds_read_b128 v[16:19], v82 offset:2048
  v_mfma_f32_16x16x32_bf16 v[40:43], a[120:123], v[24:27], v[40:43]
  v_mfma_f32_16x16x32_bf16 v[48:51], a[248:251], v[24:27], v[48:51]
  v_mfma_f32_16x16x32_bf16 v[52:55], v[20:23], v[248:251], v[52:55]
  v_mfma_f32_16x16x32_bf16 v[56:59], v[24:27], v[248:251], v[56:59]
  s_waitcnt lgkmcnt(4)
  v_mfma_f32_16x16x32_bf16 v[36:39], a[124:127], v[28:31], v[36:39]
  ds_read_b128 v[20:23], v81 offset:4096
  v_mfma_f32_16x16x32_bf16 v[44:47], a[252:255], v[28:31], v[44:47]
  ds_read_b128 v[24:27], v81 offset:6144
  v_mfma_f32_16x16x32_bf16 v[40:43], a[124:127], v[32:35], v[40:43]
  v_mfma_f32_16x16x32_bf16 v[48:51], a[252:255], v[32:35], v[48:51]
  v_mfma_f32_16x16x32_bf16 v[52:55], v[28:31], v[252:255], v[52:55]
  v_mfma_f32_16x16x32_bf16 v[56:59], v[32:35], v[252:255], v[56:59]
  s_mov_b32 s37, s31
  s_add_u32 s31, s31, 2097152
  s_xor_b32 s31, s31, 0x2000
  s_add_u32 s25, s25, 1
  s_cmp_lt_u32 s25, 64
  s_cbranch_scc1 L_QKV_top
  v_cvt_pk_bf16_f32 v60, v36, v37
  v_cvt_pk_bf16_f32 v61, v38, v39
  v_cvt_pk_bf16_f32 v62, v44, v45
  v_cvt_pk_bf16_f32 v63, v46, v47
  v_cvt_pk_bf16_f32 v64, v40, v41
  v_cvt_pk_bf16_f32 v65, v42, v43
  v_cvt_pk_bf16_f32 v66, v48, v49
  v_cvt_pk_bf16_f32 v67, v50, v51
  v_cvt_pk_bf16_f32 v68, v52, v53
  v_cvt_pk_bf16_f32 v69, v54, v55
  v_cvt_pk_bf16_f32 v70, v56, v57
  v_cvt_pk_bf16_f32 v71, v58, v59
  buffer_store_dwordx4 v[60:63], v76, s[4:7], s37 offen offset:0 sc1
  buffer_store_dwordx4 v[64:67], v76, s[4:7], s37 offen offset:1024 sc1
  buffer_store_dwordx4 v[68:71], v83, s[4:7], s37 offen sc1
  s_waitcnt vmcnt(0) lgkmcnt(0)
  s_barrier
  s_cmp_lg_u32 s20, 0
  s_cbranch_scc1 Lnosig_132
  s_mov_b32 s63, s25
  s_atomic_smax s63, s[4:5], s62 glc
Lnosig_132:
  s_branch L_END
L_WO:
  v_lshlrev_b32 v1, 4, v0
  s_lshl_b32 s32, s20, 12
  s_min_u32 s33, s32, 0x2000
  v_mov_b32 v69, v1
  v_add_u32 v70, 0x10000, v69
  s_load_dwordx2 s[8:9], s[0:1], 40
  s_mov_b32 s10, 8388608
  s_mov_b32 s11, 0x20000
  s_waitcnt lgkmcnt(0)
  s_lshr_b32 s44, s21, 3
  s_mul_i32 s44, s44, 2097152
  s_and_b32 s45, s21, 7
  s_lshl_b32 s45, s45, 8
  s_add_u32 s44, s44, s45
  s_add_u32 s45, s44, 128
  v_bfe_u32 v4, v0, 5, 1
  v_mul_u32_u24 v4, 8192, v4
  v_bfe_u32 v5, v0, 4, 1
  v_mul_u32_u24 v5, 4096, v5
  v_add_u32 v4, v4, v5
  v_bfe_u32 v5, v0, 3, 1
  v_mul_u32_u24 v5, 2048, v5
  v_add_u32 v4, v4, v5
  v_lshrrev_b32 v5, 3, v0
  v_and_b32 v5, 6, v5
  v_xor_b32 v5, v5, v0
  v_and_b32 v5, 7, v5
  v_lshl_add_u32 v4, v5, 4, v4
  s_lshr_b32 s40, s20, 1
  s_mul_i32 s40, s40, 131072
  s_and_b32 s41, s20, 1
  s_mul_i32 s41, s41, 16384
  s_add_u32 s40, s40, s41
  v_add_u32 v4, s40, v4
  v_bfe_u32 v5, v0, 3, 2
  v_xor_b32 v5, s20, v5
  v_lshlrev_b32 v5, 5, v5
  v_lshrrev_b32 v6, 2, v0
  v_lshl_add_u32 v6, v6, 7, v5
  v_and_b32 v5, 3, v0
  v_lshl_add_u32 v6, v5, 3, v6
  v_add_u32 v7, 0x10000, v6
  v_add_u32 v8, s44, v4
  v_add_u32 v9, s45, v4
  s_lshl_b32 s41, s20, 10
  s_add_u32 m0, s41, 0
  s_mov_b32 s42, 0
  buffer_load_dwordx4 v8, s[8:11], s42 offen nt lds
  s_add_u32 m0, s41, 4096
  s_mov_b32 s42, 0
  buffer_load_dwordx4 v9, s[8:11], s42 offen nt lds
  s_add_u32 m0, s41, 8192
  s_mov_b32 s42, 32768
  buffer_load_dwordx4 v8, s[8:11], s42 offen nt lds
  s_add_u32 m0, s41, 12288
  s_mov_b32 s42, 32768
  buffer_load_dwordx4 v9, s[8:11], s42 offen nt lds
  s_add_u32 m0, s41, 16384
  s_mov_b32 s42, 65536
  buffer_load_dwordx4 v8, s[8:11], s42 offen nt lds
  s_add_u32 m0, s41, 20480
  s_mov_b32 s42, 65536
  buffer_load_dwordx4 v9, s[8:11], s42 offen nt lds
  s_add_u32 m0, s41, 24576
  s_mov_b32 s42, 98304
  buffer_load_dwordx4 v8, s[8:11], s42 offen nt lds
  s_add_u32 m0, s41, 28672
  s_mov_b32 s42, 98304
  buffer_load_dwordx4 v9, s[8:11], s42 offen nt lds
  s_add_u32 m0, s41, 32768
  s_mov_b32 s42, 262144
  buffer_load_dwordx4 v8, s[8:11], s42 offen nt lds
  s_add_u32 m0, s41, 36864
  s_mov_b32 s42, 262144
  buffer_load_dwordx4 v9, s[8:11], s42 offen nt lds
  s_add_u32 m0, s41, 40960
  s_mov_b32 s42, 294912
  buffer_load_dwordx4 v8, s[8:11], s42 offen nt lds
  s_add_u32 m0, s41, 45056
  s_mov_b32 s42, 294912
  buffer_load_dwordx4 v9, s[8:11], s42 offen nt lds
  s_add_u32 m0, s41, 49152
  s_mov_b32 s42, 327680
  buffer_load_dwordx4 v8, s[8:11], s42 offen nt lds
  s_add_u32 m0, s41, 53248
  s_mov_b32 s42, 327680
  buffer_load_dwordx4 v9, s[8:11], s42 offen nt lds
  s_add_u32 m0, s41, 57344
  s_mov_b32 s42, 360448
  buffer_load_dwordx4 v8, s[8:11], s42 offen nt lds
  s_add_u32 m0, s41, 61440
  s_mov_b32 s42, 360448
  buffer_load_dwordx4 v9, s[8:11], s42 offen nt lds
  s_add_u32 m0, s41, 65536
  s_mov_b32 s42, 524288
  buffer_load_dwordx4 v8, s[8:11], s42 offen nt lds
  s_add_u32 m0, s41, 69632
  s_mov_b32 s42, 524288
  buffer_load_dwordx4 v9, s[8:11], s42 offen nt lds
  s_add_u32 m0, s41, 73728
  s_mov_b32 s42, 557056
  buffer_load_dwordx4 v8, s[8:11], s42 offen nt lds
  s_add_u32 m0, s41, 77824
  s_mov_b32 s42, 557056
  buffer_load_dwordx4 v9, s[8:11], s42 offen nt lds
  s_add_u32 m0, s41, 81920
  s_mov_b32 s42, 589824
  buffer_load_dwordx4 v8, s[8:11], s42 offen nt lds
  s_add_u32 m0, s41, 86016
  s_mov_b32 s42, 589824
  buffer_load_dwordx4 v9, s[8:11], s42 offen nt lds
  s_add_u32 m0, s41, 90112
  s_mov_b32 s42, 622592
  buffer_load_dwordx4 v8, s[8:11], s42 offen nt lds
  s_add_u32 m0, s41, 94208
  s_mov_b32 s42, 622592
  buffer_load_dwordx4 v9, s[8:11], s42 offen nt lds
  s_add_u32 m0, s41, 98304
  s_mov_b32 s42, 786432
  buffer_load_dwordx4 v8, s[8:11], s42 offen nt lds
  s_add_u32 m0, s41, 102400
  s_mov_b32 s42, 786432
  buffer_load_dwordx4 v9, s[8:11], s42 offen nt lds
  s_add_u32 m0, s41, 106496
  s_mov_b32 s42, 819200
  buffer_load_dwordx4 v8, s[8:11], s42 offen nt lds
  s_add_u32 m0, s41, 110592
  s_mov_b32 s42, 819200
  buffer_load_dwordx4 v9, s[8:11], s42 offen nt lds
  s_waitcnt vmcnt(24) lgkmcnt(0)
  s_barrier
  s_add_u32 m0, s41, 114688
  s_mov_b32 s42, 851968
  buffer_load_dwordx4 v8, s[8:11], s42 offen nt lds
  s_add_u32 m0, s41, 118784
  s_mov_b32 s42, 851968
  buffer_load_dwordx4 v9, s[8:11], s42 offen nt lds
  s_add_u32 m0, s41, 122880
  s_mov_b32 s42, 884736
  buffer_load_dwordx4 v8, s[8:11], s42 offen nt lds
  s_add_u32 m0, s41, 126976
  s_mov_b32 s42, 884736
  buffer_load_dwordx4 v9, s[8:11], s42 offen nt lds
  ds_read_b64_tr_b16 a[0:1], v6 offset:0
  ds_read_b64_tr_b16 a[2:3], v6 offset:2048
  ds_read_b64_tr_b16 a[128:129], v6 offset:4096
  ds_read_b64_tr_b16 a[130:131], v6 offset:6144
  ds_read_b64_tr_b16 a[4:5], v6 offset:8192
  ds_read_b64_tr_b16 a[6:7], v6 offset:10240
  ds_read_b64_tr_b16 a[132:133], v6 offset:12288
  ds_read_b64_tr_b16 a[134:135], v6 offset:14336
  s_waitcnt vmcnt(24) lgkmcnt(0)
  s_barrier
  s_add_u32 m0, s41, 0
  s_mov_b32 s42, 1048576
  buffer_load_dwordx4 v8, s[8:11], s42 offen nt lds
  s_add_u32 m0, s41, 4096
  s_mov_b32 s42, 1048576
  buffer_load_dwordx4 v9, s[8:11], s42 offen nt lds
  s_add_u32 m0, s41, 8192
  s_mov_b32 s42, 1081344
  buffer_load_dwordx4 v8, s[8:11], s42 offen nt lds
  s_add_u32 m0, s41, 12288
  s_mov_b32 s42, 1081344
  buffer_load_dwordx4 v9, s[8:11], s42 offen nt lds
  ds_read_b64_tr_b16 a[8:9], v6 offset:16384
  ds_read_b64_tr_b16 a[10:11], v6 offset:18432
  ds_read_b64_tr_b16 a[136:137], v6 offset:20480
  ds_read_b64_tr_b16 a[138:139], v6 offset:22528
  ds_read_b64_tr_b16 a[12:13], v6 offset:24576
  ds_read_b64_tr_b16 a[14:15], v6 offset:26624
  ds_read_b64_tr_b16 a[140:141], v6 offset:28672
  ds_read_b64_tr_b16 a[142:143], v6 offset:30720
  s_waitcnt vmcnt(24) lgkmcnt(0)
  s_barrier
  s_add_u32 m0, s41, 16384
  s_mov_b32 s42, 1114112
  buffer_load_dwordx4 v8, s[8:11], s42 offen nt lds
  s_add_u32 m0, s41, 20480
  s_mov_b32 s42, 1114112
  buffer_load_dwordx4 v9, s[8:11], s42 offen nt lds
  s_add_u32 m0, s41, 24576
  s_mov_b32 s42, 1146880
  buffer_load_dwordx4 v8, s[8:11], s42 offen nt lds
  s_add_u32 m0, s41, 28672
  s_mov_b32 s42, 1146880
  buffer_load_dwordx4 v9, s[8:11], s42 offen nt lds
  ds_read_b64_tr_b16 a[16:17], v6 offset:32768
  ds_read_b64_tr_b16 a[18:19], v6 offset:34816
  ds_read_b64_tr_b16 a[144:145], v6 offset:36864
  ds_read_b64_tr_b16 a[146:147], v6 offset:38912
  ds_read_b64_tr_b16 a[20:21], v6 offset:40960
  ds_read_b64_tr_b16 a[22:23], v6 offset:43008
  ds_read_b64_tr_b16 a[148:149], v6 offset:45056
  ds_read_b64_tr_b16 a[150:151], v6 offset:47104
  s_waitcnt vmcnt(24) lgkmcnt(0)
  s_barrier
  s_add_u32 m0, s41, 32768
  s_mov_b32 s42, 1310720
  buffer_load_dwordx4 v8, s[8:11], s42 offen nt lds
  s_add_u32 m0, s41, 36864
  s_mov_b32 s42, 1310720
  buffer_load_dwordx4 v9, s[8:11], s42 offen nt lds
  s_add_u32 m0, s41, 40960
  s_mov_b32 s42, 1343488
  buffer_load_dwordx4 v8, s[8:11], s42 offen nt lds
  s_add_u32 m0, s41, 45056
  s_mov_b32 s42, 1343488
  buffer_load_dwordx4 v9, s[8:11], s42 offen nt lds
  ds_read_b64_tr_b16 a[24:25], v6 offset:49152
  ds_read_b64_tr_b16 a[26:27], v6 offset:51200
  ds_read_b64_tr_b16 a[152:153], v6 offset:53248
  ds_read_b64_tr_b16 a[154:155], v6 offset:55296
  ds_read_b64_tr_b16 a[28:29], v6 offset:57344
  ds_read_b64_tr_b16 a[30:31], v6 offset:59392
  ds_read_b64_tr_b16 a[156:157], v6 offset:61440
  ds_read_b64_tr_b16 a[158:159], v6 offset:63488
  s_waitcnt vmcnt(24) lgkmcnt(0)
  s_barrier
  s_add_u32 m0, s41, 49152
  s_mov_b32 s42, 1376256
  buffer_load_dwordx4 v8, s[8:11], s42 offen nt lds
  s_add_u32 m0, s41, 53248
  s_mov_b32 s42, 1376256
  buffer_load_dwordx4 v9, s[8:11], s42 offen nt lds
  s_add_u32 m0, s41, 57344
  s_mov_b32 s42, 1409024
  buffer_load_dwordx4 v8, s[8:11], s42 offen nt lds
  s_add_u32 m0, s41, 61440
  s_mov_b32 s42, 1409024
  buffer_load_dwordx4 v9, s[8:11], s42 offen nt lds
  ds_read_b64_tr_b16 a[32:33], v7 offset:0
  ds_read_b64_tr_b16 a[34:35], v7 offset:2048
  ds_read_b64_tr_b16 a[160:161], v7 offset:4096
  ds_read_b64_tr_b16 a[162:163], v7 offset:6144
  ds_read_b64_tr_b16 a[36:37], v7 offset:8192
  ds_read_b64_tr_b16 a[38:39], v7 offset:10240
  ds_read_b64_tr_b16 a[164:165], v7 offset:12288
  ds_read_b64_tr_b16 a[166:167], v7 offset:14336
  s_waitcnt vmcnt(24) lgkmcnt(0)
  s_barrier
  s_add_u32 m0, s41, 65536
  s_mov_b32 s42, 1572864
  buffer_load_dwordx4 v8, s[8:11], s42 offen nt lds
  s_add_u32 m0, s41, 69632
  s_mov_b32 s42, 1572864
  buffer_load_dwordx4 v9, s[8:11], s42 offen nt lds
  s_add_u32 m0, s41, 73728
  s_mov_b32 s42, 1605632
  buffer_load_dwordx4 v8, s[8:11], s42 offen nt lds
  s_add_u32 m0, s41, 77824
  s_mov_b32 s42, 1605632
  buffer_load_dwordx4 v9, s[8:11], s42 offen nt lds
  ds_read_b64_tr_b16 a[40:41], v7 offset:16384
  ds_read_b64_tr_b16 a[42:43], v7 offset:18432
  ds_read_b64_tr_b16 a[168:169], v7 offset:20480
  ds_read_b64_tr_b16 a[170:171], v7 offset:22528
  ds_read_b64_tr_b16 a[44:45], v7 offset:24576
  ds_read_b64_tr_b16 a[46:47], v7 offset:26624
  ds_read_b64_tr_b16 a[172:173], v7 offset:28672
  ds_read_b64_tr_b16 a[174:175], v7 offset:30720
  s_waitcnt vmcnt(24) lgkmcnt(0)
  s_barrier
  s_add_u32 m0, s41, 81920
  s_mov_b32 s42, 1638400
  buffer_load_dwordx4 v8, s[8:11], s42 offen nt lds
  s_add_u32 m0, s41, 86016
  s_mov_b32 s42, 1638400
  buffer_load_dwordx4 v9, s[8:11], s42 offen nt lds
  s_add_u32 m0, s41, 90112
  s_mov_b32 s42, 1671168
  buffer_load_dwordx4 v8, s[8:11], s42 offen nt lds
  s_add_u32 m0, s41, 94208
  s_mov_b32 s42, 1671168
  buffer_load_dwordx4 v9, s[8:11], s42 offen nt lds
  ds_read_b64_tr_b16 a[48:49], v7 offset:32768
  ds_read_b64_tr_b16 a[50:51], v7 offset:34816
  ds_read_b64_tr_b16 a[176:177], v7 offset:36864
  ds_read_b64_tr_b16 a[178:179], v7 offset:38912
  ds_read_b64_tr_b16 a[52:53], v7 offset:40960
  ds_read_b64_tr_b16 a[54:55], v7 offset:43008
  ds_read_b64_tr_b16 a[180:181], v7 offset:45056
  ds_read_b64_tr_b16 a[182:183], v7 offset:47104
  s_waitcnt vmcnt(24) lgkmcnt(0)
  s_barrier
  s_add_u32 m0, s41, 98304
  s_mov_b32 s42, 1835008
  buffer_load_dwordx4 v8, s[8:11], s42 offen nt lds
  s_add_u32 m0, s41, 102400
  s_mov_b32 s42, 1835008
  buffer_load_dwordx4 v9, s[8:11], s42 offen nt lds
  s_add_u32 m0, s41, 106496
  s_mov_b32 s42, 1867776
  buffer_load_dwordx4 v8, s[8:11], s42 offen nt lds
  s_add_u32 m0, s41, 110592
  s_mov_b32 s42, 1867776
  buffer_load_dwordx4 v9, s[8:11], s42 offen nt lds
  ds_read_b64_tr_b16 a[56:57], v7 offset:49152
  ds_read_b64_tr_b16 a[58:59], v7 offset:51200
  ds_read_b64_tr_b16 a[184:185], v7 offset:53248
  ds_read_b64_tr_b16 a[186:187], v7 offset:55296
  ds_read_b64_tr_b16 a[60:61], v7 offset:57344
  ds_read_b64_tr_b16 a[62:63], v7 offset:59392
  ds_read_b64_tr_b16 a[188:189], v7 offset:61440
  ds_read_b64_tr_b16 a[190:191], v7 offset:63488
  s_waitcnt vmcnt(24) lgkmcnt(0)
  s_barrier
  s_add_u32 m0, s41, 114688
  s_mov_b32 s42, 1900544
  buffer_load_dwordx4 v8, s[8:11], s42 offen nt lds
  s_add_u32 m0, s41, 118784
  s_mov_b32 s42, 1900544
  buffer_load_dwordx4 v9, s[8:11], s42 offen nt lds
  s_add_u32 m0, s41, 122880
  s_mov_b32 s42, 1933312
  buffer_load_dwordx4 v8, s[8:11], s42 offen nt lds
  s_add_u32 m0, s41, 126976
  s_mov_b32 s42, 1933312
  buffer_load_dwordx4 v9, s[8:11], s42 offen nt lds
  ds_read_b64_tr_b16 a[64:65], v6 offset:0
  ds_read_b64_tr_b16 a[66:67], v6 offset:2048
  ds_read_b64_tr_b16 a[192:193], v6 offset:4096
  ds_read_b64_tr_b16 a[194:195], v6 offset:6144
  ds_read_b64_tr_b16 a[68:69], v6 offset:8192
  ds_read_b64_tr_b16 a[70:71], v6 offset:10240
  ds_read_b64_tr_b16 a[196:197], v6 offset:12288
  ds_read_b64_tr_b16 a[198:199], v6 offset:14336
  s_waitcnt vmcnt(24) lgkmcnt(0)
  s_barrier
  ds_read_b64_tr_b16 a[72:73], v6 offset:16384
  ds_read_b64_tr_b16 a[74:75], v6 offset:18432
  ds_read_b64_tr_b16 a[200:201], v6 offset:20480
  ds_read_b64_tr_b16 a[202:203], v6 offset:22528
  ds_read_b64_tr_b16 a[76:77], v6 offset:24576
  ds_read_b64_tr_b16 a[78:79], v6 offset:26624
  ds_read_b64_tr_b16 a[204:205], v6 offset:28672
  ds_read_b64_tr_b16 a[206:207], v6 offset:30720
  s_waitcnt vmcnt(20) lgkmcnt(0)
  s_barrier
  ds_read_b64_tr_b16 a[80:81], v6 offset:32768
  ds_read_b64_tr_b16 a[82:83], v6 offset:34816
  ds_read_b64_tr_b16 a[208:209], v6 offset:36864
  ds_read_b64_tr_b16 a[210:211], v6 offset:38912
  ds_read_b64_tr_b16 a[84:85], v6 offset:40960
  ds_read_b64_tr_b16 a[86:87], v6 offset:43008
  ds_read_b64_tr_b16 a[212:213], v6 offset:45056
  ds_read_b64_tr_b16 a[214:215], v6 offset:47104
  s_waitcnt vmcnt(16) lgkmcnt(0)
  s_barrier
  ds_read_b64_tr_b16 a[88:89], v6 offset:49152
  ds_read_b64_tr_b16 a[90:91], v6 offset:51200
  ds_read_b64_tr_b16 a[216:217], v6 offset:53248
  ds_read_b64_tr_b16 a[218:219], v6 offset:55296
  ds_read_b64_tr_b16 a[92:93], v6 offset:57344
  ds_read_b64_tr_b16 a[94:95], v6 offset:59392
  ds_read_b64_tr_b16 a[220:221], v6 offset:61440
  ds_read_b64_tr_b16 a[222:223], v6 offset:63488
  s_waitcnt vmcnt(12) lgkmcnt(0)
  s_barrier
  ds_read_b64_tr_b16 a[96:97], v7 offset:0
  ds_read_b64_tr_b16 a[98:99], v7 offset:2048
  ds_read_b64_tr_b16 a[224:225], v7 offset:4096
  ds_read_b64_tr_b16 a[226:227], v7 offset:6144
  ds_read_b64_tr_b16 a[100:101], v7 offset:8192
  ds_read_b64_tr_b16 a[102:103], v7 offset:10240
  ds_read_b64_tr_b16 a[228:229], v7 offset:12288
  ds_read_b64_tr_b16 a[230:231], v7 offset:14336
  s_waitcnt vmcnt(8) lgkmcnt(0)
  s_barrier
  ds_read_b64_tr_b16 a[104:105], v7 offset:16384
  ds_read_b64_tr_b16 a[106:107], v7 offset:18432
  ds_read_b64_tr_b16 a[232:233], v7 offset:20480
  ds_read_b64_tr_b16 a[234:235], v7 offset:22528
  ds_read_b64_tr_b16 a[108:109], v7 offset:24576
  ds_read_b64_tr_b16 a[110:111], v7 offset:26624
  ds_read_b64_tr_b16 a[236:237], v7 offset:28672
  ds_read_b64_tr_b16 a[238:239], v7 offset:30720
  s_waitcnt vmcnt(4) lgkmcnt(0)
  s_barrier
  ds_read_b64_tr_b16 a[112:113], v7 offset:32768
  ds_read_b64_tr_b16 a[114:115], v7 offset:34816
  ds_read_b64_tr_b16 a[240:241], v7 offset:36864
  ds_read_b64_tr_b16 a[242:243], v7 offset:38912
  ds_read_b64_tr_b16 a[116:117], v7 offset:40960
  ds_read_b64_tr_b16 a[118:119], v7 offset:43008
  ds_read_b64_tr_b16 a[244:245], v7 offset:45056
  ds_read_b64_tr_b16 a[246:247], v7 offset:47104
  s_waitcnt vmcnt(0) lgkmcnt(0)
  s_barrier
  ds_read_b64_tr_b16 a[120:121], v7 offset:49152
  ds_read_b64_tr_b16 a[122:123], v7 offset:51200
  ds_read_b64_tr_b16 a[248:249], v7 offset:53248
  ds_read_b64_tr_b16 a[250:251], v7 offset:55296
  ds_read_b64_tr_b16 a[124:125], v7 offset:57344
  ds_read_b64_tr_b16 a[126:127], v7 offset:59392
  ds_read_b64_tr_b16 a[252:253], v7 offset:61440
  ds_read_b64_tr_b16 a[254:255], v7 offset:63488
  s_waitcnt lgkmcnt(0)
  s_barrier
  s_and_b32 s43, s21, 24
  v_min_u32 v2, 7, v0
  v_add_u32 v2, s43, v2
  v_lshlrev_b32 v2, 7, v2
  v_add_u32 v2, 1404928, v2
  s_lshl_b32 s62, s21, 7
  s_add_u32 s62, s62, 1409024
  v_min_u32 v52, 63, v0
  v_lshlrev_b32 v52, 7, v52
  v_add_u32 v52, 1424384, v52
  s_nop 1
Lpoll_134:
  buffer_load_dword v53, v52, s[4:7], 0 offen sc1
  s_sub_u32 s24, s24, 1
  s_cbranch_scc1 L_FAIL
  s_waitcnt vmcnt(0)
  v_cmp_gt_i32 vcc, 0, v53
  s_cbranch_vccz Lpolld_135
  s_sleep 1
  s_branch Lpoll_134
Lpolld_135:
Ltab_133:
  v_lshrrev_b32 v53, 8, v53
  v_and_b32 v54, 3, v0
  v_lshl_or_b32 v53, v53, 2, v54
  s_nop 1
  v_min_u32_dpp v53, v53, v53 row_ror:8 row_mask:0xf bank_mask:0xf
  s_nop 1
  v_min_u32_dpp v53, v53, v53 row_ror:4 row_mask:0xf bank_mask:0xf
  v_mov_b32 v54, v53
  s_nop 1
  v_permlane16_swap_b32 v54, v53
  v_min_u32 v53, v53, v54
  v_mov_b32 v54, v53
  s_nop 1
  v_permlane32_swap_b32 v54, v53
  v_min_u32 v53, v53, v54
  s_nop 1
  v_min_u32_dpp v53, v53, v53 row_ror:2 row_mask:0xf bank_mask:0xf
  s_nop 1
  v_min_u32_dpp v53, v53, v53 row_ror:1 row_mask:0xf bank_mask:0xf
  s_nop 0
  v_readfirstlane_b32 s38, v53
  s_and_b32 s38, s38, 3
  s_lshl_b32 s38, s38, 13
  s_and_b32 s38, s38, 0x2000
  s_xor_b32 s38, s38, 20979712
  s_xor_b32 s27, s38, 0x2000
  s_lshr_b32 s40, s20, 1
  s_add_u32 s40, s40, s43
  s_mul_i32 s40, s40, 65536
  s_and_b32 s41, s20, 1
  s_lshl_b32 s41, s41, 12
  s_add_u32 s40, s40, s41
  s_add_u32 s40, s40, 49152
  s_add_u32 s27, s27, s40
  s_lshl_b32 s40, s21, 14
  s_add_u32 s40, s40, s38
  s_add_u32 s31, s40, 0
  s_lshl_b32 s40, s20, 11
  v_and_b32 v68, 3, v0
  v_lshlrev_b32 v68, 4, v68
  v_lshrrev_b32 v52, 4, v0
  v_lshl_add_u32 v68, v52, 6, v68
  v_bfe_u32 v52, v0, 2, 2
  v_lshl_add_u32 v68, v52, 8, v68
  v_add_u32 v68, s40, v68
  v_lshlrev_b32 v71, 2, v0
  v_add_u32 v71, 131072, v71
  s_mov_b32 s25, 0
  s_mov_b32 s26, 0
  s_mov_b32 s29, 1
  s_mov_b32 s30, 0
  s_mov_b32 s28, 0
  s_lshl_b32 s44, s20, 8
  s_add_u32 s44, s44, 131072
  s_cmp_eq_u32 s20, 0
  s_cselect_b32 s45, 0, 2147483392
  s_cselect_b32 s46, 1, -1
L_WO_top:
  s_cmp_eq_u32 s28, 1
  s_cbranch_scc1 L_WO_go
  s_cmp_eq_u32 s28, 2
  s_cbranch_scc1 L_WO_mid
  s_cmp_lg_u32 s20, 0
  s_cbranch_scc1 L_WO_park
  buffer_load_dword v3, v2, s[4:7], s30 offen sc1
  s_nop 0
  s_nop 0
  s_waitcnt vmcnt(1)
  s_barrier
  s_mov_b32 s63, s25
  s_atomic_smax s63, s[4:5], s62 glc
Lnosig_136:
  s_cmp_ge_u32 s25, 64
  s_cbranch_scc1 L_END
  s_waitcnt vmcnt(0)
  v_cmp_gt_i32 vcc, s29, v3
  s_cbranch_vccz L_WO_issue
  s_nop 3
Lpoll_137:
  buffer_load_dword v3, v2, s[4:7], s30 offen sc1
  s_sub_u32 s24, s24, 1
  s_cbranch_scc1 L_FAIL
  s_waitcnt vmcnt(0)
  v_cmp_gt_i32 vcc, s29, v3
  s_cbranch_vccz Lpolld_138
  s_sleep 1
  s_branch Lpoll_137
Lpolld_138:
  s_branch L_WO_issue
L_WO_park:
  s_waitcnt vmcnt(0)
  s_barrier
  s_cmp_ge_u32 s25, 64
  s_cbranch_scc1 L_END
L_WO_issue:
  s_barrier
L_WO_mid:
  s_mov_b32 s34, s26
  s_mov_b32 s35, s27
  s_add_u32 s36, s32, 0
  s_add_u32 m0, s34, s36
  s_add_u32 s36, s35, 0
  buffer_load_dwordx4 v1, s[4:7], s36 offen offset:0 sc1 lds
  s_nop 0
  buffer_load_dwordx4 v1, s[4:7], s36 offen offset:1024 sc1 lds
  s_nop 0
  buffer_load_dwordx4 v1, s[4:7], s36 offen offset:2048 sc1 lds
  s_nop 0
  buffer_load_dwordx4 v1, s[4:7], s36 offen offset:3072 sc1 lds
  s_nop 0
  s_add_u32 s36, s32, 16384
  s_add_u32 m0, s34, s36
  s_add_u32 s36, s35, 131072
  buffer_load_dwordx4 v1, s[4:7], s36 offen offset:0 sc1 lds
  s_nop 0
  buffer_load_dwordx4 v1, s[4:7], s36 offen offset:1024 sc1 lds
  s_nop 0
  buffer_load_dwordx4 v1, s[4:7], s36 offen offset:2048 sc1 lds
  s_nop 0
  buffer_load_dwordx4 v1, s[4:7], s36 offen offset:3072 sc1 lds
  s_nop 0
  s_add_u32 s36, s32, 32768
  s_add_u32 m0, s34, s36
  s_add_u32 s36, s35, 262144
  buffer_load_dwordx4 v1, s[4:7], s36 offen offset:0 sc1 lds
  s_nop 0
  buffer_load_dwordx4 v1, s[4:7], s36 offen offset:1024 sc1 lds
  s_nop 0
  buffer_load_dwordx4 v1, s[4:7], s36 offen offset:2048 sc1 lds
  s_nop 0
  buffer_load_dwordx4 v1, s[4:7], s36 offen offset:3072 sc1 lds
  s_nop 0
  s_cmp_eq_u32 s28, 0
  s_cbranch_scc1 L_WO_go
  s_mov_b32 s28, 0
  s_waitcnt vmcnt(12)
  s_barrier
  s_cmp_lg_u32 s20, 0
  s_cbranch_scc1 Lnosig_139
  s_mov_b32 s63, s25
  s_atomic_smax s63, s[4:5], s62 glc
Lnosig_139:
L_WO_go:
  v_add_u32 v73, s26, v69
  v_add_u32 v74, s26, v70
  s_sub_u32 s26, 65536, s26
  s_add_u32 s27, s27, 2097152
  s_xor_b32 s27, s27, 0x2000
  s_add_u32 s29, s29, 1
  s_waitcnt vmcnt(8)
  s_barrier
  ds_read_b128 v[4:7], v73 offset:0
  ds_read_b128 v[8:11], v73 offset:1024
  ds_read_b128 v[12:15], v73 offset:2048
  ds_read_b128 v[16:19], v73 offset:3072
  ds_read_b128 v[20:23], v73 offset:4096
  ds_read_b128 v[24:27], v73 offset:5120
  s_waitcnt lgkmcnt(4)
  v_mfma_f32_16x16x32_bf16 v[36:39], a[0:3], v[4:7], 0
  ds_read_b128 v[28:31], v73 offset:6144
  v_mfma_f32_16x16x32_bf16 v[40:43], a[0:3], v[8:11], 0
  ds_read_b128 v[32:35], v73 offset:7168
  v_mfma_f32_16x16x32_bf16 v[44:47], a[128:131], v[4:7], 0
  s_add_u32 s36, s32, 49152
  s_add_u32 m0, s34, s36
  s_add_u32 s36, s35, 393216
  buffer_load_dwordx4 v1, s[4:7], s36 offen offset:0 sc1 lds
  v_mfma_f32_16x16x32_bf16 v[48:51], a[128:131], v[8:11], 0
  s_waitcnt lgkmcnt(4)
  v_mfma_f32_16x16x32_bf16 v[36:39], a[4:7], v[12:15], v[36:39]
  ds_read_b128 v[4:7], v73 offset:8192
  v_mfma_f32_16x16x32_bf16 v[40:43], a[4:7], v[16:19], v[40:43]
  ds_read_b128 v[8:11], v73 offset:9216
  v_mfma_f32_16x16x32_bf16 v[44:47], a[132:135], v[12:15], v[44:47]
  buffer_load_dwordx4 v1, s[4:7], s36 offen offset:1024 sc1 lds
  v_mfma_f32_16x16x32_bf16 v[48:51], a[132:135], v[16:19], v[48:51]
  s_waitcnt lgkmcnt(4)
  v_mfma_f32_16x16x32_bf16 v[36:39], a[8:11], v[20:23], v[36:39]
  ds_read_b128 v[12:15], v73 offset:10240
  v_mfma_f32_16x16x32_bf16 v[40:43], a[8:11], v[24:27], v[40:43]
  ds_read_b128 v[16:19], v73 offset:11264
  v_mfma_f32_16x16x32_bf16 v[44:47], a[136:139], v[20:23], v[44:47]
  buffer_load_dwordx4 v1, s[4:7], s36 offen offset:2048 sc1 lds
  v_mfma_f32_16x16x32_bf16 v[48:51], a[136:139], v[24:27], v[48:51]
  s_waitcnt lgkmcnt(4)
  v_mfma_f32_16x16x32_bf16 v[36:39], a[12:15], v[28:31], v[36:39]
  ds_read_b128 v[20:23], v73 offset:12288
  v_mfma_f32_16x16x32_bf16 v[40:43], a[12:15], v[32:35], v[40:43]
  ds_read_b128 v[24:27], v73 offset:13312
  v_mfma_f32_16x16x32_bf16 v[44:47], a[140:143], v[28:31], v[44:47]
  buffer_load_dwordx4 v1, s[4:7], s36 offen offset:3072 sc1 lds
  v_mfma_f32_16x16x32_bf16 v[48:51], a[140:143], v[32:35], v[48:51]
  s_waitcnt lgkmcnt(4)
  v_mfma_f32_16x16x32_bf16 v[36:39], a[16:19], v[4:7], v[36:39]
  ds_read_b128 v[28:31], v73 offset:14336
  v_mfma_f32_16x16x32_bf16 v[40:43], a[16:19], v[8:11], v[40:43]
  ds_read_b128 v[32:35], v73 offset:15360
  v_mfma_f32_16x16x32_bf16 v[44:47], a[144:147], v[4:7], v[44:47]
  v_mfma_f32_16x16x32_bf16 v[48:51], a[144:147], v[8:11], v[48:51]
  s_waitcnt vmcnt(8)
  s_barrier
  s_waitcnt lgkmcnt(4)
  v_mfma_f32_16x16x32_bf16 v[36:39], a[20:23], v[12:15], v[36:39]
  ds_read_b128 v[4:7], v73 offset:16384
  v_mfma_f32_16x16x32_bf16 v[40:43], a[20:23], v[16:19], v[40:43]
  ds_read_b128 v[8:11], v73 offset:17408
  v_mfma_f32_16x16x32_bf16 v[44:47], a[148:151], v[12:15], v[44:47]
  v_mfma_f32_16x16x32_bf16 v[48:51], a[148:151], v[16:19], v[48:51]
  s_waitcnt lgkmcnt(4)
  v_mfma_f32_16x16x32_bf16 v[36:39], a[24:27], v[20:23], v[36:39]
  ds_read_b128 v[12:15], v73 offset:18432
  v_mfma_f32_16x16x32_bf16 v[40:43], a[24:27], v[24:27], v[40:43]
  ds_read_b128 v[16:19], v73 offset:19456
  v_mfma_f32_16x16x32_bf16 v[44:47], a[152:155], v[20:23], v[44:47]
  v_mfma_f32_16x16x32_bf16 v[48:51], a[152:155], v[24:27], v[48:51]
  s_waitcnt lgkmcnt(4)
  v_mfma_f32_16x16x32_bf16 v[36:39], a[28:31], v[28:31], v[36:39]
  ds_read_b128 v[20:23], v73 offset:20480
  v_mfma_f32_16x16x32_bf16 v[40:43], a[28:31], v[32:35], v[40:43]
  ds_read_b128 v[24:27], v73 offset:21504
  v_mfma_f32_16x16x32_bf16 v[44:47], a[156:159], v[28:31], v[44:47]
  v_mfma_f32_16x16x32_bf16 v[48:51], a[156:159], v[32:35], v[48:51]
  s_waitcnt lgkmcnt(4)
  v_mfma_f32_16x16x32_bf16 v[36:39], a[32:35], v[4:7], v[36:39]
  ds_read_b128 v[28:31], v73 offset:22528
  v_mfma_f32_16x16x32_bf16 v[40:43], a[32:35], v[8:11], v[40:43]
  ds_read_b128 v[32:35], v73 offset:23552
  v_mfma_f32_16x16x32_bf16 v[44:47], a[160:163], v[4:7], v[44:47]
  v_mfma_f32_16x16x32_bf16 v[48:51], a[160:163], v[8:11], v[48:51]
  s_waitcnt lgkmcnt(4)
  v_mfma_f32_16x16x32_bf16 v[36:39], a[36:39], v[12:15], v[36:39]
  ds_read_b128 v[4:7], v73 offset:24576
  v_mfma_f32_16x16x32_bf16 v[40:43], a[36:39], v[16:19], v[40:43]
  ds_read_b128 v[8:11], v73 offset:25600
  v_mfma_f32_16x16x32_bf16 v[44:47], a[164:167], v[12:15], v[44:47]
  v_mfma_f32_16x16x32_bf16 v[48:51], a[164:167], v[16:19], v[48:51]
  s_waitcnt lgkmcnt(4)
  v_mfma_f32_16x16x32_bf16 v[36:39], a[40:43], v[20:23], v[36:39]
  ds_read_b128 v[12:15], v73 offset:26624
  v_mfma_f32_16x16x32_bf16 v[40:43], a[40:43], v[24:27], v[40:43]
  ds_read_b128 v[16:19], v73 offset:27648
  v_mfma_f32_16x16x32_bf16 v[44:47], a[168:171], v[20:23], v[44:47]
  v_mfma_f32_16x16x32_bf16 v[48:51], a[168:171], v[24:27], v[48:51]
  s_waitcnt lgkmcnt(4)
  v_mfma_f32_16x16x32_bf16 v[36:39], a[44:47], v[28:31], v[36:39]
  ds_read_b128 v[20:23], v73 offset:28672
  v_mfma_f32_16x16x32_bf16 v[40:43], a[44:47], v[32:35], v[40:43]
  ds_read_b128 v[24:27], v73 offset:29696
  v_mfma_f32_16x16x32_bf16 v[44:47], a[172:175], v[28:31], v[44:47]
  s_mov_b32 s34, s26
  s_mov_b32 s35, s27
  v_mfma_f32_16x16x32_bf16 v[48:51], a[172:175], v[32:35], v[48:51]
  s_waitcnt lgkmcnt(4)
  v_mfma_f32_16x16x32_bf16 v[36:39], a[48:51], v[4:7], v[36:39]
  ds_read_b128 v[28:31], v73 offset:30720
  v_mfma_f32_16x16x32_bf16 v[40:43], a[48:51], v[8:11], v[40:43]
  ds_read_b128 v[32:35], v73 offset:31744
  v_mfma_f32_16x16x32_bf16 v[44:47], a[176:179], v[4:7], v[44:47]
  s_add_u32 m0, s44, 0
  s_add_u32 s40, s30, s45
  v_mfma_f32_16x16x32_bf16 v[48:51], a[176:179], v[8:11], v[48:51]
  buffer_load_dword v2, s[4:7], s40 offen sc1 lds
  s_waitcnt vmcnt(5)
  s_barrier
  s_cmp_eq_u32 s46, s28
  s_cbranch_scc1 L_WO_rep
L_WO_s2:
  s_waitcnt lgkmcnt(4)
  v_mfma_f32_16x16x32_bf16 v[36:39], a[52:55], v[12:15], v[36:39]
  ds_read_b128 v[4:7], v73 offset:32768
  v_mfma_f32_16x16x32_bf16 v[40:43], a[52:55], v[16:19], v[40:43]
  ds_read_b128 v[8:11], v73 offset:33792
  v_mfma_f32_16x16x32_bf16 v[44:47], a[180:183], v[12:15], v[44:47]
  v_mfma_f32_16x16x32_bf16 v[48:51], a[180:183], v[16:19], v[48:51]
  s_waitcnt lgkmcnt(4)
  v_mfma_f32_16x16x32_bf16 v[36:39], a[56:59], v[20:23], v[36:39]
  ds_read_b128 v[12:15], v73 offset:34816
  v_mfma_f32_16x16x32_bf16 v[40:43], a[56:59], v[24:27], v[40:43]
  ds_read_b128 v[16:19], v73 offset:35840
  v_mfma_f32_16x16x32_bf16 v[44:47], a[184:187], v[20:23], v[44:47]
  v_mfma_f32_16x16x32_bf16 v[48:51], a[184:187], v[24:27], v[48:51]
  s_waitcnt lgkmcnt(4)
  v_mfma_f32_16x16x32_bf16 v[36:39], a[60:63], v[28:31], v[36:39]
  ds_read_b128 v[20:23], v73 offset:36864
  v_mfma_f32_16x16x32_bf16 v[40:43], a[60:63], v[32:35], v[40:43]
  ds_read_b128 v[24:27], v73 offset:37888
  v_mfma_f32_16x16x32_bf16 v[44:47], a[188:191], v[28:31], v[44:47]
  v_mfma_f32_16x16x32_bf16 v[48:51], a[188:191], v[32:35], v[48:51]
  s_waitcnt lgkmcnt(4)
  v_mfma_f32_16x16x32_bf16 v[36:39], a[64:67], v[4:7], v[36:39]
  ds_read_b128 v[28:31], v73 offset:38912
  v_mfma_f32_16x16x32_bf16 v[40:43], a[64:67], v[8:11], v[40:43]
  ds_read_b128 v[32:35], v73 offset:39936
  v_mfma_f32_16x16x32_bf16 v[44:47], a[192:195], v[4:7], v[44:47]
  v_mfma_f32_16x16x32_bf16 v[48:51], a[192:195], v[8:11], v[48:51]
  s_waitcnt lgkmcnt(4)
  v_mfma_f32_16x16x32_bf16 v[36:39], a[68:71], v[12:15], v[36:39]
  ds_read_b128 v[4:7], v73 offset:40960
  v_mfma_f32_16x16x32_bf16 v[40:43], a[68:71], v[16:19], v[40:43]
  ds_read_b128 v[8:11], v73 offset:41984
  v_mfma_f32_16x16x32_bf16 v[44:47], a[196:199], v[12:15], v[44:47]
  v_mfma_f32_16x16x32_bf16 v[48:51], a[196:199], v[16:19], v[48:51]
  s_waitcnt lgkmcnt(4)
  v_mfma_f32_16x16x32_bf16 v[36:39], a[72:75], v[20:23], v[36:39]
  ds_read_b128 v[12:15], v73 offset:43008
  v_mfma_f32_16x16x32_bf16 v[40:43], a[72:75], v[24:27], v[40:43]
  ds_read_b128 v[16:19], v73 offset:44032
  v_mfma_f32_16x16x32_bf16 v[44:47], a[200:203], v[20:23], v[44:47]
  v_mfma_f32_16x16x32_bf16 v[48:51], a[200:203], v[24:27], v[48:51]
  s_waitcnt vmcnt(0)
  s_barrier
  ds_read_b32 v3, v71
  s_waitcnt lgkmcnt(4)
  v_mfma_f32_16x16x32_bf16 v[36:39], a[76:79], v[28:31], v[36:39]
  ds_read_b128 v[20:23], v73 offset:45056
  v_mfma_f32_16x16x32_bf16 v[40:43], a[76:79], v[32:35], v[40:43]
  ds_read_b128 v[24:27], v73 offset:46080
  v_mfma_f32_16x16x32_bf16 v[44:47], a[204:207], v[28:31], v[44:47]
  v_mfma_f32_16x16x32_bf16 v[48:51], a[204:207], v[32:35], v[48:51]
  s_waitcnt lgkmcnt(4)
  v_mfma_f32_16x16x32_bf16 v[36:39], a[80:83], v[4:7], v[36:39]
  ds_read_b128 v[28:31], v73 offset:47104
  v_mfma_f32_16x16x32_bf16 v[40:43], a[80:83], v[8:11], v[40:43]
  ds_read_b128 v[32:35], v73 offset:48128
  v_mfma_f32_16x16x32_bf16 v[44:47], a[208:211], v[4:7], v[44:47]
  v_mfma_f32_16x16x32_bf16 v[48:51], a[208:211], v[8:11], v[48:51]
  s_waitcnt lgkmcnt(4)
  v_cmp_gt_i32 vcc, s29, v3
  s_mov_b32 s28, 0
  s_cbranch_vccnz L_WO_nopf
  s_cmp_ge_u32 s25, 63
  s_cbranch_scc1 L_WO_nopf
  s_mov_b32 s28, 1
  s_waitcnt lgkmcnt(4)
  v_mfma_f32_16x16x32_bf16 v[36:39], a[84:87], v[12:15], v[36:39]
  ds_read_b128 v[4:7], v73 offset:49152
  v_mfma_f32_16x16x32_bf16 v[40:43], a[84:87], v[16:19], v[40:43]
  ds_read_b128 v[8:11], v73 offset:50176
  v_mfma_f32_16x16x32_bf16 v[44:47], a[212:215], v[12:15], v[44:47]
  s_add_u32 s36, s32, 0
  s_add_u32 m0, s34, s36
  s_add_u32 s36, s35, 0
  buffer_load_dwordx4 v1, s[4:7], s36 offen offset:0 sc1 lds
  v_mfma_f32_16x16x32_bf16 v[48:51], a[212:215], v[16:19], v[48:51]
  buffer_load_dwordx4 v1, s[4:7], s36 offen offset:1024 sc1 lds
  s_waitcnt lgkmcnt(4)
  v_mfma_f32_16x16x32_bf16 v[36:39], a[88:91], v[20:23], v[36:39]
  ds_read_b128 v[12:15], v73 offset:51200
  v_mfma_f32_16x16x32_bf16 v[40:43], a[88:91], v[24:27], v[40:43]
  ds_read_b128 v[16:19], v73 offset:52224
  v_mfma_f32_16x16x32_bf16 v[44:47], a[216:219], v[20:23], v[44:47]
  buffer_load_dwordx4 v1, s[4:7], s36 offen offset:2048 sc1 lds
  v_mfma_f32_16x16x32_bf16 v[48:51], a[216:219], v[24:27], v[48:51]
  buffer_load_dwordx4 v1, s[4:7], s36 offen offset:3072 sc1 lds
  s_waitcnt lgkmcnt(4)
  v_mfma_f32_16x16x32_bf16 v[36:39], a[92:95], v[28:31], v[36:39]
  ds_read_b128 v[20:23], v73 offset:53248
  v_mfma_f32_16x16x32_bf16 v[40:43], a[92:95], v[32:35], v[40:43]
  ds_read_b128 v[24:27], v73 offset:54272
  v_mfma_f32_16x16x32_bf16 v[44:47], a[220:223], v[28:31], v[44:47]
  s_add_u32 s36, s32, 16384
  s_add_u32 m0, s34, s36
  s_add_u32 s36, s35, 131072
  buffer_load_dwordx4 v1, s[4:7], s36 offen offset:0 sc1 lds
  v_mfma_f32_16x16x32_bf16 v[48:51], a[220:223], v[32:35], v[48:51]
  buffer_load_dwordx4 v1, s[4:7], s36 offen offset:1024 sc1 lds
  s_waitcnt lgkmcnt(4)
  v_mfma_f32_16x16x32_bf16 v[36:39], a[96:99], v[4:7], v[36:39]
  ds_read_b128 v[28:31], v73 offset:55296
  v_mfma_f32_16x16x32_bf16 v[40:43], a[96:99], v[8:11], v[40:43]
  ds_read_b128 v[32:35], v73 offset:56320
  v_mfma_f32_16x16x32_bf16 v[44:47], a[224:227], v[4:7], v[44:47]
  buffer_load_dwordx4 v1, s[4:7], s36 offen offset:2048 sc1 lds
  v_mfma_f32_16x16x32_bf16 v[48:51], a[224:227], v[8:11], v[48:51]
  buffer_load_dwordx4 v1, s[4:7], s36 offen offset:3072 sc1 lds
  s_waitcnt lgkmcnt(4)
  v_mfma_f32_16x16x32_bf16 v[36:39], a[100:103], v[12:15], v[36:39]
  ds_read_b128 v[4:7], v73 offset:57344
  v_mfma_f32_16x16x32_bf16 v[40:43], a[100:103], v[16:19], v[40:43]
  ds_read_b128 v[8:11], v73 offset:58368
  v_mfma_f32_16x16x32_bf16 v[44:47], a[228:231], v[12:15], v[44:47]
  s_add_u32 s36, s32, 32768
  s_add_u32 m0, s34, s36
  s_add_u32 s36, s35, 262144
  buffer_load_dwordx4 v1, s[4:7], s36 offen offset:0 sc1 lds
  v_mfma_f32_16x16x32_bf16 v[48:51], a[228:231], v[16:19], v[48:51]
  buffer_load_dwordx4 v1, s[4:7], s36 offen offset:1024 sc1 lds
  s_waitcnt lgkmcnt(4)
  v_mfma_f32_16x16x32_bf16 v[36:39], a[104:107], v[20:23], v[36:39]
  ds_read_b128 v[12:15], v73 offset:59392
  v_mfma_f32_16x16x32_bf16 v[40:43], a[104:107], v[24:27], v[40:43]
  ds_read_b128 v[16:19], v73 offset:60416
  v_mfma_f32_16x16x32_bf16 v[44:47], a[232:235], v[20:23], v[44:47]
  buffer_load_dwordx4 v1, s[4:7], s36 offen offset:2048 sc1 lds
  v_mfma_f32_16x16x32_bf16 v[48:51], a[232:235], v[24:27], v[48:51]
  buffer_load_dwordx4 v1, s[4:7], s36 offen offset:3072 sc1 lds
  s_waitcnt lgkmcnt(4)
  v_mfma_f32_16x16x32_bf16 v[36:39], a[108:111], v[28:31], v[36:39]
  ds_read_b128 v[20:23], v73 offset:61440
  v_mfma_f32_16x16x32_bf16 v[40:43], a[108:111], v[32:35], v[40:43]
  ds_read_b128 v[24:27], v73 offset:62464
  v_mfma_f32_16x16x32_bf16 v[44:47], a[236:239], v[28:31], v[44:47]
  v_mfma_f32_16x16x32_bf16 v[48:51], a[236:239], v[32:35], v[48:51]
  s_waitcnt lgkmcnt(4)
  v_mfma_f32_16x16x32_bf16 v[36:39], a[112:115], v[4:7], v[36:39]
  ds_read_b128 v[28:31], v73 offset:63488
  v_mfma_f32_16x16x32_bf16 v[40:43], a[112:115], v[8:11], v[40:43]
  ds_read_b128 v[32:35], v73 offset:64512
  v_mfma_f32_16x16x32_bf16 v[44:47], a[240:243], v[4:7], v[44:47]
  v_mfma_f32_16x16x32_bf16 v[48:51], a[240:243], v[8:11], v[48:51]
  s_waitcnt lgkmcnt(4)
  v_mfma_f32_16x16x32_bf16 v[36:39], a[116:119], v[12:15], v[36:39]
  v_mfma_f32_16x16x32_bf16 v[40:43], a[116:119], v[16:19], v[40:43]
  v_mfma_f32_16x16x32_bf16 v[44:47], a[244:247], v[12:15], v[44:47]
  v_mfma_f32_16x16x32_bf16 v[48:51], a[244:247], v[16:19], v[48:51]
  s_waitcnt lgkmcnt(2)
  v_mfma_f32_16x16x32_bf16 v[36:39], a[120:123], v[20:23], v[36:39]
  v_mfma_f32_16x16x32_bf16 v[40:43], a[120:123], v[24:27], v[40:43]
  v_mfma_f32_16x16x32_bf16 v[44:47], a[248:251], v[20:23], v[44:47]
  v_mfma_f32_16x16x32_bf16 v[48:51], a[248:251], v[24:27], v[48:51]
  s_waitcnt lgkmcnt(0)
  v_mfma_f32_16x16x32_bf16 v[36:39], a[124:127], v[28:31], v[36:39]
  v_mfma_f32_16x16x32_bf16 v[40:43], a[124:127], v[32:35], v[40:43]
  v_mfma_f32_16x16x32_bf16 v[44:47], a[252:255], v[28:31], v[44:47]
  v_mfma_f32_16x16x32_bf16 v[48:51], a[252:255], v[32:35], v[48:51]
  s_nop 7
  s_branch L_WO_epi
L_WO_nopf:
  s_waitcnt lgkmcnt(4)
  v_mfma_f32_16x16x32_bf16 v[36:39], a[84:87], v[12:15], v[36:39]
  ds_read_b128 v[4:7], v73 offset:49152
  v_mfma_f32_16x16x32_bf16 v[40:43], a[84:87], v[16:19], v[40:43]
  ds_read_b128 v[8:11], v73 offset:50176
  v_mfma_f32_16x16x32_bf16 v[44:47], a[212:215], v[12:15], v[44:47]
  v_mfma_f32_16x16x32_bf16 v[48:51], a[212:215], v[16:19], v[48:51]
  s_waitcnt lgkmcnt(4)
  v_mfma_f32_16x16x32_bf16 v[36:39], a[88:91], v[20:23], v[36:39]
  ds_read_b128 v[12:15], v73 offset:51200
  v_mfma_f32_16x16x32_bf16 v[40:43], a[88:91], v[24:27], v[40:43]
  ds_read_b128 v[16:19], v73 offset:52224
  v_mfma_f32_16x16x32_bf16 v[44:47], a[216:219], v[20:23], v[44:47]
  v_mfma_f32_16x16x32_bf16 v[48:51], a[216:219], v[24:27], v[48:51]
  s_waitcnt lgkmcnt(4)
  v_mfma_f32_16x16x32_bf16 v[36:39], a[92:95], v[28:31], v[36:39]
  ds_read_b128 v[20:23], v73 offset:53248
  v_mfma_f32_16x16x32_bf16 v[40:43], a[92:95], v[32:35], v[40:43]
  ds_read_b128 v[24:27], v73 offset:54272
  v_mfma_f32_16x16x32_bf16 v[44:47], a[220:223], v[28:31], v[44:47]
  v_mfma_f32_16x16x32_bf16 v[48:51], a[220:223], v[32:35], v[48:51]
  s_waitcnt lgkmcnt(4)
  v_mfma_f32_16x16x32_bf16 v[36:39], a[96:99], v[4:7], v[36:39]
  ds_read_b128 v[28:31], v73 offset:55296
  v_mfma_f32_16x16x32_bf16 v[40:43], a[96:99], v[8:11], v[40:43]
  ds_read_b128 v[32:35], v73 offset:56320
  v_mfma_f32_16x16x32_bf16 v[44:47], a[224:227], v[4:7], v[44:47]
  s_add_u32 m0, s44, 1024
  s_add_u32 s40, s30, s45
  v_mfma_f32_16x16x32_bf16 v[48:51], a[224:227], v[8:11], v[48:51]
  buffer_load_dword v2, s[4:7], s40 offen sc1 lds
  s_waitcnt lgkmcnt(4)
  v_mfma_f32_16x16x32_bf16 v[36:39], a[100:103], v[12:15], v[36:39]
  ds_read_b128 v[4:7], v73 offset:57344
  v_mfma_f32_16x16x32_bf16 v[40:43], a[100:103], v[16:19], v[40:43]
  ds_read_b128 v[8:11], v73 offset:58368
  v_mfma_f32_16x16x32_bf16 v[44:47], a[228:231], v[12:15], v[44:47]
  v_mfma_f32_16x16x32_bf16 v[48:51], a[228:231], v[16:19], v[48:51]
  s_waitcnt lgkmcnt(4)
  v_mfma_f32_16x16x32_bf16 v[36:39], a[104:107], v[20:23], v[36:39]
  ds_read_b128 v[12:15], v73 offset:59392
  v_mfma_f32_16x16x32_bf16 v[40:43], a[104:107], v[24:27], v[40:43]
  ds_read_b128 v[16:19], v73 offset:60416
  v_mfma_f32_16x16x32_bf16 v[44:47], a[232:235], v[20:23], v[44:47]
  v_mfma_f32_16x16x32_bf16 v[48:51], a[232:235], v[24:27], v[48:51]
  s_waitcnt lgkmcnt(4)
  v_mfma_f32_16x16x32_bf16 v[36:39], a[108:111], v[28:31], v[36:39]
  ds_read_b128 v[20:23], v73 offset:61440
  v_mfma_f32_16x16x32_bf16 v[40:43], a[108:111], v[32:35], v[40:43]
  ds_read_b128 v[24:27], v73 offset:62464
  v_mfma_f32_16x16x32_bf16 v[44:47], a[236:239], v[28:31], v[44:47]
  v_mfma_f32_16x16x32_bf16 v[48:51], a[236:239], v[32:35], v[48:51]
  s_waitcnt lgkmcnt(4)
  v_mfma_f32_16x16x32_bf16 v[36:39], a[112:115], v[4:7], v[36:39]
  ds_read_b128 v[28:31], v73 offset:63488
  v_mfma_f32_16x16x32_bf16 v[40:43], a[112:115], v[8:11], v[40:43]
  ds_read_b128 v[32:35], v73 offset:64512
  v_mfma_f32_16x16x32_bf16 v[44:47], a[240:243], v[4:7], v[44:47]
  v_mfma_f32_16x16x32_bf16 v[48:51], a[240:243], v[8:11], v[48:51]
  s_waitcnt lgkmcnt(4)
  v_mfma_f32_16x16x32_bf16 v[36:39], a[116:119], v[12:15], v[36:39]
  v_mfma_f32_16x16x32_bf16 v[40:43], a[116:119], v[16:19], v[40:43]
  v_mfma_f32_16x16x32_bf16 v[44:47], a[244:247], v[12:15], v[44:47]
  v_mfma_f32_16x16x32_bf16 v[48:51], a[244:247], v[16:19], v[48:51]
  s_waitcnt vmcnt(0)
  s_barrier
  ds_read_b32 v3, v71 offset:1024
  s_waitcnt lgkmcnt(2)
  v_mfma_f32_16x16x32_bf16 v[36:39], a[120:123], v[20:23], v[36:39]
  v_mfma_f32_16x16x32_bf16 v[40:43], a[120:123], v[24:27], v[40:43]
  v_mfma_f32_16x16x32_bf16 v[44:47], a[248:251], v[20:23], v[44:47]
  v_mfma_f32_16x16x32_bf16 v[48:51], a[248:251], v[24:27], v[48:51]
  s_waitcnt lgkmcnt(0)
  v_mfma_f32_16x16x32_bf16 v[36:39], a[124:127], v[28:31], v[36:39]
  v_mfma_f32_16x16x32_bf16 v[40:43], a[124:127], v[32:35], v[40:43]
  v_mfma_f32_16x16x32_bf16 v[44:47], a[252:255], v[28:31], v[44:47]
  v_mfma_f32_16x16x32_bf16 v[48:51], a[252:255], v[32:35], v[48:51]
  v_cmp_gt_i32 vcc, s29, v3
  s_cmp_eq_u64 vcc, 0
  s_cselect_b32 s28, 2, 0
  s_cmp_lt_u32 s25, 63
  s_cselect_b32 s28, s28, 0
L_WO_epi:
  v_cvt_pk_bf16_f32 v52, v36, v37
  v_cvt_pk_bf16_f32 v53, v38, v39
  v_cvt_pk_bf16_f32 v54, v44, v45
  v_cvt_pk_bf16_f32 v55, v46, v47
  buffer_store_dwordx4 v[52:55], v68, s[4:7], s31 offen offset:0 sc1
  v_cvt_pk_bf16_f32 v56, v40, v41
  v_cvt_pk_bf16_f32 v57, v42, v43
  v_cvt_pk_bf16_f32 v58, v48, v49
  v_cvt_pk_bf16_f32 v59, v50, v51
  buffer_store_dwordx4 v[56:59], v68, s[4:7], s31 offen offset:1024 sc1
  s_add_u32 s25, s25, 1
  s_add_u32 s31, s31, 2097152
  s_xor_b32 s31, s31, 0x2000
  s_branch L_WO_top
L_WO_rep:
  s_mov_b32 s63, s25
  s_atomic_smax s63, s[4:5], s62 glc
Lnosig_140:
  s_branch L_WO_s2
L_F1:
  v_lshlrev_b32 v1, 4, v0
  s_lshl_b32 s32, s20, 12
  s_min_u32 s33, s32, 0x2000
  v_mov_b32 v69, v1
  v_add_u32 v70, 0x10000, v69
  v_and_b32 v1, 3, v0
  v_lshlrev_b32 v1, 4, v1
  v_lshrrev_b32 v52, 4, v0
  v_lshl_add_u32 v1, v52, 6, v1
  v_bfe_u32 v52, v0, 2, 2
  v_lshl_add_u32 v1, v52, 8, v1
  s_load_dwordx2 s[8:9], s[0:1], 64
  s_mov_b32 s10, 7340032
  s_mov_b32 s11, 0x20000
  s_waitcnt lgkmcnt(0)
  s_lshl_b32 s44, s21, 7
  v_bfe_u32 v4, v0, 5, 1
  v_mul_u32_u24 v4, 28672, v4
  v_bfe_u32 v5, v0, 4, 1
  v_mul_u32_u24 v5, 14336, v5
  v_add_u32 v4, v4, v5
  v_bfe_u32 v5, v0, 3, 1
  v_mul_u32_u24 v5, 7168, v5
  v_add_u32 v4, v4, v5
  v_lshrrev_b32 v5, 3, v0
  v_and_b32 v5, 6, v5
  v_xor_b32 v5, v5, v0
  v_and_b32 v5, 7, v5
  v_lshl_add_u32 v4, v5, 4, v4
  s_lshr_b32 s40, s20, 1
  s_mul_i32 s40, s40, 458752
  s_and_b32 s41, s20, 1
  s_mul_i32 s41, s41, 57344
  s_add_u32 s40, s40, s41
  v_add_u32 v4, s40, v4
  v_bfe_u32 v5, v0, 3, 2
  v_xor_b32 v5, s20, v5
  v_lshlrev_b32 v5, 5, v5
  v_lshrrev_b32 v6, 2, v0
  v_lshl_add_u32 v6, v6, 7, v5
  v_and_b32 v5, 3, v0
  v_lshl_add_u32 v6, v5, 3, v6
  v_add_u32 v7, 0x10000, v6
  v_add_u32 v8, s44, v4
  v_add_u32 v9, s44, v4
  s_lshl_b32 s41, s20, 10
  s_add_u32 m0, s41, 0
  s_mov_b32 s42, 0
  buffer_load_dwordx4 v8, s[8:11], s42 offen nt lds
  s_add_u32 m0, s41, 4096
  s_mov_b32 s42, 114688
  buffer_load_dwordx4 v8, s[8:11], s42 offen nt lds
  s_add_u32 m0, s41, 8192
  s_mov_b32 s42, 229376
  buffer_load_dwordx4 v8, s[8:11], s42 offen nt lds
  s_add_u32 m0, s41, 12288
  s_mov_b32 s42, 344064
  buffer_load_dwordx4 v8, s[8:11], s42 offen nt lds
  s_add_u32 m0, s41, 16384
  s_mov_b32 s42, 917504
  buffer_load_dwordx4 v8, s[8:11], s42 offen nt lds
  s_add_u32 m0, s41, 20480
  s_mov_b32 s42, 1032192
  buffer_load_dwordx4 v8, s[8:11], s42 offen nt lds
  s_add_u32 m0, s41, 24576
  s_mov_b32 s42, 1146880
  buffer_load_dwordx4 v8, s[8:11], s42 offen nt lds
  s_add_u32 m0, s41, 28672
  s_mov_b32 s42, 1261568
  buffer_load_dwordx4 v8, s[8:11], s42 offen nt lds
  s_add_u32 m0, s41, 32768
  s_mov_b32 s42, 1835008
  buffer_load_dwordx4 v8, s[8:11], s42 offen nt lds
  s_add_u32 m0, s41, 36864
  s_mov_b32 s42, 1949696
  buffer_load_dwordx4 v8, s[8:11], s42 offen nt lds
  s_add_u32 m0, s41, 40960
  s_mov_b32 s42, 2064384
  buffer_load_dwordx4 v8, s[8:11], s42 offen nt lds
  s_add_u32 m0, s41, 45056
  s_mov_b32 s42, 2179072
  buffer_load_dwordx4 v8, s[8:11], s42 offen nt lds
  s_add_u32 m0, s41, 49152
  s_mov_b32 s42, 2752512
  buffer_load_dwordx4 v8, s[8:11], s42 offen nt lds
  s_add_u32 m0, s41, 53248
  s_mov_b32 s42, 2867200
  buffer_load_dwordx4 v8, s[8:11], s42 offen nt lds
  s_add_u32 m0, s41, 57344
  s_mov_b32 s42, 2981888
  buffer_load_dwordx4 v8, s[8:11], s42 offen nt lds
  s_add_u32 m0, s41, 61440
  s_mov_b32 s42, 3096576
  buffer_load_dwordx4 v8, s[8:11], s42 offen nt lds
  s_add_u32 m0, s41, 65536
  s_mov_b32 s42, 3670016
  buffer_load_dwordx4 v8, s[8:11], s42 offen nt lds
  s_add_u32 m0, s41, 69632
  s_mov_b32 s42, 3784704
  buffer_load_dwordx4 v8, s[8:11], s42 offen nt lds
  s_add_u32 m0, s41, 73728
  s_mov_b32 s42, 3899392
  buffer_load_dwordx4 v8, s[8:11], s42 offen nt lds
  s_add_u32 m0, s41, 77824
  s_mov_b32 s42, 4014080
  buffer_load_dwordx4 v8, s[8:11], s42 offen nt lds
  s_add_u32 m0, s41, 81920
  s_mov_b32 s42, 4587520
  buffer_load_dwordx4 v8, s[8:11], s42 offen nt lds
  s_add_u32 m0, s41, 86016
  s_mov_b32 s42, 4702208
  buffer_load_dwordx4 v8, s[8:11], s42 offen nt lds
  s_add_u32 m0, s41, 90112
  s_mov_b32 s42, 4816896
  buffer_load_dwordx4 v8, s[8:11], s42 offen nt lds
  s_add_u32 m0, s41, 94208
  s_mov_b32 s42, 4931584
  buffer_load_dwordx4 v8, s[8:11], s42 offen nt lds
  s_add_u32 m0, s41, 98304
  s_mov_b32 s42, 5505024
  buffer_load_dwordx4 v8, s[8:11], s42 offen nt lds
  s_add_u32 m0, s41, 102400
  s_mov_b32 s42, 5619712
  buffer_load_dwordx4 v8, s[8:11], s42 offen nt lds
  s_add_u32 m0, s41, 106496
  s_mov_b32 s42, 5734400
  buffer_load_dwordx4 v8, s[8:11], s42 offen nt lds
  s_add_u32 m0, s41, 110592
  s_mov_b32 s42, 5849088
  buffer_load_dwordx4 v8, s[8:11], s42 offen nt lds
  s_waitcnt vmcnt(24) lgkmcnt(0)
  s_barrier
  s_add_u32 m0, s41, 114688
  s_mov_b32 s42, 6422528
  buffer_load_dwordx4 v8, s[8:11], s42 offen nt lds
  s_add_u32 m0, s41, 118784
  s_mov_b32 s42, 6537216
  buffer_load_dwordx4 v8, s[8:11], s42 offen nt lds
  s_add_u32 m0, s41, 122880
  s_mov_b32 s42, 6651904
  buffer_load_dwordx4 v8, s[8:11], s42 offen nt lds
  s_add_u32 m0, s41, 126976
  s_mov_b32 s42, 6766592
  buffer_load_dwordx4 v8, s[8:11], s42 offen nt lds
  ds_read_b64_tr_b16 a[0:1], v6 offset:0
  ds_read_b64_tr_b16 a[2:3], v6 offset:2048
  ds_read_b64_tr_b16 a[4:5], v6 offset:4096
  ds_read_b64_tr_b16 a[6:7], v6 offset:6144
  ds_read_b64_tr_b16 a[8:9], v6 offset:8192
  ds_read_b64_tr_b16 a[10:11], v6 offset:10240
  ds_read_b64_tr_b16 a[12:13], v6 offset:12288
  ds_read_b64_tr_b16 a[14:15], v6 offset:14336
  s_waitcnt vmcnt(24) lgkmcnt(0)
  s_barrier
  s_load_dwordx2 s[8:9], s[0:1], 72
  s_mov_b32 s10, 7340032
  s_mov_b32 s11, 0x20000
  s_waitcnt lgkmcnt(0)
  s_add_u32 m0, s41, 0
  s_mov_b32 s42, 0
  buffer_load_dwordx4 v9, s[8:11], s42 offen nt lds
  s_add_u32 m0, s41, 4096
  s_mov_b32 s42, 114688
  buffer_load_dwordx4 v9, s[8:11], s42 offen nt lds
  s_add_u32 m0, s41, 8192
  s_mov_b32 s42, 229376
  buffer_load_dwordx4 v9, s[8:11], s42 offen nt lds
  s_add_u32 m0, s41, 12288
  s_mov_b32 s42, 344064
  buffer_load_dwordx4 v9, s[8:11], s42 offen nt lds
  ds_read_b64_tr_b16 a[16:17], v6 offset:16384
  ds_read_b64_tr_b16 a[18:19], v6 offset:18432
  ds_read_b64_tr_b16 a[20:21], v6 offset:20480
  ds_read_b64_tr_b16 a[22:23], v6 offset:22528
  ds_read_b64_tr_b16 a[24:25], v6 offset:24576
  ds_read_b64_tr_b16 a[26:27], v6 offset:26624
  ds_read_b64_tr_b16 a[28:29], v6 offset:28672
  ds_read_b64_tr_b16 a[30:31], v6 offset:30720
  s_waitcnt vmcnt(24) lgkmcnt(0)
  s_barrier
  s_add_u32 m0, s41, 16384
  s_mov_b32 s42, 917504
  buffer_load_dwordx4 v9, s[8:11], s42 offen nt lds
  s_add_u32 m0, s41, 20480
  s_mov_b32 s42, 1032192
  buffer_load_dwordx4 v9, s[8:11], s42 offen nt lds
  s_add_u32 m0, s41, 24576
  s_mov_b32 s42, 1146880
  buffer_load_dwordx4 v9, s[8:11], s42 offen nt lds
  s_add_u32 m0, s41, 28672
  s_mov_b32 s42, 1261568
  buffer_load_dwordx4 v9, s[8:11], s42 offen nt lds
  ds_read_b64_tr_b16 a[32:33], v6 offset:32768
  ds_read_b64_tr_b16 a[34:35], v6 offset:34816
  ds_read_b64_tr_b16 a[36:37], v6 offset:36864
  ds_read_b64_tr_b16 a[38:39], v6 offset:38912
  ds_read_b64_tr_b16 a[40:41], v6 offset:40960
  ds_read_b64_tr_b16 a[42:43], v6 offset:43008
  ds_read_b64_tr_b16 a[44:45], v6 offset:45056
  ds_read_b64_tr_b16 a[46:47], v6 offset:47104
  s_waitcnt vmcnt(24) lgkmcnt(0)
  s_barrier
  s_add_u32 m0, s41, 32768
  s_mov_b32 s42, 1835008
  buffer_load_dwordx4 v9, s[8:11], s42 offen nt lds
  s_add_u32 m0, s41, 36864
  s_mov_b32 s42, 1949696
  buffer_load_dwordx4 v9, s[8:11], s42 offen nt lds
  s_add_u32 m0, s41, 40960
  s_mov_b32 s42, 2064384
  buffer_load_dwordx4 v9, s[8:11], s42 offen nt lds
  s_add_u32 m0, s41, 45056
  s_mov_b32 s42, 2179072
  buffer_load_dwordx4 v9, s[8:11], s42 offen nt lds
  ds_read_b64_tr_b16 a[48:49], v6 offset:49152
  ds_read_b64_tr_b16 a[50:51], v6 offset:51200
  ds_read_b64_tr_b16 a[52:53], v6 offset:53248
  ds_read_b64_tr_b16 a[54:55], v6 offset:55296
  ds_read_b64_tr_b16 a[56:57], v6 offset:57344
  ds_read_b64_tr_b16 a[58:59], v6 offset:59392
  ds_read_b64_tr_b16 a[60:61], v6 offset:61440
  ds_read_b64_tr_b16 a[62:63], v6 offset:63488
  s_waitcnt vmcnt(24) lgkmcnt(0)
  s_barrier
  s_add_u32 m0, s41, 49152
  s_mov_b32 s42, 2752512
  buffer_load_dwordx4 v9, s[8:11], s42 offen nt lds
  s_add_u32 m0, s41, 53248
  s_mov_b32 s42, 2867200
  buffer_load_dwordx4 v9, s[8:11], s42 offen nt lds
  s_add_u32 m0, s41, 57344
  s_mov_b32 s42, 2981888
  buffer_load_dwordx4 v9, s[8:11], s42 offen nt lds
  s_add_u32 m0, s41, 61440
  s_mov_b32 s42, 3096576
  buffer_load_dwordx4 v9, s[8:11], s42 offen nt lds
  ds_read_b64_tr_b16 a[64:65], v7 offset:0
  ds_read_b64_tr_b16 a[66:67], v7 offset:2048
  ds_read_b64_tr_b16 a[68:69], v7 offset:4096
  ds_read_b64_tr_b16 a[70:71], v7 offset:6144
  ds_read_b64_tr_b16 a[72:73], v7 offset:8192
  ds_read_b64_tr_b16 a[74:75], v7 offset:10240
  ds_read_b64_tr_b16 a[76:77], v7 offset:12288
  ds_read_b64_tr_b16 a[78:79], v7 offset:14336
  s_waitcnt vmcnt(24) lgkmcnt(0)
  s_barrier
  s_add_u32 m0, s41, 65536
  s_mov_b32 s42, 3670016
  buffer_load_dwordx4 v9, s[8:11], s42 offen nt lds
  s_add_u32 m0, s41, 69632
  s_mov_b32 s42, 3784704
  buffer_load_dwordx4 v9, s[8:11], s42 offen nt lds
  s_add_u32 m0, s41, 73728
  s_mov_b32 s42, 3899392
  buffer_load_dwordx4 v9, s[8:11], s42 offen nt lds
  s_add_u32 m0, s41, 77824
  s_mov_b32 s42, 4014080
  buffer_load_dwordx4 v9, s[8:11], s42 offen nt lds
  ds_read_b64_tr_b16 a[80:81], v7 offset:16384
  ds_read_b64_tr_b16 a[82:83], v7 offset:18432
  ds_read_b64_tr_b16 a[84:85], v7 offset:20480
  ds_read_b64_tr_b16 a[86:87], v7 offset:22528
  ds_read_b64_tr_b16 a[88:89], v7 offset:24576
  ds_read_b64_tr_b16 a[90:91], v7 offset:26624
  ds_read_b64_tr_b16 a[92:93], v7 offset:28672
  ds_read_b64_tr_b16 a[94:95], v7 offset:30720
  s_waitcnt vmcnt(24) lgkmcnt(0)
  s_barrier
  s_add_u32 m0, s41, 81920
  s_mov_b32 s42, 4587520
  buffer_load_dwordx4 v9, s[8:11], s42 offen nt lds
  s_add_u32 m0, s41, 86016
  s_mov_b32 s42, 4702208
  buffer_load_dwordx4 v9, s[8:11], s42 offen nt lds
  s_add_u32 m0, s41, 90112
  s_mov_b32 s42, 4816896
  buffer_load_dwordx4 v9, s[8:11], s42 offen nt lds
  s_add_u32 m0, s41, 94208
  s_mov_b32 s42, 4931584
  buffer_load_dwordx4 v9, s[8:11], s42 offen nt lds
  ds_read_b64_tr_b16 a[96:97], v7 offset:32768
  ds_read_b64_tr_b16 a[98:99], v7 offset:34816
  ds_read_b64_tr_b16 a[100:101], v7 offset:36864
  ds_read_b64_tr_b16 a[102:103], v7 offset:38912
  ds_read_b64_tr_b16 a[104:105], v7 offset:40960
  ds_read_b64_tr_b16 a[106:107], v7 offset:43008
  ds_read_b64_tr_b16 a[108:109], v7 offset:45056
  ds_read_b64_tr_b16 a[110:111], v7 offset:47104
  s_waitcnt vmcnt(24) lgkmcnt(0)
  s_barrier
  s_add_u32 m0, s41, 98304
  s_mov_b32 s42, 5505024
  buffer_load_dwordx4 v9, s[8:11], s42 offen nt lds
  s_add_u32 m0, s41, 102400
  s_mov_b32 s42, 5619712
  buffer_load_dwordx4 v9, s[8:11], s42 offen nt lds
  s_add_u32 m0, s41, 106496
  s_mov_b32 s42, 5734400
  buffer_load_dwordx4 v9, s[8:11], s42 offen nt lds
  s_add_u32 m0, s41, 110592
  s_mov_b32 s42, 5849088
  buffer_load_dwordx4 v9, s[8:11], s42 offen nt lds
  ds_read_b64_tr_b16 a[112:113], v7 offset:49152
  ds_read_b64_tr_b16 a[114:115], v7 offset:51200
  ds_read_b64_tr_b16 a[116:117], v7 offset:53248
  ds_read_b64_tr_b16 a[118:119], v7 offset:55296
  ds_read_b64_tr_b16 a[120:121], v7 offset:57344
  ds_read_b64_tr_b16 a[122:123], v7 offset:59392
  ds_read_b64_tr_b16 a[124:125], v7 offset:61440
  ds_read_b64_tr_b16 a[126:127], v7 offset:63488
  s_waitcnt vmcnt(24) lgkmcnt(0)
  s_barrier
  s_add_u32 m0, s41, 114688
  s_mov_b32 s42, 6422528
  buffer_load_dwordx4 v9, s[8:11], s42 offen nt lds
  s_add_u32 m0, s41, 118784
  s_mov_b32 s42, 6537216
  buffer_load_dwordx4 v9, s[8:11], s42 offen nt lds
  s_add_u32 m0, s41, 122880
  s_mov_b32 s42, 6651904
  buffer_load_dwordx4 v9, s[8:11], s42 offen nt lds
  s_add_u32 m0, s41, 126976
  s_mov_b32 s42, 6766592
  buffer_load_dwordx4 v9, s[8:11], s42 offen nt lds
  ds_read_b64_tr_b16 a[128:129], v6 offset:0
  ds_read_b64_tr_b16 a[130:131], v6 offset:2048
  ds_read_b64_tr_b16 a[132:133], v6 offset:4096
  ds_read_b64_tr_b16 a[134:135], v6 offset:6144
  ds_read_b64_tr_b16 a[136:137], v6 offset:8192
  ds_read_b64_tr_b16 a[138:139], v6 offset:10240
  ds_read_b64_tr_b16 a[140:141], v6 offset:12288
  ds_read_b64_tr_b16 a[142:143], v6 offset:14336
  s_waitcnt vmcnt(24) lgkmcnt(0)
  s_barrier
  ds_read_b64_tr_b16 a[144:145], v6 offset:16384
  ds_read_b64_tr_b16 a[146:147], v6 offset:18432
  ds_read_b64_tr_b16 a[148:149], v6 offset:20480
  ds_read_b64_tr_b16 a[150:151], v6 offset:22528
  ds_read_b64_tr_b16 a[152:153], v6 offset:24576
  ds_read_b64_tr_b16 a[154:155], v6 offset:26624
  ds_read_b64_tr_b16 a[156:157], v6 offset:28672
  ds_read_b64_tr_b16 a[158:159], v6 offset:30720
  s_waitcnt vmcnt(20) lgkmcnt(0)
  s_barrier
  ds_read_b64_tr_b16 a[160:161], v6 offset:32768
  ds_read_b64_tr_b16 a[162:163], v6 offset:34816
  ds_read_b64_tr_b16 a[164:165], v6 offset:36864
  ds_read_b64_tr_b16 a[166:167], v6 offset:38912
  ds_read_b64_tr_b16 a[168:169], v6 offset:40960
  ds_read_b64_tr_b16 a[170:171], v6 offset:43008
  ds_read_b64_tr_b16 a[172:173], v6 offset:45056
  ds_read_b64_tr_b16 a[174:175], v6 offset:47104
  s_waitcnt vmcnt(16) lgkmcnt(0)
  s_barrier
  ds_read_b64_tr_b16 a[176:177], v6 offset:49152
  ds_read_b64_tr_b16 a[178:179], v6 offset:51200
  ds_read_b64_tr_b16 a[180:181], v6 offset:53248
  ds_read_b64_tr_b16 a[182:183], v6 offset:55296
  ds_read_b64_tr_b16 a[184:185], v6 offset:57344
  ds_read_b64_tr_b16 a[186:187], v6 offset:59392
  ds_read_b64_tr_b16 a[188:189], v6 offset:61440
  ds_read_b64_tr_b16 a[190:191], v6 offset:63488
  s_waitcnt vmcnt(12) lgkmcnt(0)
  s_barrier
  ds_read_b64_tr_b16 a[192:193], v7 offset:0
  ds_read_b64_tr_b16 a[194:195], v7 offset:2048
  ds_read_b64_tr_b16 a[196:197], v7 offset:4096
  ds_read_b64_tr_b16 a[198:199], v7 offset:6144
  ds_read_b64_tr_b16 a[200:201], v7 offset:8192
  ds_read_b64_tr_b16 a[202:203], v7 offset:10240
  ds_read_b64_tr_b16 a[204:205], v7 offset:12288
  ds_read_b64_tr_b16 a[206:207], v7 offset:14336
  s_waitcnt vmcnt(8) lgkmcnt(0)
  s_barrier
  ds_read_b64_tr_b16 a[208:209], v7 offset:16384
  ds_read_b64_tr_b16 a[210:211], v7 offset:18432
  ds_read_b64_tr_b16 a[212:213], v7 offset:20480
  ds_read_b64_tr_b16 a[214:215], v7 offset:22528
  ds_read_b64_tr_b16 a[216:217], v7 offset:24576
  ds_read_b64_tr_b16 a[218:219], v7 offset:26624
  ds_read_b64_tr_b16 a[220:221], v7 offset:28672
  ds_read_b64_tr_b16 a[222:223], v7 offset:30720
  s_waitcnt vmcnt(4) lgkmcnt(0)
  s_barrier
  ds_read_b64_tr_b16 a[224:225], v7 offset:32768
  ds_read_b64_tr_b16 a[226:227], v7 offset:34816
  ds_read_b64_tr_b16 a[228:229], v7 offset:36864
  ds_read_b64_tr_b16 a[230:231], v7 offset:38912
  ds_read_b64_tr_b16 a[232:233], v7 offset:40960
  ds_read_b64_tr_b16 a[234:235], v7 offset:43008
  ds_read_b64_tr_b16 a[236:237], v7 offset:45056
  ds_read_b64_tr_b16 a[238:239], v7 offset:47104
  s_waitcnt vmcnt(0) lgkmcnt(0)
  s_barrier
  ds_read_b64_tr_b16 a[240:241], v7 offset:49152
  ds_read_b64_tr_b16 a[242:243], v7 offset:51200
  ds_read_b64_tr_b16 a[244:245], v7 offset:53248
  ds_read_b64_tr_b16 a[246:247], v7 offset:55296
  ds_read_b64_tr_b16 a[248:249], v7 offset:57344
  ds_read_b64_tr_b16 a[250:251], v7 offset:59392
  ds_read_b64_tr_b16 a[252:253], v7 offset:61440
  ds_read_b64_tr_b16 a[254:255], v7 offset:63488
  s_waitcnt lgkmcnt(0)
  s_barrier
  v_min_u32 v2, 7, v0
  v_lshlrev_b32 v2, 7, v2
  v_add_u32 v2, 1413120, v2
  s_lshl_b32 s62, s21, 7
  s_add_u32 s62, s62, 1414144
  v_min_u32 v52, 63, v0
  v_lshlrev_b32 v52, 7, v52
  v_add_u32 v52, 1424384, v52
  s_nop 1
Lpoll_142:
  buffer_load_dword v53, v52, s[4:7], 0 offen sc1
  s_sub_u32 s24, s24, 1
  s_cbranch_scc1 L_FAIL
  s_waitcnt vmcnt(0)
  v_cmp_gt_i32 vcc, 0, v53
  s_cbranch_vccz Lpolld_143
  s_sleep 1
  s_branch Lpoll_142
Lpolld_143:
Ltab_141:
  v_lshrrev_b32 v53, 8, v53
  v_and_b32 v54, 3, v0
  v_lshl_or_b32 v53, v53, 2, v54
  s_nop 1
  v_min_u32_dpp v53, v53, v53 row_ror:8 row_mask:0xf bank_mask:0xf
  s_nop 1
  v_min_u32_dpp v53, v53, v53 row_ror:4 row_mask:0xf bank_mask:0xf
  v_mov_b32 v54, v53
  s_nop 1
  v_permlane16_swap_b32 v54, v53
  v_min_u32 v53, v53, v54
  v_mov_b32 v54, v53
  s_nop 1
  v_permlane32_swap_b32 v54, v53
  v_min_u32 v53, v53, v54
  s_nop 1
  v_min_u32_dpp v53, v53, v53 row_ror:2 row_mask:0xf bank_mask:0xf
  s_nop 1
  v_min_u32_dpp v53, v53, v53 row_ror:1 row_mask:0xf bank_mask:0xf
  s_nop 0
  v_readfirstlane_b32 s38, v53
  s_and_b32 s38, s38, 3
  s_lshl_b32 s38, s38, 13
  s_and_b32 s38, s38, 0x2000
  s_xor_b32 s38, s38, 20979712
  s_lshr_b32 s40, s20, 1
  s_lshl_b32 s40, s40, 14
  s_and_b32 s41, s20, 1
  s_lshl_b32 s41, s41, 12
  s_add_u32 s27, s40, s41
  s_lshr_b32 s40, s21, 1
  s_lshl_b32 s40, s40, 14
  s_and_b32 s41, s21, 1
  s_lshl_b32 s41, s41, 12
  s_add_u32 s31, s40, s41
  s_add_u32 s27, s27, s38
  s_add_u32 s27, s27, 917504
  s_add_u32 s31, s31, s38
  s_add_u32 s31, s31, 1179648
  s_lshr_b32 s40, s20, 1
  s_lshl_b32 s40, s40, 11
  s_and_b32 s41, s20, 1
  s_lshl_b32 s41, s41, 9
  s_add_u32 s40, s40, s41
  v_and_b32 v52, 31, v0
  v_lshl_add_u32 v68, v52, 4, s40
  v_lshrrev_b32 v52, 5, v0
  v_lshl_add_u32 v68, v52, 10, v68
  s_mov_b32 s37, 0xbfb8aa3b
  v_lshlrev_b32 v71, 2, v0
  v_add_u32 v71, 131072, v71
  s_mov_b32 s25, 0
  s_mov_b32 s26, 0
  s_mov_b32 s29, 1
  s_mov_b32 s30, 0
  s_mov_b32 s28, 0
  s_lshl_b32 s44, s20, 8
  s_add_u32 s44, s44, 131072
  s_cmp_eq_u32 s20, 0
  s_cselect_b32 s45, 0, 2147483392
  s_cselect_b32 s46, 1, -1
L_F1_top:
  s_cmp_eq_u32 s28, 1
  s_cbranch_scc1 L_F1_go
  s_cmp_eq_u32 s28, 2
  s_cbranch_scc1 L_F1_mid
  s_cmp_lg_u32 s20, 0
  s_cbranch_scc1 L_F1_park
  buffer_load_dword v3, v2, s[4:7], s30 offen sc1
  s_waitcnt vmcnt(1)
  s_barrier
  s_mov_b32 s63, s25
  s_atomic_smax s63, s[4:5], s62 glc
Lnosig_144:
  s_cmp_ge_u32 s25, 64
  s_cbranch_scc1 L_END
  s_waitcnt vmcnt(0)
  v_cmp_gt_i32 vcc, s29, v3
  s_cbranch_vccz L_F1_issue
  s_nop 3
Lpoll_145:
  buffer_load_dword v3, v2, s[4:7], s30 offen sc1
  s_sub_u32 s24, s24, 1
  s_cbranch_scc1 L_FAIL
  s_waitcnt vmcnt(0)
  v_cmp_gt_i32 vcc, s29, v3
  s_cbranch_vccz Lpolld_146
  s_sleep 1
  s_branch Lpoll_145
Lpolld_146:
  s_branch L_F1_issue
L_F1_park:
  s_nop 0
  s_waitcnt vmcnt(0)
  s_barrier
  s_cmp_ge_u32 s25, 64
  s_cbranch_scc1 L_END
L_F1_issue:
  s_barrier
L_F1_mid:
  s_mov_b32 s34, s26
  s_mov_b32 s35, s27
  s_add_u32 s36, s32, 0
  s_add_u32 m0, s34, s36
  s_add_u32 s36, s35, 0
  buffer_load_dwordx4 v1, s[4:7], s36 offen offset:0 sc1 lds
  s_nop 0
  buffer_load_dwordx4 v1, s[4:7], s36 offen offset:1024 sc1 lds
  s_nop 0
  buffer_load_dwordx4 v1, s[4:7], s36 offen offset:2048 sc1 lds
  s_nop 0
  buffer_load_dwordx4 v1, s[4:7], s36 offen offset:3072 sc1 lds
  s_nop 0
  s_add_u32 s36, s32, 16384
  s_add_u32 m0, s34, s36
  s_add_u32 s36, s35, 32768
  buffer_load_dwordx4 v1, s[4:7], s36 offen offset:0 sc1 lds
  s_nop 0
  buffer_load_dwordx4 v1, s[4:7], s36 offen offset:1024 sc1 lds
  s_nop 0
  buffer_load_dwordx4 v1, s[4:7], s36 offen offset:2048 sc1 lds
  s_nop 0
  buffer_load_dwordx4 v1, s[4:7], s36 offen offset:3072 sc1 lds
  s_nop 0
  s_add_u32 s36, s32, 32768
  s_add_u32 m0, s34, s36
  s_add_u32 s36, s35, 65536
  buffer_load_dwordx4 v1, s[4:7], s36 offen offset:0 sc1 lds
  s_nop 0
  buffer_load_dwordx4 v1, s[4:7], s36 offen offset:1024 sc1 lds
  s_nop 0
  buffer_load_dwordx4 v1, s[4:7], s36 offen offset:2048 sc1 lds
  s_nop 0
  buffer_load_dwordx4 v1, s[4:7], s36 offen offset:3072 sc1 lds
  s_nop 0
  s_cmp_eq_u32 s28, 0
  s_nop 0
  s_nop 0
  s_cbranch_scc1 L_F1_go
  s_mov_b32 s28, 0
  s_waitcnt vmcnt(12)
  s_barrier
  s_cmp_lg_u32 s20, 0
  s_cbranch_scc1 Lnosig_147
  s_mov_b32 s63, s25
  s_atomic_smax s63, s[4:5], s62 glc
Lnosig_147:
L_F1_go:
  v_add_u32 v73, s26, v69
  v_add_u32 v74, s26, v70
  s_sub_u32 s26, 65536, s26
  s_add_u32 s27, s27, 2097152
  s_xor_b32 s27, s27, 0x2000
  s_add_u32 s29, s29, 1
  s_waitcnt vmcnt(8)
  s_barrier
  ds_read_b128 v[4:7], v73 offset:0
  ds_read_b128 v[8:11], v73 offset:1024
  ds_read_b128 v[12:15], v73 offset:2048
  ds_read_b128 v[16:19], v73 offset:3072
  ds_read_b128 v[20:23], v73 offset:4096
  ds_read_b128 v[24:27], v73 offset:5120
  s_waitcnt lgkmcnt(4)
  v_mfma_f32_16x16x32_bf16 v[36:39], a[0:3], v[4:7], 0
  ds_read_b128 v[28:31], v73 offset:6144
  v_mfma_f32_16x16x32_bf16 v[40:43], a[0:3], v[8:11], 0
  ds_read_b128 v[32:35], v73 offset:7168
  v_mfma_f32_16x16x32_bf16 v[44:47], a[128:131], v[4:7], 0
  s_add_u32 s36, s32, 49152
  s_add_u32 m0, s34, s36
  s_add_u32 s36, s35, 98304
  buffer_load_dwordx4 v1, s[4:7], s36 offen offset:0 sc1 lds
  v_mfma_f32_16x16x32_bf16 v[48:51], a[128:131], v[8:11], 0
  s_waitcnt lgkmcnt(4)
  v_mfma_f32_16x16x32_bf16 v[36:39], a[4:7], v[12:15], v[36:39]
  ds_read_b128 v[4:7], v73 offset:8192
  v_mfma_f32_16x16x32_bf16 v[40:43], a[4:7], v[16:19], v[40:43]
  ds_read_b128 v[8:11], v73 offset:9216
  v_mfma_f32_16x16x32_bf16 v[44:47], a[132:135], v[12:15], v[44:47]
  buffer_load_dwordx4 v1, s[4:7], s36 offen offset:1024 sc1 lds
  v_mfma_f32_16x16x32_bf16 v[48:51], a[132:135], v[16:19], v[48:51]
  s_waitcnt lgkmcnt(4)
  v_mfma_f32_16x16x32_bf16 v[36:39], a[8:11], v[20:23], v[36:39]
  ds_read_b128 v[12:15], v73 offset:10240
  v_mfma_f32_16x16x32_bf16 v[40:43], a[8:11], v[24:27], v[40:43]
  ds_read_b128 v[16:19], v73 offset:11264
  v_mfma_f32_16x16x32_bf16 v[44:47], a[136:139], v[20:23], v[44:47]
  buffer_load_dwordx4 v1, s[4:7], s36 offen offset:2048 sc1 lds
  v_mfma_f32_16x16x32_bf16 v[48:51], a[136:139], v[24:27], v[48:51]
  s_waitcnt lgkmcnt(4)
  v_mfma_f32_16x16x32_bf16 v[36:39], a[12:15], v[28:31], v[36:39]
  ds_read_b128 v[20:23], v73 offset:12288
  v_mfma_f32_16x16x32_bf16 v[40:43], a[12:15], v[32:35], v[40:43]
  ds_read_b128 v[24:27], v73 offset:13312
  v_mfma_f32_16x16x32_bf16 v[44:47], a[140:143], v[28:31], v[44:47]
  buffer_load_dwordx4 v1, s[4:7], s36 offen offset:3072 sc1 lds
  v_mfma_f32_16x16x32_bf16 v[48:51], a[140:143], v[32:35], v[48:51]
  s_waitcnt lgkmcnt(4)
  v_mfma_f32_16x16x32_bf16 v[36:39], a[16:19], v[4:7], v[36:39]
  ds_read_b128 v[28:31], v73 offset:14336
  v_mfma_f32_16x16x32_bf16 v[40:43], a[16:19], v[8:11], v[40:43]
  ds_read_b128 v[32:35], v73 offset:15360
  v_mfma_f32_16x16x32_bf16 v[44:47], a[144:147], v[4:7], v[44:47]
  v_mfma_f32_16x16x32_bf16 v[48:51], a[144:147], v[8:11], v[48:51]
  s_waitcnt vmcnt(8)
  s_barrier
  s_waitcnt lgkmcnt(4)
  v_mfma_f32_16x16x32_bf16 v[36:39], a[20:23], v[12:15], v[36:39]
  ds_read_b128 v[4:7], v73 offset:16384
  v_mfma_f32_16x16x32_bf16 v[40:43], a[20:23], v[16:19], v[40:43]
  ds_read_b128 v[8:11], v73 offset:17408
  v_mfma_f32_16x16x32_bf16 v[44:47], a[148:151], v[12:15], v[44:47]
  v_mfma_f32_16x16x32_bf16 v[48:51], a[148:151], v[16:19], v[48:51]
  s_waitcnt lgkmcnt(4)
  v_mfma_f32_16x16x32_bf16 v[36:39], a[24:27], v[20:23], v[36:39]
  ds_read_b128 v[12:15], v73 offset:18432
  v_mfma_f32_16x16x32_bf16 v[40:43], a[24:27], v[24:27], v[40:43]
  ds_read_b128 v[16:19], v73 offset:19456
  v_mfma_f32_16x16x32_bf16 v[44:47], a[152:155], v[20:23], v[44:47]
  v_mfma_f32_16x16x32_bf16 v[48:51], a[152:155], v[24:27], v[48:51]
  s_waitcnt lgkmcnt(4)
  v_mfma_f32_16x16x32_bf16 v[36:39], a[28:31], v[28:31], v[36:39]
  ds_read_b128 v[20:23], v73 offset:20480
  v_mfma_f32_16x16x32_bf16 v[40:43], a[28:31], v[32:35], v[40:43]
  ds_read_b128 v[24:27], v73 offset:21504
  v_mfma_f32_16x16x32_bf16 v[44:47], a[156:159], v[28:31], v[44:47]
  v_mfma_f32_16x16x32_bf16 v[48:51], a[156:159], v[32:35], v[48:51]
  s_waitcnt lgkmcnt(4)
  v_mfma_f32_16x16x32_bf16 v[36:39], a[32:35], v[4:7], v[36:39]
  ds_read_b128 v[28:31], v73 offset:22528
  v_mfma_f32_16x16x32_bf16 v[40:43], a[32:35], v[8:11], v[40:43]
  ds_read_b128 v[32:35], v73 offset:23552
  v_mfma_f32_16x16x32_bf16 v[44:47], a[160:163], v[4:7], v[44:47]
  v_mfma_f32_16x16x32_bf16 v[48:51], a[160:163], v[8:11], v[48:51]
  s_waitcnt lgkmcnt(4)
  v_mfma_f32_16x16x32_bf16 v[36:39], a[36:39], v[12:15], v[36:39]
  ds_read_b128 v[4:7], v73 offset:24576
  v_mfma_f32_16x16x32_bf16 v[40:43], a[36:39], v[16:19], v[40:43]
  ds_read_b128 v[8:11], v73 offset:25600
  v_mfma_f32_16x16x32_bf16 v[44:47], a[164:167], v[12:15], v[44:47]
  v_mfma_f32_16x16x32_bf16 v[48:51], a[164:167], v[16:19], v[48:51]
  s_waitcnt lgkmcnt(4)
  v_mfma_f32_16x16x32_bf16 v[36:39], a[40:43], v[20:23], v[36:39]
  ds_read_b128 v[12:15], v73 offset:26624
  v_mfma_f32_16x16x32_bf16 v[40:43], a[40:43], v[24:27], v[40:43]
  ds_read_b128 v[16:19], v73 offset:27648
  v_mfma_f32_16x16x32_bf16 v[44:47], a[168:171], v[20:23], v[44:47]
  v_mfma_f32_16x16x32_bf16 v[48:51], a[168:171], v[24:27], v[48:51]
  s_waitcnt lgkmcnt(4)
  v_mfma_f32_16x16x32_bf16 v[36:39], a[44:47], v[28:31], v[36:39]
  ds_read_b128 v[20:23], v73 offset:28672
  v_mfma_f32_16x16x32_bf16 v[40:43], a[44:47], v[32:35], v[40:43]
  ds_read_b128 v[24:27], v73 offset:29696
  v_mfma_f32_16x16x32_bf16 v[44:47], a[172:175], v[28:31], v[44:47]
  s_mov_b32 s34, s26
  s_mov_b32 s35, s27
  v_mfma_f32_16x16x32_bf16 v[48:51], a[172:175], v[32:35], v[48:51]
  s_waitcnt lgkmcnt(4)
  v_mfma_f32_16x16x32_bf16 v[36:39], a[48:51], v[4:7], v[36:39]
  ds_read_b128 v[28:31], v73 offset:30720
  v_mfma_f32_16x16x32_bf16 v[40:43], a[48:51], v[8:11], v[40:43]
  ds_read_b128 v[32:35], v73 offset:31744
  v_mfma_f32_16x16x32_bf16 v[44:47], a[176:179], v[4:7], v[44:47]
  s_add_u32 m0, s44, 0
  s_add_u32 s40, s30, s45
  v_mfma_f32_16x16x32_bf16 v[48:51], a[176:179], v[8:11], v[48:51]
  buffer_load_dword v2, s[4:7], s40 offen sc1 lds
  s_waitcnt vmcnt(5)
  s_barrier
  s_cmp_eq_u32 s46, s28
  s_cbranch_scc1 L_F1_rep
L_F1_s2:
  s_waitcnt lgkmcnt(4)
  v_mfma_f32_16x16x32_bf16 v[36:39], a[52:55], v[12:15], v[36:39]
  ds_read_b128 v[4:7], v73 offset:32768
  v_mfma_f32_16x16x32_bf16 v[40:43], a[52:55], v[16:19], v[40:43]
  ds_read_b128 v[8:11], v73 offset:33792
  v_mfma_f32_16x16x32_bf16 v[44:47], a[180:183], v[12:15], v[44:47]
  v_mfma_f32_16x16x32_bf16 v[48:51], a[180:183], v[16:19], v[48:51]
  s_waitcnt lgkmcnt(4)
  v_mfma_f32_16x16x32_bf16 v[36:39], a[56:59], v[20:23], v[36:39]
  ds_read_b128 v[12:15], v73 offset:34816
  v_mfma_f32_16x16x32_bf16 v[40:43], a[56:59], v[24:27], v[40:43]
  ds_read_b128 v[16:19], v73 offset:35840
  v_mfma_f32_16x16x32_bf16 v[44:47], a[184:187], v[20:23], v[44:47]
  v_mfma_f32_16x16x32_bf16 v[48:51], a[184:187], v[24:27], v[48:51]
  s_waitcnt lgkmcnt(4)
  v_mfma_f32_16x16x32_bf16 v[36:39], a[60:63], v[28:31], v[36:39]
  ds_read_b128 v[20:23], v73 offset:36864
  v_mfma_f32_16x16x32_bf16 v[40:43], a[60:63], v[32:35], v[40:43]
  ds_read_b128 v[24:27], v73 offset:37888
  v_mfma_f32_16x16x32_bf16 v[44:47], a[188:191], v[28:31], v[44:47]
  v_mfma_f32_16x16x32_bf16 v[48:51], a[188:191], v[32:35], v[48:51]
  s_waitcnt lgkmcnt(4)
  v_mfma_f32_16x16x32_bf16 v[36:39], a[64:67], v[4:7], v[36:39]
  ds_read_b128 v[28:31], v73 offset:38912
  v_mfma_f32_16x16x32_bf16 v[40:43], a[64:67], v[8:11], v[40:43]
  ds_read_b128 v[32:35], v73 offset:39936
  v_mfma_f32_16x16x32_bf16 v[44:47], a[192:195], v[4:7], v[44:47]
  v_mfma_f32_16x16x32_bf16 v[48:51], a[192:195], v[8:11], v[48:51]
  s_waitcnt lgkmcnt(4)
  v_mfma_f32_16x16x32_bf16 v[36:39], a[68:71], v[12:15], v[36:39]
  ds_read_b128 v[4:7], v73 offset:40960
  v_mfma_f32_16x16x32_bf16 v[40:43], a[68:71], v[16:19], v[40:43]
  ds_read_b128 v[8:11], v73 offset:41984
  v_mfma_f32_16x16x32_bf16 v[44:47], a[196:199], v[12:15], v[44:47]
  v_mfma_f32_16x16x32_bf16 v[48:51], a[196:199], v[16:19], v[48:51]
  s_waitcnt lgkmcnt(4)
  v_mfma_f32_16x16x32_bf16 v[36:39], a[72:75], v[20:23], v[36:39]
  ds_read_b128 v[12:15], v73 offset:43008
  v_mfma_f32_16x16x32_bf16 v[40:43], a[72:75], v[24:27], v[40:43]
  ds_read_b128 v[16:19], v73 offset:44032
  v_mfma_f32_16x16x32_bf16 v[44:47], a[200:203], v[20:23], v[44:47]
  v_mfma_f32_16x16x32_bf16 v[48:51], a[200:203], v[24:27], v[48:51]
  s_waitcnt vmcnt(0)
  s_barrier
  ds_read_b32 v3, v71
  s_waitcnt lgkmcnt(4)
  v_mfma_f32_16x16x32_bf16 v[36:39], a[76:79], v[28:31], v[36:39]
  ds_read_b128 v[20:23], v73 offset:45056
  v_mfma_f32_16x16x32_bf16 v[40:43], a[76:79], v[32:35], v[40:43]
  ds_read_b128 v[24:27], v73 offset:46080
  v_mfma_f32_16x16x32_bf16 v[44:47], a[204:207], v[28:31], v[44:47]
  v_mfma_f32_16x16x32_bf16 v[48:51], a[204:207], v[32:35], v[48:51]
  s_waitcnt lgkmcnt(4)
  v_mfma_f32_16x16x32_bf16 v[36:39], a[80:83], v[4:7], v[36:39]
  ds_read_b128 v[28:31], v73 offset:47104
  v_mfma_f32_16x16x32_bf16 v[40:43], a[80:83], v[8:11], v[40:43]
  ds_read_b128 v[32:35], v73 offset:48128
  v_mfma_f32_16x16x32_bf16 v[44:47], a[208:211], v[4:7], v[44:47]
  v_mfma_f32_16x16x32_bf16 v[48:51], a[208:211], v[8:11], v[48:51]
  s_waitcnt lgkmcnt(4)
  v_cmp_gt_i32 vcc, s29, v3
  s_mov_b32 s28, 0
  s_cbranch_vccnz L_F1_nopf
  s_cmp_ge_u32 s25, 63
  s_cbranch_scc1 L_F1_nopf
  s_mov_b32 s28, 1
  s_waitcnt lgkmcnt(4)
  v_mfma_f32_16x16x32_bf16 v[36:39], a[84:87], v[12:15], v[36:39]
  ds_read_b128 v[4:7], v73 offset:49152
  v_mfma_f32_16x16x32_bf16 v[40:43], a[84:87], v[16:19], v[40:43]
  ds_read_b128 v[8:11], v73 offset:50176
  v_mfma_f32_16x16x32_bf16 v[44:47], a[212:215], v[12:15], v[44:47]
  s_add_u32 s36, s32, 0
  s_add_u32 m0, s34, s36
  s_add_u32 s36, s35, 0
  buffer_load_dwordx4 v1, s[4:7], s36 offen offset:0 sc1 lds
  v_mfma_f32_16x16x32_bf16 v[48:51], a[212:215], v[16:19], v[48:51]
  buffer_load_dwordx4 v1, s[4:7], s36 offen offset:1024 sc1 lds
  s_waitcnt lgkmcnt(4)
  v_mfma_f32_16x16x32_bf16 v[36:39], a[88:91], v[20:23], v[36:39]
  ds_read_b128 v[12:15], v73 offset:51200
  v_mfma_f32_16x16x32_bf16 v[40:43], a[88:91], v[24:27], v[40:43]
  ds_read_b128 v[16:19], v73 offset:52224
  v_mfma_f32_16x16x32_bf16 v[44:47], a[216:219], v[20:23], v[44:47]
  buffer_load_dwordx4 v1, s[4:7], s36 offen offset:2048 sc1 lds
  v_mfma_f32_16x16x32_bf16 v[48:51], a[216:219], v[24:27], v[48:51]
  buffer_load_dwordx4 v1, s[4:7], s36 offen offset:3072 sc1 lds
  s_waitcnt lgkmcnt(4)
  v_mfma_f32_16x16x32_bf16 v[36:39], a[92:95], v[28:31], v[36:39]
  ds_read_b128 v[20:23], v73 offset:53248
  v_mfma_f32_16x16x32_bf16 v[40:43], a[92:95], v[32:35], v[40:43]
  ds_read_b128 v[24:27], v73 offset:54272
  v_mfma_f32_16x16x32_bf16 v[44:47], a[220:223], v[28:31], v[44:47]
  s_add_u32 s36, s32, 16384
  s_add_u32 m0, s34, s36
  s_add_u32 s36, s35, 32768
  buffer_load_dwordx4 v1, s[4:7], s36 offen offset:0 sc1 lds
  v_mfma_f32_16x16x32_bf16 v[48:51], a[220:223], v[32:35], v[48:51]
  buffer_load_dwordx4 v1, s[4:7], s36 offen offset:1024 sc1 lds
  s_waitcnt lgkmcnt(4)
  v_mfma_f32_16x16x32_bf16 v[36:39], a[96:99], v[4:7], v[36:39]
  ds_read_b128 v[28:31], v73 offset:55296
  v_mfma_f32_16x16x32_bf16 v[40:43], a[96:99], v[8:11], v[40:43]
  ds_read_b128 v[32:35], v73 offset:56320
  v_mfma_f32_16x16x32_bf16 v[44:47], a[224:227], v[4:7], v[44:47]
  buffer_load_dwordx4 v1, s[4:7], s36 offen offset:2048 sc1 lds
  v_mfma_f32_16x16x32_bf16 v[48:51], a[224:227], v[8:11], v[48:51]
  buffer_load_dwordx4 v1, s[4:7], s36 offen offset:3072 sc1 lds
  s_waitcnt lgkmcnt(4)
  v_mfma_f32_16x16x32_bf16 v[36:39], a[100:103], v[12:15], v[36:39]
  ds_read_b128 v[4:7], v73 offset:57344
  v_mfma_f32_16x16x32_bf16 v[40:43], a[100:103], v[16:19], v[40:43]
  ds_read_b128 v[8:11], v73 offset:58368
  v_mfma_f32_16x16x32_bf16 v[44:47], a[228:231], v[12:15], v[44:47]
  s_add_u32 s36, s32, 32768
  s_add_u32 m0, s34, s36
  s_add_u32 s36, s35, 65536
  buffer_load_dwordx4 v1, s[4:7], s36 offen offset:0 sc1 lds
  v_mfma_f32_16x16x32_bf16 v[48:51], a[228:231], v[16:19], v[48:51]
  buffer_load_dwordx4 v1, s[4:7], s36 offen offset:1024 sc1 lds
  s_waitcnt lgkmcnt(4)
  v_mfma_f32_16x16x32_bf16 v[36:39], a[104:107], v[20:23], v[36:39]
  ds_read_b128 v[12:15], v73 offset:59392
  v_mfma_f32_16x16x32_bf16 v[40:43], a[104:107], v[24:27], v[40:43]
  ds_read_b128 v[16:19], v73 offset:60416
  v_mfma_f32_16x16x32_bf16 v[44:47], a[232:235], v[20:23], v[44:47]
  buffer_load_dwordx4 v1, s[4:7], s36 offen offset:2048 sc1 lds
  v_mfma_f32_16x16x32_bf16 v[48:51], a[232:235], v[24:27], v[48:51]
  buffer_load_dwordx4 v1, s[4:7], s36 offen offset:3072 sc1 lds
  s_waitcnt lgkmcnt(4)
  v_mfma_f32_16x16x32_bf16 v[36:39], a[108:111], v[28:31], v[36:39]
  ds_read_b128 v[20:23], v73 offset:61440
  v_mfma_f32_16x16x32_bf16 v[40:43], a[108:111], v[32:35], v[40:43]
  ds_read_b128 v[24:27], v73 offset:62464
  v_mfma_f32_16x16x32_bf16 v[44:47], a[236:239], v[28:31], v[44:47]
  v_mfma_f32_16x16x32_bf16 v[48:51], a[236:239], v[32:35], v[48:51]
  s_waitcnt lgkmcnt(4)
  v_mfma_f32_16x16x32_bf16 v[36:39], a[112:115], v[4:7], v[36:39]
  ds_read_b128 v[28:31], v73 offset:63488
  v_mfma_f32_16x16x32_bf16 v[40:43], a[112:115], v[8:11], v[40:43]
  ds_read_b128 v[32:35], v73 offset:64512
  v_mfma_f32_16x16x32_bf16 v[44:47], a[240:243], v[4:7], v[44:47]
  v_mfma_f32_16x16x32_bf16 v[48:51], a[240:243], v[8:11], v[48:51]
  s_waitcnt lgkmcnt(4)
  v_mfma_f32_16x16x32_bf16 v[36:39], a[116:119], v[12:15], v[36:39]
  v_mfma_f32_16x16x32_bf16 v[40:43], a[116:119], v[16:19], v[40:43]
  v_mfma_f32_16x16x32_bf16 v[44:47], a[244:247], v[12:15], v[44:47]
  v_mfma_f32_16x16x32_bf16 v[48:51], a[244:247], v[16:19], v[48:51]
  s_waitcnt lgkmcnt(2)
  v_mfma_f32_16x16x32_bf16 v[36:39], a[120:123], v[20:23], v[36:39]
  v_mfma_f32_16x16x32_bf16 v[40:43], a[120:123], v[24:27], v[40:43]
  v_mfma_f32_16x16x32_bf16 v[44:47], a[248:251], v[20:23], v[44:47]
  v_mfma_f32_16x16x32_bf16 v[48:51], a[248:251], v[24:27], v[48:51]
  s_waitcnt lgkmcnt(0)
  v_mfma_f32_16x16x32_bf16 v[36:39], a[124:127], v[28:31], v[36:39]
  v_mfma_f32_16x16x32_bf16 v[40:43], a[124:127], v[32:35], v[40:43]
  v_mfma_f32_16x16x32_bf16 v[44:47], a[252:255], v[28:31], v[44:47]
  v_mfma_f32_16x16x32_bf16 v[48:51], a[252:255], v[32:35], v[48:51]
  s_nop 7
  s_branch L_F1_epi
L_F1_nopf:
  s_waitcnt lgkmcnt(4)
  v_mfma_f32_16x16x32_bf16 v[36:39], a[84:87], v[12:15], v[36:39]
  ds_read_b128 v[4:7], v73 offset:49152
  v_mfma_f32_16x16x32_bf16 v[40:43], a[84:87], v[16:19], v[40:43]
  ds_read_b128 v[8:11], v73 offset:50176
  v_mfma_f32_16x16x32_bf16 v[44:47], a[212:215], v[12:15], v[44:47]
  v_mfma_f32_16x16x32_bf16 v[48:51], a[212:215], v[16:19], v[48:51]
  s_waitcnt lgkmcnt(4)
  v_mfma_f32_16x16x32_bf16 v[36:39], a[88:91], v[20:23], v[36:39]
  ds_read_b128 v[12:15], v73 offset:51200
  v_mfma_f32_16x16x32_bf16 v[40:43], a[88:91], v[24:27], v[40:43]
  ds_read_b128 v[16:19], v73 offset:52224
  v_mfma_f32_16x16x32_bf16 v[44:47], a[216:219], v[20:23], v[44:47]
  v_mfma_f32_16x16x32_bf16 v[48:51], a[216:219], v[24:27], v[48:51]
  s_waitcnt lgkmcnt(4)
  v_mfma_f32_16x16x32_bf16 v[36:39], a[92:95], v[28:31], v[36:39]
  ds_read_b128 v[20:23], v73 offset:53248
  v_mfma_f32_16x16x32_bf16 v[40:43], a[92:95], v[32:35], v[40:43]
  ds_read_b128 v[24:27], v73 offset:54272
  v_mfma_f32_16x16x32_bf16 v[44:47], a[220:223], v[28:31], v[44:47]
  v_mfma_f32_16x16x32_bf16 v[48:51], a[220:223], v[32:35], v[48:51]
  s_waitcnt lgkmcnt(4)
  v_mfma_f32_16x16x32_bf16 v[36:39], a[96:99], v[4:7], v[36:39]
  ds_read_b128 v[28:31], v73 offset:55296
  v_mfma_f32_16x16x32_bf16 v[40:43], a[96:99], v[8:11], v[40:43]
  ds_read_b128 v[32:35], v73 offset:56320
  v_mfma_f32_16x16x32_bf16 v[44:47], a[224:227], v[4:7], v[44:47]
  s_add_u32 m0, s44, 1024
  s_add_u32 s40, s30, s45
  v_mfma_f32_16x16x32_bf16 v[48:51], a[224:227], v[8:11], v[48:51]
  buffer_load_dword v2, s[4:7], s40 offen sc1 lds
  s_waitcnt lgkmcnt(4)
  v_mfma_f32_16x16x32_bf16 v[36:39], a[100:103], v[12:15], v[36:39]
  ds_read_b128 v[4:7], v73 offset:57344
  v_mfma_f32_16x16x32_bf16 v[40:43], a[100:103], v[16:19], v[40:43]
  ds_read_b128 v[8:11], v73 offset:58368
  v_mfma_f32_16x16x32_bf16 v[44:47], a[228:231], v[12:15], v[44:47]
  v_mfma_f32_16x16x32_bf16 v[48:51], a[228:231], v[16:19], v[48:51]
  s_waitcnt lgkmcnt(4)
  v_mfma_f32_16x16x32_bf16 v[36:39], a[104:107], v[20:23], v[36:39]
  ds_read_b128 v[12:15], v73 offset:59392
  v_mfma_f32_16x16x32_bf16 v[40:43], a[104:107], v[24:27], v[40:43]
  ds_read_b128 v[16:19], v73 offset:60416
  v_mfma_f32_16x16x32_bf16 v[44:47], a[232:235], v[20:23], v[44:47]
  v_mfma_f32_16x16x32_bf16 v[48:51], a[232:235], v[24:27], v[48:51]
  s_waitcnt lgkmcnt(4)
  v_mfma_f32_16x16x32_bf16 v[36:39], a[108:111], v[28:31], v[36:39]
  ds_read_b128 v[20:23], v73 offset:61440
  v_mfma_f32_16x16x32_bf16 v[40:43], a[108:111], v[32:35], v[40:43]
  ds_read_b128 v[24:27], v73 offset:62464
  v_mfma_f32_16x16x32_bf16 v[44:47], a[236:239], v[28:31], v[44:47]
  v_mfma_f32_16x16x32_bf16 v[48:51], a[236:239], v[32:35], v[48:51]
  s_waitcnt lgkmcnt(4)
  v_mfma_f32_16x16x32_bf16 v[36:39], a[112:115], v[4:7], v[36:39]
  ds_read_b128 v[28:31], v73 offset:63488
  v_mfma_f32_16x16x32_bf16 v[40:43], a[112:115], v[8:11], v[40:43]
  ds_read_b128 v[32:35], v73 offset:64512
  v_mfma_f32_16x16x32_bf16 v[44:47], a[240:243], v[4:7], v[44:47]
  v_mfma_f32_16x16x32_bf16 v[48:51], a[240:243], v[8:11], v[48:51]
  s_waitcnt lgkmcnt(4)
  v_mfma_f32_16x16x32_bf16 v[36:39], a[116:119], v[12:15], v[36:39]
  v_mfma_f32_16x16x32_bf16 v[40:43], a[116:119], v[16:19], v[40:43]
  v_mfma_f32_16x16x32_bf16 v[44:47], a[244:247], v[12:15], v[44:47]
  v_mfma_f32_16x16x32_bf16 v[48:51], a[244:247], v[16:19], v[48:51]
  s_waitcnt vmcnt(0)
  s_barrier
  ds_read_b32 v3, v71 offset:1024
  s_waitcnt lgkmcnt(2)
  v_mfma_f32_16x16x32_bf16 v[36:39], a[120:123], v[20:23], v[36:39]
  v_mfma_f32_16x16x32_bf16 v[40:43], a[120:123], v[24:27], v[40:43]
  v_mfma_f32_16x16x32_bf16 v[44:47], a[248:251], v[20:23], v[44:47]
  v_mfma_f32_16x16x32_bf16 v[48:51], a[248:251], v[24:27], v[48:51]
  s_waitcnt lgkmcnt(0)
  v_mfma_f32_16x16x32_bf16 v[36:39], a[124:127], v[28:31], v[36:39]
  v_mfma_f32_16x16x32_bf16 v[40:43], a[124:127], v[32:35], v[40:43]
  v_mfma_f32_16x16x32_bf16 v[44:47], a[252:255], v[28:31], v[44:47]
  v_mfma_f32_16x16x32_bf16 v[48:51], a[252:255], v[32:35], v[48:51]
  v_cmp_gt_i32 vcc, s29, v3
  s_cmp_eq_u64 vcc, 0
  s_cselect_b32 s28, 2, 0
  s_cmp_lt_u32 s25, 63
  s_cselect_b32 s28, s28, 0
L_F1_epi:
  v_mul_f32 v52, s37, v36
  v_mul_f32 v53, s37, v37
  v_mul_f32 v54, s37, v38
  v_mul_f32 v55, s37, v39
  v_mul_f32 v56, s37, v40
  v_mul_f32 v57, s37, v41
  v_mul_f32 v58, s37, v42
  v_mul_f32 v59, s37, v43
  v_exp_f32 v52, v52
  v_exp_f32 v53, v53
  v_exp_f32 v54, v54
  v_exp_f32 v55, v55
  v_exp_f32 v56, v56
  v_exp_f32 v57, v57
  v_exp_f32 v58, v58
  v_exp_f32 v59, v59
  v_pk_mul_f32 v[36:37], v[36:37], v[44:45]
  v_pk_mul_f32 v[38:39], v[38:39], v[46:47]
  v_pk_mul_f32 v[40:41], v[40:41], v[48:49]
  v_pk_mul_f32 v[42:43], v[42:43], v[50:51]
  v_add_f32 v52, 1.0, v52
  v_add_f32 v53, 1.0, v53
  v_add_f32 v54, 1.0, v54
  v_add_f32 v55, 1.0, v55
  v_add_f32 v56, 1.0, v56
  v_add_f32 v57, 1.0, v57
  v_add_f32 v58, 1.0, v58
  v_add_f32 v59, 1.0, v59
  v_rcp_f32 v52, v52
  v_rcp_f32 v53, v53
  v_rcp_f32 v54, v54
  v_rcp_f32 v55, v55
  v_rcp_f32 v56, v56
  v_rcp_f32 v57, v57
  v_rcp_f32 v58, v58
  v_rcp_f32 v59, v59
  v_pk_mul_f32 v[36:37], v[36:37], v[52:53]
  v_pk_mul_f32 v[38:39], v[38:39], v[54:55]
  v_pk_mul_f32 v[40:41], v[40:41], v[56:57]
  v_pk_mul_f32 v[42:43], v[42:43], v[58:59]
  v_cvt_pk_bf16_f32 v60, v36, v37
  v_cvt_pk_bf16_f32 v61, v38, v39
  v_cvt_pk_bf16_f32 v62, v40, v41
  v_cvt_pk_bf16_f32 v63, v42, v43
  s_nop 0
  v_permlane32_swap_b32 v60, v62
  v_permlane32_swap_b32 v61, v63
  buffer_store_dwordx4 v[60:63], v68, s[4:7], s31 offen sc1
  s_add_u32 s25, s25, 1
  s_add_u32 s31, s31, 2097152
  s_xor_b32 s31, s31, 0x2000
  s_branch L_F1_top
L_F1_rep:
  s_mov_b32 s63, s25
  s_atomic_smax s63, s[4:5], s62 glc
Lnosig_148:
  s_branch L_F1_s2
L_F2:
  v_lshlrev_b32 v1, 4, v0
  s_lshl_b32 s32, s20, 12
  s_min_u32 s33, s32, 0x2000
  v_mov_b32 v69, v1
  v_add_u32 v70, 0x10000, v69
  s_load_dwordx2 s[8:9], s[0:1], 80
  s_mov_b32 s10, 7340032
  s_mov_b32 s11, 0x20000
  s_waitcnt lgkmcnt(0)
  s_lshr_b32 s44, s21, 3
  s_mul_i32 s44, s44, 2490368
  s_and_b32 s45, s21, 7
  s_lshl_b32 s45, s45, 8
  s_add_u32 s44, s44, s45
  s_add_u32 s45, s44, 128
  s_cmp_ge_u32 s21, 16
  s_cselect_b32 s40, 131072, 0
  s_sub_u32 s44, s44, s40
  s_sub_u32 s45, s45, s40
  v_bfe_u32 v4, v0, 5, 1
  v_mul_u32_u24 v4, 8192, v4
  v_bfe_u32 v5, v0, 4, 1
  v_mul_u32_u24 v5, 4096, v5
  v_add_u32 v4, v4, v5
  v_bfe_u32 v5, v0, 3, 1
  v_mul_u32_u24 v5, 2048, v5
  v_add_u32 v4, v4, v5
  v_lshrrev_b32 v5, 3, v0
  v_and_b32 v5, 6, v5
  v_xor_b32 v5, v5, v0
  v_and_b32 v5, 7, v5
  v_lshl_add_u32 v4, v5, 4, v4
  s_lshr_b32 s40, s20, 1
  s_mul_i32 s40, s40, 16384
  s_and_b32 s41, s20, 1
  s_mul_i32 s41, s41, 32768
  s_add_u32 s40, s40, s41
  v_add_u32 v4, s40, v4
  v_bfe_u32 v5, v0, 3, 2
  v_xor_b32 v5, s20, v5
  v_lshlrev_b32 v5, 5, v5
  v_lshrrev_b32 v6, 2, v0
  v_lshl_add_u32 v6, v6, 7, v5
  v_and_b32 v5, 3, v0
  v_lshl_add_u32 v6, v5, 3, v6
  v_add_u32 v7, 0x10000, v6
  v_add_u32 v8, s44, v4
  v_add_u32 v9, s45, v4
  s_lshl_b32 s41, s20, 10
  s_add_u32 m0, s41, 0
  s_mov_b32 s42, 0
  buffer_load_dwordx4 v8, s[8:11], s42 offen nt lds
  s_add_u32 m0, s41, 4096
  s_mov_b32 s42, 0
  buffer_load_dwordx4 v9, s[8:11], s42 offen nt lds
  s_add_u32 m0, s41, 8192
  s_mov_b32 s42, 65536
  buffer_load_dwordx4 v8, s[8:11], s42 offen nt lds
  s_add_u32 m0, s41, 12288
  s_mov_b32 s42, 65536
  buffer_load_dwordx4 v9, s[8:11], s42 offen nt lds
  s_add_u32 m0, s41, 16384
  s_mov_b32 s42, 131072
  buffer_load_dwordx4 v8, s[8:11], s42 offen nt lds
  s_add_u32 m0, s41, 20480
  s_mov_b32 s42, 131072
  buffer_load_dwordx4 v9, s[8:11], s42 offen nt lds
  s_add_u32 m0, s41, 24576
  s_mov_b32 s42, 196608
  buffer_load_dwordx4 v8, s[8:11], s42 offen nt lds
  s_add_u32 m0, s41, 28672
  s_mov_b32 s42, 196608
  buffer_load_dwordx4 v9, s[8:11], s42 offen nt lds
  s_add_u32 m0, s41, 32768
  s_mov_b32 s42, 262144
  buffer_load_dwordx4 v8, s[8:11], s42 offen nt lds
  s_add_u32 m0, s41, 36864
  s_mov_b32 s42, 262144
  buffer_load_dwordx4 v9, s[8:11], s42 offen nt lds
  s_add_u32 m0, s41, 40960
  s_mov_b32 s42, 327680
  buffer_load_dwordx4 v8, s[8:11], s42 offen nt lds
  s_add_u32 m0, s41, 45056
  s_mov_b32 s42, 327680
  buffer_load_dwordx4 v9, s[8:11], s42 offen nt lds
  s_add_u32 m0, s41, 49152
  s_mov_b32 s42, 393216
  buffer_load_dwordx4 v8, s[8:11], s42 offen nt lds
  s_add_u32 m0, s41, 53248
  s_mov_b32 s42, 393216
  buffer_load_dwordx4 v9, s[8:11], s42 offen nt lds
  s_add_u32 m0, s41, 57344
  s_mov_b32 s42, 458752
  buffer_load_dwordx4 v8, s[8:11], s42 offen nt lds
  s_add_u32 m0, s41, 61440
  s_mov_b32 s42, 458752
  buffer_load_dwordx4 v9, s[8:11], s42 offen nt lds
  s_add_u32 m0, s41, 65536
  s_mov_b32 s42, 524288
  buffer_load_dwordx4 v8, s[8:11], s42 offen nt lds
  s_add_u32 m0, s41, 69632
  s_mov_b32 s42, 524288
  buffer_load_dwordx4 v9, s[8:11], s42 offen nt lds
  s_add_u32 m0, s41, 73728
  s_mov_b32 s42, 589824
  buffer_load_dwordx4 v8, s[8:11], s42 offen nt lds
  s_add_u32 m0, s41, 77824
  s_mov_b32 s42, 589824
  buffer_load_dwordx4 v9, s[8:11], s42 offen nt lds
  s_add_u32 m0, s41, 81920
  s_mov_b32 s42, 655360
  buffer_load_dwordx4 v8, s[8:11], s42 offen nt lds
  s_add_u32 m0, s41, 86016
  s_mov_b32 s42, 655360
  buffer_load_dwordx4 v9, s[8:11], s42 offen nt lds
  s_add_u32 m0, s41, 90112
  s_mov_b32 s42, 720896
  buffer_load_dwordx4 v8, s[8:11], s42 offen nt lds
  s_add_u32 m0, s41, 94208
  s_mov_b32 s42, 720896
  buffer_load_dwordx4 v9, s[8:11], s42 offen nt lds
  s_add_u32 m0, s41, 98304
  s_mov_b32 s42, 786432
  buffer_load_dwordx4 v8, s[8:11], s42 offen nt lds
  s_add_u32 m0, s41, 102400
  s_mov_b32 s42, 786432
  buffer_load_dwordx4 v9, s[8:11], s42 offen nt lds
  s_add_u32 m0, s41, 106496
  s_mov_b32 s42, 851968
  buffer_load_dwordx4 v8, s[8:11], s42 offen nt lds
  s_add_u32 m0, s41, 110592
  s_mov_b32 s42, 851968
  buffer_load_dwordx4 v9, s[8:11], s42 offen nt lds
  s_waitcnt vmcnt(24) lgkmcnt(0)
  s_barrier
  s_add_u32 m0, s41, 114688
  s_mov_b32 s42, 917504
  buffer_load_dwordx4 v8, s[8:11], s42 offen nt lds
  s_add_u32 m0, s41, 118784
  s_mov_b32 s42, 917504
  buffer_load_dwordx4 v9, s[8:11], s42 offen nt lds
  s_add_u32 m0, s41, 122880
  s_mov_b32 s42, 983040
  buffer_load_dwordx4 v8, s[8:11], s42 offen nt lds
  s_add_u32 m0, s41, 126976
  s_mov_b32 s42, 983040
  buffer_load_dwordx4 v9, s[8:11], s42 offen nt lds
  ds_read_b64_tr_b16 a[0:1], v6 offset:0
  ds_read_b64_tr_b16 a[2:3], v6 offset:2048
  ds_read_b64_tr_b16 a[152:153], v6 offset:4096
  ds_read_b64_tr_b16 a[154:155], v6 offset:6144
  ds_read_b64_tr_b16 a[4:5], v6 offset:8192
  ds_read_b64_tr_b16 a[6:7], v6 offset:10240
  ds_read_b64_tr_b16 a[156:157], v6 offset:12288
  ds_read_b64_tr_b16 a[158:159], v6 offset:14336
  s_waitcnt vmcnt(24) lgkmcnt(0)
  s_barrier
  s_add_u32 m0, s41, 0
  s_mov_b32 s42, 1048576
  buffer_load_dwordx4 v8, s[8:11], s42 offen nt lds
  s_add_u32 m0, s41, 4096
  s_mov_b32 s42, 1048576
  buffer_load_dwordx4 v9, s[8:11], s42 offen nt lds
  s_add_u32 m0, s41, 8192
  s_mov_b32 s42, 1114112
  buffer_load_dwordx4 v8, s[8:11], s42 offen nt lds
  s_add_u32 m0, s41, 12288
  s_mov_b32 s42, 1114112
  buffer_load_dwordx4 v9, s[8:11], s42 offen nt lds
  ds_read_b64_tr_b16 a[8:9], v6 offset:16384
  ds_read_b64_tr_b16 a[10:11], v6 offset:18432
  ds_read_b64_tr_b16 a[160:161], v6 offset:20480
  ds_read_b64_tr_b16 a[162:163], v6 offset:22528
  ds_read_b64_tr_b16 a[12:13], v6 offset:24576
  ds_read_b64_tr_b16 a[14:15], v6 offset:26624
  ds_read_b64_tr_b16 a[164:165], v6 offset:28672
  ds_read_b64_tr_b16 a[166:167], v6 offset:30720
  s_waitcnt vmcnt(24) lgkmcnt(0)
  s_barrier
  s_add_u32 m0, s41, 16384
  s_mov_b32 s42, 1179648
  buffer_load_dwordx4 v8, s[8:11], s42 offen nt lds
  s_add_u32 m0, s41, 20480
  s_mov_b32 s42, 1179648
  buffer_load_dwordx4 v9, s[8:11], s42 offen nt lds
  s_add_u32 m0, s41, 24576
  s_mov_b32 s42, 1245184
  buffer_load_dwordx4 v8, s[8:11], s42 offen nt lds
  s_add_u32 m0, s41, 28672
  s_mov_b32 s42, 1245184
  buffer_load_dwordx4 v9, s[8:11], s42 offen nt lds
  ds_read_b64_tr_b16 a[16:17], v6 offset:32768
  ds_read_b64_tr_b16 a[18:19], v6 offset:34816
  ds_read_b64_tr_b16 a[168:169], v6 offset:36864
  ds_read_b64_tr_b16 a[170:171], v6 offset:38912
  ds_read_b64_tr_b16 a[20:21], v6 offset:40960
  ds_read_b64_tr_b16 a[22:23], v6 offset:43008
  ds_read_b64_tr_b16 a[172:173], v6 offset:45056
  ds_read_b64_tr_b16 a[174:175], v6 offset:47104
  s_waitcnt vmcnt(24) lgkmcnt(0)
  s_barrier
  s_add_u32 m0, s41, 32768
  s_mov_b32 s42, 1310720
  buffer_load_dwordx4 v8, s[8:11], s42 offen nt lds
  s_add_u32 m0, s41, 36864
  s_mov_b32 s42, 1310720
  buffer_load_dwordx4 v9, s[8:11], s42 offen nt lds
  s_add_u32 m0, s41, 40960
  s_mov_b32 s42, 1376256
  buffer_load_dwordx4 v8, s[8:11], s42 offen nt lds
  s_add_u32 m0, s41, 45056
  s_mov_b32 s42, 1376256
  buffer_load_dwordx4 v9, s[8:11], s42 offen nt lds
  ds_read_b64_tr_b16 a[24:25], v6 offset:49152
  ds_read_b64_tr_b16 a[26:27], v6 offset:51200
  ds_read_b64_tr_b16 a[176:177], v6 offset:53248
  ds_read_b64_tr_b16 a[178:179], v6 offset:55296
  ds_read_b64_tr_b16 a[28:29], v6 offset:57344
  ds_read_b64_tr_b16 a[30:31], v6 offset:59392
  ds_read_b64_tr_b16 a[180:181], v6 offset:61440
  ds_read_b64_tr_b16 a[182:183], v6 offset:63488
  s_waitcnt vmcnt(24) lgkmcnt(0)
  s_barrier
  s_add_u32 m0, s41, 49152
  s_mov_b32 s42, 1441792
  buffer_load_dwordx4 v8, s[8:11], s42 offen nt lds
  s_add_u32 m0, s41, 53248
  s_mov_b32 s42, 1441792
  buffer_load_dwordx4 v9, s[8:11], s42 offen nt lds
  s_add_u32 m0, s41, 57344
  s_mov_b32 s42, 1507328
  buffer_load_dwordx4 v8, s[8:11], s42 offen nt lds
  s_add_u32 m0, s41, 61440
  s_mov_b32 s42, 1507328
  buffer_load_dwordx4 v9, s[8:11], s42 offen nt lds
  ds_read_b64_tr_b16 a[32:33], v7 offset:0
  ds_read_b64_tr_b16 a[34:35], v7 offset:2048
  ds_read_b64_tr_b16 a[184:185], v7 offset:4096
  ds_read_b64_tr_b16 a[186:187], v7 offset:6144
  ds_read_b64_tr_b16 a[36:37], v7 offset:8192
  ds_read_b64_tr_b16 a[38:39], v7 offset:10240
  ds_read_b64_tr_b16 a[188:189], v7 offset:12288
  ds_read_b64_tr_b16 a[190:191], v7 offset:14336
  s_waitcnt vmcnt(24) lgkmcnt(0)
  s_barrier
  s_add_u32 m0, s41, 65536
  s_mov_b32 s42, 1572864
  buffer_load_dwordx4 v8, s[8:11], s42 offen nt lds
  s_add_u32 m0, s41, 69632
  s_mov_b32 s42, 1572864
  buffer_load_dwordx4 v9, s[8:11], s42 offen nt lds
  s_add_u32 m0, s41, 73728
  s_mov_b32 s42, 1638400
  buffer_load_dwordx4 v8, s[8:11], s42 offen nt lds
  s_add_u32 m0, s41, 77824
  s_mov_b32 s42, 1638400
  buffer_load_dwordx4 v9, s[8:11], s42 offen nt lds
  ds_read_b64_tr_b16 a[40:41], v7 offset:16384
  ds_read_b64_tr_b16 a[42:43], v7 offset:18432
  ds_read_b64_tr_b16 a[192:193], v7 offset:20480
  ds_read_b64_tr_b16 a[194:195], v7 offset:22528
  ds_read_b64_tr_b16 a[44:45], v7 offset:24576
  ds_read_b64_tr_b16 a[46:47], v7 offset:26624
  ds_read_b64_tr_b16 a[196:197], v7 offset:28672
  ds_read_b64_tr_b16 a[198:199], v7 offset:30720
  s_waitcnt vmcnt(24) lgkmcnt(0)
  s_barrier
  s_add_u32 m0, s41, 81920
  s_mov_b32 s42, 1703936
  buffer_load_dwordx4 v8, s[8:11], s42 offen nt lds
  s_add_u32 m0, s41, 86016
  s_mov_b32 s42, 1703936
  buffer_load_dwordx4 v9, s[8:11], s42 offen nt lds
  s_add_u32 m0, s41, 90112
  s_mov_b32 s42, 1769472
  buffer_load_dwordx4 v8, s[8:11], s42 offen nt lds
  s_add_u32 m0, s41, 94208
  s_mov_b32 s42, 1769472
  buffer_load_dwordx4 v9, s[8:11], s42 offen nt lds
  ds_read_b64_tr_b16 a[48:49], v7 offset:32768
  ds_read_b64_tr_b16 a[50:51], v7 offset:34816
  ds_read_b64_tr_b16 a[200:201], v7 offset:36864
  ds_read_b64_tr_b16 a[202:203], v7 offset:38912
  ds_read_b64_tr_b16 a[52:53], v7 offset:40960
  ds_read_b64_tr_b16 a[54:55], v7 offset:43008
  ds_read_b64_tr_b16 a[204:205], v7 offset:45056
  ds_read_b64_tr_b16 a[206:207], v7 offset:47104
  s_waitcnt vmcnt(24) lgkmcnt(0)
  s_barrier
  s_add_u32 m0, s41, 98304
  s_mov_b32 s42, 1835008
  buffer_load_dwordx4 v8, s[8:11], s42 offen nt lds
  s_add_u32 m0, s41, 102400
  s_mov_b32 s42, 1835008
  buffer_load_dwordx4 v9, s[8:11], s42 offen nt lds
  s_add_u32 m0, s41, 106496
  s_mov_b32 s42, 1900544
  buffer_load_dwordx4 v8, s[8:11], s42 offen nt lds
  s_add_u32 m0, s41, 110592
  s_mov_b32 s42, 1900544
  buffer_load_dwordx4 v9, s[8:11], s42 offen nt lds
  ds_read_b64_tr_b16 a[56:57], v7 offset:49152
  ds_read_b64_tr_b16 a[58:59], v7 offset:51200
  ds_read_b64_tr_b16 a[208:209], v7 offset:53248
  ds_read_b64_tr_b16 a[210:211], v7 offset:55296
  ds_read_b64_tr_b16 a[60:61], v7 offset:57344
  ds_read_b64_tr_b16 a[62:63], v7 offset:59392
  ds_read_b64_tr_b16 a[212:213], v7 offset:61440
  ds_read_b64_tr_b16 a[214:215], v7 offset:63488
  s_waitcnt vmcnt(24) lgkmcnt(0)
  s_barrier
  s_add_u32 m0, s41, 114688
  s_mov_b32 s42, 1966080
  buffer_load_dwordx4 v8, s[8:11], s42 offen nt lds
  s_add_u32 m0, s41, 118784
  s_mov_b32 s42, 1966080
  buffer_load_dwordx4 v9, s[8:11], s42 offen nt lds
  s_add_u32 m0, s41, 122880
  s_mov_b32 s42, 2031616
  buffer_load_dwordx4 v8, s[8:11], s42 offen nt lds
  s_add_u32 m0, s41, 126976
  s_mov_b32 s42, 2031616
  buffer_load_dwordx4 v9, s[8:11], s42 offen nt lds
  ds_read_b64_tr_b16 a[64:65], v6 offset:0
  ds_read_b64_tr_b16 a[66:67], v6 offset:2048
  ds_read_b64_tr_b16 a[216:217], v6 offset:4096
  ds_read_b64_tr_b16 a[218:219], v6 offset:6144
  ds_read_b64_tr_b16 a[68:69], v6 offset:8192
  ds_read_b64_tr_b16 a[70:71], v6 offset:10240
  ds_read_b64_tr_b16 a[220:221], v6 offset:12288
  ds_read_b64_tr_b16 a[222:223], v6 offset:14336
  s_waitcnt vmcnt(24) lgkmcnt(0)
  s_barrier
  s_add_u32 m0, s41, 0
  s_mov_b32 s42, 2097152
  buffer_load_dwordx4 v8, s[8:11], s42 offen nt lds
  s_add_u32 m0, s41, 4096
  s_mov_b32 s42, 2097152
  buffer_load_dwordx4 v9, s[8:11], s42 offen nt lds
  s_add_u32 m0, s41, 8192
  s_mov_b32 s42, 2162688
  buffer_load_dwordx4 v8, s[8:11], s42 offen nt lds
  s_add_u32 m0, s41, 12288
  s_mov_b32 s42, 2162688
  buffer_load_dwordx4 v9, s[8:11], s42 offen nt lds
  ds_read_b64_tr_b16 a[72:73], v6 offset:16384
  ds_read_b64_tr_b16 a[74:75], v6 offset:18432
  ds_read_b64_tr_b16 a[224:225], v6 offset:20480
  ds_read_b64_tr_b16 a[226:227], v6 offset:22528
  ds_read_b64_tr_b16 a[76:77], v6 offset:24576
  ds_read_b64_tr_b16 a[78:79], v6 offset:26624
  ds_read_b64_tr_b16 a[228:229], v6 offset:28672
  ds_read_b64_tr_b16 a[230:231], v6 offset:30720
  s_waitcnt vmcnt(24) lgkmcnt(0)
  s_barrier
  s_add_u32 m0, s41, 16384
  s_mov_b32 s42, 2228224
  buffer_load_dwordx4 v8, s[8:11], s42 offen nt lds
  s_add_u32 m0, s41, 20480
  s_mov_b32 s42, 2228224
  buffer_load_dwordx4 v9, s[8:11], s42 offen nt lds
  s_add_u32 m0, s41, 24576
  s_mov_b32 s42, 2293760
  buffer_load_dwordx4 v8, s[8:11], s42 offen nt lds
  s_add_u32 m0, s41, 28672
  s_mov_b32 s42, 2293760
  buffer_load_dwordx4 v9, s[8:11], s42 offen nt lds
  ds_read_b64_tr_b16 a[80:81], v6 offset:32768
  ds_read_b64_tr_b16 a[82:83], v6 offset:34816
  ds_read_b64_tr_b16 a[232:233], v6 offset:36864
  ds_read_b64_tr_b16 a[234:235], v6 offset:38912
  ds_read_b64_tr_b16 a[84:85], v6 offset:40960
  ds_read_b64_tr_b16 a[86:87], v6 offset:43008
  ds_read_b64_tr_b16 a[236:237], v6 offset:45056
  ds_read_b64_tr_b16 a[238:239], v6 offset:47104
  s_waitcnt vmcnt(24) lgkmcnt(0)
  s_barrier
  s_add_u32 m0, s41, 32768
  s_mov_b32 s42, 2359296
  buffer_load_dwordx4 v8, s[8:11], s42 offen nt lds
  s_add_u32 m0, s41, 36864
  s_mov_b32 s42, 2359296
  buffer_load_dwordx4 v9, s[8:11], s42 offen nt lds
  s_add_u32 m0, s41, 40960
  s_mov_b32 s42, 2424832
  buffer_load_dwordx4 v8, s[8:11], s42 offen nt lds
  s_add_u32 m0, s41, 45056
  s_mov_b32 s42, 2424832
  buffer_load_dwordx4 v9, s[8:11], s42 offen nt lds
  ds_read_b64_tr_b16 a[88:89], v6 offset:49152
  ds_read_b64_tr_b16 a[90:91], v6 offset:51200
  ds_read_b64_tr_b16 a[240:241], v6 offset:53248
  ds_read_b64_tr_b16 a[242:243], v6 offset:55296
  ds_read_b64_tr_b16 a[92:93], v6 offset:57344
  ds_read_b64_tr_b16 a[94:95], v6 offset:59392
  ds_read_b64_tr_b16 a[244:245], v6 offset:61440
  ds_read_b64_tr_b16 a[246:247], v6 offset:63488
  s_waitcnt vmcnt(24) lgkmcnt(0)
  s_barrier
  ds_read_b64_tr_b16 a[96:97], v7 offset:0
  ds_read_b64_tr_b16 a[98:99], v7 offset:2048
  ds_read_b64_tr_b16 a[248:249], v7 offset:4096
  ds_read_b64_tr_b16 a[250:251], v7 offset:6144
  ds_read_b64_tr_b16 a[100:101], v7 offset:8192
  ds_read_b64_tr_b16 a[102:103], v7 offset:10240
  ds_read_b64_tr_b16 a[252:253], v7 offset:12288
  ds_read_b64_tr_b16 a[254:255], v7 offset:14336
  s_waitcnt vmcnt(20) lgkmcnt(0)
  s_barrier
  ds_read_b64_tr_b16 a[104:105], v7 offset:16384
  ds_read_b64_tr_b16 a[106:107], v7 offset:18432
  ds_read_b64_tr_b16 v[128:129], v7 offset:20480
  ds_read_b64_tr_b16 v[130:131], v7 offset:22528
  ds_read_b64_tr_b16 a[108:109], v7 offset:24576
  ds_read_b64_tr_b16 a[110:111], v7 offset:26624
  ds_read_b64_tr_b16 v[132:133], v7 offset:28672
  ds_read_b64_tr_b16 v[134:135], v7 offset:30720
  s_waitcnt vmcnt(16) lgkmcnt(0)
  s_barrier
  ds_read_b64_tr_b16 a[112:113], v7 offset:32768
  ds_read_b64_tr_b16 a[114:115], v7 offset:34816
  ds_read_b64_tr_b16 v[136:137], v7 offset:36864
  ds_read_b64_tr_b16 v[138:139], v7 offset:38912
  ds_read_b64_tr_b16 a[116:117], v7 offset:40960
  ds_read_b64_tr_b16 a[118:119], v7 offset:43008
  ds_read_b64_tr_b16 v[140:141], v7 offset:45056
  ds_read_b64_tr_b16 v[142:143], v7 offset:47104
  s_waitcnt vmcnt(12) lgkmcnt(0)
  s_barrier
  ds_read_b64_tr_b16 a[120:121], v7 offset:49152
  ds_read_b64_tr_b16 a[122:123], v7 offset:51200
  ds_read_b64_tr_b16 v[144:145], v7 offset:53248
  ds_read_b64_tr_b16 v[146:147], v7 offset:55296
  ds_read_b64_tr_b16 a[124:125], v7 offset:57344
  ds_read_b64_tr_b16 a[126:127], v7 offset:59392
  ds_read_b64_tr_b16 v[148:149], v7 offset:61440
  ds_read_b64_tr_b16 v[150:151], v7 offset:63488
  s_waitcnt vmcnt(8) lgkmcnt(0)
  s_barrier
  ds_read_b64_tr_b16 a[128:129], v6 offset:0
  ds_read_b64_tr_b16 a[130:131], v6 offset:2048
  ds_read_b64_tr_b16 v[152:153], v6 offset:4096
  ds_read_b64_tr_b16 v[154:155], v6 offset:6144
  ds_read_b64_tr_b16 a[132:133], v6 offset:8192
  ds_read_b64_tr_b16 a[134:135], v6 offset:10240
  ds_read_b64_tr_b16 v[156:157], v6 offset:12288
  ds_read_b64_tr_b16 v[158:159], v6 offset:14336
  s_waitcnt vmcnt(4) lgkmcnt(0)
  s_barrier
  ds_read_b64_tr_b16 a[136:137], v6 offset:16384
  ds_read_b64_tr_b16 a[138:139], v6 offset:18432
  ds_read_b64_tr_b16 v[160:161], v6 offset:20480
  ds_read_b64_tr_b16 v[162:163], v6 offset:22528
  ds_read_b64_tr_b16 a[140:141], v6 offset:24576
  ds_read_b64_tr_b16 a[142:143], v6 offset:26624
  ds_read_b64_tr_b16 v[164:165], v6 offset:28672
  ds_read_b64_tr_b16 v[166:167], v6 offset:30720
  s_waitcnt vmcnt(0) lgkmcnt(0)
  s_barrier
  ds_read_b64_tr_b16 a[144:145], v6 offset:32768
  ds_read_b64_tr_b16 a[146:147], v6 offset:34816
  ds_read_b64_tr_b16 v[168:169], v6 offset:36864
  ds_read_b64_tr_b16 v[170:171], v6 offset:38912
  ds_read_b64_tr_b16 a[148:149], v6 offset:40960
  ds_read_b64_tr_b16 a[150:151], v6 offset:43008
  ds_read_b64_tr_b16 v[172:173], v6 offset:45056
  ds_read_b64_tr_b16 v[174:175], v6 offset:47104
  s_waitcnt lgkmcnt(0)
  s_barrier
  s_cmp_lt_u32 s21, 16
  s_cbranch_scc1 L_F2_keep
  v_accvgpr_write_b32 a0, 0
  v_accvgpr_write_b32 a1, 0
  v_accvgpr_write_b32 a2, 0
  v_accvgpr_write_b32 a3, 0
  v_accvgpr_write_b32 a4, 0
  v_accvgpr_write_b32 a5, 0
  v_accvgpr_write_b32 a6, 0
  v_accvgpr_write_b32 a7, 0
  v_accvgpr_write_b32 a152, 0
  v_accvgpr_write_b32 a153, 0
  v_accvgpr_write_b32 a154, 0
  v_accvgpr_write_b32 a155, 0
  v_accvgpr_write_b32 a156, 0
  v_accvgpr_write_b32 a157, 0
  v_accvgpr_write_b32 a158, 0
  v_accvgpr_write_b32 a159, 0
  s_nop 1
L_F2_keep:
  v_min_u32 v52, 63, v0
  v_lshlrev_b32 v52, 7, v52
  v_add_u32 v52, 1424384, v52
  s_nop 1
Lpoll_150:
  buffer_load_dword v53, v52, s[4:7], 0 offen sc1
  s_sub_u32 s24, s24, 1
  s_cbranch_scc1 L_FAIL
  s_waitcnt vmcnt(0)
  v_cmp_gt_i32 vcc, 0, v53
  s_cbranch_vccz Lpolld_151
  s_sleep 1
  s_branch Lpoll_150
Lpolld_151:
Ltab_149:
  v_lshrrev_b32 v53, 8, v53
  v_and_b32 v54, 3, v0
  v_lshl_or_b32 v53, v53, 2, v54
  s_nop 1
  v_min_u32_dpp v53, v53, v53 row_ror:8 row_mask:0xf bank_mask:0xf
  s_nop 1
  v_min_u32_dpp v53, v53, v53 row_ror:4 row_mask:0xf bank_mask:0xf
  v_mov_b32 v54, v53
  s_nop 1
  v_permlane16_swap_b32 v54, v53
  v_min_u32 v53, v53, v54
  v_mov_b32 v54, v53
  s_nop 1
  v_permlane32_swap_b32 v54, v53
  v_min_u32 v53, v53, v54
  s_nop 1
  v_min_u32_dpp v53, v53, v53 row_ror:2 row_mask:0xf bank_mask:0xf
  s_nop 1
  v_min_u32_dpp v53, v53, v53 row_ror:1 row_mask:0xf bank_mask:0xf
  s_nop 0
  v_readfirstlane_b32 s38, v53
  s_and_b32 s38, s38, 3
  s_lshl_b32 s38, s38, 13
  s_and_b32 s38, s38, 0x2000
  s_xor_b32 s38, s38, 20979712
  s_lshr_b32 s43, s21, 3
  s_mul_i32 s43, s43, 19
  s_min_u32 s43, s43, 37
  v_min_u32 v2, 18, v0
  v_add_u32 v2, s43, v2
  v_lshlrev_b32 v2, 7, v2
  v_add_u32 v2, 1414144, v2
  s_add_u32 s44, s43, s20
  s_min_u32 s45, s20, 2
  s_add_u32 s45, s45, s43
  s_lshr_b32 s40, s44, 1
  s_lshl_b32 s40, s40, 14
  s_and_b32 s41, s44, 1
  s_lshl_b32 s41, s41, 12
  s_add_u32 s27, s40, s41
  s_lshr_b32 s40, s45, 1
  s_lshl_b32 s40, s40, 14
  s_and_b32 s41, s45, 1
  s_lshl_b32 s41, s41, 12
  s_add_u32 s39, s40, s41
  s_sub_u32 s39, s39, s27
  s_add_u32 s27, s27, s38
  s_add_u32 s27, s27, 1179648
  s_lshl_b32 s62, s21, 7
  s_add_u32 s62, s62, 1421312
  s_lshl_b32 s40, s21, 14
  s_add_u32 s40, s40, s38
  s_add_u32 s31, s40, 524288
  s_lshl_b32 s40, s20, 11
  v_and_b32 v68, 3, v0
  v_lshlrev_b32 v68, 4, v68
  v_lshrrev_b32 v52, 4, v0
  v_lshl_add_u32 v68, v52, 6, v68
  v_bfe_u32 v52, v0, 2, 2
  v_lshl_add_u32 v68, v52, 8, v68
  v_add_u32 v68, s40, v68
  v_lshlrev_b32 v71, 2, v0
  v_add_u32 v71, 155648, v71
  s_mov_b32 s25, 0
  s_mov_b32 s26, 0
  s_mov_b32 s29, 1
  s_mov_b32 s30, 0
  s_mov_b32 s28, 0
  s_lshl_b32 s44, s20, 8
  s_add_u32 s44, s44, 155648
  s_cmp_eq_u32 s20, 0
  s_cselect_b32 s45, 0, 2147483392
  s_cselect_b32 s46, 1, -1
L_F2_top:
  s_cmp_eq_u32 s28, 1
  s_cbranch_scc1 L_F2_go
  s_cmp_eq_u32 s28, 2
  s_nop 0
  s_nop 0
  s_cbranch_scc1 L_F2_mid
  s_cmp_lg_u32 s20, 0
  s_cbranch_scc1 L_F2_park
  buffer_load_dword v3, v2, s[4:7], s30 offen sc1
  s_waitcnt vmcnt(1)
  s_barrier
  s_mov_b32 s63, s25
  s_atomic_smax s63, s[4:5], s62 glc
Lnosig_152:
  s_cmp_ge_u32 s25, 64
  s_cbranch_scc1 L_END
  s_nop 0
  s_waitcnt vmcnt(0)
  v_cmp_gt_i32_e64 vcc, s29, v3
  s_cbranch_vccz L_F2_issue
  s_nop 3
Lpoll_153:
  buffer_load_dword v3, v2, s[4:7], s30 offen sc1
  s_sub_u32 s24, s24, 1
  s_cbranch_scc1 L_FAIL
  s_waitcnt vmcnt(0)
  v_cmp_gt_i32 vcc, s29, v3
  s_cbranch_vccz Lpolld_154
  s_sleep 1
  s_branch Lpoll_153
Lpolld_154:
  s_branch L_F2_issue
L_F2_park:
  s_nop 0
  s_waitcnt vmcnt(0)
  s_barrier
  s_cmp_ge_u32 s25, 64
  s_cbranch_scc1 L_END
L_F2_issue:
  s_barrier
L_F2_mid:
  s_mov_b32 s34, s26
  s_mov_b32 s35, s27
  s_add_u32 s36, s32, 0
  s_add_u32 m0, s34, s36
  s_add_u32 s36, s35, 0
  buffer_load_dwordx4 v1, s[4:7], s36 offen offset:0 sc1 lds
  s_nop 0
  buffer_load_dwordx4 v1, s[4:7], s36 offen offset:1024 sc1 lds
  s_nop 0
  buffer_load_dwordx4 v1, s[4:7], s36 offen offset:2048 sc1 lds
  s_nop 0
  buffer_load_dwordx4 v1, s[4:7], s36 offen offset:3072 sc1 lds
  s_nop 0
  s_add_u32 s36, s32, 16384
  s_add_u32 m0, s34, s36
  s_add_u32 s36, s35, 32768
  buffer_load_dwordx4 v1, s[4:7], s36 offen offset:0 sc1 lds
  s_nop 0
  buffer_load_dwordx4 v1, s[4:7], s36 offen offset:1024 sc1 lds
  s_nop 0
  buffer_load_dwordx4 v1, s[4:7], s36 offen offset:2048 sc1 lds
  s_nop 0
  buffer_load_dwordx4 v1, s[4:7], s36 offen offset:3072 sc1 lds
  s_nop 0
  s_add_u32 s36, s32, 32768
  s_add_u32 m0, s34, s36
  s_add_u32 s36, s35, 65536
  buffer_load_dwordx4 v1, s[4:7], s36 offen offset:0 sc1 lds
  s_nop 0
  buffer_load_dwordx4 v1, s[4:7], s36 offen offset:1024 sc1 lds
  s_nop 0
  buffer_load_dwordx4 v1, s[4:7], s36 offen offset:2048 sc1 lds
  s_nop 0
  buffer_load_dwordx4 v1, s[4:7], s36 offen offset:3072 sc1 lds
  s_nop 0
  s_cmp_eq_u32 s28, 0
  s_nop 0
  s_nop 0
  s_cbranch_scc1 L_F2_go
  s_mov_b32 s28, 0
  s_waitcnt vmcnt(12)
  s_barrier
  s_cmp_lg_u32 s20, 0
  s_cbranch_scc1 Lnosig_155
  s_mov_b32 s63, s25
  s_atomic_smax s63, s[4:5], s62 glc
Lnosig_155:
L_F2_go:
  v_add_u32 v73, s26, v69
  v_add_u32 v74, s26, v70
  s_sub_u32 s26, 77824, s26
  s_add_u32 s27, s27, 2097152
  s_xor_b32 s27, s27, 0x2000
  s_add_u32 s29, s29, 1
  s_waitcnt vmcnt(8)
  s_barrier
  ds_read_b128 v[4:7], v73 offset:0
  ds_read_b128 v[8:11], v73 offset:1024
  ds_read_b128 v[12:15], v73 offset:2048
  ds_read_b128 v[16:19], v73 offset:3072
  ds_read_b128 v[20:23], v73 offset:4096
  ds_read_b128 v[24:27], v73 offset:5120
  s_waitcnt lgkmcnt(4)
  v_mfma_f32_16x16x32_bf16 v[36:39], a[0:3], v[4:7], 0
  ds_read_b128 v[28:31], v73 offset:6144
  v_mfma_f32_16x16x32_bf16 v[40:43], a[0:3], v[8:11], 0
  ds_read_b128 v[32:35], v73 offset:7168
  v_mfma_f32_16x16x32_bf16 v[44:47], a[152:155], v[4:7], 0
  s_add_u32 s36, s32, 49152
  s_add_u32 m0, s34, s36
  s_add_u32 s36, s35, 98304
  buffer_load_dwordx4 v1, s[4:7], s36 offen offset:0 sc1 lds
  v_mfma_f32_16x16x32_bf16 v[48:51], a[152:155], v[8:11], 0
  s_waitcnt lgkmcnt(4)
  v_mfma_f32_16x16x32_bf16 v[36:39], a[4:7], v[12:15], v[36:39]
  ds_read_b128 v[4:7], v73 offset:8192
  v_mfma_f32_16x16x32_bf16 v[40:43], a[4:7], v[16:19], v[40:43]
  ds_read_b128 v[8:11], v73 offset:9216
  v_mfma_f32_16x16x32_bf16 v[44:47], a[156:159], v[12:15], v[44:47]
  buffer_load_dwordx4 v1, s[4:7], s36 offen offset:1024 sc1 lds
  v_mfma_f32_16x16x32_bf16 v[48:51], a[156:159], v[16:19], v[48:51]
  s_waitcnt lgkmcnt(4)
  v_mfma_f32_16x16x32_bf16 v[36:39], a[8:11], v[20:23], v[36:39]
  ds_read_b128 v[12:15], v73 offset:10240
  v_mfma_f32_16x16x32_bf16 v[40:43], a[8:11], v[24:27], v[40:43]
  ds_read_b128 v[16:19], v73 offset:11264
  v_mfma_f32_16x16x32_bf16 v[44:47], a[160:163], v[20:23], v[44:47]
  buffer_load_dwordx4 v1, s[4:7], s36 offen offset:2048 sc1 lds
  v_mfma_f32_16x16x32_bf16 v[48:51], a[160:163], v[24:27], v[48:51]
  s_waitcnt lgkmcnt(4)
  v_mfma_f32_16x16x32_bf16 v[36:39], a[12:15], v[28:31], v[36:39]
  ds_read_b128 v[20:23], v73 offset:12288
  v_mfma_f32_16x16x32_bf16 v[40:43], a[12:15], v[32:35], v[40:43]
  ds_read_b128 v[24:27], v73 offset:13312
  v_mfma_f32_16x16x32_bf16 v[44:47], a[164:167], v[28:31], v[44:47]
  buffer_load_dwordx4 v1, s[4:7], s36 offen offset:3072 sc1 lds
  v_mfma_f32_16x16x32_bf16 v[48:51], a[164:167], v[32:35], v[48:51]
  s_waitcnt lgkmcnt(4)
  v_mfma_f32_16x16x32_bf16 v[36:39], a[16:19], v[4:7], v[36:39]
  ds_read_b128 v[28:31], v73 offset:14336
  v_mfma_f32_16x16x32_bf16 v[40:43], a[16:19], v[8:11], v[40:43]
  ds_read_b128 v[32:35], v73 offset:15360
  v_mfma_f32_16x16x32_bf16 v[44:47], a[168:171], v[4:7], v[44:47]
  s_add_u32 s36, s33, 65536
  s_add_u32 m0, s34, s36
  s_add_u32 s36, s35, 131072
  s_add_u32 s36, s36, s39
  buffer_load_dwordx4 v1, s[4:7], s36 offen offset:0 sc1 lds
  v_mfma_f32_16x16x32_bf16 v[48:51], a[168:171], v[8:11], v[48:51]
  s_waitcnt vmcnt(9)
  s_barrier
  s_waitcnt lgkmcnt(4)
  v_mfma_f32_16x16x32_bf16 v[36:39], a[20:23], v[12:15], v[36:39]
  ds_read_b128 v[4:7], v73 offset:16384
  v_mfma_f32_16x16x32_bf16 v[40:43], a[20:23], v[16:19], v[40:43]
  ds_read_b128 v[8:11], v73 offset:17408
  v_mfma_f32_16x16x32_bf16 v[44:47], a[172:175], v[12:15], v[44:47]
  buffer_load_dwordx4 v1, s[4:7], s36 offen offset:1024 sc1 lds
  v_mfma_f32_16x16x32_bf16 v[48:51], a[172:175], v[16:19], v[48:51]
  s_waitcnt lgkmcnt(4)
  v_mfma_f32_16x16x32_bf16 v[36:39], a[24:27], v[20:23], v[36:39]
  ds_read_b128 v[12:15], v73 offset:18432
  v_mfma_f32_16x16x32_bf16 v[40:43], a[24:27], v[24:27], v[40:43]
  ds_read_b128 v[16:19], v73 offset:19456
  v_mfma_f32_16x16x32_bf16 v[44:47], a[176:179], v[20:23], v[44:47]
  buffer_load_dwordx4 v1, s[4:7], s36 offen offset:2048 sc1 lds
  v_mfma_f32_16x16x32_bf16 v[48:51], a[176:179], v[24:27], v[48:51]
  s_waitcnt lgkmcnt(4)
  v_mfma_f32_16x16x32_bf16 v[36:39], a[28:31], v[28:31], v[36:39]
  ds_read_b128 v[20:23], v73 offset:20480
  v_mfma_f32_16x16x32_bf16 v[40:43], a[28:31], v[32:35], v[40:43]
  ds_read_b128 v[24:27], v73 offset:21504
  v_mfma_f32_16x16x32_bf16 v[44:47], a[180:183], v[28:31], v[44:47]
  buffer_load_dwordx4 v1, s[4:7], s36 offen offset:3072 sc1 lds
  v_mfma_f32_16x16x32_bf16 v[48:51], a[180:183], v[32:35], v[48:51]
  s_waitcnt lgkmcnt(4)
  v_mfma_f32_16x16x32_bf16 v[36:39], a[32:35], v[4:7], v[36:39]
  ds_read_b128 v[28:31], v73 offset:22528
  v_mfma_f32_16x16x32_bf16 v[40:43], a[32:35], v[8:11], v[40:43]
  ds_read_b128 v[32:35], v73 offset:23552
  v_mfma_f32_16x16x32_bf16 v[44:47], a[184:187], v[4:7], v[44:47]
  v_mfma_f32_16x16x32_bf16 v[48:51], a[184:187], v[8:11], v[48:51]
  s_waitcnt lgkmcnt(4)
  v_mfma_f32_16x16x32_bf16 v[36:39], a[36:39], v[12:15], v[36:39]
  ds_read_b128 v[4:7], v73 offset:24576
  v_mfma_f32_16x16x32_bf16 v[40:43], a[36:39], v[16:19], v[40:43]
  ds_read_b128 v[8:11], v73 offset:25600
  v_mfma_f32_16x16x32_bf16 v[44:47], a[188:191], v[12:15], v[44:47]
  v_mfma_f32_16x16x32_bf16 v[48:51], a[188:191], v[16:19], v[48:51]
  s_waitcnt lgkmcnt(4)
  v_mfma_f32_16x16x32_bf16 v[36:39], a[40:43], v[20:23], v[36:39]
  ds_read_b128 v[12:15], v73 offset:26624
  v_mfma_f32_16x16x32_bf16 v[40:43], a[40:43], v[24:27], v[40:43]
  ds_read_b128 v[16:19], v73 offset:27648
  v_mfma_f32_16x16x32_bf16 v[44:47], a[192:195], v[20:23], v[44:47]
  v_mfma_f32_16x16x32_bf16 v[48:51], a[192:195], v[24:27], v[48:51]
  s_waitcnt lgkmcnt(4)
  v_mfma_f32_16x16x32_bf16 v[36:39], a[44:47], v[28:31], v[36:39]
  ds_read_b128 v[20:23], v73 offset:28672
  v_mfma_f32_16x16x32_bf16 v[40:43], a[44:47], v[32:35], v[40:43]
  ds_read_b128 v[24:27], v73 offset:29696
  v_mfma_f32_16x16x32_bf16 v[44:47], a[196:199], v[28:31], v[44:47]
  s_mov_b32 s34, s26
  s_mov_b32 s35, s27
  v_mfma_f32_16x16x32_bf16 v[48:51], a[196:199], v[32:35], v[48:51]
  s_waitcnt lgkmcnt(4)
  v_mfma_f32_16x16x32_bf16 v[36:39], a[48:51], v[4:7], v[36:39]
  ds_read_b128 v[28:31], v73 offset:30720
  v_mfma_f32_16x16x32_bf16 v[40:43], a[48:51], v[8:11], v[40:43]
  ds_read_b128 v[32:35], v73 offset:31744
  v_mfma_f32_16x16x32_bf16 v[44:47], a[200:203], v[4:7], v[44:47]
  s_add_u32 m0, s44, 0
  s_add_u32 s40, s30, s45
  v_mfma_f32_16x16x32_bf16 v[48:51], a[200:203], v[8:11], v[48:51]
  buffer_load_dword v2, s[4:7], s40 offen sc1 lds
  s_nop 0
  s_waitcnt vmcnt(9)
  s_barrier
  s_cmp_eq_u32 s46, s28
  s_cbranch_scc1 L_F2_rep
L_F2_s2:
  s_waitcnt lgkmcnt(4)
  v_mfma_f32_16x16x32_bf16 v[36:39], a[52:55], v[12:15], v[36:39]
  ds_read_b128 v[4:7], v73 offset:32768
  v_mfma_f32_16x16x32_bf16 v[40:43], a[52:55], v[16:19], v[40:43]
  ds_read_b128 v[8:11], v73 offset:33792
  v_mfma_f32_16x16x32_bf16 v[44:47], a[204:207], v[12:15], v[44:47]
  v_mfma_f32_16x16x32_bf16 v[48:51], a[204:207], v[16:19], v[48:51]
  s_waitcnt lgkmcnt(4)
  v_mfma_f32_16x16x32_bf16 v[36:39], a[56:59], v[20:23], v[36:39]
  ds_read_b128 v[12:15], v73 offset:34816
  v_mfma_f32_16x16x32_bf16 v[40:43], a[56:59], v[24:27], v[40:43]
  ds_read_b128 v[16:19], v73 offset:35840
  v_mfma_f32_16x16x32_bf16 v[44:47], a[208:211], v[20:23], v[44:47]
  v_mfma_f32_16x16x32_bf16 v[48:51], a[208:211], v[24:27], v[48:51]
  s_waitcnt lgkmcnt(4)
  v_mfma_f32_16x16x32_bf16 v[36:39], a[60:63], v[28:31], v[36:39]
  ds_read_b128 v[20:23], v73 offset:36864
  v_mfma_f32_16x16x32_bf16 v[40:43], a[60:63], v[32:35], v[40:43]
  ds_read_b128 v[24:27], v73 offset:37888
  v_mfma_f32_16x16x32_bf16 v[44:47], a[212:215], v[28:31], v[44:47]
  v_mfma_f32_16x16x32_bf16 v[48:51], a[212:215], v[32:35], v[48:51]
  s_waitcnt lgkmcnt(4)
  v_mfma_f32_16x16x32_bf16 v[36:39], a[64:67], v[4:7], v[36:39]
  ds_read_b128 v[28:31], v73 offset:38912
  v_mfma_f32_16x16x32_bf16 v[40:43], a[64:67], v[8:11], v[40:43]
  ds_read_b128 v[32:35], v73 offset:39936
  v_mfma_f32_16x16x32_bf16 v[44:47], a[216:219], v[4:7], v[44:47]
  v_mfma_f32_16x16x32_bf16 v[48:51], a[216:219], v[8:11], v[48:51]
  s_waitcnt lgkmcnt(4)
  v_mfma_f32_16x16x32_bf16 v[36:39], a[68:71], v[12:15], v[36:39]
  ds_read_b128 v[4:7], v73 offset:40960
  v_mfma_f32_16x16x32_bf16 v[40:43], a[68:71], v[16:19], v[40:43]
  ds_read_b128 v[8:11], v73 offset:41984
  v_mfma_f32_16x16x32_bf16 v[44:47], a[220:223], v[12:15], v[44:47]
  v_mfma_f32_16x16x32_bf16 v[48:51], a[220:223], v[16:19], v[48:51]
  s_waitcnt lgkmcnt(4)
  v_mfma_f32_16x16x32_bf16 v[36:39], a[72:75], v[20:23], v[36:39]
  ds_read_b128 v[12:15], v73 offset:43008
  v_mfma_f32_16x16x32_bf16 v[40:43], a[72:75], v[24:27], v[40:43]
  ds_read_b128 v[16:19], v73 offset:44032
  v_mfma_f32_16x16x32_bf16 v[44:47], a[224:227], v[20:23], v[44:47]
  v_mfma_f32_16x16x32_bf16 v[48:51], a[224:227], v[24:27], v[48:51]
  s_waitcnt vmcnt(0)
  s_barrier
  ds_read_b32 v3, v71
  s_waitcnt lgkmcnt(4)
  v_mfma_f32_16x16x32_bf16 v[36:39], a[76:79], v[28:31], v[36:39]
  ds_read_b128 v[20:23], v73 offset:45056
  v_mfma_f32_16x16x32_bf16 v[40:43], a[76:79], v[32:35], v[40:43]
  ds_read_b128 v[24:27], v73 offset:46080
  v_mfma_f32_16x16x32_bf16 v[44:47], a[228:231], v[28:31], v[44:47]
  v_mfma_f32_16x16x32_bf16 v[48:51], a[228:231], v[32:35], v[48:51]
  s_waitcnt lgkmcnt(4)
  v_mfma_f32_16x16x32_bf16 v[36:39], a[80:83], v[4:7], v[36:39]
  ds_read_b128 v[28:31], v73 offset:47104
  v_mfma_f32_16x16x32_bf16 v[40:43], a[80:83], v[8:11], v[40:43]
  ds_read_b128 v[32:35], v73 offset:48128
  v_mfma_f32_16x16x32_bf16 v[44:47], a[232:235], v[4:7], v[44:47]
  v_mfma_f32_16x16x32_bf16 v[48:51], a[232:235], v[8:11], v[48:51]
  s_waitcnt lgkmcnt(4)
  v_cmp_gt_i32 vcc, s29, v3
  s_mov_b32 s28, 0
  s_cbranch_vccnz L_F2_nopf
  s_cmp_ge_u32 s25, 63
  s_cbranch_scc1 L_F2_nopf
  s_mov_b32 s28, 1
  s_waitcnt lgkmcnt(4)
  v_mfma_f32_16x16x32_bf16 v[36:39], a[84:87], v[12:15], v[36:39]
  ds_read_b128 v[4:7], v73 offset:49152
  v_mfma_f32_16x16x32_bf16 v[40:43], a[84:87], v[16:19], v[40:43]
  ds_read_b128 v[8:11], v73 offset:50176
  v_mfma_f32_16x16x32_bf16 v[44:47], a[236:239], v[12:15], v[44:47]
  s_add_u32 s36, s32, 0
  s_add_u32 m0, s34, s36
  s_add_u32 s36, s35, 0
  buffer_load_dwordx4 v1, s[4:7], s36 offen offset:0 sc1 lds
  v_mfma_f32_16x16x32_bf16 v[48:51], a[236:239], v[16:19], v[48:51]
  s_waitcnt lgkmcnt(4)
  v_mfma_f32_16x16x32_bf16 v[36:39], a[88:91], v[20:23], v[36:39]
  ds_read_b128 v[12:15], v73 offset:51200
  v_mfma_f32_16x16x32_bf16 v[40:43], a[88:91], v[24:27], v[40:43]
  ds_read_b128 v[16:19], v73 offset:52224
  v_mfma_f32_16x16x32_bf16 v[44:47], a[240:243], v[20:23], v[44:47]
  buffer_load_dwordx4 v1, s[4:7], s36 offen offset:1024 sc1 lds
  v_mfma_f32_16x16x32_bf16 v[48:51], a[240:243], v[24:27], v[48:51]
  s_waitcnt lgkmcnt(4)
  v_mfma_f32_16x16x32_bf16 v[36:39], a[92:95], v[28:31], v[36:39]
  ds_read_b128 v[20:23], v73 offset:53248
  v_mfma_f32_16x16x32_bf16 v[40:43], a[92:95], v[32:35], v[40:43]
  ds_read_b128 v[24:27], v73 offset:54272
  v_mfma_f32_16x16x32_bf16 v[44:47], a[244:247], v[28:31], v[44:47]
  buffer_load_dwordx4 v1, s[4:7], s36 offen offset:2048 sc1 lds
  v_mfma_f32_16x16x32_bf16 v[48:51], a[244:247], v[32:35], v[48:51]
  s_waitcnt lgkmcnt(4)
  v_mfma_f32_16x16x32_bf16 v[36:39], a[96:99], v[4:7], v[36:39]
  ds_read_b128 v[28:31], v73 offset:55296
  v_mfma_f32_16x16x32_bf16 v[40:43], a[96:99], v[8:11], v[40:43]
  ds_read_b128 v[32:35], v73 offset:56320
  v_mfma_f32_16x16x32_bf16 v[44:47], a[248:251], v[4:7], v[44:47]
  buffer_load_dwordx4 v1, s[4:7], s36 offen offset:3072 sc1 lds
  v_mfma_f32_16x16x32_bf16 v[48:51], a[248:251], v[8:11], v[48:51]
  s_waitcnt lgkmcnt(4)
  v_mfma_f32_16x16x32_bf16 v[36:39], a[100:103], v[12:15], v[36:39]
  ds_read_b128 v[4:7], v73 offset:57344
  v_mfma_f32_16x16x32_bf16 v[40:43], a[100:103], v[16:19], v[40:43]
  ds_read_b128 v[8:11], v73 offset:58368
  v_mfma_f32_16x16x32_bf16 v[44:47], a[252:255], v[12:15], v[44:47]
  s_add_u32 s36, s32, 16384
  s_add_u32 m0, s34, s36
  s_add_u32 s36, s35, 32768
  buffer_load_dwordx4 v1, s[4:7], s36 offen offset:0 sc1 lds
  v_mfma_f32_16x16x32_bf16 v[48:51], a[252:255], v[16:19], v[48:51]
  s_waitcnt lgkmcnt(4)
  v_mfma_f32_16x16x32_bf16 v[36:39], a[104:107], v[20:23], v[36:39]
  ds_read_b128 v[12:15], v73 offset:59392
  v_mfma_f32_16x16x32_bf16 v[40:43], a[104:107], v[24:27], v[40:43]
  ds_read_b128 v[16:19], v73 offset:60416
  v_mfma_f32_16x16x32_bf16 v[44:47], v[128:131], v[20:23], v[44:47]
  buffer_load_dwordx4 v1, s[4:7], s36 offen offset:1024 sc1 lds
  v_mfma_f32_16x16x32_bf16 v[48:51], v[128:131], v[24:27], v[48:51]
  s_waitcnt lgkmcnt(4)
  v_mfma_f32_16x16x32_bf16 v[36:39], a[108:111], v[28:31], v[36:39]
  ds_read_b128 v[20:23], v73 offset:61440
  v_mfma_f32_16x16x32_bf16 v[40:43], a[108:111], v[32:35], v[40:43]
  ds_read_b128 v[24:27], v73 offset:62464
  v_mfma_f32_16x16x32_bf16 v[44:47], v[132:135], v[28:31], v[44:47]
  buffer_load_dwordx4 v1, s[4:7], s36 offen offset:2048 sc1 lds
  v_mfma_f32_16x16x32_bf16 v[48:51], v[132:135], v[32:35], v[48:51]
  s_waitcnt lgkmcnt(4)
  v_mfma_f32_16x16x32_bf16 v[36:39], a[112:115], v[4:7], v[36:39]
  ds_read_b128 v[28:31], v73 offset:63488
  v_mfma_f32_16x16x32_bf16 v[40:43], a[112:115], v[8:11], v[40:43]
  ds_read_b128 v[32:35], v73 offset:64512
  v_mfma_f32_16x16x32_bf16 v[44:47], v[136:139], v[4:7], v[44:47]
  buffer_load_dwordx4 v1, s[4:7], s36 offen offset:3072 sc1 lds
  v_mfma_f32_16x16x32_bf16 v[48:51], v[136:139], v[8:11], v[48:51]
  s_waitcnt lgkmcnt(4)
  v_mfma_f32_16x16x32_bf16 v[36:39], a[116:119], v[12:15], v[36:39]
  ds_read_b128 v[4:7], v74 offset:0
  v_mfma_f32_16x16x32_bf16 v[40:43], a[116:119], v[16:19], v[40:43]
  ds_read_b128 v[8:11], v74 offset:1024
  v_mfma_f32_16x16x32_bf16 v[44:47], v[140:143], v[12:15], v[44:47]
  s_add_u32 s36, s32, 32768
  s_add_u32 m0, s34, s36
  s_add_u32 s36, s35, 65536
  buffer_load_dwordx4 v1, s[4:7], s36 offen offset:0 sc1 lds
  v_mfma_f32_16x16x32_bf16 v[48:51], v[140:143], v[16:19], v[48:51]
  s_waitcnt lgkmcnt(4)
  v_mfma_f32_16x16x32_bf16 v[36:39], a[120:123], v[20:23], v[36:39]
  ds_read_b128 v[12:15], v74 offset:2048
  v_mfma_f32_16x16x32_bf16 v[40:43], a[120:123], v[24:27], v[40:43]
  ds_read_b128 v[16:19], v74 offset:3072
  v_mfma_f32_16x16x32_bf16 v[44:47], v[144:147], v[20:23], v[44:47]
  buffer_load_dwordx4 v1, s[4:7], s36 offen offset:1024 sc1 lds
  v_mfma_f32_16x16x32_bf16 v[48:51], v[144:147], v[24:27], v[48:51]
  s_waitcnt lgkmcnt(4)
  v_mfma_f32_16x16x32_bf16 v[36:39], a[124:127], v[28:31], v[36:39]
  ds_read_b128 v[20:23], v74 offset:4096
  v_mfma_f32_16x16x32_bf16 v[40:43], a[124:127], v[32:35], v[40:43]
  ds_read_b128 v[24:27], v74 offset:5120
  v_mfma_f32_16x16x32_bf16 v[44:47], v[148:151], v[28:31], v[44:47]
  buffer_load_dwordx4 v1, s[4:7], s36 offen offset:2048 sc1 lds
  v_mfma_f32_16x16x32_bf16 v[48:51], v[148:151], v[32:35], v[48:51]
  s_waitcnt lgkmcnt(4)
  v_mfma_f32_16x16x32_bf16 v[36:39], a[128:131], v[4:7], v[36:39]
  ds_read_b128 v[28:31], v74 offset:6144
  v_mfma_f32_16x16x32_bf16 v[40:43], a[128:131], v[8:11], v[40:43]
  ds_read_b128 v[32:35], v74 offset:7168
  v_mfma_f32_16x16x32_bf16 v[44:47], v[152:155], v[4:7], v[44:47]
  buffer_load_dwordx4 v1, s[4:7], s36 offen offset:3072 sc1 lds
  v_mfma_f32_16x16x32_bf16 v[48:51], v[152:155], v[8:11], v[48:51]
  s_waitcnt lgkmcnt(4)
  v_mfma_f32_16x16x32_bf16 v[36:39], a[132:135], v[12:15], v[36:39]
  ds_read_b128 v[4:7], v74 offset:8192
  v_mfma_f32_16x16x32_bf16 v[40:43], a[132:135], v[16:19], v[40:43]
  ds_read_b128 v[8:11], v74 offset:9216
  v_mfma_f32_16x16x32_bf16 v[44:47], v[156:159], v[12:15], v[44:47]
  v_mfma_f32_16x16x32_bf16 v[48:51], v[156:159], v[16:19], v[48:51]
  s_waitcnt lgkmcnt(4)
  v_mfma_f32_16x16x32_bf16 v[36:39], a[136:139], v[20:23], v[36:39]
  ds_read_b128 v[12:15], v74 offset:10240
  v_mfma_f32_16x16x32_bf16 v[40:43], a[136:139], v[24:27], v[40:43]
  ds_read_b128 v[16:19], v74 offset:11264
  v_mfma_f32_16x16x32_bf16 v[44:47], v[160:163], v[20:23], v[44:47]
  v_mfma_f32_16x16x32_bf16 v[48:51], v[160:163], v[24:27], v[48:51]
  s_waitcnt lgkmcnt(4)
  v_mfma_f32_16x16x32_bf16 v[36:39], a[140:143], v[28:31], v[36:39]
  v_mfma_f32_16x16x32_bf16 v[40:43], a[140:143], v[32:35], v[40:43]
  v_mfma_f32_16x16x32_bf16 v[44:47], v[164:167], v[28:31], v[44:47]
  v_mfma_f32_16x16x32_bf16 v[48:51], v[164:167], v[32:35], v[48:51]
  s_waitcnt lgkmcnt(2)
  v_mfma_f32_16x16x32_bf16 v[36:39], a[144:147], v[4:7], v[36:39]
  v_mfma_f32_16x16x32_bf16 v[40:43], a[144:147], v[8:11], v[40:43]
  v_mfma_f32_16x16x32_bf16 v[44:47], v[168:171], v[4:7], v[44:47]
  v_mfma_f32_16x16x32_bf16 v[48:51], v[168:171], v[8:11], v[48:51]
  s_waitcnt lgkmcnt(0)
  v_mfma_f32_16x16x32_bf16 v[36:39], a[148:151], v[12:15], v[36:39]
  v_mfma_f32_16x16x32_bf16 v[40:43], a[148:151], v[16:19], v[40:43]
  v_mfma_f32_16x16x32_bf16 v[44:47], v[172:175], v[12:15], v[44:47]
  v_mfma_f32_16x16x32_bf16 v[48:51], v[172:175], v[16:19], v[48:51]
  s_nop 7
  s_branch L_F2_epi
L_F2_nopf:
  s_waitcnt lgkmcnt(4)
  v_mfma_f32_16x16x32_bf16 v[36:39], a[84:87], v[12:15], v[36:39]
  ds_read_b128 v[4:7], v73 offset:49152
  v_mfma_f32_16x16x32_bf16 v[40:43], a[84:87], v[16:19], v[40:43]
  ds_read_b128 v[8:11], v73 offset:50176
  v_mfma_f32_16x16x32_bf16 v[44:47], a[236:239], v[12:15], v[44:47]
  v_mfma_f32_16x16x32_bf16 v[48:51], a[236:239], v[16:19], v[48:51]
  s_waitcnt lgkmcnt(4)
  v_mfma_f32_16x16x32_bf16 v[36:39], a[88:91], v[20:23], v[36:39]
  ds_read_b128 v[12:15], v73 offset:51200
  v_mfma_f32_16x16x32_bf16 v[40:43], a[88:91], v[24:27], v[40:43]
  ds_read_b128 v[16:19], v73 offset:52224
  v_mfma_f32_16x16x32_bf16 v[44:47], a[240:243], v[20:23], v[44:47]
  v_mfma_f32_16x16x32_bf16 v[48:51], a[240:243], v[24:27], v[48:51]
  s_waitcnt lgkmcnt(4)
  v_mfma_f32_16x16x32_bf16 v[36:39], a[92:95], v[28:31], v[36:39]
  ds_read_b128 v[20:23], v73 offset:53248
  v_mfma_f32_16x16x32_bf16 v[40:43], a[92:95], v[32:35], v[40:43]
  ds_read_b128 v[24:27], v73 offset:54272
  v_mfma_f32_16x16x32_bf16 v[44:47], a[244:247], v[28:31], v[44:47]
  v_mfma_f32_16x16x32_bf16 v[48:51], a[244:247], v[32:35], v[48:51]
  s_waitcnt lgkmcnt(4)
  v_mfma_f32_16x16x32_bf16 v[36:39], a[96:99], v[4:7], v[36:39]
  ds_read_b128 v[28:31], v73 offset:55296
  v_mfma_f32_16x16x32_bf16 v[40:43], a[96:99], v[8:11], v[40:43]
  ds_read_b128 v[32:35], v73 offset:56320
  v_mfma_f32_16x16x32_bf16 v[44:47], a[248:251], v[4:7], v[44:47]
  v_mfma_f32_16x16x32_bf16 v[48:51], a[248:251], v[8:11], v[48:51]
  s_waitcnt lgkmcnt(4)
  v_mfma_f32_16x16x32_bf16 v[36:39], a[100:103], v[12:15], v[36:39]
  ds_read_b128 v[4:7], v73 offset:57344
  v_mfma_f32_16x16x32_bf16 v[40:43], a[100:103], v[16:19], v[40:43]
  ds_read_b128 v[8:11], v73 offset:58368
  v_mfma_f32_16x16x32_bf16 v[44:47], a[252:255], v[12:15], v[44:47]
  v_mfma_f32_16x16x32_bf16 v[48:51], a[252:255], v[16:19], v[48:51]
  s_waitcnt lgkmcnt(4)
  v_mfma_f32_16x16x32_bf16 v[36:39], a[104:107], v[20:23], v[36:39]
  ds_read_b128 v[12:15], v73 offset:59392
  v_mfma_f32_16x16x32_bf16 v[40:43], a[104:107], v[24:27], v[40:43]
  ds_read_b128 v[16:19], v73 offset:60416
  v_mfma_f32_16x16x32_bf16 v[44:47], v[128:131], v[20:23], v[44:47]
  v_mfma_f32_16x16x32_bf16 v[48:51], v[128:131], v[24:27], v[48:51]
  s_waitcnt lgkmcnt(4)
  v_mfma_f32_16x16x32_bf16 v[36:39], a[108:111], v[28:31], v[36:39]
  ds_read_b128 v[20:23], v73 offset:61440
  v_mfma_f32_16x16x32_bf16 v[40:43], a[108:111], v[32:35], v[40:43]
  ds_read_b128 v[24:27], v73 offset:62464
  v_mfma_f32_16x16x32_bf16 v[44:47], v[132:135], v[28:31], v[44:47]
  v_mfma_f32_16x16x32_bf16 v[48:51], v[132:135], v[32:35], v[48:51]
  s_waitcnt lgkmcnt(4)
  v_mfma_f32_16x16x32_bf16 v[36:39], a[112:115], v[4:7], v[36:39]
  ds_read_b128 v[28:31], v73 offset:63488
  v_mfma_f32_16x16x32_bf16 v[40:43], a[112:115], v[8:11], v[40:43]
  ds_read_b128 v[32:35], v73 offset:64512
  v_mfma_f32_16x16x32_bf16 v[44:47], v[136:139], v[4:7], v[44:47]
  v_mfma_f32_16x16x32_bf16 v[48:51], v[136:139], v[8:11], v[48:51]
  s_waitcnt lgkmcnt(4)
  v_mfma_f32_16x16x32_bf16 v[36:39], a[116:119], v[12:15], v[36:39]
  ds_read_b128 v[4:7], v74 offset:0
  v_mfma_f32_16x16x32_bf16 v[40:43], a[116:119], v[16:19], v[40:43]
  ds_read_b128 v[8:11], v74 offset:1024
  v_mfma_f32_16x16x32_bf16 v[44:47], v[140:143], v[12:15], v[44:47]
  v_mfma_f32_16x16x32_bf16 v[48:51], v[140:143], v[16:19], v[48:51]
  s_waitcnt lgkmcnt(4)
  v_mfma_f32_16x16x32_bf16 v[36:39], a[120:123], v[20:23], v[36:39]
  ds_read_b128 v[12:15], v74 offset:2048
  v_mfma_f32_16x16x32_bf16 v[40:43], a[120:123], v[24:27], v[40:43]
  ds_read_b128 v[16:19], v74 offset:3072
  v_mfma_f32_16x16x32_bf16 v[44:47], v[144:147], v[20:23], v[44:47]
  s_add_u32 m0, s44, 1024
  s_add_u32 s40, s30, s45
  v_mfma_f32_16x16x32_bf16 v[48:51], v[144:147], v[24:27], v[48:51]
  buffer_load_dword v2, s[4:7], s40 offen sc1 lds
  s_waitcnt lgkmcnt(4)
  v_mfma_f32_16x16x32_bf16 v[36:39], a[124:127], v[28:31], v[36:39]
  ds_read_b128 v[20:23], v74 offset:4096
  v_mfma_f32_16x16x32_bf16 v[40:43], a[124:127], v[32:35], v[40:43]
  ds_read_b128 v[24:27], v74 offset:5120
  v_mfma_f32_16x16x32_bf16 v[44:47], v[148:151], v[28:31], v[44:47]
  v_mfma_f32_16x16x32_bf16 v[48:51], v[148:151], v[32:35], v[48:51]
  s_waitcnt lgkmcnt(4)
  v_mfma_f32_16x16x32_bf16 v[36:39], a[128:131], v[4:7], v[36:39]
  ds_read_b128 v[28:31], v74 offset:6144
  v_mfma_f32_16x16x32_bf16 v[40:43], a[128:131], v[8:11], v[40:43]
  ds_read_b128 v[32:35], v74 offset:7168
  v_mfma_f32_16x16x32_bf16 v[44:47], v[152:155], v[4:7], v[44:47]
  v_mfma_f32_16x16x32_bf16 v[48:51], v[152:155], v[8:11], v[48:51]
  s_waitcnt lgkmcnt(4)
  v_mfma_f32_16x16x32_bf16 v[36:39], a[132:135], v[12:15], v[36:39]
  ds_read_b128 v[4:7], v74 offset:8192
  v_mfma_f32_16x16x32_bf16 v[40:43], a[132:135], v[16:19], v[40:43]
  ds_read_b128 v[8:11], v74 offset:9216
  v_mfma_f32_16x16x32_bf16 v[44:47], v[156:159], v[12:15], v[44:47]
  v_mfma_f32_16x16x32_bf16 v[48:51], v[156:159], v[16:19], v[48:51]
  s_waitcnt lgkmcnt(4)
  v_mfma_f32_16x16x32_bf16 v[36:39], a[136:139], v[20:23], v[36:39]
  ds_read_b128 v[12:15], v74 offset:10240
  v_mfma_f32_16x16x32_bf16 v[40:43], a[136:139], v[24:27], v[40:43]
  ds_read_b128 v[16:19], v74 offset:11264
  v_mfma_f32_16x16x32_bf16 v[44:47], v[160:163], v[20:23], v[44:47]
  v_mfma_f32_16x16x32_bf16 v[48:51], v[160:163], v[24:27], v[48:51]
  s_waitcnt lgkmcnt(4)
  v_mfma_f32_16x16x32_bf16 v[36:39], a[140:143], v[28:31], v[36:39]
  v_mfma_f32_16x16x32_bf16 v[40:43], a[140:143], v[32:35], v[40:43]
  v_mfma_f32_16x16x32_bf16 v[44:47], v[164:167], v[28:31], v[44:47]
  v_mfma_f32_16x16x32_bf16 v[48:51], v[164:167], v[32:35], v[48:51]
  s_waitcnt vmcnt(0)
  s_barrier
  ds_read_b32 v3, v71 offset:1024
  s_waitcnt lgkmcnt(2)
  v_mfma_f32_16x16x32_bf16 v[36:39], a[144:147], v[4:7], v[36:39]
  v_mfma_f32_16x16x32_bf16 v[40:43], a[144:147], v[8:11], v[40:43]
  v_mfma_f32_16x16x32_bf16 v[44:47], v[168:171], v[4:7], v[44:47]
  v_mfma_f32_16x16x32_bf16 v[48:51], v[168:171], v[8:11], v[48:51]
  s_waitcnt lgkmcnt(0)
  v_mfma_f32_16x16x32_bf16 v[36:39], a[148:151], v[12:15], v[36:39]
  v_mfma_f32_16x16x32_bf16 v[40:43], a[148:151], v[16:19], v[40:43]
  v_mfma_f32_16x16x32_bf16 v[44:47], v[172:175], v[12:15], v[44:47]
  v_mfma_f32_16x16x32_bf16 v[48:51], v[172:175], v[16:19], v[48:51]
  v_cmp_gt_i32 vcc, s29, v3
  s_cmp_eq_u64 vcc, 0
  s_cselect_b32 s28, 2, 0
  s_cmp_lt_u32 s25, 63
  s_cselect_b32 s28, s28, 0
L_F2_epi:
  v_cvt_pk_bf16_f32 v52, v36, v37
  v_cvt_pk_bf16_f32 v53, v38, v39
  v_cvt_pk_bf16_f32 v54, v44, v45
  v_cvt_pk_bf16_f32 v55, v46, v47
  buffer_store_dwordx4 v[52:55], v68, s[4:7], s31 offen offset:0 sc1
  v_cvt_pk_bf16_f32 v56, v40, v41
  v_cvt_pk_bf16_f32 v57, v42, v43
  v_cvt_pk_bf16_f32 v58, v48, v49
  v_cvt_pk_bf16_f32 v59, v50, v51
  buffer_store_dwordx4 v[56:59], v68, s[4:7], s31 offen offset:1024 sc1
  s_add_u32 s25, s25, 1
  s_add_u32 s31, s31, 2097152
  s_xor_b32 s31, s31, 0x2000
  s_branch L_F2_top
L_F2_rep:
  s_mov_b32 s63, s25
  s_atomic_smax s63, s[4:5], s62 glc
Lnosig_156:
  s_branch L_F2_s2
L_WOF:
  s_load_dwordx2 s[8:9], s[0:1], 40
  s_mov_b32 s10, 8388608
  s_mov_b32 s11, 0x20000
  s_waitcnt lgkmcnt(0)
  v_bfe_u32 v1, v0, 5, 1
  v_mul_u32_u24 v1, 131072, v1
  v_bfe_u32 v2, v0, 4, 1
  v_mul_u32_u24 v2, 8192, v2
  v_add_u32 v1, v1, v2
  v_bfe_u32 v2, v0, 3, 1
  v_mul_u32_u24 v2, 2048, v2
  v_add_u32 v1, v1, v2
  v_lshrrev_b32 v2, 3, v0
  v_and_b32 v2, 6, v2
  v_xor_b32 v2, v2, v0
  v_and_b32 v2, 7, v2
  v_lshl_add_u32 v1, v2, 4, v1
  v_bfe_u32 v2, v0, 3, 2
  v_xor_b32 v2, 0, v2
  v_lshlrev_b32 v2, 5, v2
  v_lshrrev_b32 v4, 2, v0
  v_lshl_add_u32 v4, v4, 7, v2
  v_and_b32 v2, 3, v0
  v_lshl_add_u32 v4, v2, 3, v4
  s_and_b32 s43, s21, 3
  s_lshl_b32 s43, s43, 2
  s_add_u32 s43, s43, s20
  s_lshr_b32 s44, s21, 2
  s_lshl_b32 s40, s43, 19
  s_lshl_b32 s41, s44, 7
  s_add_u32 s40, s40, s41
  v_add_u32 v1, s40, v1
  s_lshl_b32 s41, s20, 15
  v_add_u32 v4, s41, v4
  s_lshl_b32 s40, s44, 19
  s_lshl_b32 s45, s43, 14
  s_add_u32 s40, s40, s45
  v_lshl_add_u32 v3, v0, 4, s40
  v_xor_b32 v5, 32, v4
  v_xor_b32 v6, 64, v4
  v_xor_b32 v7, 96, v4
  s_add_u32 m0, s41, 0
  s_mov_b32 s42, 0
  buffer_load_dwordx4 v1, s[8:11], s42 offen nt lds
  s_add_u32 m0, s41, 1024
  s_mov_b32 s42, 16384
  buffer_load_dwordx4 v1, s[8:11], s42 offen nt lds
  s_add_u32 m0, s41, 2048
  s_mov_b32 s42, 4096
  buffer_load_dwordx4 v1, s[8:11], s42 offen nt lds
  s_add_u32 m0, s41, 3072
  s_mov_b32 s42, 20480
  buffer_load_dwordx4 v1, s[8:11], s42 offen nt lds
  s_add_u32 m0, s41, 4096
  s_mov_b32 s42, 32768
  buffer_load_dwordx4 v1, s[8:11], s42 offen nt lds
  s_add_u32 m0, s41, 5120
  s_mov_b32 s42, 49152
  buffer_load_dwordx4 v1, s[8:11], s42 offen nt lds
  s_add_u32 m0, s41, 6144
  s_mov_b32 s42, 36864
  buffer_load_dwordx4 v1, s[8:11], s42 offen nt lds
  s_add_u32 m0, s41, 7168
  s_mov_b32 s42, 53248
  buffer_load_dwordx4 v1, s[8:11], s42 offen nt lds
  s_add_u32 m0, s41, 8192
  s_mov_b32 s42, 65536
  buffer_load_dwordx4 v1, s[8:11], s42 offen nt lds
  s_add_u32 m0, s41, 9216
  s_mov_b32 s42, 81920
  buffer_load_dwordx4 v1, s[8:11], s42 offen nt lds
  s_add_u32 m0, s41, 10240
  s_mov_b32 s42, 69632
  buffer_load_dwordx4 v1, s[8:11], s42 offen nt lds
  s_add_u32 m0, s41, 11264
  s_mov_b32 s42, 86016
  buffer_load_dwordx4 v1, s[8:11], s42 offen nt lds
  s_add_u32 m0, s41, 12288
  s_mov_b32 s42, 98304
  buffer_load_dwordx4 v1, s[8:11], s42 offen nt lds
  s_add_u32 m0, s41, 13312
  s_mov_b32 s42, 114688
  buffer_load_dwordx4 v1, s[8:11], s42 offen nt lds
  s_add_u32 m0, s41, 14336
  s_mov_b32 s42, 102400
  buffer_load_dwordx4 v1, s[8:11], s42 offen nt lds
  s_add_u32 m0, s41, 15360
  s_mov_b32 s42, 118784
  buffer_load_dwordx4 v1, s[8:11], s42 offen nt lds
  s_add_u32 m0, s41, 16384
  s_mov_b32 s42, 262144
  buffer_load_dwordx4 v1, s[8:11], s42 offen nt lds
  s_add_u32 m0, s41, 17408
  s_mov_b32 s42, 278528
  buffer_load_dwordx4 v1, s[8:11], s42 offen nt lds
  s_add_u32 m0, s41, 18432
  s_mov_b32 s42, 266240
  buffer_load_dwordx4 v1, s[8:11], s42 offen nt lds
  s_add_u32 m0, s41, 19456
  s_mov_b32 s42, 282624
  buffer_load_dwordx4 v1, s[8:11], s42 offen nt lds
  s_add_u32 m0, s41, 20480
  s_mov_b32 s42, 294912
  buffer_load_dwordx4 v1, s[8:11], s42 offen nt lds
  s_add_u32 m0, s41, 21504
  s_mov_b32 s42, 311296
  buffer_load_dwordx4 v1, s[8:11], s42 offen nt lds
  s_add_u32 m0, s41, 22528
  s_mov_b32 s42, 299008
  buffer_load_dwordx4 v1, s[8:11], s42 offen nt lds
  s_add_u32 m0, s41, 23552
  s_mov_b32 s42, 315392
  buffer_load_dwordx4 v1, s[8:11], s42 offen nt lds
  s_add_u32 m0, s41, 24576
  s_mov_b32 s42, 327680
  buffer_load_dwordx4 v1, s[8:11], s42 offen nt lds
  s_add_u32 m0, s41, 25600
  s_mov_b32 s42, 344064
  buffer_load_dwordx4 v1, s[8:11], s42 offen nt lds
  s_add_u32 m0, s41, 26624
  s_mov_b32 s42, 331776
  buffer_load_dwordx4 v1, s[8:11], s42 offen nt lds
  s_add_u32 m0, s41, 27648
  s_mov_b32 s42, 348160
  buffer_load_dwordx4 v1, s[8:11], s42 offen nt lds
  s_add_u32 m0, s41, 28672
  s_mov_b32 s42, 360448
  buffer_load_dwordx4 v1, s[8:11], s42 offen nt lds
  s_add_u32 m0, s41, 29696
  s_mov_b32 s42, 376832
  buffer_load_dwordx4 v1, s[8:11], s42 offen nt lds
  s_add_u32 m0, s41, 30720
  s_mov_b32 s42, 364544
  buffer_load_dwordx4 v1, s[8:11], s42 offen nt lds
  s_add_u32 m0, s41, 31744
  s_mov_b32 s42, 380928
  buffer_load_dwordx4 v1, s[8:11], s42 offen nt lds
  s_waitcnt vmcnt(24)
  ds_read_b64_tr_b16 v[8:9], v4 offset:0
  ds_read_b64_tr_b16 v[10:11], v4 offset:2048
  ds_read_b64_tr_b16 v[12:13], v4 offset:4096
  ds_read_b64_tr_b16 v[14:15], v4 offset:6144
  ds_read_b64_tr_b16 v[16:17], v5 offset:0
  ds_read_b64_tr_b16 v[18:19], v5 offset:2048
  ds_read_b64_tr_b16 v[20:21], v5 offset:4096
  ds_read_b64_tr_b16 v[22:23], v5 offset:6144
  ds_read_b64_tr_b16 v[24:25], v6 offset:0
  ds_read_b64_tr_b16 v[26:27], v6 offset:2048
  ds_read_b64_tr_b16 v[28:29], v6 offset:4096
  ds_read_b64_tr_b16 v[30:31], v6 offset:6144
  ds_read_b64_tr_b16 v[32:33], v7 offset:0
  ds_read_b64_tr_b16 v[34:35], v7 offset:2048
  ds_read_b64_tr_b16 v[36:37], v7 offset:4096
  ds_read_b64_tr_b16 v[38:39], v7 offset:6144
  s_mov_b32 s42, 10485760
  s_waitcnt lgkmcnt(12)
  buffer_store_dwordx4 v[8:11], v3, s[4:7], s42 offen offset:0 sc1
  buffer_store_dwordx4 v[12:15], v3, s[4:7], s42 offen offset:1024 sc1
  s_mov_b32 s42, 10485760
  s_waitcnt lgkmcnt(8)
  buffer_store_dwordx4 v[16:19], v3, s[4:7], s42 offen offset:2048 sc1
  buffer_store_dwordx4 v[20:23], v3, s[4:7], s42 offen offset:3072 sc1
  s_mov_b32 s42, 10747904
  s_waitcnt lgkmcnt(4)
  buffer_store_dwordx4 v[24:27], v3, s[4:7], s42 offen offset:0 sc1
  buffer_store_dwordx4 v[28:31], v3, s[4:7], s42 offen offset:1024 sc1
  s_mov_b32 s42, 10747904
  s_waitcnt lgkmcnt(0)
  buffer_store_dwordx4 v[32:35], v3, s[4:7], s42 offen offset:2048 sc1
  buffer_store_dwordx4 v[36:39], v3, s[4:7], s42 offen offset:3072 sc1
  s_waitcnt vmcnt(24)
  ds_read_b64_tr_b16 v[40:41], v4 offset:8192
  ds_read_b64_tr_b16 v[42:43], v4 offset:10240
  ds_read_b64_tr_b16 v[44:45], v4 offset:12288
  ds_read_b64_tr_b16 v[46:47], v4 offset:14336
  ds_read_b64_tr_b16 v[48:49], v5 offset:8192
  ds_read_b64_tr_b16 v[50:51], v5 offset:10240
  ds_read_b64_tr_b16 v[52:53], v5 offset:12288
  ds_read_b64_tr_b16 v[54:55], v5 offset:14336
  ds_read_b64_tr_b16 v[56:57], v6 offset:8192
  ds_read_b64_tr_b16 v[58:59], v6 offset:10240
  ds_read_b64_tr_b16 v[60:61], v6 offset:12288
  ds_read_b64_tr_b16 v[62:63], v6 offset:14336
  ds_read_b64_tr_b16 v[64:65], v7 offset:8192
  ds_read_b64_tr_b16 v[66:67], v7 offset:10240
  ds_read_b64_tr_b16 v[68:69], v7 offset:12288
  ds_read_b64_tr_b16 v[70:71], v7 offset:14336
  s_mov_b32 s42, 10489856
  s_waitcnt lgkmcnt(12)
  buffer_store_dwordx4 v[40:43], v3, s[4:7], s42 offen offset:0 sc1
  buffer_store_dwordx4 v[44:47], v3, s[4:7], s42 offen offset:1024 sc1
  s_mov_b32 s42, 10489856
  s_waitcnt lgkmcnt(8)
  buffer_store_dwordx4 v[48:51], v3, s[4:7], s42 offen offset:2048 sc1
  buffer_store_dwordx4 v[52:55], v3, s[4:7], s42 offen offset:3072 sc1
  s_mov_b32 s42, 10752000
  s_waitcnt lgkmcnt(4)
  buffer_store_dwordx4 v[56:59], v3, s[4:7], s42 offen offset:0 sc1
  buffer_store_dwordx4 v[60:63], v3, s[4:7], s42 offen offset:1024 sc1
  s_mov_b32 s42, 10752000
  s_waitcnt lgkmcnt(0)
  buffer_store_dwordx4 v[64:67], v3, s[4:7], s42 offen offset:2048 sc1
  buffer_store_dwordx4 v[68:71], v3, s[4:7], s42 offen offset:3072 sc1
  s_waitcnt vmcnt(24)
  ds_read_b64_tr_b16 v[72:73], v4 offset:16384
  ds_read_b64_tr_b16 v[74:75], v4 offset:18432
  ds_read_b64_tr_b16 v[76:77], v4 offset:20480
  ds_read_b64_tr_b16 v[78:79], v4 offset:22528
  ds_read_b64_tr_b16 v[80:81], v5 offset:16384
  ds_read_b64_tr_b16 v[82:83], v5 offset:18432
  ds_read_b64_tr_b16 v[84:85], v5 offset:20480
  ds_read_b64_tr_b16 v[86:87], v5 offset:22528
  ds_read_b64_tr_b16 v[88:89], v6 offset:16384
  ds_read_b64_tr_b16 v[90:91], v6 offset:18432
  ds_read_b64_tr_b16 v[92:93], v6 offset:20480
  ds_read_b64_tr_b16 v[94:95], v6 offset:22528
  ds_read_b64_tr_b16 v[96:97], v7 offset:16384
  ds_read_b64_tr_b16 v[98:99], v7 offset:18432
  ds_read_b64_tr_b16 v[100:101], v7 offset:20480
  ds_read_b64_tr_b16 v[102:103], v7 offset:22528
  s_mov_b32 s42, 10493952
  s_waitcnt lgkmcnt(12)
  buffer_store_dwordx4 v[72:75], v3, s[4:7], s42 offen offset:0 sc1
  buffer_store_dwordx4 v[76:79], v3, s[4:7], s42 offen offset:1024 sc1
  s_mov_b32 s42, 10493952
  s_waitcnt lgkmcnt(8)
  buffer_store_dwordx4 v[80:83], v3, s[4:7], s42 offen offset:2048 sc1
  buffer_store_dwordx4 v[84:87], v3, s[4:7], s42 offen offset:3072 sc1
  s_mov_b32 s42, 10756096
  s_waitcnt lgkmcnt(4)
  buffer_store_dwordx4 v[88:91], v3, s[4:7], s42 offen offset:0 sc1
  buffer_store_dwordx4 v[92:95], v3, s[4:7], s42 offen offset:1024 sc1
  s_mov_b32 s42, 10756096
  s_waitcnt lgkmcnt(0)
  buffer_store_dwordx4 v[96:99], v3, s[4:7], s42 offen offset:2048 sc1
  buffer_store_dwordx4 v[100:103], v3, s[4:7], s42 offen offset:3072 sc1
  s_waitcnt vmcnt(24)
  ds_read_b64_tr_b16 v[104:105], v4 offset:24576
  ds_read_b64_tr_b16 v[106:107], v4 offset:26624
  ds_read_b64_tr_b16 v[108:109], v4 offset:28672
  ds_read_b64_tr_b16 v[110:111], v4 offset:30720
  ds_read_b64_tr_b16 v[112:113], v5 offset:24576
  ds_read_b64_tr_b16 v[114:115], v5 offset:26624
  ds_read_b64_tr_b16 v[116:117], v5 offset:28672
  ds_read_b64_tr_b16 v[118:119], v5 offset:30720
  ds_read_b64_tr_b16 v[120:121], v6 offset:24576
  ds_read_b64_tr_b16 v[122:123], v6 offset:26624
  ds_read_b64_tr_b16 v[124:125], v6 offset:28672
  ds_read_b64_tr_b16 v[126:127], v6 offset:30720
  ds_read_b64_tr_b16 v[128:129], v7 offset:24576
  ds_read_b64_tr_b16 v[130:131], v7 offset:26624
  ds_read_b64_tr_b16 v[132:133], v7 offset:28672
  ds_read_b64_tr_b16 v[134:135], v7 offset:30720
  s_mov_b32 s42, 10498048
  s_waitcnt lgkmcnt(12)
  buffer_store_dwordx4 v[104:107], v3, s[4:7], s42 offen offset:0 sc1
  buffer_store_dwordx4 v[108:111], v3, s[4:7], s42 offen offset:1024 sc1
  s_mov_b32 s42, 10498048
  s_waitcnt lgkmcnt(8)
  buffer_store_dwordx4 v[112:115], v3, s[4:7], s42 offen offset:2048 sc1
  buffer_store_dwordx4 v[116:119], v3, s[4:7], s42 offen offset:3072 sc1
  s_mov_b32 s42, 10760192
  s_waitcnt lgkmcnt(4)
  buffer_store_dwordx4 v[120:123], v3, s[4:7], s42 offen offset:0 sc1
  buffer_store_dwordx4 v[124:127], v3, s[4:7], s42 offen offset:1024 sc1
  s_mov_b32 s42, 10760192
  s_waitcnt lgkmcnt(0)
  buffer_store_dwordx4 v[128:131], v3, s[4:7], s42 offen offset:2048 sc1
  buffer_store_dwordx4 v[132:135], v3, s[4:7], s42 offen offset:3072 sc1
  v_min_u32 v1, 31, v0
  v_lshlrev_b32 v1, 2, v1
  v_add_u32 v1, 128, v1
  s_nop 1
Lpoll_157:
  buffer_load_dword v2, v1, s[12:15], 0 offen sc1
  s_sub_u32 s24, s24, 1
  s_cbranch_scc1 L_FAIL
  s_waitcnt vmcnt(0)
  v_cmp_gt_i32 vcc, 1, v2
  s_cbranch_vccz Lpolld_158
  s_sleep 2
  s_branch Lpoll_157
Lpolld_158:
  s_barrier
  s_lshl_b32 s40, s21, 7
  s_add_u32 s40, s40, 1432576
  s_cmp_lg_u32 s20, 0
  s_cbranch_scc1 Lnosig_159
  s_mov_b32 s63, 1
  s_atomic_smax s63, s[4:5], s40 glc
Lnosig_159:
  s_branch L_LN1
L_QK:
  v_bfe_u32 v76, v0, 3, 2
  v_xor_b32 v76, s20, v76
  v_lshlrev_b32 v76, 5, v76
  v_lshrrev_b32 v4, 2, v0
  v_lshl_add_u32 v4, v4, 7, v76
  v_and_b32 v76, 3, v0
  v_lshl_add_u32 v4, v76, 3, v4
  s_lshl_b32 s40, s20, 15
  v_add_u32 v4, s40, v4
  v_lshl_add_u32 v85, v0, 4, s40
  s_lshl_b32 s40, s20, 12
  s_add_u32 s40, s40, 131072
  v_lshl_add_u32 v1, v0, 4, s40
  s_lshr_b32 s54, s21, 4
  s_lshl_b32 s52, s54, 22
  s_sub_u32 s53, 0, s52
  v_xor_b32 v5, 32768, v4
  v_xor_b32 v2, 4096, v1
  v_xor_b32 v6, 65536, v4
  v_xor_b32 v3, 8192, v1
  v_xor_b32 v7, 98304, v4
  v_xor_b32 v84, 12288, v1
  v_bfe_u32 v8, v0, 5, 1
  v_mul_u32_u24 v8, 16384, v8
  v_bfe_u32 v76, v0, 4, 1
  v_mul_u32_u24 v76, 32768, v76
  v_add_u32 v8, v8, v76
  v_bfe_u32 v76, v0, 3, 1
  v_mul_u32_u24 v76, 131072, v76
  v_add_u32 v8, v8, v76
  v_lshrrev_b32 v76, 3, v0
  v_and_b32 v76, 6, v76
  v_xor_b32 v76, v76, v0
  v_and_b32 v76, 7, v76
  v_lshl_add_u32 v8, v76, 4, v8
  s_lshl_b32 s40, s20, 19
  v_add_u32 v8, s40, v8
  s_lshl_b32 s44, s21, 8
  s_add_u32 s45, s44, 128
  v_add_u32 v9, s44, v8
  v_add_u32 v10, s44, v8
  v_add_u32 v11, s45, v8
  v_add_u32 v12, s45, v8
  s_lshl_b32 s41, s20, 15
  s_and_b32 s40, s21, 3
  s_cmp_eq_u32 s40, 1
  s_cselect_b64 vcc, -1, 0
  s_load_dwordx2 s[8:9], s[0:1], 24
  s_mov_b32 s10, 8388608
  s_mov_b32 s11, 0x20000
  s_waitcnt lgkmcnt(0)
  s_add_u32 m0, s41, 0
  s_add_u32 s42, s52, 0
  buffer_load_dwordx4 v9, s[8:11], s42 offen lds
  s_add_u32 m0, s41, 1024
  s_add_u32 s42, s52, 65536
  buffer_load_dwordx4 v9, s[8:11], s42 offen lds
  s_add_u32 m0, s41, 2048
  s_add_u32 s42, s52, 8192
  buffer_load_dwordx4 v9, s[8:11], s42 offen lds
  s_add_u32 m0, s41, 3072
  s_add_u32 s42, s52, 73728
  buffer_load_dwordx4 v9, s[8:11], s42 offen lds
  s_add_u32 m0, s41, 4096
  s_add_u32 s42, s52, 262144
  buffer_load_dwordx4 v9, s[8:11], s42 offen lds
  s_add_u32 m0, s41, 5120
  s_add_u32 s42, s52, 327680
  buffer_load_dwordx4 v9, s[8:11], s42 offen lds
  s_add_u32 m0, s41, 6144
  s_add_u32 s42, s52, 270336
  buffer_load_dwordx4 v9, s[8:11], s42 offen lds
  s_add_u32 m0, s41, 7168
  s_add_u32 s42, s52, 335872
  buffer_load_dwordx4 v9, s[8:11], s42 offen lds
  s_add_u32 m0, s41, 8192
  s_add_u32 s42, s52, 2097152
  buffer_load_dwordx4 v9, s[8:11], s42 offen lds
  s_add_u32 m0, s41, 9216
  s_add_u32 s42, s52, 2162688
  buffer_load_dwordx4 v9, s[8:11], s42 offen lds
  s_add_u32 m0, s41, 10240
  s_add_u32 s42, s52, 2105344
  buffer_load_dwordx4 v9, s[8:11], s42 offen lds
  s_add_u32 m0, s41, 11264
  s_add_u32 s42, s52, 2170880
  buffer_load_dwordx4 v9, s[8:11], s42 offen lds
  s_add_u32 m0, s41, 12288
  s_add_u32 s42, s52, 2359296
  buffer_load_dwordx4 v9, s[8:11], s42 offen lds
  s_add_u32 m0, s41, 13312
  s_add_u32 s42, s52, 2424832
  buffer_load_dwordx4 v9, s[8:11], s42 offen lds
  s_add_u32 m0, s41, 14336
  s_add_u32 s42, s52, 2367488
  buffer_load_dwordx4 v9, s[8:11], s42 offen lds
  s_add_u32 m0, s41, 15360
  s_add_u32 s42, s52, 2433024
  buffer_load_dwordx4 v9, s[8:11], s42 offen lds
  s_add_u32 m0, s41, 16384
  s_add_u32 s42, s53, 4194304
  buffer_load_dwordx4 v9, s[8:11], s42 offen lds
  s_add_u32 m0, s41, 17408
  s_add_u32 s42, s53, 4259840
  buffer_load_dwordx4 v9, s[8:11], s42 offen lds
  s_add_u32 m0, s41, 18432
  s_add_u32 s42, s53, 4202496
  buffer_load_dwordx4 v9, s[8:11], s42 offen lds
  s_add_u32 m0, s41, 19456
  s_add_u32 s42, s53, 4268032
  buffer_load_dwordx4 v9, s[8:11], s42 offen lds
  s_add_u32 m0, s41, 20480
  s_add_u32 s42, s53, 4456448
  buffer_load_dwordx4 v9, s[8:11], s42 offen lds
  s_add_u32 m0, s41, 21504
  s_add_u32 s42, s53, 4521984
  buffer_load_dwordx4 v9, s[8:11], s42 offen lds
  s_add_u32 m0, s41, 22528
  s_add_u32 s42, s53, 4464640
  buffer_load_dwordx4 v9, s[8:11], s42 offen lds
  s_add_u32 m0, s41, 23552
  s_add_u32 s42, s53, 4530176
  buffer_load_dwordx4 v9, s[8:11], s42 offen lds
  s_waitcnt vmcnt(16) lgkmcnt(0)
  s_barrier
  s_add_u32 m0, s41, 24576
  s_add_u32 s42, s53, 6291456
  buffer_load_dwordx4 v9, s[8:11], s42 offen lds
  s_add_u32 m0, s41, 25600
  s_add_u32 s42, s53, 6356992
  buffer_load_dwordx4 v9, s[8:11], s42 offen lds
  s_add_u32 m0, s41, 26624
  s_add_u32 s42, s53, 6299648
  buffer_load_dwordx4 v9, s[8:11], s42 offen lds
  s_add_u32 m0, s41, 27648
  s_add_u32 s42, s53, 6365184
  buffer_load_dwordx4 v9, s[8:11], s42 offen lds
  s_add_u32 m0, s41, 28672
  s_add_u32 s42, s53, 6553600
  buffer_load_dwordx4 v9, s[8:11], s42 offen lds
  s_add_u32 m0, s41, 29696
  s_add_u32 s42, s53, 6619136
  buffer_load_dwordx4 v9, s[8:11], s42 offen lds
  s_add_u32 m0, s41, 30720
  s_add_u32 s42, s53, 6561792
  buffer_load_dwordx4 v9, s[8:11], s42 offen lds
  s_add_u32 m0, s41, 31744
  s_add_u32 s42, s53, 6627328
  buffer_load_dwordx4 v9, s[8:11], s42 offen lds
  ds_read_b64_tr_b16 v[128:129], v4 offset:0
  ds_read_b64_tr_b16 v[130:131], v4 offset:2048
  ds_read_b64_tr_b16 v[132:133], v4 offset:4096
  ds_read_b64_tr_b16 v[134:135], v4 offset:6144
  ds_read_b64_tr_b16 v[144:145], v5 offset:0
  ds_read_b64_tr_b16 v[146:147], v5 offset:2048
  ds_read_b64_tr_b16 v[148:149], v5 offset:4096
  ds_read_b64_tr_b16 v[150:151], v5 offset:6144
  ds_read_b64_tr_b16 v[160:161], v6 offset:0
  ds_read_b64_tr_b16 v[162:163], v6 offset:2048
  ds_read_b64_tr_b16 v[164:165], v6 offset:4096
  ds_read_b64_tr_b16 v[166:167], v6 offset:6144
  ds_read_b64_tr_b16 v[176:177], v7 offset:0
  ds_read_b64_tr_b16 v[178:179], v7 offset:2048
  ds_read_b64_tr_b16 v[180:181], v7 offset:4096
  ds_read_b64_tr_b16 v[182:183], v7 offset:6144
  s_waitcnt vmcnt(16) lgkmcnt(0)
  s_barrier
  s_load_dwordx2 s[8:9], s[0:1], 16
  s_mov_b32 s10, 8388608
  s_mov_b32 s11, 0x20000
  s_waitcnt lgkmcnt(0)
  s_add_u32 m0, s41, 0
  s_add_u32 s42, s52, 0
  buffer_load_dwordx4 v10, s[8:11], s42 offen lds
  s_add_u32 m0, s41, 1024
  s_add_u32 s42, s52, 65536
  buffer_load_dwordx4 v10, s[8:11], s42 offen lds
  s_add_u32 m0, s41, 2048
  s_add_u32 s42, s52, 8192
  buffer_load_dwordx4 v10, s[8:11], s42 offen lds
  s_add_u32 m0, s41, 3072
  s_add_u32 s42, s52, 73728
  buffer_load_dwordx4 v10, s[8:11], s42 offen lds
  s_add_u32 m0, s41, 4096
  s_add_u32 s42, s52, 262144
  buffer_load_dwordx4 v10, s[8:11], s42 offen lds
  s_add_u32 m0, s41, 5120
  s_add_u32 s42, s52, 327680
  buffer_load_dwordx4 v10, s[8:11], s42 offen lds
  s_add_u32 m0, s41, 6144
  s_add_u32 s42, s52, 270336
  buffer_load_dwordx4 v10, s[8:11], s42 offen lds
  s_add_u32 m0, s41, 7168
  s_add_u32 s42, s52, 335872
  buffer_load_dwordx4 v10, s[8:11], s42 offen lds
  ds_read_b64_tr_b16 v[136:137], v4 offset:8192
  ds_read_b64_tr_b16 v[138:139], v4 offset:10240
  ds_read_b64_tr_b16 v[140:141], v4 offset:12288
  ds_read_b64_tr_b16 v[142:143], v4 offset:14336
  ds_read_b64_tr_b16 v[152:153], v5 offset:8192
  ds_read_b64_tr_b16 v[154:155], v5 offset:10240
  ds_read_b64_tr_b16 v[156:157], v5 offset:12288
  ds_read_b64_tr_b16 v[158:159], v5 offset:14336
  ds_read_b64_tr_b16 v[168:169], v6 offset:8192
  ds_read_b64_tr_b16 v[170:171], v6 offset:10240
  ds_read_b64_tr_b16 v[172:173], v6 offset:12288
  ds_read_b64_tr_b16 v[174:175], v6 offset:14336
  ds_read_b64_tr_b16 v[184:185], v7 offset:8192
  ds_read_b64_tr_b16 v[186:187], v7 offset:10240
  ds_read_b64_tr_b16 v[188:189], v7 offset:12288
  ds_read_b64_tr_b16 v[190:191], v7 offset:14336
  s_waitcnt vmcnt(16) lgkmcnt(0)
  s_barrier
  s_add_u32 m0, s41, 8192
  s_add_u32 s42, s52, 2097152
  buffer_load_dwordx4 v10, s[8:11], s42 offen lds
  s_add_u32 m0, s41, 9216
  s_add_u32 s42, s52, 2162688
  buffer_load_dwordx4 v10, s[8:11], s42 offen lds
  s_add_u32 m0, s41, 10240
  s_add_u32 s42, s52, 2105344
  buffer_load_dwordx4 v10, s[8:11], s42 offen lds
  s_add_u32 m0, s41, 11264
  s_add_u32 s42, s52, 2170880
  buffer_load_dwordx4 v10, s[8:11], s42 offen lds
  s_add_u32 m0, s41, 12288
  s_add_u32 s42, s52, 2359296
  buffer_load_dwordx4 v10, s[8:11], s42 offen lds
  s_add_u32 m0, s41, 13312
  s_add_u32 s42, s52, 2424832
  buffer_load_dwordx4 v10, s[8:11], s42 offen lds
  s_add_u32 m0, s41, 14336
  s_add_u32 s42, s52, 2367488
  buffer_load_dwordx4 v10, s[8:11], s42 offen lds
  s_add_u32 m0, s41, 15360
  s_add_u32 s42, s52, 2433024
  buffer_load_dwordx4 v10, s[8:11], s42 offen lds
  ds_read_b64_tr_b16 v[192:193], v4 offset:16384
  ds_read_b64_tr_b16 v[194:195], v4 offset:18432
  ds_read_b64_tr_b16 v[196:197], v4 offset:20480
  ds_read_b64_tr_b16 v[198:199], v4 offset:22528
  ds_read_b64_tr_b16 v[208:209], v5 offset:16384
  ds_read_b64_tr_b16 v[210:211], v5 offset:18432
  ds_read_b64_tr_b16 v[212:213], v5 offset:20480
  ds_read_b64_tr_b16 v[214:215], v5 offset:22528
  ds_read_b64_tr_b16 v[224:225], v6 offset:16384
  ds_read_b64_tr_b16 v[226:227], v6 offset:18432
  ds_read_b64_tr_b16 v[228:229], v6 offset:20480
  ds_read_b64_tr_b16 v[230:231], v6 offset:22528
  ds_read_b64_tr_b16 v[240:241], v7 offset:16384
  ds_read_b64_tr_b16 v[242:243], v7 offset:18432
  ds_read_b64_tr_b16 v[244:245], v7 offset:20480
  ds_read_b64_tr_b16 v[246:247], v7 offset:22528
  s_waitcnt vmcnt(16) lgkmcnt(0)
  s_barrier
  s_add_u32 m0, s41, 16384
  s_add_u32 s42, s53, 4194304
  buffer_load_dwordx4 v10, s[8:11], s42 offen lds
  s_add_u32 m0, s41, 17408
  s_add_u32 s42, s53, 4259840
  buffer_load_dwordx4 v10, s[8:11], s42 offen lds
  s_add_u32 m0, s41, 18432
  s_add_u32 s42, s53, 4202496
  buffer_load_dwordx4 v10, s[8:11], s42 offen lds
  s_add_u32 m0, s41, 19456
  s_add_u32 s42, s53, 4268032
  buffer_load_dwordx4 v10, s[8:11], s42 offen lds
  s_add_u32 m0, s41, 20480
  s_add_u32 s42, s53, 4456448
  buffer_load_dwordx4 v10, s[8:11], s42 offen lds
  s_add_u32 m0, s41, 21504
  s_add_u32 s42, s53, 4521984
  buffer_load_dwordx4 v10, s[8:11], s42 offen lds
  s_add_u32 m0, s41, 22528
  s_add_u32 s42, s53, 4464640
  buffer_load_dwordx4 v10, s[8:11], s42 offen lds
  s_add_u32 m0, s41, 23552
  s_add_u32 s42, s53, 4530176
  buffer_load_dwordx4 v10, s[8:11], s42 offen lds
  ds_read_b64_tr_b16 v[200:201], v4 offset:24576
  ds_read_b64_tr_b16 v[202:203], v4 offset:26624
  ds_read_b64_tr_b16 v[204:205], v4 offset:28672
  ds_read_b64_tr_b16 v[206:207], v4 offset:30720
  ds_read_b64_tr_b16 v[216:217], v5 offset:24576
  ds_read_b64_tr_b16 v[218:219], v5 offset:26624
  ds_read_b64_tr_b16 v[220:221], v5 offset:28672
  ds_read_b64_tr_b16 v[222:223], v5 offset:30720
  ds_read_b64_tr_b16 v[232:233], v6 offset:24576
  ds_read_b64_tr_b16 v[234:235], v6 offset:26624
  ds_read_b64_tr_b16 v[236:237], v6 offset:28672
  ds_read_b64_tr_b16 v[238:239], v6 offset:30720
  ds_read_b64_tr_b16 v[248:249], v7 offset:24576
  ds_read_b64_tr_b16 v[250:251], v7 offset:26624
  ds_read_b64_tr_b16 v[252:253], v7 offset:28672
  ds_read_b64_tr_b16 v[254:255], v7 offset:30720
  s_waitcnt vmcnt(16) lgkmcnt(0)
  s_barrier
  s_add_u32 m0, s41, 24576
  s_add_u32 s42, s53, 6291456
  buffer_load_dwordx4 v10, s[8:11], s42 offen lds
  s_add_u32 m0, s41, 25600
  s_add_u32 s42, s53, 6356992
  buffer_load_dwordx4 v10, s[8:11], s42 offen lds
  s_add_u32 m0, s41, 26624
  s_add_u32 s42, s53, 6299648
  buffer_load_dwordx4 v10, s[8:11], s42 offen lds
  s_add_u32 m0, s41, 27648
  s_add_u32 s42, s53, 6365184
  buffer_load_dwordx4 v10, s[8:11], s42 offen lds
  s_add_u32 m0, s41, 28672
  s_add_u32 s42, s53, 6553600
  buffer_load_dwordx4 v10, s[8:11], s42 offen lds
  s_add_u32 m0, s41, 29696
  s_add_u32 s42, s53, 6619136
  buffer_load_dwordx4 v10, s[8:11], s42 offen lds
  s_add_u32 m0, s41, 30720
  s_add_u32 s42, s53, 6561792
  buffer_load_dwordx4 v10, s[8:11], s42 offen lds
  s_add_u32 m0, s41, 31744
  s_add_u32 s42, s53, 6627328
  buffer_load_dwordx4 v10, s[8:11], s42 offen lds
  ds_read_b64_tr_b16 a[0:1], v4 offset:0
  ds_read_b64_tr_b16 a[2:3], v4 offset:2048
  ds_read_b64_tr_b16 a[4:5], v4 offset:4096
  ds_read_b64_tr_b16 a[6:7], v4 offset:6144
  ds_read_b64_tr_b16 a[16:17], v5 offset:0
  ds_read_b64_tr_b16 a[18:19], v5 offset:2048
  ds_read_b64_tr_b16 a[20:21], v5 offset:4096
  ds_read_b64_tr_b16 a[22:23], v5 offset:6144
  ds_read_b64_tr_b16 a[32:33], v6 offset:0
  ds_read_b64_tr_b16 a[34:35], v6 offset:2048
  ds_read_b64_tr_b16 a[36:37], v6 offset:4096
  ds_read_b64_tr_b16 a[38:39], v6 offset:6144
  ds_read_b64_tr_b16 a[48:49], v7 offset:0
  ds_read_b64_tr_b16 a[50:51], v7 offset:2048
  ds_read_b64_tr_b16 a[52:53], v7 offset:4096
  ds_read_b64_tr_b16 a[54:55], v7 offset:6144
  s_waitcnt vmcnt(16) lgkmcnt(0)
  s_barrier
  s_load_dwordx2 s[8:9], s[0:1], 16
  s_mov_b32 s10, 8388608
  s_mov_b32 s11, 0x20000
  s_waitcnt lgkmcnt(0)
  s_add_u32 m0, s41, 0
  s_add_u32 s42, s52, 0
  buffer_load_dwordx4 v11, s[8:11], s42 offen lds
  s_add_u32 m0, s41, 1024
  s_add_u32 s42, s52, 65536
  buffer_load_dwordx4 v11, s[8:11], s42 offen lds
  s_add_u32 m0, s41, 2048
  s_add_u32 s42, s52, 8192
  buffer_load_dwordx4 v11, s[8:11], s42 offen lds
  s_add_u32 m0, s41, 3072
  s_add_u32 s42, s52, 73728
  buffer_load_dwordx4 v11, s[8:11], s42 offen lds
  s_add_u32 m0, s41, 4096
  s_add_u32 s42, s52, 262144
  buffer_load_dwordx4 v11, s[8:11], s42 offen lds
  s_add_u32 m0, s41, 5120
  s_add_u32 s42, s52, 327680
  buffer_load_dwordx4 v11, s[8:11], s42 offen lds
  s_add_u32 m0, s41, 6144
  s_add_u32 s42, s52, 270336
  buffer_load_dwordx4 v11, s[8:11], s42 offen lds
  s_add_u32 m0, s41, 7168
  s_add_u32 s42, s52, 335872
  buffer_load_dwordx4 v11, s[8:11], s42 offen lds
  ds_read_b64_tr_b16 a[8:9], v4 offset:8192
  ds_read_b64_tr_b16 a[10:11], v4 offset:10240
  ds_read_b64_tr_b16 a[12:13], v4 offset:12288
  ds_read_b64_tr_b16 a[14:15], v4 offset:14336
  ds_read_b64_tr_b16 a[24:25], v5 offset:8192
  ds_read_b64_tr_b16 a[26:27], v5 offset:10240
  ds_read_b64_tr_b16 a[28:29], v5 offset:12288
  ds_read_b64_tr_b16 a[30:31], v5 offset:14336
  ds_read_b64_tr_b16 a[40:41], v6 offset:8192
  ds_read_b64_tr_b16 a[42:43], v6 offset:10240
  ds_read_b64_tr_b16 a[44:45], v6 offset:12288
  ds_read_b64_tr_b16 a[46:47], v6 offset:14336
  ds_read_b64_tr_b16 a[56:57], v7 offset:8192
  ds_read_b64_tr_b16 a[58:59], v7 offset:10240
  ds_read_b64_tr_b16 a[60:61], v7 offset:12288
  ds_read_b64_tr_b16 a[62:63], v7 offset:14336
  s_waitcnt vmcnt(16) lgkmcnt(0)
  s_barrier
  s_add_u32 m0, s41, 8192
  s_add_u32 s42, s52, 2097152
  buffer_load_dwordx4 v11, s[8:11], s42 offen lds
  s_add_u32 m0, s41, 9216
  s_add_u32 s42, s52, 2162688
  buffer_load_dwordx4 v11, s[8:11], s42 offen lds
  s_add_u32 m0, s41, 10240
  s_add_u32 s42, s52, 2105344
  buffer_load_dwordx4 v11, s[8:11], s42 offen lds
  s_add_u32 m0, s41, 11264
  s_add_u32 s42, s52, 2170880
  buffer_load_dwordx4 v11, s[8:11], s42 offen lds
  s_add_u32 m0, s41, 12288
  s_add_u32 s42, s52, 2359296
  buffer_load_dwordx4 v11, s[8:11], s42 offen lds
  s_add_u32 m0, s41, 13312
  s_add_u32 s42, s52, 2424832
  buffer_load_dwordx4 v11, s[8:11], s42 offen lds
  s_add_u32 m0, s41, 14336
  s_add_u32 s42, s52, 2367488
  buffer_load_dwordx4 v11, s[8:11], s42 offen lds
  s_add_u32 m0, s41, 15360
  s_add_u32 s42, s52, 2433024
  buffer_load_dwordx4 v11, s[8:11], s42 offen lds
  ds_read_b64_tr_b16 a[64:65], v4 offset:16384
  ds_read_b64_tr_b16 a[66:67], v4 offset:18432
  ds_read_b64_tr_b16 a[68:69], v4 offset:20480
  ds_read_b64_tr_b16 a[70:71], v4 offset:22528
  ds_read_b64_tr_b16 a[80:81], v5 offset:16384
  ds_read_b64_tr_b16 a[82:83], v5 offset:18432
  ds_read_b64_tr_b16 a[84:85], v5 offset:20480
  ds_read_b64_tr_b16 a[86:87], v5 offset:22528
  ds_read_b64_tr_b16 a[96:97], v6 offset:16384
  ds_read_b64_tr_b16 a[98:99], v6 offset:18432
  ds_read_b64_tr_b16 a[100:101], v6 offset:20480
  ds_read_b64_tr_b16 a[102:103], v6 offset:22528
  ds_read_b64_tr_b16 a[112:113], v7 offset:16384
  ds_read_b64_tr_b16 a[114:115], v7 offset:18432
  ds_read_b64_tr_b16 a[116:117], v7 offset:20480
  ds_read_b64_tr_b16 a[118:119], v7 offset:22528
  s_cmp_lg_u32 s20, 0
  s_cbranch_scc1 Lchore_160
Lini_161:
  s_load_dwordx16 s[64:79], s[12:13], 128 glc
  s_load_dwordx16 s[80:95], s[12:13], 192 glc
  s_sub_u32 s24, s24, 1
  s_cbranch_scc1 L_FAIL
  s_waitcnt lgkmcnt(0)
  s_and_b64 s[64:65], s[64:65], s[66:67]
  s_and_b64 s[64:65], s[64:65], s[68:69]
  s_and_b64 s[64:65], s[64:65], s[70:71]
  s_and_b64 s[64:65], s[64:65], s[72:73]
  s_and_b64 s[64:65], s[64:65], s[74:75]
  s_and_b64 s[64:65], s[64:65], s[76:77]
  s_and_b64 s[64:65], s[64:65], s[78:79]
  s_and_b64 s[64:65], s[64:65], s[80:81]
  s_and_b64 s[64:65], s[64:65], s[82:83]
  s_and_b64 s[64:65], s[64:65], s[84:85]
  s_and_b64 s[64:65], s[64:65], s[86:87]
  s_and_b64 s[64:65], s[64:65], s[88:89]
  s_and_b64 s[64:65], s[64:65], s[90:91]
  s_and_b64 s[64:65], s[64:65], s[92:93]
  s_and_b64 s[64:65], s[64:65], s[94:95]
  s_and_b32 s64, s64, s65
  s_cbranch_scc0 Lini_161
  s_mov_b32 s46, 0xffff
  s_and_b32 s40, s21, 3
  s_lshl_b32 s40, s40, 13
  s_lshr_b32 s43, s21, 2
  s_lshl_b32 s43, s43, 10
  s_add_u32 s43, s43, s40
  s_add_u32 s43, s43, 1343488
  s_waitcnt lgkmcnt(0)
  s_memtime s[64:65]
  s_waitcnt lgkmcnt(0)
  s_load_dword s68, s[4:5], s43 glc
  s_waitcnt lgkmcnt(0)
  s_memtime s[66:67]
  s_waitcnt lgkmcnt(0)
  s_sub_u32 s64, s66, s64
  s_min_u32 s46, s46, s64
  s_getreg_b32 s55, hwreg(HW_REG_XCC_ID)
  s_and_b32 s55, s55, 15
  s_lshl_b32 s46, s46, 8
  s_or_b32 s46, s46, s55
  s_add_u32 s40, s21, 0
  s_lshl_b32 s40, s40, 7
  s_add_u32 s40, s40, 1424384
  s_mov_b32 s63, s46
  s_atomic_smax s63, s[4:5], s40 glc
Lnosig_162:
Lchore_160:
  s_waitcnt vmcnt(16) lgkmcnt(0)
  s_barrier
  s_add_u32 m0, s41, 16384
  s_add_u32 s42, s53, 4194304
  buffer_load_dwordx4 v11, s[8:11], s42 offen lds
  s_add_u32 m0, s41, 17408
  s_add_u32 s42, s53, 4259840
  buffer_load_dwordx4 v11, s[8:11], s42 offen lds
  s_add_u32 m0, s41, 18432
  s_add_u32 s42, s53, 4202496
  buffer_load_dwordx4 v11, s[8:11], s42 offen lds
  s_add_u32 m0, s41, 19456
  s_add_u32 s42, s53, 4268032
  buffer_load_dwordx4 v11, s[8:11], s42 offen lds
  s_add_u32 m0, s41, 20480
  s_add_u32 s42, s53, 4456448
  buffer_load_dwordx4 v11, s[8:11], s42 offen lds
  s_add_u32 m0, s41, 21504
  s_add_u32 s42, s53, 4521984
  buffer_load_dwordx4 v11, s[8:11], s42 offen lds
  s_add_u32 m0, s41, 22528
  s_add_u32 s42, s53, 4464640
  buffer_load_dwordx4 v11, s[8:11], s42 offen lds
  s_add_u32 m0, s41, 23552
  s_add_u32 s42, s53, 4530176
  buffer_load_dwordx4 v11, s[8:11], s42 offen lds
  ds_read_b64_tr_b16 a[72:73], v4 offset:24576
  ds_read_b64_tr_b16 a[74:75], v4 offset:26624
  ds_read_b64_tr_b16 a[76:77], v4 offset:28672
  ds_read_b64_tr_b16 a[78:79], v4 offset:30720
  ds_read_b64_tr_b16 a[88:89], v5 offset:24576
  ds_read_b64_tr_b16 a[90:91], v5 offset:26624
  ds_read_b64_tr_b16 a[92:93], v5 offset:28672
  ds_read_b64_tr_b16 a[94:95], v5 offset:30720
  ds_read_b64_tr_b16 a[104:105], v6 offset:24576
  ds_read_b64_tr_b16 a[106:107], v6 offset:26624
  ds_read_b64_tr_b16 a[108:109], v6 offset:28672
  ds_read_b64_tr_b16 a[110:111], v6 offset:30720
  ds_read_b64_tr_b16 a[120:121], v7 offset:24576
  ds_read_b64_tr_b16 a[122:123], v7 offset:26624
  ds_read_b64_tr_b16 a[124:125], v7 offset:28672
  ds_read_b64_tr_b16 a[126:127], v7 offset:30720
  s_waitcnt vmcnt(16) lgkmcnt(0)
  s_barrier
  s_add_u32 m0, s41, 24576
  s_add_u32 s42, s53, 6291456
  buffer_load_dwordx4 v11, s[8:11], s42 offen lds
  s_add_u32 m0, s41, 25600
  s_add_u32 s42, s53, 6356992
  buffer_load_dwordx4 v11, s[8:11], s42 offen lds
  s_add_u32 m0, s41, 26624
  s_add_u32 s42, s53, 6299648
  buffer_load_dwordx4 v11, s[8:11], s42 offen lds
  s_add_u32 m0, s41, 27648
  s_add_u32 s42, s53, 6365184
  buffer_load_dwordx4 v11, s[8:11], s42 offen lds
  s_add_u32 m0, s41, 28672
  s_add_u32 s42, s53, 6553600
  buffer_load_dwordx4 v11, s[8:11], s42 offen lds
  s_add_u32 m0, s41, 29696
  s_add_u32 s42, s53, 6619136
  buffer_load_dwordx4 v11, s[8:11], s42 offen lds
  s_add_u32 m0, s41, 30720
  s_add_u32 s42, s53, 6561792
  buffer_load_dwordx4 v11, s[8:11], s42 offen lds
  s_add_u32 m0, s41, 31744
  s_add_u32 s42, s53, 6627328
  buffer_load_dwordx4 v11, s[8:11], s42 offen lds
  ds_read_b64_tr_b16 a[128:129], v4 offset:0
  ds_read_b64_tr_b16 a[130:131], v4 offset:2048
  ds_read_b64_tr_b16 a[132:133], v4 offset:4096
  ds_read_b64_tr_b16 a[134:135], v4 offset:6144
  ds_read_b64_tr_b16 a[144:145], v5 offset:0
  ds_read_b64_tr_b16 a[146:147], v5 offset:2048
  ds_read_b64_tr_b16 a[148:149], v5 offset:4096
  ds_read_b64_tr_b16 a[150:151], v5 offset:6144
  ds_read_b64_tr_b16 a[160:161], v6 offset:0
  ds_read_b64_tr_b16 a[162:163], v6 offset:2048
  ds_read_b64_tr_b16 a[164:165], v6 offset:4096
  ds_read_b64_tr_b16 a[166:167], v6 offset:6144
  ds_read_b64_tr_b16 a[176:177], v7 offset:0
  ds_read_b64_tr_b16 a[178:179], v7 offset:2048
  ds_read_b64_tr_b16 a[180:181], v7 offset:4096
  ds_read_b64_tr_b16 a[182:183], v7 offset:6144
  s_waitcnt vmcnt(16) lgkmcnt(0)
  s_barrier
  s_load_dwordx2 s[8:9], s[0:1], 24
  s_mov_b32 s10, 8388608
  s_mov_b32 s11, 0x20000
  s_waitcnt lgkmcnt(0)
  s_add_u32 m0, s41, 0
  s_add_u32 s42, s52, 0
  buffer_load_dwordx4 v12, s[8:11], s42 offen lds
  s_add_u32 m0, s41, 1024
  s_add_u32 s42, s52, 65536
  buffer_load_dwordx4 v12, s[8:11], s42 offen lds
  s_add_u32 m0, s41, 2048
  s_add_u32 s42, s52, 8192
  buffer_load_dwordx4 v12, s[8:11], s42 offen lds
  s_add_u32 m0, s41, 3072
  s_add_u32 s42, s52, 73728
  buffer_load_dwordx4 v12, s[8:11], s42 offen lds
  s_add_u32 m0, s41, 4096
  s_add_u32 s42, s52, 262144
  buffer_load_dwordx4 v12, s[8:11], s42 offen lds
  s_add_u32 m0, s41, 5120
  s_add_u32 s42, s52, 327680
  buffer_load_dwordx4 v12, s[8:11], s42 offen lds
  s_add_u32 m0, s41, 6144
  s_add_u32 s42, s52, 270336
  buffer_load_dwordx4 v12, s[8:11], s42 offen lds
  s_add_u32 m0, s41, 7168
  s_add_u32 s42, s52, 335872
  buffer_load_dwordx4 v12, s[8:11], s42 offen lds
  ds_read_b64_tr_b16 a[136:137], v4 offset:8192
  ds_read_b64_tr_b16 a[138:139], v4 offset:10240
  ds_read_b64_tr_b16 a[140:141], v4 offset:12288
  ds_read_b64_tr_b16 a[142:143], v4 offset:14336
  ds_read_b64_tr_b16 a[152:153], v5 offset:8192
  ds_read_b64_tr_b16 a[154:155], v5 offset:10240
  ds_read_b64_tr_b16 a[156:157], v5 offset:12288
  ds_read_b64_tr_b16 a[158:159], v5 offset:14336
  ds_read_b64_tr_b16 a[168:169], v6 offset:8192
  ds_read_b64_tr_b16 a[170:171], v6 offset:10240
  ds_read_b64_tr_b16 a[172:173], v6 offset:12288
  ds_read_b64_tr_b16 a[174:175], v6 offset:14336
  ds_read_b64_tr_b16 a[184:185], v7 offset:8192
  ds_read_b64_tr_b16 a[186:187], v7 offset:10240
  ds_read_b64_tr_b16 a[188:189], v7 offset:12288
  ds_read_b64_tr_b16 a[190:191], v7 offset:14336
  s_waitcnt vmcnt(16) lgkmcnt(0)
  s_barrier
  s_add_u32 m0, s41, 8192
  s_add_u32 s42, s52, 2097152
  buffer_load_dwordx4 v12, s[8:11], s42 offen lds
  s_add_u32 m0, s41, 9216
  s_add_u32 s42, s52, 2162688
  buffer_load_dwordx4 v12, s[8:11], s42 offen lds
  s_add_u32 m0, s41, 10240
  s_add_u32 s42, s52, 2105344
  buffer_load_dwordx4 v12, s[8:11], s42 offen lds
  s_add_u32 m0, s41, 11264
  s_add_u32 s42, s52, 2170880
  buffer_load_dwordx4 v12, s[8:11], s42 offen lds
  s_add_u32 m0, s41, 12288
  s_add_u32 s42, s52, 2359296
  buffer_load_dwordx4 v12, s[8:11], s42 offen lds
  s_add_u32 m0, s41, 13312
  s_add_u32 s42, s52, 2424832
  buffer_load_dwordx4 v12, s[8:11], s42 offen lds
  s_add_u32 m0, s41, 14336
  s_add_u32 s42, s52, 2367488
  buffer_load_dwordx4 v12, s[8:11], s42 offen lds
  s_add_u32 m0, s41, 15360
  s_add_u32 s42, s52, 2433024
  buffer_load_dwordx4 v12, s[8:11], s42 offen lds
  ds_read_b64_tr_b16 a[192:193], v4 offset:16384
  ds_read_b64_tr_b16 a[194:195], v4 offset:18432
  ds_read_b64_tr_b16 a[196:197], v4 offset:20480
  ds_read_b64_tr_b16 a[198:199], v4 offset:22528
  ds_read_b64_tr_b16 a[208:209], v5 offset:16384
  ds_read_b64_tr_b16 a[210:211], v5 offset:18432
  ds_read_b64_tr_b16 a[212:213], v5 offset:20480
  ds_read_b64_tr_b16 a[214:215], v5 offset:22528
  ds_read_b64_tr_b16 a[224:225], v6 offset:16384
  ds_read_b64_tr_b16 a[226:227], v6 offset:18432
  ds_read_b64_tr_b16 a[228:229], v6 offset:20480
  ds_read_b64_tr_b16 a[230:231], v6 offset:22528
  ds_read_b64_tr_b16 a[240:241], v7 offset:16384
  ds_read_b64_tr_b16 a[242:243], v7 offset:18432
  ds_read_b64_tr_b16 a[244:245], v7 offset:20480
  ds_read_b64_tr_b16 a[246:247], v7 offset:22528
  s_waitcnt vmcnt(16) lgkmcnt(0)
  s_barrier
  s_add_u32 m0, s41, 16384
  s_add_u32 s42, s53, 4194304
  buffer_load_dwordx4 v12, s[8:11], s42 offen lds
  s_add_u32 m0, s41, 17408
  s_add_u32 s42, s53, 4259840
  buffer_load_dwordx4 v12, s[8:11], s42 offen lds
  s_add_u32 m0, s41, 18432
  s_add_u32 s42, s53, 4202496
  buffer_load_dwordx4 v12, s[8:11], s42 offen lds
  s_add_u32 m0, s41, 19456
  s_add_u32 s42, s53, 4268032
  buffer_load_dwordx4 v12, s[8:11], s42 offen lds
  s_add_u32 m0, s41, 20480
  s_add_u32 s42, s53, 4456448
  buffer_load_dwordx4 v12, s[8:11], s42 offen lds
  s_add_u32 m0, s41, 21504
  s_add_u32 s42, s53, 4521984
  buffer_load_dwordx4 v12, s[8:11], s42 offen lds
  s_add_u32 m0, s41, 22528
  s_add_u32 s42, s53, 4464640
  buffer_load_dwordx4 v12, s[8:11], s42 offen lds
  s_add_u32 m0, s41, 23552
  s_add_u32 s42, s53, 4530176
  buffer_load_dwordx4 v12, s[8:11], s42 offen lds
  ds_read_b64_tr_b16 a[200:201], v4 offset:24576
  ds_read_b64_tr_b16 a[202:203], v4 offset:26624
  ds_read_b64_tr_b16 a[204:205], v4 offset:28672
  ds_read_b64_tr_b16 a[206:207], v4 offset:30720
  ds_read_b64_tr_b16 a[216:217], v5 offset:24576
  ds_read_b64_tr_b16 a[218:219], v5 offset:26624
  ds_read_b64_tr_b16 a[220:221], v5 offset:28672
  ds_read_b64_tr_b16 a[222:223], v5 offset:30720
  ds_read_b64_tr_b16 a[232:233], v6 offset:24576
  ds_read_b64_tr_b16 a[234:235], v6 offset:26624
  ds_read_b64_tr_b16 a[236:237], v6 offset:28672
  ds_read_b64_tr_b16 a[238:239], v6 offset:30720
  ds_read_b64_tr_b16 a[248:249], v7 offset:24576
  ds_read_b64_tr_b16 a[250:251], v7 offset:26624
  ds_read_b64_tr_b16 a[252:253], v7 offset:28672
  ds_read_b64_tr_b16 a[254:255], v7 offset:30720
  s_waitcnt vmcnt(16) lgkmcnt(0)
  s_barrier
  s_add_u32 m0, s41, 24576
  s_add_u32 s42, s53, 6291456
  buffer_load_dwordx4 v12, s[8:11], s42 offen lds
  s_add_u32 m0, s41, 25600
  s_add_u32 s42, s53, 6356992
  buffer_load_dwordx4 v12, s[8:11], s42 offen lds
  s_add_u32 m0, s41, 26624
  s_add_u32 s42, s53, 6299648
  buffer_load_dwordx4 v12, s[8:11], s42 offen lds
  s_add_u32 m0, s41, 27648
  s_add_u32 s42, s53, 6365184
  buffer_load_dwordx4 v12, s[8:11], s42 offen lds
  s_add_u32 m0, s41, 28672
  s_add_u32 s42, s53, 6553600
  buffer_load_dwordx4 v12, s[8:11], s42 offen lds
  s_add_u32 m0, s41, 29696
  s_add_u32 s42, s53, 6619136
  buffer_load_dwordx4 v12, s[8:11], s42 offen lds
  s_add_u32 m0, s41, 30720
  s_add_u32 s42, s53, 6561792
  buffer_load_dwordx4 v12, s[8:11], s42 offen lds
  s_add_u32 m0, s41, 31744
  s_add_u32 s42, s53, 6627328
  buffer_load_dwordx4 v12, s[8:11], s42 offen lds
  ds_read_b64_tr_b16 v[20:21], v4 offset:0
  ds_read_b64_tr_b16 v[22:23], v4 offset:2048
  ds_read_b64_tr_b16 v[24:25], v4 offset:4096
  ds_read_b64_tr_b16 v[26:27], v4 offset:6144
  ds_read_b64_tr_b16 v[28:29], v5 offset:0
  ds_read_b64_tr_b16 v[30:31], v5 offset:2048
  ds_read_b64_tr_b16 v[32:33], v5 offset:4096
  ds_read_b64_tr_b16 v[34:35], v5 offset:6144
  ds_read_b64_tr_b16 v[36:37], v6 offset:0
  ds_read_b64_tr_b16 v[38:39], v6 offset:2048
  ds_read_b64_tr_b16 v[40:41], v6 offset:4096
  ds_read_b64_tr_b16 v[42:43], v6 offset:6144
  ds_read_b64_tr_b16 v[44:45], v7 offset:0
  ds_read_b64_tr_b16 v[46:47], v7 offset:2048
  ds_read_b64_tr_b16 v[48:49], v7 offset:4096
  ds_read_b64_tr_b16 v[50:51], v7 offset:6144
  s_waitcnt lgkmcnt(0)
  s_barrier
  ds_write_b128 v85, v[20:23] offset:0
  ds_write_b128 v85, v[24:27] offset:1024
  ds_write_b128 v85, v[28:31] offset:2048
  ds_write_b128 v85, v[32:35] offset:3072
  ds_write_b128 v85, v[36:39] offset:4096
  ds_write_b128 v85, v[40:43] offset:5120
  ds_write_b128 v85, v[44:47] offset:6144
  ds_write_b128 v85, v[48:51] offset:7168
  s_waitcnt vmcnt(16) lgkmcnt(0)
  s_barrier
  ds_read_b64_tr_b16 v[20:21], v4 offset:8192
  ds_read_b64_tr_b16 v[22:23], v4 offset:10240
  ds_read_b64_tr_b16 v[24:25], v4 offset:12288
  ds_read_b64_tr_b16 v[26:27], v4 offset:14336
  ds_read_b64_tr_b16 v[28:29], v5 offset:8192
  ds_read_b64_tr_b16 v[30:31], v5 offset:10240
  ds_read_b64_tr_b16 v[32:33], v5 offset:12288
  ds_read_b64_tr_b16 v[34:35], v5 offset:14336
  ds_read_b64_tr_b16 v[36:37], v6 offset:8192
  ds_read_b64_tr_b16 v[38:39], v6 offset:10240
  ds_read_b64_tr_b16 v[40:41], v6 offset:12288
  ds_read_b64_tr_b16 v[42:43], v6 offset:14336
  ds_read_b64_tr_b16 v[44:45], v7 offset:8192
  ds_read_b64_tr_b16 v[46:47], v7 offset:10240
  ds_read_b64_tr_b16 v[48:49], v7 offset:12288
  ds_read_b64_tr_b16 v[50:51], v7 offset:14336
  s_waitcnt lgkmcnt(0)
  s_barrier
  ds_write_b128 v85, v[20:23] offset:8192
  ds_write_b128 v85, v[24:27] offset:9216
  ds_write_b128 v85, v[28:31] offset:10240
  ds_write_b128 v85, v[32:35] offset:11264
  ds_write_b128 v85, v[36:39] offset:12288
  ds_write_b128 v85, v[40:43] offset:13312
  ds_write_b128 v85, v[44:47] offset:14336
  ds_write_b128 v85, v[48:51] offset:15360
  s_waitcnt vmcnt(8) lgkmcnt(0)
  s_barrier
  ds_read_b64_tr_b16 v[20:21], v4 offset:16384
  ds_read_b64_tr_b16 v[22:23], v4 offset:18432
  ds_read_b64_tr_b16 v[24:25], v4 offset:20480
  ds_read_b64_tr_b16 v[26:27], v4 offset:22528
  ds_read_b64_tr_b16 v[28:29], v5 offset:16384
  ds_read_b64_tr_b16 v[30:31], v5 offset:18432
  ds_read_b64_tr_b16 v[32:33], v5 offset:20480
  ds_read_b64_tr_b16 v[34:35], v5 offset:22528
  ds_read_b64_tr_b16 v[36:37], v6 offset:16384
  ds_read_b64_tr_b16 v[38:39], v6 offset:18432
  ds_read_b64_tr_b16 v[40:41], v6 offset:20480
  ds_read_b64_tr_b16 v[42:43], v6 offset:22528
  ds_read_b64_tr_b16 v[44:45], v7 offset:16384
  ds_read_b64_tr_b16 v[46:47], v7 offset:18432
  ds_read_b64_tr_b16 v[48:49], v7 offset:20480
  ds_read_b64_tr_b16 v[50:51], v7 offset:22528
  s_waitcnt lgkmcnt(0)
  s_barrier
  ds_write_b128 v85, v[20:23] offset:16384
  ds_write_b128 v85, v[24:27] offset:17408
  ds_write_b128 v85, v[28:31] offset:18432
  ds_write_b128 v85, v[32:35] offset:19456
  ds_write_b128 v85, v[36:39] offset:20480
  ds_write_b128 v85, v[40:43] offset:21504
  ds_write_b128 v85, v[44:47] offset:22528
  ds_write_b128 v85, v[48:51] offset:23552
  s_waitcnt vmcnt(0) lgkmcnt(0)
  s_barrier
  ds_read_b64_tr_b16 v[20:21], v4 offset:24576
  ds_read_b64_tr_b16 v[22:23], v4 offset:26624
  ds_read_b64_tr_b16 v[24:25], v4 offset:28672
  ds_read_b64_tr_b16 v[26:27], v4 offset:30720
  ds_read_b64_tr_b16 v[28:29], v5 offset:24576
  ds_read_b64_tr_b16 v[30:31], v5 offset:26624
  ds_read_b64_tr_b16 v[32:33], v5 offset:28672
  ds_read_b64_tr_b16 v[34:35], v5 offset:30720
  ds_read_b64_tr_b16 v[36:37], v6 offset:24576
  ds_read_b64_tr_b16 v[38:39], v6 offset:26624
  ds_read_b64_tr_b16 v[40:41], v6 offset:28672
  ds_read_b64_tr_b16 v[42:43], v6 offset:30720
  ds_read_b64_tr_b16 v[44:45], v7 offset:24576
  ds_read_b64_tr_b16 v[46:47], v7 offset:26624
  ds_read_b64_tr_b16 v[48:49], v7 offset:28672
  ds_read_b64_tr_b16 v[50:51], v7 offset:30720
  s_waitcnt lgkmcnt(0)
  s_barrier
  ds_write_b128 v85, v[20:23] offset:24576
  ds_write_b128 v85, v[24:27] offset:25600
  ds_write_b128 v85, v[28:31] offset:26624
  ds_write_b128 v85, v[32:35] offset:27648
  ds_write_b128 v85, v[36:39] offset:28672
  ds_write_b128 v85, v[40:43] offset:29696
  ds_write_b128 v85, v[44:47] offset:30720
  ds_write_b128 v85, v[48:51] offset:31744
  s_waitcnt lgkmcnt(0)
  s_getreg_b32 s55, hwreg(HW_REG_XCC_ID)
  s_and_b32 s55, s55, 15
  v_min_u32 v76, 63, v0
  v_lshlrev_b32 v76, 7, v76
  v_add_u32 v76, 1424384, v76
  s_nop 1
Lpoll_163:
  buffer_load_dword v77, v76, s[4:7], 0 offen sc1
  s_sub_u32 s24, s24, 1
  s_cbranch_scc1 L_FAIL
  s_waitcnt vmcnt(0)
  v_cmp_gt_i32 vcc, 0, v77
  s_cbranch_vccz Lpolld_164
  s_sleep 1
  s_branch Lpoll_163
Lpolld_164:
  v_and_b32 v78, 15, v77
  v_cmp_ne_u32 vcc, s55, v78
  s_lshl_b32 s40, s54, 4
  s_lshl_b32 s40, 0xffff, s40
  s_or_b32 s41, vcc_lo, vcc_hi
  s_and_b32 s40, s40, s41
  s_cselect_b32 s36, 0, 8192
  v_lshrrev_b32 v77, 8, v77
  v_and_b32 v78, 3, v0
  v_lshl_or_b32 v77, v77, 2, v78
  s_nop 1
  v_min_u32_dpp v77, v77, v77 row_ror:8 row_mask:0xf bank_mask:0xf
  s_nop 1
  v_min_u32_dpp v77, v77, v77 row_ror:4 row_mask:0xf bank_mask:0xf
  v_mov_b32 v78, v77
  s_nop 1
  v_permlane16_swap_b32 v78, v77
  v_min_u32 v77, v77, v78
  v_mov_b32 v78, v77
  s_nop 1
  v_permlane32_swap_b32 v78, v77
  v_min_u32 v77, v77, v78
  s_nop 1
  v_min_u32_dpp v77, v77, v77 row_ror:2 row_mask:0xf bank_mask:0xf
  s_nop 1
  v_min_u32_dpp v77, v77, v77 row_ror:1 row_mask:0xf bank_mask:0xf
  s_nop 0
  v_readfirstlane_b32 s26, v77
  s_and_b32 s26, s26, 3
  s_lshl_b32 s26, s26, 13
  s_lshr_b32 s40, s20, 1
  s_mul_i32 s40, s40, 32768
  s_and_b32 s41, s20, 1
  s_lshl_b32 s41, s41, 10
  s_add_u32 s40, s40, s41
  s_lshl_b32 s41, s54, 12
  s_add_u32 s40, s40, s41
  v_lshl_add_u32 v86, v0, 4, s40
  v_xor_b32 v87, 0x1000, v86
  v_and_b32 v76, 2, v0
  v_cmp_eq_u32 vcc, 0, v76
  v_mov_b32 v76, 0xeeee
  v_mov_b32 v77, 0x4444
  v_cndmask_b32 v88, v76, v77, vcc
  s_lshr_b32 s40, s21, 2
  s_mul_i32 s40, s40, 32768
  s_and_b32 s41, s21, 3
  s_lshl_b32 s41, s41, 11
  s_add_u32 s47, s40, s41
  s_lshl_b32 s41, s20, 9
  s_add_u32 s47, s47, s41
  v_lshl_add_u32 v92, v0, 3, s47
  s_lshl_b32 s41, s54, 12
  s_add_u32 s40, s41, 1310720
  s_add_u32 s40, s40, s26
  v_lshrrev_b32 v76, 2, v0
  v_lshl_add_u32 v76, v76, 7, s40
  v_and_b32 v77, 3, v0
  v_lshl_add_u32 v90, v77, 2, v76
  s_mov_b32 s57, s40
  s_cmp_eq_u32 s36, 0
  s_cselect_b32 s56, 1, s20
  s_and_b32 s41, s21, 15
  s_lshl_b32 s41, s41, 7
  s_lshl_b32 s40, s20, 2
  s_add_u32 s40, s40, s41
  s_add_u32 s40, s40, 2048
  s_mov_b32 s25, 0
  s_mov_b32 s60, 0
  s_mov_b32 s61, 0
  s_mov_b32 s51, -1
  v_mov_b32 v91, 2147483392
  s_mov_b64 exec, 1
  v_mov_b32 v91, s40
  s_mov_b64 exec, -1
  v_mov_b32 v80, -1
  v_mov_b32 v81, -1
  v_mov_b32 v82, -1
  v_mov_b32 v83, -1
  v_mov_b32 v112, 0
  v_mov_b32 v113, 0
  v_mov_b32 v114, 0
  v_mov_b32 v115, 0
  v_mov_b32 v116, 0
  v_mov_b32 v117, 0
  v_mov_b32 v118, 0
  v_mov_b32 v119, 0
  v_mov_b32 v120, 0
  v_mov_b32 v121, 0
  v_mov_b32 v106, 0
  v_mov_b32 v107, 0
  v_mov_b32 v108, 0x3f803f80
  v_mov_b32 v109, 0x3f803f80
  v_mov_b32 v110, 0x3f803f80
  v_mov_b32 v111, 0x3f803f80
  v_lshlrev_b32 v95, 4, v0
  s_lshl_b32 s58, s20, 12
  s_add_u32 s40, s58, 149504
  s_add_u32 s58, s58, 131072
  v_lshrrev_b32 v76, 4, v0
  v_bfe_u32 v77, v0, 2, 2
  v_xor_b32 v77, v76, v77
  v_lshl_add_u32 v123, v77, 3, s40
  v_and_b32 v77, 15, v0
  v_lshl_add_u32 v123, v77, 5, v123
  v_xor_b32 v76, v76, v0
  v_lshl_add_u32 v124, v76, 3, s40
  v_bfe_u32 v76, v0, 4, 1
  v_lshlrev_b32 v76, 1, v76
  v_and_b32 v77, 13, v0
  v_or_b32 v76, v76, v77
  v_lshl_add_u32 v122, v76, 4, s47
  v_lshrrev_b32 v76, 5, v0
  v_lshl_add_u32 v122, v76, 8, v122
  v_and_b32 v76, 2, v0
  v_cmp_eq_u32 vcc, 0, v76
  v_mov_b32 v77, 2147483392
  s_nop 0
  v_cndmask_b32 v122, v122, v77, vcc
  s_lshl_b32 s43, s21, 2
  s_add_u32 s43, s43, s20
  s_and_b32 s49, s20, 1
  s_lshl_b32 s49, s49, 10
  s_mul_i32 s32, s21, 65536
  s_lshl_b32 s40, s20, 11
  s_add_u32 s32, s32, s40
  s_and_b32 s40, s26, 0x2000
  s_xor_b32 s40, s40, 20971520
  s_add_u32 s32, s32, s40
  s_add_u32 s30, s32, s49
  s_add_u32 s30, s30, 49152
  s_lshr_b32 s59, s21, 1
  s_lshl_b32 s59, s59, 7
  s_add_u32 s59, s59, 1396736
  s_lshl_b32 s62, s21, 7
  s_add_u32 s62, s62, 1404928
  s_mov_b32 s38, 0x3e0293ee
  s_mov_b32 s39, s38
  v_xor_b32 v125, 4096, v124
  v_xor_b32 v126, 8192, v124
  v_xor_b32 v127, 12288, v124
  v_readfirstlane_b32 s88, v86
  s_xor_b32 s41, s47, 131072
  v_min_u32 v76, 3, v0
  v_lshl_add_u32 v87, v76, 7, s41
  v_lshrrev_b32 v76, 4, v0
  v_lshlrev_b32 v76, 2, v76
  v_and_b32 v77, 15, v0
  v_sub_u32 v76, v77, v76
  s_lshr_b32 s41, s49, 6
  v_add_u32 v76, s41, v76
  v_and_b32 v92, 0xfffffdff, v92
  v_mov_b32 v86, 0xd028965f
  v_cmp_le_i32 s[8:9], 0, v76
  v_cmp_le_i32 s[10:11], 1, v76
  v_cmp_le_i32 s[16:17], 2, v76
  v_cmp_le_i32 s[18:19], 3, v76
  v_cmp_le_i32 s[42:43], 16, v76
  v_cmp_le_i32 s[100:101], 17, v76
  v_cmp_le_i32 s[52:53], 18, v76
  v_cmp_le_i32 s[54:55], 19, v76
  s_xor_b32 s89, s88, 1024
  s_xor_b32 s90, s88, 32768
  s_xor_b32 s91, s88, 33792
  v_lshrrev_b32 v76, 4, v0
  v_lshl_add_u32 v76, v76, 7, s57
  v_and_b32 v77, 15, v0
  v_lshl_add_u32 v90, v77, 2, v76
  s_mov_b32 s25, 0
  s_add_u32 s27, s25, 32
  s_and_b32 s40, s27, 0x28
  s_mul_i32 s40, s40, 0x900
  s_and_b32 s40, s40, 0x6000
  s_xor_b32 s40, s40, s26
  s_lshl_b32 s27, s27, 16
  s_add_u32 s27, s27, s40
  s_lshl_b32 s37, s36, 1
  s_xor_b32 s37, s27, s37
  s_and_b32 s40, s25, 3
  s_lshl_b32 s40, s40, 18
  s_add_u32 s28, s40, s26
  s_lshr_b32 s40, s40, 5
  s_and_b32 s40, s40, 0x4000
  s_xor_b32 s28, s28, s40
  s_xor_b32 s29, s28, 0x4000
  s_xor_b32 s40, s28, 8192
  buffer_load_dword v89, v122, s[4:7], s40 offen sc1
  s_mov_b32 s25, 1
  s_add_u32 s27, s25, 32
  s_and_b32 s40, s27, 0x28
  s_mul_i32 s40, s40, 0x900
  s_and_b32 s40, s40, 0x6000
  s_xor_b32 s40, s40, s26
  s_lshl_b32 s27, s27, 16
  s_add_u32 s27, s27, s40
  s_lshl_b32 s37, s36, 1
  s_xor_b32 s37, s27, s37
  s_and_b32 s40, s25, 3
  s_lshl_b32 s40, s40, 18
  s_add_u32 s28, s40, s26
  s_lshr_b32 s40, s40, 5
  s_and_b32 s40, s40, 0x4000
  s_xor_b32 s28, s28, s40
  s_xor_b32 s29, s28, 0x4000
  s_xor_b32 s40, s28, 8192
  buffer_load_dword v89, v122, s[4:7], s40 offen sc1
  s_mov_b32 s25, 2
  s_add_u32 s27, s25, 32
  s_and_b32 s40, s27, 0x28
  s_mul_i32 s40, s40, 0x900
  s_and_b32 s40, s40, 0x6000
  s_xor_b32 s40, s40, s26
  s_lshl_b32 s27, s27, 16
  s_add_u32 s27, s27, s40
  s_lshl_b32 s37, s36, 1
  s_xor_b32 s37, s27, s37
  s_and_b32 s40, s25, 3
  s_lshl_b32 s40, s40, 18
  s_add_u32 s28, s40, s26
  s_lshr_b32 s40, s40, 5
  s_and_b32 s40, s40, 0x4000
  s_xor_b32 s28, s28, s40
  s_xor_b32 s29, s28, 0x4000
  s_xor_b32 s40, s28, 8192
  buffer_load_dword v89, v122, s[4:7], s40 offen sc1
  s_mov_b32 s25, 3
  s_add_u32 s27, s25, 32
  s_and_b32 s40, s27, 0x28
  s_mul_i32 s40, s40, 0x900
  s_and_b32 s40, s40, 0x6000
  s_xor_b32 s40, s40, s26
  s_lshl_b32 s27, s27, 16
  s_add_u32 s27, s27, s40
  s_lshl_b32 s37, s36, 1
  s_xor_b32 s37, s27, s37
  s_and_b32 s40, s25, 3
  s_lshl_b32 s40, s40, 18
  s_add_u32 s28, s40, s26
  s_lshr_b32 s40, s40, 5
  s_and_b32 s40, s40, 0x4000
  s_xor_b32 s28, s28, s40
  s_xor_b32 s29, s28, 0x4000
  s_xor_b32 s40, s28, 8192
  buffer_load_dword v89, v122, s[4:7], s40 offen sc1
  buffer_load_dword v89, v90, s[4:7], 0 offen offset:0 sc1
  s_mov_b32 s25, 0
  s_mov_b32 s33, 1
  s_mov_b64 s[44:45], 0
  s_mov_b64 s[46:47], 0
  s_cmp_lg_u32 s20, 1
  s_cbranch_scc1 Lskip_167
Lask_165:
  s_min_i32 s50, s44, s45
  s_min_i32 s50, s50, s46
  s_min_i32 s50, s50, s47
  s_cmp_ge_i32 s50, s33
  s_cbranch_scc1 Lhave_166
  s_load_dwordx4 s[44:47], s[4:5], s59 glc
  s_sub_u32 s24, s24, 1
  s_cbranch_scc1 L_FAIL
  s_waitcnt lgkmcnt(0)
  s_branch Lask_165
Lhave_166:
  s_add_u32 s33, s33, 2
  s_min_u32 s33, s33, 64
  s_cmp_ge_i32 s50, s33
  s_cbranch_scc1 Lskip_167
  s_load_dwordx4 s[44:47], s[4:5], s59 glc
Lskip_167:
  s_barrier
  s_add_u32 m0, s58, 16384
  s_add_u32 s31, s32, 16384
  buffer_load_dwordx4 v95, s[4:7], s31 offen offset:0 sc1 lds
  buffer_load_dwordx4 v95, s[4:7], s31 offen offset:1024 sc1 lds
  s_add_u32 m0, s58, 2048
  s_add_u32 s31, s32, 32768
  buffer_load_dwordx4 v95, s[4:7], s31 offen offset:0 sc1 lds
  buffer_load_dwordx4 v95, s[4:7], s31 offen offset:1024 sc1 lds
  s_mov_b32 m0, s58
  s_add_u32 s31, s32, s49
  buffer_load_dwordx4 v95, s[4:7], s31 offen offset:0 sc1 lds
  s_sub_u32 s31, s32, s49
  buffer_load_dwordx4 v95, s[4:7], s31 offen offset:1024 sc1 lds
  s_add_u32 s27, s25, 32
  s_and_b32 s40, s27, 0x28
  s_mul_i32 s40, s40, 0x900
  s_and_b32 s40, s40, 0x6000
  s_xor_b32 s40, s40, s26
  s_lshl_b32 s27, s27, 16
  s_add_u32 s27, s27, s40
  s_lshl_b32 s37, s36, 1
  s_xor_b32 s37, s27, s37
  s_and_b32 s40, s25, 3
  s_lshl_b32 s40, s40, 18
  s_add_u32 s28, s40, s26
  s_lshr_b32 s40, s40, 5
  s_and_b32 s40, s40, 0x4000
  s_xor_b32 s28, s28, s40
  s_xor_b32 s29, s28, 0x4000
  s_xor_b32 s34, s28, 0x84000
  s_xor_b32 s48, s28, 8192
  s_lshr_b32 s40, s49, 1
  s_add_u32 s29, s29, s40
  s_xor_b32 s35, s29, 512
  s_add_u32 s92, s37, s88
  s_add_u32 s96, s27, s88
  s_xor_b32 s96, s96, 0x1000
  s_add_u32 s93, s37, s89
  s_add_u32 s97, s27, s89
  s_xor_b32 s97, s97, 0x1000
  s_add_u32 s94, s37, s90
  s_add_u32 s98, s27, s90
  s_xor_b32 s98, s98, 0x1000
  s_add_u32 s95, s37, s91
  s_add_u32 s99, s27, s91
  s_xor_b32 s99, s99, 0x1000
L_QK_top:
  v_mov_b32_e64 v94, s25
  v_mov_b64 v[52:53], 0
  v_mov_b64 v[54:55], 0
  v_mov_b64 v[56:57], 0
  v_mov_b64 v[58:59], 0
  v_mov_b64 v[60:61], 0
  v_mov_b64 v[62:63], 0
  v_mov_b64 v[64:65], 0
  v_mov_b64 v[66:67], 0
  ds_read_b128 v[20:23], v85 offset:0
  ds_read_b128 v[24:27], v85 offset:1024
  ds_read_b128 v[28:31], v85 offset:8192
  ds_read_b128 v[32:35], v85 offset:9216
  ds_read_b128 v[36:39], v85 offset:2048
  ds_read_b128 v[40:43], v85 offset:3072
  ds_read_b128 v[44:47], v85 offset:10240
  ds_read_b128 v[48:51], v85 offset:11264
  s_waitcnt lgkmcnt(0)
  s_and_b32 s40, s25, 63
  s_cselect_b32 s40, s56, 1
  s_cmp_lg_u32 s40, 0
  s_cbranch_scc1 L_QK_park
  v_mov_b32 v76, -1
  s_sleep 4
  s_nop 0
  s_nop 0
L_QK_spin:
  s_sub_u32 s24, s24, 1
  s_nop 0
  s_nop 0
  s_cbranch_scc1 L_FAIL
  s_nop 0
  s_waitcnt vmcnt(40)
  buffer_load_dword v76, v90, s[4:7], 0 offen sc1
  s_nop 3
  v_cmp_gt_i32_e64 vcc, s25, v76
  s_cbranch_vccz L_QK_rel
  buffer_load_dword v76, v90, s[4:7], 0 offen sc1
  s_nop 3
  v_cmp_gt_i32 vcc, s25, v76
  s_cbranch_vccz L_QK_rel
  buffer_load_dword v76, v90, s[4:7], 0 offen sc1
  s_nop 3
  v_cmp_gt_i32 vcc, s25, v76
  s_cbranch_vccz L_QK_rel
  buffer_load_dword v76, v90, s[4:7], 0 offen sc1
  s_nop 3
  v_cmp_gt_i32_e64 vcc, s25, v76
  s_cbranch_vccnz L_QK_spin
L_QK_rel:
  s_barrier
  s_mov_b64 exec, -1
L_QK_go:
L_QKM_again:
  buffer_load_dwordx4 v[4:7], v95, s[4:7], s92 offen offset:0
  s_nop 0
  buffer_load_dwordx4 v[8:11], v95, s[4:7], s92 offen offset:2048
  s_nop 0
  buffer_load_dwordx4 v[12:15], v95, s[4:7], s93 offen offset:0
  s_nop 0
  buffer_load_dwordx4 v[16:19], v95, s[4:7], s93 offen offset:2048
  s_nop 0
  buffer_load_dwordx4 v[68:71], v95, s[4:7], s94 offen offset:0
  s_nop 0
  ds_read_b128 v[96:99], v1 offset:2048
  ds_read_b128 v[100:103], v1 offset:3072
  s_cmp_lg_u32 s20, 0
  s_nop 0
  s_cbranch_scc1 L_QK_sigd
  s_mov_b32 s63, s25
  s_waitcnt vmcnt(5)
  s_atomic_smax s63, s[4:5], s62 glc
L_QK_sigd:
  s_waitcnt vmcnt(4)
  v_cmp_eq_u32_e64 vcc, -1, v4
  s_cbranch_vccnz L_QKM_g0
L_QKM_ok0:
  v_smfmac_f32_16x16x64_bf16 v[52:55], v[4:7], a[0:7], v88
  buffer_load_dwordx4 v[72:75], v95, s[4:7], s94 offen offset:2048
  v_smfmac_f32_16x16x64_bf16 v[60:63], v[4:7], v[128:135], v88
  s_waitcnt vmcnt(4)
  v_cmp_eq_u32 vcc, -1, v8
  v_smfmac_f32_16x16x64_bf16 v[56:59], v[4:7], a[128:135], v88
  v_smfmac_f32_16x16x64_bf16 v[64:67], v[4:7], v[20:27], v88
  s_cbranch_vccnz L_QKM_g1
L_QKM_ok1:
  v_smfmac_f32_16x16x64_bf16 v[52:55], v[8:11], a[8:15], v88
  buffer_load_dwordx4 v[4:7], v95, s[4:7], s95 offen offset:0
  ds_read_b128 v[20:23], v85 offset:4096
  v_smfmac_f32_16x16x64_bf16 v[60:63], v[8:11], v[136:143], v88
  s_nop 0
  s_waitcnt vmcnt(4)
  v_cmp_eq_u32_e64 vcc, -1, v12
  v_smfmac_f32_16x16x64_bf16 v[56:59], v[8:11], a[136:143], v88
  ds_read_b128 v[24:27], v85 offset:5120
  v_smfmac_f32_16x16x64_bf16 v[64:67], v[8:11], v[28:35], v88
  s_cbranch_vccnz L_QKM_g2
L_QKM_ok2:
  v_smfmac_f32_16x16x64_bf16 v[52:55], v[12:15], a[16:23], v88
  buffer_load_dwordx4 v[8:11], v95, s[4:7], s95 offen offset:2048
  ds_read_b128 v[28:31], v85 offset:12288
  v_smfmac_f32_16x16x64_bf16 v[60:63], v[12:15], v[144:151], v88
  s_waitcnt vmcnt(4)
  v_cmp_eq_u32 vcc, -1, v16
  v_smfmac_f32_16x16x64_bf16 v[56:59], v[12:15], a[144:151], v88
  ds_read_b128 v[32:35], v85 offset:13312
  v_smfmac_f32_16x16x64_bf16 v[64:67], v[12:15], v[36:43], v88
  s_cbranch_vccnz L_QKM_g3
L_QKM_ok3:
  v_smfmac_f32_16x16x64_bf16 v[52:55], v[16:19], a[24:31], v88
  buffer_load_dwordx4 v[12:15], v95, s[4:7], s96 offen offset:0
  ds_read_b128 v[36:39], v85 offset:6144
  v_smfmac_f32_16x16x64_bf16 v[60:63], v[16:19], v[152:159], v88
  s_waitcnt vmcnt(4)
  v_cmp_eq_u32 vcc, -1, v68
  v_smfmac_f32_16x16x64_bf16 v[56:59], v[16:19], a[152:159], v88
  ds_read_b128 v[40:43], v85 offset:7168
  v_smfmac_f32_16x16x64_bf16 v[64:67], v[16:19], v[44:51], v88
  s_cbranch_vccnz L_QKM_g4
L_QKM_ok4:
  v_smfmac_f32_16x16x64_bf16 v[52:55], v[68:71], a[32:39], v88
  buffer_load_dwordx4 v[16:19], v95, s[4:7], s96 offen offset:2048
  ds_read_b128 v[44:47], v85 offset:14336
  v_smfmac_f32_16x16x64_bf16 v[60:63], v[68:71], v[160:167], v88
  s_waitcnt vmcnt(4)
  v_cmp_eq_u32 vcc, -1, v72
  v_smfmac_f32_16x16x64_bf16 v[56:59], v[68:71], a[160:167], v88
  ds_read_b128 v[48:51], v85 offset:15360
  s_waitcnt lgkmcnt(6)
  v_smfmac_f32_16x16x64_bf16 v[64:67], v[68:71], v[20:27], v88
  s_cbranch_vccnz L_QKM_g5
L_QKM_ok5:
  v_smfmac_f32_16x16x64_bf16 v[52:55], v[72:75], a[40:47], v88
  buffer_load_dwordx4 v[68:71], v95, s[4:7], s97 offen offset:0
  ds_read_b128 v[20:23], v85 offset:16384
  v_smfmac_f32_16x16x64_bf16 v[60:63], v[72:75], v[168:175], v88
  s_waitcnt vmcnt(4)
  v_cmp_eq_u32_e64 vcc, -1, v4
  v_smfmac_f32_16x16x64_bf16 v[56:59], v[72:75], a[168:175], v88
  ds_read_b128 v[24:27], v85 offset:17408
  s_nop 0
  s_waitcnt lgkmcnt(6)
  v_smfmac_f32_16x16x64_bf16 v[64:67], v[72:75], v[28:35], v88
  s_cbranch_vccnz L_QKM_g6
L_QKM_ok6:
  v_smfmac_f32_16x16x64_bf16 v[52:55], v[4:7], a[48:55], v88
  buffer_load_dwordx4 v[72:75], v95, s[4:7], s97 offen offset:2048
  ds_read_b128 v[28:31], v85 offset:24576
  v_smfmac_f32_16x16x64_bf16 v[60:63], v[4:7], v[176:183], v88
  s_waitcnt vmcnt(4)
  v_cmp_eq_u32 vcc, -1, v8
  v_smfmac_f32_16x16x64_bf16 v[56:59], v[4:7], a[176:183], v88
  ds_read_b128 v[32:35], v85 offset:25600
  s_waitcnt lgkmcnt(6)
  v_smfmac_f32_16x16x64_bf16 v[64:67], v[4:7], v[36:43], v88
  s_cbranch_vccnz L_QKM_g7
L_QKM_ok7:
  v_smfmac_f32_16x16x64_bf16 v[52:55], v[8:11], a[56:63], v88
  buffer_load_dwordx4 v[4:7], v95, s[4:7], s98 offen offset:0
  ds_read_b128 v[36:39], v85 offset:18432
  v_smfmac_f32_16x16x64_bf16 v[60:63], v[8:11], v[184:191], v88
  s_waitcnt vmcnt(4)
  v_cmp_eq_u32 vcc, -1, v12
  v_smfmac_f32_16x16x64_bf16 v[56:59], v[8:11], a[184:191], v88
  ds_read_b128 v[40:43], v85 offset:19456
  s_waitcnt lgkmcnt(6)
  v_smfmac_f32_16x16x64_bf16 v[64:67], v[8:11], v[44:51], v88
  s_cbranch_vccnz L_QKM_g8
L_QKM_ok8:
  v_smfmac_f32_16x16x64_bf16 v[52:55], v[12:15], a[64:71], v88
  buffer_load_dwordx4 v[8:11], v95, s[4:7], s98 offen offset:2048
  ds_read_b128 v[44:47], v85 offset:26624
  v_smfmac_f32_16x16x64_bf16 v[60:63], v[12:15], v[192:199], v88
  s_waitcnt vmcnt(4)
  v_cmp_eq_u32_e64 vcc, -1, v16
  v_smfmac_f32_16x16x64_bf16 v[56:59], v[12:15], a[192:199], v88
  ds_read_b128 v[48:51], v85 offset:27648
  s_nop 0
  s_waitcnt lgkmcnt(6)
  v_smfmac_f32_16x16x64_bf16 v[64:67], v[12:15], v[20:27], v88
  s_cbranch_vccnz L_QKM_g9
L_QKM_ok9:
  v_smfmac_f32_16x16x64_bf16 v[52:55], v[16:19], a[72:79], v88
  buffer_load_dwordx4 v[12:15], v95, s[4:7], s99 offen offset:0
  ds_read_b128 v[20:23], v85 offset:20480
  v_smfmac_f32_16x16x64_bf16 v[60:63], v[16:19], v[200:207], v88
  s_waitcnt vmcnt(4)
  v_cmp_eq_u32 vcc, -1, v68
  v_smfmac_f32_16x16x64_bf16 v[56:59], v[16:19], a[200:207], v88
  ds_read_b128 v[24:27], v85 offset:21504
  s_waitcnt lgkmcnt(6)
  v_smfmac_f32_16x16x64_bf16 v[64:67], v[16:19], v[28:35], v88
  s_cbranch_vccnz L_QKM_g10
L_QKM_ok10:
  v_smfmac_f32_16x16x64_bf16 v[52:55], v[68:71], a[80:87], v88
  buffer_load_dwordx4 v[16:19], v95, s[4:7], s99 offen offset:2048
  ds_read_b128 v[28:31], v85 offset:28672
  v_smfmac_f32_16x16x64_bf16 v[60:63], v[68:71], v[208:215], v88
  s_waitcnt vmcnt(4)
  v_cmp_eq_u32 vcc, -1, v72
  v_smfmac_f32_16x16x64_bf16 v[56:59], v[68:71], a[208:215], v88
  ds_read_b128 v[32:35], v85 offset:29696
  s_waitcnt lgkmcnt(6)
  v_smfmac_f32_16x16x64_bf16 v[64:67], v[68:71], v[36:43], v88
  s_cbranch_vccnz L_QKM_g11
L_QKM_ok11:
  v_smfmac_f32_16x16x64_bf16 v[52:55], v[72:75], a[88:95], v88
  ds_read_b128 v[36:39], v85 offset:22528
  v_smfmac_f32_16x16x64_bf16 v[60:63], v[72:75], v[216:223], v88
  s_waitcnt vmcnt(3)
  v_cmp_eq_u32 vcc, -1, v4
  v_smfmac_f32_16x16x64_bf16 v[56:59], v[72:75], a[216:223], v88
  ds_read_b128 v[40:43], v85 offset:23552
  s_waitcnt lgkmcnt(6)
  v_smfmac_f32_16x16x64_bf16 v[64:67], v[72:75], v[44:51], v88
  s_cbranch_vccnz L_QKM_g12
L_QKM_ok12:
  v_smfmac_f32_16x16x64_bf16 v[52:55], v[4:7], a[96:103], v88
  ds_read_b128 v[44:47], v85 offset:30720
  v_smfmac_f32_16x16x64_bf16 v[60:63], v[4:7], v[224:231], v88
  s_waitcnt vmcnt(2)
  v_cmp_eq_u32 vcc, -1, v8
  v_smfmac_f32_16x16x64_bf16 v[56:59], v[4:7], a[224:231], v88
  ds_read_b128 v[48:51], v85 offset:31744
  s_waitcnt lgkmcnt(6)
  v_smfmac_f32_16x16x64_bf16 v[64:67], v[4:7], v[20:27], v88
  s_cbranch_vccnz L_QKM_g13
L_QKM_ok13:
  v_smfmac_f32_16x16x64_bf16 v[52:55], v[8:11], a[104:111], v88
  ds_read_b128 v[20:23], v1 offset:16384
  ds_read_b128 v[24:27], v1 offset:17408
  v_smfmac_f32_16x16x64_bf16 v[60:63], v[8:11], v[232:239], v88
  s_waitcnt vmcnt(1)
  v_cmp_eq_u32_e64 vcc, -1, v12
  v_smfmac_f32_16x16x64_bf16 v[56:59], v[8:11], a[232:239], v88
  ds_read_b128 v[68:71], v84 offset:16384
  s_nop 0
  s_waitcnt lgkmcnt(7)
  v_smfmac_f32_16x16x64_bf16 v[64:67], v[8:11], v[28:35], v88
  s_cbranch_vccnz L_QKM_g14
L_QKM_ok14:
  v_smfmac_f32_16x16x64_bf16 v[52:55], v[12:15], a[112:119], v88
  ds_read_b128 v[28:31], v2 offset:16384
  ds_read_b128 v[32:35], v2 offset:17408
  v_smfmac_f32_16x16x64_bf16 v[60:63], v[12:15], v[240:247], v88
  s_waitcnt vmcnt(0)
  v_cmp_eq_u32 vcc, -1, v16
  v_smfmac_f32_16x16x64_bf16 v[56:59], v[12:15], a[240:247], v88
  ds_read_b128 v[72:75], v84 offset:17408
  s_waitcnt lgkmcnt(8)
  v_smfmac_f32_16x16x64_bf16 v[64:67], v[12:15], v[36:43], v88
  s_cbranch_vccnz L_QKM_g15
L_QKM_ok15:
  v_smfmac_f32_16x16x64_bf16 v[52:55], v[16:19], a[120:127], v88
  ds_read_b128 v[36:39], v3 offset:16384
  v_smfmac_f32_16x16x64_bf16 v[60:63], v[16:19], v[248:255], v88
  ds_read_b128 v[40:43], v3 offset:17408
  v_smfmac_f32_16x16x64_bf16 v[56:59], v[16:19], a[248:255], v88
  s_waitcnt lgkmcnt(8)
  v_smfmac_f32_16x16x64_bf16 v[64:67], v[16:19], v[44:51], v88
L_QKM_join:
  s_nop 1
  v_pk_add_f32 v[52:53], v[52:53], v[54:55]
  s_nop 0
  v_pk_add_f32 v[60:61], v[60:61], v[62:63]
  v_cmp_u_f32 vcc, v52, v53
  v_cvt_pk_bf16_f32 v77, v52, v53
  v_cvt_pk_bf16_f32 v76, v60, v61
  ds_write_b64 v123, v[76:77] offset:0
  v_pk_add_f32 v[56:57], v[56:57], v[58:59]
  v_pk_add_f32 v[64:65], v[64:65], v[66:67]
  v_cvt_pk_bf16_f32 v79, v56, v57
  v_cvt_pk_bf16_f32 v78, v64, v65
  ds_write_b64 v123, v[78:79] offset:512
  ds_read_b64_tr_b16 v[4:5], v124 offset:0
  ds_read_b64_tr_b16 v[6:7], v124 offset:512
  s_cbranch_vccnz L_QKM_nan
L_QKM_done:
  s_waitcnt lgkmcnt(2)
  s_barrier
  ds_read_b64_tr_b16 v[8:9], v125 offset:0
  ds_read_b64_tr_b16 v[10:11], v125 offset:512
  s_waitcnt lgkmcnt(2)
  v_mfma_f32_16x16x32_bf16 v[52:55], v[20:23], v[4:7], 0
  ds_read_b64_tr_b16 v[12:13], v126 offset:0
  ds_read_b64_tr_b16 v[14:15], v126 offset:512
  v_mfma_f32_16x16x32_bf16 v[56:59], v[24:27], v[4:7], 0
  ds_read_b64_tr_b16 v[16:17], v127 offset:0
  ds_read_b64_tr_b16 v[18:19], v127 offset:512
  v_mfma_f32_16x16x32_bf16 v[60:63], v[4:7], v[4:7], 0
  s_waitcnt lgkmcnt(4)
  v_mfma_f32_16x16x32_bf16 v[52:55], v[28:31], v[8:11], v[52:55]
  v_mfma_f32_16x16x32_bf16 v[56:59], v[32:35], v[8:11], v[56:59]
  v_mfma_f32_16x16x32_bf16 v[60:63], v[8:11], v[8:11], v[60:63]
  s_waitcnt lgkmcnt(2)
  v_mfma_f32_16x16x32_bf16 v[52:55], v[36:39], v[12:15], v[52:55]
  v_mfma_f32_16x16x32_bf16 v[56:59], v[40:43], v[12:15], v[56:59]
  v_mfma_f32_16x16x32_bf16 v[60:63], v[12:15], v[12:15], v[60:63]
  s_waitcnt lgkmcnt(0)
  v_mfma_f32_16x16x32_bf16 v[52:55], v[68:71], v[16:19], v[52:55]
  buffer_load_dwordx2 v[104:105], v92, s[4:7], s29 offen sc1
  v_mfma_f32_16x16x32_bf16 v[56:59], v[72:75], v[16:19], v[56:59]
  v_mfma_f32_16x16x32_bf16 v[60:63], v[16:19], v[16:19], v[60:63]
  s_mov_b32 vcc_lo, 0xcccccccc
  s_mov_b32 vcc_hi, 0xcccccccc
  v_mov_b32 v79, s38
  s_nop 1
  v_max3_f32 v64, v52, v53, v54
  s_nop 0
  v_max3_f32 v65, v55, v56, v57
  v_max3_f32 v64, v64, v58, v59
  v_max3_f32 v65, v65, v60, v61
  v_max_f32 v66, v64, v65
  v_max_f32 v67, v64, v65
  v_cndmask_b32_dpp v60, v61, v60, vcc quad_perm:[2,3,2,3] row_mask:0xf bank_mask:0xf
  v_cndmask_b32_dpp v52, v56, v52, vcc quad_perm:[2,3,2,3] row_mask:0xf bank_mask:0xf
  v_permlane16_swap_b32 v66, v67
  v_max_f32 v64, v66, v67
  v_max_f32 v65, v66, v67
  v_cndmask_b32_dpp v53, v57, v53, vcc quad_perm:[2,3,2,3] row_mask:0xf bank_mask:0xf
  v_cndmask_b32_dpp v54, v58, v54, vcc quad_perm:[2,3,2,3] row_mask:0xf bank_mask:0xf
  v_permlane32_swap_b32 v64, v65
  v_max_f32 v64, v64, v65
  v_cndmask_b32_dpp v55, v59, v55, vcc quad_perm:[2,3,2,3] row_mask:0xf bank_mask:0xf
  s_nop 0
  v_mul_f32_dpp v64, v64, v79 quad_perm:[2,3,2,3] row_mask:0xf bank_mask:0xf
  v_pk_fma_f32 v[52:53], v[52:53], s[38:39], v[64:65] op_sel_hi:[1,1,0] neg_lo:[0,0,1] neg_hi:[0,0,1]
  v_pk_fma_f32 v[54:55], v[54:55], s[38:39], v[64:65] op_sel_hi:[1,1,0] neg_lo:[0,0,1] neg_hi:[0,0,1]
  v_exp_f32 v52, v52
  v_exp_f32 v53, v53
  v_exp_f32 v54, v54
  v_cvt_pk_bf16_f32 v76, v52, v53
  v_exp_f32 v55, v55
  v_fma_f32 v60, v60, s38, -v64
  v_cvt_pk_bf16_f32 v77, v54, v55
  v_mov_b32_dpp v78, v76 quad_perm:[0,1,0,1] row_mask:0xf bank_mask:0xf
  v_exp_f32 v60, v60
  v_mov_b32_dpp v79, v77 quad_perm:[0,1,0,1] row_mask:0xf bank_mask:0xf
  s_nop 0
  v_mov_b32_dpp v61, v60 quad_perm:[0,1,0,1] row_mask:0xf bank_mask:0xf
  v_mfma_f32_16x16x32_bf16 v[64:67], v[108:111], v[76:79], 0
  v_cvt_pk_bf16_f32 v114, v60, v61
  v_cvt_pk_bf16_f32 v119, v60, v61
  s_waitcnt vmcnt(0)
  v_mfma_f32_16x16x32_bf16 v[44:47], v[96:99], v[76:79], 0
  v_max_u32 v89, v104, v105
  v_cmp_eq_u32 vcc, -1, v89
  v_mfma_f32_16x16x32_bf16 v[64:67], v[108:111], v[114:117], v[64:67]
  v_mfma_f32_16x16x32_bf16 v[48:51], v[100:103], v[76:79], 0
  s_cbranch_vccnz L_QK_vbad0
L_QK_vok0:
  buffer_store_dword v94, v91, s[4:7], s57 offen
  v_mfma_f32_16x16x32_bf16 v[44:47], v[104:107], v[114:117], v[44:47]
  v_mfma_f32_16x16x32_bf16 v[48:51], v[104:107], v[118:121], v[48:51]
  s_nop 2
  v_rcp_f32_e64 v64, v64
  s_nop 2
  v_pk_mul_f32 v[44:45], v[44:45], v[64:65] op_sel_hi:[1,0]
  v_pk_mul_f32 v[46:47], v[46:47], v[64:65] op_sel_hi:[1,0]
  v_pk_mul_f32 v[48:49], v[48:49], v[64:65] op_sel_hi:[1,0]
  v_pk_mul_f32 v[50:51], v[50:51], v[64:65] op_sel_hi:[1,0]
  v_cvt_pk_bf16_f32 v52, v44, v45
  v_cvt_pk_bf16_f32 v53, v46, v47
  v_cvt_pk_bf16_f32 v54, v48, v49
  v_cvt_pk_bf16_f32 v55, v50, v51
  buffer_store_dwordx4 v[52:55], v122, s[4:7], s48 offen
  ds_read_b128 v[44:47], v1 offset:0
  ds_read_b128 v[48:51], v2 offset:1024
  s_add_u32 s32, s32, 2097152
  s_xor_b32 s32, s32, 0x2000
  s_add_u32 s33, s25, 2
  s_min_u32 s33, s33, 64
  s_waitcnt lgkmcnt(0)
  buffer_load_dwordx2 v[106:107], v92, s[4:7], s35 offen sc1
  buffer_store_dwordx4 v[52:55], v122, s[4:7], s28 offen sc1
  v_mfma_f32_16x16x32_bf16 v[56:59], v[20:23], v[44:47], 0
  v_mfma_f32_16x16x32_bf16 v[60:63], v[24:27], v[44:47], 0
  v_mfma_f32_16x16x32_bf16 v[64:67], v[4:7], v[44:47], 0
  ds_read_b128 v[20:23], v3 offset:0
  ds_read_b128 v[24:27], v2 offset:2048
  v_mfma_f32_16x16x32_bf16 v[56:59], v[28:31], v[48:51], v[56:59]
  v_mfma_f32_16x16x32_bf16 v[60:63], v[32:35], v[48:51], v[60:63]
  v_mfma_f32_16x16x32_bf16 v[64:67], v[8:11], v[48:51], v[64:67]
  ds_read_b128 v[28:31], v84 offset:1024
  ds_read_b128 v[32:35], v2 offset:3072
  s_waitcnt lgkmcnt(3)
  v_mfma_f32_16x16x32_bf16 v[56:59], v[36:39], v[20:23], v[56:59]
  v_mfma_f32_16x16x32_bf16 v[60:63], v[40:43], v[20:23], v[60:63]
  v_mfma_f32_16x16x32_bf16 v[64:67], v[12:15], v[20:23], v[64:67]
  s_nop 0
  s_waitcnt lgkmcnt(0)
  v_mfma_f32_16x16x32_bf16 v[56:59], v[68:71], v[28:31], v[56:59]
  v_mfma_f32_16x16x32_bf16 v[60:63], v[72:75], v[28:31], v[60:63]
  v_mfma_f32_16x16x32_bf16 v[64:67], v[16:19], v[28:31], v[64:67]
  s_cmp_lg_u32 s20, 1
  s_cbranch_scc1 Lskip_170
Lask_168:
  s_min_i32 s50, s44, s45
  s_min_i32 s50, s50, s46
  s_min_i32 s50, s50, s47
  s_cmp_ge_i32 s50, s33
  s_cbranch_scc1 Lhave_169
  s_load_dwordx4 s[44:47], s[4:5], s59 glc
  s_sub_u32 s24, s24, 1
  s_cbranch_scc1 L_FAIL
  s_waitcnt lgkmcnt(0)
  s_branch Lask_168
Lhave_169:
  s_add_u32 s33, s33, 2
  s_min_u32 s33, s33, 64
  s_cmp_ge_i32 s50, s33
  s_nop 0
  s_cbranch_scc1 Lskip_170
  s_load_dwordx4 s[44:47], s[4:5], s59 glc
Lskip_170:
  s_barrier
  v_cndmask_b32 v56, v86, v56, s[8:9]
  v_cndmask_b32 v57, v86, v57, s[10:11]
  v_cndmask_b32 v58, v86, v58, s[16:17]
  v_cndmask_b32 v59, v86, v59, s[18:19]
  v_cndmask_b32 v60, v86, v60, s[42:43]
  v_cndmask_b32 v61, v86, v61, s[100:101]
  buffer_load_dword v77, v87, s[4:7], s28 offen sc1
  v_cndmask_b32 v62, v86, v62, s[52:53]
  v_cndmask_b32 v63, v86, v63, s[54:55]
  s_add_u32 m0, s58, 16384
  s_add_u32 s31, s32, 16384
  buffer_load_dwordx4 v95, s[4:7], s31 offen offset:0 sc1 lds
  v_max3_f32 v72, v56, v57, v58
  v_max3_f32 v73, v59, v60, v61
  buffer_load_dwordx4 v95, s[4:7], s31 offen offset:1024 sc1 lds
  v_max3_f32 v72, v72, v62, v63
  v_max3_f32 v73, v73, v64, v65
  s_add_u32 m0, s58, 2048
  s_add_u32 s31, s32, 32768
  buffer_load_dwordx4 v95, s[4:7], s31 offen offset:0 sc1 lds
  v_max_f32 v74, v72, v73
  v_max_f32 v75, v72, v73
  buffer_load_dwordx4 v95, s[4:7], s31 offen offset:1024 sc1 lds
  s_nop 0
  v_permlane16_swap_b32 v74, v75
  v_max_f32 v72, v74, v75
  s_mov_b32 m0, s58
  s_add_u32 s31, s32, s49
  buffer_load_dwordx4 v95, s[4:7], s31 offen offset:0 sc1 lds
  v_max_f32 v73, v74, v75
  s_nop 1
  v_permlane32_swap_b32 v72, v73
  s_sub_u32 s31, s32, s49
  buffer_load_dwordx4 v95, s[4:7], s31 offen offset:1024 sc1 lds
  v_max_f32 v72, v72, v73
  v_mul_f32 v72, s38, v72
  buffer_store_dwordx4 v[80:83], v122, s[4:7], s34 offen sc1
  v_pk_fma_f32 v[56:57], v[56:57], s[38:39], v[72:73] op_sel_hi:[1,1,0] neg_lo:[0,0,1] neg_hi:[0,0,1]
  v_pk_fma_f32 v[58:59], v[58:59], s[38:39], v[72:73] op_sel_hi:[1,1,0] neg_lo:[0,0,1] neg_hi:[0,0,1]
  s_xor_b32 s40, s34, 8192
  buffer_store_dwordx4 v[80:83], v122, s[4:7], s40 offen
  v_pk_fma_f32 v[60:61], v[60:61], s[38:39], v[72:73] op_sel_hi:[1,1,0] neg_lo:[0,0,1] neg_hi:[0,0,1]
  v_pk_fma_f32 v[62:63], v[62:63], s[38:39], v[72:73] op_sel_hi:[1,1,0] neg_lo:[0,0,1] neg_hi:[0,0,1]
  v_pk_fma_f32 v[64:65], v[64:65], s[38:39], v[72:73] op_sel_hi:[1,1,0] neg_lo:[0,0,1] neg_hi:[0,0,1]
  v_exp_f32 v56, v56
  v_exp_f32 v57, v57
  v_exp_f32 v58, v58
  v_exp_f32 v59, v59
  v_exp_f32 v60, v60
  v_exp_f32 v61, v61
  v_exp_f32 v62, v62
  v_exp_f32 v63, v63
  v_exp_f32 v64, v64
  v_exp_f32 v65, v65
  s_waitcnt vmcnt(10)
  v_max_u32 v89, v106, v107
  v_cmp_eq_u32 vcc, -1, v89
  v_cvt_pk_bf16_f32 v36, v56, v57
  v_cvt_pk_bf16_f32 v37, v58, v59
  v_cvt_pk_bf16_f32 v38, v60, v61
  v_cvt_pk_bf16_f32 v39, v62, v63
  v_cvt_pk_bf16_f32 v114, v64, v65
  v_cvt_pk_bf16_f32 v119, v64, v65
  s_cbranch_vccnz L_QK_vbad1
L_QK_vok1:
  s_add_u32 s25, s25, 1
  s_xor_b32 s41, s30, 2048
  v_mfma_f32_16x16x32_bf16 v[40:43], v[108:111], v[36:39], 0
  s_add_u32 s27, s25, 32
  s_and_b32 s40, s27, 0x28
  s_mul_i32 s40, s40, 0x900
  v_mfma_f32_16x16x32_bf16 v[52:55], v[96:99], v[36:39], 0
  s_and_b32 s40, s40, 0x6000
  s_xor_b32 s40, s40, s26
  s_lshl_b32 s27, s27, 16
  v_mfma_f32_16x16x32_bf16 v[56:59], v[100:103], v[36:39], 0
  s_add_u32 s27, s27, s40
  s_lshl_b32 s37, s36, 1
  s_xor_b32 s37, s27, s37
  v_mfma_f32_16x16x32_bf16 v[60:63], v[24:27], v[36:39], 0
  s_and_b32 s40, s25, 3
  s_lshl_b32 s40, s40, 18
  s_add_u32 s28, s40, s26
  v_mfma_f32_16x16x32_bf16 v[64:67], v[32:35], v[36:39], 0
  s_lshr_b32 s40, s40, 5
  s_and_b32 s40, s40, 0x4000
  s_xor_b32 s28, s28, s40
  v_mfma_f32_16x16x32_bf16 v[40:43], v[108:111], v[114:117], v[40:43]
  s_xor_b32 s29, s28, 0x4000
  s_xor_b32 s34, s28, 0x84000
  s_xor_b32 s48, s28, 8192
  v_mfma_f32_16x16x32_bf16 v[52:55], v[104:107], v[114:117], v[52:55]
  s_lshr_b32 s40, s49, 1
  s_add_u32 s29, s29, s40
  s_xor_b32 s35, s29, 512
  v_mfma_f32_16x16x32_bf16 v[56:59], v[104:107], v[118:121], v[56:59]
  s_add_u32 s92, s37, s88
  s_add_u32 s96, s27, s88
  s_xor_b32 s96, s96, 0x1000
  v_mfma_f32_16x16x32_bf16 v[60:63], v[104:107], v[112:115], v[60:63]
  s_add_u32 s93, s37, s89
  s_add_u32 s97, s27, s89
  s_xor_b32 s97, s97, 0x1000
  v_mfma_f32_16x16x32_bf16 v[64:67], v[104:107], v[116:119], v[64:67]
  s_add_u32 s94, s37, s90
  s_add_u32 s98, s27, s90
  s_xor_b32 s98, s98, 0x1000
  s_add_u32 s95, s37, s91
  s_add_u32 s99, s27, s91
  s_xor_b32 s99, s99, 0x1000
  v_rcp_f32 v40, v40
  s_nop 0
  v_pk_mul_f32 v[52:53], v[52:53], v[40:41] op_sel_hi:[1,0]
  v_pk_mul_f32 v[54:55], v[54:55], v[40:41] op_sel_hi:[1,0]
  v_pk_mul_f32 v[56:57], v[56:57], v[40:41] op_sel_hi:[1,0]
  v_pk_mul_f32 v[58:59], v[58:59], v[40:41] op_sel_hi:[1,0]
  v_cvt_pk_bf16_f32 v4, v52, v53
  v_cvt_pk_bf16_f32 v5, v54, v55
  v_cvt_pk_bf16_f32 v6, v56, v57
  v_cvt_pk_bf16_f32 v7, v58, v59
  buffer_store_dwordx4 v[4:7], v95, s[4:7], s30 offen sc1
  v_pk_mul_f32 v[60:61], v[60:61], v[40:41] op_sel_hi:[1,0]
  v_pk_mul_f32 v[62:63], v[62:63], v[40:41] op_sel_hi:[1,0]
  v_pk_mul_f32 v[64:65], v[64:65], v[40:41] op_sel_hi:[1,0]
  v_pk_mul_f32 v[66:67], v[66:67], v[40:41] op_sel_hi:[1,0]
  v_cvt_pk_bf16_f32 v8, v60, v61
  v_cvt_pk_bf16_f32 v9, v62, v63
  v_cvt_pk_bf16_f32 v10, v64, v65
  v_cvt_pk_bf16_f32 v11, v66, v67
  buffer_store_dwordx4 v[8:11], v95, s[4:7], s41 offen sc1
  s_add_u32 s30, s30, 2097152
  s_xor_b32 s30, s30, 0x2000
  s_branch L_QK_top
L_QK_park:
  s_waitcnt vmcnt(0)
  s_cmp_lt_u32 s25, 64
  s_cbranch_scc1 L_QK_rel
  s_barrier
  s_cmp_lg_u32 s20, 0
  s_cbranch_scc1 Lnosig_171
  s_mov_b32 s63, s25
  s_atomic_smax s63, s[4:5], s62 glc
Lnosig_171:
  s_branch L_END
L_QKM_nan:
  s_cmp_eq_u32 s51, s25
  s_cbranch_scc1 L_QKM_done
  s_mov_b32 s51, s25
  s_add_u32 s60, s60, 0x10000
  s_waitcnt vmcnt(0) lgkmcnt(0)
L_QKM_v0:
  s_sub_u32 s24, s24, 1
  s_cbranch_scc1 L_FAIL
  buffer_load_dwordx4 v[4:7], v95, s[4:7], s92 offen offset:0 sc1
  buffer_load_dwordx4 v[8:11], v95, s[4:7], s92 offen offset:2048 sc1
  buffer_load_dwordx4 v[12:15], v95, s[4:7], s93 offen offset:0 sc1
  buffer_load_dwordx4 v[16:19], v95, s[4:7], s93 offen offset:2048 sc1
  v_mov_b32 v89, 0
  s_waitcnt vmcnt(0)
  v_max3_u32 v89, v4, v5, v89
  v_max3_u32 v89, v6, v7, v89
  v_max3_u32 v89, v8, v9, v89
  v_max3_u32 v89, v10, v11, v89
  v_max3_u32 v89, v12, v13, v89
  v_max3_u32 v89, v14, v15, v89
  v_max3_u32 v89, v16, v17, v89
  v_max3_u32 v89, v18, v19, v89
  v_cmp_eq_u32 vcc, -1, v89
  s_cbranch_vccnz L_QKM_v0
L_QKM_v4:
  s_sub_u32 s24, s24, 1
  s_cbranch_scc1 L_FAIL
  buffer_load_dwordx4 v[68:71], v95, s[4:7], s94 offen offset:0 sc1
  buffer_load_dwordx4 v[72:75], v95, s[4:7], s94 offen offset:2048 sc1
  buffer_load_dwordx4 v[4:7], v95, s[4:7], s95 offen offset:0 sc1
  buffer_load_dwordx4 v[8:11], v95, s[4:7], s95 offen offset:2048 sc1
  v_mov_b32 v89, 0
  s_waitcnt vmcnt(0)
  v_max3_u32 v89, v68, v69, v89
  v_max3_u32 v89, v70, v71, v89
  v_max3_u32 v89, v72, v73, v89
  v_max3_u32 v89, v74, v75, v89
  v_max3_u32 v89, v4, v5, v89
  v_max3_u32 v89, v6, v7, v89
  v_max3_u32 v89, v8, v9, v89
  v_max3_u32 v89, v10, v11, v89
  v_cmp_eq_u32 vcc, -1, v89
  s_cbranch_vccnz L_QKM_v4
L_QKM_v8:
  s_sub_u32 s24, s24, 1
  s_cbranch_scc1 L_FAIL
  buffer_load_dwordx4 v[12:15], v95, s[4:7], s96 offen offset:0 sc1
  buffer_load_dwordx4 v[16:19], v95, s[4:7], s96 offen offset:2048 sc1
  buffer_load_dwordx4 v[68:71], v95, s[4:7], s97 offen offset:0 sc1
  buffer_load_dwordx4 v[72:75], v95, s[4:7], s97 offen offset:2048 sc1
  v_mov_b32 v89, 0
  s_waitcnt vmcnt(0)
  v_max3_u32 v89, v12, v13, v89
  v_max3_u32 v89, v14, v15, v89
  v_max3_u32 v89, v16, v17, v89
  v_max3_u32 v89, v18, v19, v89
  v_max3_u32 v89, v68, v69, v89
  v_max3_u32 v89, v70, v71, v89
  v_max3_u32 v89, v72, v73, v89
  v_max3_u32 v89, v74, v75, v89
  v_cmp_eq_u32 vcc, -1, v89
  s_cbranch_vccnz L_QKM_v8
L_QKM_v12:
  s_sub_u32 s24, s24, 1
  s_cbranch_scc1 L_FAIL
  buffer_load_dwordx4 v[4:7], v95, s[4:7], s98 offen offset:0 sc1
  buffer_load_dwordx4 v[8:11], v95, s[4:7], s98 offen offset:2048 sc1
  buffer_load_dwordx4 v[12:15], v95, s[4:7], s99 offen offset:0 sc1
  buffer_load_dwordx4 v[16:19], v95, s[4:7], s99 offen offset:2048 sc1
  v_mov_b32 v89, 0
  s_waitcnt vmcnt(0)
  v_max3_u32 v89, v4, v5, v89
  v_max3_u32 v89, v6, v7, v89
  v_max3_u32 v89, v8, v9, v89
  v_max3_u32 v89, v10, v11, v89
  v_max3_u32 v89, v12, v13, v89
  v_max3_u32 v89, v14, v15, v89
  v_max3_u32 v89, v16, v17, v89
  v_max3_u32 v89, v18, v19, v89
  v_cmp_eq_u32 vcc, -1, v89
  s_cbranch_vccnz L_QKM_v12
  v_mov_b64 v[52:53], 0
  v_mov_b64 v[54:55], 0
  v_mov_b64 v[56:57], 0
  v_mov_b64 v[58:59], 0
  v_mov_b64 v[60:61], 0
  v_mov_b64 v[62:63], 0
  v_mov_b64 v[64:65], 0
  v_mov_b64 v[66:67], 0
  ds_read_b128 v[20:23], v85 offset:0
  ds_read_b128 v[24:27], v85 offset:1024
  ds_read_b128 v[28:31], v85 offset:8192
  ds_read_b128 v[32:35], v85 offset:9216
  ds_read_b128 v[36:39], v85 offset:2048
  ds_read_b128 v[40:43], v85 offset:3072
  ds_read_b128 v[44:47], v85 offset:10240
  ds_read_b128 v[48:51], v85 offset:11264
  s_waitcnt lgkmcnt(0)
L_QKMS_again:
  buffer_load_dwordx4 v[4:7], v95, s[4:7], s92 offen offset:0 sc1
  s_nop 0
  buffer_load_dwordx4 v[8:11], v95, s[4:7], s92 offen offset:2048 sc1
  s_nop 0
  buffer_load_dwordx4 v[12:15], v95, s[4:7], s93 offen offset:0 sc1
  s_nop 0
  buffer_load_dwordx4 v[16:19], v95, s[4:7], s93 offen offset:2048 sc1
  s_nop 0
  buffer_load_dwordx4 v[68:71], v95, s[4:7], s94 offen offset:0 sc1
  s_nop 0
  s_waitcnt vmcnt(4)
  buffer_load_dwordx4 v[72:75], v95, s[4:7], s94 offen offset:2048 sc1
  v_smfmac_f32_16x16x64_bf16 v[52:55], v[4:7], a[0:7], v88
  v_smfmac_f32_16x16x64_bf16 v[60:63], v[4:7], v[128:135], v88
  s_waitcnt vmcnt(4)
  v_smfmac_f32_16x16x64_bf16 v[56:59], v[4:7], a[128:135], v88
  v_smfmac_f32_16x16x64_bf16 v[64:67], v[4:7], v[20:27], v88
  buffer_load_dwordx4 v[4:7], v95, s[4:7], s95 offen offset:0 sc1
  v_smfmac_f32_16x16x64_bf16 v[52:55], v[8:11], a[8:15], v88
  ds_read_b128 v[20:23], v85 offset:4096
  v_smfmac_f32_16x16x64_bf16 v[60:63], v[8:11], v[136:143], v88
  ds_read_b128 v[24:27], v85 offset:5120
  s_waitcnt vmcnt(4)
  v_smfmac_f32_16x16x64_bf16 v[56:59], v[8:11], a[136:143], v88
  v_smfmac_f32_16x16x64_bf16 v[64:67], v[8:11], v[28:35], v88
  buffer_load_dwordx4 v[8:11], v95, s[4:7], s95 offen offset:2048 sc1
  v_smfmac_f32_16x16x64_bf16 v[52:55], v[12:15], a[16:23], v88
  ds_read_b128 v[28:31], v85 offset:12288
  v_smfmac_f32_16x16x64_bf16 v[60:63], v[12:15], v[144:151], v88
  ds_read_b128 v[32:35], v85 offset:13312
  s_waitcnt vmcnt(4)
  v_smfmac_f32_16x16x64_bf16 v[56:59], v[12:15], a[144:151], v88
  v_smfmac_f32_16x16x64_bf16 v[64:67], v[12:15], v[36:43], v88
  buffer_load_dwordx4 v[12:15], v95, s[4:7], s96 offen offset:0 sc1
  v_smfmac_f32_16x16x64_bf16 v[52:55], v[16:19], a[24:31], v88
  ds_read_b128 v[36:39], v85 offset:6144
  v_smfmac_f32_16x16x64_bf16 v[60:63], v[16:19], v[152:159], v88
  ds_read_b128 v[40:43], v85 offset:7168
  s_waitcnt vmcnt(4)
  v_smfmac_f32_16x16x64_bf16 v[56:59], v[16:19], a[152:159], v88
  v_smfmac_f32_16x16x64_bf16 v[64:67], v[16:19], v[44:51], v88
  buffer_load_dwordx4 v[16:19], v95, s[4:7], s96 offen offset:2048 sc1
  v_smfmac_f32_16x16x64_bf16 v[52:55], v[68:71], a[32:39], v88
  ds_read_b128 v[44:47], v85 offset:14336
  v_smfmac_f32_16x16x64_bf16 v[60:63], v[68:71], v[160:167], v88
  ds_read_b128 v[48:51], v85 offset:15360
  s_waitcnt vmcnt(4)
  v_smfmac_f32_16x16x64_bf16 v[56:59], v[68:71], a[160:167], v88
  s_waitcnt lgkmcnt(6)
  v_smfmac_f32_16x16x64_bf16 v[64:67], v[68:71], v[20:27], v88
  buffer_load_dwordx4 v[68:71], v95, s[4:7], s97 offen offset:0 sc1
  v_smfmac_f32_16x16x64_bf16 v[52:55], v[72:75], a[40:47], v88
  ds_read_b128 v[20:23], v85 offset:16384
  v_smfmac_f32_16x16x64_bf16 v[60:63], v[72:75], v[168:175], v88
  ds_read_b128 v[24:27], v85 offset:17408
  s_waitcnt vmcnt(4)
  v_smfmac_f32_16x16x64_bf16 v[56:59], v[72:75], a[168:175], v88
  s_waitcnt lgkmcnt(6)
  v_smfmac_f32_16x16x64_bf16 v[64:67], v[72:75], v[28:35], v88
  buffer_load_dwordx4 v[72:75], v95, s[4:7], s97 offen offset:2048 sc1
  v_smfmac_f32_16x16x64_bf16 v[52:55], v[4:7], a[48:55], v88
  ds_read_b128 v[28:31], v85 offset:24576
  v_smfmac_f32_16x16x64_bf16 v[60:63], v[4:7], v[176:183], v88
  ds_read_b128 v[32:35], v85 offset:25600
  s_waitcnt vmcnt(4)
  v_smfmac_f32_16x16x64_bf16 v[56:59], v[4:7], a[176:183], v88
  s_waitcnt lgkmcnt(6)
  v_smfmac_f32_16x16x64_bf16 v[64:67], v[4:7], v[36:43], v88
  buffer_load_dwordx4 v[4:7], v95, s[4:7], s98 offen offset:0 sc1
  v_smfmac_f32_16x16x64_bf16 v[52:55], v[8:11], a[56:63], v88
  ds_read_b128 v[36:39], v85 offset:18432
  v_smfmac_f32_16x16x64_bf16 v[60:63], v[8:11], v[184:191], v88
  ds_read_b128 v[40:43], v85 offset:19456
  s_waitcnt vmcnt(4)
  v_smfmac_f32_16x16x64_bf16 v[56:59], v[8:11], a[184:191], v88
  s_waitcnt lgkmcnt(6)
  v_smfmac_f32_16x16x64_bf16 v[64:67], v[8:11], v[44:51], v88
  buffer_load_dwordx4 v[8:11], v95, s[4:7], s98 offen offset:2048 sc1
  v_smfmac_f32_16x16x64_bf16 v[52:55], v[12:15], a[64:71], v88
  ds_read_b128 v[44:47], v85 offset:26624
  v_smfmac_f32_16x16x64_bf16 v[60:63], v[12:15], v[192:199], v88
  ds_read_b128 v[48:51], v85 offset:27648
  s_waitcnt vmcnt(4)
  v_smfmac_f32_16x16x64_bf16 v[56:59], v[12:15], a[192:199], v88
  s_waitcnt lgkmcnt(6)
  v_smfmac_f32_16x16x64_bf16 v[64:67], v[12:15], v[20:27], v88
  buffer_load_dwordx4 v[12:15], v95, s[4:7], s99 offen offset:0 sc1
  v_smfmac_f32_16x16x64_bf16 v[52:55], v[16:19], a[72:79], v88
  ds_read_b128 v[20:23], v85 offset:20480
  v_smfmac_f32_16x16x64_bf16 v[60:63], v[16:19], v[200:207], v88
  ds_read_b128 v[24:27], v85 offset:21504
  s_waitcnt vmcnt(4)
  v_smfmac_f32_16x16x64_bf16 v[56:59], v[16:19], a[200:207], v88
  s_waitcnt lgkmcnt(6)
  v_smfmac_f32_16x16x64_bf16 v[64:67], v[16:19], v[28:35], v88
  buffer_load_dwordx4 v[16:19], v95, s[4:7], s99 offen offset:2048 sc1
  v_smfmac_f32_16x16x64_bf16 v[52:55], v[68:71], a[80:87], v88
  ds_read_b128 v[28:31], v85 offset:28672
  v_smfmac_f32_16x16x64_bf16 v[60:63], v[68:71], v[208:215], v88
  ds_read_b128 v[32:35], v85 offset:29696
  s_waitcnt vmcnt(4)
  v_smfmac_f32_16x16x64_bf16 v[56:59], v[68:71], a[208:215], v88
  s_waitcnt lgkmcnt(6)
  v_smfmac_f32_16x16x64_bf16 v[64:67], v[68:71], v[36:43], v88
  ds_read_b128 v[36:39], v85 offset:22528
  v_smfmac_f32_16x16x64_bf16 v[52:55], v[72:75], a[88:95], v88
  ds_read_b128 v[40:43], v85 offset:23552
  v_smfmac_f32_16x16x64_bf16 v[60:63], v[72:75], v[216:223], v88
  s_waitcnt vmcnt(3)
  v_smfmac_f32_16x16x64_bf16 v[56:59], v[72:75], a[216:223], v88
  s_waitcnt lgkmcnt(6)
  v_smfmac_f32_16x16x64_bf16 v[64:67], v[72:75], v[44:51], v88
  ds_read_b128 v[44:47], v85 offset:30720
  v_smfmac_f32_16x16x64_bf16 v[52:55], v[4:7], a[96:103], v88
  ds_read_b128 v[48:51], v85 offset:31744
  v_smfmac_f32_16x16x64_bf16 v[60:63], v[4:7], v[224:231], v88
  s_waitcnt vmcnt(2)
  v_smfmac_f32_16x16x64_bf16 v[56:59], v[4:7], a[224:231], v88
  s_waitcnt lgkmcnt(6)
  v_smfmac_f32_16x16x64_bf16 v[64:67], v[4:7], v[20:27], v88
  ds_read_b128 v[20:23], v1 offset:16384
  v_smfmac_f32_16x16x64_bf16 v[52:55], v[8:11], a[104:111], v88
  ds_read_b128 v[24:27], v1 offset:17408
  v_smfmac_f32_16x16x64_bf16 v[60:63], v[8:11], v[232:239], v88
  ds_read_b128 v[68:71], v84 offset:16384
  s_waitcnt vmcnt(1)
  v_smfmac_f32_16x16x64_bf16 v[56:59], v[8:11], a[232:239], v88
  s_waitcnt lgkmcnt(7)
  v_smfmac_f32_16x16x64_bf16 v[64:67], v[8:11], v[28:35], v88
  ds_read_b128 v[28:31], v2 offset:16384
  v_smfmac_f32_16x16x64_bf16 v[52:55], v[12:15], a[112:119], v88
  ds_read_b128 v[32:35], v2 offset:17408
  v_smfmac_f32_16x16x64_bf16 v[60:63], v[12:15], v[240:247], v88
  ds_read_b128 v[72:75], v84 offset:17408
  s_waitcnt vmcnt(0)
  v_smfmac_f32_16x16x64_bf16 v[56:59], v[12:15], a[240:247], v88
  s_waitcnt lgkmcnt(8)
  v_smfmac_f32_16x16x64_bf16 v[64:67], v[12:15], v[36:43], v88
  ds_read_b128 v[36:39], v3 offset:16384
  v_smfmac_f32_16x16x64_bf16 v[52:55], v[16:19], a[120:127], v88
  ds_read_b128 v[40:43], v3 offset:17408
  v_smfmac_f32_16x16x64_bf16 v[60:63], v[16:19], v[248:255], v88
  v_smfmac_f32_16x16x64_bf16 v[56:59], v[16:19], a[248:255], v88
  s_waitcnt lgkmcnt(8)
  v_smfmac_f32_16x16x64_bf16 v[64:67], v[16:19], v[44:51], v88
  s_nop 7
  s_branch L_QKM_join
L_QKM_g0:
  s_sub_u32 s24, s24, 1
  s_cbranch_scc1 L_FAIL
  s_add_u32 s60, s60, 1
  buffer_load_dwordx4 v[4:7], v95, s[4:7], s92 offen offset:0 sc1
  s_waitcnt vmcnt(0)
  v_cmp_eq_u32 vcc, -1, v4
  s_cbranch_vccnz L_QKM_g0
  v_mov_b32 v89, 0
  v_max3_u32 v89, v8, v12, v89
  v_max3_u32 v89, v16, v68, v89
  v_cmp_eq_u32 vcc, -1, v89
  s_cbranch_vccz L_QKM_ok0
  buffer_load_dwordx4 v[8:11], v95, s[4:7], s92 offen offset:2048 sc1
  s_nop 0
  buffer_load_dwordx4 v[12:15], v95, s[4:7], s93 offen offset:0 sc1
  s_nop 0
  buffer_load_dwordx4 v[16:19], v95, s[4:7], s93 offen offset:2048 sc1
  s_nop 0
  buffer_load_dwordx4 v[68:71], v95, s[4:7], s94 offen offset:0 sc1
  s_nop 0
  s_branch L_QKM_ok0
L_QKM_g1:
  s_sub_u32 s24, s24, 1
  s_cbranch_scc1 L_FAIL
  s_add_u32 s60, s60, 1
  buffer_load_dwordx4 v[8:11], v95, s[4:7], s92 offen offset:2048 sc1
  s_waitcnt vmcnt(0)
  v_cmp_eq_u32 vcc, -1, v8
  s_cbranch_vccnz L_QKM_g1
  v_mov_b32 v89, 0
  v_max3_u32 v89, v12, v16, v89
  v_max3_u32 v89, v68, v72, v89
  v_cmp_eq_u32 vcc, -1, v89
  s_cbranch_vccz L_QKM_ok1
  buffer_load_dwordx4 v[12:15], v95, s[4:7], s93 offen offset:0 sc1
  s_nop 0
  buffer_load_dwordx4 v[16:19], v95, s[4:7], s93 offen offset:2048 sc1
  s_nop 0
  buffer_load_dwordx4 v[68:71], v95, s[4:7], s94 offen offset:0 sc1
  s_nop 0
  buffer_load_dwordx4 v[72:75], v95, s[4:7], s94 offen offset:2048 sc1
  s_nop 0
  s_branch L_QKM_ok1
L_QKM_g2:
  s_sub_u32 s24, s24, 1
  s_cbranch_scc1 L_FAIL
  s_add_u32 s60, s60, 1
  buffer_load_dwordx4 v[12:15], v95, s[4:7], s93 offen offset:0 sc1
  s_waitcnt vmcnt(0)
  v_cmp_eq_u32 vcc, -1, v12
  s_cbranch_vccnz L_QKM_g2
  v_mov_b32 v89, 0
  v_max3_u32 v89, v16, v68, v89
  v_max3_u32 v89, v72, v4, v89
  v_cmp_eq_u32 vcc, -1, v89
  s_cbranch_vccz L_QKM_ok2
  buffer_load_dwordx4 v[16:19], v95, s[4:7], s93 offen offset:2048 sc1
  s_nop 0
  buffer_load_dwordx4 v[68:71], v95, s[4:7], s94 offen offset:0 sc1
  s_nop 0
  buffer_load_dwordx4 v[72:75], v95, s[4:7], s94 offen offset:2048 sc1
  s_nop 0
  buffer_load_dwordx4 v[4:7], v95, s[4:7], s95 offen offset:0 sc1
  s_nop 0
  s_branch L_QKM_ok2
L_QKM_g3:
  s_sub_u32 s24, s24, 1
  s_cbranch_scc1 L_FAIL
  s_add_u32 s60, s60, 1
  buffer_load_dwordx4 v[16:19], v95, s[4:7], s93 offen offset:2048 sc1
  s_waitcnt vmcnt(0)
  v_cmp_eq_u32 vcc, -1, v16
  s_cbranch_vccnz L_QKM_g3
  v_mov_b32 v89, 0
  v_max3_u32 v89, v68, v72, v89
  v_max3_u32 v89, v4, v8, v89
  v_cmp_eq_u32 vcc, -1, v89
  s_cbranch_vccz L_QKM_ok3
  buffer_load_dwordx4 v[68:71], v95, s[4:7], s94 offen offset:0 sc1
  s_nop 0
  buffer_load_dwordx4 v[72:75], v95, s[4:7], s94 offen offset:2048 sc1
  s_nop 0
  buffer_load_dwordx4 v[4:7], v95, s[4:7], s95 offen offset:0 sc1
  s_nop 0
  buffer_load_dwordx4 v[8:11], v95, s[4:7], s95 offen offset:2048 sc1
  s_nop 0
  s_branch L_QKM_ok3
L_QKM_g4:
  s_sub_u32 s24, s24, 1
  s_cbranch_scc1 L_FAIL
  s_add_u32 s60, s60, 1
  buffer_load_dwordx4 v[68:71], v95, s[4:7], s94 offen offset:0 sc1
  s_waitcnt vmcnt(0)
  v_cmp_eq_u32 vcc, -1, v68
  s_cbranch_vccnz L_QKM_g4
  v_mov_b32 v89, 0
  v_max3_u32 v89, v72, v4, v89
  v_max3_u32 v89, v8, v12, v89
  v_cmp_eq_u32 vcc, -1, v89
  s_cbranch_vccz L_QKM_ok4
  buffer_load_dwordx4 v[72:75], v95, s[4:7], s94 offen offset:2048 sc1
  s_nop 0
  buffer_load_dwordx4 v[4:7], v95, s[4:7], s95 offen offset:0 sc1
  s_nop 0
  buffer_load_dwordx4 v[8:11], v95, s[4:7], s95 offen offset:2048 sc1
  s_nop 0
  buffer_load_dwordx4 v[12:15], v95, s[4:7], s96 offen offset:0 sc1
  s_nop 0
  s_branch L_QKM_ok4
L_QKM_g5:
  s_sub_u32 s24, s24, 1
  s_cbranch_scc1 L_FAIL
  s_add_u32 s60, s60, 1
  buffer_load_dwordx4 v[72:75], v95, s[4:7], s94 offen offset:2048 sc1
  s_waitcnt vmcnt(0)
  v_cmp_eq_u32 vcc, -1, v72
  s_cbranch_vccnz L_QKM_g5
  v_mov_b32 v89, 0
  v_max3_u32 v89, v4, v8, v89
  v_max3_u32 v89, v12, v16, v89
  v_cmp_eq_u32 vcc, -1, v89
  s_cbranch_vccz L_QKM_ok5
  buffer_load_dwordx4 v[4:7], v95, s[4:7], s95 offen offset:0 sc1
  s_nop 0
  buffer_load_dwordx4 v[8:11], v95, s[4:7], s95 offen offset:2048 sc1
  s_nop 0
  buffer_load_dwordx4 v[12:15], v95, s[4:7], s96 offen offset:0 sc1
  s_nop 0
  buffer_load_dwordx4 v[16:19], v95, s[4:7], s96 offen offset:2048 sc1
  s_nop 0
  s_branch L_QKM_ok5
L_QKM_g6:
  s_sub_u32 s24, s24, 1
  s_cbranch_scc1 L_FAIL
  s_add_u32 s60, s60, 1
  buffer_load_dwordx4 v[4:7], v95, s[4:7], s95 offen offset:0 sc1
  s_waitcnt vmcnt(0)
  v_cmp_eq_u32 vcc, -1, v4
  s_cbranch_vccnz L_QKM_g6
  v_mov_b32 v89, 0
  v_max3_u32 v89, v8, v12, v89
  v_max3_u32 v89, v16, v68, v89
  v_cmp_eq_u32 vcc, -1, v89
  s_cbranch_vccz L_QKM_ok6
  buffer_load_dwordx4 v[8:11], v95, s[4:7], s95 offen offset:2048 sc1
  s_nop 0
  buffer_load_dwordx4 v[12:15], v95, s[4:7], s96 offen offset:0 sc1
  s_nop 0
  buffer_load_dwordx4 v[16:19], v95, s[4:7], s96 offen offset:2048 sc1
  s_nop 0
  buffer_load_dwordx4 v[68:71], v95, s[4:7], s97 offen offset:0 sc1
  s_nop 0
  s_branch L_QKM_ok6
L_QKM_g7:
  s_sub_u32 s24, s24, 1
  s_cbranch_scc1 L_FAIL
  s_add_u32 s60, s60, 1
  buffer_load_dwordx4 v[8:11], v95, s[4:7], s95 offen offset:2048 sc1
  s_waitcnt vmcnt(0)
  v_cmp_eq_u32 vcc, -1, v8
  s_cbranch_vccnz L_QKM_g7
  v_mov_b32 v89, 0
  v_max3_u32 v89, v12, v16, v89
  v_max3_u32 v89, v68, v72, v89
  v_cmp_eq_u32 vcc, -1, v89
  s_cbranch_vccz L_QKM_ok7
  buffer_load_dwordx4 v[12:15], v95, s[4:7], s96 offen offset:0 sc1
  s_nop 0
  buffer_load_dwordx4 v[16:19], v95, s[4:7], s96 offen offset:2048 sc1
  s_nop 0
  buffer_load_dwordx4 v[68:71], v95, s[4:7], s97 offen offset:0 sc1
  s_nop 0
  buffer_load_dwordx4 v[72:75], v95, s[4:7], s97 offen offset:2048 sc1
  s_nop 0
  s_branch L_QKM_ok7
L_QKM_g8:
  s_sub_u32 s24, s24, 1
  s_cbranch_scc1 L_FAIL
  s_add_u32 s60, s60, 256
  buffer_load_dwordx4 v[12:15], v95, s[4:7], s96 offen offset:0 sc1
  s_waitcnt vmcnt(0)
  v_cmp_eq_u32 vcc, -1, v12
  s_cbranch_vccnz L_QKM_g8
  v_mov_b32 v89, 0
  v_max3_u32 v89, v16, v68, v89
  v_max3_u32 v89, v72, v4, v89
  v_cmp_eq_u32 vcc, -1, v89
  s_cbranch_vccz L_QKM_ok8
  buffer_load_dwordx4 v[16:19], v95, s[4:7], s96 offen offset:2048 sc1
  s_nop 0
  buffer_load_dwordx4 v[68:71], v95, s[4:7], s97 offen offset:0 sc1
  s_nop 0
  buffer_load_dwordx4 v[72:75], v95, s[4:7], s97 offen offset:2048 sc1
  s_nop 0
  buffer_load_dwordx4 v[4:7], v95, s[4:7], s98 offen offset:0 sc1
  s_nop 0
  s_branch L_QKM_ok8
L_QKM_g9:
  s_sub_u32 s24, s24, 1
  s_cbranch_scc1 L_FAIL
  s_add_u32 s60, s60, 256
  buffer_load_dwordx4 v[16:19], v95, s[4:7], s96 offen offset:2048 sc1
  s_waitcnt vmcnt(0)
  v_cmp_eq_u32 vcc, -1, v16
  s_cbranch_vccnz L_QKM_g9
  v_mov_b32 v89, 0
  v_max3_u32 v89, v68, v72, v89
  v_max3_u32 v89, v4, v8, v89
  v_cmp_eq_u32 vcc, -1, v89
  s_cbranch_vccz L_QKM_ok9
  buffer_load_dwordx4 v[68:71], v95, s[4:7], s97 offen offset:0 sc1
  s_nop 0
  buffer_load_dwordx4 v[72:75], v95, s[4:7], s97 offen offset:2048 sc1
  s_nop 0
  buffer_load_dwordx4 v[4:7], v95, s[4:7], s98 offen offset:0 sc1
  s_nop 0
  buffer_load_dwordx4 v[8:11], v95, s[4:7], s98 offen offset:2048 sc1
  s_nop 0
  s_branch L_QKM_ok9
L_QKM_g10:
  s_sub_u32 s24, s24, 1
  s_cbranch_scc1 L_FAIL
  s_add_u32 s60, s60, 256
  buffer_load_dwordx4 v[68:71], v95, s[4:7], s97 offen offset:0 sc1
  s_waitcnt vmcnt(0)
  v_cmp_eq_u32 vcc, -1, v68
  s_cbranch_vccnz L_QKM_g10
  v_mov_b32 v89, 0
  v_max3_u32 v89, v72, v4, v89
  v_max3_u32 v89, v8, v12, v89
  v_cmp_eq_u32 vcc, -1, v89
  s_cbranch_vccz L_QKM_ok10
  buffer_load_dwordx4 v[72:75], v95, s[4:7], s97 offen offset:2048 sc1
  s_nop 0
  buffer_load_dwordx4 v[4:7], v95, s[4:7], s98 offen offset:0 sc1
  s_nop 0
  buffer_load_dwordx4 v[8:11], v95, s[4:7], s98 offen offset:2048 sc1
  s_nop 0
  buffer_load_dwordx4 v[12:15], v95, s[4:7], s99 offen offset:0 sc1
  s_nop 0
  s_branch L_QKM_ok10
L_QKM_g11:
  s_sub_u32 s24, s24, 1
  s_cbranch_scc1 L_FAIL
  s_add_u32 s60, s60, 256
  buffer_load_dwordx4 v[72:75], v95, s[4:7], s97 offen offset:2048 sc1
  s_waitcnt vmcnt(0)
  v_cmp_eq_u32 vcc, -1, v72
  s_cbranch_vccnz L_QKM_g11
  v_mov_b32 v89, 0
  v_max3_u32 v89, v4, v8, v89
  v_max3_u32 v89, v12, v16, v89
  v_cmp_eq_u32 vcc, -1, v89
  s_cbranch_vccz L_QKM_ok11
  buffer_load_dwordx4 v[4:7], v95, s[4:7], s98 offen offset:0 sc1
  s_nop 0
  buffer_load_dwordx4 v[8:11], v95, s[4:7], s98 offen offset:2048 sc1
  s_nop 0
  buffer_load_dwordx4 v[12:15], v95, s[4:7], s99 offen offset:0 sc1
  s_nop 0
  buffer_load_dwordx4 v[16:19], v95, s[4:7], s99 offen offset:2048 sc1
  s_nop 0
  s_branch L_QKM_ok11
L_QKM_g12:
  s_sub_u32 s24, s24, 1
  s_cbranch_scc1 L_FAIL
  s_add_u32 s60, s60, 256
  buffer_load_dwordx4 v[4:7], v95, s[4:7], s98 offen offset:0 sc1
  s_waitcnt vmcnt(0)
  v_cmp_eq_u32 vcc, -1, v4
  s_cbranch_vccnz L_QKM_g12
  v_mov_b32 v89, 0
  v_max3_u32 v89, v8, v12, v89
  v_max3_u32 v89, v16, v16, v89
  v_cmp_eq_u32 vcc, -1, v89
  s_cbranch_vccz L_QKM_ok12
  buffer_load_dwordx4 v[8:11], v95, s[4:7], s98 offen offset:2048 sc1
  s_nop 0
  buffer_load_dwordx4 v[12:15], v95, s[4:7], s99 offen offset:0 sc1
  s_nop 0
  buffer_load_dwordx4 v[16:19], v95, s[4:7], s99 offen offset:2048 sc1
  s_nop 0
  s_branch L_QKM_ok12
L_QKM_g13:
  s_sub_u32 s24, s24, 1
  s_cbranch_scc1 L_FAIL
  s_add_u32 s60, s60, 256
  buffer_load_dwordx4 v[8:11], v95, s[4:7], s98 offen offset:2048 sc1
  s_waitcnt vmcnt(0)
  v_cmp_eq_u32 vcc, -1, v8
  s_cbranch_vccnz L_QKM_g13
  v_mov_b32 v89, 0
  v_max3_u32 v89, v12, v16, v89
  v_cmp_eq_u32 vcc, -1, v89
  s_cbranch_vccz L_QKM_ok13
  buffer_load_dwordx4 v[12:15], v95, s[4:7], s99 offen offset:0 sc1
  s_nop 0
  buffer_load_dwordx4 v[16:19], v95, s[4:7], s99 offen offset:2048 sc1
  s_nop 0
  s_branch L_QKM_ok13
L_QKM_g14:
  s_sub_u32 s24, s24, 1
  s_cbranch_scc1 L_FAIL
  s_add_u32 s60, s60, 256
  buffer_load_dwordx4 v[12:15], v95, s[4:7], s99 offen offset:0 sc1
  s_waitcnt vmcnt(0)
  v_cmp_eq_u32 vcc, -1, v12
  s_cbranch_vccnz L_QKM_g14
  v_mov_b32 v89, 0
  v_max3_u32 v89, v16, v16, v89
  v_cmp_eq_u32 vcc, -1, v89
  s_cbranch_vccz L_QKM_ok14
  buffer_load_dwordx4 v[16:19], v95, s[4:7], s99 offen offset:2048 sc1
  s_nop 0
  s_branch L_QKM_ok14
L_QKM_g15:
  s_sub_u32 s24, s24, 1
  s_cbranch_scc1 L_FAIL
  s_add_u32 s60, s60, 256
  buffer_load_dwordx4 v[16:19], v95, s[4:7], s99 offen offset:2048 sc1
  s_waitcnt vmcnt(0)
  v_cmp_eq_u32 vcc, -1, v16
  s_cbranch_vccnz L_QKM_g15
  s_branch L_QKM_ok15
L_QK_vbad0:
  s_sub_u32 s24, s24, 1
  s_cbranch_scc1 L_FAIL
  s_add_u32 s61, s61, 1
  buffer_load_dwordx2 v[104:105], v92, s[4:7], s29 offen sc1
  s_waitcnt vmcnt(0)
  v_max_u32 v89, v104, v105
  v_cmp_eq_u32 vcc, -1, v89
  s_cbranch_vccnz L_QK_vbad0
  s_branch L_QK_vok0
L_QK_vbad1:
  s_sub_u32 s24, s24, 1
  s_cbranch_scc1 L_FAIL
  s_add_u32 s61, s61, 1
  buffer_load_dwordx2 v[106:107], v92, s[4:7], s35 offen sc1
  s_waitcnt vmcnt(0)
  v_max_u32 v89, v106, v107
  v_cmp_eq_u32 vcc, -1, v89
  s_cbranch_vccnz L_QK_vbad1
  s_branch L_QK_vok1
L_VO:
  v_bfe_u32 v76, v0, 3, 2
  v_xor_b32 v76, s20, v76
  v_lshlrev_b32 v76, 5, v76
  v_lshrrev_b32 v4, 2, v0
  v_lshl_add_u32 v4, v4, 7, v76
  v_and_b32 v76, 3, v0
  v_lshl_add_u32 v4, v76, 3, v4
  s_lshl_b32 s40, s20, 15
  v_add_u32 v4, s40, v4
  v_lshl_add_u32 v85, v0, 4, s40
  s_lshl_b32 s40, s20, 12
  s_add_u32 s40, s40, 131072
  v_lshl_add_u32 v1, v0, 4, s40
  s_lshr_b32 s54, s21, 4
  s_lshl_b32 s52, s54, 22
  s_sub_u32 s53, 0, s52
  v_xor_b32 v5, 32768, v4
  v_xor_b32 v2, 4096, v1
  v_xor_b32 v6, 65536, v4
  v_xor_b32 v3, 8192, v1
  v_xor_b32 v7, 98304, v4
  v_xor_b32 v84, 12288, v1
  v_bfe_u32 v8, v0, 5, 1
  v_mul_u32_u24 v8, 16384, v8
  v_bfe_u32 v76, v0, 4, 1
  v_mul_u32_u24 v76, 32768, v76
  v_add_u32 v8, v8, v76
  v_bfe_u32 v76, v0, 3, 1
  v_mul_u32_u24 v76, 131072, v76
  v_add_u32 v8, v8, v76
  v_lshrrev_b32 v76, 3, v0
  v_and_b32 v76, 6, v76
  v_xor_b32 v76, v76, v0
  v_and_b32 v76, 7, v76
  v_lshl_add_u32 v8, v76, 4, v8
  s_lshl_b32 s40, s20, 19
  v_add_u32 v8, s40, v8
  s_lshl_b32 s44, s21, 8
  s_add_u32 s45, s44, 128
  s_load_dwordx2 s[8:9], s[0:1], 32
  s_mov_b32 s10, 8388608
  s_mov_b32 s11, 0x20000
  s_waitcnt lgkmcnt(0)
  v_add_u32 v9, s44, v8
  v_add_u32 v10, s45, v8
  s_lshl_b32 s41, s20, 15
  s_and_b32 s40, s21, 3
  s_cmp_eq_u32 s40, 1
  s_cselect_b64 vcc, -1, 0
  s_add_u32 m0, s41, 0
  s_add_u32 s42, s52, 0
  buffer_load_dwordx4 v9, s[8:11], s42 offen lds
  s_add_u32 m0, s41, 1024
  s_add_u32 s42, s52, 65536
  buffer_load_dwordx4 v9, s[8:11], s42 offen lds
  s_add_u32 m0, s41, 2048
  s_add_u32 s42, s52, 8192
  buffer_load_dwordx4 v9, s[8:11], s42 offen lds
  s_add_u32 m0, s41, 3072
  s_add_u32 s42, s52, 73728
  buffer_load_dwordx4 v9, s[8:11], s42 offen lds
  s_add_u32 m0, s41, 4096
  s_add_u32 s42, s52, 262144
  buffer_load_dwordx4 v9, s[8:11], s42 offen lds
  s_add_u32 m0, s41, 5120
  s_add_u32 s42, s52, 327680
  buffer_load_dwordx4 v9, s[8:11], s42 offen lds
  s_add_u32 m0, s41, 6144
  s_add_u32 s42, s52, 270336
  buffer_load_dwordx4 v9, s[8:11], s42 offen lds
  s_add_u32 m0, s41, 7168
  s_add_u32 s42, s52, 335872
  buffer_load_dwordx4 v9, s[8:11], s42 offen lds
  s_add_u32 m0, s41, 8192
  s_add_u32 s42, s52, 2097152
  buffer_load_dwordx4 v9, s[8:11], s42 offen lds
  s_add_u32 m0, s41, 9216
  s_add_u32 s42, s52, 2162688
  buffer_load_dwordx4 v9, s[8:11], s42 offen lds
  s_add_u32 m0, s41, 10240
  s_add_u32 s42, s52, 2105344
  buffer_load_dwordx4 v9, s[8:11], s42 offen lds
  s_add_u32 m0, s41, 11264
  s_add_u32 s42, s52, 2170880
  buffer_load_dwordx4 v9, s[8:11], s42 offen lds
  s_add_u32 m0, s41, 12288
  s_add_u32 s42, s52, 2359296
  buffer_load_dwordx4 v9, s[8:11], s42 offen lds
  s_add_u32 m0, s41, 13312
  s_add_u32 s42, s52, 2424832
  buffer_load_dwordx4 v9, s[8:11], s42 offen lds
  s_add_u32 m0, s41, 14336
  s_add_u32 s42, s52, 2367488
  buffer_load_dwordx4 v9, s[8:11], s42 offen lds
  s_add_u32 m0, s41, 15360
  s_add_u32 s42, s52, 2433024
  buffer_load_dwordx4 v9, s[8:11], s42 offen lds
  s_add_u32 m0, s41, 16384
  s_add_u32 s42, s53, 4194304
  buffer_load_dwordx4 v9, s[8:11], s42 offen lds
  s_add_u32 m0, s41, 17408
  s_add_u32 s42, s53, 4259840
  buffer_load_dwordx4 v9, s[8:11], s42 offen lds
  s_add_u32 m0, s41, 18432
  s_add_u32 s42, s53, 4202496
  buffer_load_dwordx4 v9, s[8:11], s42 offen lds
  s_add_u32 m0, s41, 19456
  s_add_u32 s42, s53, 4268032
  buffer_load_dwordx4 v9, s[8:11], s42 offen lds
  s_add_u32 m0, s41, 20480
  s_add_u32 s42, s53, 4456448
  buffer_load_dwordx4 v9, s[8:11], s42 offen lds
  s_add_u32 m0, s41, 21504
  s_add_u32 s42, s53, 4521984
  buffer_load_dwordx4 v9, s[8:11], s42 offen lds
  s_add_u32 m0, s41, 22528
  s_add_u32 s42, s53, 4464640
  buffer_load_dwordx4 v9, s[8:11], s42 offen lds
  s_add_u32 m0, s41, 23552
  s_add_u32 s42, s53, 4530176
  buffer_load_dwordx4 v9, s[8:11], s42 offen lds
  s_waitcnt vmcnt(16) lgkmcnt(0)
  s_barrier
  s_add_u32 m0, s41, 24576
  s_add_u32 s42, s53, 6291456
  buffer_load_dwordx4 v9, s[8:11], s42 offen lds
  s_add_u32 m0, s41, 25600
  s_add_u32 s42, s53, 6356992
  buffer_load_dwordx4 v9, s[8:11], s42 offen lds
  s_add_u32 m0, s41, 26624
  s_add_u32 s42, s53, 6299648
  buffer_load_dwordx4 v9, s[8:11], s42 offen lds
  s_add_u32 m0, s41, 27648
  s_add_u32 s42, s53, 6365184
  buffer_load_dwordx4 v9, s[8:11], s42 offen lds
  s_add_u32 m0, s41, 28672
  s_add_u32 s42, s53, 6553600
  buffer_load_dwordx4 v9, s[8:11], s42 offen lds
  s_add_u32 m0, s41, 29696
  s_add_u32 s42, s53, 6619136
  buffer_load_dwordx4 v9, s[8:11], s42 offen lds
  s_add_u32 m0, s41, 30720
  s_add_u32 s42, s53, 6561792
  buffer_load_dwordx4 v9, s[8:11], s42 offen lds
  s_add_u32 m0, s41, 31744
  s_add_u32 s42, s53, 6627328
  buffer_load_dwordx4 v9, s[8:11], s42 offen lds
  ds_read_b64_tr_b16 v[128:129], v4 offset:0
  ds_read_b64_tr_b16 v[130:131], v4 offset:2048
  ds_read_b64_tr_b16 v[132:133], v4 offset:4096
  ds_read_b64_tr_b16 v[134:135], v4 offset:6144
  ds_read_b64_tr_b16 v[144:145], v5 offset:0
  ds_read_b64_tr_b16 v[146:147], v5 offset:2048
  ds_read_b64_tr_b16 v[148:149], v5 offset:4096
  ds_read_b64_tr_b16 v[150:151], v5 offset:6144
  ds_read_b64_tr_b16 v[160:161], v6 offset:0
  ds_read_b64_tr_b16 v[162:163], v6 offset:2048
  ds_read_b64_tr_b16 v[164:165], v6 offset:4096
  ds_read_b64_tr_b16 v[166:167], v6 offset:6144
  ds_read_b64_tr_b16 v[176:177], v7 offset:0
  ds_read_b64_tr_b16 v[178:179], v7 offset:2048
  ds_read_b64_tr_b16 v[180:181], v7 offset:4096
  ds_read_b64_tr_b16 v[182:183], v7 offset:6144
  s_waitcnt vmcnt(16) lgkmcnt(0)
  s_barrier
  s_add_u32 m0, s41, 0
  s_add_u32 s42, s52, 0
  buffer_load_dwordx4 v10, s[8:11], s42 offen lds
  s_add_u32 m0, s41, 1024
  s_add_u32 s42, s52, 65536
  buffer_load_dwordx4 v10, s[8:11], s42 offen lds
  s_add_u32 m0, s41, 2048
  s_add_u32 s42, s52, 8192
  buffer_load_dwordx4 v10, s[8:11], s42 offen lds
  s_add_u32 m0, s41, 3072
  s_add_u32 s42, s52, 73728
  buffer_load_dwordx4 v10, s[8:11], s42 offen lds
  s_add_u32 m0, s41, 4096
  s_add_u32 s42, s52, 262144
  buffer_load_dwordx4 v10, s[8:11], s42 offen lds
  s_add_u32 m0, s41, 5120
  s_add_u32 s42, s52, 327680
  buffer_load_dwordx4 v10, s[8:11], s42 offen lds
  s_add_u32 m0, s41, 6144
  s_add_u32 s42, s52, 270336
  buffer_load_dwordx4 v10, s[8:11], s42 offen lds
  s_add_u32 m0, s41, 7168
  s_add_u32 s42, s52, 335872
  buffer_load_dwordx4 v10, s[8:11], s42 offen lds
  ds_read_b64_tr_b16 v[136:137], v4 offset:8192
  ds_read_b64_tr_b16 v[138:139], v4 offset:10240
  ds_read_b64_tr_b16 v[140:141], v4 offset:12288
  ds_read_b64_tr_b16 v[142:143], v4 offset:14336
  ds_read_b64_tr_b16 v[152:153], v5 offset:8192
  ds_read_b64_tr_b16 v[154:155], v5 offset:10240
  ds_read_b64_tr_b16 v[156:157], v5 offset:12288
  ds_read_b64_tr_b16 v[158:159], v5 offset:14336
  ds_read_b64_tr_b16 v[168:169], v6 offset:8192
  ds_read_b64_tr_b16 v[170:171], v6 offset:10240
  ds_read_b64_tr_b16 v[172:173], v6 offset:12288
  ds_read_b64_tr_b16 v[174:175], v6 offset:14336
  ds_read_b64_tr_b16 v[184:185], v7 offset:8192
  ds_read_b64_tr_b16 v[186:187], v7 offset:10240
  ds_read_b64_tr_b16 v[188:189], v7 offset:12288
  ds_read_b64_tr_b16 v[190:191], v7 offset:14336
  s_waitcnt vmcnt(16) lgkmcnt(0)
  s_barrier
  s_add_u32 m0, s41, 8192
  s_add_u32 s42, s52, 2097152
  buffer_load_dwordx4 v10, s[8:11], s42 offen lds
  s_add_u32 m0, s41, 9216
  s_add_u32 s42, s52, 2162688
  buffer_load_dwordx4 v10, s[8:11], s42 offen lds
  s_add_u32 m0, s41, 10240
  s_add_u32 s42, s52, 2105344
  buffer_load_dwordx4 v10, s[8:11], s42 offen lds
  s_add_u32 m0, s41, 11264
  s_add_u32 s42, s52, 2170880
  buffer_load_dwordx4 v10, s[8:11], s42 offen lds
  s_add_u32 m0, s41, 12288
  s_add_u32 s42, s52, 2359296
  buffer_load_dwordx4 v10, s[8:11], s42 offen lds
  s_add_u32 m0, s41, 13312
  s_add_u32 s42, s52, 2424832
  buffer_load_dwordx4 v10, s[8:11], s42 offen lds
  s_add_u32 m0, s41, 14336
  s_add_u32 s42, s52, 2367488
  buffer_load_dwordx4 v10, s[8:11], s42 offen lds
  s_add_u32 m0, s41, 15360
  s_add_u32 s42, s52, 2433024
  buffer_load_dwordx4 v10, s[8:11], s42 offen lds
  ds_read_b64_tr_b16 v[192:193], v4 offset:16384
  ds_read_b64_tr_b16 v[194:195], v4 offset:18432
  ds_read_b64_tr_b16 v[196:197], v4 offset:20480
  ds_read_b64_tr_b16 v[198:199], v4 offset:22528
  ds_read_b64_tr_b16 v[208:209], v5 offset:16384
  ds_read_b64_tr_b16 v[210:211], v5 offset:18432
  ds_read_b64_tr_b16 v[212:213], v5 offset:20480
  ds_read_b64_tr_b16 v[214:215], v5 offset:22528
  ds_read_b64_tr_b16 v[224:225], v6 offset:16384
  ds_read_b64_tr_b16 v[226:227], v6 offset:18432
  ds_read_b64_tr_b16 v[228:229], v6 offset:20480
  ds_read_b64_tr_b16 v[230:231], v6 offset:22528
  ds_read_b64_tr_b16 v[240:241], v7 offset:16384
  ds_read_b64_tr_b16 v[242:243], v7 offset:18432
  ds_read_b64_tr_b16 v[244:245], v7 offset:20480
  ds_read_b64_tr_b16 v[246:247], v7 offset:22528
  s_waitcnt vmcnt(16) lgkmcnt(0)
  s_barrier
  s_add_u32 m0, s41, 16384
  s_add_u32 s42, s53, 4194304
  buffer_load_dwordx4 v10, s[8:11], s42 offen lds
  s_add_u32 m0, s41, 17408
  s_add_u32 s42, s53, 4259840
  buffer_load_dwordx4 v10, s[8:11], s42 offen lds
  s_add_u32 m0, s41, 18432
  s_add_u32 s42, s53, 4202496
  buffer_load_dwordx4 v10, s[8:11], s42 offen lds
  s_add_u32 m0, s41, 19456
  s_add_u32 s42, s53, 4268032
  buffer_load_dwordx4 v10, s[8:11], s42 offen lds
  s_add_u32 m0, s41, 20480
  s_add_u32 s42, s53, 4456448
  buffer_load_dwordx4 v10, s[8:11], s42 offen lds
  s_add_u32 m0, s41, 21504
  s_add_u32 s42, s53, 4521984
  buffer_load_dwordx4 v10, s[8:11], s42 offen lds
  s_add_u32 m0, s41, 22528
  s_add_u32 s42, s53, 4464640
  buffer_load_dwordx4 v10, s[8:11], s42 offen lds
  s_add_u32 m0, s41, 23552
  s_add_u32 s42, s53, 4530176
  buffer_load_dwordx4 v10, s[8:11], s42 offen lds
  ds_read_b64_tr_b16 v[200:201], v4 offset:24576
  ds_read_b64_tr_b16 v[202:203], v4 offset:26624
  ds_read_b64_tr_b16 v[204:205], v4 offset:28672
  ds_read_b64_tr_b16 v[206:207], v4 offset:30720
  ds_read_b64_tr_b16 v[216:217], v5 offset:24576
  ds_read_b64_tr_b16 v[218:219], v5 offset:26624
  ds_read_b64_tr_b16 v[220:221], v5 offset:28672
  ds_read_b64_tr_b16 v[222:223], v5 offset:30720
  ds_read_b64_tr_b16 v[232:233], v6 offset:24576
  ds_read_b64_tr_b16 v[234:235], v6 offset:26624
  ds_read_b64_tr_b16 v[236:237], v6 offset:28672
  ds_read_b64_tr_b16 v[238:239], v6 offset:30720
  ds_read_b64_tr_b16 v[248:249], v7 offset:24576
  ds_read_b64_tr_b16 v[250:251], v7 offset:26624
  ds_read_b64_tr_b16 v[252:253], v7 offset:28672
  ds_read_b64_tr_b16 v[254:255], v7 offset:30720
  s_cmp_lg_u32 s20, 0
  s_cbranch_scc1 Lchore_172
Lini_173:
  s_load_dwordx16 s[64:79], s[12:13], 128 glc
  s_load_dwordx16 s[80:95], s[12:13], 192 glc
  s_sub_u32 s24, s24, 1
  s_cbranch_scc1 L_FAIL
  s_waitcnt lgkmcnt(0)
  s_and_b64 s[64:65], s[64:65], s[66:67]
  s_and_b64 s[64:65], s[64:65], s[68:69]
  s_and_b64 s[64:65], s[64:65], s[70:71]
  s_and_b64 s[64:65], s[64:65], s[72:73]
  s_and_b64 s[64:65], s[64:65], s[74:75]
  s_and_b64 s[64:65], s[64:65], s[76:77]
  s_and_b64 s[64:65], s[64:65], s[78:79]
  s_and_b64 s[64:65], s[64:65], s[80:81]
  s_and_b64 s[64:65], s[64:65], s[82:83]
  s_and_b64 s[64:65], s[64:65], s[84:85]
  s_and_b64 s[64:65], s[64:65], s[86:87]
  s_and_b64 s[64:65], s[64:65], s[88:89]
  s_and_b64 s[64:65], s[64:65], s[90:91]
  s_and_b64 s[64:65], s[64:65], s[92:93]
  s_and_b64 s[64:65], s[64:65], s[94:95]
  s_and_b32 s64, s64, s65
  s_cbranch_scc0 Lini_173
  s_mov_b32 s46, 0xffff
  s_and_b32 s40, s21, 3
  s_lshl_b32 s40, s40, 13
  s_lshr_b32 s43, s21, 2
  s_lshl_b32 s43, s43, 10
  s_add_u32 s43, s43, s40
  s_add_u32 s43, s43, 1344000
  s_waitcnt lgkmcnt(0)
  s_memtime s[64:65]
  s_waitcnt lgkmcnt(0)
  s_load_dword s68, s[4:5], s43 glc
  s_waitcnt lgkmcnt(0)
  s_memtime s[66:67]
  s_waitcnt lgkmcnt(0)
  s_sub_u32 s64, s66, s64
  s_min_u32 s46, s46, s64
  s_getreg_b32 s55, hwreg(HW_REG_XCC_ID)
  s_and_b32 s55, s55, 15
  s_lshl_b32 s46, s46, 8
  s_or_b32 s46, s46, s55
  s_add_u32 s40, s21, 32
  s_lshl_b32 s40, s40, 7
  s_add_u32 s40, s40, 1424384
  s_mov_b32 s63, s46
  s_atomic_smax s63, s[4:5], s40 glc
Lnosig_174:
Lchore_172:
  s_waitcnt vmcnt(16) lgkmcnt(0)
  s_barrier
  s_add_u32 m0, s41, 24576
  s_add_u32 s42, s53, 6291456
  buffer_load_dwordx4 v10, s[8:11], s42 offen lds
  s_add_u32 m0, s41, 25600
  s_add_u32 s42, s53, 6356992
  buffer_load_dwordx4 v10, s[8:11], s42 offen lds
  s_add_u32 m0, s41, 26624
  s_add_u32 s42, s53, 6299648
  buffer_load_dwordx4 v10, s[8:11], s42 offen lds
  s_add_u32 m0, s41, 27648
  s_add_u32 s42, s53, 6365184
  buffer_load_dwordx4 v10, s[8:11], s42 offen lds
  s_add_u32 m0, s41, 28672
  s_add_u32 s42, s53, 6553600
  buffer_load_dwordx4 v10, s[8:11], s42 offen lds
  s_add_u32 m0, s41, 29696
  s_add_u32 s42, s53, 6619136
  buffer_load_dwordx4 v10, s[8:11], s42 offen lds
  s_add_u32 m0, s41, 30720
  s_add_u32 s42, s53, 6561792
  buffer_load_dwordx4 v10, s[8:11], s42 offen lds
  s_add_u32 m0, s41, 31744
  s_add_u32 s42, s53, 6627328
  buffer_load_dwordx4 v10, s[8:11], s42 offen lds
  ds_read_b64_tr_b16 v[20:21], v4 offset:0
  ds_read_b64_tr_b16 v[22:23], v4 offset:2048
  ds_read_b64_tr_b16 v[24:25], v4 offset:4096
  ds_read_b64_tr_b16 v[26:27], v4 offset:6144
  ds_read_b64_tr_b16 v[28:29], v5 offset:0
  ds_read_b64_tr_b16 v[30:31], v5 offset:2048
  ds_read_b64_tr_b16 v[32:33], v5 offset:4096
  ds_read_b64_tr_b16 v[34:35], v5 offset:6144
  ds_read_b64_tr_b16 v[36:37], v6 offset:0
  ds_read_b64_tr_b16 v[38:39], v6 offset:2048
  ds_read_b64_tr_b16 v[40:41], v6 offset:4096
  ds_read_b64_tr_b16 v[42:43], v6 offset:6144
  ds_read_b64_tr_b16 v[44:45], v7 offset:0
  ds_read_b64_tr_b16 v[46:47], v7 offset:2048
  ds_read_b64_tr_b16 v[48:49], v7 offset:4096
  ds_read_b64_tr_b16 v[50:51], v7 offset:6144
  s_waitcnt lgkmcnt(0)
  s_barrier
  ds_write_b128 v85, v[20:23] offset:0
  ds_write_b128 v85, v[24:27] offset:1024
  ds_write_b128 v85, v[28:31] offset:2048
  ds_write_b128 v85, v[32:35] offset:3072
  ds_write_b128 v85, v[36:39] offset:4096
  ds_write_b128 v85, v[40:43] offset:5120
  ds_write_b128 v85, v[44:47] offset:6144
  ds_write_b128 v85, v[48:51] offset:7168
  s_waitcnt vmcnt(16) lgkmcnt(0)
  s_barrier
  ds_read_b64_tr_b16 v[20:21], v4 offset:8192
  ds_read_b64_tr_b16 v[22:23], v4 offset:10240
  ds_read_b64_tr_b16 v[24:25], v4 offset:12288
  ds_read_b64_tr_b16 v[26:27], v4 offset:14336
  ds_read_b64_tr_b16 v[28:29], v5 offset:8192
  ds_read_b64_tr_b16 v[30:31], v5 offset:10240
  ds_read_b64_tr_b16 v[32:33], v5 offset:12288
  ds_read_b64_tr_b16 v[34:35], v5 offset:14336
  ds_read_b64_tr_b16 v[36:37], v6 offset:8192
  ds_read_b64_tr_b16 v[38:39], v6 offset:10240
  ds_read_b64_tr_b16 v[40:41], v6 offset:12288
  ds_read_b64_tr_b16 v[42:43], v6 offset:14336
  ds_read_b64_tr_b16 v[44:45], v7 offset:8192
  ds_read_b64_tr_b16 v[46:47], v7 offset:10240
  ds_read_b64_tr_b16 v[48:49], v7 offset:12288
  ds_read_b64_tr_b16 v[50:51], v7 offset:14336
  s_waitcnt lgkmcnt(0)
  s_barrier
  ds_write_b128 v85, v[20:23] offset:8192
  ds_write_b128 v85, v[24:27] offset:9216
  ds_write_b128 v85, v[28:31] offset:10240
  ds_write_b128 v85, v[32:35] offset:11264
  ds_write_b128 v85, v[36:39] offset:12288
  ds_write_b128 v85, v[40:43] offset:13312
  ds_write_b128 v85, v[44:47] offset:14336
  ds_write_b128 v85, v[48:51] offset:15360
  s_waitcnt vmcnt(8) lgkmcnt(0)
  s_barrier
  ds_read_b64_tr_b16 v[20:21], v4 offset:16384
  ds_read_b64_tr_b16 v[22:23], v4 offset:18432
  ds_read_b64_tr_b16 v[24:25], v4 offset:20480
  ds_read_b64_tr_b16 v[26:27], v4 offset:22528
  ds_read_b64_tr_b16 v[28:29], v5 offset:16384
  ds_read_b64_tr_b16 v[30:31], v5 offset:18432
  ds_read_b64_tr_b16 v[32:33], v5 offset:20480
  ds_read_b64_tr_b16 v[34:35], v5 offset:22528
  ds_read_b64_tr_b16 v[36:37], v6 offset:16384
  ds_read_b64_tr_b16 v[38:39], v6 offset:18432
  ds_read_b64_tr_b16 v[40:41], v6 offset:20480
  ds_read_b64_tr_b16 v[42:43], v6 offset:22528
  ds_read_b64_tr_b16 v[44:45], v7 offset:16384
  ds_read_b64_tr_b16 v[46:47], v7 offset:18432
  ds_read_b64_tr_b16 v[48:49], v7 offset:20480
  ds_read_b64_tr_b16 v[50:51], v7 offset:22528
  s_waitcnt lgkmcnt(0)
  s_barrier
  ds_write_b128 v85, v[20:23] offset:16384
  ds_write_b128 v85, v[24:27] offset:17408
  ds_write_b128 v85, v[28:31] offset:18432
  ds_write_b128 v85, v[32:35] offset:19456
  ds_write_b128 v85, v[36:39] offset:20480
  ds_write_b128 v85, v[40:43] offset:21504
  ds_write_b128 v85, v[44:47] offset:22528
  ds_write_b128 v85, v[48:51] offset:23552
  s_waitcnt vmcnt(0) lgkmcnt(0)
  s_barrier
  ds_read_b64_tr_b16 v[20:21], v4 offset:24576
  ds_read_b64_tr_b16 v[22:23], v4 offset:26624
  ds_read_b64_tr_b16 v[24:25], v4 offset:28672
  ds_read_b64_tr_b16 v[26:27], v4 offset:30720
  ds_read_b64_tr_b16 v[28:29], v5 offset:24576
  ds_read_b64_tr_b16 v[30:31], v5 offset:26624
  ds_read_b64_tr_b16 v[32:33], v5 offset:28672
  ds_read_b64_tr_b16 v[34:35], v5 offset:30720
  ds_read_b64_tr_b16 v[36:37], v6 offset:24576
  ds_read_b64_tr_b16 v[38:39], v6 offset:26624
  ds_read_b64_tr_b16 v[40:41], v6 offset:28672
  ds_read_b64_tr_b16 v[42:43], v6 offset:30720
  ds_read_b64_tr_b16 v[44:45], v7 offset:24576
  ds_read_b64_tr_b16 v[46:47], v7 offset:26624
  ds_read_b64_tr_b16 v[48:49], v7 offset:28672
  ds_read_b64_tr_b16 v[50:51], v7 offset:30720
  s_waitcnt lgkmcnt(0)
  s_barrier
  ds_write_b128 v85, v[20:23] offset:24576
  ds_write_b128 v85, v[24:27] offset:25600
  ds_write_b128 v85, v[28:31] offset:26624
  ds_write_b128 v85, v[32:35] offset:27648
  ds_write_b128 v85, v[36:39] offset:28672
  ds_write_b128 v85, v[40:43] offset:29696
  ds_write_b128 v85, v[44:47] offset:30720
  ds_write_b128 v85, v[48:51] offset:31744
  s_waitcnt lgkmcnt(0)
  s_lshr_b32 s40, s21, 1
  s_lshl_b32 s40, s40, 2
  v_min_u32 v76, 3, v0
  v_add_u32 v76, s40, v76
  v_lshlrev_b32 v76, 7, v76
  v_add_u32 v76, 1432576, v76
  s_nop 1
Lpoll_175:
  buffer_load_dword v77, v76, s[4:7], 0 offen sc1
  s_sub_u32 s24, s24, 1
  s_cbranch_scc1 L_FAIL
  s_waitcnt vmcnt(0)
  v_cmp_gt_i32 vcc, 1, v77
  s_cbranch_vccz Lpolld_176
  s_sleep 1
  s_branch Lpoll_175
Lpolld_176:
  s_lshl_b32 s40, s21, 18
  s_lshl_b32 s41, s20, 15
  s_add_u32 s40, s40, s41
  v_lshl_add_u32 v76, v0, 4, s40
  s_add_u32 s50, s21, s20
  s_and_b32 s50, s50, 3
  s_lshl_b32 s41, s54, 5
  s_add_u32 s41, s41, s50
  s_lshl_b32 s41, s41, 12
  s_xor_b32 s40, s41, 0
  s_add_u32 s40, s40, 10485760
  buffer_load_dwordx4 a[0:3], v76, s[4:7], s40 offen offset:0 sc1
  buffer_load_dwordx4 a[4:7], v76, s[4:7], s40 offen offset:1024 sc1
  buffer_load_dwordx4 a[8:11], v76, s[4:7], s40 offen offset:2048 sc1
  buffer_load_dwordx4 a[12:15], v76, s[4:7], s40 offen offset:3072 sc1
  s_waitcnt vmcnt(32)
  s_xor_b32 s40, s41, 4096
  s_add_u32 s40, s40, 10485760
  buffer_load_dwordx4 a[16:19], v76, s[4:7], s40 offen offset:0 sc1
  buffer_load_dwordx4 a[20:23], v76, s[4:7], s40 offen offset:1024 sc1
  buffer_load_dwordx4 a[24:27], v76, s[4:7], s40 offen offset:2048 sc1
  buffer_load_dwordx4 a[28:31], v76, s[4:7], s40 offen offset:3072 sc1
  s_waitcnt vmcnt(32)
  s_xor_b32 s40, s41, 8192
  s_add_u32 s40, s40, 10485760
  buffer_load_dwordx4 a[32:35], v76, s[4:7], s40 offen offset:0 sc1
  buffer_load_dwordx4 a[36:39], v76, s[4:7], s40 offen offset:1024 sc1
  buffer_load_dwordx4 a[40:43], v76, s[4:7], s40 offen offset:2048 sc1
  buffer_load_dwordx4 a[44:47], v76, s[4:7], s40 offen offset:3072 sc1
  s_waitcnt vmcnt(32)
  s_xor_b32 s40, s41, 12288
  s_add_u32 s40, s40, 10485760
  buffer_load_dwordx4 a[48:51], v76, s[4:7], s40 offen offset:0 sc1
  buffer_load_dwordx4 a[52:55], v76, s[4:7], s40 offen offset:1024 sc1
  buffer_load_dwordx4 a[56:59], v76, s[4:7], s40 offen offset:2048 sc1
  buffer_load_dwordx4 a[60:63], v76, s[4:7], s40 offen offset:3072 sc1
  s_waitcnt vmcnt(32)
  s_xor_b32 s40, s41, 16384
  s_add_u32 s40, s40, 10485760
  buffer_load_dwordx4 a[64:67], v76, s[4:7], s40 offen offset:0 sc1
  buffer_load_dwordx4 a[68:71], v76, s[4:7], s40 offen offset:1024 sc1
  buffer_load_dwordx4 a[72:75], v76, s[4:7], s40 offen offset:2048 sc1
  buffer_load_dwordx4 a[76:79], v76, s[4:7], s40 offen offset:3072 sc1
  s_waitcnt vmcnt(32)
  s_xor_b32 s40, s41, 20480
  s_add_u32 s40, s40, 10485760
  buffer_load_dwordx4 a[80:83], v76, s[4:7], s40 offen offset:0 sc1
  buffer_load_dwordx4 a[84:87], v76, s[4:7], s40 offen offset:1024 sc1
  buffer_load_dwordx4 a[88:91], v76, s[4:7], s40 offen offset:2048 sc1
  buffer_load_dwordx4 a[92:95], v76, s[4:7], s40 offen offset:3072 sc1
  s_waitcnt vmcnt(32)
  s_xor_b32 s40, s41, 24576
  s_add_u32 s40, s40, 10485760
  buffer_load_dwordx4 a[96:99], v76, s[4:7], s40 offen offset:0 sc1
  buffer_load_dwordx4 a[100:103], v76, s[4:7], s40 offen offset:1024 sc1
  buffer_load_dwordx4 a[104:107], v76, s[4:7], s40 offen offset:2048 sc1
  buffer_load_dwordx4 a[108:111], v76, s[4:7], s40 offen offset:3072 sc1
  s_waitcnt vmcnt(32)
  s_xor_b32 s40, s41, 28672
  s_add_u32 s40, s40, 10485760
  buffer_load_dwordx4 a[112:115], v76, s[4:7], s40 offen offset:0 sc1
  buffer_load_dwordx4 a[116:119], v76, s[4:7], s40 offen offset:1024 sc1
  buffer_load_dwordx4 a[120:123], v76, s[4:7], s40 offen offset:2048 sc1
  buffer_load_dwordx4 a[124:127], v76, s[4:7], s40 offen offset:3072 sc1
  s_waitcnt vmcnt(32)
  s_xor_b32 s40, s41, 131072
  s_add_u32 s40, s40, 10485760
  buffer_load_dwordx4 a[128:131], v76, s[4:7], s40 offen offset:0 sc1
  buffer_load_dwordx4 a[132:135], v76, s[4:7], s40 offen offset:1024 sc1
  buffer_load_dwordx4 a[136:139], v76, s[4:7], s40 offen offset:2048 sc1
  buffer_load_dwordx4 a[140:143], v76, s[4:7], s40 offen offset:3072 sc1
  s_waitcnt vmcnt(32)
  s_xor_b32 s40, s41, 135168
  s_add_u32 s40, s40, 10485760
  buffer_load_dwordx4 a[144:147], v76, s[4:7], s40 offen offset:0 sc1
  buffer_load_dwordx4 a[148:151], v76, s[4:7], s40 offen offset:1024 sc1
  buffer_load_dwordx4 a[152:155], v76, s[4:7], s40 offen offset:2048 sc1
  buffer_load_dwordx4 a[156:159], v76, s[4:7], s40 offen offset:3072 sc1
  s_waitcnt vmcnt(32)
  s_xor_b32 s40, s41, 139264
  s_add_u32 s40, s40, 10485760
  buffer_load_dwordx4 a[160:163], v76, s[4:7], s40 offen offset:0 sc1
  buffer_load_dwordx4 a[164:167], v76, s[4:7], s40 offen offset:1024 sc1
  buffer_load_dwordx4 a[168:171], v76, s[4:7], s40 offen offset:2048 sc1
  buffer_load_dwordx4 a[172:175], v76, s[4:7], s40 offen offset:3072 sc1
  s_waitcnt vmcnt(32)
  s_xor_b32 s40, s41, 143360
  s_add_u32 s40, s40, 10485760
  buffer_load_dwordx4 a[176:179], v76, s[4:7], s40 offen offset:0 sc1
  buffer_load_dwordx4 a[180:183], v76, s[4:7], s40 offen offset:1024 sc1
  buffer_load_dwordx4 a[184:187], v76, s[4:7], s40 offen offset:2048 sc1
  buffer_load_dwordx4 a[188:191], v76, s[4:7], s40 offen offset:3072 sc1
  s_waitcnt vmcnt(32)
  s_xor_b32 s40, s41, 147456
  s_add_u32 s40, s40, 10485760
  buffer_load_dwordx4 a[192:195], v76, s[4:7], s40 offen offset:0 sc1
  buffer_load_dwordx4 a[196:199], v76, s[4:7], s40 offen offset:1024 sc1
  buffer_load_dwordx4 a[200:203], v76, s[4:7], s40 offen offset:2048 sc1
  buffer_load_dwordx4 a[204:207], v76, s[4:7], s40 offen offset:3072 sc1
  s_waitcnt vmcnt(32)
  s_xor_b32 s40, s41, 151552
  s_add_u32 s40, s40, 10485760
  buffer_load_dwordx4 a[208:211], v76, s[4:7], s40 offen offset:0 sc1
  buffer_load_dwordx4 a[212:215], v76, s[4:7], s40 offen offset:1024 sc1
  buffer_load_dwordx4 a[216:219], v76, s[4:7], s40 offen offset:2048 sc1
  buffer_load_dwordx4 a[220:223], v76, s[4:7], s40 offen offset:3072 sc1
  s_waitcnt vmcnt(32)
  s_xor_b32 s40, s41, 155648
  s_add_u32 s40, s40, 10485760
  buffer_load_dwordx4 a[224:227], v76, s[4:7], s40 offen offset:0 sc1
  buffer_load_dwordx4 a[228:231], v76, s[4:7], s40 offen offset:1024 sc1
  buffer_load_dwordx4 a[232:235], v76, s[4:7], s40 offen offset:2048 sc1
  buffer_load_dwordx4 a[236:239], v76, s[4:7], s40 offen offset:3072 sc1
  s_waitcnt vmcnt(32)
  s_xor_b32 s40, s41, 159744
  s_add_u32 s40, s40, 10485760
  buffer_load_dwordx4 a[240:243], v76, s[4:7], s40 offen offset:0 sc1
  buffer_load_dwordx4 a[244:247], v76, s[4:7], s40 offen offset:1024 sc1
  buffer_load_dwordx4 a[248:251], v76, s[4:7], s40 offen offset:2048 sc1
  buffer_load_dwordx4 a[252:255], v76, s[4:7], s40 offen offset:3072 sc1
  s_waitcnt vmcnt(32)
  s_cmp_lg_u32 s20, 2
  s_cbranch_scc1 Lnotlb_177
  v_lshlrev_b32 v77, 21, v0
  s_mov_b32 s40, 0x1fff80
  buffer_load_dword v78, v77, s[4:7], s40 offen sc1
  s_add_u32 s40, s40, 134217728
  buffer_load_dword v78, v77, s[4:7], s40 offen sc1
  s_waitcnt vmcnt(0)
Lnotlb_177:
  s_getreg_b32 s55, hwreg(HW_REG_XCC_ID)
  s_and_b32 s55, s55, 15
  v_min_u32 v76, 63, v0
  v_lshlrev_b32 v76, 7, v76
  v_add_u32 v76, 1424384, v76
  s_nop 1
Lpoll_178:
  buffer_load_dword v77, v76, s[4:7], 0 offen sc1
  s_sub_u32 s24, s24, 1
  s_cbranch_scc1 L_FAIL
  s_waitcnt vmcnt(0)
  v_cmp_gt_i32 vcc, 0, v77
  s_cbranch_vccz Lpolld_179
  s_sleep 1
  s_branch Lpoll_178
Lpolld_179:
  v_and_b32 v78, 15, v77
  v_cmp_ne_u32 vcc, s55, v78
  s_lshl_b32 s40, s54, 4
  s_lshl_b32 s40, 0xffff, s40
  s_or_b32 s41, vcc_lo, vcc_hi
  s_and_b32 s40, s40, s41
  s_cselect_b32 s36, 0, 8192
  v_lshrrev_b32 v77, 8, v77
  v_and_b32 v78, 3, v0
  v_lshl_or_b32 v77, v77, 2, v78
  s_nop 1
  v_min_u32_dpp v77, v77, v77 row_ror:8 row_mask:0xf bank_mask:0xf
  s_nop 1
  v_min_u32_dpp v77, v77, v77 row_ror:4 row_mask:0xf bank_mask:0xf
  v_mov_b32 v78, v77
  s_nop 1
  v_permlane16_swap_b32 v78, v77
  v_min_u32 v77, v77, v78
  v_mov_b32 v78, v77
  s_nop 1
  v_permlane32_swap_b32 v78, v77
  v_min_u32 v77, v77, v78
  s_nop 1
  v_min_u32_dpp v77, v77, v77 row_ror:2 row_mask:0xf bank_mask:0xf
  s_nop 1
  v_min_u32_dpp v77, v77, v77 row_ror:1 row_mask:0xf bank_mask:0xf
  s_nop 0
  v_readfirstlane_b32 s26, v77
  s_and_b32 s26, s26, 3
  s_lshl_b32 s26, s26, 13
  s_lshr_b32 s40, s20, 1
  s_mul_i32 s40, s40, 32768
  s_and_b32 s41, s20, 1
  s_lshl_b32 s41, s41, 10
  s_add_u32 s40, s40, s41
  s_lshl_b32 s41, s54, 12
  s_add_u32 s40, s40, s41
  v_lshl_add_u32 v86, v0, 4, s40
  v_xor_b32 v87, 0x1000, v86
  v_and_b32 v76, 2, v0
  v_cmp_eq_u32 vcc, 0, v76
  v_mov_b32 v76, 0xeeee
  v_mov_b32 v77, 0x4444
  v_cndmask_b32 v88, v76, v77, vcc
  s_lshr_b32 s40, s21, 2
  s_mul_i32 s40, s40, 32768
  s_and_b32 s41, s21, 3
  s_lshl_b32 s41, s41, 11
  s_add_u32 s47, s40, s41
  s_lshl_b32 s41, s20, 9
  s_add_u32 s47, s47, s41
  v_lshl_add_u32 v92, v0, 3, s47
  s_lshl_b32 s41, s54, 12
  s_add_u32 s40, s41, 1310720
  s_add_u32 s40, s40, s26
  v_lshrrev_b32 v76, 2, v0
  v_lshl_add_u32 v76, v76, 7, s40
  v_and_b32 v77, 3, v0
  v_lshl_add_u32 v90, v77, 2, v76
  s_mov_b32 s57, s40
  s_cmp_eq_u32 s36, 0
  s_cselect_b32 s56, 1, s20
  s_and_b32 s41, s21, 15
  s_lshl_b32 s41, s41, 7
  s_lshl_b32 s40, s20, 2
  s_add_u32 s40, s40, s41
  s_add_u32 s40, s40, 0
  s_mov_b32 s25, 0
  s_mov_b32 s60, 0
  s_mov_b32 s61, 0
  s_mov_b32 s51, -1
  v_mov_b32 v91, 2147483392
  s_mov_b64 exec, 1
  v_mov_b32 v91, s40
  s_mov_b64 exec, -1
  v_mov_b32 v80, -1
  v_mov_b32 v81, -1
  v_mov_b32 v82, -1
  v_mov_b32 v83, -1
  s_mul_i32 s40, s20, 32768
  s_and_b32 s41, s50, 3
  s_lshl_b32 s41, s41, 10
  s_add_u32 s40, s40, s41
  v_lshl_add_u32 v111, v0, 4, s40
  v_xor_b32 v112, 0x400, v111
  v_xor_b32 v113, 0x800, v111
  v_xor_b32 v114, 0xc00, v111
  s_mul_i32 s58, s54, 131072
  s_and_b32 s41, s50, 4
  s_lshl_b32 s41, s41, 10
  s_add_u32 s58, s58, s41
  s_bfe_u32 s40, s21, 0x20002
  s_lshl_b32 s40, s40, 7
  s_and_b32 s41, s21, 3
  s_lshl_b32 s41, s41, 4
  s_add_u32 s40, s40, s41
  s_lshl_b32 s41, s20, 2
  s_add_u32 s41, s41, s40
  s_cmp_eq_u32 s20, 0
  s_cselect_b32 s40, s40, s41
  s_mov_b64 exec, 1
  v_mov_b32 v91, s40
  s_mov_b64 exec, -1
  s_mul_i32 s40, s20, 512
  v_add_u32 v90, s40, v90
  v_bfe_u32 v76, v0, 2, 2
  v_xor_b32 v76, s20, v76
  v_lshlrev_b32 v76, 3, v76
  v_lshl_add_u32 v76, v0, 5, v76
  v_add_u32 v95, 147456, v76
  s_and_b32 s40, s20, 1
  s_lshl_b32 s40, s40, 3
  v_bfe_u32 v4, v0, 2, 3
  v_add_u32 v4, s40, v4
  s_lshr_b32 s40, s20, 1
  s_lshl_b32 s40, s40, 3
  v_and_b32 v5, 3, v0
  v_add_u32 v5, s40, v5
  v_bfe_u32 v76, v4, 1, 1
  v_lshl_add_u32 v5, v76, 2, v5
  v_lshrrev_b32 v76, 2, v4
  v_and_b32 v77, 1, v4
  v_lshl_add_u32 v78, v76, 4, v5
  v_lshlrev_b32 v78, 5, v78
  v_mul_u32_u24 v77, 2064, v77
  v_add_u32 v78, v77, v78
  v_add_u32 v108, 147456, v78
  v_xor_b32 v109, 16, v108
  s_bfe_u32 s41, s21, 0x10002
  s_mul_i32 s41, s41, 32768
  s_lshr_b32 s40, s21, 3
  s_lshl_b32 s40, s40, 11
  s_add_u32 s40, s40, s41
  s_and_b32 s41, s21, 3
  s_lshl_b32 s41, s41, 9
  s_add_u32 s40, s40, s41
  s_lshl_b32 s41, s20, 7
  s_add_u32 s40, s40, s41
  v_lshl_add_u32 v110, v0, 2, s40
  s_mov_b32 exec_lo, 0
  v_mov_b32 v110, 2147483392
  s_mov_b64 exec, -1
  ds_read_b128 v[116:119], v85 offset:20480
  ds_read_b128 v[120:123], v85 offset:21504
  s_mov_b32 s59, 2147483392
  s_mov_b32 s25, 0
  s_add_u32 s27, s25, 32
  s_and_b32 s40, s27, 0x28
  s_mul_i32 s40, s40, 0x900
  s_and_b32 s40, s40, 0x6000
  s_xor_b32 s40, s40, s26
  s_lshl_b32 s27, s27, 16
  s_add_u32 s27, s27, s40
  s_lshl_b32 s37, s36, 1
  s_xor_b32 s37, s27, s37
  s_and_b32 s40, s25, 3
  s_lshl_b32 s40, s40, 18
  s_add_u32 s28, s40, s26
  s_lshr_b32 s40, s40, 5
  s_and_b32 s40, s40, 0x4000
  s_xor_b32 s28, s28, s40
  s_xor_b32 s29, s28, 0x4000
  s_xor_b32 s40, s29, 0
  buffer_load_dword v89, v92, s[4:7], s40 offen sc1
  s_xor_b32 s40, s27, 16384
  buffer_load_dword v89, v110, s[4:7], s40 offen sc1
  s_mov_b32 s25, 1
  s_add_u32 s27, s25, 32
  s_and_b32 s40, s27, 0x28
  s_mul_i32 s40, s40, 0x900
  s_and_b32 s40, s40, 0x6000
  s_xor_b32 s40, s40, s26
  s_lshl_b32 s27, s27, 16
  s_add_u32 s27, s27, s40
  s_lshl_b32 s37, s36, 1
  s_xor_b32 s37, s27, s37
  s_and_b32 s40, s25, 3
  s_lshl_b32 s40, s40, 18
  s_add_u32 s28, s40, s26
  s_lshr_b32 s40, s40, 5
  s_and_b32 s40, s40, 0x4000
  s_xor_b32 s28, s28, s40
  s_xor_b32 s29, s28, 0x4000
  s_xor_b32 s40, s29, 0
  buffer_load_dword v89, v92, s[4:7], s40 offen sc1
  s_xor_b32 s40, s27, 16384
  buffer_load_dword v89, v110, s[4:7], s40 offen sc1
  s_mov_b32 s25, 2
  s_add_u32 s27, s25, 32
  s_and_b32 s40, s27, 0x28
  s_mul_i32 s40, s40, 0x900
  s_and_b32 s40, s40, 0x6000
  s_xor_b32 s40, s40, s26
  s_lshl_b32 s27, s27, 16
  s_add_u32 s27, s27, s40
  s_lshl_b32 s37, s36, 1
  s_xor_b32 s37, s27, s37
  s_and_b32 s40, s25, 3
  s_lshl_b32 s40, s40, 18
  s_add_u32 s28, s40, s26
  s_lshr_b32 s40, s40, 5
  s_and_b32 s40, s40, 0x4000
  s_xor_b32 s28, s28, s40
  s_xor_b32 s29, s28, 0x4000
  s_xor_b32 s40, s29, 0
  buffer_load_dword v89, v92, s[4:7], s40 offen sc1
  s_xor_b32 s40, s27, 16384
  buffer_load_dword v89, v110, s[4:7], s40 offen sc1
  s_mov_b32 s25, 3
  s_add_u32 s27, s25, 32
  s_and_b32 s40, s27, 0x28
  s_mul_i32 s40, s40, 0x900
  s_and_b32 s40, s40, 0x6000
  s_xor_b32 s40, s40, s26
  s_lshl_b32 s27, s27, 16
  s_add_u32 s27, s27, s40
  s_lshl_b32 s37, s36, 1
  s_xor_b32 s37, s27, s37
  s_and_b32 s40, s25, 3
  s_lshl_b32 s40, s40, 18
  s_add_u32 s28, s40, s26
  s_lshr_b32 s40, s40, 5
  s_and_b32 s40, s40, 0x4000
  s_xor_b32 s28, s28, s40
  s_xor_b32 s29, s28, 0x4000
  s_xor_b32 s40, s29, 0
  buffer_load_dword v89, v92, s[4:7], s40 offen sc1
  s_xor_b32 s40, s27, 16384
  buffer_load_dword v89, v110, s[4:7], s40 offen sc1
  buffer_load_dword v89, v90, s[4:7], 0 offen offset:2048 sc1
  s_mov_b32 s25, 0
  v_mov_b64 v[52:53], 0
  v_mov_b64 v[54:55], 0
  v_mov_b64 v[56:57], 0
  v_mov_b64 v[58:59], 0
  ds_read_b128 v[20:23], v85 offset:0
  ds_read_b128 v[24:27], v85 offset:1024
  ds_read_b128 v[28:31], v85 offset:8192
  ds_read_b128 v[32:35], v85 offset:9216
  ds_read_b128 v[36:39], v85 offset:2048
  ds_read_b128 v[40:43], v85 offset:3072
  ds_read_b128 v[44:47], v85 offset:10240
  ds_read_b128 v[48:51], v85 offset:11264
L_VO_top:
  s_add_u32 s27, s25, 32
  s_and_b32 s40, s27, 0x28
  s_mul_i32 s40, s40, 0x900
  s_and_b32 s40, s40, 0x6000
  s_xor_b32 s40, s40, s26
  s_lshl_b32 s27, s27, 16
  s_add_u32 s27, s27, s40
  s_lshl_b32 s37, s36, 1
  s_xor_b32 s37, s27, s37
  s_and_b32 s40, s25, 3
  s_lshl_b32 s40, s40, 18
  s_add_u32 s28, s40, s26
  s_lshr_b32 s40, s40, 5
  s_and_b32 s40, s40, 0x4000
  s_xor_b32 s28, s28, s40
  s_xor_b32 s29, s28, 0x4000
  s_add_u32 s33, s25, 33
  s_and_b32 s40, s33, 0x28
  s_mul_i32 s40, s40, 0x900
  s_and_b32 s40, s40, 0x6000
  s_xor_b32 s40, s40, s26
  s_lshl_b32 s33, s33, 16
  s_add_u32 s33, s33, s40
  s_xor_b32 s49, s33, 16384
  s_add_u32 s34, s25, 35
  s_and_b32 s40, s34, 0x28
  s_mul_i32 s40, s40, 0x900
  s_and_b32 s40, s40, 0x6000
  s_xor_b32 s40, s40, s26
  s_lshl_b32 s34, s34, 16
  s_add_u32 s34, s34, s40
  s_cmp_lt_u32 s25, 61
  s_cselect_b32 s34, s34, 2147483392
  s_sleep 4
L_VO_retry:
  buffer_load_dwordx4 v[4:7], v86, s[4:7], s37 offen offset:0 sc1
  s_nop 0
  buffer_load_dwordx4 v[8:11], v86, s[4:7], s37 offen offset:2048 sc1
  s_nop 0
  s_waitcnt vmcnt(1) lgkmcnt(0)
  buffer_load_dwordx4 v[68:71], v87, s[4:7], s27 offen offset:0 sc1
  buffer_load_dwordx4 v[72:75], v87, s[4:7], s27 offen offset:2048 sc1
  v_smfmac_f32_16x16x64_bf16 v[52:55], v[4:7], v[128:135], v88
  ds_write_b128 v1, v[4:7] offset:0
  v_max3_u32 v89, v4, v5, v6
  v_smfmac_f32_16x16x64_bf16 v[56:59], v[4:7], v[20:27], v88
  v_max3_u32 v89, v6, v7, v89
  s_nop 0
  s_waitcnt vmcnt(2)
  ds_write_b128 v1, v[8:11] offset:1024
  v_max3_u32 v89, v8, v9, v89
  v_max3_u32 v89, v10, v11, v89
  v_cmp_eq_u32_e64 vcc, -1, v89
  s_cbranch_vccnz L_VO_bad
  s_waitcnt lgkmcnt(0)
  s_barrier
  ds_read_b128 v[12:15], v2 offset:0
  ds_read_b128 v[16:19], v2 offset:1024
  v_smfmac_f32_16x16x64_bf16 v[52:55], v[8:11], v[136:143], v88
  ds_read_b128 v[4:7], v3 offset:0
  ds_read_b128 v[20:23], v85 offset:4096
  v_smfmac_f32_16x16x64_bf16 v[56:59], v[8:11], v[28:35], v88
  ds_read_b128 v[24:27], v85 offset:5120
  s_waitcnt lgkmcnt(4)
  v_smfmac_f32_16x16x64_bf16 v[52:55], v[12:15], v[144:151], v88
  ds_read_b128 v[8:11], v3 offset:1024
  ds_read_b128 v[28:31], v85 offset:12288
  v_smfmac_f32_16x16x64_bf16 v[56:59], v[12:15], v[36:43], v88
  ds_read_b128 v[32:35], v85 offset:13312
  s_waitcnt lgkmcnt(6)
  v_smfmac_f32_16x16x64_bf16 v[52:55], v[16:19], v[152:159], v88
  ds_read_b128 v[12:15], v84 offset:0
  ds_read_b128 v[36:39], v85 offset:6144
  v_smfmac_f32_16x16x64_bf16 v[56:59], v[16:19], v[44:51], v88
  ds_read_b128 v[40:43], v85 offset:7168
  s_waitcnt lgkmcnt(6)
  v_smfmac_f32_16x16x64_bf16 v[52:55], v[4:7], v[160:167], v88
  ds_read_b128 v[16:19], v84 offset:1024
  ds_read_b128 v[44:47], v85 offset:14336
  v_smfmac_f32_16x16x64_bf16 v[56:59], v[4:7], v[20:27], v88
  ds_read_b128 v[48:51], v85 offset:15360
  s_waitcnt lgkmcnt(6)
  v_smfmac_f32_16x16x64_bf16 v[52:55], v[8:11], v[168:175], v88
  ds_read_b128 v[20:23], v85 offset:16384
  v_smfmac_f32_16x16x64_bf16 v[56:59], v[8:11], v[28:35], v88
  ds_read_b128 v[24:27], v85 offset:17408
  s_waitcnt lgkmcnt(5)
  v_smfmac_f32_16x16x64_bf16 v[52:55], v[12:15], v[176:183], v88
  ds_read_b128 v[28:31], v85 offset:24576
  v_smfmac_f32_16x16x64_bf16 v[56:59], v[12:15], v[36:43], v88
  ds_read_b128 v[32:35], v85 offset:25600
  s_waitcnt lgkmcnt(4)
  s_waitcnt vmcnt(0)
  ds_write_b128 v1, v[68:71] offset:2048
  v_smfmac_f32_16x16x64_bf16 v[52:55], v[16:19], v[184:191], v88
  ds_write_b128 v1, v[72:75] offset:3072
  v_max3_u32 v89, v68, v69, v70
  v_max3_u32 v89, v70, v71, v89
  v_max3_u32 v89, v72, v73, v89
  v_smfmac_f32_16x16x64_bf16 v[56:59], v[16:19], v[44:51], v88
  v_max3_u32 v89, v74, v75, v89
  v_cmp_eq_u32 vcc, -1, v89
  ds_read_b128 v[36:39], v85 offset:18432
  ds_read_b128 v[40:43], v85 offset:19456
  s_cbranch_vccnz L_VO_rbad
L_VO_rok:
  s_waitcnt lgkmcnt(6)
  s_waitcnt lgkmcnt(2)
  s_barrier
  v_smfmac_f32_16x16x64_bf16 v[52:55], v[68:71], v[192:199], v88
  ds_read_b128 v[12:15], v2 offset:2048
  ds_read_b128 v[16:19], v2 offset:3072
  v_smfmac_f32_16x16x64_bf16 v[56:59], v[68:71], v[20:27], v88
  ds_read_b128 v[44:47], v85 offset:26624
  ds_read_b128 v[48:51], v85 offset:27648
  v_smfmac_f32_16x16x64_bf16 v[52:55], v[72:75], v[200:207], v88
  ds_read_b128 v[4:7], v3 offset:2048
  v_smfmac_f32_16x16x64_bf16 v[56:59], v[72:75], v[28:35], v88
  s_waitcnt lgkmcnt(4)
  v_smfmac_f32_16x16x64_bf16 v[52:55], v[12:15], v[208:215], v88
  ds_read_b128 v[8:11], v3 offset:3072
  ds_read_b128 v[28:31], v85 offset:28672
  v_smfmac_f32_16x16x64_bf16 v[56:59], v[12:15], v[36:43], v88
  ds_read_b128 v[32:35], v85 offset:29696
  s_waitcnt lgkmcnt(4)
  v_smfmac_f32_16x16x64_bf16 v[52:55], v[16:19], v[216:223], v88
  ds_read_b128 v[12:15], v84 offset:2048
  ds_read_b128 v[36:39], v85 offset:22528
  v_smfmac_f32_16x16x64_bf16 v[56:59], v[16:19], v[44:51], v88
  ds_read_b128 v[40:43], v85 offset:23552
  s_waitcnt lgkmcnt(6)
  v_smfmac_f32_16x16x64_bf16 v[52:55], v[4:7], v[224:231], v88
  ds_read_b128 v[16:19], v84 offset:3072
  ds_read_b128 v[44:47], v85 offset:30720
  v_smfmac_f32_16x16x64_bf16 v[56:59], v[4:7], v[116:123], v88
  ds_read_b128 v[48:51], v85 offset:31744
  s_waitcnt lgkmcnt(6)
  v_smfmac_f32_16x16x64_bf16 v[52:55], v[8:11], v[232:239], v88
  v_smfmac_f32_16x16x64_bf16 v[56:59], v[8:11], v[28:35], v88
  s_waitcnt lgkmcnt(3)
  v_smfmac_f32_16x16x64_bf16 v[52:55], v[12:15], v[240:247], v88
  v_smfmac_f32_16x16x64_bf16 v[56:59], v[12:15], v[36:43], v88
  s_waitcnt lgkmcnt(0)
  v_smfmac_f32_16x16x64_bf16 v[52:55], v[16:19], v[248:255], v88
  v_smfmac_f32_16x16x64_bf16 v[56:59], v[16:19], v[44:51], v88
  s_nop 6
  v_pk_add_f32 v[52:53], v[52:53], v[54:55]
  v_pk_add_f32 v[56:57], v[56:57], v[58:59]
  v_cvt_pk_bf16_f32 v100, v52, v53
  v_cvt_pk_bf16_f32 v101, v56, v57
  s_cmp_eq_u32 s36, 0
  s_cbranch_scc1 Lwt_180
  buffer_store_dwordx2 v[100:101], v92, s[4:7], s29 offen
  s_branch Lwtd_181
Lwt_180:
  buffer_store_dwordx2 v[100:101], v92, s[4:7], s29 offen sc1
Lwtd_181:
  s_cmp_ge_u32 s25, 63
  s_cbranch_scc1 L_VO_end
  s_add_u32 s42, s28, s58
  s_xor_b32 s30, s42, s36
  s_xor_b32 s31, s30, 4096
  s_xor_b32 s32, s42, 131072
  s_xor_b32 s48, s32, 4096
  s_add_u32 s41, s25, 1
  v_mov_b32 v94, s41
  s_xor_b32 s35, s29, 0x84000
  buffer_load_dword v76, v110, s[4:7], s59 offen sc1
  buffer_store_dword v80, v110, s[4:7], s34 offen sc1
  s_xor_b32 s59, s34, 16384
  buffer_store_dword v80, v110, s[4:7], s59 offen sc1
  s_cmp_eq_u32 s36, 0
  s_cbranch_scc1 Lwt_182
  buffer_store_dwordx2 v[80:81], v92, s[4:7], s35 offen
  s_branch Lwtd_183
Lwt_182:
  buffer_store_dwordx2 v[80:81], v92, s[4:7], s35 offen sc1
Lwtd_183:
  v_mov_b64 v[60:61], 0
  v_mov_b64 v[62:63], 0
  v_mov_b64 v[64:65], 0
  v_mov_b64 v[66:67], 0
  v_mov_b64 v[52:53], 0
  v_mov_b64 v[54:55], 0
  v_mov_b64 v[56:57], 0
  v_mov_b64 v[58:59], 0
  ds_read_b128 v[20:23], v85 offset:0
  ds_read_b128 v[24:27], v85 offset:1024
  ds_read_b128 v[28:31], v85 offset:8192
  ds_read_b128 v[32:35], v85 offset:9216
  ds_read_b128 v[36:39], v85 offset:2048
  ds_read_b128 v[40:43], v85 offset:3072
  ds_read_b128 v[44:47], v85 offset:10240
  ds_read_b128 v[48:51], v85 offset:11264
  s_cmp_eq_u32 s36, 0
  s_nop 0
  s_cbranch_scc1 Ltrigd_185
  s_mov_b64 exec, 0xffff
  s_sleep 4
  s_nop 0
  s_nop 0
  s_nop 0
  buffer_load_dword v76, v90, s[4:7], 0 offen offset:2048 sc1
  s_sleep 1
  buffer_load_dword v77, v90, s[4:7], 0 offen offset:2048 sc1
  s_sleep 1
  buffer_load_dword v78, v90, s[4:7], 0 offen offset:2048 sc1
  s_sleep 1
Ltrig_184:
  s_sub_u32 s24, s24, 1
  s_cbranch_scc1 L_FAIL
  buffer_load_dword v79, v90, s[4:7], 0 offen offset:2048 sc1
  s_nop 0
  s_waitcnt vmcnt(3)
  v_cmp_gt_i32_e64 vcc, s25, v76
  s_cbranch_vccz Ltrigd_185
  buffer_load_dword v76, v90, s[4:7], 0 offen offset:2048 sc1
  s_waitcnt vmcnt(3)
  v_cmp_gt_i32 vcc, s25, v77
  s_cbranch_vccz Ltrigd_185
  buffer_load_dword v77, v90, s[4:7], 0 offen offset:2048 sc1
  s_waitcnt vmcnt(3)
  v_cmp_gt_i32 vcc, s25, v78
  s_cbranch_vccz Ltrigd_185
  buffer_load_dword v78, v90, s[4:7], 0 offen offset:2048 sc1
  s_waitcnt vmcnt(3)
  v_cmp_gt_i32_e64 vcc, s25, v79
  s_cbranch_vccnz Ltrig_184
Ltrigd_185:
  s_mov_b64 exec, -1
L_VOO_again:
  buffer_load_dwordx4 v[4:7], v111, s[4:7], s30 offen sc1
  s_nop 0
  buffer_load_dwordx4 v[8:11], v112, s[4:7], s30 offen sc1
  s_nop 0
  buffer_load_dwordx4 v[12:15], v113, s[4:7], s30 offen sc1
  s_nop 0
  buffer_load_dwordx4 v[16:19], v114, s[4:7], s30 offen sc1
  s_nop 0
  buffer_load_dwordx4 v[68:71], v111, s[4:7], s31 offen sc1
  s_nop 0
  buffer_load_dwordx4 v[72:75], v112, s[4:7], s31 offen sc1
  s_nop 0
  s_nop 0
  s_waitcnt vmcnt(5)
  v_cmp_eq_u32_e64 vcc, -1, v4
  s_cbranch_vccnz L_VOO_g0
L_VOO_ok0:
  buffer_load_dwordx4 v[96:99], v113, s[4:7], s31 offen sc1
  v_smfmac_f32_16x16x64_bf16 v[60:63], v[4:7], a[0:7], v88
  s_waitcnt vmcnt(5)
  v_cmp_eq_u32 vcc, -1, v8
  v_smfmac_f32_16x16x64_bf16 v[64:67], v[4:7], a[8:15], v88
  s_cbranch_vccnz L_VOO_g1
L_VOO_ok1:
  buffer_load_dwordx4 v[4:7], v114, s[4:7], s31 offen sc1
  v_smfmac_f32_16x16x64_bf16 v[60:63], v[8:11], a[16:23], v88
  s_waitcnt vmcnt(5)
  v_cmp_eq_u32 vcc, -1, v12
  v_smfmac_f32_16x16x64_bf16 v[64:67], v[8:11], a[24:31], v88
  s_cbranch_vccnz L_VOO_g2
L_VOO_ok2:
  buffer_load_dwordx4 v[8:11], v111, s[4:7], s32 offen sc1
  v_smfmac_f32_16x16x64_bf16 v[60:63], v[12:15], a[32:39], v88
  s_waitcnt vmcnt(5)
  v_cmp_eq_u32 vcc, -1, v16
  v_smfmac_f32_16x16x64_bf16 v[64:67], v[12:15], a[40:47], v88
  s_cbranch_vccnz L_VOO_g3
L_VOO_ok3:
  buffer_load_dwordx4 v[12:15], v112, s[4:7], s32 offen sc1
  v_smfmac_f32_16x16x64_bf16 v[60:63], v[16:19], a[48:55], v88
  s_waitcnt vmcnt(5)
  v_cmp_eq_u32 vcc, -1, v68
  v_smfmac_f32_16x16x64_bf16 v[64:67], v[16:19], a[56:63], v88
  s_cbranch_vccnz L_VOO_g4
L_VOO_ok4:
  buffer_load_dwordx4 v[16:19], v113, s[4:7], s32 offen sc1
  v_smfmac_f32_16x16x64_bf16 v[60:63], v[68:71], a[64:71], v88
  s_waitcnt vmcnt(5)
  v_cmp_eq_u32 vcc, -1, v72
  v_smfmac_f32_16x16x64_bf16 v[64:67], v[68:71], a[72:79], v88
  s_cbranch_vccnz L_VOO_g5
L_VOO_ok5:
  buffer_load_dwordx4 v[68:71], v114, s[4:7], s32 offen sc1
  v_smfmac_f32_16x16x64_bf16 v[60:63], v[72:75], a[80:87], v88
  s_nop 0
  s_waitcnt vmcnt(5)
  v_cmp_eq_u32_e64 vcc, -1, v96
  v_smfmac_f32_16x16x64_bf16 v[64:67], v[72:75], a[88:95], v88
  s_cbranch_vccnz L_VOO_g6
L_VOO_ok6:
  buffer_load_dwordx4 v[72:75], v111, s[4:7], s48 offen sc1
  v_smfmac_f32_16x16x64_bf16 v[60:63], v[96:99], a[96:103], v88
  s_waitcnt vmcnt(5)
  v_cmp_eq_u32 vcc, -1, v4
  v_smfmac_f32_16x16x64_bf16 v[64:67], v[96:99], a[104:111], v88
  s_cbranch_vccnz L_VOO_g7
L_VOO_ok7:
  buffer_load_dwordx4 v[96:99], v112, s[4:7], s48 offen sc1
  v_smfmac_f32_16x16x64_bf16 v[60:63], v[4:7], a[112:119], v88
  s_waitcnt vmcnt(5)
  v_cmp_eq_u32 vcc, -1, v8
  v_smfmac_f32_16x16x64_bf16 v[64:67], v[4:7], a[120:127], v88
  s_cbranch_vccnz L_VOO_g8
L_VOO_ok8:
  buffer_load_dwordx4 v[4:7], v113, s[4:7], s48 offen sc1
  v_smfmac_f32_16x16x64_bf16 v[60:63], v[8:11], a[128:135], v88
  s_waitcnt vmcnt(5)
  v_cmp_eq_u32 vcc, -1, v12
  v_smfmac_f32_16x16x64_bf16 v[64:67], v[8:11], a[136:143], v88
  s_cbranch_vccnz L_VOO_g9
L_VOO_ok9:
  buffer_load_dwordx4 v[8:11], v114, s[4:7], s48 offen sc1
  v_smfmac_f32_16x16x64_bf16 v[60:63], v[12:15], a[144:151], v88
  s_waitcnt vmcnt(5)
  v_cmp_eq_u32 vcc, -1, v16
  v_smfmac_f32_16x16x64_bf16 v[64:67], v[12:15], a[152:159], v88
  s_cbranch_vccnz L_VOO_g10
L_VOO_ok10:
  v_smfmac_f32_16x16x64_bf16 v[60:63], v[16:19], a[160:167], v88
  s_waitcnt vmcnt(4)
  v_cmp_eq_u32 vcc, -1, v68
  v_smfmac_f32_16x16x64_bf16 v[64:67], v[16:19], a[168:175], v88
  s_cbranch_vccnz L_VOO_g11
L_VOO_ok11:
  v_smfmac_f32_16x16x64_bf16 v[60:63], v[68:71], a[176:183], v88
  s_waitcnt vmcnt(3)
  v_cmp_eq_u32 vcc, -1, v72
  v_smfmac_f32_16x16x64_bf16 v[64:67], v[68:71], a[184:191], v88
  s_cbranch_vccnz L_VOO_g12
L_VOO_ok12:
  v_smfmac_f32_16x16x64_bf16 v[60:63], v[72:75], a[192:199], v88
  s_waitcnt vmcnt(2)
  v_cmp_eq_u32 vcc, -1, v96
  v_smfmac_f32_16x16x64_bf16 v[64:67], v[72:75], a[200:207], v88
  s_cbranch_vccnz L_VOO_g13
L_VOO_ok13:
  v_smfmac_f32_16x16x64_bf16 v[60:63], v[96:99], a[208:215], v88
  s_waitcnt vmcnt(1)
  v_cmp_eq_u32 vcc, -1, v4
  v_smfmac_f32_16x16x64_bf16 v[64:67], v[96:99], a[216:223], v88
  s_cbranch_vccnz L_VOO_g14
L_VOO_ok14:
  v_smfmac_f32_16x16x64_bf16 v[60:63], v[4:7], a[224:231], v88
  s_waitcnt vmcnt(0)
  v_cmp_eq_u32_e64 vcc, -1, v8
  v_smfmac_f32_16x16x64_bf16 v[64:67], v[4:7], a[232:239], v88
  s_cbranch_vccnz L_VOO_g15
L_VOO_ok15:
  v_smfmac_f32_16x16x64_bf16 v[60:63], v[8:11], a[240:247], v88
  v_smfmac_f32_16x16x64_bf16 v[64:67], v[8:11], a[248:255], v88
L_VOO_join:
  s_nop 6
  v_add_f32 v100, v60, v62
  v_add_f32 v101, v64, v66
  v_add_f32 v102, v61, v63
  v_add_f32 v103, v65, v67
  ds_write_b64 v95, v[100:101]
  ds_write_b64 v95, v[102:103] offset:2048
  buffer_store_dword v94, v91, s[4:7], s57 offen
  v_cmp_u_f32 vcc, v100, v102
  s_cbranch_vccnz L_VOO_nan
L_VOO_done:
  s_waitcnt lgkmcnt(0)
  s_barrier
  ds_read_b128 v[100:103], v108
  ds_read_b128 v[104:107], v109
  s_waitcnt lgkmcnt(1)
  v_pk_add_f32 v[100:101], v[100:101], v[102:103]
  s_waitcnt lgkmcnt(0)
  v_pk_add_f32 v[104:105], v[104:105], v[106:107]
  v_pk_add_f32 v[100:101], v[100:101], v[104:105]
  v_cvt_pk_bf16_f32 v100, v100, v101
  buffer_store_dword v100, v110, s[4:7], s49 offen
  buffer_store_dword v100, v110, s[4:7], s33 offen sc1
  s_add_u32 s25, s25, 1
  s_branch L_VO_top
L_VO_end:
  s_branch L_END
L_VO_bad:
  s_nop 7
  s_sub_u32 s24, s24, 1
  s_cbranch_scc1 L_FAIL
  s_add_u32 s60, s60, 1
  v_mov_b64 v[52:53], 0
  v_mov_b64 v[54:55], 0
  v_mov_b64 v[56:57], 0
  v_mov_b64 v[58:59], 0
  s_nop 1
  s_branch L_VO_retry
L_VO_rbad:
  s_sub_u32 s24, s24, 1
  s_cbranch_scc1 L_FAIL
  s_add_u32 s60, s60, 0x10000
  s_waitcnt lgkmcnt(0)
  buffer_load_dwordx4 v[68:71], v87, s[4:7], s27 offen offset:0 sc1
  buffer_load_dwordx4 v[72:75], v87, s[4:7], s27 offen offset:2048 sc1
  s_waitcnt vmcnt(0)
  ds_write_b128 v1, v[68:71] offset:2048
  ds_write_b128 v1, v[72:75] offset:3072
  v_max3_u32 v89, v68, v69, v70
  v_max3_u32 v89, v70, v71, v89
  v_max3_u32 v89, v72, v73, v89
  v_max3_u32 v89, v74, v75, v89
  v_cmp_eq_u32 vcc, -1, v89
  s_waitcnt lgkmcnt(0)
  s_cbranch_vccnz L_VO_rbad
  s_branch L_VO_rok
L_VOO_nan:
  s_cmp_eq_u32 s51, s25
  s_cbranch_scc1 L_VOO_done
  s_mov_b32 s51, s25
  s_add_u32 s61, s61, 0x10000
  s_waitcnt vmcnt(0) lgkmcnt(0)
L_VOO_v0:
  s_sub_u32 s24, s24, 1
  s_cbranch_scc1 L_FAIL
  buffer_load_dwordx4 v[4:7], v111, s[4:7], s30 offen sc1
  buffer_load_dwordx4 v[8:11], v112, s[4:7], s30 offen sc1
  buffer_load_dwordx4 v[12:15], v113, s[4:7], s30 offen sc1
  buffer_load_dwordx4 v[16:19], v114, s[4:7], s30 offen sc1
  v_mov_b32 v89, 0
  s_waitcnt vmcnt(0)
  v_max3_u32 v89, v4, v5, v89
  v_max3_u32 v89, v6, v7, v89
  v_max3_u32 v89, v8, v9, v89
  v_max3_u32 v89, v10, v11, v89
  v_max3_u32 v89, v12, v13, v89
  v_max3_u32 v89, v14, v15, v89
  v_max3_u32 v89, v16, v17, v89
  v_max3_u32 v89, v18, v19, v89
  v_cmp_eq_u32 vcc, -1, v89
  s_cbranch_vccnz L_VOO_v0
L_VOO_v4:
  s_sub_u32 s24, s24, 1
  s_cbranch_scc1 L_FAIL
  buffer_load_dwordx4 v[68:71], v111, s[4:7], s31 offen sc1
  buffer_load_dwordx4 v[72:75], v112, s[4:7], s31 offen sc1
  buffer_load_dwordx4 v[96:99], v113, s[4:7], s31 offen sc1
  buffer_load_dwordx4 v[4:7], v114, s[4:7], s31 offen sc1
  v_mov_b32 v89, 0
  s_waitcnt vmcnt(0)
  v_max3_u32 v89, v68, v69, v89
  v_max3_u32 v89, v70, v71, v89
  v_max3_u32 v89, v72, v73, v89
  v_max3_u32 v89, v74, v75, v89
  v_max3_u32 v89, v96, v97, v89
  v_max3_u32 v89, v98, v99, v89
  v_max3_u32 v89, v4, v5, v89
  v_max3_u32 v89, v6, v7, v89
  v_cmp_eq_u32 vcc, -1, v89
  s_cbranch_vccnz L_VOO_v4
L_VOO_v8:
  s_sub_u32 s24, s24, 1
  s_cbranch_scc1 L_FAIL
  buffer_load_dwordx4 v[8:11], v111, s[4:7], s32 offen sc1
  buffer_load_dwordx4 v[12:15], v112, s[4:7], s32 offen sc1
  buffer_load_dwordx4 v[16:19], v113, s[4:7], s32 offen sc1
  buffer_load_dwordx4 v[68:71], v114, s[4:7], s32 offen sc1
  v_mov_b32 v89, 0
  s_waitcnt vmcnt(0)
  v_max3_u32 v89, v8, v9, v89
  v_max3_u32 v89, v10, v11, v89
  v_max3_u32 v89, v12, v13, v89
  v_max3_u32 v89, v14, v15, v89
  v_max3_u32 v89, v16, v17, v89
  v_max3_u32 v89, v18, v19, v89
  v_max3_u32 v89, v68, v69, v89
  v_max3_u32 v89, v70, v71, v89
  v_cmp_eq_u32 vcc, -1, v89
  s_cbranch_vccnz L_VOO_v8
L_VOO_v12:
  s_sub_u32 s24, s24, 1
  s_cbranch_scc1 L_FAIL
  buffer_load_dwordx4 v[72:75], v111, s[4:7], s48 offen sc1
  buffer_load_dwordx4 v[96:99], v112, s[4:7], s48 offen sc1
  buffer_load_dwordx4 v[4:7], v113, s[4:7], s48 offen sc1
  buffer_load_dwordx4 v[8:11], v114, s[4:7], s48 offen sc1
  v_mov_b32 v89, 0
  s_waitcnt vmcnt(0)
  v_max3_u32 v89, v72, v73, v89
  v_max3_u32 v89, v74, v75, v89
  v_max3_u32 v89, v96, v97, v89
  v_max3_u32 v89, v98, v99, v89
  v_max3_u32 v89, v4, v5, v89
  v_max3_u32 v89, v6, v7, v89
  v_max3_u32 v89, v8, v9, v89
  v_max3_u32 v89, v10, v11, v89
  v_cmp_eq_u32 vcc, -1, v89
  s_cbranch_vccnz L_VOO_v12
  v_mov_b64 v[60:61], 0
  v_mov_b64 v[62:63], 0
  v_mov_b64 v[64:65], 0
  v_mov_b64 v[66:67], 0
L_VOOS_again:
  buffer_load_dwordx4 v[4:7], v111, s[4:7], s30 offen sc1
  s_nop 0
  buffer_load_dwordx4 v[8:11], v112, s[4:7], s30 offen sc1
  s_nop 0
  buffer_load_dwordx4 v[12:15], v113, s[4:7], s30 offen sc1
  s_nop 0
  buffer_load_dwordx4 v[16:19], v114, s[4:7], s30 offen sc1
  s_nop 0
  buffer_load_dwordx4 v[68:71], v111, s[4:7], s31 offen sc1
  s_nop 0
  buffer_load_dwordx4 v[72:75], v112, s[4:7], s31 offen sc1
  s_nop 0
  s_waitcnt vmcnt(5)
  buffer_load_dwordx4 v[96:99], v113, s[4:7], s31 offen sc1
  v_smfmac_f32_16x16x64_bf16 v[60:63], v[4:7], a[0:7], v88
  s_waitcnt vmcnt(5)
  v_smfmac_f32_16x16x64_bf16 v[64:67], v[4:7], a[8:15], v88
  buffer_load_dwordx4 v[4:7], v114, s[4:7], s31 offen sc1
  v_smfmac_f32_16x16x64_bf16 v[60:63], v[8:11], a[16:23], v88
  s_waitcnt vmcnt(5)
  v_smfmac_f32_16x16x64_bf16 v[64:67], v[8:11], a[24:31], v88
  buffer_load_dwordx4 v[8:11], v111, s[4:7], s32 offen sc1
  v_smfmac_f32_16x16x64_bf16 v[60:63], v[12:15], a[32:39], v88
  s_waitcnt vmcnt(5)
  v_smfmac_f32_16x16x64_bf16 v[64:67], v[12:15], a[40:47], v88
  buffer_load_dwordx4 v[12:15], v112, s[4:7], s32 offen sc1
  v_smfmac_f32_16x16x64_bf16 v[60:63], v[16:19], a[48:55], v88
  s_waitcnt vmcnt(5)
  v_smfmac_f32_16x16x64_bf16 v[64:67], v[16:19], a[56:63], v88
  buffer_load_dwordx4 v[16:19], v113, s[4:7], s32 offen sc1
  v_smfmac_f32_16x16x64_bf16 v[60:63], v[68:71], a[64:71], v88
  s_waitcnt vmcnt(5)
  v_smfmac_f32_16x16x64_bf16 v[64:67], v[68:71], a[72:79], v88
  buffer_load_dwordx4 v[68:71], v114, s[4:7], s32 offen sc1
  v_smfmac_f32_16x16x64_bf16 v[60:63], v[72:75], a[80:87], v88
  s_waitcnt vmcnt(5)
  v_smfmac_f32_16x16x64_bf16 v[64:67], v[72:75], a[88:95], v88
  buffer_load_dwordx4 v[72:75], v111, s[4:7], s48 offen sc1
  v_smfmac_f32_16x16x64_bf16 v[60:63], v[96:99], a[96:103], v88
  s_waitcnt vmcnt(5)
  v_smfmac_f32_16x16x64_bf16 v[64:67], v[96:99], a[104:111], v88
  buffer_load_dwordx4 v[96:99], v112, s[4:7], s48 offen sc1
  v_smfmac_f32_16x16x64_bf16 v[60:63], v[4:7], a[112:119], v88
  s_waitcnt vmcnt(5)
  v_smfmac_f32_16x16x64_bf16 v[64:67], v[4:7], a[120:127], v88
  buffer_load_dwordx4 v[4:7], v113, s[4:7], s48 offen sc1
  v_smfmac_f32_16x16x64_bf16 v[60:63], v[8:11], a[128:135], v88
  s_waitcnt vmcnt(5)
  v_smfmac_f32_16x16x64_bf16 v[64:67], v[8:11], a[136:143], v88
  buffer_load_dwordx4 v[8:11], v114, s[4:7], s48 offen sc1
  v_smfmac_f32_16x16x64_bf16 v[60:63], v[12:15], a[144:151], v88
  s_waitcnt vmcnt(5)
  v_smfmac_f32_16x16x64_bf16 v[64:67], v[12:15], a[152:159], v88
  v_smfmac_f32_16x16x64_bf16 v[60:63], v[16:19], a[160:167], v88
  s_waitcnt vmcnt(4)
  v_smfmac_f32_16x16x64_bf16 v[64:67], v[16:19], a[168:175], v88
  v_smfmac_f32_16x16x64_bf16 v[60:63], v[68:71], a[176:183], v88
  s_waitcnt vmcnt(3)
  v_smfmac_f32_16x16x64_bf16 v[64:67], v[68:71], a[184:191], v88
  v_smfmac_f32_16x16x64_bf16 v[60:63], v[72:75], a[192:199], v88
  s_waitcnt vmcnt(2)
  v_smfmac_f32_16x16x64_bf16 v[64:67], v[72:75], a[200:207], v88
  v_smfmac_f32_16x16x64_bf16 v[60:63], v[96:99], a[208:215], v88
  s_waitcnt vmcnt(1)
  v_smfmac_f32_16x16x64_bf16 v[64:67], v[96:99], a[216:223], v88
  v_smfmac_f32_16x16x64_bf16 v[60:63], v[4:7], a[224:231], v88
  s_waitcnt vmcnt(0)
  v_smfmac_f32_16x16x64_bf16 v[64:67], v[4:7], a[232:239], v88
  v_smfmac_f32_16x16x64_bf16 v[60:63], v[8:11], a[240:247], v88
  v_smfmac_f32_16x16x64_bf16 v[64:67], v[8:11], a[248:255], v88
  s_nop 7
  s_branch L_VOO_join
L_VOO_g0:
  s_sub_u32 s24, s24, 1
  s_cbranch_scc1 L_FAIL
  s_add_u32 s61, s61, 1
  buffer_load_dwordx4 v[4:7], v111, s[4:7], s30 offen sc1
  s_waitcnt vmcnt(0)
  v_cmp_eq_u32 vcc, -1, v4
  s_cbranch_vccnz L_VOO_g0
  v_mov_b32 v89, 0
  v_max3_u32 v89, v8, v12, v89
  v_max3_u32 v89, v16, v68, v89
  v_max3_u32 v89, v72, v72, v89
  v_cmp_eq_u32 vcc, -1, v89
  s_cbranch_vccz L_VOO_ok0
  buffer_load_dwordx4 v[8:11], v112, s[4:7], s30 offen sc1
  s_nop 0
  buffer_load_dwordx4 v[12:15], v113, s[4:7], s30 offen sc1
  s_nop 0
  buffer_load_dwordx4 v[16:19], v114, s[4:7], s30 offen sc1
  s_nop 0
  buffer_load_dwordx4 v[68:71], v111, s[4:7], s31 offen sc1
  s_nop 0
  buffer_load_dwordx4 v[72:75], v112, s[4:7], s31 offen sc1
  s_nop 0
  s_branch L_VOO_ok0
L_VOO_g1:
  s_sub_u32 s24, s24, 1
  s_cbranch_scc1 L_FAIL
  s_add_u32 s61, s61, 1
  buffer_load_dwordx4 v[8:11], v112, s[4:7], s30 offen sc1
  s_waitcnt vmcnt(0)
  v_cmp_eq_u32 vcc, -1, v8
  s_cbranch_vccnz L_VOO_g1
  v_mov_b32 v89, 0
  v_max3_u32 v89, v12, v16, v89
  v_max3_u32 v89, v68, v72, v89
  v_max3_u32 v89, v96, v96, v89
  v_cmp_eq_u32 vcc, -1, v89
  s_cbranch_vccz L_VOO_ok1
  buffer_load_dwordx4 v[12:15], v113, s[4:7], s30 offen sc1
  s_nop 0
  buffer_load_dwordx4 v[16:19], v114, s[4:7], s30 offen sc1
  s_nop 0
  buffer_load_dwordx4 v[68:71], v111, s[4:7], s31 offen sc1
  s_nop 0
  buffer_load_dwordx4 v[72:75], v112, s[4:7], s31 offen sc1
  s_nop 0
  buffer_load_dwordx4 v[96:99], v113, s[4:7], s31 offen sc1
  s_nop 0
  s_branch L_VOO_ok1
L_VOO_g2:
  s_sub_u32 s24, s24, 1
  s_cbranch_scc1 L_FAIL
  s_add_u32 s61, s61, 1
  buffer_load_dwordx4 v[12:15], v113, s[4:7], s30 offen sc1
  s_waitcnt vmcnt(0)
  v_cmp_eq_u32 vcc, -1, v12
  s_cbranch_vccnz L_VOO_g2
  v_mov_b32 v89, 0
  v_max3_u32 v89, v16, v68, v89
  v_max3_u32 v89, v72, v96, v89
  v_max3_u32 v89, v4, v4, v89
  v_cmp_eq_u32 vcc, -1, v89
  s_cbranch_vccz L_VOO_ok2
  buffer_load_dwordx4 v[16:19], v114, s[4:7], s30 offen sc1
  s_nop 0
  buffer_load_dwordx4 v[68:71], v111, s[4:7], s31 offen sc1
  s_nop 0
  buffer_load_dwordx4 v[72:75], v112, s[4:7], s31 offen sc1
  s_nop 0
  buffer_load_dwordx4 v[96:99], v113, s[4:7], s31 offen sc1
  s_nop 0
  buffer_load_dwordx4 v[4:7], v114, s[4:7], s31 offen sc1
  s_nop 0
  s_branch L_VOO_ok2
L_VOO_g3:
  s_sub_u32 s24, s24, 1
  s_cbranch_scc1 L_FAIL
  s_add_u32 s61, s61, 1
  buffer_load_dwordx4 v[16:19], v114, s[4:7], s30 offen sc1
  s_waitcnt vmcnt(0)
  v_cmp_eq_u32 vcc, -1, v16
  s_cbranch_vccnz L_VOO_g3
  v_mov_b32 v89, 0
  v_max3_u32 v89, v68, v72, v89
  v_max3_u32 v89, v96, v4, v89
  v_max3_u32 v89, v8, v8, v89
  v_cmp_eq_u32 vcc, -1, v89
  s_cbranch_vccz L_VOO_ok3
  buffer_load_dwordx4 v[68:71], v111, s[4:7], s31 offen sc1
  s_nop 0
  buffer_load_dwordx4 v[72:75], v112, s[4:7], s31 offen sc1
  s_nop 0
  buffer_load_dwordx4 v[96:99], v113, s[4:7], s31 offen sc1
  s_nop 0
  buffer_load_dwordx4 v[4:7], v114, s[4:7], s31 offen sc1
  s_nop 0
  buffer_load_dwordx4 v[8:11], v111, s[4:7], s32 offen sc1
  s_nop 0
  s_branch L_VOO_ok3
L_VOO_g4:
  s_sub_u32 s24, s24, 1
  s_cbranch_scc1 L_FAIL
  s_add_u32 s61, s61, 1
  buffer_load_dwordx4 v[68:71], v111, s[4:7], s31 offen sc1
  s_waitcnt vmcnt(0)
  v_cmp_eq_u32 vcc, -1, v68
  s_cbranch_vccnz L_VOO_g4
  v_mov_b32 v89, 0
  v_max3_u32 v89, v72, v96, v89
  v_max3_u32 v89, v4, v8, v89
  v_max3_u32 v89, v12, v12, v89
  v_cmp_eq_u32 vcc, -1, v89
  s_cbranch_vccz L_VOO_ok4
  buffer_load_dwordx4 v[72:75], v112, s[4:7], s31 offen sc1
  s_nop 0
  buffer_load_dwordx4 v[96:99], v113, s[4:7], s31 offen sc1
  s_nop 0
  buffer_load_dwordx4 v[4:7], v114, s[4:7], s31 offen sc1
  s_nop 0
  buffer_load_dwordx4 v[8:11], v111, s[4:7], s32 offen sc1
  s_nop 0
  buffer_load_dwordx4 v[12:15], v112, s[4:7], s32 offen sc1
  s_nop 0
  s_branch L_VOO_ok4
L_VOO_g5:
  s_sub_u32 s24, s24, 1
  s_cbranch_scc1 L_FAIL
  s_add_u32 s61, s61, 1
  buffer_load_dwordx4 v[72:75], v112, s[4:7], s31 offen sc1
  s_waitcnt vmcnt(0)
  v_cmp_eq_u32 vcc, -1, v72
  s_cbranch_vccnz L_VOO_g5
  v_mov_b32 v89, 0
  v_max3_u32 v89, v96, v4, v89
  v_max3_u32 v89, v8, v12, v89
  v_max3_u32 v89, v16, v16, v89
  v_cmp_eq_u32 vcc, -1, v89
  s_cbranch_vccz L_VOO_ok5
  buffer_load_dwordx4 v[96:99], v113, s[4:7], s31 offen sc1
  s_nop 0
  buffer_load_dwordx4 v[4:7], v114, s[4:7], s31 offen sc1
  s_nop 0
  buffer_load_dwordx4 v[8:11], v111, s[4:7], s32 offen sc1
  s_nop 0
  buffer_load_dwordx4 v[12:15], v112, s[4:7], s32 offen sc1
  s_nop 0
  buffer_load_dwordx4 v[16:19], v113, s[4:7], s32 offen sc1
  s_nop 0
  s_branch L_VOO_ok5
L_VOO_g6:
  s_sub_u32 s24, s24, 1
  s_cbranch_scc1 L_FAIL
  s_add_u32 s61, s61, 1
  buffer_load_dwordx4 v[96:99], v113, s[4:7], s31 offen sc1
  s_waitcnt vmcnt(0)
  v_cmp_eq_u32 vcc, -1, v96
  s_cbranch_vccnz L_VOO_g6
  v_mov_b32 v89, 0
  v_max3_u32 v89, v4, v8, v89
  v_max3_u32 v89, v12, v16, v89
  v_max3_u32 v89, v68, v68, v89
  v_cmp_eq_u32 vcc, -1, v89
  s_cbranch_vccz L_VOO_ok6
  buffer_load_dwordx4 v[4:7], v114, s[4:7], s31 offen sc1
  s_nop 0
  buffer_load_dwordx4 v[8:11], v111, s[4:7], s32 offen sc1
  s_nop 0
  buffer_load_dwordx4 v[12:15], v112, s[4:7], s32 offen sc1
  s_nop 0
  buffer_load_dwordx4 v[16:19], v113, s[4:7], s32 offen sc1
  s_nop 0
  buffer_load_dwordx4 v[68:71], v114, s[4:7], s32 offen sc1
  s_nop 0
  s_branch L_VOO_ok6
L_VOO_g7:
  s_sub_u32 s24, s24, 1
  s_cbranch_scc1 L_FAIL
  s_add_u32 s61, s61, 1
  buffer_load_dwordx4 v[4:7], v114, s[4:7], s31 offen sc1
  s_waitcnt vmcnt(0)
  v_cmp_eq_u32 vcc, -1, v4
  s_cbranch_vccnz L_VOO_g7
  v_mov_b32 v89, 0
  v_max3_u32 v89, v8, v12, v89
  v_max3_u32 v89, v16, v68, v89
  v_max3_u32 v89, v72, v72, v89
  v_cmp_eq_u32 vcc, -1, v89
  s_cbranch_vccz L_VOO_ok7
  buffer_load_dwordx4 v[8:11], v111, s[4:7], s32 offen sc1
  s_nop 0
  buffer_load_dwordx4 v[12:15], v112, s[4:7], s32 offen sc1
  s_nop 0
  buffer_load_dwordx4 v[16:19], v113, s[4:7], s32 offen sc1
  s_nop 0
  buffer_load_dwordx4 v[68:71], v114, s[4:7], s32 offen sc1
  s_nop 0
  buffer_load_dwordx4 v[72:75], v111, s[4:7], s48 offen sc1
  s_nop 0
  s_branch L_VOO_ok7
L_VOO_g8:
  s_sub_u32 s24, s24, 1
  s_cbranch_scc1 L_FAIL
  s_add_u32 s61, s61, 256
  buffer_load_dwordx4 v[8:11], v111, s[4:7], s32 offen sc1
  s_waitcnt vmcnt(0)
  v_cmp_eq_u32 vcc, -1, v8
  s_cbranch_vccnz L_VOO_g8
  v_mov_b32 v89, 0
  v_max3_u32 v89, v12, v16, v89
  v_max3_u32 v89, v68, v72, v89
  v_max3_u32 v89, v96, v96, v89
  v_cmp_eq_u32 vcc, -1, v89
  s_cbranch_vccz L_VOO_ok8
  buffer_load_dwordx4 v[12:15], v112, s[4:7], s32 offen sc1
  s_nop 0
  buffer_load_dwordx4 v[16:19], v113, s[4:7], s32 offen sc1
  s_nop 0
  buffer_load_dwordx4 v[68:71], v114, s[4:7], s32 offen sc1
  s_nop 0
  buffer_load_dwordx4 v[72:75], v111, s[4:7], s48 offen sc1
  s_nop 0
  buffer_load_dwordx4 v[96:99], v112, s[4:7], s48 offen sc1
  s_nop 0
  s_branch L_VOO_ok8
L_VOO_g9:
  s_sub_u32 s24, s24, 1
  s_cbranch_scc1 L_FAIL
  s_add_u32 s61, s61, 256
  buffer_load_dwordx4 v[12:15], v112, s[4:7], s32 offen sc1
  s_waitcnt vmcnt(0)
  v_cmp_eq_u32 vcc, -1, v12
  s_cbranch_vccnz L_VOO_g9
  v_mov_b32 v89, 0
  v_max3_u32 v89, v16, v68, v89
  v_max3_u32 v89, v72, v96, v89
  v_max3_u32 v89, v4, v4, v89
  v_cmp_eq_u32 vcc, -1, v89
  s_cbranch_vccz L_VOO_ok9
  buffer_load_dwordx4 v[16:19], v113, s[4:7], s32 offen sc1
  s_nop 0
  buffer_load_dwordx4 v[68:71], v114, s[4:7], s32 offen sc1
  s_nop 0
  buffer_load_dwordx4 v[72:75], v111, s[4:7], s48 offen sc1
  s_nop 0
  buffer_load_dwordx4 v[96:99], v112, s[4:7], s48 offen sc1
  s_nop 0
  buffer_load_dwordx4 v[4:7], v113, s[4:7], s48 offen sc1
  s_nop 0
  s_branch L_VOO_ok9
L_VOO_g10:
  s_sub_u32 s24, s24, 1
  s_cbranch_scc1 L_FAIL
  s_add_u32 s61, s61, 256
  buffer_load_dwordx4 v[16:19], v113, s[4:7], s32 offen sc1
  s_waitcnt vmcnt(0)
  v_cmp_eq_u32 vcc, -1, v16
  s_cbranch_vccnz L_VOO_g10
  v_mov_b32 v89, 0
  v_max3_u32 v89, v68, v72, v89
  v_max3_u32 v89, v96, v4, v89
  v_max3_u32 v89, v8, v8, v89
  v_cmp_eq_u32 vcc, -1, v89
  s_cbranch_vccz L_VOO_ok10
  buffer_load_dwordx4 v[68:71], v114, s[4:7], s32 offen sc1
  s_nop 0
  buffer_load_dwordx4 v[72:75], v111, s[4:7], s48 offen sc1
  s_nop 0
  buffer_load_dwordx4 v[96:99], v112, s[4:7], s48 offen sc1
  s_nop 0
  buffer_load_dwordx4 v[4:7], v113, s[4:7], s48 offen sc1
  s_nop 0
  buffer_load_dwordx4 v[8:11], v114, s[4:7], s48 offen sc1
  s_nop 0
  s_branch L_VOO_ok10
L_VOO_g11:
  s_sub_u32 s24, s24, 1
  s_cbranch_scc1 L_FAIL
  s_add_u32 s61, s61, 256
  buffer_load_dwordx4 v[68:71], v114, s[4:7], s32 offen sc1
  s_waitcnt vmcnt(0)
  v_cmp_eq_u32 vcc, -1, v68
  s_cbranch_vccnz L_VOO_g11
  v_mov_b32 v89, 0
  v_max3_u32 v89, v72, v96, v89
  v_max3_u32 v89, v4, v8, v89
  v_cmp_eq_u32 vcc, -1, v89
  s_cbranch_vccz L_VOO_ok11
  buffer_load_dwordx4 v[72:75], v111, s[4:7], s48 offen sc1
  s_nop 0
  buffer_load_dwordx4 v[96:99], v112, s[4:7], s48 offen sc1
  s_nop 0
  buffer_load_dwordx4 v[4:7], v113, s[4:7], s48 offen sc1
  s_nop 0
  buffer_load_dwordx4 v[8:11], v114, s[4:7], s48 offen sc1
  s_nop 0
  s_branch L_VOO_ok11
L_VOO_g12:
  s_sub_u32 s24, s24, 1
  s_cbranch_scc1 L_FAIL
  s_add_u32 s61, s61, 256
  buffer_load_dwordx4 v[72:75], v111, s[4:7], s48 offen sc1
  s_waitcnt vmcnt(0)
  v_cmp_eq_u32 vcc, -1, v72
  s_cbranch_vccnz L_VOO_g12
  v_mov_b32 v89, 0
  v_max3_u32 v89, v96, v4, v89
  v_max3_u32 v89, v8, v8, v89
  v_cmp_eq_u32 vcc, -1, v89
  s_cbranch_vccz L_VOO_ok12
  buffer_load_dwordx4 v[96:99], v112, s[4:7], s48 offen sc1
  s_nop 0
  buffer_load_dwordx4 v[4:7], v113, s[4:7], s48 offen sc1
  s_nop 0
  buffer_load_dwordx4 v[8:11], v114, s[4:7], s48 offen sc1
  s_nop 0
  s_branch L_VOO_ok12
L_VOO_g13:
  s_sub_u32 s24, s24, 1
  s_cbranch_scc1 L_FAIL
  s_add_u32 s61, s61, 256
  buffer_load_dwordx4 v[96:99], v112, s[4:7], s48 offen sc1
  s_waitcnt vmcnt(0)
  v_cmp_eq_u32 vcc, -1, v96
  s_cbranch_vccnz L_VOO_g13
  v_mov_b32 v89, 0
  v_max3_u32 v89, v4, v8, v89
  v_cmp_eq_u32 vcc, -1, v89
  s_cbranch_vccz L_VOO_ok13
  buffer_load_dwordx4 v[4:7], v113, s[4:7], s48 offen sc1
  s_nop 0
  buffer_load_dwordx4 v[8:11], v114, s[4:7], s48 offen sc1
  s_nop 0
  s_branch L_VOO_ok13
L_VOO_g14:
  s_sub_u32 s24, s24, 1
  s_cbranch_scc1 L_FAIL
  s_add_u32 s61, s61, 256
  buffer_load_dwordx4 v[4:7], v113, s[4:7], s48 offen sc1
  s_waitcnt vmcnt(0)
  v_cmp_eq_u32 vcc, -1, v4
  s_cbranch_vccnz L_VOO_g14
  v_mov_b32 v89, 0
  v_max3_u32 v89, v8, v8, v89
  v_cmp_eq_u32 vcc, -1, v89
  s_cbranch_vccz L_VOO_ok14
  buffer_load_dwordx4 v[8:11], v114, s[4:7], s48 offen sc1
  s_nop 0
  s_branch L_VOO_ok14
L_VOO_g15:
  s_sub_u32 s24, s24, 1
  s_cbranch_scc1 L_FAIL
  s_add_u32 s61, s61, 256
  buffer_load_dwordx4 v[8:11], v114, s[4:7], s48 offen sc1
  s_waitcnt vmcnt(0)
  v_cmp_eq_u32 vcc, -1, v8
  s_cbranch_vccnz L_VOO_g15
  s_branch L_VOO_ok15
L_LAST:
  s_endpgm
.section .rodata,"a"
.p2align 6
.amdhsa_kernel adaLN_cond__memory_aug_recurrent_mem_tr__glu_gated_swiglu__prompt_kernel
  .amdhsa_next_free_vgpr 512
  .amdhsa_next_free_sgpr 102
  .amdhsa_accum_offset 256
  .amdhsa_group_segment_fixed_size 0
  .amdhsa_kernarg_size 128
  .amdhsa_user_sgpr_count 2
  .amdhsa_user_sgpr_kernarg_segment_ptr 1
  .amdhsa_system_sgpr_workgroup_id_x 1
  .amdhsa_float_denorm_mode_32 3
.end_amdhsa_kernel
```
